```python
import torch

def _softmax(x, axis=-1):
    return torch.softmax(x, dim=axis)
def _gelu(x):
    return torch.nn.functional.gelu(x, approximate="tanh")
def _silu(x):
    return torch.nn.functional.silu(x)
def _sigmoid(x):
    return torch.sigmoid(x)
def _layernorm(x, axis=-1, eps=1e-5):
    m = x.mean(dim=axis, keepdim=True)
    v = x.var(dim=axis, keepdim=True, unbiased=False)
    return (x - m) / torch.sqrt(v + eps)
def _scatter_add(tgt, idx, src, axis=0):
    return tgt.clone().index_add_(axis, idx, src)
def _segment_sum(src, seg, n):
    out = torch.zeros((n,) + src.shape[1:], dtype=src.dtype)
    return out.index_add_(0, seg, src)
def _pad(x, pw):
    flat = tuple(v for pair in reversed(pw) for v in pair)
    return torch.nn.functional.pad(x, flat)

kernel_name = 'sequential_preLN__sliding_local_dilated__mixer_token_mlp__prompt'

def setup_inputs():

    _w = (lambda a: (lambda t: t.to(torch.bfloat16) if t.is_floating_point() else t)(torch.as_tensor(a)))
    def _A_setup():
        B, S, D = 1, 2048, 448
        return {
            "x": _w((lambda *s: torch.randn(*s, dtype=torch.bfloat16) * 0.05)(B, S, D)),
            "wqkv": _w((lambda *s: torch.randn(*s, dtype=torch.bfloat16) * 0.05)(D, 3 * D)),
            "wo": _w((lambda *s: torch.randn(*s, dtype=torch.bfloat16) * 0.05)(D, D)),
        }
    _A_in = _A_setup()

    def _B_setup():
        B, S, D, F = 1, 2048, 448, 1792
        return {
            "x": _w((lambda *s: torch.randn(*s, dtype=torch.bfloat16) * 0.05)(B, S, D)),
            "w1": _w((lambda *s: torch.randn(*s, dtype=torch.bfloat16) * 1.6)(S, F) * (S ** -0.5)),
            "b1": _w((lambda *s: torch.randn(*s, dtype=torch.bfloat16) * 12.8)(F) * 0.02),
            "w2": _w((lambda *s: torch.randn(*s, dtype=torch.bfloat16) * 0.4)(F, S) * (F ** -0.5)),
            "b2": _w((lambda *s: torch.randn(*s, dtype=torch.bfloat16) * 6.4)(S) * 0.02),
        }
    _B_in = _B_setup()

    return {
        "A_x": _A_in["x"],
        "A_wqkv": _A_in["wqkv"],
        "A_wo": _A_in["wo"],
        "B_x": _B_in["x"],
        "B_w1": _B_in["w1"],
        "B_b1": _B_in["b1"],
        "B_w2": _B_in["w2"],
        "B_b2": _B_in["b2"],
    }

def reference(A_x, A_wqkv, A_wo, B_x, B_w1, B_b1, B_w2, B_b2):
    def _A_ref(x, wqkv, wo):
        B, S, D = x.shape
        H = 16; Dh = D // H
        W, dil = 8, 2
        qkv = (lambda x, *d: x.permute(*d))((x @ wqkv).reshape(B, S, 3, H, Dh), 2, 0, 3, 1, 4)
        q, k, v = qkv[0], qkv[1], qkv[2]
        scale = Dh ** -0.5
        pos = torch.arange(S)
        off = torch.arange(W) * dil
        idx = pos[:, None] - off[None, :]
        mask = idx >= 0
        idx_c = torch.where(mask, idx, 0).reshape(-1)
        kg = k[:, :, idx_c, :].reshape(B, H, S, W, Dh)
        vg = v[:, :, idx_c, :].reshape(B, H, S, W, Dh)
        logits = torch.einsum("bhsd,bhswd->bhsw", q, kg) * scale
        logits = torch.where(mask[None, None, :, :], logits, -1e9)
        attn = _softmax(logits, axis=-1)
        o = torch.einsum("bhsw,bhswd->bhsd", attn, vg)
        return (lambda x, *d: x.permute(*d))(o, 0, 2, 1, 3).reshape(B, S, D) @ wo

    def _B_ref(x, w1, b1, w2, b2):
        B, S, D = x.shape
        h = _layernorm(x, axis=-1)
        u = torch.einsum("bsd,sf->bdf", h, w1) + b1
        u = _gelu(u)
        y = torch.einsum("bdf,fs->bds", u, w2) + b2
        return (lambda x, *d: x.permute(*d))(y, 0, 2, 1)

    x = A_x
    h = x + _A_ref(_layernorm(x, axis=-1), A_wqkv, A_wo)
    h2 = h + _B_ref(_layernorm(h, axis=-1), B_w1, B_b1, B_w2, B_b2)
    return h2
```

```asm
; @launch kernel=phaseA_kernel grid=(256,1,1) block=(256,1,1) lds=98304
; @launch kernel=phaseB_kernel grid=(256,1,1) block=(256,1,1) lds=151552
; @launch kernel=phaseC_kernel grid=(256,1,1) block=(256,1,1) lds=131072
; @launch kernel=phaseD_kernel grid=(256,1,1) block=(256,1,1) lds=131072
.amdgcn_target "amdgcn-amd-amdhsa--gfx950"
.text
.globl phaseA_kernel
.p2align 8
.type phaseA_kernel,@function
phaseA_kernel:
    s_cmp_ge_u32 s2, 256
    s_cbranch_scc1 L_end_A
    s_load_dwordx2 s[8:9], s[0:1], 0
    s_load_dwordx2 s[12:13], s[0:1], 8
    s_load_dwordx2 s[40:41], s[0:1], 80
    v_lshrrev_b32 v1, 6, v0
    s_nop 0
    v_readfirstlane_b32 s3, v1
    v_and_b32 v1, 63, v0
    v_and_b32 v2, 15, v0
    v_lshrrev_b32 v3, 4, v1
    v_lshlrev_b32 v4, 4, v1
    s_mov_b32 s10, 0x1c0000
    s_mov_b32 s11, 0x00020000
    s_mov_b32 s14, 0x126000
    s_mov_b32 s15, 0x00020000
    s_mov_b32 s42, 0x900000
    s_mov_b32 s43, 0x00020000
    s_mov_b32 s5, 0x3f803f80
    s_and_b32 s48, s2, 7
    s_lshl_b32 s48, s48, 1
    s_lshr_b32 s53, s2, 7
    s_add_u32 s48, s48, s53
    s_lshr_b32 s49, s2, 3
    s_and_b32 s49, s49, 15
    v_lshrrev_b32 v237, 2, v1
    v_mul_u32_u24 v232, 2688, v237
    v_lshrrev_b32 v237, 5, v1
    v_lshlrev_b32 v237, 1, v237
    v_and_b32 v238, 3, v1
    v_xor_b32 v237, v237, v238
    v_lshl_add_u32 v232, v237, 4, v232
    s_mul_i32 s53, s49, 56
    s_mul_i32 s51, s3, 43008
    s_add_u32 s53, s53, s51
    v_add_u32 v232, s53, v232
    s_lshr_b32 s53, s3, 1
    s_mul_i32 s51, s53, 6144
    s_and_b32 s53, s3, 1
    s_lshl_b32 s53, s53, 10
    s_add_u32 s51, s51, s53
    v_mul_u32_u24 v231, 896, v2
    v_lshl_add_u32 v231, v3, 4, v231
    s_lshl_b32 s50, s48, 7
    s_lshl_b32 s53, s3, 5
    s_add_u32 s53, s53, s50
    s_mul_i32 s53, s53, 896
    v_add_u32 v230, s53, v231
    s_sub_u32 s53, s50, 16
    s_mul_i32 s53, s53, 896
    s_cmp_eq_u32 s48, 0
    s_cselect_b32 s53, 0x40000000, s53
    v_add_u32 v231, s53, v231
    s_mov_b32 s52, 14336
    s_mov_b32 s54, 0xfffefffe
    s_mov_b32 s55, 0xfffefffe
    s_add_u32 m0, s51, 12288
    s_mov_b32 s53, 0
    s_waitcnt lgkmcnt(0)
    buffer_load_dwordx4 v232, s[12:15], s53 offen lds
    s_add_u32 m0, s51, 14336
    s_mov_b32 s53, 896
    buffer_load_dwordx4 v232, s[12:15], s53 offen lds
    s_add_u32 m0, s51, 16384
    s_mov_b32 s53, 1792
    buffer_load_dwordx4 v232, s[12:15], s53 offen lds
    v_mov_b32 v24, s5
    v_mov_b32 v25, s5
    v_mov_b32 v26, s5
    v_mov_b32 v27, s5
    buffer_load_dwordx4 v[16:19], v230, s[8:11], 0 offen offset:0
    buffer_load_dwordx4 v[20:23], v230, s[8:11], s52 offen offset:0
    s_mov_b64 exec, s[54:55]
    buffer_load_dwordx4 v[24:27], v231, s[8:11], 0 offen offset:0
    s_mov_b64 exec, -1
    v_mov_b32 v36, s5
    v_mov_b32 v37, s5
    v_mov_b32 v38, s5
    v_mov_b32 v39, s5
    buffer_load_dwordx4 v[28:31], v230, s[8:11], 0 offen offset:64
    buffer_load_dwordx4 v[32:35], v230, s[8:11], s52 offen offset:64
    s_mov_b64 exec, s[54:55]
    buffer_load_dwordx4 v[36:39], v231, s[8:11], 0 offen offset:64
    s_mov_b64 exec, -1
    s_add_u32 m0, s51, 24576
    s_mov_b32 s53, 172032
    buffer_load_dwordx4 v232, s[12:15], s53 offen lds
    s_add_u32 m0, s51, 26624
    s_mov_b32 s53, 172928
    buffer_load_dwordx4 v232, s[12:15], s53 offen lds
    s_add_u32 m0, s51, 28672
    s_mov_b32 s53, 173824
    buffer_load_dwordx4 v232, s[12:15], s53 offen lds
    v_mov_b32 v48, s5
    v_mov_b32 v49, s5
    v_mov_b32 v50, s5
    v_mov_b32 v51, s5
    buffer_load_dwordx4 v[40:43], v230, s[8:11], 0 offen offset:128
    buffer_load_dwordx4 v[44:47], v230, s[8:11], s52 offen offset:128
    s_mov_b64 exec, s[54:55]
    buffer_load_dwordx4 v[48:51], v231, s[8:11], 0 offen offset:128
    s_mov_b64 exec, -1
    v_mov_b32 v60, s5
    v_mov_b32 v61, s5
    v_mov_b32 v62, s5
    v_mov_b32 v63, s5
    buffer_load_dwordx4 v[52:55], v230, s[8:11], 0 offen offset:192
    buffer_load_dwordx4 v[56:59], v230, s[8:11], s52 offen offset:192
    s_mov_b64 exec, s[54:55]
    buffer_load_dwordx4 v[60:63], v231, s[8:11], 0 offen offset:192
    s_mov_b64 exec, -1
    s_add_u32 m0, s51, 36864
    s_mov_b32 s53, 344064
    buffer_load_dwordx4 v232, s[12:15], s53 offen lds
    s_add_u32 m0, s51, 38912
    s_mov_b32 s53, 344960
    buffer_load_dwordx4 v232, s[12:15], s53 offen lds
    s_add_u32 m0, s51, 40960
    s_mov_b32 s53, 345856
    buffer_load_dwordx4 v232, s[12:15], s53 offen lds
    v_mov_b32 v72, s5
    v_mov_b32 v73, s5
    v_mov_b32 v74, s5
    v_mov_b32 v75, s5
    buffer_load_dwordx4 v[64:67], v230, s[8:11], 0 offen offset:256
    buffer_load_dwordx4 v[68:71], v230, s[8:11], s52 offen offset:256
    s_mov_b64 exec, s[54:55]
    buffer_load_dwordx4 v[72:75], v231, s[8:11], 0 offen offset:256
    s_mov_b64 exec, -1
    v_mov_b32 v84, s5
    v_mov_b32 v85, s5
    v_mov_b32 v86, s5
    v_mov_b32 v87, s5
    buffer_load_dwordx4 v[76:79], v230, s[8:11], 0 offen offset:320
    buffer_load_dwordx4 v[80:83], v230, s[8:11], s52 offen offset:320
    s_mov_b64 exec, s[54:55]
    buffer_load_dwordx4 v[84:87], v231, s[8:11], 0 offen offset:320
    s_mov_b64 exec, -1
    s_add_u32 m0, s51, 49152
    s_mov_b32 s53, 516096
    buffer_load_dwordx4 v232, s[12:15], s53 offen lds
    s_add_u32 m0, s51, 51200
    s_mov_b32 s53, 516992
    buffer_load_dwordx4 v232, s[12:15], s53 offen lds
    s_add_u32 m0, s51, 53248
    s_mov_b32 s53, 517888
    buffer_load_dwordx4 v232, s[12:15], s53 offen lds
    v_mov_b32 v96, s5
    v_mov_b32 v97, s5
    v_mov_b32 v98, s5
    v_mov_b32 v99, s5
    buffer_load_dwordx4 v[88:91], v230, s[8:11], 0 offen offset:384
    buffer_load_dwordx4 v[92:95], v230, s[8:11], s52 offen offset:384
    s_mov_b64 exec, s[54:55]
    buffer_load_dwordx4 v[96:99], v231, s[8:11], 0 offen offset:384
    s_mov_b64 exec, -1
    v_mov_b32 v108, s5
    v_mov_b32 v109, s5
    v_mov_b32 v110, s5
    v_mov_b32 v111, s5
    buffer_load_dwordx4 v[100:103], v230, s[8:11], 0 offen offset:448
    buffer_load_dwordx4 v[104:107], v230, s[8:11], s52 offen offset:448
    s_mov_b64 exec, s[54:55]
    buffer_load_dwordx4 v[108:111], v231, s[8:11], 0 offen offset:448
    s_mov_b64 exec, -1
    s_add_u32 m0, s51, 61440
    s_mov_b32 s53, 688128
    buffer_load_dwordx4 v232, s[12:15], s53 offen lds
    s_add_u32 m0, s51, 63488
    s_mov_b32 s53, 689024
    buffer_load_dwordx4 v232, s[12:15], s53 offen lds
    s_add_u32 m0, s51, 65536
    s_mov_b32 s53, 689920
    buffer_load_dwordx4 v232, s[12:15], s53 offen lds
    v_mov_b32 v120, s5
    v_mov_b32 v121, s5
    v_mov_b32 v122, s5
    v_mov_b32 v123, s5
    buffer_load_dwordx4 v[112:115], v230, s[8:11], 0 offen offset:512
    buffer_load_dwordx4 v[116:119], v230, s[8:11], s52 offen offset:512
    s_mov_b64 exec, s[54:55]
    buffer_load_dwordx4 v[120:123], v231, s[8:11], 0 offen offset:512
    s_mov_b64 exec, -1
    v_mov_b32 v132, s5
    v_mov_b32 v133, s5
    v_mov_b32 v134, s5
    v_mov_b32 v135, s5
    buffer_load_dwordx4 v[124:127], v230, s[8:11], 0 offen offset:576
    buffer_load_dwordx4 v[128:131], v230, s[8:11], s52 offen offset:576
    s_mov_b64 exec, s[54:55]
    buffer_load_dwordx4 v[132:135], v231, s[8:11], 0 offen offset:576
    s_mov_b64 exec, -1
    s_add_u32 m0, s51, 73728
    s_mov_b32 s53, 860160
    buffer_load_dwordx4 v232, s[12:15], s53 offen lds
    s_add_u32 m0, s51, 75776
    s_mov_b32 s53, 861056
    buffer_load_dwordx4 v232, s[12:15], s53 offen lds
    s_add_u32 m0, s51, 77824
    s_mov_b32 s53, 861952
    buffer_load_dwordx4 v232, s[12:15], s53 offen lds
    s_add_u32 m0, s51, 86016
    s_mov_b32 s53, 1032192
    buffer_load_dwordx4 v232, s[12:15], s53 offen lds
    s_add_u32 m0, s51, 88064
    s_mov_b32 s53, 1033088
    buffer_load_dwordx4 v232, s[12:15], s53 offen lds
    s_add_u32 m0, s51, 90112
    s_mov_b32 s53, 1033984
    buffer_load_dwordx4 v232, s[12:15], s53 offen lds
    v_lshlrev_b32 v233, 9, v3
    v_bfe_u32 v237, v1, 2, 2
    v_lshl_add_u32 v233, v237, 6, v233
    v_and_b32 v237, 3, v1
    v_lshl_add_u32 v233, v237, 3, v233
    v_and_b32 v237, 1, v3
    v_lshlrev_b32 v237, 5, v237
    v_add_u32 v233, v233, v237
    v_add_u32 v233, 12288, v233
    v_xor_b32 v234, 32, v233
    s_and_b32 s53, s3, 1
    s_lshl_b32 s53, s53, 5
    v_xor_b32 v236, s53, v233
    s_lshr_b32 s53, s3, 1
    s_lshl_b32 s53, s53, 11
    s_add_u32 s53, s53, 2048
    v_add_u32 v235, s53, v236
    v_lshlrev_b32 v237, 2, v3
    v_sub_u32 v237, v2, v237
    v_mov_b32 v239, 0xf149f2ca
    v_add_u32 v238, 16, v237
    v_and_b32 v238, 0xfffffff1, v238
    v_cmp_eq_u32 vcc, 0, v238
    s_nop 1
    v_cndmask_b32 v240, v239, 0, vcc
    v_add_u32 v238, 15, v237
    v_and_b32 v238, 0xfffffff1, v238
    v_cmp_eq_u32 vcc, 0, v238
    s_nop 1
    v_cndmask_b32 v241, v239, 0, vcc
    v_add_u32 v238, 14, v237
    v_and_b32 v238, 0xfffffff1, v238
    v_cmp_eq_u32 vcc, 0, v238
    s_nop 1
    v_cndmask_b32 v242, v239, 0, vcc
    v_add_u32 v238, 13, v237
    v_and_b32 v238, 0xfffffff1, v238
    v_cmp_eq_u32 vcc, 0, v238
    s_nop 1
    v_cndmask_b32 v243, v239, 0, vcc
    v_add_u32 v238, 0, v237
    v_and_b32 v238, 0xfffffff1, v238
    v_cmp_eq_u32 vcc, 0, v238
    s_nop 1
    v_cndmask_b32 v244, v239, 0, vcc
    v_add_u32 v238, -1, v237
    v_and_b32 v238, 0xfffffff1, v238
    v_cmp_eq_u32 vcc, 0, v238
    s_nop 1
    v_cndmask_b32 v245, v239, 0, vcc
    v_add_u32 v238, -2, v237
    v_and_b32 v238, 0xfffffff1, v238
    v_cmp_eq_u32 vcc, 0, v238
    s_nop 1
    v_cndmask_b32 v246, v239, 0, vcc
    v_add_u32 v238, -3, v237
    v_and_b32 v238, 0xfffffff1, v238
    v_cmp_eq_u32 vcc, 0, v238
    s_nop 1
    v_cndmask_b32 v247, v239, 0, vcc
    s_or_b32 s53, s48, s3
    s_cmp_eq_u32 s53, 0
    s_cselect_b64 vcc, -1, 0
    v_cndmask_b32 v248, v240, v239, vcc
    v_cndmask_b32 v249, v241, v239, vcc
    v_cndmask_b32 v250, v242, v239, vcc
    v_cndmask_b32 v251, v243, v239, vcc
    v_mov_b32 v224, 0
    v_mov_b32 v225, 0
    v_mov_b32 v226, 0
    v_mov_b32 v227, 0
    v_mov_b32 v228, 0
    v_mov_b32 v229, 0
    s_waitcnt vmcnt(48)
    s_barrier
    ds_read_b64_tr_b16 v[192:193], v233 offset:0
    ds_read_b64_tr_b16 v[194:195], v233 offset:256
    ds_read_b64_tr_b16 v[196:197], v234 offset:0
    ds_read_b64_tr_b16 v[198:199], v234 offset:256
    ds_read_b64_tr_b16 v[200:201], v233 offset:2048
    ds_read_b64_tr_b16 v[202:203], v233 offset:2304
    ds_read_b64_tr_b16 v[204:205], v234 offset:2048
    ds_read_b64_tr_b16 v[206:207], v234 offset:2304
    ds_read_b64_tr_b16 v[208:209], v233 offset:4096
    ds_read_b64_tr_b16 v[210:211], v233 offset:4352
    ds_read_b64_tr_b16 v[212:213], v234 offset:4096
    ds_read_b64_tr_b16 v[214:215], v234 offset:4352
    ds_read_b64_tr_b16 v[216:217], v235 offset:0
    ds_read_b64_tr_b16 v[218:219], v235 offset:256
    ds_read_b64_tr_b16 v[220:221], v236 offset:0
    ds_read_b64_tr_b16 v[222:223], v236 offset:256
    s_waitcnt vmcnt(47)
    v_dot2c_f32_bf16 v224, s5, v16
    v_dot2c_f32_bf16 v225, v16, v16
    s_waitcnt vmcnt(46)
    v_dot2c_f32_bf16 v226, s5, v20
    v_dot2c_f32_bf16 v227, v20, v20
    s_waitcnt vmcnt(45)
    v_dot2c_f32_bf16 v228, s5, v24
    v_dot2c_f32_bf16 v229, v24, v24
    v_dot2c_f32_bf16 v224, s5, v17
    v_dot2c_f32_bf16 v225, v17, v17
    v_dot2c_f32_bf16 v226, s5, v21
    v_dot2c_f32_bf16 v227, v21, v21
    v_dot2c_f32_bf16 v228, s5, v25
    v_dot2c_f32_bf16 v229, v25, v25
    v_dot2c_f32_bf16 v224, s5, v18
    v_dot2c_f32_bf16 v225, v18, v18
    v_dot2c_f32_bf16 v226, s5, v22
    v_dot2c_f32_bf16 v227, v22, v22
    v_dot2c_f32_bf16 v228, s5, v26
    v_dot2c_f32_bf16 v229, v26, v26
    v_dot2c_f32_bf16 v224, s5, v19
    v_dot2c_f32_bf16 v225, v19, v19
    v_dot2c_f32_bf16 v226, s5, v23
    v_dot2c_f32_bf16 v227, v23, v23
    v_dot2c_f32_bf16 v228, s5, v27
    v_dot2c_f32_bf16 v229, v27, v27
    s_waitcnt lgkmcnt(14)
    v_mfma_f32_16x16x32_bf16 v[136:139], v[192:195], v[16:19], 0
    v_mfma_f32_16x16x32_bf16 v[160:163], v[192:195], v[20:23], 0
    ds_read_b64_tr_b16 v[192:193], v233 offset:6144
    ds_read_b64_tr_b16 v[194:195], v233 offset:6400
    s_waitcnt lgkmcnt(14)
    v_mfma_f32_16x16x32_bf16 v[140:143], v[196:199], v[16:19], 0
    v_mfma_f32_16x16x32_bf16 v[164:167], v[196:199], v[20:23], 0
    ds_read_b64_tr_b16 v[196:197], v234 offset:6144
    ds_read_b64_tr_b16 v[198:199], v234 offset:6400
    s_waitcnt lgkmcnt(14)
    v_mfma_f32_16x16x32_bf16 v[144:147], v[200:203], v[16:19], 0
    v_mfma_f32_16x16x32_bf16 v[168:171], v[200:203], v[20:23], 0
    ds_read_b64_tr_b16 v[200:201], v233 offset:8192
    ds_read_b64_tr_b16 v[202:203], v233 offset:8448
    s_waitcnt lgkmcnt(14)
    v_mfma_f32_16x16x32_bf16 v[148:151], v[204:207], v[16:19], 0
    v_mfma_f32_16x16x32_bf16 v[172:175], v[204:207], v[20:23], 0
    ds_read_b64_tr_b16 v[204:205], v234 offset:8192
    ds_read_b64_tr_b16 v[206:207], v234 offset:8448
    s_waitcnt lgkmcnt(14)
    v_mfma_f32_16x16x32_bf16 v[152:155], v[16:19], v[208:211], 0
    v_mfma_f32_16x16x32_bf16 v[176:179], v[20:23], v[208:211], 0
    ds_read_b64_tr_b16 v[208:209], v233 offset:10240
    ds_read_b64_tr_b16 v[210:211], v233 offset:10496
    s_waitcnt lgkmcnt(14)
    v_mfma_f32_16x16x32_bf16 v[156:159], v[16:19], v[212:215], 0
    v_mfma_f32_16x16x32_bf16 v[180:183], v[20:23], v[212:215], 0
    ds_read_b64_tr_b16 v[212:213], v234 offset:10240
    ds_read_b64_tr_b16 v[214:215], v234 offset:10496
    s_waitcnt lgkmcnt(14)
    v_mfma_f32_16x16x32_bf16 v[184:187], v[216:219], v[24:27], 0
    ds_read_b64_tr_b16 v[216:217], v235 offset:6144
    ds_read_b64_tr_b16 v[218:219], v235 offset:6400
    s_waitcnt lgkmcnt(14)
    v_mfma_f32_16x16x32_bf16 v[188:191], v[220:223], v[24:27], 0
    ds_read_b64_tr_b16 v[220:221], v236 offset:6144
    ds_read_b64_tr_b16 v[222:223], v236 offset:6400
    buffer_load_dwordx4 v[16:19], v230, s[8:11], 0 offen offset:640
    buffer_load_dwordx4 v[20:23], v230, s[8:11], s52 offen offset:640
    s_mov_b64 exec, s[54:55]
    buffer_load_dwordx4 v[24:27], v231, s[8:11], 0 offen offset:640
    s_mov_b64 exec, -1
    s_waitcnt vmcnt(42)
    s_barrier
    v_dot2c_f32_bf16 v224, s5, v28
    v_dot2c_f32_bf16 v225, v28, v28
    v_dot2c_f32_bf16 v226, s5, v32
    v_dot2c_f32_bf16 v227, v32, v32
    v_dot2c_f32_bf16 v228, s5, v36
    v_dot2c_f32_bf16 v229, v36, v36
    v_dot2c_f32_bf16 v224, s5, v29
    v_dot2c_f32_bf16 v225, v29, v29
    v_dot2c_f32_bf16 v226, s5, v33
    v_dot2c_f32_bf16 v227, v33, v33
    v_dot2c_f32_bf16 v228, s5, v37
    v_dot2c_f32_bf16 v229, v37, v37
    v_dot2c_f32_bf16 v224, s5, v30
    v_dot2c_f32_bf16 v225, v30, v30
    v_dot2c_f32_bf16 v226, s5, v34
    v_dot2c_f32_bf16 v227, v34, v34
    v_dot2c_f32_bf16 v228, s5, v38
    v_dot2c_f32_bf16 v229, v38, v38
    v_dot2c_f32_bf16 v224, s5, v31
    v_dot2c_f32_bf16 v225, v31, v31
    v_dot2c_f32_bf16 v226, s5, v35
    v_dot2c_f32_bf16 v227, v35, v35
    v_dot2c_f32_bf16 v228, s5, v39
    v_dot2c_f32_bf16 v229, v39, v39
    s_waitcnt lgkmcnt(14)
    v_mfma_f32_16x16x32_bf16 v[136:139], v[192:195], v[28:31], v[136:139]
    v_mfma_f32_16x16x32_bf16 v[160:163], v[192:195], v[32:35], v[160:163]
    ds_read_b64_tr_b16 v[192:193], v233 offset:12288
    ds_read_b64_tr_b16 v[194:195], v233 offset:12544
    s_waitcnt lgkmcnt(14)
    v_mfma_f32_16x16x32_bf16 v[140:143], v[196:199], v[28:31], v[140:143]
    v_mfma_f32_16x16x32_bf16 v[164:167], v[196:199], v[32:35], v[164:167]
    ds_read_b64_tr_b16 v[196:197], v234 offset:12288
    ds_read_b64_tr_b16 v[198:199], v234 offset:12544
    s_waitcnt lgkmcnt(14)
    v_mfma_f32_16x16x32_bf16 v[144:147], v[200:203], v[28:31], v[144:147]
    v_mfma_f32_16x16x32_bf16 v[168:171], v[200:203], v[32:35], v[168:171]
    ds_read_b64_tr_b16 v[200:201], v233 offset:14336
    ds_read_b64_tr_b16 v[202:203], v233 offset:14592
    s_waitcnt lgkmcnt(14)
    v_mfma_f32_16x16x32_bf16 v[148:151], v[204:207], v[28:31], v[148:151]
    v_mfma_f32_16x16x32_bf16 v[172:175], v[204:207], v[32:35], v[172:175]
    ds_read_b64_tr_b16 v[204:205], v234 offset:14336
    ds_read_b64_tr_b16 v[206:207], v234 offset:14592
    s_waitcnt lgkmcnt(14)
    v_mfma_f32_16x16x32_bf16 v[152:155], v[28:31], v[208:211], v[152:155]
    v_mfma_f32_16x16x32_bf16 v[176:179], v[32:35], v[208:211], v[176:179]
    ds_read_b64_tr_b16 v[208:209], v233 offset:16384
    ds_read_b64_tr_b16 v[210:211], v233 offset:16640
    s_waitcnt lgkmcnt(14)
    v_mfma_f32_16x16x32_bf16 v[156:159], v[28:31], v[212:215], v[156:159]
    v_mfma_f32_16x16x32_bf16 v[180:183], v[32:35], v[212:215], v[180:183]
    ds_read_b64_tr_b16 v[212:213], v234 offset:16384
    ds_read_b64_tr_b16 v[214:215], v234 offset:16640
    s_waitcnt lgkmcnt(14)
    v_mfma_f32_16x16x32_bf16 v[184:187], v[216:219], v[36:39], v[184:187]
    ds_read_b64_tr_b16 v[216:217], v235 offset:12288
    ds_read_b64_tr_b16 v[218:219], v235 offset:12544
    s_waitcnt lgkmcnt(14)
    v_mfma_f32_16x16x32_bf16 v[188:191], v[220:223], v[36:39], v[188:191]
    ds_read_b64_tr_b16 v[220:221], v236 offset:12288
    ds_read_b64_tr_b16 v[222:223], v236 offset:12544
    buffer_load_dwordx4 v[28:31], v230, s[8:11], 0 offen offset:704
    buffer_load_dwordx4 v[32:35], v230, s[8:11], s52 offen offset:704
    s_mov_b64 exec, s[54:55]
    buffer_load_dwordx4 v[36:39], v231, s[8:11], 0 offen offset:704
    s_mov_b64 exec, -1
    s_waitcnt vmcnt(44)
    v_dot2c_f32_bf16 v224, s5, v40
    v_dot2c_f32_bf16 v225, v40, v40
    s_waitcnt vmcnt(43)
    v_dot2c_f32_bf16 v226, s5, v44
    v_dot2c_f32_bf16 v227, v44, v44
    s_waitcnt vmcnt(42)
    v_dot2c_f32_bf16 v228, s5, v48
    v_dot2c_f32_bf16 v229, v48, v48
    v_dot2c_f32_bf16 v224, s5, v41
    v_dot2c_f32_bf16 v225, v41, v41
    v_dot2c_f32_bf16 v226, s5, v45
    v_dot2c_f32_bf16 v227, v45, v45
    v_dot2c_f32_bf16 v228, s5, v49
    v_dot2c_f32_bf16 v229, v49, v49
    v_dot2c_f32_bf16 v224, s5, v42
    v_dot2c_f32_bf16 v225, v42, v42
    v_dot2c_f32_bf16 v226, s5, v46
    v_dot2c_f32_bf16 v227, v46, v46
    v_dot2c_f32_bf16 v228, s5, v50
    v_dot2c_f32_bf16 v229, v50, v50
    v_dot2c_f32_bf16 v224, s5, v43
    v_dot2c_f32_bf16 v225, v43, v43
    v_dot2c_f32_bf16 v226, s5, v47
    v_dot2c_f32_bf16 v227, v47, v47
    v_dot2c_f32_bf16 v228, s5, v51
    v_dot2c_f32_bf16 v229, v51, v51
    s_waitcnt lgkmcnt(14)
    v_mfma_f32_16x16x32_bf16 v[136:139], v[192:195], v[40:43], v[136:139]
    v_mfma_f32_16x16x32_bf16 v[160:163], v[192:195], v[44:47], v[160:163]
    ds_read_b64_tr_b16 v[192:193], v233 offset:18432
    ds_read_b64_tr_b16 v[194:195], v233 offset:18688
    s_waitcnt lgkmcnt(14)
    v_mfma_f32_16x16x32_bf16 v[140:143], v[196:199], v[40:43], v[140:143]
    v_mfma_f32_16x16x32_bf16 v[164:167], v[196:199], v[44:47], v[164:167]
    ds_read_b64_tr_b16 v[196:197], v234 offset:18432
    ds_read_b64_tr_b16 v[198:199], v234 offset:18688
    s_waitcnt lgkmcnt(14)
    v_mfma_f32_16x16x32_bf16 v[144:147], v[200:203], v[40:43], v[144:147]
    v_mfma_f32_16x16x32_bf16 v[168:171], v[200:203], v[44:47], v[168:171]
    ds_read_b64_tr_b16 v[200:201], v233 offset:20480
    ds_read_b64_tr_b16 v[202:203], v233 offset:20736
    s_waitcnt lgkmcnt(14)
    v_mfma_f32_16x16x32_bf16 v[148:151], v[204:207], v[40:43], v[148:151]
    v_mfma_f32_16x16x32_bf16 v[172:175], v[204:207], v[44:47], v[172:175]
    ds_read_b64_tr_b16 v[204:205], v234 offset:20480
    ds_read_b64_tr_b16 v[206:207], v234 offset:20736
    s_waitcnt lgkmcnt(14)
    v_mfma_f32_16x16x32_bf16 v[152:155], v[40:43], v[208:211], v[152:155]
    v_mfma_f32_16x16x32_bf16 v[176:179], v[44:47], v[208:211], v[176:179]
    ds_read_b64_tr_b16 v[208:209], v233 offset:22528
    ds_read_b64_tr_b16 v[210:211], v233 offset:22784
    s_waitcnt lgkmcnt(14)
    v_mfma_f32_16x16x32_bf16 v[156:159], v[40:43], v[212:215], v[156:159]
    v_mfma_f32_16x16x32_bf16 v[180:183], v[44:47], v[212:215], v[180:183]
    ds_read_b64_tr_b16 v[212:213], v234 offset:22528
    ds_read_b64_tr_b16 v[214:215], v234 offset:22784
    s_waitcnt lgkmcnt(14)
    v_mfma_f32_16x16x32_bf16 v[184:187], v[216:219], v[48:51], v[184:187]
    ds_read_b64_tr_b16 v[216:217], v235 offset:18432
    ds_read_b64_tr_b16 v[218:219], v235 offset:18688
    s_waitcnt lgkmcnt(14)
    v_mfma_f32_16x16x32_bf16 v[188:191], v[220:223], v[48:51], v[188:191]
    ds_read_b64_tr_b16 v[220:221], v236 offset:18432
    ds_read_b64_tr_b16 v[222:223], v236 offset:18688
    buffer_load_dwordx4 v[40:43], v230, s[8:11], 0 offen offset:768
    buffer_load_dwordx4 v[44:47], v230, s[8:11], s52 offen offset:768
    s_mov_b64 exec, s[54:55]
    buffer_load_dwordx4 v[48:51], v231, s[8:11], 0 offen offset:768
    s_mov_b64 exec, -1
    s_waitcnt vmcnt(39)
    s_barrier
    v_dot2c_f32_bf16 v224, s5, v52
    v_dot2c_f32_bf16 v225, v52, v52
    v_dot2c_f32_bf16 v226, s5, v56
    v_dot2c_f32_bf16 v227, v56, v56
    v_dot2c_f32_bf16 v228, s5, v60
    v_dot2c_f32_bf16 v229, v60, v60
    v_dot2c_f32_bf16 v224, s5, v53
    v_dot2c_f32_bf16 v225, v53, v53
    v_dot2c_f32_bf16 v226, s5, v57
    v_dot2c_f32_bf16 v227, v57, v57
    v_dot2c_f32_bf16 v228, s5, v61
    v_dot2c_f32_bf16 v229, v61, v61
    v_dot2c_f32_bf16 v224, s5, v54
    v_dot2c_f32_bf16 v225, v54, v54
    v_dot2c_f32_bf16 v226, s5, v58
    v_dot2c_f32_bf16 v227, v58, v58
    v_dot2c_f32_bf16 v228, s5, v62
    v_dot2c_f32_bf16 v229, v62, v62
    v_dot2c_f32_bf16 v224, s5, v55
    v_dot2c_f32_bf16 v225, v55, v55
    v_dot2c_f32_bf16 v226, s5, v59
    v_dot2c_f32_bf16 v227, v59, v59
    v_dot2c_f32_bf16 v228, s5, v63
    v_dot2c_f32_bf16 v229, v63, v63
    s_waitcnt lgkmcnt(14)
    v_mfma_f32_16x16x32_bf16 v[136:139], v[192:195], v[52:55], v[136:139]
    v_mfma_f32_16x16x32_bf16 v[160:163], v[192:195], v[56:59], v[160:163]
    ds_read_b64_tr_b16 v[192:193], v233 offset:24576
    ds_read_b64_tr_b16 v[194:195], v233 offset:24832
    s_waitcnt lgkmcnt(14)
    v_mfma_f32_16x16x32_bf16 v[140:143], v[196:199], v[52:55], v[140:143]
    v_mfma_f32_16x16x32_bf16 v[164:167], v[196:199], v[56:59], v[164:167]
    ds_read_b64_tr_b16 v[196:197], v234 offset:24576
    ds_read_b64_tr_b16 v[198:199], v234 offset:24832
    s_waitcnt lgkmcnt(14)
    v_mfma_f32_16x16x32_bf16 v[144:147], v[200:203], v[52:55], v[144:147]
    v_mfma_f32_16x16x32_bf16 v[168:171], v[200:203], v[56:59], v[168:171]
    ds_read_b64_tr_b16 v[200:201], v233 offset:26624
    ds_read_b64_tr_b16 v[202:203], v233 offset:26880
    s_waitcnt lgkmcnt(14)
    v_mfma_f32_16x16x32_bf16 v[148:151], v[204:207], v[52:55], v[148:151]
    v_mfma_f32_16x16x32_bf16 v[172:175], v[204:207], v[56:59], v[172:175]
    ds_read_b64_tr_b16 v[204:205], v234 offset:26624
    ds_read_b64_tr_b16 v[206:207], v234 offset:26880
    s_waitcnt lgkmcnt(14)
    v_mfma_f32_16x16x32_bf16 v[152:155], v[52:55], v[208:211], v[152:155]
    v_mfma_f32_16x16x32_bf16 v[176:179], v[56:59], v[208:211], v[176:179]
    ds_read_b64_tr_b16 v[208:209], v233 offset:28672
    ds_read_b64_tr_b16 v[210:211], v233 offset:28928
    s_waitcnt lgkmcnt(14)
    v_mfma_f32_16x16x32_bf16 v[156:159], v[52:55], v[212:215], v[156:159]
    v_mfma_f32_16x16x32_bf16 v[180:183], v[56:59], v[212:215], v[180:183]
    ds_read_b64_tr_b16 v[212:213], v234 offset:28672
    ds_read_b64_tr_b16 v[214:215], v234 offset:28928
    s_waitcnt lgkmcnt(14)
    v_mfma_f32_16x16x32_bf16 v[184:187], v[216:219], v[60:63], v[184:187]
    ds_read_b64_tr_b16 v[216:217], v235 offset:24576
    ds_read_b64_tr_b16 v[218:219], v235 offset:24832
    s_waitcnt lgkmcnt(14)
    v_mfma_f32_16x16x32_bf16 v[188:191], v[220:223], v[60:63], v[188:191]
    ds_read_b64_tr_b16 v[220:221], v236 offset:24576
    ds_read_b64_tr_b16 v[222:223], v236 offset:24832
    buffer_load_dwordx4 v[52:55], v230, s[8:11], 0 offen offset:832
    buffer_load_dwordx4 v[56:59], v230, s[8:11], s52 offen offset:832
    s_mov_b64 exec, s[54:55]
    buffer_load_dwordx4 v[60:63], v231, s[8:11], 0 offen offset:832
    s_mov_b64 exec, -1
    s_waitcnt vmcnt(41)
    v_dot2c_f32_bf16 v224, s5, v64
    v_dot2c_f32_bf16 v225, v64, v64
    s_waitcnt vmcnt(40)
    v_dot2c_f32_bf16 v226, s5, v68
    v_dot2c_f32_bf16 v227, v68, v68
    s_waitcnt vmcnt(39)
    v_dot2c_f32_bf16 v228, s5, v72
    v_dot2c_f32_bf16 v229, v72, v72
    v_dot2c_f32_bf16 v224, s5, v65
    v_dot2c_f32_bf16 v225, v65, v65
    v_dot2c_f32_bf16 v226, s5, v69
    v_dot2c_f32_bf16 v227, v69, v69
    v_dot2c_f32_bf16 v228, s5, v73
    v_dot2c_f32_bf16 v229, v73, v73
    v_dot2c_f32_bf16 v224, s5, v66
    v_dot2c_f32_bf16 v225, v66, v66
    v_dot2c_f32_bf16 v226, s5, v70
    v_dot2c_f32_bf16 v227, v70, v70
    v_dot2c_f32_bf16 v228, s5, v74
    v_dot2c_f32_bf16 v229, v74, v74
    v_dot2c_f32_bf16 v224, s5, v67
    v_dot2c_f32_bf16 v225, v67, v67
    v_dot2c_f32_bf16 v226, s5, v71
    v_dot2c_f32_bf16 v227, v71, v71
    v_dot2c_f32_bf16 v228, s5, v75
    v_dot2c_f32_bf16 v229, v75, v75
    s_waitcnt lgkmcnt(14)
    v_mfma_f32_16x16x32_bf16 v[136:139], v[192:195], v[64:67], v[136:139]
    v_mfma_f32_16x16x32_bf16 v[160:163], v[192:195], v[68:71], v[160:163]
    ds_read_b64_tr_b16 v[192:193], v233 offset:30720
    ds_read_b64_tr_b16 v[194:195], v233 offset:30976
    s_waitcnt lgkmcnt(14)
    v_mfma_f32_16x16x32_bf16 v[140:143], v[196:199], v[64:67], v[140:143]
    v_mfma_f32_16x16x32_bf16 v[164:167], v[196:199], v[68:71], v[164:167]
    ds_read_b64_tr_b16 v[196:197], v234 offset:30720
    ds_read_b64_tr_b16 v[198:199], v234 offset:30976
    s_waitcnt lgkmcnt(14)
    v_mfma_f32_16x16x32_bf16 v[144:147], v[200:203], v[64:67], v[144:147]
    v_mfma_f32_16x16x32_bf16 v[168:171], v[200:203], v[68:71], v[168:171]
    ds_read_b64_tr_b16 v[200:201], v233 offset:32768
    ds_read_b64_tr_b16 v[202:203], v233 offset:33024
    s_waitcnt lgkmcnt(14)
    v_mfma_f32_16x16x32_bf16 v[148:151], v[204:207], v[64:67], v[148:151]
    v_mfma_f32_16x16x32_bf16 v[172:175], v[204:207], v[68:71], v[172:175]
    ds_read_b64_tr_b16 v[204:205], v234 offset:32768
    ds_read_b64_tr_b16 v[206:207], v234 offset:33024
    s_waitcnt lgkmcnt(14)
    v_mfma_f32_16x16x32_bf16 v[152:155], v[64:67], v[208:211], v[152:155]
    v_mfma_f32_16x16x32_bf16 v[176:179], v[68:71], v[208:211], v[176:179]
    ds_read_b64_tr_b16 v[208:209], v233 offset:34816
    ds_read_b64_tr_b16 v[210:211], v233 offset:35072
    s_waitcnt lgkmcnt(14)
    v_mfma_f32_16x16x32_bf16 v[156:159], v[64:67], v[212:215], v[156:159]
    v_mfma_f32_16x16x32_bf16 v[180:183], v[68:71], v[212:215], v[180:183]
    ds_read_b64_tr_b16 v[212:213], v234 offset:34816
    ds_read_b64_tr_b16 v[214:215], v234 offset:35072
    s_waitcnt lgkmcnt(14)
    v_mfma_f32_16x16x32_bf16 v[184:187], v[216:219], v[72:75], v[184:187]
    ds_read_b64_tr_b16 v[216:217], v235 offset:30720
    ds_read_b64_tr_b16 v[218:219], v235 offset:30976
    s_waitcnt lgkmcnt(14)
    v_mfma_f32_16x16x32_bf16 v[188:191], v[220:223], v[72:75], v[188:191]
    ds_read_b64_tr_b16 v[220:221], v236 offset:30720
    ds_read_b64_tr_b16 v[222:223], v236 offset:30976
    s_waitcnt vmcnt(33)
    s_barrier
    v_dot2c_f32_bf16 v224, s5, v76
    v_dot2c_f32_bf16 v225, v76, v76
    v_dot2c_f32_bf16 v226, s5, v80
    v_dot2c_f32_bf16 v227, v80, v80
    v_dot2c_f32_bf16 v228, s5, v84
    v_dot2c_f32_bf16 v229, v84, v84
    v_dot2c_f32_bf16 v224, s5, v77
    v_dot2c_f32_bf16 v225, v77, v77
    v_dot2c_f32_bf16 v226, s5, v81
    v_dot2c_f32_bf16 v227, v81, v81
    v_dot2c_f32_bf16 v228, s5, v85
    v_dot2c_f32_bf16 v229, v85, v85
    v_dot2c_f32_bf16 v224, s5, v78
    v_dot2c_f32_bf16 v225, v78, v78
    v_dot2c_f32_bf16 v226, s5, v82
    v_dot2c_f32_bf16 v227, v82, v82
    v_dot2c_f32_bf16 v228, s5, v86
    v_dot2c_f32_bf16 v229, v86, v86
    v_dot2c_f32_bf16 v224, s5, v79
    v_dot2c_f32_bf16 v225, v79, v79
    v_dot2c_f32_bf16 v226, s5, v83
    v_dot2c_f32_bf16 v227, v83, v83
    v_dot2c_f32_bf16 v228, s5, v87
    v_dot2c_f32_bf16 v229, v87, v87
    s_waitcnt lgkmcnt(14)
    v_mfma_f32_16x16x32_bf16 v[136:139], v[192:195], v[76:79], v[136:139]
    v_mfma_f32_16x16x32_bf16 v[160:163], v[192:195], v[80:83], v[160:163]
    ds_read_b64_tr_b16 v[192:193], v233 offset:36864
    ds_read_b64_tr_b16 v[194:195], v233 offset:37120
    s_waitcnt lgkmcnt(14)
    v_mfma_f32_16x16x32_bf16 v[140:143], v[196:199], v[76:79], v[140:143]
    v_mfma_f32_16x16x32_bf16 v[164:167], v[196:199], v[80:83], v[164:167]
    ds_read_b64_tr_b16 v[196:197], v234 offset:36864
    ds_read_b64_tr_b16 v[198:199], v234 offset:37120
    s_waitcnt lgkmcnt(14)
    v_mfma_f32_16x16x32_bf16 v[144:147], v[200:203], v[76:79], v[144:147]
    v_mfma_f32_16x16x32_bf16 v[168:171], v[200:203], v[80:83], v[168:171]
    ds_read_b64_tr_b16 v[200:201], v233 offset:38912
    ds_read_b64_tr_b16 v[202:203], v233 offset:39168
    s_waitcnt lgkmcnt(14)
    v_mfma_f32_16x16x32_bf16 v[148:151], v[204:207], v[76:79], v[148:151]
    v_mfma_f32_16x16x32_bf16 v[172:175], v[204:207], v[80:83], v[172:175]
    ds_read_b64_tr_b16 v[204:205], v234 offset:38912
    ds_read_b64_tr_b16 v[206:207], v234 offset:39168
    s_waitcnt lgkmcnt(14)
    v_mfma_f32_16x16x32_bf16 v[152:155], v[76:79], v[208:211], v[152:155]
    v_mfma_f32_16x16x32_bf16 v[176:179], v[80:83], v[208:211], v[176:179]
    ds_read_b64_tr_b16 v[208:209], v233 offset:40960
    ds_read_b64_tr_b16 v[210:211], v233 offset:41216
    s_waitcnt lgkmcnt(14)
    v_mfma_f32_16x16x32_bf16 v[156:159], v[76:79], v[212:215], v[156:159]
    v_mfma_f32_16x16x32_bf16 v[180:183], v[80:83], v[212:215], v[180:183]
    ds_read_b64_tr_b16 v[212:213], v234 offset:40960
    ds_read_b64_tr_b16 v[214:215], v234 offset:41216
    s_waitcnt lgkmcnt(14)
    v_mfma_f32_16x16x32_bf16 v[184:187], v[216:219], v[84:87], v[184:187]
    ds_read_b64_tr_b16 v[216:217], v235 offset:36864
    ds_read_b64_tr_b16 v[218:219], v235 offset:37120
    s_waitcnt lgkmcnt(14)
    v_mfma_f32_16x16x32_bf16 v[188:191], v[220:223], v[84:87], v[188:191]
    ds_read_b64_tr_b16 v[220:221], v236 offset:36864
    ds_read_b64_tr_b16 v[222:223], v236 offset:37120
    v_add_u32 v233, 43008, v233
    v_add_u32 v234, 43008, v234
    v_add_u32 v235, 43008, v235
    v_add_u32 v236, 43008, v236
    s_waitcnt vmcnt(32)
    v_dot2c_f32_bf16 v224, s5, v88
    v_dot2c_f32_bf16 v225, v88, v88
    s_waitcnt vmcnt(31)
    v_dot2c_f32_bf16 v226, s5, v92
    v_dot2c_f32_bf16 v227, v92, v92
    s_waitcnt vmcnt(30)
    v_dot2c_f32_bf16 v228, s5, v96
    v_dot2c_f32_bf16 v229, v96, v96
    v_dot2c_f32_bf16 v224, s5, v89
    v_dot2c_f32_bf16 v225, v89, v89
    v_dot2c_f32_bf16 v226, s5, v93
    v_dot2c_f32_bf16 v227, v93, v93
    v_dot2c_f32_bf16 v228, s5, v97
    v_dot2c_f32_bf16 v229, v97, v97
    v_dot2c_f32_bf16 v224, s5, v90
    v_dot2c_f32_bf16 v225, v90, v90
    v_dot2c_f32_bf16 v226, s5, v94
    v_dot2c_f32_bf16 v227, v94, v94
    v_dot2c_f32_bf16 v228, s5, v98
    v_dot2c_f32_bf16 v229, v98, v98
    v_dot2c_f32_bf16 v224, s5, v91
    v_dot2c_f32_bf16 v225, v91, v91
    v_dot2c_f32_bf16 v226, s5, v95
    v_dot2c_f32_bf16 v227, v95, v95
    v_dot2c_f32_bf16 v228, s5, v99
    v_dot2c_f32_bf16 v229, v99, v99
    s_waitcnt lgkmcnt(14)
    v_mfma_f32_16x16x32_bf16 v[136:139], v[192:195], v[88:91], v[136:139]
    v_mfma_f32_16x16x32_bf16 v[160:163], v[192:195], v[92:95], v[160:163]
    ds_read_b64_tr_b16 v[192:193], v233 offset:0
    ds_read_b64_tr_b16 v[194:195], v233 offset:256
    s_waitcnt lgkmcnt(14)
    v_mfma_f32_16x16x32_bf16 v[140:143], v[196:199], v[88:91], v[140:143]
    v_mfma_f32_16x16x32_bf16 v[164:167], v[196:199], v[92:95], v[164:167]
    ds_read_b64_tr_b16 v[196:197], v234 offset:0
    ds_read_b64_tr_b16 v[198:199], v234 offset:256
    s_waitcnt lgkmcnt(14)
    v_mfma_f32_16x16x32_bf16 v[144:147], v[200:203], v[88:91], v[144:147]
    v_mfma_f32_16x16x32_bf16 v[168:171], v[200:203], v[92:95], v[168:171]
    ds_read_b64_tr_b16 v[200:201], v233 offset:2048
    ds_read_b64_tr_b16 v[202:203], v233 offset:2304
    s_waitcnt lgkmcnt(14)
    v_mfma_f32_16x16x32_bf16 v[148:151], v[204:207], v[88:91], v[148:151]
    v_mfma_f32_16x16x32_bf16 v[172:175], v[204:207], v[92:95], v[172:175]
    ds_read_b64_tr_b16 v[204:205], v234 offset:2048
    ds_read_b64_tr_b16 v[206:207], v234 offset:2304
    s_waitcnt lgkmcnt(14)
    v_mfma_f32_16x16x32_bf16 v[152:155], v[88:91], v[208:211], v[152:155]
    v_mfma_f32_16x16x32_bf16 v[176:179], v[92:95], v[208:211], v[176:179]
    ds_read_b64_tr_b16 v[208:209], v233 offset:4096
    ds_read_b64_tr_b16 v[210:211], v233 offset:4352
    s_waitcnt lgkmcnt(14)
    v_mfma_f32_16x16x32_bf16 v[156:159], v[88:91], v[212:215], v[156:159]
    v_mfma_f32_16x16x32_bf16 v[180:183], v[92:95], v[212:215], v[180:183]
    ds_read_b64_tr_b16 v[212:213], v234 offset:4096
    ds_read_b64_tr_b16 v[214:215], v234 offset:4352
    s_waitcnt lgkmcnt(14)
    v_mfma_f32_16x16x32_bf16 v[184:187], v[216:219], v[96:99], v[184:187]
    ds_read_b64_tr_b16 v[216:217], v235 offset:0
    ds_read_b64_tr_b16 v[218:219], v235 offset:256
    s_waitcnt lgkmcnt(14)
    v_mfma_f32_16x16x32_bf16 v[188:191], v[220:223], v[96:99], v[188:191]
    ds_read_b64_tr_b16 v[220:221], v236 offset:0
    ds_read_b64_tr_b16 v[222:223], v236 offset:256
    s_waitcnt vmcnt(24)
    s_barrier
    v_dot2c_f32_bf16 v224, s5, v100
    v_dot2c_f32_bf16 v225, v100, v100
    v_dot2c_f32_bf16 v226, s5, v104
    v_dot2c_f32_bf16 v227, v104, v104
    v_dot2c_f32_bf16 v228, s5, v108
    v_dot2c_f32_bf16 v229, v108, v108
    v_dot2c_f32_bf16 v224, s5, v101
    v_dot2c_f32_bf16 v225, v101, v101
    v_dot2c_f32_bf16 v226, s5, v105
    v_dot2c_f32_bf16 v227, v105, v105
    v_dot2c_f32_bf16 v228, s5, v109
    v_dot2c_f32_bf16 v229, v109, v109
    v_dot2c_f32_bf16 v224, s5, v102
    v_dot2c_f32_bf16 v225, v102, v102
    v_dot2c_f32_bf16 v226, s5, v106
    v_dot2c_f32_bf16 v227, v106, v106
    v_dot2c_f32_bf16 v228, s5, v110
    v_dot2c_f32_bf16 v229, v110, v110
    v_dot2c_f32_bf16 v224, s5, v103
    v_dot2c_f32_bf16 v225, v103, v103
    v_dot2c_f32_bf16 v226, s5, v107
    v_dot2c_f32_bf16 v227, v107, v107
    v_dot2c_f32_bf16 v228, s5, v111
    v_dot2c_f32_bf16 v229, v111, v111
    s_waitcnt lgkmcnt(14)
    v_mfma_f32_16x16x32_bf16 v[136:139], v[192:195], v[100:103], v[136:139]
    v_mfma_f32_16x16x32_bf16 v[160:163], v[192:195], v[104:107], v[160:163]
    ds_read_b64_tr_b16 v[192:193], v233 offset:6144
    ds_read_b64_tr_b16 v[194:195], v233 offset:6400
    s_waitcnt lgkmcnt(14)
    v_mfma_f32_16x16x32_bf16 v[140:143], v[196:199], v[100:103], v[140:143]
    v_mfma_f32_16x16x32_bf16 v[164:167], v[196:199], v[104:107], v[164:167]
    ds_read_b64_tr_b16 v[196:197], v234 offset:6144
    ds_read_b64_tr_b16 v[198:199], v234 offset:6400
    s_waitcnt lgkmcnt(14)
    v_mfma_f32_16x16x32_bf16 v[144:147], v[200:203], v[100:103], v[144:147]
    v_mfma_f32_16x16x32_bf16 v[168:171], v[200:203], v[104:107], v[168:171]
    ds_read_b64_tr_b16 v[200:201], v233 offset:8192
    ds_read_b64_tr_b16 v[202:203], v233 offset:8448
    s_waitcnt lgkmcnt(14)
    v_mfma_f32_16x16x32_bf16 v[148:151], v[204:207], v[100:103], v[148:151]
    v_mfma_f32_16x16x32_bf16 v[172:175], v[204:207], v[104:107], v[172:175]
    ds_read_b64_tr_b16 v[204:205], v234 offset:8192
    ds_read_b64_tr_b16 v[206:207], v234 offset:8448
    s_waitcnt lgkmcnt(14)
    v_mfma_f32_16x16x32_bf16 v[152:155], v[100:103], v[208:211], v[152:155]
    v_mfma_f32_16x16x32_bf16 v[176:179], v[104:107], v[208:211], v[176:179]
    ds_read_b64_tr_b16 v[208:209], v233 offset:10240
    ds_read_b64_tr_b16 v[210:211], v233 offset:10496
    s_waitcnt lgkmcnt(14)
    v_mfma_f32_16x16x32_bf16 v[156:159], v[100:103], v[212:215], v[156:159]
    v_mfma_f32_16x16x32_bf16 v[180:183], v[104:107], v[212:215], v[180:183]
    ds_read_b64_tr_b16 v[212:213], v234 offset:10240
    ds_read_b64_tr_b16 v[214:215], v234 offset:10496
    s_waitcnt lgkmcnt(14)
    v_mfma_f32_16x16x32_bf16 v[184:187], v[216:219], v[108:111], v[184:187]
    ds_read_b64_tr_b16 v[216:217], v235 offset:6144
    ds_read_b64_tr_b16 v[218:219], v235 offset:6400
    s_waitcnt lgkmcnt(14)
    v_mfma_f32_16x16x32_bf16 v[188:191], v[220:223], v[108:111], v[188:191]
    ds_read_b64_tr_b16 v[220:221], v236 offset:6144
    ds_read_b64_tr_b16 v[222:223], v236 offset:6400
    s_waitcnt vmcnt(23)
    v_dot2c_f32_bf16 v224, s5, v112
    v_dot2c_f32_bf16 v225, v112, v112
    s_waitcnt vmcnt(22)
    v_dot2c_f32_bf16 v226, s5, v116
    v_dot2c_f32_bf16 v227, v116, v116
    s_waitcnt vmcnt(21)
    v_dot2c_f32_bf16 v228, s5, v120
    v_dot2c_f32_bf16 v229, v120, v120
    v_dot2c_f32_bf16 v224, s5, v113
    v_dot2c_f32_bf16 v225, v113, v113
    v_dot2c_f32_bf16 v226, s5, v117
    v_dot2c_f32_bf16 v227, v117, v117
    v_dot2c_f32_bf16 v228, s5, v121
    v_dot2c_f32_bf16 v229, v121, v121
    v_dot2c_f32_bf16 v224, s5, v114
    v_dot2c_f32_bf16 v225, v114, v114
    v_dot2c_f32_bf16 v226, s5, v118
    v_dot2c_f32_bf16 v227, v118, v118
    v_dot2c_f32_bf16 v228, s5, v122
    v_dot2c_f32_bf16 v229, v122, v122
    v_dot2c_f32_bf16 v224, s5, v115
    v_dot2c_f32_bf16 v225, v115, v115
    v_dot2c_f32_bf16 v226, s5, v119
    v_dot2c_f32_bf16 v227, v119, v119
    v_dot2c_f32_bf16 v228, s5, v123
    v_dot2c_f32_bf16 v229, v123, v123
    s_waitcnt lgkmcnt(14)
    v_mfma_f32_16x16x32_bf16 v[136:139], v[192:195], v[112:115], v[136:139]
    v_mfma_f32_16x16x32_bf16 v[160:163], v[192:195], v[116:119], v[160:163]
    ds_read_b64_tr_b16 v[192:193], v233 offset:12288
    ds_read_b64_tr_b16 v[194:195], v233 offset:12544
    s_waitcnt lgkmcnt(14)
    v_mfma_f32_16x16x32_bf16 v[140:143], v[196:199], v[112:115], v[140:143]
    v_mfma_f32_16x16x32_bf16 v[164:167], v[196:199], v[116:119], v[164:167]
    ds_read_b64_tr_b16 v[196:197], v234 offset:12288
    ds_read_b64_tr_b16 v[198:199], v234 offset:12544
    s_waitcnt lgkmcnt(14)
    v_mfma_f32_16x16x32_bf16 v[144:147], v[200:203], v[112:115], v[144:147]
    v_mfma_f32_16x16x32_bf16 v[168:171], v[200:203], v[116:119], v[168:171]
    ds_read_b64_tr_b16 v[200:201], v233 offset:14336
    ds_read_b64_tr_b16 v[202:203], v233 offset:14592
    s_waitcnt lgkmcnt(14)
    v_mfma_f32_16x16x32_bf16 v[148:151], v[204:207], v[112:115], v[148:151]
    v_mfma_f32_16x16x32_bf16 v[172:175], v[204:207], v[116:119], v[172:175]
    ds_read_b64_tr_b16 v[204:205], v234 offset:14336
    ds_read_b64_tr_b16 v[206:207], v234 offset:14592
    s_waitcnt lgkmcnt(14)
    v_mfma_f32_16x16x32_bf16 v[152:155], v[112:115], v[208:211], v[152:155]
    v_mfma_f32_16x16x32_bf16 v[176:179], v[116:119], v[208:211], v[176:179]
    ds_read_b64_tr_b16 v[208:209], v233 offset:16384
    ds_read_b64_tr_b16 v[210:211], v233 offset:16640
    s_waitcnt lgkmcnt(14)
    v_mfma_f32_16x16x32_bf16 v[156:159], v[112:115], v[212:215], v[156:159]
    v_mfma_f32_16x16x32_bf16 v[180:183], v[116:119], v[212:215], v[180:183]
    ds_read_b64_tr_b16 v[212:213], v234 offset:16384
    ds_read_b64_tr_b16 v[214:215], v234 offset:16640
    s_waitcnt lgkmcnt(14)
    v_mfma_f32_16x16x32_bf16 v[184:187], v[216:219], v[120:123], v[184:187]
    ds_read_b64_tr_b16 v[216:217], v235 offset:12288
    ds_read_b64_tr_b16 v[218:219], v235 offset:12544
    s_waitcnt lgkmcnt(14)
    v_mfma_f32_16x16x32_bf16 v[188:191], v[220:223], v[120:123], v[188:191]
    ds_read_b64_tr_b16 v[220:221], v236 offset:12288
    ds_read_b64_tr_b16 v[222:223], v236 offset:12544
    s_waitcnt vmcnt(15)
    s_barrier
    v_dot2c_f32_bf16 v224, s5, v124
    v_dot2c_f32_bf16 v225, v124, v124
    v_dot2c_f32_bf16 v226, s5, v128
    v_dot2c_f32_bf16 v227, v128, v128
    v_dot2c_f32_bf16 v228, s5, v132
    v_dot2c_f32_bf16 v229, v132, v132
    v_dot2c_f32_bf16 v224, s5, v125
    v_dot2c_f32_bf16 v225, v125, v125
    v_dot2c_f32_bf16 v226, s5, v129
    v_dot2c_f32_bf16 v227, v129, v129
    v_dot2c_f32_bf16 v228, s5, v133
    v_dot2c_f32_bf16 v229, v133, v133
    v_dot2c_f32_bf16 v224, s5, v126
    v_dot2c_f32_bf16 v225, v126, v126
    v_dot2c_f32_bf16 v226, s5, v130
    v_dot2c_f32_bf16 v227, v130, v130
    v_dot2c_f32_bf16 v228, s5, v134
    v_dot2c_f32_bf16 v229, v134, v134
    v_dot2c_f32_bf16 v224, s5, v127
    v_dot2c_f32_bf16 v225, v127, v127
    v_dot2c_f32_bf16 v226, s5, v131
    v_dot2c_f32_bf16 v227, v131, v131
    v_dot2c_f32_bf16 v228, s5, v135
    v_dot2c_f32_bf16 v229, v135, v135
    s_waitcnt lgkmcnt(14)
    v_mfma_f32_16x16x32_bf16 v[136:139], v[192:195], v[124:127], v[136:139]
    v_mfma_f32_16x16x32_bf16 v[160:163], v[192:195], v[128:131], v[160:163]
    ds_read_b64_tr_b16 v[192:193], v233 offset:18432
    ds_read_b64_tr_b16 v[194:195], v233 offset:18688
    s_waitcnt lgkmcnt(14)
    v_mfma_f32_16x16x32_bf16 v[140:143], v[196:199], v[124:127], v[140:143]
    v_mfma_f32_16x16x32_bf16 v[164:167], v[196:199], v[128:131], v[164:167]
    ds_read_b64_tr_b16 v[196:197], v234 offset:18432
    ds_read_b64_tr_b16 v[198:199], v234 offset:18688
    s_waitcnt lgkmcnt(14)
    v_mfma_f32_16x16x32_bf16 v[144:147], v[200:203], v[124:127], v[144:147]
    v_mfma_f32_16x16x32_bf16 v[168:171], v[200:203], v[128:131], v[168:171]
    ds_read_b64_tr_b16 v[200:201], v233 offset:20480
    ds_read_b64_tr_b16 v[202:203], v233 offset:20736
    s_waitcnt lgkmcnt(14)
    v_mfma_f32_16x16x32_bf16 v[148:151], v[204:207], v[124:127], v[148:151]
    v_mfma_f32_16x16x32_bf16 v[172:175], v[204:207], v[128:131], v[172:175]
    ds_read_b64_tr_b16 v[204:205], v234 offset:20480
    ds_read_b64_tr_b16 v[206:207], v234 offset:20736
    s_waitcnt lgkmcnt(14)
    v_mfma_f32_16x16x32_bf16 v[152:155], v[124:127], v[208:211], v[152:155]
    v_mfma_f32_16x16x32_bf16 v[176:179], v[128:131], v[208:211], v[176:179]
    ds_read_b64_tr_b16 v[208:209], v233 offset:22528
    ds_read_b64_tr_b16 v[210:211], v233 offset:22784
    s_waitcnt lgkmcnt(14)
    v_mfma_f32_16x16x32_bf16 v[156:159], v[124:127], v[212:215], v[156:159]
    v_mfma_f32_16x16x32_bf16 v[180:183], v[128:131], v[212:215], v[180:183]
    ds_read_b64_tr_b16 v[212:213], v234 offset:22528
    ds_read_b64_tr_b16 v[214:215], v234 offset:22784
    s_waitcnt lgkmcnt(14)
    v_mfma_f32_16x16x32_bf16 v[184:187], v[216:219], v[132:135], v[184:187]
    ds_read_b64_tr_b16 v[216:217], v235 offset:18432
    ds_read_b64_tr_b16 v[218:219], v235 offset:18688
    s_waitcnt lgkmcnt(14)
    v_mfma_f32_16x16x32_bf16 v[188:191], v[220:223], v[132:135], v[188:191]
    ds_read_b64_tr_b16 v[220:221], v236 offset:18432
    ds_read_b64_tr_b16 v[222:223], v236 offset:18688
    s_waitcnt vmcnt(11)
    v_dot2c_f32_bf16 v224, s5, v16
    v_dot2c_f32_bf16 v225, v16, v16
    s_waitcnt vmcnt(10)
    v_dot2c_f32_bf16 v226, s5, v20
    v_dot2c_f32_bf16 v227, v20, v20
    s_waitcnt vmcnt(9)
    v_dot2c_f32_bf16 v228, s5, v24
    v_dot2c_f32_bf16 v229, v24, v24
    v_dot2c_f32_bf16 v224, s5, v17
    v_dot2c_f32_bf16 v225, v17, v17
    v_dot2c_f32_bf16 v226, s5, v21
    v_dot2c_f32_bf16 v227, v21, v21
    v_dot2c_f32_bf16 v228, s5, v25
    v_dot2c_f32_bf16 v229, v25, v25
    v_dot2c_f32_bf16 v224, s5, v18
    v_dot2c_f32_bf16 v225, v18, v18
    v_dot2c_f32_bf16 v226, s5, v22
    v_dot2c_f32_bf16 v227, v22, v22
    v_dot2c_f32_bf16 v228, s5, v26
    v_dot2c_f32_bf16 v229, v26, v26
    v_dot2c_f32_bf16 v224, s5, v19
    v_dot2c_f32_bf16 v225, v19, v19
    v_dot2c_f32_bf16 v226, s5, v23
    v_dot2c_f32_bf16 v227, v23, v23
    v_dot2c_f32_bf16 v228, s5, v27
    v_dot2c_f32_bf16 v229, v27, v27
    s_waitcnt lgkmcnt(14)
    v_mfma_f32_16x16x32_bf16 v[136:139], v[192:195], v[16:19], v[136:139]
    v_mfma_f32_16x16x32_bf16 v[160:163], v[192:195], v[20:23], v[160:163]
    ds_read_b64_tr_b16 v[192:193], v233 offset:24576
    ds_read_b64_tr_b16 v[194:195], v233 offset:24832
    s_waitcnt lgkmcnt(14)
    v_mfma_f32_16x16x32_bf16 v[140:143], v[196:199], v[16:19], v[140:143]
    v_mfma_f32_16x16x32_bf16 v[164:167], v[196:199], v[20:23], v[164:167]
    ds_read_b64_tr_b16 v[196:197], v234 offset:24576
    ds_read_b64_tr_b16 v[198:199], v234 offset:24832
    s_waitcnt lgkmcnt(14)
    v_mfma_f32_16x16x32_bf16 v[144:147], v[200:203], v[16:19], v[144:147]
    v_mfma_f32_16x16x32_bf16 v[168:171], v[200:203], v[20:23], v[168:171]
    ds_read_b64_tr_b16 v[200:201], v233 offset:26624
    ds_read_b64_tr_b16 v[202:203], v233 offset:26880
    s_waitcnt lgkmcnt(14)
    v_mfma_f32_16x16x32_bf16 v[148:151], v[204:207], v[16:19], v[148:151]
    v_mfma_f32_16x16x32_bf16 v[172:175], v[204:207], v[20:23], v[172:175]
    ds_read_b64_tr_b16 v[204:205], v234 offset:26624
    ds_read_b64_tr_b16 v[206:207], v234 offset:26880
    s_waitcnt lgkmcnt(14)
    v_mfma_f32_16x16x32_bf16 v[152:155], v[16:19], v[208:211], v[152:155]
    v_mfma_f32_16x16x32_bf16 v[176:179], v[20:23], v[208:211], v[176:179]
    ds_read_b64_tr_b16 v[208:209], v233 offset:28672
    ds_read_b64_tr_b16 v[210:211], v233 offset:28928
    s_waitcnt lgkmcnt(14)
    v_mfma_f32_16x16x32_bf16 v[156:159], v[16:19], v[212:215], v[156:159]
    v_mfma_f32_16x16x32_bf16 v[180:183], v[20:23], v[212:215], v[180:183]
    ds_read_b64_tr_b16 v[212:213], v234 offset:28672
    ds_read_b64_tr_b16 v[214:215], v234 offset:28928
    s_waitcnt lgkmcnt(14)
    v_mfma_f32_16x16x32_bf16 v[184:187], v[216:219], v[24:27], v[184:187]
    ds_read_b64_tr_b16 v[216:217], v235 offset:24576
    ds_read_b64_tr_b16 v[218:219], v235 offset:24832
    s_waitcnt lgkmcnt(14)
    v_mfma_f32_16x16x32_bf16 v[188:191], v[220:223], v[24:27], v[188:191]
    ds_read_b64_tr_b16 v[220:221], v236 offset:24576
    ds_read_b64_tr_b16 v[222:223], v236 offset:24832
    s_barrier
    s_waitcnt vmcnt(8)
    v_dot2c_f32_bf16 v224, s5, v28
    v_dot2c_f32_bf16 v225, v28, v28
    s_waitcnt vmcnt(7)
    v_dot2c_f32_bf16 v226, s5, v32
    v_dot2c_f32_bf16 v227, v32, v32
    s_waitcnt vmcnt(6)
    v_dot2c_f32_bf16 v228, s5, v36
    v_dot2c_f32_bf16 v229, v36, v36
    v_dot2c_f32_bf16 v224, s5, v29
    v_dot2c_f32_bf16 v225, v29, v29
    v_dot2c_f32_bf16 v226, s5, v33
    v_dot2c_f32_bf16 v227, v33, v33
    v_dot2c_f32_bf16 v228, s5, v37
    v_dot2c_f32_bf16 v229, v37, v37
    v_dot2c_f32_bf16 v224, s5, v30
    v_dot2c_f32_bf16 v225, v30, v30
    v_dot2c_f32_bf16 v226, s5, v34
    v_dot2c_f32_bf16 v227, v34, v34
    v_dot2c_f32_bf16 v228, s5, v38
    v_dot2c_f32_bf16 v229, v38, v38
    v_dot2c_f32_bf16 v224, s5, v31
    v_dot2c_f32_bf16 v225, v31, v31
    v_dot2c_f32_bf16 v226, s5, v35
    v_dot2c_f32_bf16 v227, v35, v35
    v_dot2c_f32_bf16 v228, s5, v39
    v_dot2c_f32_bf16 v229, v39, v39
    s_waitcnt lgkmcnt(14)
    v_mfma_f32_16x16x32_bf16 v[136:139], v[192:195], v[28:31], v[136:139]
    v_mfma_f32_16x16x32_bf16 v[160:163], v[192:195], v[32:35], v[160:163]
    ds_read_b64_tr_b16 v[192:193], v233 offset:30720
    ds_read_b64_tr_b16 v[194:195], v233 offset:30976
    s_waitcnt lgkmcnt(14)
    v_mfma_f32_16x16x32_bf16 v[140:143], v[196:199], v[28:31], v[140:143]
    v_mfma_f32_16x16x32_bf16 v[164:167], v[196:199], v[32:35], v[164:167]
    ds_read_b64_tr_b16 v[196:197], v234 offset:30720
    ds_read_b64_tr_b16 v[198:199], v234 offset:30976
    s_waitcnt lgkmcnt(14)
    v_mfma_f32_16x16x32_bf16 v[144:147], v[200:203], v[28:31], v[144:147]
    v_mfma_f32_16x16x32_bf16 v[168:171], v[200:203], v[32:35], v[168:171]
    ds_read_b64_tr_b16 v[200:201], v233 offset:32768
    ds_read_b64_tr_b16 v[202:203], v233 offset:33024
    s_waitcnt lgkmcnt(14)
    v_mfma_f32_16x16x32_bf16 v[148:151], v[204:207], v[28:31], v[148:151]
    v_mfma_f32_16x16x32_bf16 v[172:175], v[204:207], v[32:35], v[172:175]
    ds_read_b64_tr_b16 v[204:205], v234 offset:32768
    ds_read_b64_tr_b16 v[206:207], v234 offset:33024
    s_waitcnt lgkmcnt(14)
    v_mfma_f32_16x16x32_bf16 v[152:155], v[28:31], v[208:211], v[152:155]
    v_mfma_f32_16x16x32_bf16 v[176:179], v[32:35], v[208:211], v[176:179]
    ds_read_b64_tr_b16 v[208:209], v233 offset:34816
    ds_read_b64_tr_b16 v[210:211], v233 offset:35072
    s_waitcnt lgkmcnt(14)
    v_mfma_f32_16x16x32_bf16 v[156:159], v[28:31], v[212:215], v[156:159]
    v_mfma_f32_16x16x32_bf16 v[180:183], v[32:35], v[212:215], v[180:183]
    ds_read_b64_tr_b16 v[212:213], v234 offset:34816
    ds_read_b64_tr_b16 v[214:215], v234 offset:35072
    s_waitcnt lgkmcnt(14)
    v_mfma_f32_16x16x32_bf16 v[184:187], v[216:219], v[36:39], v[184:187]
    ds_read_b64_tr_b16 v[216:217], v235 offset:30720
    ds_read_b64_tr_b16 v[218:219], v235 offset:30976
    s_waitcnt lgkmcnt(14)
    v_mfma_f32_16x16x32_bf16 v[188:191], v[220:223], v[36:39], v[188:191]
    ds_read_b64_tr_b16 v[220:221], v236 offset:30720
    ds_read_b64_tr_b16 v[222:223], v236 offset:30976
    s_waitcnt vmcnt(5)
    v_dot2c_f32_bf16 v224, s5, v40
    v_dot2c_f32_bf16 v225, v40, v40
    s_waitcnt vmcnt(4)
    v_dot2c_f32_bf16 v226, s5, v44
    v_dot2c_f32_bf16 v227, v44, v44
    s_waitcnt vmcnt(3)
    v_dot2c_f32_bf16 v228, s5, v48
    v_dot2c_f32_bf16 v229, v48, v48
    v_dot2c_f32_bf16 v224, s5, v41
    v_dot2c_f32_bf16 v225, v41, v41
    v_dot2c_f32_bf16 v226, s5, v45
    v_dot2c_f32_bf16 v227, v45, v45
    v_dot2c_f32_bf16 v228, s5, v49
    v_dot2c_f32_bf16 v229, v49, v49
    v_dot2c_f32_bf16 v224, s5, v42
    v_dot2c_f32_bf16 v225, v42, v42
    v_dot2c_f32_bf16 v226, s5, v46
    v_dot2c_f32_bf16 v227, v46, v46
    v_dot2c_f32_bf16 v228, s5, v50
    v_dot2c_f32_bf16 v229, v50, v50
    v_dot2c_f32_bf16 v224, s5, v43
    v_dot2c_f32_bf16 v225, v43, v43
    v_dot2c_f32_bf16 v226, s5, v47
    v_dot2c_f32_bf16 v227, v47, v47
    v_dot2c_f32_bf16 v228, s5, v51
    v_dot2c_f32_bf16 v229, v51, v51
    s_waitcnt lgkmcnt(14)
    v_mfma_f32_16x16x32_bf16 v[136:139], v[192:195], v[40:43], v[136:139]
    v_mfma_f32_16x16x32_bf16 v[160:163], v[192:195], v[44:47], v[160:163]
    ds_read_b64_tr_b16 v[192:193], v233 offset:36864
    ds_read_b64_tr_b16 v[194:195], v233 offset:37120
    s_waitcnt lgkmcnt(14)
    v_mfma_f32_16x16x32_bf16 v[140:143], v[196:199], v[40:43], v[140:143]
    v_mfma_f32_16x16x32_bf16 v[164:167], v[196:199], v[44:47], v[164:167]
    ds_read_b64_tr_b16 v[196:197], v234 offset:36864
    ds_read_b64_tr_b16 v[198:199], v234 offset:37120
    s_waitcnt lgkmcnt(14)
    v_mfma_f32_16x16x32_bf16 v[144:147], v[200:203], v[40:43], v[144:147]
    v_mfma_f32_16x16x32_bf16 v[168:171], v[200:203], v[44:47], v[168:171]
    ds_read_b64_tr_b16 v[200:201], v233 offset:38912
    ds_read_b64_tr_b16 v[202:203], v233 offset:39168
    s_waitcnt lgkmcnt(14)
    v_mfma_f32_16x16x32_bf16 v[148:151], v[204:207], v[40:43], v[148:151]
    v_mfma_f32_16x16x32_bf16 v[172:175], v[204:207], v[44:47], v[172:175]
    ds_read_b64_tr_b16 v[204:205], v234 offset:38912
    ds_read_b64_tr_b16 v[206:207], v234 offset:39168
    s_waitcnt lgkmcnt(14)
    v_mfma_f32_16x16x32_bf16 v[152:155], v[40:43], v[208:211], v[152:155]
    v_mfma_f32_16x16x32_bf16 v[176:179], v[44:47], v[208:211], v[176:179]
    ds_read_b64_tr_b16 v[208:209], v233 offset:40960
    ds_read_b64_tr_b16 v[210:211], v233 offset:41216
    s_waitcnt lgkmcnt(14)
    v_mfma_f32_16x16x32_bf16 v[156:159], v[40:43], v[212:215], v[156:159]
    v_mfma_f32_16x16x32_bf16 v[180:183], v[44:47], v[212:215], v[180:183]
    ds_read_b64_tr_b16 v[212:213], v234 offset:40960
    ds_read_b64_tr_b16 v[214:215], v234 offset:41216
    s_waitcnt lgkmcnt(14)
    v_mfma_f32_16x16x32_bf16 v[184:187], v[216:219], v[48:51], v[184:187]
    ds_read_b64_tr_b16 v[216:217], v235 offset:36864
    ds_read_b64_tr_b16 v[218:219], v235 offset:37120
    s_waitcnt lgkmcnt(14)
    v_mfma_f32_16x16x32_bf16 v[188:191], v[220:223], v[48:51], v[188:191]
    ds_read_b64_tr_b16 v[220:221], v236 offset:36864
    ds_read_b64_tr_b16 v[222:223], v236 offset:37120
    s_waitcnt vmcnt(2)
    v_dot2c_f32_bf16 v224, s5, v52
    v_dot2c_f32_bf16 v225, v52, v52
    s_waitcnt vmcnt(1)
    v_dot2c_f32_bf16 v226, s5, v56
    v_dot2c_f32_bf16 v227, v56, v56
    s_waitcnt vmcnt(0)
    v_dot2c_f32_bf16 v228, s5, v60
    v_dot2c_f32_bf16 v229, v60, v60
    v_dot2c_f32_bf16 v224, s5, v53
    v_dot2c_f32_bf16 v225, v53, v53
    v_dot2c_f32_bf16 v226, s5, v57
    v_dot2c_f32_bf16 v227, v57, v57
    v_dot2c_f32_bf16 v228, s5, v61
    v_dot2c_f32_bf16 v229, v61, v61
    v_dot2c_f32_bf16 v224, s5, v54
    v_dot2c_f32_bf16 v225, v54, v54
    v_dot2c_f32_bf16 v226, s5, v58
    v_dot2c_f32_bf16 v227, v58, v58
    v_dot2c_f32_bf16 v228, s5, v62
    v_dot2c_f32_bf16 v229, v62, v62
    v_dot2c_f32_bf16 v224, s5, v55
    v_dot2c_f32_bf16 v225, v55, v55
    v_dot2c_f32_bf16 v226, s5, v59
    v_dot2c_f32_bf16 v227, v59, v59
    v_dot2c_f32_bf16 v228, s5, v63
    v_dot2c_f32_bf16 v229, v63, v63
    s_waitcnt lgkmcnt(14)
    v_mfma_f32_16x16x32_bf16 v[136:139], v[192:195], v[52:55], v[136:139]
    v_mfma_f32_16x16x32_bf16 v[160:163], v[192:195], v[56:59], v[160:163]
    s_waitcnt lgkmcnt(12)
    v_mfma_f32_16x16x32_bf16 v[140:143], v[196:199], v[52:55], v[140:143]
    v_mfma_f32_16x16x32_bf16 v[164:167], v[196:199], v[56:59], v[164:167]
    s_waitcnt lgkmcnt(10)
    v_mfma_f32_16x16x32_bf16 v[144:147], v[200:203], v[52:55], v[144:147]
    v_mfma_f32_16x16x32_bf16 v[168:171], v[200:203], v[56:59], v[168:171]
    s_waitcnt lgkmcnt(8)
    v_mfma_f32_16x16x32_bf16 v[148:151], v[204:207], v[52:55], v[148:151]
    v_mfma_f32_16x16x32_bf16 v[172:175], v[204:207], v[56:59], v[172:175]
    s_waitcnt lgkmcnt(6)
    v_mfma_f32_16x16x32_bf16 v[152:155], v[52:55], v[208:211], v[152:155]
    v_mfma_f32_16x16x32_bf16 v[176:179], v[56:59], v[208:211], v[176:179]
    s_waitcnt lgkmcnt(4)
    v_mfma_f32_16x16x32_bf16 v[156:159], v[52:55], v[212:215], v[156:159]
    v_mfma_f32_16x16x32_bf16 v[180:183], v[56:59], v[212:215], v[180:183]
    s_waitcnt lgkmcnt(2)
    v_mfma_f32_16x16x32_bf16 v[184:187], v[216:219], v[60:63], v[184:187]
    s_waitcnt lgkmcnt(0)
    v_mfma_f32_16x16x32_bf16 v[188:191], v[220:223], v[60:63], v[188:191]
    v_mov_b32 v16, v224
    v_mov_b32 v17, v225
    v_mov_b32 v18, v226
    v_mov_b32 v19, v227
    v_mov_b32 v20, v228
    v_mov_b32 v21, v229
    v_permlane32_swap_b32 v224, v16
    v_permlane32_swap_b32 v225, v17
    v_permlane32_swap_b32 v226, v18
    v_permlane32_swap_b32 v227, v19
    v_permlane32_swap_b32 v228, v20
    v_permlane32_swap_b32 v229, v21
    v_add_f32 v224, v224, v16
    v_add_f32 v225, v225, v17
    v_add_f32 v226, v226, v18
    v_add_f32 v227, v227, v19
    v_add_f32 v228, v228, v20
    v_add_f32 v229, v229, v21
    v_mov_b32 v16, v224
    v_mov_b32 v17, v225
    v_mov_b32 v18, v226
    v_mov_b32 v19, v227
    v_mov_b32 v20, v228
    v_mov_b32 v21, v229
    v_permlane16_swap_b32 v224, v16
    v_permlane16_swap_b32 v225, v17
    v_permlane16_swap_b32 v226, v18
    v_permlane16_swap_b32 v227, v19
    v_permlane16_swap_b32 v228, v20
    v_permlane16_swap_b32 v229, v21
    v_add_f32 v224, v224, v16
    v_add_f32 v225, v225, v17
    v_add_f32 v226, v226, v18
    v_add_f32 v227, v227, v19
    v_add_f32 v228, v228, v20
    v_add_f32 v229, v229, v21
    v_mul_f32 v25, 0x3b124925, v224
    v_mul_f32 v24, v25, v25
    v_mul_f32 v225, 0x3b124925, v225
    v_sub_f32 v24, v225, v24
    v_max_f32 v24, 0, v24
    v_add_f32 v24, 0x3727c5ac, v24
    v_rsq_f32 v24, v24
    v_mul_f32 v27, 0x3b124925, v226
    v_mul_f32 v26, v27, v27
    v_mul_f32 v227, 0x3b124925, v227
    v_sub_f32 v26, v227, v26
    v_max_f32 v26, 0, v26
    v_add_f32 v26, 0x3727c5ac, v26
    v_rsq_f32 v26, v26
    v_mul_f32 v29, 0x3b124925, v228
    v_mul_f32 v28, v29, v29
    v_mul_f32 v229, 0x3b124925, v229
    v_sub_f32 v28, v229, v28
    v_max_f32 v28, 0, v28
    v_add_f32 v28, 0x3727c5ac, v28
    v_rsq_f32 v28, v28
    v_lshlrev_b32 v32, 4, v3
    s_lshl_b32 s53, s3, 6
    v_add_u32 v33, s53, v32
    s_and_b32 s53, s53, 64
    v_add_u32 v34, s53, v32
    s_not_b64 exec, s[54:55]
    ds_write_b128 v33, v[184:187] offset:128
    ds_write_b128 v34, v[188:191] offset:0
    s_mov_b64 exec, 0xffff
    s_lshl_b32 s53, s3, 8
    v_lshl_add_u32 v35, v2, 2, s53
    ds_write_b32 v35, v24 offset:512
    ds_write_b32 v35, v25 offset:576
    ds_write_b32 v35, v26 offset:640
    ds_write_b32 v35, v27 offset:704
    s_mov_b64 exec, -1
    v_mov_b32_dpp v40, v184 row_newbcast:0 row_mask:0xf bank_mask:0xf
    v_mov_b32_dpp v41, v185 row_newbcast:0 row_mask:0xf bank_mask:0xf
    v_mov_b32_dpp v42, v186 row_newbcast:0 row_mask:0xf bank_mask:0xf
    v_mov_b32_dpp v43, v187 row_newbcast:0 row_mask:0xf bank_mask:0xf
    v_fma_f32 v40, -v29, v40, v184
    v_fma_f32 v41, -v29, v41, v185
    v_fma_f32 v42, -v29, v42, v186
    v_fma_f32 v43, -v29, v43, v187
    v_mul_f32 v40, v28, v40
    v_mul_f32 v41, v28, v41
    v_mul_f32 v42, v28, v42
    v_mul_f32 v43, v28, v43
    v_cvt_pk_bf16_f32 v40, v40, v41
    v_cvt_pk_bf16_f32 v42, v42, v43
    s_and_b32 s53, s3, 1
    s_lshl_b32 s53, s53, 3
    v_add_u32 v44, s53, v4
    v_lshrrev_b32 v45, 2, v2
    v_lshlrev_b32 v45, 8, v45
    v_lshl_add_u32 v45, v3, 6, v45
    v_and_b32 v46, 3, v2
    v_lshl_add_u32 v45, v46, 1, v45
    v_add_u32 v45, s53, v45
    v_add_u32 v45, 1024, v45
    s_cmp_lt_u32 s3, 2
    s_cselect_b64 vcc, -1, 0
    s_cselect_b32 s53, 2, 16
    v_cndmask_b32 v44, v45, v44, vcc
    v_add_u32 v45, s53, v44
    v_add_u32 v46, s53, v45
    v_add_u32 v47, s53, v46
    ds_write_b16 v44, v40 offset:2048
    ds_write_b16_d16_hi v45, v40 offset:2048
    ds_write_b16 v46, v42 offset:2048
    ds_write_b16_d16_hi v47, v42 offset:2048
    s_waitcnt lgkmcnt(0)
    s_barrier
    ds_read_b128 v[48:51], v32 offset:0
    ds_read_b128 v[52:55], v32 offset:64
    ds_read_b128 v[56:59], v32 offset:128
    ds_read_b128 v[60:63], v32 offset:192
    v_lshlrev_b32 v33, 2, v2
    ds_read_b32 v64, v33 offset:256
    ds_read_b32 v65, v33 offset:320
    s_lshl_b32 s53, s3, 8
    v_add_u32 v34, s53, v32
    ds_read_b128 v[68:71], v34 offset:512
    ds_read_b128 v[72:75], v34 offset:576
    ds_read_b128 v[76:79], v34 offset:640
    ds_read_b128 v[80:83], v34 offset:704
    v_cmp_ne_u32 vcc, 3, v3
    v_mul_f32 v84, 0x3e8b97f6, v24
    v_mul_f32 v86, 0x3e8b97f6, v26
    v_cndmask_b32 v85, 0, v84, vcc
    v_cndmask_b32 v87, 0, v86, vcc
    s_waitcnt lgkmcnt(7)
    v_fma_f32 v168, -v27, v56, v168
    v_fma_f32 v169, -v27, v57, v169
    v_fma_f32 v170, -v27, v58, v170
    v_fma_f32 v171, -v27, v59, v171
    v_mul_f32 v168, v26, v168
    v_mul_f32 v169, v26, v169
    v_mul_f32 v170, v26, v170
    v_mul_f32 v171, v26, v171
    v_cvt_pk_bf16_f32 v104, v168, v169
    v_cvt_pk_bf16_f32 v105, v170, v171
    s_waitcnt lgkmcnt(6)
    v_fma_f32 v172, -v27, v60, v172
    v_fma_f32 v173, -v27, v61, v173
    v_fma_f32 v174, -v27, v62, v174
    v_fma_f32 v175, -v27, v63, v175
    v_mul_f32 v172, v26, v172
    v_mul_f32 v173, v26, v173
    v_mul_f32 v174, v26, v174
    v_mul_f32 v175, v26, v175
    v_cvt_pk_bf16_f32 v106, v172, v173
    v_cvt_pk_bf16_f32 v107, v174, v175
    s_waitcnt lgkmcnt(0)
    v_fma_f32 v176, -v80, v64, v176
    v_fma_f32 v177, -v81, v64, v177
    v_fma_f32 v178, -v82, v64, v178
    v_fma_f32 v179, -v83, v64, v179
    v_mul_f32 v176, v76, v176
    v_mul_f32 v177, v77, v177
    v_mul_f32 v178, v78, v178
    v_mul_f32 v179, v79, v179
    v_cvt_pk_bf16_f32 v112, v176, v177
    v_cvt_pk_bf16_f32 v113, v178, v179
    v_fma_f32 v180, -v80, v65, v180
    v_fma_f32 v181, -v81, v65, v181
    v_fma_f32 v182, -v82, v65, v182
    v_fma_f32 v183, -v83, v65, v183
    v_mul_f32 v180, v76, v180
    v_mul_f32 v181, v77, v181
    v_mul_f32 v182, v78, v182
    v_mul_f32 v183, v79, v183
    v_cvt_pk_bf16_f32 v118, v180, v181
    v_cvt_pk_bf16_f32 v119, v182, v183
    s_lshl_b32 s53, s3, 11
    v_add_u32 v35, s53, v4
    ds_write_b128 v35, v[104:107] offset:4096
    ds_write_b64 v35, v[112:113] offset:5120
    ds_write_b64 v35, v[118:119] offset:5128
    v_fma_f32 v144, -v25, v56, v144
    v_fma_f32 v145, -v25, v57, v145
    v_fma_f32 v146, -v25, v58, v146
    v_fma_f32 v147, -v25, v59, v147
    v_mul_f32 v144, v24, v144
    v_mul_f32 v145, v24, v145
    v_mul_f32 v146, v24, v146
    v_mul_f32 v147, v24, v147
    v_cvt_pk_bf16_f32 v100, v144, v145
    v_cvt_pk_bf16_f32 v101, v146, v147
    v_fma_f32 v148, -v25, v60, v148
    v_fma_f32 v149, -v25, v61, v149
    v_fma_f32 v150, -v25, v62, v150
    v_fma_f32 v151, -v25, v63, v151
    v_mul_f32 v148, v24, v148
    v_mul_f32 v149, v24, v149
    v_mul_f32 v150, v24, v150
    v_mul_f32 v151, v24, v151
    v_cvt_pk_bf16_f32 v102, v148, v149
    v_cvt_pk_bf16_f32 v103, v150, v151
    v_fma_f32 v160, -v27, v48, v160
    v_fma_f32 v161, -v27, v49, v161
    v_fma_f32 v162, -v27, v50, v162
    v_fma_f32 v163, -v27, v51, v163
    v_mul_f32 v160, v86, v160
    v_mul_f32 v161, v86, v161
    v_mul_f32 v162, v86, v162
    v_mul_f32 v163, v86, v163
    v_cvt_pk_bf16_f32 v92, v160, v161
    v_cvt_pk_bf16_f32 v93, v162, v163
    v_fma_f32 v164, -v27, v52, v164
    v_fma_f32 v165, -v27, v53, v165
    v_fma_f32 v166, -v27, v54, v166
    v_fma_f32 v167, -v27, v55, v167
    v_mul_f32 v164, v87, v164
    v_mul_f32 v165, v87, v165
    v_mul_f32 v166, v87, v166
    v_mul_f32 v167, v87, v167
    v_cvt_pk_bf16_f32 v94, v164, v165
    v_cvt_pk_bf16_f32 v95, v166, v167
    s_waitcnt lgkmcnt(0)
    s_barrier
    ds_read_b128 v[96:99], v35 offset:2048
    ds_read_b64 v[108:109], v35 offset:3072
    ds_read_b64 v[114:115], v35 offset:3080
    v_mfma_f32_16x16x32_bf16 v[128:131], v[100:103], v[92:95], v[240:243]
    v_mfma_f32_16x16x32_bf16 v[132:135], v[104:107], v[92:95], v[244:247]
    v_fma_f32 v136, -v25, v48, v136
    v_fma_f32 v137, -v25, v49, v137
    v_fma_f32 v138, -v25, v50, v138
    v_fma_f32 v139, -v25, v51, v139
    v_mul_f32 v136, v84, v136
    v_mul_f32 v137, v84, v137
    v_mul_f32 v138, v84, v138
    v_mul_f32 v139, v84, v139
    v_cvt_pk_bf16_f32 v88, v136, v137
    v_cvt_pk_bf16_f32 v89, v138, v139
    v_fma_f32 v140, -v25, v52, v140
    v_fma_f32 v141, -v25, v53, v141
    v_fma_f32 v142, -v25, v54, v142
    v_fma_f32 v143, -v25, v55, v143
    v_mul_f32 v140, v85, v140
    v_mul_f32 v141, v85, v141
    v_mul_f32 v142, v85, v142
    v_mul_f32 v143, v85, v143
    v_cvt_pk_bf16_f32 v90, v140, v141
    v_cvt_pk_bf16_f32 v91, v142, v143
    v_fma_f32 v152, -v72, v64, v152
    v_fma_f32 v153, -v73, v64, v153
    v_fma_f32 v154, -v74, v64, v154
    v_fma_f32 v155, -v75, v64, v155
    v_mul_f32 v152, v68, v152
    v_mul_f32 v153, v69, v153
    v_mul_f32 v154, v70, v154
    v_mul_f32 v155, v71, v155
    v_cvt_pk_bf16_f32 v110, v152, v153
    v_cvt_pk_bf16_f32 v111, v154, v155
    v_fma_f32 v156, -v72, v65, v156
    v_fma_f32 v157, -v73, v65, v157
    v_fma_f32 v158, -v74, v65, v158
    v_fma_f32 v159, -v75, v65, v159
    v_mul_f32 v156, v68, v156
    v_mul_f32 v157, v69, v157
    v_mul_f32 v158, v70, v158
    v_mul_f32 v159, v71, v159
    v_cvt_pk_bf16_f32 v116, v156, v157
    v_cvt_pk_bf16_f32 v117, v158, v159
    s_waitcnt lgkmcnt(2)
    v_mfma_f32_16x16x32_bf16 v[120:123], v[96:99], v[88:91], v[248:251]
    v_mfma_f32_16x16x32_bf16 v[124:127], v[100:103], v[88:91], v[244:247]
    v_max3_f32 v137, v128, v129, v130
    v_max3_f32 v139, v131, v132, v133
    v_max3_f32 v137, v137, v134, v135
    v_max_f32 v137, v137, v139
    s_nop 2
    v_max3_f32 v136, v120, v121, v122
    v_max3_f32 v138, v123, v124, v125
    v_max3_f32 v136, v136, v126, v127
    v_max_f32 v136, v136, v138
    v_mov_b32 v138, v136
    v_mov_b32 v139, v137
    s_nop 0
    v_permlane32_swap_b32 v136, v138
    v_permlane32_swap_b32 v137, v139
    v_max_f32 v136, v136, v138
    v_max_f32 v137, v137, v139
    v_mov_b32 v138, v136
    v_mov_b32 v139, v137
    s_nop 0
    v_permlane16_swap_b32 v136, v138
    v_permlane16_swap_b32 v137, v139
    v_max_f32 v136, v136, v138
    v_max_f32 v137, v137, v139
    v_sub_f32 v128, v128, v137
    v_sub_f32 v129, v129, v137
    v_sub_f32 v130, v130, v137
    v_sub_f32 v131, v131, v137
    v_sub_f32 v132, v132, v137
    v_sub_f32 v133, v133, v137
    v_sub_f32 v134, v134, v137
    v_sub_f32 v135, v135, v137
    v_exp_f32 v128, v128
    v_exp_f32 v129, v129
    v_exp_f32 v130, v130
    v_exp_f32 v131, v131
    v_exp_f32 v132, v132
    v_exp_f32 v133, v133
    v_exp_f32 v134, v134
    v_exp_f32 v135, v135
    v_cvt_pk_bf16_f32 v148, v128, v129
    v_cvt_pk_bf16_f32 v149, v130, v131
    v_cvt_pk_bf16_f32 v150, v132, v133
    v_cvt_pk_bf16_f32 v151, v134, v135
    v_sub_f32 v120, v120, v136
    v_sub_f32 v121, v121, v136
    v_sub_f32 v122, v122, v136
    v_sub_f32 v123, v123, v136
    v_sub_f32 v124, v124, v136
    v_sub_f32 v125, v125, v136
    v_sub_f32 v126, v126, v136
    v_sub_f32 v127, v127, v136
    v_exp_f32 v120, v120
    v_exp_f32 v121, v121
    v_exp_f32 v122, v122
    v_exp_f32 v123, v123
    v_exp_f32 v124, v124
    v_exp_f32 v125, v125
    v_exp_f32 v126, v126
    v_exp_f32 v127, v127
    v_cvt_pk_bf16_f32 v144, v120, v121
    v_cvt_pk_bf16_f32 v145, v122, v123
    v_cvt_pk_bf16_f32 v146, v124, v125
    v_cvt_pk_bf16_f32 v147, v126, v127
    v_mfma_f32_16x16x32_bf16 v[160:163], v[110:113], v[148:151], 0
    v_mfma_f32_16x16x32_bf16 v[164:167], v[116:119], v[148:151], 0
    s_waitcnt lgkmcnt(1)
    v_mfma_f32_16x16x32_bf16 v[152:155], v[108:111], v[144:147], 0
    s_waitcnt lgkmcnt(0)
    v_mfma_f32_16x16x32_bf16 v[156:159], v[114:117], v[144:147], 0
    v_add_f32 v140, v120, v121
    v_add_f32 v138, v122, v123
    v_add_f32 v140, v140, v124
    v_add_f32 v138, v138, v125
    v_add_f32 v140, v140, v126
    v_add_f32 v138, v138, v127
    v_add_f32 v140, v140, v138
    v_add_f32 v141, v128, v129
    v_add_f32 v139, v130, v131
    v_add_f32 v141, v141, v132
    v_add_f32 v139, v139, v133
    v_add_f32 v141, v141, v134
    v_add_f32 v139, v139, v135
    v_add_f32 v141, v141, v139
    v_mov_b32 v138, v140
    v_mov_b32 v139, v141
    s_nop 0
    v_permlane32_swap_b32 v140, v138
    v_permlane32_swap_b32 v141, v139
    v_add_f32 v140, v140, v138
    v_add_f32 v141, v141, v139
    v_mov_b32 v138, v140
    v_mov_b32 v139, v141
    s_nop 0
    v_permlane16_swap_b32 v140, v138
    v_permlane16_swap_b32 v141, v139
    v_add_f32 v140, v140, v138
    v_add_f32 v141, v141, v139
    v_cmp_ne_u32 vcc, 3, v3
    v_rcp_f32 v140, v140
    v_rcp_f32 v141, v141
    v_cndmask_b32 v138, 0, v140, vcc
    v_cndmask_b32 v139, 0, v141, vcc
    s_lshl_b32 s53, s48, 3
    s_lshl_b32 s50, s3, 1
    s_add_u32 s53, s53, s50
    s_lshl_b32 s53, s53, 4
    s_add_u32 s53, s53, s49
    s_lshl_b32 s53, s53, 10
    s_add_u32 s50, s53, 16384
    v_mul_f32 v152, v140, v152
    v_mul_f32 v153, v140, v153
    v_mul_f32 v154, v140, v154
    v_mul_f32 v155, v140, v155
    v_mul_f32 v156, v138, v156
    v_mul_f32 v157, v138, v157
    v_mul_f32 v158, v138, v158
    v_mul_f32 v159, v138, v159
    v_cvt_pk_bf16_f32 v144, v152, v153
    v_cvt_pk_bf16_f32 v145, v154, v155
    v_cvt_pk_bf16_f32 v146, v156, v157
    v_cvt_pk_bf16_f32 v147, v158, v159
    buffer_store_dwordx4 v[144:147], v4, s[40:43], s53 offen
    v_mul_f32 v160, v141, v160
    v_mul_f32 v161, v141, v161
    v_mul_f32 v162, v141, v162
    v_mul_f32 v163, v141, v163
    v_mul_f32 v164, v139, v164
    v_mul_f32 v165, v139, v165
    v_mul_f32 v166, v139, v166
    v_mul_f32 v167, v139, v167
    v_cvt_pk_bf16_f32 v148, v160, v161
    v_cvt_pk_bf16_f32 v149, v162, v163
    v_cvt_pk_bf16_f32 v150, v164, v165
    v_cvt_pk_bf16_f32 v151, v166, v167
    buffer_store_dwordx4 v[148:151], v4, s[40:43], s50 offen
L_end_A:
    s_endpgm

.globl phaseB_kernel
.p2align 8
.type phaseB_kernel,@function
phaseB_kernel:
    s_cmp_ge_u32 s2, 256
    s_cbranch_scc1 L_end_B
    s_load_dwordx2 s[8:9], s[0:1], 0
    s_load_dwordx2 s[16:17], s[0:1], 16
    s_load_dwordx2 s[40:41], s[0:1], 80
    s_load_dwordx2 s[44:45], s[0:1], 72
    v_lshrrev_b32 v1, 6, v0
    s_nop 0
    v_readfirstlane_b32 s3, v1
    v_and_b32 v1, 63, v0
    v_and_b32 v2, 15, v0
    v_lshrrev_b32 v3, 4, v1
    v_lshlrev_b32 v4, 4, v1
    s_mov_b32 s10, 0x1c0000
    s_mov_b32 s11, 0x00020000
    s_mov_b32 s18, 0x62000
    s_mov_b32 s19, 0x00020000
    s_mov_b32 s42, 0x900000
    s_mov_b32 s43, 0x00020000
    s_mov_b32 s46, 0x100
    s_mov_b32 s47, 0x00020000
    s_mov_b32 s5, 0x3f803f80
    s_or_b32 s48, s2, s3
    s_cmp_lg_u32 s48, 0
    s_cbranch_scc1 Lep_B_1
    s_memrealtime s[48:49]
    v_mov_b32 v251, 0
    s_waitcnt lgkmcnt(0)
    s_or_b32 s48, s48, 1
    v_mov_b32 v250, s48
    s_mov_b64 exec, 1
    buffer_store_dword v250, v251, s[44:47], 0 offen sc0 sc1
    s_mov_b64 exec, -1
    s_waitcnt vmcnt(0)
Lep_B_1:
    s_and_b32 s56, s2, 7
    s_lshl_b32 s56, s56, 3
    s_lshr_b32 s58, s2, 5
    s_add_u32 s56, s56, s58
    s_lshr_b32 s57, s2, 3
    s_and_b32 s57, s57, 3
    v_lshrrev_b32 v209, 2, v1
    v_mul_u32_u24 v208, 896, v209
    v_and_b32 v209, 1, v3
    v_lshlrev_b32 v209, 1, v209
    v_and_b32 v210, 3, v1
    v_xor_b32 v209, v209, v210
    v_lshl_add_u32 v208, v209, 4, v208
    s_mul_i32 s58, s57, 224
    s_lshl_b32 s60, s3, 6
    s_add_u32 s58, s58, s60
    v_add_u32 v208, s58, v208
    s_mul_i32 s59, s3, 28672
    s_add_u32 s59, s59, 36864
    v_bfe_u32 v64, v1, 2, 2
    v_lshlrev_b32 v64, 6, v64
    v_and_b32 v65, 3, v1
    v_lshl_add_u32 v64, v65, 3, v64
    v_add_u32 v64, s59, v64
    v_and_b32 v65, 1, v3
    v_lshlrev_b32 v65, 5, v65
    v_add_u32 v64, v64, v65
    v_lshl_add_u32 v209, v3, 8, v64
    v_xor_b32 v210, 32, v209
    v_cmp_eq_u32 vcc, 3, v3
    s_nop 1
    v_cndmask_b32 v65, v3, 1, vcc
    v_lshl_add_u32 v211, v65, 8, v64
    v_add_u32 v211, 1024, v211
    v_xor_b32 v212, 32, v211
    s_add_u32 m0, s59, 0
    s_mov_b32 s58, 0
    s_waitcnt lgkmcnt(0)
    buffer_load_dwordx4 v208, s[16:19], s58 offen lds
    s_add_u32 m0, s59, 1024
    s_mov_b32 s58, 14336
    buffer_load_dwordx4 v208, s[16:19], s58 offen lds
    s_add_u32 m0, s59, 2048
    s_mov_b32 s58, 28672
    buffer_load_dwordx4 v208, s[16:19], s58 offen lds
    s_add_u32 m0, s59, 3072
    s_mov_b32 s58, 43008
    buffer_load_dwordx4 v208, s[16:19], s58 offen lds
    s_add_u32 m0, s59, 4096
    s_mov_b32 s58, 57344
    buffer_load_dwordx4 v208, s[16:19], s58 offen lds
    s_add_u32 m0, s59, 5120
    s_mov_b32 s58, 71680
    buffer_load_dwordx4 v208, s[16:19], s58 offen lds
    s_add_u32 m0, s59, 6144
    s_mov_b32 s58, 86016
    buffer_load_dwordx4 v208, s[16:19], s58 offen lds
    s_add_u32 m0, s59, 7168
    s_mov_b32 s58, 100352
    buffer_load_dwordx4 v208, s[16:19], s58 offen lds
    s_add_u32 m0, s59, 8192
    s_mov_b32 s58, 114688
    buffer_load_dwordx4 v208, s[16:19], s58 offen lds
    s_add_u32 m0, s59, 9216
    s_mov_b32 s58, 129024
    buffer_load_dwordx4 v208, s[16:19], s58 offen lds
    s_add_u32 m0, s59, 10240
    s_mov_b32 s58, 143360
    buffer_load_dwordx4 v208, s[16:19], s58 offen lds
    s_add_u32 m0, s59, 11264
    s_mov_b32 s58, 157696
    buffer_load_dwordx4 v208, s[16:19], s58 offen lds
    s_add_u32 m0, s59, 12288
    s_mov_b32 s58, 172032
    buffer_load_dwordx4 v208, s[16:19], s58 offen lds
    s_add_u32 m0, s59, 13312
    s_mov_b32 s58, 186368
    buffer_load_dwordx4 v208, s[16:19], s58 offen lds
    s_add_u32 m0, s59, 14336
    s_mov_b32 s58, 200704
    buffer_load_dwordx4 v208, s[16:19], s58 offen lds
    s_add_u32 m0, s59, 15360
    s_mov_b32 s58, 215040
    buffer_load_dwordx4 v208, s[16:19], s58 offen lds
    s_add_u32 m0, s59, 16384
    s_mov_b32 s58, 229376
    buffer_load_dwordx4 v208, s[16:19], s58 offen lds
    s_add_u32 m0, s59, 17408
    s_mov_b32 s58, 243712
    buffer_load_dwordx4 v208, s[16:19], s58 offen lds
    s_add_u32 m0, s59, 18432
    s_mov_b32 s58, 258048
    buffer_load_dwordx4 v208, s[16:19], s58 offen lds
    s_add_u32 m0, s59, 19456
    s_mov_b32 s58, 272384
    buffer_load_dwordx4 v208, s[16:19], s58 offen lds
    s_add_u32 m0, s59, 20480
    s_mov_b32 s58, 286720
    buffer_load_dwordx4 v208, s[16:19], s58 offen lds
    s_add_u32 m0, s59, 21504
    s_mov_b32 s58, 301056
    buffer_load_dwordx4 v208, s[16:19], s58 offen lds
    s_add_u32 m0, s59, 22528
    s_mov_b32 s58, 315392
    buffer_load_dwordx4 v208, s[16:19], s58 offen lds
    s_add_u32 m0, s59, 23552
    s_mov_b32 s58, 329728
    buffer_load_dwordx4 v208, s[16:19], s58 offen lds
    s_add_u32 m0, s59, 24576
    s_mov_b32 s58, 344064
    buffer_load_dwordx4 v208, s[16:19], s58 offen lds
    s_add_u32 m0, s59, 25600
    s_mov_b32 s58, 358400
    buffer_load_dwordx4 v208, s[16:19], s58 offen lds
    s_add_u32 m0, s59, 26624
    s_mov_b32 s58, 372736
    buffer_load_dwordx4 v208, s[16:19], s58 offen lds
    s_add_u32 m0, s59, 27648
    s_mov_b32 s58, 387072
    buffer_load_dwordx4 v208, s[16:19], s58 offen lds
    v_mul_u32_u24 v64, 3584, v3
    v_lshl_add_u32 v64, v2, 1, v64
    s_mul_i32 s58, s56, 28672
    s_mul_i32 s60, s57, 224
    s_add_u32 s58, s58, s60
    s_lshl_b32 s60, s3, 6
    s_add_u32 s58, s58, s60
    s_add_u32 s60, s58, 14336
    buffer_load_ushort v16, v64, s[8:11], s58 offen offset:0
    buffer_load_ushort v17, v64, s[8:11], s58 offen offset:896
    buffer_load_ushort v18, v64, s[8:11], s58 offen offset:1792
    buffer_load_ushort v19, v64, s[8:11], s58 offen offset:2688
    buffer_load_ushort v20, v64, s[8:11], s58 offen offset:32
    buffer_load_ushort v21, v64, s[8:11], s58 offen offset:928
    buffer_load_ushort v22, v64, s[8:11], s58 offen offset:1824
    buffer_load_ushort v23, v64, s[8:11], s58 offen offset:2720
    buffer_load_ushort v24, v64, s[8:11], s60 offen offset:0
    buffer_load_ushort v25, v64, s[8:11], s60 offen offset:896
    buffer_load_ushort v26, v64, s[8:11], s60 offen offset:1792
    buffer_load_ushort v27, v64, s[8:11], s60 offen offset:2688
    buffer_load_ushort v28, v64, s[8:11], s60 offen offset:32
    buffer_load_ushort v29, v64, s[8:11], s60 offen offset:928
    buffer_load_ushort v30, v64, s[8:11], s60 offen offset:1824
    buffer_load_ushort v31, v64, s[8:11], s60 offen offset:2720
    s_waitcnt vmcnt(30)
    ds_read_b64_tr_b16 a[0:1], v209 offset:0
    ds_read_b64_tr_b16 a[2:3], v211 offset:0
    ds_read_b64_tr_b16 a[4:5], v210 offset:0
    ds_read_b64_tr_b16 a[6:7], v212 offset:0
    ds_read_b64_tr_b16 a[8:9], v210 offset:1792
    ds_read_b64_tr_b16 a[10:11], v212 offset:1792
    ds_read_b64_tr_b16 a[12:13], v209 offset:1792
    ds_read_b64_tr_b16 a[14:15], v211 offset:1792
    ds_read_b64_tr_b16 a[16:17], v209 offset:3584
    ds_read_b64_tr_b16 a[18:19], v211 offset:3584
    ds_read_b64_tr_b16 a[20:21], v210 offset:3584
    ds_read_b64_tr_b16 a[22:23], v212 offset:3584
    ds_read_b64_tr_b16 a[24:25], v210 offset:5376
    ds_read_b64_tr_b16 a[26:27], v212 offset:5376
    ds_read_b64_tr_b16 a[28:29], v209 offset:5376
    ds_read_b64_tr_b16 a[30:31], v211 offset:5376
    ds_read_b64_tr_b16 a[32:33], v209 offset:7168
    ds_read_b64_tr_b16 a[34:35], v211 offset:7168
    ds_read_b64_tr_b16 a[36:37], v210 offset:7168
    ds_read_b64_tr_b16 a[38:39], v212 offset:7168
    ds_read_b64_tr_b16 a[40:41], v210 offset:8960
    ds_read_b64_tr_b16 a[42:43], v212 offset:8960
    ds_read_b64_tr_b16 a[44:45], v209 offset:8960
    ds_read_b64_tr_b16 a[46:47], v211 offset:8960
    ds_read_b64_tr_b16 a[48:49], v209 offset:10752
    ds_read_b64_tr_b16 a[50:51], v211 offset:10752
    ds_read_b64_tr_b16 a[52:53], v210 offset:10752
    ds_read_b64_tr_b16 a[54:55], v212 offset:10752
    ds_read_b64_tr_b16 a[56:57], v210 offset:12544
    ds_read_b64_tr_b16 a[58:59], v212 offset:12544
    ds_read_b64_tr_b16 a[60:61], v209 offset:12544
    ds_read_b64_tr_b16 a[62:63], v211 offset:12544
    s_waitcnt vmcnt(16)
    ds_read_b64_tr_b16 a[64:65], v209 offset:14336
    ds_read_b64_tr_b16 a[66:67], v211 offset:14336
    ds_read_b64_tr_b16 a[68:69], v210 offset:14336
    ds_read_b64_tr_b16 a[70:71], v212 offset:14336
    ds_read_b64_tr_b16 a[72:73], v210 offset:16128
    ds_read_b64_tr_b16 a[74:75], v212 offset:16128
    ds_read_b64_tr_b16 a[76:77], v209 offset:16128
    ds_read_b64_tr_b16 a[78:79], v211 offset:16128
    ds_read_b64_tr_b16 a[80:81], v209 offset:17920
    ds_read_b64_tr_b16 a[82:83], v211 offset:17920
    ds_read_b64_tr_b16 a[84:85], v210 offset:17920
    ds_read_b64_tr_b16 a[86:87], v212 offset:17920
    ds_read_b64_tr_b16 a[88:89], v210 offset:19712
    ds_read_b64_tr_b16 a[90:91], v212 offset:19712
    ds_read_b64_tr_b16 a[92:93], v209 offset:19712
    ds_read_b64_tr_b16 a[94:95], v211 offset:19712
    ds_read_b64_tr_b16 a[96:97], v209 offset:21504
    ds_read_b64_tr_b16 a[98:99], v211 offset:21504
    ds_read_b64_tr_b16 a[100:101], v210 offset:21504
    ds_read_b64_tr_b16 a[102:103], v212 offset:21504
    ds_read_b64_tr_b16 a[104:105], v210 offset:23296
    ds_read_b64_tr_b16 a[106:107], v212 offset:23296
    ds_read_b64_tr_b16 a[108:109], v209 offset:23296
    ds_read_b64_tr_b16 a[110:111], v211 offset:23296
    ds_read_b64_tr_b16 a[112:113], v209 offset:25088
    ds_read_b64_tr_b16 a[114:115], v211 offset:25088
    ds_read_b64_tr_b16 a[116:117], v210 offset:25088
    ds_read_b64_tr_b16 a[118:119], v212 offset:25088
    ds_read_b64_tr_b16 a[120:121], v210 offset:26880
    ds_read_b64_tr_b16 a[122:123], v212 offset:26880
    ds_read_b64_tr_b16 a[124:125], v209 offset:26880
    ds_read_b64_tr_b16 a[126:127], v211 offset:26880
    s_waitcnt vmcnt(15)
    v_lshlrev_b32 v16, 16, v16
    s_waitcnt vmcnt(14)
    v_lshlrev_b32 v17, 16, v17
    s_waitcnt vmcnt(13)
    v_lshlrev_b32 v18, 16, v18
    s_waitcnt vmcnt(12)
    v_lshlrev_b32 v19, 16, v19
    s_waitcnt vmcnt(11)
    v_lshlrev_b32 v20, 16, v20
    s_waitcnt vmcnt(10)
    v_lshlrev_b32 v21, 16, v21
    s_waitcnt vmcnt(9)
    v_lshlrev_b32 v22, 16, v22
    s_waitcnt vmcnt(8)
    v_lshlrev_b32 v23, 16, v23
    s_waitcnt vmcnt(7)
    v_lshlrev_b32 v24, 16, v24
    s_waitcnt vmcnt(6)
    v_lshlrev_b32 v25, 16, v25
    s_waitcnt vmcnt(5)
    v_lshlrev_b32 v26, 16, v26
    s_waitcnt vmcnt(4)
    v_lshlrev_b32 v27, 16, v27
    s_waitcnt vmcnt(3)
    v_lshlrev_b32 v28, 16, v28
    s_waitcnt vmcnt(2)
    v_lshlrev_b32 v29, 16, v29
    s_waitcnt vmcnt(1)
    v_lshlrev_b32 v30, 16, v30
    s_waitcnt vmcnt(0)
    v_lshlrev_b32 v31, 16, v31
    v_mov_b32 v251, 0
    s_nop 4
Lepg_B_2:
    buffer_load_dword v250, v251, s[44:47], 0 offen sc0 sc1
    s_waitcnt vmcnt(0)
    v_readfirstlane_b32 s4, v250
    s_nop 1
    s_cmp_eq_u32 s4, 0
    s_cbranch_scc1 Lepg_B_2
    s_lshl_b32 s58, s56, 15
    s_lshl_b32 s60, s3, 13
    s_add_u32 s58, s58, s60
    s_add_u32 m0, s60, 4096
    s_nop 0
    buffer_load_dwordx4 v4, s[40:43], s58 offen offset:0 lds
    buffer_load_dwordx4 v4, s[40:43], s58 offen offset:1024 lds
    buffer_load_dwordx4 v4, s[40:43], s58 offen offset:2048 lds
    buffer_load_dwordx4 v4, s[40:43], s58 offen offset:3072 lds
    s_add_u32 m0, s60, 8192
    s_add_u32 s58, s58, 4096
    buffer_load_dwordx4 v4, s[40:43], s58 offen offset:0 lds
    buffer_load_dwordx4 v4, s[40:43], s58 offen offset:1024 lds
    buffer_load_dwordx4 v4, s[40:43], s58 offen offset:2048 lds
    buffer_load_dwordx4 v4, s[40:43], s58 offen offset:3072 lds
    v_add_u32 v64, 4096, v4
    s_cmp_lg_u32 s3, 3
    s_cselect_b32 s61, 1.0, 0
    s_waitcnt vmcnt(0)
    s_barrier
    ds_read_b128 v[32:35], v64 offset:0
    ds_read_b128 v[36:39], v64 offset:16384
    ds_read_b128 v[40:43], v64 offset:1024
    ds_read_b128 v[44:47], v64 offset:17408
    ds_read_b128 v[48:51], v64 offset:2048
    ds_read_b128 v[52:55], v64 offset:18432
    ds_read_b128 v[56:59], v64 offset:3072
    ds_read_b128 v[60:63], v64 offset:19456
    s_waitcnt lgkmcnt(7)
    v_mfma_f32_16x16x32_bf16 v[16:19], v[32:35], a[0:3], v[16:19]
    v_mfma_f32_16x16x32_bf16 v[20:23], v[32:35], a[4:7], v[20:23]
    ds_read_b128 v[32:35], v64 offset:4096
    s_waitcnt lgkmcnt(7)
    v_mfma_f32_16x16x32_bf16 v[24:27], v[36:39], a[0:3], v[24:27]
    v_mfma_f32_16x16x32_bf16 v[28:31], v[36:39], a[4:7], v[28:31]
    ds_read_b128 v[36:39], v64 offset:20480
    s_waitcnt lgkmcnt(7)
    v_mfma_f32_16x16x32_bf16 v[16:19], v[40:43], a[8:11], v[16:19]
    v_mfma_f32_16x16x32_bf16 v[20:23], v[40:43], a[12:15], v[20:23]
    ds_read_b128 v[40:43], v64 offset:5120
    s_waitcnt lgkmcnt(7)
    v_mfma_f32_16x16x32_bf16 v[24:27], v[44:47], a[8:11], v[24:27]
    v_mfma_f32_16x16x32_bf16 v[28:31], v[44:47], a[12:15], v[28:31]
    ds_read_b128 v[44:47], v64 offset:21504
    s_waitcnt lgkmcnt(7)
    v_mfma_f32_16x16x32_bf16 v[16:19], v[48:51], a[16:19], v[16:19]
    v_mfma_f32_16x16x32_bf16 v[20:23], v[48:51], a[20:23], v[20:23]
    ds_read_b128 v[48:51], v64 offset:6144
    s_waitcnt lgkmcnt(7)
    v_mfma_f32_16x16x32_bf16 v[24:27], v[52:55], a[16:19], v[24:27]
    v_mfma_f32_16x16x32_bf16 v[28:31], v[52:55], a[20:23], v[28:31]
    ds_read_b128 v[52:55], v64 offset:22528
    s_waitcnt lgkmcnt(7)
    v_mfma_f32_16x16x32_bf16 v[16:19], v[56:59], a[24:27], v[16:19]
    v_mfma_f32_16x16x32_bf16 v[20:23], v[56:59], a[28:31], v[20:23]
    ds_read_b128 v[56:59], v64 offset:7168
    s_waitcnt lgkmcnt(7)
    v_mfma_f32_16x16x32_bf16 v[24:27], v[60:63], a[24:27], v[24:27]
    v_mfma_f32_16x16x32_bf16 v[28:31], v[60:63], a[28:31], v[28:31]
    ds_read_b128 v[60:63], v64 offset:23552
    s_waitcnt lgkmcnt(7)
    v_mfma_f32_16x16x32_bf16 v[16:19], v[32:35], a[32:35], v[16:19]
    v_mfma_f32_16x16x32_bf16 v[20:23], v[32:35], a[36:39], v[20:23]
    ds_read_b128 v[32:35], v64 offset:8192
    s_waitcnt lgkmcnt(7)
    v_mfma_f32_16x16x32_bf16 v[24:27], v[36:39], a[32:35], v[24:27]
    v_mfma_f32_16x16x32_bf16 v[28:31], v[36:39], a[36:39], v[28:31]
    ds_read_b128 v[36:39], v64 offset:24576
    s_waitcnt lgkmcnt(7)
    v_mfma_f32_16x16x32_bf16 v[16:19], v[40:43], a[40:43], v[16:19]
    v_mfma_f32_16x16x32_bf16 v[20:23], v[40:43], a[44:47], v[20:23]
    ds_read_b128 v[40:43], v64 offset:9216
    s_waitcnt lgkmcnt(7)
    v_mfma_f32_16x16x32_bf16 v[24:27], v[44:47], a[40:43], v[24:27]
    v_mfma_f32_16x16x32_bf16 v[28:31], v[44:47], a[44:47], v[28:31]
    ds_read_b128 v[44:47], v64 offset:25600
    s_waitcnt lgkmcnt(7)
    v_mfma_f32_16x16x32_bf16 v[16:19], v[48:51], a[48:51], v[16:19]
    v_mfma_f32_16x16x32_bf16 v[20:23], v[48:51], a[52:55], v[20:23]
    ds_read_b128 v[48:51], v64 offset:10240
    s_waitcnt lgkmcnt(7)
    v_mfma_f32_16x16x32_bf16 v[24:27], v[52:55], a[48:51], v[24:27]
    v_mfma_f32_16x16x32_bf16 v[28:31], v[52:55], a[52:55], v[28:31]
    ds_read_b128 v[52:55], v64 offset:26624
    s_waitcnt lgkmcnt(7)
    v_mfma_f32_16x16x32_bf16 v[16:19], v[56:59], a[56:59], v[16:19]
    v_mfma_f32_16x16x32_bf16 v[20:23], v[56:59], a[60:63], v[20:23]
    ds_read_b128 v[56:59], v64 offset:11264
    s_waitcnt lgkmcnt(7)
    v_mfma_f32_16x16x32_bf16 v[24:27], v[60:63], a[56:59], v[24:27]
    v_mfma_f32_16x16x32_bf16 v[28:31], v[60:63], a[60:63], v[28:31]
    ds_read_b128 v[60:63], v64 offset:27648
    s_waitcnt lgkmcnt(7)
    v_mfma_f32_16x16x32_bf16 v[16:19], v[32:35], a[64:67], v[16:19]
    v_mfma_f32_16x16x32_bf16 v[20:23], v[32:35], a[68:71], v[20:23]
    ds_read_b128 v[32:35], v64 offset:12288
    s_waitcnt lgkmcnt(7)
    v_mfma_f32_16x16x32_bf16 v[24:27], v[36:39], a[64:67], v[24:27]
    v_mfma_f32_16x16x32_bf16 v[28:31], v[36:39], a[68:71], v[28:31]
    ds_read_b128 v[36:39], v64 offset:28672
    s_waitcnt lgkmcnt(7)
    v_mfma_f32_16x16x32_bf16 v[16:19], v[40:43], a[72:75], v[16:19]
    v_mfma_f32_16x16x32_bf16 v[20:23], v[40:43], a[76:79], v[20:23]
    ds_read_b128 v[40:43], v64 offset:13312
    s_waitcnt lgkmcnt(7)
    v_mfma_f32_16x16x32_bf16 v[24:27], v[44:47], a[72:75], v[24:27]
    v_mfma_f32_16x16x32_bf16 v[28:31], v[44:47], a[76:79], v[28:31]
    ds_read_b128 v[44:47], v64 offset:29696
    s_waitcnt lgkmcnt(7)
    v_mfma_f32_16x16x32_bf16 v[16:19], v[48:51], a[80:83], v[16:19]
    v_mfma_f32_16x16x32_bf16 v[20:23], v[48:51], a[84:87], v[20:23]
    ds_read_b128 v[48:51], v64 offset:14336
    s_waitcnt lgkmcnt(7)
    v_mfma_f32_16x16x32_bf16 v[24:27], v[52:55], a[80:83], v[24:27]
    v_mfma_f32_16x16x32_bf16 v[28:31], v[52:55], a[84:87], v[28:31]
    ds_read_b128 v[52:55], v64 offset:30720
    s_waitcnt lgkmcnt(7)
    v_mfma_f32_16x16x32_bf16 v[16:19], v[56:59], a[88:91], v[16:19]
    v_mfma_f32_16x16x32_bf16 v[20:23], v[56:59], a[92:95], v[20:23]
    ds_read_b128 v[56:59], v64 offset:15360
    s_waitcnt lgkmcnt(7)
    v_mfma_f32_16x16x32_bf16 v[24:27], v[60:63], a[88:91], v[24:27]
    v_mfma_f32_16x16x32_bf16 v[28:31], v[60:63], a[92:95], v[28:31]
    ds_read_b128 v[60:63], v64 offset:31744
    s_waitcnt lgkmcnt(7)
    v_mfma_f32_16x16x32_bf16 v[16:19], v[32:35], a[96:99], v[16:19]
    v_mfma_f32_16x16x32_bf16 v[20:23], v[32:35], a[100:103], v[20:23]
    s_waitcnt lgkmcnt(6)
    v_mfma_f32_16x16x32_bf16 v[24:27], v[36:39], a[96:99], v[24:27]
    v_mfma_f32_16x16x32_bf16 v[28:31], v[36:39], a[100:103], v[28:31]
    s_waitcnt lgkmcnt(5)
    v_mfma_f32_16x16x32_bf16 v[16:19], v[40:43], a[104:107], v[16:19]
    v_mfma_f32_16x16x32_bf16 v[20:23], v[40:43], a[108:111], v[20:23]
    s_waitcnt lgkmcnt(4)
    v_mfma_f32_16x16x32_bf16 v[24:27], v[44:47], a[104:107], v[24:27]
    v_mfma_f32_16x16x32_bf16 v[28:31], v[44:47], a[108:111], v[28:31]
    s_waitcnt lgkmcnt(3)
    v_mfma_f32_16x16x32_bf16 v[16:19], v[48:51], a[112:115], v[16:19]
    v_mfma_f32_16x16x32_bf16 v[20:23], v[48:51], a[116:119], v[20:23]
    s_waitcnt lgkmcnt(2)
    v_mfma_f32_16x16x32_bf16 v[24:27], v[52:55], a[112:115], v[24:27]
    v_mfma_f32_16x16x32_bf16 v[28:31], v[52:55], a[116:119], v[28:31]
    s_waitcnt lgkmcnt(1)
    v_mfma_f32_16x16x32_bf16 v[16:19], v[56:59], a[120:123], v[16:19]
    v_mfma_f32_16x16x32_bf16 v[20:23], v[56:59], a[124:127], v[20:23]
    s_waitcnt lgkmcnt(0)
    v_mfma_f32_16x16x32_bf16 v[24:27], v[60:63], a[120:123], v[24:27]
    v_mfma_f32_16x16x32_bf16 v[28:31], v[60:63], a[124:127], v[28:31]
    s_nop 4
    v_mul_f32 v84, s61, v20
    v_mul_f32 v85, s61, v21
    v_mul_f32 v86, s61, v22
    v_mul_f32 v87, s61, v23
    v_mul_f32 v88, s61, v28
    v_mul_f32 v89, s61, v29
    v_mul_f32 v90, s61, v30
    v_mul_f32 v91, s61, v31
    v_add_f32 v68, v16, v84
    v_mul_f32 v72, v16, v16
    v_add_f32 v70, v17, v85
    v_mul_f32 v74, v17, v17
    v_add_f32 v69, v18, v86
    v_mul_f32 v73, v18, v18
    v_add_f32 v71, v19, v87
    v_mul_f32 v75, v19, v19
    v_fmac_f32 v72, v84, v84
    v_fmac_f32 v74, v85, v85
    v_fmac_f32 v73, v86, v86
    v_fmac_f32 v75, v87, v87
    v_add_f32 v76, v24, v88
    v_mul_f32 v80, v24, v24
    v_add_f32 v78, v25, v89
    v_mul_f32 v82, v25, v25
    v_add_f32 v77, v26, v90
    v_mul_f32 v81, v26, v26
    v_add_f32 v79, v27, v91
    v_mul_f32 v83, v27, v27
    v_fmac_f32 v80, v88, v88
    v_fmac_f32 v82, v89, v89
    v_fmac_f32 v81, v90, v90
    v_fmac_f32 v83, v91, v91
    v_add_f32_dpp v68, v68, v68 row_mirror row_mask:0xf bank_mask:0x3
    v_add_f32_dpp v70, v70, v70 row_mirror row_mask:0xf bank_mask:0x3
    v_add_f32_dpp v72, v72, v72 row_mirror row_mask:0xf bank_mask:0x3
    v_add_f32_dpp v74, v74, v74 row_mirror row_mask:0xf bank_mask:0x3
    v_add_f32_dpp v76, v76, v76 row_mirror row_mask:0xf bank_mask:0x3
    v_add_f32_dpp v78, v78, v78 row_mirror row_mask:0xf bank_mask:0x3
    v_add_f32_dpp v80, v80, v80 row_mirror row_mask:0xf bank_mask:0x3
    v_add_f32_dpp v82, v82, v82 row_mirror row_mask:0xf bank_mask:0x3
    v_add_f32_dpp v68, v69, v69 row_mirror row_mask:0xf bank_mask:0xc
    v_add_f32_dpp v70, v71, v71 row_mirror row_mask:0xf bank_mask:0xc
    v_add_f32_dpp v72, v73, v73 row_mirror row_mask:0xf bank_mask:0xc
    v_add_f32_dpp v74, v75, v75 row_mirror row_mask:0xf bank_mask:0xc
    v_add_f32_dpp v76, v77, v77 row_mirror row_mask:0xf bank_mask:0xc
    v_add_f32_dpp v78, v79, v79 row_mirror row_mask:0xf bank_mask:0xc
    v_add_f32_dpp v80, v81, v81 row_mirror row_mask:0xf bank_mask:0xc
    v_add_f32_dpp v82, v83, v83 row_mirror row_mask:0xf bank_mask:0xc
    v_add_f32_dpp v68, v68, v68 row_half_mirror row_mask:0xf bank_mask:0x5
    v_add_f32_dpp v72, v72, v72 row_half_mirror row_mask:0xf bank_mask:0x5
    v_add_f32_dpp v76, v76, v76 row_half_mirror row_mask:0xf bank_mask:0x5
    v_add_f32_dpp v80, v80, v80 row_half_mirror row_mask:0xf bank_mask:0x5
    v_add_f32_dpp v68, v70, v70 row_half_mirror row_mask:0xf bank_mask:0xa
    v_add_f32_dpp v72, v74, v74 row_half_mirror row_mask:0xf bank_mask:0xa
    v_add_f32_dpp v76, v78, v78 row_half_mirror row_mask:0xf bank_mask:0xa
    v_add_f32_dpp v80, v82, v82 row_half_mirror row_mask:0xf bank_mask:0xa
    v_add_f32_dpp v69, v68, v68 quad_perm:[1,0,3,2] row_mask:0xf bank_mask:0xf
    v_add_f32_dpp v73, v72, v72 quad_perm:[1,0,3,2] row_mask:0xf bank_mask:0xf
    v_add_f32_dpp v77, v76, v76 quad_perm:[1,0,3,2] row_mask:0xf bank_mask:0xf
    v_add_f32_dpp v81, v80, v80 quad_perm:[1,0,3,2] row_mask:0xf bank_mask:0xf
    v_add_f32_dpp v84, v69, v69 quad_perm:[2,3,0,1] row_mask:0xf bank_mask:0xf
    v_add_f32_dpp v85, v73, v73 quad_perm:[2,3,0,1] row_mask:0xf bank_mask:0xf
    v_add_f32_dpp v86, v77, v77 quad_perm:[2,3,0,1] row_mask:0xf bank_mask:0xf
    v_add_f32_dpp v87, v81, v81 quad_perm:[2,3,0,1] row_mask:0xf bank_mask:0xf
    v_lshrrev_b32 v65, 2, v1
    s_lshl_b32 s58, s3, 8
    v_lshl_add_u32 v65, v65, 3, s58
    ds_write_b64 v65, v[84:85] offset:0
    ds_write_b64 v65, v[86:87] offset:128
    v_and_b32 v67, 31, v1
    v_lshrrev_b32 v66, 5, v1
    v_lshlrev_b32 v66, 9, v66
    v_lshl_add_u32 v65, v67, 4, v66
    v_lshl_add_u32 v66, v67, 3, v66
    s_lshl_b32 s58, s56, 11
    s_add_u32 s58, s58, 0x800000
    s_lshl_b32 s60, s57, 9
    s_add_u32 s60, s60, s58
    s_waitcnt lgkmcnt(0)
    s_barrier
    ds_read_b64 v[68:69], v66 offset:0
    ds_read_b64 v[70:71], v66 offset:256
    s_waitcnt lgkmcnt(0)
    v_add_f32 v72, v68, v70
    v_add_f32 v74, v69, v71
    v_mov_b32 v68, v72
    v_mov_b32 v69, v74
    s_nop 0
    v_permlane32_swap_b32 v72, v68
    v_permlane32_swap_b32 v74, v69
    v_add_f32 v72, v72, v68
    v_add_f32 v74, v74, v69
    v_mov_b32 v73, s4
    v_mov_b32 v75, s4
    s_cmp_eq_u32 s3, 0
    s_cselect_b32 exec_lo, -1, 0
    s_mov_b32 exec_hi, 0
    buffer_store_dwordx4 v[72:75], v65, s[40:43], s60 offen sc0 sc1
    s_mov_b64 exec, -1
    v_lshrrev_b32 v92, 1, v3
    v_lshlrev_b32 v92, 5, v92
    v_add_u32 v92, v92, v2
    v_lshlrev_b32 v92, 4, v92
    v_and_b32 v93, 1, v3
    v_lshl_add_u32 v92, v93, 3, v92
    s_cmp_eq_u32 s3, 3
    s_cselect_b32 s62, 0x40000000, 0
    v_add_u32 v93, s62, v92
    s_mul_i32 s62, s57, 7
    s_lshl_b32 s60, s3, 1
    s_add_u32 s62, s62, s60
    s_and_b32 s60, s62, 1
    s_lshl_b32 s60, s60, 8
    s_lshr_b32 s62, s62, 1
    s_lshl_b32 s62, s62, 17
    s_add_u32 s62, s62, s60
    s_lshl_b32 s60, s56, 11
    s_add_u32 s62, s62, s60
    s_add_u32 s62, s62, 0x400000
    s_mul_i32 s63, s57, 7
    s_lshl_b32 s60, s3, 1
    s_add_u32 s63, s63, s60
    s_add_u32 s63, s63, 1
    s_and_b32 s60, s63, 1
    s_lshl_b32 s60, s60, 8
    s_lshr_b32 s63, s63, 1
    s_lshl_b32 s63, s63, 17
    s_add_u32 s63, s63, s60
    s_lshl_b32 s60, s56, 11
    s_add_u32 s63, s63, s60
    s_add_u32 s63, s63, 0x400000
    v_cvt_pk_bf16_f32 v76, v16, v17
    v_cvt_pk_bf16_f32 v77, v18, v19
    buffer_store_dwordx2 v[76:77], v92, s[40:43], s62 offen offset:0
    v_cvt_pk_bf16_f32 v78, v20, v21
    v_cvt_pk_bf16_f32 v79, v22, v23
    buffer_store_dwordx2 v[78:79], v93, s[40:43], s63 offen offset:0
    v_cvt_pk_bf16_f32 v80, v24, v25
    v_cvt_pk_bf16_f32 v81, v26, v27
    buffer_store_dwordx2 v[80:81], v92, s[40:43], s62 offen offset:1024
    v_cvt_pk_bf16_f32 v82, v28, v29
    v_cvt_pk_bf16_f32 v83, v30, v31
    buffer_store_dwordx2 v[82:83], v93, s[40:43], s63 offen offset:1024
    s_sub_u32 s62, s62, 0x200000
    s_sub_u32 s63, s63, 0x200000
    s_nop 1
Lst_B_3:
    buffer_load_dwordx4 v[96:99], v65, s[40:43], s58 offen sc0 sc1
    buffer_load_dwordx4 v[100:103], v65, s[40:43], s58 offen offset:1024 sc0 sc1
    s_waitcnt vmcnt(0)
    v_xor_b32 v97, s4, v97
    v_xor_b32 v99, s4, v99
    v_xor_b32 v101, s4, v101
    v_xor_b32 v103, s4, v103
    v_or3_b32 v97, v97, v99, v101
    v_or_b32 v97, v97, v103
    v_cmp_ne_u32 vcc, 0, v97
    s_nop 1
    s_cbranch_vccnz Lst_B_3
    v_add_f32 v96, v96, v100
    v_add_f32 v98, v98, v102
    v_mov_b32 v100, v96
    v_mov_b32 v102, v98
    s_nop 0
    v_permlane32_swap_b32 v96, v100
    v_permlane32_swap_b32 v98, v102
    v_add_f32 v96, v96, v100
    v_add_f32 v98, v98, v102
    v_mul_f32 v97, 0x3b124925, v96
    v_mul_f32 v98, 0x3b124925, v98
    v_fma_f32 v98, -v97, v97, v98
    v_max_f32 v98, 0, v98
    v_add_f32 v99, 0x3727c5ac, v98
    v_rsq_f32 v99, v99
    s_nop 0
    v_mul_f32 v98, v98, v99
    v_fmaak_f32 v98, v98, v99, 0x3727c5ac
    v_rsq_f32 v98, v98
    s_nop 0
    v_mul_f32 v99, v99, v98
    s_lshl_b32 s60, s3, 8
    v_lshl_add_u32 v66, v67, 2, s60
    ds_write_b32 v66, v97 offset:1024
    ds_write_b32 v66, v99 offset:1152
    v_lshl_add_u32 v66, v3, 4, s60
    s_waitcnt lgkmcnt(0)
    ds_read_b128 v[104:107], v66 offset:1024
    ds_read_b128 v[108:111], v66 offset:1152
    ds_read_b128 v[112:115], v66 offset:1088
    ds_read_b128 v[116:119], v66 offset:1216
    s_waitcnt lgkmcnt(3)
    v_pk_add_f32 v[16:17], v[16:17], v[104:105] neg_lo:[0,1] neg_hi:[0,1]
    v_pk_add_f32 v[18:19], v[18:19], v[106:107] neg_lo:[0,1] neg_hi:[0,1]
    s_waitcnt lgkmcnt(2)
    v_pk_mul_f32 v[16:17], v[16:17], v[108:109]
    v_pk_mul_f32 v[18:19], v[18:19], v[110:111]
    v_cvt_pk_bf16_f32 v76, v16, v17
    v_cvt_pk_bf16_f32 v77, v18, v19
    buffer_store_dwordx2 v[76:77], v92, s[40:43], s62 offen offset:0
    v_pk_add_f32 v[20:21], v[20:21], v[104:105] neg_lo:[0,1] neg_hi:[0,1]
    v_pk_add_f32 v[22:23], v[22:23], v[106:107] neg_lo:[0,1] neg_hi:[0,1]
    v_pk_mul_f32 v[20:21], v[20:21], v[108:109]
    v_pk_mul_f32 v[22:23], v[22:23], v[110:111]
    v_cvt_pk_bf16_f32 v78, v20, v21
    v_cvt_pk_bf16_f32 v79, v22, v23
    buffer_store_dwordx2 v[78:79], v93, s[40:43], s63 offen offset:0
    s_waitcnt lgkmcnt(1)
    v_pk_add_f32 v[24:25], v[24:25], v[112:113] neg_lo:[0,1] neg_hi:[0,1]
    v_pk_add_f32 v[26:27], v[26:27], v[114:115] neg_lo:[0,1] neg_hi:[0,1]
    s_waitcnt lgkmcnt(0)
    v_pk_mul_f32 v[24:25], v[24:25], v[116:117]
    v_pk_mul_f32 v[26:27], v[26:27], v[118:119]
    v_cvt_pk_bf16_f32 v80, v24, v25
    v_cvt_pk_bf16_f32 v81, v26, v27
    buffer_store_dwordx2 v[80:81], v92, s[40:43], s62 offen offset:1024
    v_pk_add_f32 v[28:29], v[28:29], v[112:113] neg_lo:[0,1] neg_hi:[0,1]
    v_pk_add_f32 v[30:31], v[30:31], v[114:115] neg_lo:[0,1] neg_hi:[0,1]
    v_pk_mul_f32 v[28:29], v[28:29], v[116:117]
    v_pk_mul_f32 v[30:31], v[30:31], v[118:119]
    v_cvt_pk_bf16_f32 v82, v28, v29
    v_cvt_pk_bf16_f32 v83, v30, v31
    buffer_store_dwordx2 v[82:83], v93, s[40:43], s63 offen offset:1024
L_end_B:
    s_endpgm

.globl phaseC_kernel
.p2align 8
.type phaseC_kernel,@function
phaseC_kernel:
    s_cmp_ge_u32 s2, 256
    s_cbranch_scc1 L_end_C
    s_load_dwordx2 s[20:21], s[0:1], 32
    s_load_dwordx2 s[28:29], s[0:1], 40
    s_load_dwordx2 s[40:41], s[0:1], 80
    v_lshrrev_b32 v1, 6, v0
    s_nop 0
    v_readfirstlane_b32 s3, v1
    v_and_b32 v1, 63, v0
    v_and_b32 v2, 15, v0
    v_lshrrev_b32 v3, 4, v1
    v_lshlrev_b32 v4, 4, v1
    s_mov_b32 s22, 0x700000
    s_mov_b32 s23, 0x00020000
    s_mov_b32 s30, 0xe00
    s_mov_b32 s31, 0x00020000
    s_mov_b32 s42, 0x900000
    s_mov_b32 s43, 0x00020000
    s_mov_b32 s5, 0x3f803f80
    s_lshr_b32 s68, s2, 3
    s_mul_i32 s69, s68, 37
    s_lshr_b32 s69, s69, 8
    s_mul_i32 s64, s69, 7
    s_sub_u32 s64, s68, s64
    s_mov_b32 s66, s64
    s_and_b32 s68, s2, 7
    s_lshl_b32 s67, s68, 2
    s_add_u32 s67, s67, s69
    s_cmp_ge_u32 s69, 4
    s_cselect_b32 s67, 99, s67
    s_mul_i32 s71, s68, 3
    s_add_u32 s71, s71, 4
    s_lshl_b32 s72, s68, 2
    s_cmp_lt_u32 s68, 4
    s_cselect_b32 s65, s72, s71
    s_cselect_b32 s71, 4, 3
    s_add_u32 s65, s65, s69
    s_cmp_ge_u32 s69, s71
    s_cselect_b32 s65, 99, s65
    s_cmp_ge_u32 s65, 99
    s_cbranch_scc1 L_end_C
    s_mul_i32 s70, s3, 32768
    s_add_u32 s70, s70, 0
    v_lshrrev_b32 v220, 3, v1
    v_mul_u32_u24 v213, 3584, v220
    v_and_b32 v220, 1, v3
    v_lshlrev_b32 v220, 2, v220
    v_and_b32 v221, 7, v1
    v_xor_b32 v220, v220, v221
    v_lshl_add_u32 v213, v220, 4, v213
    s_mul_i32 s68, s3, 1835008
    s_lshl_b32 s69, s65, 7
    s_add_u32 s68, s68, s69
    v_add_u32 v213, s68, v213
    v_lshrrev_b32 v220, 5, v1
    v_lshlrev_b32 v215, 10, v220
    v_bfe_u32 v220, v1, 2, 2
    v_lshl_add_u32 v215, v220, 7, v215
    v_lshrrev_b32 v220, 1, v220
    s_lshr_b32 s68, s3, 1
    v_xor_b32 v220, s68, v220
    v_lshl_add_u32 v215, v220, 6, v215
    v_and_b32 v220, 1, v3
    v_lshl_add_u32 v215, v220, 5, v215
    v_and_b32 v220, 3, v1
    v_lshl_add_u32 v215, v220, 3, v215
    v_add_u32 v215, s70, v215
    v_xor_b32 v216, 64, v215
    s_add_u32 m0, s70, 0
    s_mov_b32 s68, 0
    s_waitcnt lgkmcnt(0)
    buffer_load_dwordx4 v213, s[20:23], s68 offen lds
    s_add_u32 m0, s70, 1024
    s_mov_b32 s68, 28672
    buffer_load_dwordx4 v213, s[20:23], s68 offen lds
    s_add_u32 m0, s70, 2048
    s_mov_b32 s68, 57344
    buffer_load_dwordx4 v213, s[20:23], s68 offen lds
    s_add_u32 m0, s70, 3072
    s_mov_b32 s68, 86016
    buffer_load_dwordx4 v213, s[20:23], s68 offen lds
    s_add_u32 m0, s70, 4096
    s_mov_b32 s68, 114688
    buffer_load_dwordx4 v213, s[20:23], s68 offen lds
    s_add_u32 m0, s70, 5120
    s_mov_b32 s68, 143360
    buffer_load_dwordx4 v213, s[20:23], s68 offen lds
    s_add_u32 m0, s70, 6144
    s_mov_b32 s68, 172032
    buffer_load_dwordx4 v213, s[20:23], s68 offen lds
    s_add_u32 m0, s70, 7168
    s_mov_b32 s68, 200704
    buffer_load_dwordx4 v213, s[20:23], s68 offen lds
    s_add_u32 m0, s70, 8192
    s_mov_b32 s68, 229376
    buffer_load_dwordx4 v213, s[20:23], s68 offen lds
    s_add_u32 m0, s70, 9216
    s_mov_b32 s68, 258048
    buffer_load_dwordx4 v213, s[20:23], s68 offen lds
    s_add_u32 m0, s70, 10240
    s_mov_b32 s68, 286720
    buffer_load_dwordx4 v213, s[20:23], s68 offen lds
    s_add_u32 m0, s70, 11264
    s_mov_b32 s68, 315392
    buffer_load_dwordx4 v213, s[20:23], s68 offen lds
    s_add_u32 m0, s70, 12288
    s_mov_b32 s68, 344064
    buffer_load_dwordx4 v213, s[20:23], s68 offen lds
    s_add_u32 m0, s70, 13312
    s_mov_b32 s68, 372736
    buffer_load_dwordx4 v213, s[20:23], s68 offen lds
    s_add_u32 m0, s70, 14336
    s_mov_b32 s68, 401408
    buffer_load_dwordx4 v213, s[20:23], s68 offen lds
    s_add_u32 m0, s70, 15360
    s_mov_b32 s68, 430080
    buffer_load_dwordx4 v213, s[20:23], s68 offen lds
    s_add_u32 m0, s70, 16384
    s_mov_b32 s68, 458752
    buffer_load_dwordx4 v213, s[20:23], s68 offen lds
    s_add_u32 m0, s70, 17408
    s_mov_b32 s68, 487424
    buffer_load_dwordx4 v213, s[20:23], s68 offen lds
    s_add_u32 m0, s70, 18432
    s_mov_b32 s68, 516096
    buffer_load_dwordx4 v213, s[20:23], s68 offen lds
    s_add_u32 m0, s70, 19456
    s_mov_b32 s68, 544768
    buffer_load_dwordx4 v213, s[20:23], s68 offen lds
    s_add_u32 m0, s70, 20480
    s_mov_b32 s68, 573440
    buffer_load_dwordx4 v213, s[20:23], s68 offen lds
    s_add_u32 m0, s70, 21504
    s_mov_b32 s68, 602112
    buffer_load_dwordx4 v213, s[20:23], s68 offen lds
    s_add_u32 m0, s70, 22528
    s_mov_b32 s68, 630784
    buffer_load_dwordx4 v213, s[20:23], s68 offen lds
    s_add_u32 m0, s70, 23552
    s_mov_b32 s68, 659456
    buffer_load_dwordx4 v213, s[20:23], s68 offen lds
    s_add_u32 m0, s70, 24576
    s_mov_b32 s68, 688128
    buffer_load_dwordx4 v213, s[20:23], s68 offen lds
    s_add_u32 m0, s70, 25600
    s_mov_b32 s68, 716800
    buffer_load_dwordx4 v213, s[20:23], s68 offen lds
    s_add_u32 m0, s70, 26624
    s_mov_b32 s68, 745472
    buffer_load_dwordx4 v213, s[20:23], s68 offen lds
    s_add_u32 m0, s70, 27648
    s_mov_b32 s68, 774144
    buffer_load_dwordx4 v213, s[20:23], s68 offen lds
    s_add_u32 m0, s70, 28672
    s_mov_b32 s68, 802816
    buffer_load_dwordx4 v213, s[20:23], s68 offen lds
    s_add_u32 m0, s70, 29696
    s_mov_b32 s68, 831488
    buffer_load_dwordx4 v213, s[20:23], s68 offen lds
    s_add_u32 m0, s70, 30720
    s_mov_b32 s68, 860160
    buffer_load_dwordx4 v213, s[20:23], s68 offen lds
    s_add_u32 m0, s70, 31744
    s_mov_b32 s68, 888832
    buffer_load_dwordx4 v213, s[20:23], s68 offen lds
    s_lshl_b32 s68, s64, 1
    s_and_b32 s69, s3, 1
    s_add_u32 s71, s68, s69
    s_xor_b32 s72, s71, 1
    s_mul_i32 s68, s3, 32768
    s_add_u32 s68, s68, 0x200000
    s_mul_i32 s71, s71, 131072
    s_add_u32 s71, s71, s68
    s_mul_i32 s72, s72, 131072
    s_add_u32 s72, s72, s68
    v_lshrrev_b32 v220, 5, v1
    v_lshlrev_b32 v220, 3, v220
    s_lshl_b32 s68, s65, 7
    s_lshr_b32 s69, s3, 1
    s_lshl_b32 s69, s69, 6
    s_add_u32 s68, s68, s69
    buffer_load_dwordx2 v[222:223], v220, s[28:31], s68 offen offset:0
    buffer_load_dwordx2 v[224:225], v220, s[28:31], s68 offen offset:16
    buffer_load_dwordx2 v[226:227], v220, s[28:31], s68 offen offset:32
    buffer_load_dwordx2 v[228:229], v220, s[28:31], s68 offen offset:48
    buffer_load_dwordx4 v[80:83], v4, s[40:43], s71 offen offset:0
    buffer_load_dwordx4 v[84:87], v4, s[40:43], s72 offen offset:0
    buffer_load_dwordx4 v[88:91], v4, s[40:43], s71 offen offset:1024
    buffer_load_dwordx4 v[92:95], v4, s[40:43], s72 offen offset:1024
    buffer_load_dwordx4 v[96:99], v4, s[40:43], s71 offen offset:2048
    buffer_load_dwordx4 v[100:103], v4, s[40:43], s72 offen offset:2048
    buffer_load_dwordx4 v[104:107], v4, s[40:43], s71 offen offset:3072
    buffer_load_dwordx4 v[108:111], v4, s[40:43], s72 offen offset:3072
    s_add_u32 s71, s71, 4096
    s_add_u32 s72, s72, 4096
    buffer_load_dwordx4 v[112:115], v4, s[40:43], s71 offen offset:0
    buffer_load_dwordx4 v[116:119], v4, s[40:43], s72 offen offset:0
    buffer_load_dwordx4 v[120:123], v4, s[40:43], s71 offen offset:1024
    buffer_load_dwordx4 v[124:127], v4, s[40:43], s72 offen offset:1024
    buffer_load_dwordx4 v[128:131], v4, s[40:43], s71 offen offset:2048
    buffer_load_dwordx4 v[132:135], v4, s[40:43], s72 offen offset:2048
    buffer_load_dwordx4 v[136:139], v4, s[40:43], s71 offen offset:3072
    buffer_load_dwordx4 v[140:143], v4, s[40:43], s72 offen offset:3072
    s_add_u32 s71, s71, 4096
    s_add_u32 s72, s72, 4096
    buffer_load_dwordx4 v[144:147], v4, s[40:43], s71 offen offset:0
    buffer_load_dwordx4 v[148:151], v4, s[40:43], s72 offen offset:0
    buffer_load_dwordx4 v[152:155], v4, s[40:43], s71 offen offset:1024
    buffer_load_dwordx4 v[156:159], v4, s[40:43], s72 offen offset:1024
    s_waitcnt vmcnt(24)
    ds_read_b64_tr_b16 a[0:1], v215 offset:0
    ds_read_b64_tr_b16 a[2:3], v215 offset:512
    ds_read_b64_tr_b16 a[4:5], v216 offset:0
    ds_read_b64_tr_b16 a[6:7], v216 offset:512
    ds_read_b64_tr_b16 a[8:9], v215 offset:2048
    ds_read_b64_tr_b16 a[10:11], v215 offset:2560
    ds_read_b64_tr_b16 a[12:13], v216 offset:2048
    ds_read_b64_tr_b16 a[14:15], v216 offset:2560
    ds_read_b64_tr_b16 a[16:17], v215 offset:4096
    ds_read_b64_tr_b16 a[18:19], v215 offset:4608
    ds_read_b64_tr_b16 a[20:21], v216 offset:4096
    ds_read_b64_tr_b16 a[22:23], v216 offset:4608
    ds_read_b64_tr_b16 a[24:25], v215 offset:6144
    ds_read_b64_tr_b16 a[26:27], v215 offset:6656
    ds_read_b64_tr_b16 a[28:29], v216 offset:6144
    ds_read_b64_tr_b16 a[30:31], v216 offset:6656
    ds_read_b64_tr_b16 a[32:33], v215 offset:8192
    ds_read_b64_tr_b16 a[34:35], v215 offset:8704
    ds_read_b64_tr_b16 a[36:37], v216 offset:8192
    ds_read_b64_tr_b16 a[38:39], v216 offset:8704
    ds_read_b64_tr_b16 a[40:41], v215 offset:10240
    ds_read_b64_tr_b16 a[42:43], v215 offset:10752
    ds_read_b64_tr_b16 a[44:45], v216 offset:10240
    ds_read_b64_tr_b16 a[46:47], v216 offset:10752
    ds_read_b64_tr_b16 a[48:49], v215 offset:12288
    ds_read_b64_tr_b16 a[50:51], v215 offset:12800
    ds_read_b64_tr_b16 a[52:53], v216 offset:12288
    ds_read_b64_tr_b16 a[54:55], v216 offset:12800
    ds_read_b64_tr_b16 a[56:57], v215 offset:14336
    ds_read_b64_tr_b16 a[58:59], v215 offset:14848
    ds_read_b64_tr_b16 a[60:61], v216 offset:14336
    ds_read_b64_tr_b16 a[62:63], v216 offset:14848
    ds_read_b64_tr_b16 a[64:65], v215 offset:16384
    ds_read_b64_tr_b16 a[66:67], v215 offset:16896
    ds_read_b64_tr_b16 a[68:69], v216 offset:16384
    ds_read_b64_tr_b16 a[70:71], v216 offset:16896
    ds_read_b64_tr_b16 a[72:73], v215 offset:18432
    ds_read_b64_tr_b16 a[74:75], v215 offset:18944
    ds_read_b64_tr_b16 a[76:77], v216 offset:18432
    ds_read_b64_tr_b16 a[78:79], v216 offset:18944
    ds_read_b64_tr_b16 a[80:81], v215 offset:20480
    ds_read_b64_tr_b16 a[82:83], v215 offset:20992
    ds_read_b64_tr_b16 a[84:85], v216 offset:20480
    ds_read_b64_tr_b16 a[86:87], v216 offset:20992
    ds_read_b64_tr_b16 a[88:89], v215 offset:22528
    ds_read_b64_tr_b16 a[90:91], v215 offset:23040
    ds_read_b64_tr_b16 a[92:93], v216 offset:22528
    ds_read_b64_tr_b16 a[94:95], v216 offset:23040
    ds_read_b64_tr_b16 a[96:97], v215 offset:24576
    ds_read_b64_tr_b16 a[98:99], v215 offset:25088
    ds_read_b64_tr_b16 a[100:101], v216 offset:24576
    ds_read_b64_tr_b16 a[102:103], v216 offset:25088
    ds_read_b64_tr_b16 a[104:105], v215 offset:26624
    ds_read_b64_tr_b16 a[106:107], v215 offset:27136
    ds_read_b64_tr_b16 a[108:109], v216 offset:26624
    ds_read_b64_tr_b16 a[110:111], v216 offset:27136
    ds_read_b64_tr_b16 a[112:113], v215 offset:28672
    ds_read_b64_tr_b16 a[114:115], v215 offset:29184
    ds_read_b64_tr_b16 a[116:117], v216 offset:28672
    ds_read_b64_tr_b16 a[118:119], v216 offset:29184
    ds_read_b64_tr_b16 a[120:121], v215 offset:30720
    ds_read_b64_tr_b16 a[122:123], v215 offset:31232
    ds_read_b64_tr_b16 a[124:125], v216 offset:30720
    ds_read_b64_tr_b16 a[126:127], v216 offset:31232
    s_waitcnt lgkmcnt(0)
    s_add_u32 m0, s70, 0
    s_mov_b32 s68, 917504
    buffer_load_dwordx4 v213, s[20:23], s68 offen lds
    s_add_u32 m0, s70, 1024
    s_mov_b32 s68, 946176
    buffer_load_dwordx4 v213, s[20:23], s68 offen lds
    s_add_u32 m0, s70, 2048
    s_mov_b32 s68, 974848
    buffer_load_dwordx4 v213, s[20:23], s68 offen lds
    s_add_u32 m0, s70, 3072
    s_mov_b32 s68, 1003520
    buffer_load_dwordx4 v213, s[20:23], s68 offen lds
    s_add_u32 m0, s70, 4096
    s_mov_b32 s68, 1032192
    buffer_load_dwordx4 v213, s[20:23], s68 offen lds
    s_add_u32 m0, s70, 5120
    s_mov_b32 s68, 1060864
    buffer_load_dwordx4 v213, s[20:23], s68 offen lds
    s_add_u32 m0, s70, 6144
    s_mov_b32 s68, 1089536
    buffer_load_dwordx4 v213, s[20:23], s68 offen lds
    s_add_u32 m0, s70, 7168
    s_mov_b32 s68, 1118208
    buffer_load_dwordx4 v213, s[20:23], s68 offen lds
    s_add_u32 m0, s70, 8192
    s_mov_b32 s68, 1146880
    buffer_load_dwordx4 v213, s[20:23], s68 offen lds
    s_add_u32 m0, s70, 9216
    s_mov_b32 s68, 1175552
    buffer_load_dwordx4 v213, s[20:23], s68 offen lds
    s_add_u32 m0, s70, 10240
    s_mov_b32 s68, 1204224
    buffer_load_dwordx4 v213, s[20:23], s68 offen lds
    s_add_u32 m0, s70, 11264
    s_mov_b32 s68, 1232896
    buffer_load_dwordx4 v213, s[20:23], s68 offen lds
    s_add_u32 m0, s70, 12288
    s_mov_b32 s68, 1261568
    buffer_load_dwordx4 v213, s[20:23], s68 offen lds
    s_add_u32 m0, s70, 13312
    s_mov_b32 s68, 1290240
    buffer_load_dwordx4 v213, s[20:23], s68 offen lds
    s_add_u32 m0, s70, 14336
    s_mov_b32 s68, 1318912
    buffer_load_dwordx4 v213, s[20:23], s68 offen lds
    s_add_u32 m0, s70, 15360
    s_mov_b32 s68, 1347584
    buffer_load_dwordx4 v213, s[20:23], s68 offen lds
    s_add_u32 m0, s70, 16384
    s_mov_b32 s68, 1376256
    buffer_load_dwordx4 v213, s[20:23], s68 offen lds
    s_add_u32 m0, s70, 17408
    s_mov_b32 s68, 1404928
    buffer_load_dwordx4 v213, s[20:23], s68 offen lds
    s_add_u32 m0, s70, 18432
    s_mov_b32 s68, 1433600
    buffer_load_dwordx4 v213, s[20:23], s68 offen lds
    s_add_u32 m0, s70, 19456
    s_mov_b32 s68, 1462272
    buffer_load_dwordx4 v213, s[20:23], s68 offen lds
    s_add_u32 m0, s70, 20480
    s_mov_b32 s68, 1490944
    buffer_load_dwordx4 v213, s[20:23], s68 offen lds
    s_add_u32 m0, s70, 21504
    s_mov_b32 s68, 1519616
    buffer_load_dwordx4 v213, s[20:23], s68 offen lds
    s_add_u32 m0, s70, 22528
    s_mov_b32 s68, 1548288
    buffer_load_dwordx4 v213, s[20:23], s68 offen lds
    s_add_u32 m0, s70, 23552
    s_mov_b32 s68, 1576960
    buffer_load_dwordx4 v213, s[20:23], s68 offen lds
    s_add_u32 m0, s70, 24576
    s_mov_b32 s68, 1605632
    buffer_load_dwordx4 v213, s[20:23], s68 offen lds
    s_add_u32 m0, s70, 25600
    s_mov_b32 s68, 1634304
    buffer_load_dwordx4 v213, s[20:23], s68 offen lds
    s_add_u32 m0, s70, 26624
    s_mov_b32 s68, 1662976
    buffer_load_dwordx4 v213, s[20:23], s68 offen lds
    s_add_u32 m0, s70, 27648
    s_mov_b32 s68, 1691648
    buffer_load_dwordx4 v213, s[20:23], s68 offen lds
    s_add_u32 m0, s70, 28672
    s_mov_b32 s68, 1720320
    buffer_load_dwordx4 v213, s[20:23], s68 offen lds
    s_add_u32 m0, s70, 29696
    s_mov_b32 s68, 1748992
    buffer_load_dwordx4 v213, s[20:23], s68 offen lds
    s_add_u32 m0, s70, 30720
    s_mov_b32 s68, 1777664
    buffer_load_dwordx4 v213, s[20:23], s68 offen lds
    s_add_u32 m0, s70, 31744
    s_mov_b32 s68, 1806336
    buffer_load_dwordx4 v213, s[20:23], s68 offen lds
    s_waitcnt vmcnt(55)
    v_lshlrev_b32 v16, 16, v222
    v_and_b32 v17, 0xffff0000, v222
    v_lshlrev_b32 v18, 16, v223
    v_and_b32 v19, 0xffff0000, v223
    s_waitcnt vmcnt(54)
    v_lshlrev_b32 v20, 16, v224
    v_and_b32 v21, 0xffff0000, v224
    v_lshlrev_b32 v22, 16, v225
    v_and_b32 v23, 0xffff0000, v225
    s_waitcnt vmcnt(53)
    v_lshlrev_b32 v24, 16, v226
    v_and_b32 v25, 0xffff0000, v226
    v_lshlrev_b32 v26, 16, v227
    v_and_b32 v27, 0xffff0000, v227
    s_waitcnt vmcnt(52)
    v_lshlrev_b32 v28, 16, v228
    v_and_b32 v29, 0xffff0000, v228
    v_lshlrev_b32 v30, 16, v229
    v_and_b32 v31, 0xffff0000, v229
    s_waitcnt vmcnt(51)
    s_nop 0
    v_mfma_f32_32x32x16_bf16 v[16:31], a[0:3], v[80:83], v[16:31]
    s_waitcnt vmcnt(50)
    v_mfma_f32_32x32x16_bf16 v[32:47], a[0:3], v[84:87], 0
    v_mfma_f32_32x32x16_bf16 v[48:63], a[4:7], v[80:83], 0
    v_mfma_f32_32x32x16_bf16 v[64:79], a[4:7], v[84:87], 0
    buffer_load_dwordx4 v[160:163], v4, s[40:43], s71 offen offset:2048
    buffer_load_dwordx4 v[164:167], v4, s[40:43], s72 offen offset:2048
    buffer_load_dwordx4 v[168:171], v4, s[40:43], s71 offen offset:3072
    buffer_load_dwordx4 v[172:175], v4, s[40:43], s72 offen offset:3072
    s_add_u32 s71, s71, 4096
    s_add_u32 s72, s72, 4096
    buffer_load_dwordx4 v[176:179], v4, s[40:43], s71 offen offset:0
    buffer_load_dwordx4 v[180:183], v4, s[40:43], s72 offen offset:0
    buffer_load_dwordx4 v[184:187], v4, s[40:43], s71 offen offset:1024
    buffer_load_dwordx4 v[188:191], v4, s[40:43], s72 offen offset:1024
    buffer_load_dwordx4 v[192:195], v4, s[40:43], s71 offen offset:2048
    buffer_load_dwordx4 v[196:199], v4, s[40:43], s72 offen offset:2048
    buffer_load_dwordx4 v[200:203], v4, s[40:43], s71 offen offset:3072
    buffer_load_dwordx4 v[204:207], v4, s[40:43], s72 offen offset:3072
    s_waitcnt vmcnt(61)
    v_mfma_f32_32x32x16_bf16 v[16:31], a[8:11], v[88:91], v[16:31]
    s_waitcnt vmcnt(60)
    v_mfma_f32_32x32x16_bf16 v[32:47], a[8:11], v[92:95], v[32:47]
    v_mfma_f32_32x32x16_bf16 v[48:63], a[12:15], v[88:91], v[48:63]
    v_mfma_f32_32x32x16_bf16 v[64:79], a[12:15], v[92:95], v[64:79]
    s_add_u32 s71, s71, 4096
    s_add_u32 s72, s72, 4096
    buffer_load_dwordx4 v[80:83], v4, s[40:43], s71 offen offset:0
    buffer_load_dwordx4 v[84:87], v4, s[40:43], s72 offen offset:0
    s_waitcnt vmcnt(61)
    v_mfma_f32_32x32x16_bf16 v[16:31], a[16:19], v[96:99], v[16:31]
    s_waitcnt vmcnt(60)
    v_mfma_f32_32x32x16_bf16 v[32:47], a[16:19], v[100:103], v[32:47]
    v_mfma_f32_32x32x16_bf16 v[48:63], a[20:23], v[96:99], v[48:63]
    v_mfma_f32_32x32x16_bf16 v[64:79], a[20:23], v[100:103], v[64:79]
    buffer_load_dwordx4 v[88:91], v4, s[40:43], s71 offen offset:1024
    buffer_load_dwordx4 v[92:95], v4, s[40:43], s72 offen offset:1024
    s_waitcnt vmcnt(61)
    v_mfma_f32_32x32x16_bf16 v[16:31], a[24:27], v[104:107], v[16:31]
    s_waitcnt vmcnt(60)
    v_mfma_f32_32x32x16_bf16 v[32:47], a[24:27], v[108:111], v[32:47]
    v_mfma_f32_32x32x16_bf16 v[48:63], a[28:31], v[104:107], v[48:63]
    v_mfma_f32_32x32x16_bf16 v[64:79], a[28:31], v[108:111], v[64:79]
    buffer_load_dwordx4 v[96:99], v4, s[40:43], s71 offen offset:2048
    buffer_load_dwordx4 v[100:103], v4, s[40:43], s72 offen offset:2048
    s_waitcnt vmcnt(61)
    v_mfma_f32_32x32x16_bf16 v[16:31], a[32:35], v[112:115], v[16:31]
    s_waitcnt vmcnt(60)
    v_mfma_f32_32x32x16_bf16 v[32:47], a[32:35], v[116:119], v[32:47]
    v_mfma_f32_32x32x16_bf16 v[48:63], a[36:39], v[112:115], v[48:63]
    v_mfma_f32_32x32x16_bf16 v[64:79], a[36:39], v[116:119], v[64:79]
    buffer_load_dwordx4 v[104:107], v4, s[40:43], s71 offen offset:3072
    buffer_load_dwordx4 v[108:111], v4, s[40:43], s72 offen offset:3072
    s_waitcnt vmcnt(61)
    v_mfma_f32_32x32x16_bf16 v[16:31], a[40:43], v[120:123], v[16:31]
    s_waitcnt vmcnt(60)
    v_mfma_f32_32x32x16_bf16 v[32:47], a[40:43], v[124:127], v[32:47]
    v_mfma_f32_32x32x16_bf16 v[48:63], a[44:47], v[120:123], v[48:63]
    v_mfma_f32_32x32x16_bf16 v[64:79], a[44:47], v[124:127], v[64:79]
    s_add_u32 s71, s71, 4096
    s_add_u32 s72, s72, 4096
    buffer_load_dwordx4 v[112:115], v4, s[40:43], s71 offen offset:0
    buffer_load_dwordx4 v[116:119], v4, s[40:43], s72 offen offset:0
    s_waitcnt vmcnt(61)
    v_mfma_f32_32x32x16_bf16 v[16:31], a[48:51], v[128:131], v[16:31]
    s_waitcnt vmcnt(60)
    v_mfma_f32_32x32x16_bf16 v[32:47], a[48:51], v[132:135], v[32:47]
    v_mfma_f32_32x32x16_bf16 v[48:63], a[52:55], v[128:131], v[48:63]
    v_mfma_f32_32x32x16_bf16 v[64:79], a[52:55], v[132:135], v[64:79]
    buffer_load_dwordx4 v[120:123], v4, s[40:43], s71 offen offset:1024
    buffer_load_dwordx4 v[124:127], v4, s[40:43], s72 offen offset:1024
    s_waitcnt vmcnt(61)
    v_mfma_f32_32x32x16_bf16 v[16:31], a[56:59], v[136:139], v[16:31]
    s_waitcnt vmcnt(60)
    v_mfma_f32_32x32x16_bf16 v[32:47], a[56:59], v[140:143], v[32:47]
    v_mfma_f32_32x32x16_bf16 v[48:63], a[60:63], v[136:139], v[48:63]
    v_mfma_f32_32x32x16_bf16 v[64:79], a[60:63], v[140:143], v[64:79]
    buffer_load_dwordx4 v[128:131], v4, s[40:43], s71 offen offset:2048
    buffer_load_dwordx4 v[132:135], v4, s[40:43], s72 offen offset:2048
    s_waitcnt vmcnt(61)
    v_mfma_f32_32x32x16_bf16 v[16:31], a[64:67], v[144:147], v[16:31]
    s_waitcnt vmcnt(60)
    v_mfma_f32_32x32x16_bf16 v[32:47], a[64:67], v[148:151], v[32:47]
    v_mfma_f32_32x32x16_bf16 v[48:63], a[68:71], v[144:147], v[48:63]
    v_mfma_f32_32x32x16_bf16 v[64:79], a[68:71], v[148:151], v[64:79]
    buffer_load_dwordx4 v[136:139], v4, s[40:43], s71 offen offset:3072
    buffer_load_dwordx4 v[140:143], v4, s[40:43], s72 offen offset:3072
    s_waitcnt vmcnt(61)
    v_mfma_f32_32x32x16_bf16 v[16:31], a[72:75], v[152:155], v[16:31]
    s_waitcnt vmcnt(60)
    v_mfma_f32_32x32x16_bf16 v[32:47], a[72:75], v[156:159], v[32:47]
    v_mfma_f32_32x32x16_bf16 v[48:63], a[76:79], v[152:155], v[48:63]
    v_mfma_f32_32x32x16_bf16 v[64:79], a[76:79], v[156:159], v[64:79]
    s_add_u32 s71, s71, 4096
    s_add_u32 s72, s72, 4096
    buffer_load_dwordx4 v[144:147], v4, s[40:43], s71 offen offset:0
    buffer_load_dwordx4 v[148:151], v4, s[40:43], s72 offen offset:0
    s_waitcnt vmcnt(29)
    v_mfma_f32_32x32x16_bf16 v[16:31], a[80:83], v[160:163], v[16:31]
    s_waitcnt vmcnt(28)
    v_mfma_f32_32x32x16_bf16 v[32:47], a[80:83], v[164:167], v[32:47]
    v_mfma_f32_32x32x16_bf16 v[48:63], a[84:87], v[160:163], v[48:63]
    v_mfma_f32_32x32x16_bf16 v[64:79], a[84:87], v[164:167], v[64:79]
    buffer_load_dwordx4 v[152:155], v4, s[40:43], s71 offen offset:1024
    buffer_load_dwordx4 v[156:159], v4, s[40:43], s72 offen offset:1024
    s_waitcnt vmcnt(29)
    v_mfma_f32_32x32x16_bf16 v[16:31], a[88:91], v[168:171], v[16:31]
    s_waitcnt vmcnt(28)
    v_mfma_f32_32x32x16_bf16 v[32:47], a[88:91], v[172:175], v[32:47]
    v_mfma_f32_32x32x16_bf16 v[48:63], a[92:95], v[168:171], v[48:63]
    v_mfma_f32_32x32x16_bf16 v[64:79], a[92:95], v[172:175], v[64:79]
    buffer_load_dwordx4 v[160:163], v4, s[40:43], s71 offen offset:2048
    buffer_load_dwordx4 v[164:167], v4, s[40:43], s72 offen offset:2048
    s_waitcnt vmcnt(29)
    v_mfma_f32_32x32x16_bf16 v[16:31], a[96:99], v[176:179], v[16:31]
    s_waitcnt vmcnt(28)
    v_mfma_f32_32x32x16_bf16 v[32:47], a[96:99], v[180:183], v[32:47]
    v_mfma_f32_32x32x16_bf16 v[48:63], a[100:103], v[176:179], v[48:63]
    v_mfma_f32_32x32x16_bf16 v[64:79], a[100:103], v[180:183], v[64:79]
    buffer_load_dwordx4 v[168:171], v4, s[40:43], s71 offen offset:3072
    buffer_load_dwordx4 v[172:175], v4, s[40:43], s72 offen offset:3072
    s_waitcnt vmcnt(29)
    v_mfma_f32_32x32x16_bf16 v[16:31], a[104:107], v[184:187], v[16:31]
    s_waitcnt vmcnt(28)
    v_mfma_f32_32x32x16_bf16 v[32:47], a[104:107], v[188:191], v[32:47]
    v_mfma_f32_32x32x16_bf16 v[48:63], a[108:111], v[184:187], v[48:63]
    v_mfma_f32_32x32x16_bf16 v[64:79], a[108:111], v[188:191], v[64:79]
    s_add_u32 s71, s71, 4096
    s_add_u32 s72, s72, 4096
    buffer_load_dwordx4 v[176:179], v4, s[40:43], s71 offen offset:0
    buffer_load_dwordx4 v[180:183], v4, s[40:43], s72 offen offset:0
    s_waitcnt vmcnt(29)
    v_mfma_f32_32x32x16_bf16 v[16:31], a[112:115], v[192:195], v[16:31]
    s_waitcnt vmcnt(28)
    v_mfma_f32_32x32x16_bf16 v[32:47], a[112:115], v[196:199], v[32:47]
    v_mfma_f32_32x32x16_bf16 v[48:63], a[116:119], v[192:195], v[48:63]
    v_mfma_f32_32x32x16_bf16 v[64:79], a[116:119], v[196:199], v[64:79]
    buffer_load_dwordx4 v[184:187], v4, s[40:43], s71 offen offset:1024
    buffer_load_dwordx4 v[188:191], v4, s[40:43], s72 offen offset:1024
    s_waitcnt vmcnt(29)
    v_mfma_f32_32x32x16_bf16 v[16:31], a[120:123], v[200:203], v[16:31]
    s_waitcnt vmcnt(28)
    v_mfma_f32_32x32x16_bf16 v[32:47], a[120:123], v[204:207], v[32:47]
    v_mfma_f32_32x32x16_bf16 v[48:63], a[124:127], v[200:203], v[48:63]
    v_mfma_f32_32x32x16_bf16 v[64:79], a[124:127], v[204:207], v[64:79]
    buffer_load_dwordx4 v[192:195], v4, s[40:43], s71 offen offset:2048
    buffer_load_dwordx4 v[196:199], v4, s[40:43], s72 offen offset:2048
    ds_read_b64_tr_b16 a[128:129], v215 offset:0
    ds_read_b64_tr_b16 a[130:131], v215 offset:512
    ds_read_b64_tr_b16 a[132:133], v216 offset:0
    ds_read_b64_tr_b16 a[134:135], v216 offset:512
    ds_read_b64_tr_b16 a[136:137], v215 offset:2048
    ds_read_b64_tr_b16 a[138:139], v215 offset:2560
    ds_read_b64_tr_b16 a[140:141], v216 offset:2048
    ds_read_b64_tr_b16 a[142:143], v216 offset:2560
    ds_read_b64_tr_b16 a[144:145], v215 offset:4096
    ds_read_b64_tr_b16 a[146:147], v215 offset:4608
    ds_read_b64_tr_b16 a[148:149], v216 offset:4096
    ds_read_b64_tr_b16 a[150:151], v216 offset:4608
    ds_read_b64_tr_b16 a[152:153], v215 offset:6144
    ds_read_b64_tr_b16 a[154:155], v215 offset:6656
    ds_read_b64_tr_b16 a[156:157], v216 offset:6144
    ds_read_b64_tr_b16 a[158:159], v216 offset:6656
    ds_read_b64_tr_b16 a[160:161], v215 offset:8192
    ds_read_b64_tr_b16 a[162:163], v215 offset:8704
    ds_read_b64_tr_b16 a[164:165], v216 offset:8192
    ds_read_b64_tr_b16 a[166:167], v216 offset:8704
    ds_read_b64_tr_b16 a[168:169], v215 offset:10240
    ds_read_b64_tr_b16 a[170:171], v215 offset:10752
    ds_read_b64_tr_b16 a[172:173], v216 offset:10240
    ds_read_b64_tr_b16 a[174:175], v216 offset:10752
    ds_read_b64_tr_b16 a[176:177], v215 offset:12288
    ds_read_b64_tr_b16 a[178:179], v215 offset:12800
    ds_read_b64_tr_b16 a[180:181], v216 offset:12288
    ds_read_b64_tr_b16 a[182:183], v216 offset:12800
    ds_read_b64_tr_b16 a[184:185], v215 offset:14336
    ds_read_b64_tr_b16 a[186:187], v215 offset:14848
    ds_read_b64_tr_b16 a[188:189], v216 offset:14336
    ds_read_b64_tr_b16 a[190:191], v216 offset:14848
    ds_read_b64_tr_b16 a[192:193], v215 offset:16384
    ds_read_b64_tr_b16 a[194:195], v215 offset:16896
    ds_read_b64_tr_b16 a[196:197], v216 offset:16384
    ds_read_b64_tr_b16 a[198:199], v216 offset:16896
    ds_read_b64_tr_b16 a[200:201], v215 offset:18432
    ds_read_b64_tr_b16 a[202:203], v215 offset:18944
    ds_read_b64_tr_b16 a[204:205], v216 offset:18432
    ds_read_b64_tr_b16 a[206:207], v216 offset:18944
    ds_read_b64_tr_b16 a[208:209], v215 offset:20480
    ds_read_b64_tr_b16 a[210:211], v215 offset:20992
    ds_read_b64_tr_b16 a[212:213], v216 offset:20480
    ds_read_b64_tr_b16 a[214:215], v216 offset:20992
    ds_read_b64_tr_b16 a[216:217], v215 offset:22528
    ds_read_b64_tr_b16 a[218:219], v215 offset:23040
    ds_read_b64_tr_b16 a[220:221], v216 offset:22528
    ds_read_b64_tr_b16 a[222:223], v216 offset:23040
    ds_read_b64_tr_b16 a[224:225], v215 offset:24576
    ds_read_b64_tr_b16 a[226:227], v215 offset:25088
    ds_read_b64_tr_b16 a[228:229], v216 offset:24576
    ds_read_b64_tr_b16 a[230:231], v216 offset:25088
    ds_read_b64_tr_b16 a[232:233], v215 offset:26624
    ds_read_b64_tr_b16 a[234:235], v215 offset:27136
    ds_read_b64_tr_b16 a[236:237], v216 offset:26624
    ds_read_b64_tr_b16 a[238:239], v216 offset:27136
    ds_read_b64_tr_b16 a[240:241], v215 offset:28672
    ds_read_b64_tr_b16 a[242:243], v215 offset:29184
    ds_read_b64_tr_b16 a[244:245], v216 offset:28672
    ds_read_b64_tr_b16 a[246:247], v216 offset:29184
    ds_read_b64_tr_b16 a[248:249], v215 offset:30720
    ds_read_b64_tr_b16 a[250:251], v215 offset:31232
    ds_read_b64_tr_b16 a[252:253], v216 offset:30720
    ds_read_b64_tr_b16 a[254:255], v216 offset:31232
    s_waitcnt vmcnt(29) lgkmcnt(15)
    v_mfma_f32_32x32x16_bf16 v[16:31], a[128:131], v[80:83], v[16:31]
    s_waitcnt vmcnt(28)
    v_mfma_f32_32x32x16_bf16 v[32:47], a[128:131], v[84:87], v[32:47]
    v_mfma_f32_32x32x16_bf16 v[48:63], a[132:135], v[80:83], v[48:63]
    v_mfma_f32_32x32x16_bf16 v[64:79], a[132:135], v[84:87], v[64:79]
    buffer_load_dwordx4 v[200:203], v4, s[40:43], s71 offen offset:3072
    buffer_load_dwordx4 v[204:207], v4, s[40:43], s72 offen offset:3072
    s_waitcnt vmcnt(29)
    v_mfma_f32_32x32x16_bf16 v[16:31], a[136:139], v[88:91], v[16:31]
    s_waitcnt vmcnt(28)
    v_mfma_f32_32x32x16_bf16 v[32:47], a[136:139], v[92:95], v[32:47]
    v_mfma_f32_32x32x16_bf16 v[48:63], a[140:143], v[88:91], v[48:63]
    v_mfma_f32_32x32x16_bf16 v[64:79], a[140:143], v[92:95], v[64:79]
    s_waitcnt vmcnt(27)
    v_mfma_f32_32x32x16_bf16 v[16:31], a[144:147], v[96:99], v[16:31]
    s_waitcnt vmcnt(26)
    v_mfma_f32_32x32x16_bf16 v[32:47], a[144:147], v[100:103], v[32:47]
    v_mfma_f32_32x32x16_bf16 v[48:63], a[148:151], v[96:99], v[48:63]
    v_mfma_f32_32x32x16_bf16 v[64:79], a[148:151], v[100:103], v[64:79]
    s_waitcnt vmcnt(25)
    v_mfma_f32_32x32x16_bf16 v[16:31], a[152:155], v[104:107], v[16:31]
    s_waitcnt vmcnt(24)
    v_mfma_f32_32x32x16_bf16 v[32:47], a[152:155], v[108:111], v[32:47]
    v_mfma_f32_32x32x16_bf16 v[48:63], a[156:159], v[104:107], v[48:63]
    v_mfma_f32_32x32x16_bf16 v[64:79], a[156:159], v[108:111], v[64:79]
    s_waitcnt vmcnt(23)
    v_mfma_f32_32x32x16_bf16 v[16:31], a[160:163], v[112:115], v[16:31]
    s_waitcnt vmcnt(22)
    v_mfma_f32_32x32x16_bf16 v[32:47], a[160:163], v[116:119], v[32:47]
    v_mfma_f32_32x32x16_bf16 v[48:63], a[164:167], v[112:115], v[48:63]
    v_mfma_f32_32x32x16_bf16 v[64:79], a[164:167], v[116:119], v[64:79]
    s_waitcnt vmcnt(21)
    v_mfma_f32_32x32x16_bf16 v[16:31], a[168:171], v[120:123], v[16:31]
    s_waitcnt vmcnt(20)
    v_mfma_f32_32x32x16_bf16 v[32:47], a[168:171], v[124:127], v[32:47]
    v_mfma_f32_32x32x16_bf16 v[48:63], a[172:175], v[120:123], v[48:63]
    v_mfma_f32_32x32x16_bf16 v[64:79], a[172:175], v[124:127], v[64:79]
    s_waitcnt vmcnt(19)
    v_mfma_f32_32x32x16_bf16 v[16:31], a[176:179], v[128:131], v[16:31]
    s_waitcnt vmcnt(18)
    v_mfma_f32_32x32x16_bf16 v[32:47], a[176:179], v[132:135], v[32:47]
    v_mfma_f32_32x32x16_bf16 v[48:63], a[180:183], v[128:131], v[48:63]
    v_mfma_f32_32x32x16_bf16 v[64:79], a[180:183], v[132:135], v[64:79]
    s_waitcnt vmcnt(17)
    v_mfma_f32_32x32x16_bf16 v[16:31], a[184:187], v[136:139], v[16:31]
    s_waitcnt vmcnt(16)
    v_mfma_f32_32x32x16_bf16 v[32:47], a[184:187], v[140:143], v[32:47]
    v_mfma_f32_32x32x16_bf16 v[48:63], a[188:191], v[136:139], v[48:63]
    v_mfma_f32_32x32x16_bf16 v[64:79], a[188:191], v[140:143], v[64:79]
    s_waitcnt vmcnt(15)
    v_mfma_f32_32x32x16_bf16 v[16:31], a[192:195], v[144:147], v[16:31]
    s_waitcnt vmcnt(14)
    v_mfma_f32_32x32x16_bf16 v[32:47], a[192:195], v[148:151], v[32:47]
    v_mfma_f32_32x32x16_bf16 v[48:63], a[196:199], v[144:147], v[48:63]
    v_mfma_f32_32x32x16_bf16 v[64:79], a[196:199], v[148:151], v[64:79]
    s_waitcnt vmcnt(13)
    v_mfma_f32_32x32x16_bf16 v[16:31], a[200:203], v[152:155], v[16:31]
    s_waitcnt vmcnt(12)
    v_mfma_f32_32x32x16_bf16 v[32:47], a[200:203], v[156:159], v[32:47]
    v_mfma_f32_32x32x16_bf16 v[48:63], a[204:207], v[152:155], v[48:63]
    v_mfma_f32_32x32x16_bf16 v[64:79], a[204:207], v[156:159], v[64:79]
    s_waitcnt vmcnt(11)
    v_mfma_f32_32x32x16_bf16 v[16:31], a[208:211], v[160:163], v[16:31]
    s_waitcnt vmcnt(10)
    v_mfma_f32_32x32x16_bf16 v[32:47], a[208:211], v[164:167], v[32:47]
    v_mfma_f32_32x32x16_bf16 v[48:63], a[212:215], v[160:163], v[48:63]
    v_mfma_f32_32x32x16_bf16 v[64:79], a[212:215], v[164:167], v[64:79]
    s_waitcnt vmcnt(9)
    v_mfma_f32_32x32x16_bf16 v[16:31], a[216:219], v[168:171], v[16:31]
    s_waitcnt vmcnt(8)
    v_mfma_f32_32x32x16_bf16 v[32:47], a[216:219], v[172:175], v[32:47]
    v_mfma_f32_32x32x16_bf16 v[48:63], a[220:223], v[168:171], v[48:63]
    v_mfma_f32_32x32x16_bf16 v[64:79], a[220:223], v[172:175], v[64:79]
    s_waitcnt vmcnt(7) lgkmcnt(14)
    v_mfma_f32_32x32x16_bf16 v[16:31], a[224:227], v[176:179], v[16:31]
    s_waitcnt vmcnt(6)
    v_mfma_f32_32x32x16_bf16 v[32:47], a[224:227], v[180:183], v[32:47]
    s_waitcnt lgkmcnt(12)
    v_mfma_f32_32x32x16_bf16 v[48:63], a[228:231], v[176:179], v[48:63]
    v_mfma_f32_32x32x16_bf16 v[64:79], a[228:231], v[180:183], v[64:79]
    s_waitcnt vmcnt(5) lgkmcnt(10)
    v_mfma_f32_32x32x16_bf16 v[16:31], a[232:235], v[184:187], v[16:31]
    s_waitcnt vmcnt(4)
    v_mfma_f32_32x32x16_bf16 v[32:47], a[232:235], v[188:191], v[32:47]
    s_waitcnt lgkmcnt(8)
    v_mfma_f32_32x32x16_bf16 v[48:63], a[236:239], v[184:187], v[48:63]
    v_mfma_f32_32x32x16_bf16 v[64:79], a[236:239], v[188:191], v[64:79]
    s_waitcnt vmcnt(3) lgkmcnt(6)
    v_mfma_f32_32x32x16_bf16 v[16:31], a[240:243], v[192:195], v[16:31]
    s_waitcnt vmcnt(2)
    v_mfma_f32_32x32x16_bf16 v[32:47], a[240:243], v[196:199], v[32:47]
    s_waitcnt lgkmcnt(4)
    v_mfma_f32_32x32x16_bf16 v[48:63], a[244:247], v[192:195], v[48:63]
    v_mfma_f32_32x32x16_bf16 v[64:79], a[244:247], v[196:199], v[64:79]
    s_waitcnt vmcnt(1) lgkmcnt(2)
    v_mfma_f32_32x32x16_bf16 v[16:31], a[248:251], v[200:203], v[16:31]
    s_waitcnt vmcnt(0)
    v_mfma_f32_32x32x16_bf16 v[32:47], a[248:251], v[204:207], v[32:47]
    s_waitcnt lgkmcnt(0)
    v_mfma_f32_32x32x16_bf16 v[48:63], a[252:255], v[200:203], v[48:63]
    v_mfma_f32_32x32x16_bf16 v[64:79], a[252:255], v[204:207], v[64:79]
    s_barrier
    s_xor_b32 s68, s3, 1
    s_mul_i32 s68, s68, 12288
    s_add_u32 s68, s68, 0
    v_add_u32 v221, s68, v4
    s_xor_b32 s68, s3, 2
    s_mul_i32 s68, s68, 12288
    s_add_u32 s68, s68, 4096
    v_add_u32 v222, s68, v4
    s_xor_b32 s68, s3, 3
    s_mul_i32 s68, s68, 12288
    s_add_u32 s68, s68, 8192
    v_add_u32 v223, s68, v4
    ds_write_b128 v221, v[32:35] offset:0
    ds_write_b128 v221, v[36:39] offset:1024
    ds_write_b128 v221, v[40:43] offset:2048
    ds_write_b128 v221, v[44:47] offset:3072
    ds_write_b128 v222, v[48:51] offset:0
    ds_write_b128 v222, v[52:55] offset:1024
    ds_write_b128 v222, v[56:59] offset:2048
    ds_write_b128 v222, v[60:63] offset:3072
    ds_write_b128 v223, v[64:67] offset:0
    ds_write_b128 v223, v[68:71] offset:1024
    ds_write_b128 v223, v[72:75] offset:2048
    ds_write_b128 v223, v[76:79] offset:3072
    s_mul_i32 s68, s3, 12288
    s_add_u32 s68, s68, 0
    v_add_u32 v220, s68, v4
    s_lshl_b32 s68, s64, 1
    s_and_b32 s69, s3, 1
    s_add_u32 s68, s68, s69
    s_mul_i32 s68, s68, 112
    s_lshl_b32 s69, s65, 2
    s_add_u32 s68, s68, s69
    s_and_b32 s69, s3, 2
    s_add_u32 s68, s68, s69
    s_lshl_b32 s68, s68, 10
    s_add_u32 s68, s68, 0x600000
    s_waitcnt lgkmcnt(0)
    s_barrier
    ds_read_b128 v[32:35], v220 offset:0
    ds_read_b128 v[48:51], v220 offset:4096
    ds_read_b128 v[64:67], v220 offset:8192
    ds_read_b128 v[36:39], v220 offset:1024
    ds_read_b128 v[52:55], v220 offset:5120
    ds_read_b128 v[68:71], v220 offset:9216
    ds_read_b128 v[40:43], v220 offset:2048
    ds_read_b128 v[56:59], v220 offset:6144
    ds_read_b128 v[72:75], v220 offset:10240
    ds_read_b128 v[44:47], v220 offset:3072
    ds_read_b128 v[60:63], v220 offset:7168
    ds_read_b128 v[76:79], v220 offset:11264
    s_mov_b32 s74, 0xc0135761
    s_mov_b32 s76, 0xbdd2d3e8
    v_mov_b32 v224, s74
    v_mov_b32 v225, s74
    s_waitcnt lgkmcnt(10)
    v_pk_add_f32 v[32:33], v[32:33], v[48:49]
    s_waitcnt lgkmcnt(9)
    v_pk_add_f32 v[16:17], v[16:17], v[64:65]
    v_pk_add_f32 v[34:35], v[34:35], v[50:51]
    v_pk_add_f32 v[18:19], v[18:19], v[66:67]
    s_waitcnt lgkmcnt(7)
    v_pk_add_f32 v[36:37], v[36:37], v[52:53]
    s_waitcnt lgkmcnt(6)
    v_pk_add_f32 v[20:21], v[20:21], v[68:69]
    v_pk_add_f32 v[38:39], v[38:39], v[54:55]
    v_pk_add_f32 v[22:23], v[22:23], v[70:71]
    v_pk_add_f32 v[16:17], v[16:17], v[32:33]
    v_pk_add_f32 v[18:19], v[18:19], v[34:35]
    v_pk_add_f32 v[20:21], v[20:21], v[36:37]
    v_pk_add_f32 v[22:23], v[22:23], v[38:39]
    v_pk_mul_f32 v[80:81], v[16:17], v[16:17]
    v_pk_mul_f32 v[82:83], v[18:19], v[18:19]
    v_pk_mul_f32 v[84:85], v[20:21], v[20:21]
    v_pk_mul_f32 v[86:87], v[22:23], v[22:23]
    v_pk_fma_f32 v[80:81], v[80:81], s[76:77], v[224:225] op_sel_hi:[1,0,1]
    v_pk_fma_f32 v[82:83], v[82:83], s[76:77], v[224:225] op_sel_hi:[1,0,1]
    v_pk_fma_f32 v[84:85], v[84:85], s[76:77], v[224:225] op_sel_hi:[1,0,1]
    v_pk_fma_f32 v[86:87], v[86:87], s[76:77], v[224:225] op_sel_hi:[1,0,1]
    v_pk_mul_f32 v[80:81], v[80:81], v[16:17]
    v_pk_mul_f32 v[82:83], v[82:83], v[18:19]
    v_pk_mul_f32 v[84:85], v[84:85], v[20:21]
    v_pk_mul_f32 v[86:87], v[86:87], v[22:23]
    v_exp_f32 v80, v80
    v_exp_f32 v81, v81
    v_exp_f32 v82, v82
    v_exp_f32 v83, v83
    v_exp_f32 v84, v84
    v_exp_f32 v85, v85
    v_exp_f32 v86, v86
    v_exp_f32 v87, v87
    v_pk_add_f32 v[80:81], v[80:81], 1.0 op_sel_hi:[1,0]
    v_pk_add_f32 v[82:83], v[82:83], 1.0 op_sel_hi:[1,0]
    v_pk_add_f32 v[84:85], v[84:85], 1.0 op_sel_hi:[1,0]
    v_pk_add_f32 v[86:87], v[86:87], 1.0 op_sel_hi:[1,0]
    v_rcp_f32 v80, v80
    v_rcp_f32 v81, v81
    v_rcp_f32 v82, v82
    v_rcp_f32 v83, v83
    v_rcp_f32 v84, v84
    v_rcp_f32 v85, v85
    v_rcp_f32 v86, v86
    v_rcp_f32 v87, v87
    v_pk_mul_f32 v[80:81], v[80:81], v[16:17]
    v_pk_mul_f32 v[82:83], v[82:83], v[18:19]
    v_pk_mul_f32 v[84:85], v[84:85], v[20:21]
    v_pk_mul_f32 v[86:87], v[86:87], v[22:23]
    v_cvt_pk_bf16_f32 v96, v80, v81
    v_cvt_pk_bf16_f32 v97, v82, v83
    v_cvt_pk_bf16_f32 v98, v84, v85
    v_cvt_pk_bf16_f32 v99, v86, v87
    buffer_store_dwordx4 v[96:99], v4, s[40:43], s68 offen offset:0
    s_waitcnt lgkmcnt(4)
    v_pk_add_f32 v[40:41], v[40:41], v[56:57]
    s_waitcnt lgkmcnt(3)
    v_pk_add_f32 v[24:25], v[24:25], v[72:73]
    v_pk_add_f32 v[42:43], v[42:43], v[58:59]
    v_pk_add_f32 v[26:27], v[26:27], v[74:75]
    s_waitcnt lgkmcnt(1)
    v_pk_add_f32 v[44:45], v[44:45], v[60:61]
    s_waitcnt lgkmcnt(0)
    v_pk_add_f32 v[28:29], v[28:29], v[76:77]
    v_pk_add_f32 v[46:47], v[46:47], v[62:63]
    v_pk_add_f32 v[30:31], v[30:31], v[78:79]
    v_pk_add_f32 v[24:25], v[24:25], v[40:41]
    v_pk_add_f32 v[26:27], v[26:27], v[42:43]
    v_pk_add_f32 v[28:29], v[28:29], v[44:45]
    v_pk_add_f32 v[30:31], v[30:31], v[46:47]
    v_pk_mul_f32 v[88:89], v[24:25], v[24:25]
    v_pk_mul_f32 v[90:91], v[26:27], v[26:27]
    v_pk_mul_f32 v[92:93], v[28:29], v[28:29]
    v_pk_mul_f32 v[94:95], v[30:31], v[30:31]
    v_pk_fma_f32 v[88:89], v[88:89], s[76:77], v[224:225] op_sel_hi:[1,0,1]
    v_pk_fma_f32 v[90:91], v[90:91], s[76:77], v[224:225] op_sel_hi:[1,0,1]
    v_pk_fma_f32 v[92:93], v[92:93], s[76:77], v[224:225] op_sel_hi:[1,0,1]
    v_pk_fma_f32 v[94:95], v[94:95], s[76:77], v[224:225] op_sel_hi:[1,0,1]
    v_pk_mul_f32 v[88:89], v[88:89], v[24:25]
    v_pk_mul_f32 v[90:91], v[90:91], v[26:27]
    v_pk_mul_f32 v[92:93], v[92:93], v[28:29]
    v_pk_mul_f32 v[94:95], v[94:95], v[30:31]
    v_exp_f32 v88, v88
    v_exp_f32 v89, v89
    v_exp_f32 v90, v90
    v_exp_f32 v91, v91
    v_exp_f32 v92, v92
    v_exp_f32 v93, v93
    v_exp_f32 v94, v94
    v_exp_f32 v95, v95
    v_pk_add_f32 v[88:89], v[88:89], 1.0 op_sel_hi:[1,0]
    v_pk_add_f32 v[90:91], v[90:91], 1.0 op_sel_hi:[1,0]
    v_pk_add_f32 v[92:93], v[92:93], 1.0 op_sel_hi:[1,0]
    v_pk_add_f32 v[94:95], v[94:95], 1.0 op_sel_hi:[1,0]
    v_rcp_f32 v88, v88
    v_rcp_f32 v89, v89
    v_rcp_f32 v90, v90
    v_rcp_f32 v91, v91
    v_rcp_f32 v92, v92
    v_rcp_f32 v93, v93
    v_rcp_f32 v94, v94
    v_rcp_f32 v95, v95
    v_pk_mul_f32 v[88:89], v[88:89], v[24:25]
    v_pk_mul_f32 v[90:91], v[90:91], v[26:27]
    v_pk_mul_f32 v[92:93], v[92:93], v[28:29]
    v_pk_mul_f32 v[94:95], v[94:95], v[30:31]
    v_cvt_pk_bf16_f32 v100, v88, v89
    v_cvt_pk_bf16_f32 v101, v90, v91
    v_cvt_pk_bf16_f32 v102, v92, v93
    v_cvt_pk_bf16_f32 v103, v94, v95
    buffer_store_dwordx4 v[100:103], v4, s[40:43], s68 offen offset:1024
L_end_C:
    s_endpgm

.globl phaseD_kernel
.p2align 8
.type phaseD_kernel,@function
phaseD_kernel:
    s_cmp_ge_u32 s2, 256
    s_cbranch_scc1 L_end_D
    s_load_dwordx2 s[24:25], s[0:1], 48
    s_load_dwordx2 s[32:33], s[0:1], 56
    s_load_dwordx2 s[40:41], s[0:1], 80
    s_load_dwordx2 s[36:37], s[0:1], 64
    v_lshrrev_b32 v1, 6, v0
    s_nop 0
    v_readfirstlane_b32 s3, v1
    v_and_b32 v1, 63, v0
    v_and_b32 v2, 15, v0
    v_lshrrev_b32 v3, 4, v1
    v_lshlrev_b32 v4, 4, v1
    s_mov_b32 s26, 0x700000
    s_mov_b32 s27, 0x00020000
    s_mov_b32 s34, 0x1000
    s_mov_b32 s35, 0x00020000
    s_mov_b32 s42, 0x900000
    s_mov_b32 s43, 0x00020000
    s_mov_b32 s38, 0x1c0000
    s_mov_b32 s39, 0x00020000
    s_mov_b32 s5, 0x3f803f80
    s_lshr_b32 s68, s2, 3
    s_mul_i32 s69, s68, 37
    s_lshr_b32 s69, s69, 8
    s_mul_i32 s64, s69, 7
    s_sub_u32 s64, s68, s64
    s_mov_b32 s66, s64
    s_and_b32 s68, s2, 7
    s_lshl_b32 s67, s68, 2
    s_add_u32 s67, s67, s69
    s_cmp_ge_u32 s69, 4
    s_cselect_b32 s67, 99, s67
    s_mul_i32 s71, s68, 3
    s_add_u32 s71, s71, 4
    s_lshl_b32 s72, s68, 2
    s_cmp_lt_u32 s68, 4
    s_cselect_b32 s65, s72, s71
    s_cselect_b32 s71, 4, 3
    s_add_u32 s65, s65, s69
    s_cmp_ge_u32 s69, s71
    s_cselect_b32 s65, 99, s65
    s_cmp_ge_u32 s67, 99
    s_cbranch_scc1 L_end_D
    s_mul_i32 s70, s3, 32768
    s_add_u32 s70, s70, 0
    v_lshrrev_b32 v220, 3, v1
    v_mul_u32_u24 v214, 4096, v220
    v_and_b32 v220, 1, v3
    v_lshlrev_b32 v220, 2, v220
    v_and_b32 v221, 7, v1
    v_xor_b32 v220, v220, v221
    v_lshl_add_u32 v214, v220, 4, v214
    s_mul_i32 s68, s3, 1835008
    s_lshl_b32 s69, s67, 7
    s_add_u32 s68, s68, s69
    v_add_u32 v214, s68, v214
    v_lshrrev_b32 v220, 5, v1
    v_lshlrev_b32 v217, 9, v220
    v_bfe_u32 v220, v1, 2, 2
    v_lshl_add_u32 v217, v220, 7, v217
    v_lshrrev_b32 v220, 1, v220
    s_lshr_b32 s68, s3, 1
    v_xor_b32 v220, s68, v220
    v_lshl_add_u32 v217, v220, 6, v217
    v_and_b32 v220, 1, v3
    v_lshl_add_u32 v217, v220, 5, v217
    v_and_b32 v220, 3, v1
    v_lshl_add_u32 v217, v220, 3, v217
    v_add_u32 v217, s70, v217
    v_xor_b32 v218, 64, v217
    s_add_u32 m0, s70, 0
    s_mov_b32 s68, 0
    s_waitcnt lgkmcnt(0)
    buffer_load_dwordx4 v214, s[24:27], s68 offen lds
    s_add_u32 m0, s70, 1024
    s_mov_b32 s68, 32768
    buffer_load_dwordx4 v214, s[24:27], s68 offen lds
    s_add_u32 m0, s70, 2048
    s_mov_b32 s68, 65536
    buffer_load_dwordx4 v214, s[24:27], s68 offen lds
    s_add_u32 m0, s70, 3072
    s_mov_b32 s68, 98304
    buffer_load_dwordx4 v214, s[24:27], s68 offen lds
    s_add_u32 m0, s70, 4096
    s_mov_b32 s68, 131072
    buffer_load_dwordx4 v214, s[24:27], s68 offen lds
    s_add_u32 m0, s70, 5120
    s_mov_b32 s68, 163840
    buffer_load_dwordx4 v214, s[24:27], s68 offen lds
    s_add_u32 m0, s70, 6144
    s_mov_b32 s68, 196608
    buffer_load_dwordx4 v214, s[24:27], s68 offen lds
    s_add_u32 m0, s70, 7168
    s_mov_b32 s68, 229376
    buffer_load_dwordx4 v214, s[24:27], s68 offen lds
    s_add_u32 m0, s70, 8192
    s_mov_b32 s68, 262144
    buffer_load_dwordx4 v214, s[24:27], s68 offen lds
    s_add_u32 m0, s70, 9216
    s_mov_b32 s68, 294912
    buffer_load_dwordx4 v214, s[24:27], s68 offen lds
    s_add_u32 m0, s70, 10240
    s_mov_b32 s68, 327680
    buffer_load_dwordx4 v214, s[24:27], s68 offen lds
    s_add_u32 m0, s70, 11264
    s_mov_b32 s68, 360448
    buffer_load_dwordx4 v214, s[24:27], s68 offen lds
    s_add_u32 m0, s70, 12288
    s_mov_b32 s68, 393216
    buffer_load_dwordx4 v214, s[24:27], s68 offen lds
    s_add_u32 m0, s70, 13312
    s_mov_b32 s68, 425984
    buffer_load_dwordx4 v214, s[24:27], s68 offen lds
    s_add_u32 m0, s70, 14336
    s_mov_b32 s68, 458752
    buffer_load_dwordx4 v214, s[24:27], s68 offen lds
    s_add_u32 m0, s70, 15360
    s_mov_b32 s68, 491520
    buffer_load_dwordx4 v214, s[24:27], s68 offen lds
    s_add_u32 m0, s70, 16384
    s_mov_b32 s68, 524288
    buffer_load_dwordx4 v214, s[24:27], s68 offen lds
    s_add_u32 m0, s70, 17408
    s_mov_b32 s68, 557056
    buffer_load_dwordx4 v214, s[24:27], s68 offen lds
    s_add_u32 m0, s70, 18432
    s_mov_b32 s68, 589824
    buffer_load_dwordx4 v214, s[24:27], s68 offen lds
    s_add_u32 m0, s70, 19456
    s_mov_b32 s68, 622592
    buffer_load_dwordx4 v214, s[24:27], s68 offen lds
    s_add_u32 m0, s70, 20480
    s_mov_b32 s68, 655360
    buffer_load_dwordx4 v214, s[24:27], s68 offen lds
    s_add_u32 m0, s70, 21504
    s_mov_b32 s68, 688128
    buffer_load_dwordx4 v214, s[24:27], s68 offen lds
    s_add_u32 m0, s70, 22528
    s_mov_b32 s68, 720896
    buffer_load_dwordx4 v214, s[24:27], s68 offen lds
    s_add_u32 m0, s70, 23552
    s_mov_b32 s68, 753664
    buffer_load_dwordx4 v214, s[24:27], s68 offen lds
    s_add_u32 m0, s70, 24576
    s_mov_b32 s68, 786432
    buffer_load_dwordx4 v214, s[24:27], s68 offen lds
    s_add_u32 m0, s70, 25600
    s_mov_b32 s68, 819200
    buffer_load_dwordx4 v214, s[24:27], s68 offen lds
    s_add_u32 m0, s70, 26624
    s_mov_b32 s68, 851968
    buffer_load_dwordx4 v214, s[24:27], s68 offen lds
    s_add_u32 m0, s70, 27648
    s_mov_b32 s68, 884736
    buffer_load_dwordx4 v214, s[24:27], s68 offen lds
    s_lshl_b32 s68, s66, 1
    s_and_b32 s69, s3, 1
    s_add_u32 s71, s68, s69
    s_xor_b32 s72, s71, 1
    s_mul_i32 s68, s3, 28672
    s_add_u32 s68, s68, 0x600000
    s_mul_i32 s71, s71, 114688
    s_add_u32 s71, s71, s68
    s_mul_i32 s72, s72, 114688
    s_add_u32 s72, s72, s68
    v_lshrrev_b32 v220, 5, v1
    v_lshlrev_b32 v220, 3, v220
    s_lshl_b32 s68, s67, 7
    s_lshr_b32 s69, s3, 1
    s_lshl_b32 s69, s69, 6
    s_add_u32 s68, s68, s69
    buffer_load_dwordx2 v[222:223], v220, s[32:35], s68 offen offset:0
    buffer_load_dwordx2 v[224:225], v220, s[32:35], s68 offen offset:16
    buffer_load_dwordx2 v[226:227], v220, s[32:35], s68 offen offset:32
    buffer_load_dwordx2 v[228:229], v220, s[32:35], s68 offen offset:48
    v_and_b32 v221, 31, v1
    v_lshl_add_u32 v221, v221, 4, v220
    s_lshl_b32 s68, s66, 1
    s_and_b32 s69, s3, 1
    s_add_u32 s68, s68, s69
    s_lshl_b32 s68, s68, 7
    s_lshl_b32 s69, s67, 2
    s_add_u32 s68, s68, s69
    s_and_b32 s69, s3, 2
    s_add_u32 s68, s68, s69
    s_lshl_b32 s68, s68, 10
    s_add_u32 s68, s68, 0x400000
    buffer_load_dwordx2 v[230:231], v221, s[40:43], s68 offen offset:0
    buffer_load_dwordx2 v[232:233], v221, s[40:43], s68 offen offset:512
    buffer_load_dwordx2 v[234:235], v221, s[40:43], s68 offen offset:1024
    buffer_load_dwordx2 v[236:237], v221, s[40:43], s68 offen offset:1536
    buffer_load_dwordx4 v[80:83], v4, s[40:43], s71 offen offset:0
    buffer_load_dwordx4 v[84:87], v4, s[40:43], s72 offen offset:0
    buffer_load_dwordx4 v[88:91], v4, s[40:43], s71 offen offset:1024
    buffer_load_dwordx4 v[92:95], v4, s[40:43], s72 offen offset:1024
    buffer_load_dwordx4 v[96:99], v4, s[40:43], s71 offen offset:2048
    buffer_load_dwordx4 v[100:103], v4, s[40:43], s72 offen offset:2048
    buffer_load_dwordx4 v[104:107], v4, s[40:43], s71 offen offset:3072
    buffer_load_dwordx4 v[108:111], v4, s[40:43], s72 offen offset:3072
    s_add_u32 s71, s71, 4096
    s_add_u32 s72, s72, 4096
    buffer_load_dwordx4 v[112:115], v4, s[40:43], s71 offen offset:0
    buffer_load_dwordx4 v[116:119], v4, s[40:43], s72 offen offset:0
    buffer_load_dwordx4 v[120:123], v4, s[40:43], s71 offen offset:1024
    buffer_load_dwordx4 v[124:127], v4, s[40:43], s72 offen offset:1024
    buffer_load_dwordx4 v[128:131], v4, s[40:43], s71 offen offset:2048
    buffer_load_dwordx4 v[132:135], v4, s[40:43], s72 offen offset:2048
    buffer_load_dwordx4 v[136:139], v4, s[40:43], s71 offen offset:3072
    buffer_load_dwordx4 v[140:143], v4, s[40:43], s72 offen offset:3072
    s_add_u32 s71, s71, 4096
    s_add_u32 s72, s72, 4096
    buffer_load_dwordx4 v[144:147], v4, s[40:43], s71 offen offset:0
    buffer_load_dwordx4 v[148:151], v4, s[40:43], s72 offen offset:0
    buffer_load_dwordx4 v[152:155], v4, s[40:43], s71 offen offset:1024
    buffer_load_dwordx4 v[156:159], v4, s[40:43], s72 offen offset:1024
    s_waitcnt vmcnt(28)
    ds_read_b64_tr_b16 a[0:1], v217 offset:0
    ds_read_b64_tr_b16 a[2:3], v217 offset:1024
    ds_read_b64_tr_b16 a[4:5], v218 offset:0
    ds_read_b64_tr_b16 a[6:7], v218 offset:1024
    ds_read_b64_tr_b16 a[8:9], v217 offset:2048
    ds_read_b64_tr_b16 a[10:11], v217 offset:3072
    ds_read_b64_tr_b16 a[12:13], v218 offset:2048
    ds_read_b64_tr_b16 a[14:15], v218 offset:3072
    ds_read_b64_tr_b16 a[16:17], v217 offset:4096
    ds_read_b64_tr_b16 a[18:19], v217 offset:5120
    ds_read_b64_tr_b16 a[20:21], v218 offset:4096
    ds_read_b64_tr_b16 a[22:23], v218 offset:5120
    ds_read_b64_tr_b16 a[24:25], v217 offset:6144
    ds_read_b64_tr_b16 a[26:27], v217 offset:7168
    ds_read_b64_tr_b16 a[28:29], v218 offset:6144
    ds_read_b64_tr_b16 a[30:31], v218 offset:7168
    ds_read_b64_tr_b16 a[32:33], v217 offset:8192
    ds_read_b64_tr_b16 a[34:35], v217 offset:9216
    ds_read_b64_tr_b16 a[36:37], v218 offset:8192
    ds_read_b64_tr_b16 a[38:39], v218 offset:9216
    ds_read_b64_tr_b16 a[40:41], v217 offset:10240
    ds_read_b64_tr_b16 a[42:43], v217 offset:11264
    ds_read_b64_tr_b16 a[44:45], v218 offset:10240
    ds_read_b64_tr_b16 a[46:47], v218 offset:11264
    ds_read_b64_tr_b16 a[48:49], v217 offset:12288
    ds_read_b64_tr_b16 a[50:51], v217 offset:13312
    ds_read_b64_tr_b16 a[52:53], v218 offset:12288
    ds_read_b64_tr_b16 a[54:55], v218 offset:13312
    ds_read_b64_tr_b16 a[56:57], v217 offset:14336
    ds_read_b64_tr_b16 a[58:59], v217 offset:15360
    ds_read_b64_tr_b16 a[60:61], v218 offset:14336
    ds_read_b64_tr_b16 a[62:63], v218 offset:15360
    ds_read_b64_tr_b16 a[64:65], v217 offset:16384
    ds_read_b64_tr_b16 a[66:67], v217 offset:17408
    ds_read_b64_tr_b16 a[68:69], v218 offset:16384
    ds_read_b64_tr_b16 a[70:71], v218 offset:17408
    ds_read_b64_tr_b16 a[72:73], v217 offset:18432
    ds_read_b64_tr_b16 a[74:75], v217 offset:19456
    ds_read_b64_tr_b16 a[76:77], v218 offset:18432
    ds_read_b64_tr_b16 a[78:79], v218 offset:19456
    ds_read_b64_tr_b16 a[80:81], v217 offset:20480
    ds_read_b64_tr_b16 a[82:83], v217 offset:21504
    ds_read_b64_tr_b16 a[84:85], v218 offset:20480
    ds_read_b64_tr_b16 a[86:87], v218 offset:21504
    ds_read_b64_tr_b16 a[88:89], v217 offset:22528
    ds_read_b64_tr_b16 a[90:91], v217 offset:23552
    ds_read_b64_tr_b16 a[92:93], v218 offset:22528
    ds_read_b64_tr_b16 a[94:95], v218 offset:23552
    ds_read_b64_tr_b16 a[96:97], v217 offset:24576
    ds_read_b64_tr_b16 a[98:99], v217 offset:25600
    ds_read_b64_tr_b16 a[100:101], v218 offset:24576
    ds_read_b64_tr_b16 a[102:103], v218 offset:25600
    ds_read_b64_tr_b16 a[104:105], v217 offset:26624
    ds_read_b64_tr_b16 a[106:107], v217 offset:27648
    ds_read_b64_tr_b16 a[108:109], v218 offset:26624
    ds_read_b64_tr_b16 a[110:111], v218 offset:27648
    s_waitcnt lgkmcnt(0)
    s_add_u32 m0, s70, 0
    s_mov_b32 s68, 917504
    buffer_load_dwordx4 v214, s[24:27], s68 offen lds
    s_add_u32 m0, s70, 1024
    s_mov_b32 s68, 950272
    buffer_load_dwordx4 v214, s[24:27], s68 offen lds
    s_add_u32 m0, s70, 2048
    s_mov_b32 s68, 983040
    buffer_load_dwordx4 v214, s[24:27], s68 offen lds
    s_add_u32 m0, s70, 3072
    s_mov_b32 s68, 1015808
    buffer_load_dwordx4 v214, s[24:27], s68 offen lds
    s_add_u32 m0, s70, 4096
    s_mov_b32 s68, 1048576
    buffer_load_dwordx4 v214, s[24:27], s68 offen lds
    s_add_u32 m0, s70, 5120
    s_mov_b32 s68, 1081344
    buffer_load_dwordx4 v214, s[24:27], s68 offen lds
    s_add_u32 m0, s70, 6144
    s_mov_b32 s68, 1114112
    buffer_load_dwordx4 v214, s[24:27], s68 offen lds
    s_add_u32 m0, s70, 7168
    s_mov_b32 s68, 1146880
    buffer_load_dwordx4 v214, s[24:27], s68 offen lds
    s_add_u32 m0, s70, 8192
    s_mov_b32 s68, 1179648
    buffer_load_dwordx4 v214, s[24:27], s68 offen lds
    s_add_u32 m0, s70, 9216
    s_mov_b32 s68, 1212416
    buffer_load_dwordx4 v214, s[24:27], s68 offen lds
    s_add_u32 m0, s70, 10240
    s_mov_b32 s68, 1245184
    buffer_load_dwordx4 v214, s[24:27], s68 offen lds
    s_add_u32 m0, s70, 11264
    s_mov_b32 s68, 1277952
    buffer_load_dwordx4 v214, s[24:27], s68 offen lds
    s_add_u32 m0, s70, 12288
    s_mov_b32 s68, 1310720
    buffer_load_dwordx4 v214, s[24:27], s68 offen lds
    s_add_u32 m0, s70, 13312
    s_mov_b32 s68, 1343488
    buffer_load_dwordx4 v214, s[24:27], s68 offen lds
    s_add_u32 m0, s70, 14336
    s_mov_b32 s68, 1376256
    buffer_load_dwordx4 v214, s[24:27], s68 offen lds
    s_add_u32 m0, s70, 15360
    s_mov_b32 s68, 1409024
    buffer_load_dwordx4 v214, s[24:27], s68 offen lds
    s_add_u32 m0, s70, 16384
    s_mov_b32 s68, 1441792
    buffer_load_dwordx4 v214, s[24:27], s68 offen lds
    s_add_u32 m0, s70, 17408
    s_mov_b32 s68, 1474560
    buffer_load_dwordx4 v214, s[24:27], s68 offen lds
    s_add_u32 m0, s70, 18432
    s_mov_b32 s68, 1507328
    buffer_load_dwordx4 v214, s[24:27], s68 offen lds
    s_add_u32 m0, s70, 19456
    s_mov_b32 s68, 1540096
    buffer_load_dwordx4 v214, s[24:27], s68 offen lds
    s_add_u32 m0, s70, 20480
    s_mov_b32 s68, 1572864
    buffer_load_dwordx4 v214, s[24:27], s68 offen lds
    s_add_u32 m0, s70, 21504
    s_mov_b32 s68, 1605632
    buffer_load_dwordx4 v214, s[24:27], s68 offen lds
    s_add_u32 m0, s70, 22528
    s_mov_b32 s68, 1638400
    buffer_load_dwordx4 v214, s[24:27], s68 offen lds
    s_add_u32 m0, s70, 23552
    s_mov_b32 s68, 1671168
    buffer_load_dwordx4 v214, s[24:27], s68 offen lds
    s_add_u32 m0, s70, 24576
    s_mov_b32 s68, 1703936
    buffer_load_dwordx4 v214, s[24:27], s68 offen lds
    s_add_u32 m0, s70, 25600
    s_mov_b32 s68, 1736704
    buffer_load_dwordx4 v214, s[24:27], s68 offen lds
    s_add_u32 m0, s70, 26624
    s_mov_b32 s68, 1769472
    buffer_load_dwordx4 v214, s[24:27], s68 offen lds
    s_add_u32 m0, s70, 27648
    s_mov_b32 s68, 1802240
    buffer_load_dwordx4 v214, s[24:27], s68 offen lds
    s_waitcnt vmcnt(55)
    v_lshlrev_b32 v16, 16, v222
    v_and_b32 v17, 0xffff0000, v222
    s_waitcnt vmcnt(51)
    v_lshlrev_b32 v238, 16, v230
    v_and_b32 v239, 0xffff0000, v230
    v_pk_add_f32 v[16:17], v[16:17], v[238:239]
    v_lshlrev_b32 v18, 16, v223
    v_and_b32 v19, 0xffff0000, v223
    v_lshlrev_b32 v238, 16, v231
    v_and_b32 v239, 0xffff0000, v231
    v_pk_add_f32 v[18:19], v[18:19], v[238:239]
    v_lshlrev_b32 v20, 16, v224
    v_and_b32 v21, 0xffff0000, v224
    s_waitcnt vmcnt(50)
    v_lshlrev_b32 v238, 16, v232
    v_and_b32 v239, 0xffff0000, v232
    v_pk_add_f32 v[20:21], v[20:21], v[238:239]
    v_lshlrev_b32 v22, 16, v225
    v_and_b32 v23, 0xffff0000, v225
    v_lshlrev_b32 v238, 16, v233
    v_and_b32 v239, 0xffff0000, v233
    v_pk_add_f32 v[22:23], v[22:23], v[238:239]
    v_lshlrev_b32 v24, 16, v226
    v_and_b32 v25, 0xffff0000, v226
    s_waitcnt vmcnt(49)
    v_lshlrev_b32 v238, 16, v234
    v_and_b32 v239, 0xffff0000, v234
    v_pk_add_f32 v[24:25], v[24:25], v[238:239]
    v_lshlrev_b32 v26, 16, v227
    v_and_b32 v27, 0xffff0000, v227
    v_lshlrev_b32 v238, 16, v235
    v_and_b32 v239, 0xffff0000, v235
    v_pk_add_f32 v[26:27], v[26:27], v[238:239]
    v_lshlrev_b32 v28, 16, v228
    v_and_b32 v29, 0xffff0000, v228
    s_waitcnt vmcnt(48)
    v_lshlrev_b32 v238, 16, v236
    v_and_b32 v239, 0xffff0000, v236
    v_pk_add_f32 v[28:29], v[28:29], v[238:239]
    v_lshlrev_b32 v30, 16, v229
    v_and_b32 v31, 0xffff0000, v229
    v_lshlrev_b32 v238, 16, v237
    v_and_b32 v239, 0xffff0000, v237
    v_pk_add_f32 v[30:31], v[30:31], v[238:239]
    s_waitcnt vmcnt(47)
    s_nop 0
    v_mfma_f32_32x32x16_bf16 v[16:31], a[0:3], v[80:83], v[16:31]
    s_waitcnt vmcnt(46)
    v_mfma_f32_32x32x16_bf16 v[32:47], a[0:3], v[84:87], 0
    v_mfma_f32_32x32x16_bf16 v[48:63], a[4:7], v[80:83], 0
    v_mfma_f32_32x32x16_bf16 v[64:79], a[4:7], v[84:87], 0
    buffer_load_dwordx4 v[160:163], v4, s[40:43], s71 offen offset:2048
    buffer_load_dwordx4 v[164:167], v4, s[40:43], s72 offen offset:2048
    buffer_load_dwordx4 v[168:171], v4, s[40:43], s71 offen offset:3072
    buffer_load_dwordx4 v[172:175], v4, s[40:43], s72 offen offset:3072
    s_add_u32 s71, s71, 4096
    s_add_u32 s72, s72, 4096
    buffer_load_dwordx4 v[176:179], v4, s[40:43], s71 offen offset:0
    buffer_load_dwordx4 v[180:183], v4, s[40:43], s72 offen offset:0
    buffer_load_dwordx4 v[184:187], v4, s[40:43], s71 offen offset:1024
    buffer_load_dwordx4 v[188:191], v4, s[40:43], s72 offen offset:1024
    buffer_load_dwordx4 v[192:195], v4, s[40:43], s71 offen offset:2048
    buffer_load_dwordx4 v[196:199], v4, s[40:43], s72 offen offset:2048
    buffer_load_dwordx4 v[200:203], v4, s[40:43], s71 offen offset:3072
    buffer_load_dwordx4 v[204:207], v4, s[40:43], s72 offen offset:3072
    s_waitcnt vmcnt(57)
    v_mfma_f32_32x32x16_bf16 v[16:31], a[8:11], v[88:91], v[16:31]
    s_waitcnt vmcnt(56)
    v_mfma_f32_32x32x16_bf16 v[32:47], a[8:11], v[92:95], v[32:47]
    v_mfma_f32_32x32x16_bf16 v[48:63], a[12:15], v[88:91], v[48:63]
    v_mfma_f32_32x32x16_bf16 v[64:79], a[12:15], v[92:95], v[64:79]
    s_add_u32 s71, s71, 4096
    s_add_u32 s72, s72, 4096
    buffer_load_dwordx4 v[80:83], v4, s[40:43], s71 offen offset:0
    buffer_load_dwordx4 v[84:87], v4, s[40:43], s72 offen offset:0
    s_waitcnt vmcnt(57)
    v_mfma_f32_32x32x16_bf16 v[16:31], a[16:19], v[96:99], v[16:31]
    s_waitcnt vmcnt(56)
    v_mfma_f32_32x32x16_bf16 v[32:47], a[16:19], v[100:103], v[32:47]
    v_mfma_f32_32x32x16_bf16 v[48:63], a[20:23], v[96:99], v[48:63]
    v_mfma_f32_32x32x16_bf16 v[64:79], a[20:23], v[100:103], v[64:79]
    buffer_load_dwordx4 v[88:91], v4, s[40:43], s71 offen offset:1024
    buffer_load_dwordx4 v[92:95], v4, s[40:43], s72 offen offset:1024
    s_waitcnt vmcnt(57)
    v_mfma_f32_32x32x16_bf16 v[16:31], a[24:27], v[104:107], v[16:31]
    s_waitcnt vmcnt(56)
    v_mfma_f32_32x32x16_bf16 v[32:47], a[24:27], v[108:111], v[32:47]
    v_mfma_f32_32x32x16_bf16 v[48:63], a[28:31], v[104:107], v[48:63]
    v_mfma_f32_32x32x16_bf16 v[64:79], a[28:31], v[108:111], v[64:79]
    buffer_load_dwordx4 v[96:99], v4, s[40:43], s71 offen offset:2048
    buffer_load_dwordx4 v[100:103], v4, s[40:43], s72 offen offset:2048
    s_waitcnt vmcnt(57)
    v_mfma_f32_32x32x16_bf16 v[16:31], a[32:35], v[112:115], v[16:31]
    s_waitcnt vmcnt(56)
    v_mfma_f32_32x32x16_bf16 v[32:47], a[32:35], v[116:119], v[32:47]
    v_mfma_f32_32x32x16_bf16 v[48:63], a[36:39], v[112:115], v[48:63]
    v_mfma_f32_32x32x16_bf16 v[64:79], a[36:39], v[116:119], v[64:79]
    buffer_load_dwordx4 v[104:107], v4, s[40:43], s71 offen offset:3072
    buffer_load_dwordx4 v[108:111], v4, s[40:43], s72 offen offset:3072
    s_waitcnt vmcnt(57)
    v_mfma_f32_32x32x16_bf16 v[16:31], a[40:43], v[120:123], v[16:31]
    s_waitcnt vmcnt(56)
    v_mfma_f32_32x32x16_bf16 v[32:47], a[40:43], v[124:127], v[32:47]
    v_mfma_f32_32x32x16_bf16 v[48:63], a[44:47], v[120:123], v[48:63]
    v_mfma_f32_32x32x16_bf16 v[64:79], a[44:47], v[124:127], v[64:79]
    s_add_u32 s71, s71, 4096
    s_add_u32 s72, s72, 4096
    buffer_load_dwordx4 v[112:115], v4, s[40:43], s71 offen offset:0
    buffer_load_dwordx4 v[116:119], v4, s[40:43], s72 offen offset:0
    s_waitcnt vmcnt(57)
    v_mfma_f32_32x32x16_bf16 v[16:31], a[48:51], v[128:131], v[16:31]
    s_waitcnt vmcnt(56)
    v_mfma_f32_32x32x16_bf16 v[32:47], a[48:51], v[132:135], v[32:47]
    v_mfma_f32_32x32x16_bf16 v[48:63], a[52:55], v[128:131], v[48:63]
    v_mfma_f32_32x32x16_bf16 v[64:79], a[52:55], v[132:135], v[64:79]
    buffer_load_dwordx4 v[120:123], v4, s[40:43], s71 offen offset:1024
    buffer_load_dwordx4 v[124:127], v4, s[40:43], s72 offen offset:1024
    s_waitcnt vmcnt(57)
    v_mfma_f32_32x32x16_bf16 v[16:31], a[56:59], v[136:139], v[16:31]
    s_waitcnt vmcnt(56)
    v_mfma_f32_32x32x16_bf16 v[32:47], a[56:59], v[140:143], v[32:47]
    v_mfma_f32_32x32x16_bf16 v[48:63], a[60:63], v[136:139], v[48:63]
    v_mfma_f32_32x32x16_bf16 v[64:79], a[60:63], v[140:143], v[64:79]
    buffer_load_dwordx4 v[128:131], v4, s[40:43], s71 offen offset:2048
    buffer_load_dwordx4 v[132:135], v4, s[40:43], s72 offen offset:2048
    s_waitcnt vmcnt(57)
    v_mfma_f32_32x32x16_bf16 v[16:31], a[64:67], v[144:147], v[16:31]
    s_waitcnt vmcnt(56)
    v_mfma_f32_32x32x16_bf16 v[32:47], a[64:67], v[148:151], v[32:47]
    v_mfma_f32_32x32x16_bf16 v[48:63], a[68:71], v[144:147], v[48:63]
    v_mfma_f32_32x32x16_bf16 v[64:79], a[68:71], v[148:151], v[64:79]
    buffer_load_dwordx4 v[136:139], v4, s[40:43], s71 offen offset:3072
    buffer_load_dwordx4 v[140:143], v4, s[40:43], s72 offen offset:3072
    s_waitcnt vmcnt(57)
    v_mfma_f32_32x32x16_bf16 v[16:31], a[72:75], v[152:155], v[16:31]
    s_waitcnt vmcnt(56)
    v_mfma_f32_32x32x16_bf16 v[32:47], a[72:75], v[156:159], v[32:47]
    v_mfma_f32_32x32x16_bf16 v[48:63], a[76:79], v[152:155], v[48:63]
    v_mfma_f32_32x32x16_bf16 v[64:79], a[76:79], v[156:159], v[64:79]
    s_add_u32 s71, s71, 4096
    s_add_u32 s72, s72, 4096
    buffer_load_dwordx4 v[144:147], v4, s[40:43], s71 offen offset:0
    buffer_load_dwordx4 v[148:151], v4, s[40:43], s72 offen offset:0
    s_waitcnt vmcnt(29)
    v_mfma_f32_32x32x16_bf16 v[16:31], a[80:83], v[160:163], v[16:31]
    s_waitcnt vmcnt(28)
    v_mfma_f32_32x32x16_bf16 v[32:47], a[80:83], v[164:167], v[32:47]
    v_mfma_f32_32x32x16_bf16 v[48:63], a[84:87], v[160:163], v[48:63]
    v_mfma_f32_32x32x16_bf16 v[64:79], a[84:87], v[164:167], v[64:79]
    buffer_load_dwordx4 v[152:155], v4, s[40:43], s71 offen offset:1024
    buffer_load_dwordx4 v[156:159], v4, s[40:43], s72 offen offset:1024
    s_waitcnt vmcnt(29)
    v_mfma_f32_32x32x16_bf16 v[16:31], a[88:91], v[168:171], v[16:31]
    s_waitcnt vmcnt(28)
    v_mfma_f32_32x32x16_bf16 v[32:47], a[88:91], v[172:175], v[32:47]
    v_mfma_f32_32x32x16_bf16 v[48:63], a[92:95], v[168:171], v[48:63]
    v_mfma_f32_32x32x16_bf16 v[64:79], a[92:95], v[172:175], v[64:79]
    buffer_load_dwordx4 v[160:163], v4, s[40:43], s71 offen offset:2048
    buffer_load_dwordx4 v[164:167], v4, s[40:43], s72 offen offset:2048
    s_waitcnt vmcnt(29)
    v_mfma_f32_32x32x16_bf16 v[16:31], a[96:99], v[176:179], v[16:31]
    s_waitcnt vmcnt(28)
    v_mfma_f32_32x32x16_bf16 v[32:47], a[96:99], v[180:183], v[32:47]
    v_mfma_f32_32x32x16_bf16 v[48:63], a[100:103], v[176:179], v[48:63]
    v_mfma_f32_32x32x16_bf16 v[64:79], a[100:103], v[180:183], v[64:79]
    buffer_load_dwordx4 v[168:171], v4, s[40:43], s71 offen offset:3072
    buffer_load_dwordx4 v[172:175], v4, s[40:43], s72 offen offset:3072
    s_waitcnt vmcnt(29)
    v_mfma_f32_32x32x16_bf16 v[16:31], a[104:107], v[184:187], v[16:31]
    s_waitcnt vmcnt(28)
    v_mfma_f32_32x32x16_bf16 v[32:47], a[104:107], v[188:191], v[32:47]
    v_mfma_f32_32x32x16_bf16 v[48:63], a[108:111], v[184:187], v[48:63]
    v_mfma_f32_32x32x16_bf16 v[64:79], a[108:111], v[188:191], v[64:79]
    ds_read_b64_tr_b16 a[112:113], v217 offset:0
    ds_read_b64_tr_b16 a[114:115], v217 offset:1024
    ds_read_b64_tr_b16 a[116:117], v218 offset:0
    ds_read_b64_tr_b16 a[118:119], v218 offset:1024
    ds_read_b64_tr_b16 a[120:121], v217 offset:2048
    ds_read_b64_tr_b16 a[122:123], v217 offset:3072
    ds_read_b64_tr_b16 a[124:125], v218 offset:2048
    ds_read_b64_tr_b16 a[126:127], v218 offset:3072
    ds_read_b64_tr_b16 a[128:129], v217 offset:4096
    ds_read_b64_tr_b16 a[130:131], v217 offset:5120
    ds_read_b64_tr_b16 a[132:133], v218 offset:4096
    ds_read_b64_tr_b16 a[134:135], v218 offset:5120
    ds_read_b64_tr_b16 a[136:137], v217 offset:6144
    ds_read_b64_tr_b16 a[138:139], v217 offset:7168
    ds_read_b64_tr_b16 a[140:141], v218 offset:6144
    ds_read_b64_tr_b16 a[142:143], v218 offset:7168
    ds_read_b64_tr_b16 a[144:145], v217 offset:8192
    ds_read_b64_tr_b16 a[146:147], v217 offset:9216
    ds_read_b64_tr_b16 a[148:149], v218 offset:8192
    ds_read_b64_tr_b16 a[150:151], v218 offset:9216
    ds_read_b64_tr_b16 a[152:153], v217 offset:10240
    ds_read_b64_tr_b16 a[154:155], v217 offset:11264
    ds_read_b64_tr_b16 a[156:157], v218 offset:10240
    ds_read_b64_tr_b16 a[158:159], v218 offset:11264
    ds_read_b64_tr_b16 a[160:161], v217 offset:12288
    ds_read_b64_tr_b16 a[162:163], v217 offset:13312
    ds_read_b64_tr_b16 a[164:165], v218 offset:12288
    ds_read_b64_tr_b16 a[166:167], v218 offset:13312
    ds_read_b64_tr_b16 a[168:169], v217 offset:14336
    ds_read_b64_tr_b16 a[170:171], v217 offset:15360
    ds_read_b64_tr_b16 a[172:173], v218 offset:14336
    ds_read_b64_tr_b16 a[174:175], v218 offset:15360
    ds_read_b64_tr_b16 a[176:177], v217 offset:16384
    ds_read_b64_tr_b16 a[178:179], v217 offset:17408
    ds_read_b64_tr_b16 a[180:181], v218 offset:16384
    ds_read_b64_tr_b16 a[182:183], v218 offset:17408
    ds_read_b64_tr_b16 a[184:185], v217 offset:18432
    ds_read_b64_tr_b16 a[186:187], v217 offset:19456
    ds_read_b64_tr_b16 a[188:189], v218 offset:18432
    ds_read_b64_tr_b16 a[190:191], v218 offset:19456
    ds_read_b64_tr_b16 a[192:193], v217 offset:20480
    ds_read_b64_tr_b16 a[194:195], v217 offset:21504
    ds_read_b64_tr_b16 a[196:197], v218 offset:20480
    ds_read_b64_tr_b16 a[198:199], v218 offset:21504
    ds_read_b64_tr_b16 a[200:201], v217 offset:22528
    ds_read_b64_tr_b16 a[202:203], v217 offset:23552
    ds_read_b64_tr_b16 a[204:205], v218 offset:22528
    ds_read_b64_tr_b16 a[206:207], v218 offset:23552
    ds_read_b64_tr_b16 a[208:209], v217 offset:24576
    ds_read_b64_tr_b16 a[210:211], v217 offset:25600
    ds_read_b64_tr_b16 a[212:213], v218 offset:24576
    ds_read_b64_tr_b16 a[214:215], v218 offset:25600
    ds_read_b64_tr_b16 a[216:217], v217 offset:26624
    ds_read_b64_tr_b16 a[218:219], v217 offset:27648
    ds_read_b64_tr_b16 a[220:221], v218 offset:26624
    ds_read_b64_tr_b16 a[222:223], v218 offset:27648
    s_waitcnt vmcnt(27) lgkmcnt(15)
    v_mfma_f32_32x32x16_bf16 v[16:31], a[112:115], v[192:195], v[16:31]
    s_waitcnt vmcnt(26)
    v_mfma_f32_32x32x16_bf16 v[32:47], a[112:115], v[196:199], v[32:47]
    v_mfma_f32_32x32x16_bf16 v[48:63], a[116:119], v[192:195], v[48:63]
    v_mfma_f32_32x32x16_bf16 v[64:79], a[116:119], v[196:199], v[64:79]
    s_waitcnt vmcnt(25)
    v_mfma_f32_32x32x16_bf16 v[16:31], a[120:123], v[200:203], v[16:31]
    s_waitcnt vmcnt(24)
    v_mfma_f32_32x32x16_bf16 v[32:47], a[120:123], v[204:207], v[32:47]
    v_mfma_f32_32x32x16_bf16 v[48:63], a[124:127], v[200:203], v[48:63]
    v_mfma_f32_32x32x16_bf16 v[64:79], a[124:127], v[204:207], v[64:79]
    s_waitcnt vmcnt(23)
    v_mfma_f32_32x32x16_bf16 v[16:31], a[128:131], v[80:83], v[16:31]
    s_waitcnt vmcnt(22)
    v_mfma_f32_32x32x16_bf16 v[32:47], a[128:131], v[84:87], v[32:47]
    v_mfma_f32_32x32x16_bf16 v[48:63], a[132:135], v[80:83], v[48:63]
    v_mfma_f32_32x32x16_bf16 v[64:79], a[132:135], v[84:87], v[64:79]
    s_waitcnt vmcnt(21)
    v_mfma_f32_32x32x16_bf16 v[16:31], a[136:139], v[88:91], v[16:31]
    s_waitcnt vmcnt(20)
    v_mfma_f32_32x32x16_bf16 v[32:47], a[136:139], v[92:95], v[32:47]
    v_mfma_f32_32x32x16_bf16 v[48:63], a[140:143], v[88:91], v[48:63]
    v_mfma_f32_32x32x16_bf16 v[64:79], a[140:143], v[92:95], v[64:79]
    s_waitcnt vmcnt(19)
    v_mfma_f32_32x32x16_bf16 v[16:31], a[144:147], v[96:99], v[16:31]
    s_waitcnt vmcnt(18)
    v_mfma_f32_32x32x16_bf16 v[32:47], a[144:147], v[100:103], v[32:47]
    v_mfma_f32_32x32x16_bf16 v[48:63], a[148:151], v[96:99], v[48:63]
    v_mfma_f32_32x32x16_bf16 v[64:79], a[148:151], v[100:103], v[64:79]
    s_waitcnt vmcnt(17)
    v_mfma_f32_32x32x16_bf16 v[16:31], a[152:155], v[104:107], v[16:31]
    s_waitcnt vmcnt(16)
    v_mfma_f32_32x32x16_bf16 v[32:47], a[152:155], v[108:111], v[32:47]
    v_mfma_f32_32x32x16_bf16 v[48:63], a[156:159], v[104:107], v[48:63]
    v_mfma_f32_32x32x16_bf16 v[64:79], a[156:159], v[108:111], v[64:79]
    s_waitcnt vmcnt(15)
    v_mfma_f32_32x32x16_bf16 v[16:31], a[160:163], v[112:115], v[16:31]
    s_waitcnt vmcnt(14)
    v_mfma_f32_32x32x16_bf16 v[32:47], a[160:163], v[116:119], v[32:47]
    v_mfma_f32_32x32x16_bf16 v[48:63], a[164:167], v[112:115], v[48:63]
    v_mfma_f32_32x32x16_bf16 v[64:79], a[164:167], v[116:119], v[64:79]
    s_waitcnt vmcnt(13)
    v_mfma_f32_32x32x16_bf16 v[16:31], a[168:171], v[120:123], v[16:31]
    s_waitcnt vmcnt(12)
    v_mfma_f32_32x32x16_bf16 v[32:47], a[168:171], v[124:127], v[32:47]
    v_mfma_f32_32x32x16_bf16 v[48:63], a[172:175], v[120:123], v[48:63]
    v_mfma_f32_32x32x16_bf16 v[64:79], a[172:175], v[124:127], v[64:79]
    s_waitcnt vmcnt(11)
    v_mfma_f32_32x32x16_bf16 v[16:31], a[176:179], v[128:131], v[16:31]
    s_waitcnt vmcnt(10)
    v_mfma_f32_32x32x16_bf16 v[32:47], a[176:179], v[132:135], v[32:47]
    v_mfma_f32_32x32x16_bf16 v[48:63], a[180:183], v[128:131], v[48:63]
    v_mfma_f32_32x32x16_bf16 v[64:79], a[180:183], v[132:135], v[64:79]
    s_waitcnt vmcnt(9)
    v_mfma_f32_32x32x16_bf16 v[16:31], a[184:187], v[136:139], v[16:31]
    s_waitcnt vmcnt(8)
    v_mfma_f32_32x32x16_bf16 v[32:47], a[184:187], v[140:143], v[32:47]
    v_mfma_f32_32x32x16_bf16 v[48:63], a[188:191], v[136:139], v[48:63]
    v_mfma_f32_32x32x16_bf16 v[64:79], a[188:191], v[140:143], v[64:79]
    s_waitcnt vmcnt(7) lgkmcnt(14)
    v_mfma_f32_32x32x16_bf16 v[16:31], a[192:195], v[144:147], v[16:31]
    s_waitcnt vmcnt(6)
    v_mfma_f32_32x32x16_bf16 v[32:47], a[192:195], v[148:151], v[32:47]
    s_waitcnt lgkmcnt(12)
    v_mfma_f32_32x32x16_bf16 v[48:63], a[196:199], v[144:147], v[48:63]
    v_mfma_f32_32x32x16_bf16 v[64:79], a[196:199], v[148:151], v[64:79]
    s_waitcnt vmcnt(5) lgkmcnt(10)
    v_mfma_f32_32x32x16_bf16 v[16:31], a[200:203], v[152:155], v[16:31]
    s_waitcnt vmcnt(4)
    v_mfma_f32_32x32x16_bf16 v[32:47], a[200:203], v[156:159], v[32:47]
    s_waitcnt lgkmcnt(8)
    v_mfma_f32_32x32x16_bf16 v[48:63], a[204:207], v[152:155], v[48:63]
    v_mfma_f32_32x32x16_bf16 v[64:79], a[204:207], v[156:159], v[64:79]
    s_waitcnt vmcnt(3) lgkmcnt(6)
    v_mfma_f32_32x32x16_bf16 v[16:31], a[208:211], v[160:163], v[16:31]
    s_waitcnt vmcnt(2)
    v_mfma_f32_32x32x16_bf16 v[32:47], a[208:211], v[164:167], v[32:47]
    s_waitcnt lgkmcnt(4)
    v_mfma_f32_32x32x16_bf16 v[48:63], a[212:215], v[160:163], v[48:63]
    v_mfma_f32_32x32x16_bf16 v[64:79], a[212:215], v[164:167], v[64:79]
    s_waitcnt vmcnt(1) lgkmcnt(2)
    v_mfma_f32_32x32x16_bf16 v[16:31], a[216:219], v[168:171], v[16:31]
    s_waitcnt vmcnt(0)
    v_mfma_f32_32x32x16_bf16 v[32:47], a[216:219], v[172:175], v[32:47]
    s_waitcnt lgkmcnt(0)
    v_mfma_f32_32x32x16_bf16 v[48:63], a[220:223], v[168:171], v[48:63]
    v_mfma_f32_32x32x16_bf16 v[64:79], a[220:223], v[172:175], v[64:79]
    s_barrier
    v_lshrrev_b32 v220, 5, v1
    v_lshlrev_b32 v220, 10, v220
    v_and_b32 v221, 31, v1
    v_lshl_add_u32 v220, v221, 2, v220
    s_lshl_b32 s68, s3, 14
    s_add_u32 s68, s68, 0
    s_lshr_b32 s69, s3, 1
    s_lshl_b32 s69, s69, 13
    s_add_u32 s68, s68, s69
    s_and_b32 s69, s3, 1
    s_lshl_b32 s69, s69, 7
    s_add_u32 s68, s68, s69
    v_add_u32 v220, s68, v220
    v_xor_b32 v221, 128, v220
    v_xor_b32 v222, 0x2000, v220
    v_xor_b32 v223, 0x2080, v220
    ds_write2st64_b32 v220, v16, v17 offset0:0 offset1:1
    ds_write2st64_b32 v220, v18, v19 offset0:2 offset1:3
    ds_write2st64_b32 v220, v20, v21 offset0:8 offset1:9
    ds_write2st64_b32 v220, v22, v23 offset0:10 offset1:11
    ds_write2st64_b32 v220, v24, v25 offset0:16 offset1:17
    ds_write2st64_b32 v220, v26, v27 offset0:18 offset1:19
    ds_write2st64_b32 v220, v28, v29 offset0:24 offset1:25
    ds_write2st64_b32 v220, v30, v31 offset0:26 offset1:27
    ds_write2st64_b32 v221, v32, v33 offset0:0 offset1:1
    ds_write2st64_b32 v221, v34, v35 offset0:2 offset1:3
    ds_write2st64_b32 v221, v36, v37 offset0:8 offset1:9
    ds_write2st64_b32 v221, v38, v39 offset0:10 offset1:11
    ds_write2st64_b32 v221, v40, v41 offset0:16 offset1:17
    ds_write2st64_b32 v221, v42, v43 offset0:18 offset1:19
    ds_write2st64_b32 v221, v44, v45 offset0:24 offset1:25
    ds_write2st64_b32 v221, v46, v47 offset0:26 offset1:27
    ds_write2st64_b32 v222, v48, v49 offset0:0 offset1:1
    ds_write2st64_b32 v222, v50, v51 offset0:2 offset1:3
    ds_write2st64_b32 v222, v52, v53 offset0:8 offset1:9
    ds_write2st64_b32 v222, v54, v55 offset0:10 offset1:11
    ds_write2st64_b32 v222, v56, v57 offset0:16 offset1:17
    ds_write2st64_b32 v222, v58, v59 offset0:18 offset1:19
    ds_write2st64_b32 v222, v60, v61 offset0:24 offset1:25
    ds_write2st64_b32 v222, v62, v63 offset0:26 offset1:27
    ds_write2st64_b32 v223, v64, v65 offset0:0 offset1:1
    ds_write2st64_b32 v223, v66, v67 offset0:2 offset1:3
    ds_write2st64_b32 v223, v68, v69 offset0:8 offset1:9
    ds_write2st64_b32 v223, v70, v71 offset0:10 offset1:11
    ds_write2st64_b32 v223, v72, v73 offset0:16 offset1:17
    ds_write2st64_b32 v223, v74, v75 offset0:18 offset1:19
    ds_write2st64_b32 v223, v76, v77 offset0:24 offset1:25
    ds_write2st64_b32 v223, v78, v79 offset0:26 offset1:27
    s_lshl_b32 s68, s3, 12
    s_add_u32 s68, s68, 0
    v_add_u32 v224, s68, v4
    v_mul_u32_u24 v225, 896, v3
    v_lshl_add_u32 v225, v2, 3, v225
    s_lshl_b32 s68, s67, 2
    s_add_u32 s68, s68, s3
    s_mul_i32 s68, s68, 14336
    s_lshl_b32 s69, s66, 7
    s_add_u32 s68, s68, s69
    s_add_u32 s69, s68, 7168
    s_waitcnt lgkmcnt(0)
    s_barrier
    ds_read_b128 v[16:19], v224 offset:0
    ds_read_b128 v[20:23], v224 offset:16384
    ds_read_b128 v[24:27], v224 offset:32768
    ds_read_b128 v[28:31], v224 offset:49152
    ds_read_b128 v[32:35], v224 offset:1024
    ds_read_b128 v[36:39], v224 offset:17408
    ds_read_b128 v[40:43], v224 offset:33792
    ds_read_b128 v[44:47], v224 offset:50176
    ds_read_b128 v[48:51], v224 offset:2048
    ds_read_b128 v[52:55], v224 offset:18432
    ds_read_b128 v[56:59], v224 offset:34816
    ds_read_b128 v[60:63], v224 offset:51200
    ds_read_b128 v[64:67], v224 offset:3072
    ds_read_b128 v[68:71], v224 offset:19456
    ds_read_b128 v[72:75], v224 offset:35840
    ds_read_b128 v[76:79], v224 offset:52224
    s_waitcnt lgkmcnt(14)
    v_pk_add_f32 v[16:17], v[16:17], v[20:21]
    s_waitcnt lgkmcnt(12)
    v_pk_add_f32 v[24:25], v[24:25], v[28:29]
    v_pk_add_f32 v[18:19], v[18:19], v[22:23]
    v_pk_add_f32 v[26:27], v[26:27], v[30:31]
    v_pk_add_f32 v[16:17], v[16:17], v[24:25]
    v_pk_add_f32 v[18:19], v[18:19], v[26:27]
    v_cvt_pk_bf16_f32 v20, v16, v17
    v_cvt_pk_bf16_f32 v21, v18, v19
    buffer_store_dwordx2 v[20:21], v225, s[36:39], s68 offen offset:0
    s_waitcnt lgkmcnt(10)
    v_pk_add_f32 v[32:33], v[32:33], v[36:37]
    s_waitcnt lgkmcnt(8)
    v_pk_add_f32 v[40:41], v[40:41], v[44:45]
    v_pk_add_f32 v[34:35], v[34:35], v[38:39]
    v_pk_add_f32 v[42:43], v[42:43], v[46:47]
    v_pk_add_f32 v[32:33], v[32:33], v[40:41]
    v_pk_add_f32 v[34:35], v[34:35], v[42:43]
    v_cvt_pk_bf16_f32 v36, v32, v33
    v_cvt_pk_bf16_f32 v37, v34, v35
    buffer_store_dwordx2 v[36:37], v225, s[36:39], s68 offen offset:3584
    s_waitcnt lgkmcnt(6)
    v_pk_add_f32 v[48:49], v[48:49], v[52:53]
    s_waitcnt lgkmcnt(4)
    v_pk_add_f32 v[56:57], v[56:57], v[60:61]
    v_pk_add_f32 v[50:51], v[50:51], v[54:55]
    v_pk_add_f32 v[58:59], v[58:59], v[62:63]
    v_pk_add_f32 v[48:49], v[48:49], v[56:57]
    v_pk_add_f32 v[50:51], v[50:51], v[58:59]
    v_cvt_pk_bf16_f32 v52, v48, v49
    v_cvt_pk_bf16_f32 v53, v50, v51
    buffer_store_dwordx2 v[52:53], v225, s[36:39], s69 offen offset:0
    s_waitcnt lgkmcnt(2)
    v_pk_add_f32 v[64:65], v[64:65], v[68:69]
    s_waitcnt lgkmcnt(0)
    v_pk_add_f32 v[72:73], v[72:73], v[76:77]
    v_pk_add_f32 v[66:67], v[66:67], v[70:71]
    v_pk_add_f32 v[74:75], v[74:75], v[78:79]
    v_pk_add_f32 v[64:65], v[64:65], v[72:73]
    v_pk_add_f32 v[66:67], v[66:67], v[74:75]
    v_cvt_pk_bf16_f32 v68, v64, v65
    v_cvt_pk_bf16_f32 v69, v66, v67
    buffer_store_dwordx2 v[68:69], v225, s[36:39], s69 offen offset:3584
L_end_D:
    s_endpgm

.section .rodata,"a"
.p2align 6
.amdhsa_kernel phaseA_kernel
  .amdhsa_next_free_vgpr 252
  .amdhsa_next_free_sgpr 102
  .amdhsa_accum_offset 252
  .amdhsa_group_segment_fixed_size 0
  .amdhsa_kernarg_size 88
  .amdhsa_user_sgpr_count 2
  .amdhsa_user_sgpr_kernarg_segment_ptr 1
  .amdhsa_system_sgpr_workgroup_id_x 1
.end_amdhsa_kernel
.p2align 6
.amdhsa_kernel phaseB_kernel
  .amdhsa_next_free_vgpr 380
  .amdhsa_next_free_sgpr 102
  .amdhsa_accum_offset 252
  .amdhsa_group_segment_fixed_size 0
  .amdhsa_kernarg_size 88
  .amdhsa_user_sgpr_count 2
  .amdhsa_user_sgpr_kernarg_segment_ptr 1
  .amdhsa_system_sgpr_workgroup_id_x 1
.end_amdhsa_kernel
.p2align 6
.amdhsa_kernel phaseC_kernel
  .amdhsa_next_free_vgpr 488
  .amdhsa_next_free_sgpr 102
  .amdhsa_accum_offset 232
  .amdhsa_group_segment_fixed_size 0
  .amdhsa_kernarg_size 88
  .amdhsa_user_sgpr_count 2
  .amdhsa_user_sgpr_kernarg_segment_ptr 1
  .amdhsa_system_sgpr_workgroup_id_x 1
.end_amdhsa_kernel
.p2align 6
.amdhsa_kernel phaseD_kernel
  .amdhsa_next_free_vgpr 464
  .amdhsa_next_free_sgpr 102
  .amdhsa_accum_offset 240
  .amdhsa_group_segment_fixed_size 0
  .amdhsa_kernarg_size 88
  .amdhsa_user_sgpr_count 2
  .amdhsa_user_sgpr_kernarg_segment_ptr 1
  .amdhsa_system_sgpr_workgroup_id_x 1
.end_amdhsa_kernel
```

```asm
; @launch grid=(256,1,1) block=(256,1,1) lds=163840
.amdgcn_target "amdgcn-amd-amdhsa--gfx950"
.text
.globl sequential_preLN__sliding_local_dilated__mixer_token_mlp__prompt_kernel
.p2align 8
.type sequential_preLN__sliding_local_dilated__mixer_token_mlp__prompt_kernel,@function
sequential_preLN__sliding_local_dilated__mixer_token_mlp__prompt_kernel:
    s_cmp_ge_u32 s2, 256
    s_cbranch_scc1 L_end_P
    s_load_dwordx2 s[8:9], s[0:1], 0
    s_load_dwordx2 s[12:13], s[0:1], 8
    s_load_dwordx2 s[44:45], s[0:1], 72
    s_load_dwordx2 s[40:41], s[0:1], 80
    s_load_dwordx2 s[16:17], s[0:1], 16
    s_load_dwordx2 s[20:21], s[0:1], 32
    s_load_dwordx2 s[24:25], s[0:1], 48
    s_load_dwordx2 s[28:29], s[0:1], 40
    s_load_dwordx2 s[32:33], s[0:1], 56
    s_load_dwordx2 s[36:37], s[0:1], 64
    v_lshrrev_b32 v1, 6, v0
    s_nop 0
    v_readfirstlane_b32 s3, v1
    v_and_b32 v1, 63, v0
    v_and_b32 v2, 15, v0
    v_lshrrev_b32 v3, 4, v1
    v_lshlrev_b32 v4, 4, v1
    s_mov_b32 s10, 0x1c0000
    s_mov_b32 s11, 0x00020000
    s_mov_b32 s14, 0x126000
    s_mov_b32 s15, 0x00020000
    s_mov_b32 s46, 0x100
    s_mov_b32 s47, 0x00020000
    s_mov_b32 s42, 0x900000
    s_mov_b32 s43, 0x00020000
    s_mov_b32 s18, 0x62000
    s_mov_b32 s19, 0x00020000
    s_mov_b32 s22, 0x700000
    s_mov_b32 s23, 0x00020000
    s_mov_b32 s26, 0x700000
    s_mov_b32 s27, 0x00020000
    s_mov_b32 s30, 0xe00
    s_mov_b32 s31, 0x00020000
    s_mov_b32 s34, 0x1000
    s_mov_b32 s35, 0x00020000
    s_mov_b32 s38, 0x1c0000
    s_mov_b32 s39, 0x00020000
    s_mov_b32 s5, 0x3f803f80
    s_mov_b32 s6, 0x40000
    s_and_b32 s48, s2, 7
    s_lshl_b32 s48, s48, 1
    s_lshr_b32 s53, s2, 7
    s_add_u32 s48, s48, s53
    s_lshr_b32 s49, s2, 3
    s_and_b32 s49, s49, 15
    v_lshrrev_b32 v237, 2, v1
    v_mul_u32_u24 v123, 2688, v237
    v_lshrrev_b32 v237, 5, v1
    v_lshlrev_b32 v237, 1, v237
    v_and_b32 v238, 3, v1
    v_xor_b32 v237, v237, v238
    v_lshl_add_u32 v123, v237, 4, v123
    s_mul_i32 s53, s49, 56
    s_mul_i32 s51, s3, 43008
    s_add_u32 s53, s53, s51
    v_add_u32 v123, s53, v123
    s_lshr_b32 s53, s3, 1
    s_mul_i32 s51, s53, 6144
    s_and_b32 s53, s3, 1
    s_lshl_b32 s53, s53, 10
    s_add_u32 s51, s51, s53
    v_lshrrev_b32 v237, 3, v1
    v_mul_u32_u24 v122, 896, v237
    v_and_b32 v237, 7, v1
    v_xor_b32 v237, v237, v3
    v_lshl_add_u32 v120, v237, 4, v122
    s_lshl_b32 s50, s48, 7
    s_lshl_b32 s53, s3, 5
    s_add_u32 s53, s53, s50
    s_mul_i32 s53, s53, 896
    v_xor_b32 v121, 64, v120
    v_add_u32 v120, s53, v120
    s_add_u32 s53, s53, 7168
    v_add_u32 v121, s53, v121
    s_lshl_b32 s53, s3, 1
    v_xor_b32 v237, s53, v237
    v_lshl_add_u32 v122, v237, 4, v122
    s_lshl_b32 s53, s3, 2
    s_add_u32 s53, s53, s50
    s_sub_u32 s53, s53, 16
    s_mul_i32 s53, s53, 896
    s_cmp_eq_u32 s48, 0
    s_cselect_b32 s53, 0x40000000, s53
    v_add_u32 v122, s53, v122
    s_lshl_b32 s52, s3, 12
    s_add_u32 s52, s52, 63488
    s_lshl_b32 s78, s3, 9
    s_cmp_eq_u32 s3, 0
    s_cselect_b32 s54, 0xffffff00, -1
    s_mov_b32 s55, 0
    s_memrealtime s[86:87]
    v_mov_b32 v7, 0
    s_waitcnt lgkmcnt(0)
    s_or_b32 s86, s86, 1
    v_mov_b32 v6, s86
    s_or_b32 s86, s2, s3
    s_cmp_eq_u32 s86, 0
    s_cselect_b64 exec, 1, 0
    buffer_store_dword v6, v7, s[44:47], 0 offen sc1
    s_mov_b64 exec, -1
    s_add_u32 m0, s51, 12288
    s_mov_b32 s53, 0
    buffer_load_dwordx4 v123, s[12:15], s53 offen lds
    s_add_u32 m0, s51, 14336
    s_mov_b32 s53, 896
    buffer_load_dwordx4 v123, s[12:15], s53 offen lds
    s_add_u32 m0, s51, 16384
    s_mov_b32 s53, 1792
    buffer_load_dwordx4 v123, s[12:15], s53 offen lds
    s_add_u32 m0, s52, 36864
    s_mov_b32 s53, 0
    buffer_load_dwordx4 v120, s[8:11], s53 offen lds
    s_add_u32 m0, s52, 37888
    s_mov_b32 s53, 0
    buffer_load_dwordx4 v121, s[8:11], s53 offen lds
    s_add_u32 m0, s52, 38912
    s_mov_b32 s53, 14336
    buffer_load_dwordx4 v120, s[8:11], s53 offen lds
    s_add_u32 m0, s52, 39936
    s_mov_b32 s53, 14336
    buffer_load_dwordx4 v121, s[8:11], s53 offen lds
    s_add_u32 m0, s78, 98304
    s_mov_b32 s53, 0
    s_mov_b64 exec, s[54:55]
    buffer_load_dwordx4 v122, s[8:11], s53 offen lds
    s_mov_b64 exec, -1
    s_add_u32 m0, s51, 24576
    s_mov_b32 s53, 172032
    buffer_load_dwordx4 v123, s[12:15], s53 offen lds
    s_add_u32 m0, s51, 26624
    s_mov_b32 s53, 172928
    buffer_load_dwordx4 v123, s[12:15], s53 offen lds
    s_add_u32 m0, s51, 28672
    s_mov_b32 s53, 173824
    buffer_load_dwordx4 v123, s[12:15], s53 offen lds
    s_add_u32 m0, s52, 18432
    s_mov_b32 s53, 128
    buffer_load_dwordx4 v120, s[8:11], s53 offen lds
    s_add_u32 m0, s52, 19456
    s_mov_b32 s53, 128
    buffer_load_dwordx4 v121, s[8:11], s53 offen lds
    s_add_u32 m0, s52, 20480
    s_mov_b32 s53, 14464
    buffer_load_dwordx4 v120, s[8:11], s53 offen lds
    s_add_u32 m0, s52, 21504
    s_mov_b32 s53, 14464
    buffer_load_dwordx4 v121, s[8:11], s53 offen lds
    s_add_u32 m0, s78, 79872
    s_mov_b32 s53, 128
    s_mov_b64 exec, s[54:55]
    buffer_load_dwordx4 v122, s[8:11], s53 offen lds
    s_mov_b64 exec, -1
    v_mul_u32_u24 v237, 18432, v3
    v_lshl_add_u32 v237, v2, 3, v237
    v_mov_b32 v238, s5
    v_add_u32 v237, 61440, v237
    ds_write2_b32 v237, v238, v238 offset0:0 offset1:1
    s_lshr_b32 s68, s2, 3
    s_mul_i32 s69, s68, 37
    s_lshr_b32 s69, s69, 8
    s_mul_i32 s64, s69, 7
    s_sub_u32 s64, s68, s64
    s_mov_b32 s66, s64
    s_and_b32 s68, s2, 7
    s_lshl_b32 s67, s68, 2
    s_add_u32 s67, s67, s69
    s_cmp_ge_u32 s69, 4
    s_cselect_b32 s67, 99, s67
    s_mul_i32 s71, s68, 3
    s_add_u32 s71, s71, 4
    s_lshl_b32 s72, s68, 2
    s_cmp_lt_u32 s68, 4
    s_cselect_b32 s65, s72, s71
    s_cselect_b32 s71, 4, 3
    s_add_u32 s65, s65, s69
    s_cmp_ge_u32 s69, s71
    s_cselect_b32 s65, 99, s65
    s_and_b32 s56, s2, 7
    s_lshl_b32 s56, s56, 3
    s_lshr_b32 s58, s2, 5
    s_add_u32 s56, s56, s58
    s_lshr_b32 s57, s2, 3
    s_and_b32 s57, s57, 3
    v_lshrrev_b32 v209, 2, v1
    v_mul_u32_u24 v208, 896, v209
    v_and_b32 v209, 1, v3
    v_lshlrev_b32 v209, 1, v209
    v_and_b32 v210, 3, v1
    v_xor_b32 v209, v209, v210
    v_lshl_add_u32 v208, v209, 4, v208
    s_mul_i32 s58, s57, 224
    s_lshl_b32 s60, s3, 6
    s_add_u32 s58, s58, s60
    v_add_u32 v208, s58, v208
    s_mul_i32 s59, s3, 7168
    v_bfe_u32 v219, v1, 2, 2
    v_lshlrev_b32 v219, 6, v219
    v_and_b32 v220, 3, v1
    v_lshl_add_u32 v219, v220, 3, v219
    v_add_u32 v219, s59, v219
    v_and_b32 v220, 1, v3
    v_lshlrev_b32 v220, 5, v220
    v_add_u32 v219, v219, v220
    v_lshl_add_u32 v209, v3, 8, v219
    v_xor_b32 v210, 32, v209
    v_cmp_eq_u32 vcc, 3, v3
    s_nop 1
    v_cndmask_b32 v220, v3, 1, vcc
    v_lshl_add_u32 v211, v220, 8, v219
    v_add_u32 v211, 1024, v211
    v_xor_b32 v212, 32, v211
    s_mul_i32 s70, s3, 24576
    s_add_u32 s70, s70, 65536
    v_lshrrev_b32 v219, 3, v1
    v_mul_u32_u24 v213, 3584, v219
    v_and_b32 v219, 1, v3
    v_lshlrev_b32 v219, 2, v219
    v_and_b32 v220, 7, v1
    v_xor_b32 v219, v219, v220
    v_lshl_add_u32 v213, v219, 4, v213
    s_mul_i32 s68, s3, 1835008
    s_lshl_b32 s69, s65, 7
    s_add_u32 s68, s68, s69
    s_cmp_ge_u32 s65, 99
    s_cselect_b32 s68, 0x40000000, s68
    v_add_u32 v213, s68, v213
    s_cselect_b32 s68, 0x40000000, 0
    v_add_u32 v5, s68, v4
    v_lshrrev_b32 v219, 5, v1
    v_lshlrev_b32 v215, 10, v219
    v_bfe_u32 v219, v1, 2, 2
    v_lshl_add_u32 v215, v219, 7, v215
    v_lshrrev_b32 v219, 1, v219
    s_lshr_b32 s68, s3, 1
    v_xor_b32 v219, s68, v219
    v_lshl_add_u32 v215, v219, 6, v215
    v_and_b32 v219, 1, v3
    v_lshl_add_u32 v215, v219, 5, v215
    v_and_b32 v219, 3, v1
    v_lshl_add_u32 v215, v219, 3, v215
    v_add_u32 v215, s70, v215
    v_xor_b32 v216, 64, v215
    s_mul_i32 s70, s3, 24576
    s_add_u32 s70, s70, 65536
    v_lshrrev_b32 v219, 3, v1
    v_mul_u32_u24 v214, 4096, v219
    v_and_b32 v219, 1, v3
    v_lshlrev_b32 v219, 2, v219
    v_and_b32 v220, 7, v1
    v_xor_b32 v219, v219, v220
    v_lshl_add_u32 v214, v219, 4, v214
    s_mul_i32 s68, s3, 1835008
    s_lshl_b32 s69, s67, 7
    s_add_u32 s68, s68, s69
    s_cmp_ge_u32 s67, 99
    s_cselect_b32 s68, 0x40000000, s68
    v_add_u32 v214, s68, v214
    v_lshrrev_b32 v219, 5, v1
    v_lshlrev_b32 v217, 9, v219
    v_bfe_u32 v219, v1, 2, 2
    v_lshl_add_u32 v217, v219, 7, v217
    v_lshrrev_b32 v219, 1, v219
    s_lshr_b32 s68, s3, 1
    v_xor_b32 v219, s68, v219
    v_lshl_add_u32 v217, v219, 6, v217
    v_and_b32 v219, 1, v3
    v_lshl_add_u32 v217, v219, 5, v217
    v_and_b32 v219, 3, v1
    v_lshl_add_u32 v217, v219, 3, v217
    v_add_u32 v217, s70, v217
    v_xor_b32 v218, 64, v217
    s_lshl_b32 s80, s48, 2
    s_add_u32 s80, s80, s3
    s_lshl_b32 s80, s80, 4
    s_add_u32 s80, s80, s49
    s_lshl_b32 s80, s80, 2
    s_add_u32 s80, s80, 0x840000
    s_lshl_b32 s83, s56, 6
    s_and_b32 s79, s3, 1
    s_lshl_b32 s79, s79, 5
    s_add_u32 s83, s83, s79
    s_add_u32 s83, s83, 0x840000
    v_and_b32 v10, 7, v1
    v_lshlrev_b32 v10, 2, v10
    s_lshl_b32 s81, s57, 2
    s_add_u32 s81, s81, s3
    s_lshl_b32 s81, s81, 6
    s_add_u32 s81, s81, s56
    s_lshl_b32 s81, s81, 2
    s_add_u32 s81, s81, 0x841000
    s_lshl_b32 s84, s64, 1
    s_cmp_ge_u32 s64, 4
    s_addc_u32 s84, s84, 0
    s_lshl_b32 s84, s84, 8
    s_lshl_b32 s79, s3, 6
    s_add_u32 s84, s84, s79
    s_add_u32 s84, s84, 0x841000
    v_min_u32 v11, 2, v3
    v_lshlrev_b32 v11, 8, v11
    v_lshl_add_u32 v11, v2, 2, v11
    s_lshl_b32 s85, s64, 9
    s_add_u32 s85, s85, 0x842000
    s_lshl_b32 s82, s65, 2
    s_add_u32 s82, s82, s3
    s_lshl_b32 s82, s82, 2
    s_add_u32 s82, s82, s85
    s_mul_i32 s79, s3, 112
    s_add_u32 s85, s85, s79
    v_min_u32 v12, 27, v1
    v_lshlrev_b32 v12, 2, v12
    v_mov_b32 v9, 0
    v_lshlrev_b32 v124, 9, v3
    v_bfe_u32 v237, v1, 2, 2
    v_lshl_add_u32 v124, v237, 6, v124
    v_and_b32 v237, 3, v1
    v_lshl_add_u32 v124, v237, 3, v124
    v_and_b32 v237, 1, v3
    v_lshlrev_b32 v237, 5, v237
    v_add_u32 v124, v124, v237
    v_add_u32 v124, 12288, v124
    v_xor_b32 v125, 32, v124
    s_and_b32 s53, s3, 1
    s_lshl_b32 s53, s53, 5
    v_xor_b32 v127, s53, v124
    s_lshr_b32 s53, s3, 1
    s_lshl_b32 s53, s53, 11
    s_add_u32 s53, s53, 2048
    v_add_u32 v126, s53, v127
    v_lshrrev_b32 v237, 1, v2
    v_xor_b32 v237, v237, v3
    v_lshlrev_b32 v237, 4, v237
    v_lshl_add_u32 v237, v2, 7, v237
    v_add_u32 v130, 61440, v237
    v_xor_b32 v131, 64, v130
    v_add_u32 v128, s52, v237
    v_xor_b32 v129, 64, v128
    v_lshlrev_b32 v237, 2, v3
    v_sub_u32 v237, v2, v237
    v_mov_b32 v239, 0xf149f2ca
    v_add_u32 v238, 16, v237
    v_and_b32 v238, 0xfffffff1, v238
    v_cmp_eq_u32 vcc, 0, v238
    s_nop 1
    v_cndmask_b32 v240, v239, 0, vcc
    v_add_u32 v238, 15, v237
    v_and_b32 v238, 0xfffffff1, v238
    v_cmp_eq_u32 vcc, 0, v238
    s_nop 1
    v_cndmask_b32 v241, v239, 0, vcc
    v_add_u32 v238, 14, v237
    v_and_b32 v238, 0xfffffff1, v238
    v_cmp_eq_u32 vcc, 0, v238
    s_nop 1
    v_cndmask_b32 v242, v239, 0, vcc
    v_add_u32 v238, 13, v237
    v_and_b32 v238, 0xfffffff1, v238
    v_cmp_eq_u32 vcc, 0, v238
    s_nop 1
    v_cndmask_b32 v243, v239, 0, vcc
    v_add_u32 v238, 0, v237
    v_and_b32 v238, 0xfffffff1, v238
    v_cmp_eq_u32 vcc, 0, v238
    s_nop 1
    v_cndmask_b32 v244, v239, 0, vcc
    v_add_u32 v238, -1, v237
    v_and_b32 v238, 0xfffffff1, v238
    v_cmp_eq_u32 vcc, 0, v238
    s_nop 1
    v_cndmask_b32 v245, v239, 0, vcc
    v_add_u32 v238, -2, v237
    v_and_b32 v238, 0xfffffff1, v238
    v_cmp_eq_u32 vcc, 0, v238
    s_nop 1
    v_cndmask_b32 v246, v239, 0, vcc
    v_add_u32 v238, -3, v237
    v_and_b32 v238, 0xfffffff1, v238
    v_cmp_eq_u32 vcc, 0, v238
    s_nop 1
    v_cndmask_b32 v247, v239, 0, vcc
    s_or_b32 s53, s48, s3
    s_cmp_eq_u32 s53, 0
    s_cselect_b64 vcc, -1, 0
    v_cndmask_b32 v248, v240, v239, vcc
    v_cndmask_b32 v249, v241, v239, vcc
    v_cndmask_b32 v250, v242, v239, vcc
    v_cndmask_b32 v251, v243, v239, vcc
    v_mov_b32 v224, 0
    v_mov_b32 v225, 0
    v_mov_b32 v226, 0
    v_mov_b32 v227, 0
    v_mov_b32 v228, 0
    v_mov_b32 v229, 0
    s_waitcnt vmcnt(8)
    s_waitcnt lgkmcnt(0)
    s_barrier
    ds_read_b128 v[16:19], v128 offset:36864
    ds_read_b128 v[20:23], v128 offset:38912
    ds_read_b128 v[24:27], v130 offset:36864
    ds_read_b64_tr_b16 v[88:89], v124 offset:0
    ds_read_b64_tr_b16 v[90:91], v124 offset:256
    ds_read_b64_tr_b16 v[92:93], v125 offset:0
    ds_read_b64_tr_b16 v[94:95], v125 offset:256
    ds_read_b64_tr_b16 v[96:97], v124 offset:2048
    ds_read_b64_tr_b16 v[98:99], v124 offset:2304
    ds_read_b64_tr_b16 v[100:101], v125 offset:2048
    ds_read_b64_tr_b16 v[102:103], v125 offset:2304
    ds_read_b64_tr_b16 v[104:105], v124 offset:4096
    ds_read_b64_tr_b16 v[106:107], v124 offset:4352
    ds_read_b64_tr_b16 v[108:109], v125 offset:4096
    ds_read_b64_tr_b16 v[110:111], v125 offset:4352
    ds_read_b64_tr_b16 v[112:113], v126 offset:0
    ds_read_b64_tr_b16 v[114:115], v126 offset:256
    ds_read_b64_tr_b16 v[116:117], v127 offset:0
    ds_read_b64_tr_b16 v[118:119], v127 offset:256
    s_add_u32 m0, s51, 36864
    s_mov_b32 s53, 344064
    buffer_load_dwordx4 v123, s[12:15], s53 offen lds
    s_add_u32 m0, s51, 38912
    s_mov_b32 s53, 344960
    buffer_load_dwordx4 v123, s[12:15], s53 offen lds
    s_add_u32 m0, s51, 40960
    s_mov_b32 s53, 345856
    buffer_load_dwordx4 v123, s[12:15], s53 offen lds
    s_add_u32 m0, s52, 0
    s_mov_b32 s53, 256
    buffer_load_dwordx4 v120, s[8:11], s53 offen lds
    s_add_u32 m0, s52, 1024
    s_mov_b32 s53, 256
    buffer_load_dwordx4 v121, s[8:11], s53 offen lds
    s_add_u32 m0, s52, 2048
    s_mov_b32 s53, 14592
    buffer_load_dwordx4 v120, s[8:11], s53 offen lds
    s_add_u32 m0, s52, 3072
    s_mov_b32 s53, 14592
    buffer_load_dwordx4 v121, s[8:11], s53 offen lds
    s_add_u32 m0, s78, 61440
    s_mov_b32 s53, 256
    s_mov_b64 exec, s[54:55]
    buffer_load_dwordx4 v122, s[8:11], s53 offen lds
    s_mov_b64 exec, -1
    s_waitcnt lgkmcnt(15)
    v_dot2c_f32_bf16 v224, s5, v16
    v_dot2c_f32_bf16 v225, v16, v16
    v_dot2c_f32_bf16 v226, s5, v20
    v_dot2c_f32_bf16 v227, v20, v20
    v_dot2c_f32_bf16 v228, s5, v24
    v_dot2c_f32_bf16 v229, v24, v24
    v_dot2c_f32_bf16 v224, s5, v17
    v_dot2c_f32_bf16 v225, v17, v17
    v_dot2c_f32_bf16 v226, s5, v21
    v_dot2c_f32_bf16 v227, v21, v21
    v_dot2c_f32_bf16 v228, s5, v25
    v_dot2c_f32_bf16 v229, v25, v25
    v_dot2c_f32_bf16 v224, s5, v18
    v_dot2c_f32_bf16 v225, v18, v18
    v_dot2c_f32_bf16 v226, s5, v22
    v_dot2c_f32_bf16 v227, v22, v22
    v_dot2c_f32_bf16 v228, s5, v26
    v_dot2c_f32_bf16 v229, v26, v26
    v_dot2c_f32_bf16 v224, s5, v19
    v_dot2c_f32_bf16 v225, v19, v19
    v_dot2c_f32_bf16 v226, s5, v23
    v_dot2c_f32_bf16 v227, v23, v23
    v_dot2c_f32_bf16 v228, s5, v27
    v_dot2c_f32_bf16 v229, v27, v27
    ds_read_b128 v[28:31], v129 offset:36864
    ds_read_b128 v[32:35], v129 offset:38912
    ds_read_b128 v[36:39], v131 offset:36864
    s_waitcnt lgkmcnt(15)
    v_mfma_f32_16x16x32_bf16 v[136:139], v[88:91], v[16:19], 0
    v_mfma_f32_16x16x32_bf16 v[160:163], v[88:91], v[20:23], 0
    ds_read_b64_tr_b16 v[88:89], v124 offset:6144
    ds_read_b64_tr_b16 v[90:91], v124 offset:6400
    v_mfma_f32_16x16x32_bf16 v[140:143], v[92:95], v[16:19], 0
    v_mfma_f32_16x16x32_bf16 v[164:167], v[92:95], v[20:23], 0
    ds_read_b64_tr_b16 v[92:93], v125 offset:6144
    ds_read_b64_tr_b16 v[94:95], v125 offset:6400
    s_waitcnt lgkmcnt(15)
    v_mfma_f32_16x16x32_bf16 v[144:147], v[96:99], v[16:19], 0
    v_mfma_f32_16x16x32_bf16 v[168:171], v[96:99], v[20:23], 0
    ds_read_b64_tr_b16 v[96:97], v124 offset:8192
    ds_read_b64_tr_b16 v[98:99], v124 offset:8448
    v_mfma_f32_16x16x32_bf16 v[148:151], v[100:103], v[16:19], 0
    v_mfma_f32_16x16x32_bf16 v[172:175], v[100:103], v[20:23], 0
    ds_read_b64_tr_b16 v[100:101], v125 offset:8192
    ds_read_b64_tr_b16 v[102:103], v125 offset:8448
    s_waitcnt lgkmcnt(15)
    v_mfma_f32_16x16x32_bf16 v[152:155], v[16:19], v[104:107], 0
    v_mfma_f32_16x16x32_bf16 v[176:179], v[20:23], v[104:107], 0
    ds_read_b64_tr_b16 v[104:105], v124 offset:10240
    ds_read_b64_tr_b16 v[106:107], v124 offset:10496
    v_mfma_f32_16x16x32_bf16 v[156:159], v[16:19], v[108:111], 0
    v_mfma_f32_16x16x32_bf16 v[180:183], v[20:23], v[108:111], 0
    ds_read_b64_tr_b16 v[108:109], v125 offset:10240
    ds_read_b64_tr_b16 v[110:111], v125 offset:10496
    s_waitcnt lgkmcnt(15)
    v_mfma_f32_16x16x32_bf16 v[184:187], v[112:115], v[24:27], 0
    ds_read_b64_tr_b16 v[112:113], v126 offset:6144
    ds_read_b64_tr_b16 v[114:115], v126 offset:6400
    v_mfma_f32_16x16x32_bf16 v[188:191], v[116:119], v[24:27], 0
    ds_read_b64_tr_b16 v[116:117], v127 offset:6144
    ds_read_b64_tr_b16 v[118:119], v127 offset:6400
    s_waitcnt vmcnt(8)
    s_barrier
    s_add_u32 m0, s51, 49152
    s_mov_b32 s53, 516096
    buffer_load_dwordx4 v123, s[12:15], s53 offen lds
    s_add_u32 m0, s51, 51200
    s_mov_b32 s53, 516992
    buffer_load_dwordx4 v123, s[12:15], s53 offen lds
    s_add_u32 m0, s51, 53248
    s_mov_b32 s53, 517888
    buffer_load_dwordx4 v123, s[12:15], s53 offen lds
    s_add_u32 m0, s52, 55296
    s_mov_b32 s53, 384
    buffer_load_dwordx4 v120, s[8:11], s53 offen lds
    s_add_u32 m0, s52, 56320
    s_mov_b32 s53, 384
    buffer_load_dwordx4 v121, s[8:11], s53 offen lds
    s_add_u32 m0, s52, 57344
    s_mov_b32 s53, 14720
    buffer_load_dwordx4 v120, s[8:11], s53 offen lds
    s_add_u32 m0, s52, 58368
    s_mov_b32 s53, 14720
    buffer_load_dwordx4 v121, s[8:11], s53 offen lds
    s_add_u32 m0, s78, 116736
    s_mov_b32 s53, 384
    s_mov_b64 exec, s[54:55]
    buffer_load_dwordx4 v122, s[8:11], s53 offen lds
    s_mov_b64 exec, -1
    s_waitcnt lgkmcnt(15)
    v_dot2c_f32_bf16 v224, s5, v28
    v_dot2c_f32_bf16 v225, v28, v28
    v_dot2c_f32_bf16 v226, s5, v32
    v_dot2c_f32_bf16 v227, v32, v32
    v_dot2c_f32_bf16 v228, s5, v36
    v_dot2c_f32_bf16 v229, v36, v36
    v_dot2c_f32_bf16 v224, s5, v29
    v_dot2c_f32_bf16 v225, v29, v29
    v_dot2c_f32_bf16 v226, s5, v33
    v_dot2c_f32_bf16 v227, v33, v33
    v_dot2c_f32_bf16 v228, s5, v37
    v_dot2c_f32_bf16 v229, v37, v37
    v_dot2c_f32_bf16 v224, s5, v30
    v_dot2c_f32_bf16 v225, v30, v30
    v_dot2c_f32_bf16 v226, s5, v34
    v_dot2c_f32_bf16 v227, v34, v34
    v_dot2c_f32_bf16 v228, s5, v38
    v_dot2c_f32_bf16 v229, v38, v38
    v_dot2c_f32_bf16 v224, s5, v31
    v_dot2c_f32_bf16 v225, v31, v31
    v_dot2c_f32_bf16 v226, s5, v35
    v_dot2c_f32_bf16 v227, v35, v35
    v_dot2c_f32_bf16 v228, s5, v39
    v_dot2c_f32_bf16 v229, v39, v39
    ds_read_b128 v[16:19], v128 offset:18432
    ds_read_b128 v[20:23], v128 offset:20480
    ds_read_b128 v[24:27], v130 offset:18432
    s_waitcnt lgkmcnt(15)
    v_mfma_f32_16x16x32_bf16 v[136:139], v[88:91], v[28:31], v[136:139]
    v_mfma_f32_16x16x32_bf16 v[160:163], v[88:91], v[32:35], v[160:163]
    ds_read_b64_tr_b16 v[88:89], v124 offset:12288
    ds_read_b64_tr_b16 v[90:91], v124 offset:12544
    v_mfma_f32_16x16x32_bf16 v[140:143], v[92:95], v[28:31], v[140:143]
    v_mfma_f32_16x16x32_bf16 v[164:167], v[92:95], v[32:35], v[164:167]
    ds_read_b64_tr_b16 v[92:93], v125 offset:12288
    ds_read_b64_tr_b16 v[94:95], v125 offset:12544
    s_waitcnt lgkmcnt(15)
    v_mfma_f32_16x16x32_bf16 v[144:147], v[96:99], v[28:31], v[144:147]
    v_mfma_f32_16x16x32_bf16 v[168:171], v[96:99], v[32:35], v[168:171]
    ds_read_b64_tr_b16 v[96:97], v124 offset:14336
    ds_read_b64_tr_b16 v[98:99], v124 offset:14592
    v_mfma_f32_16x16x32_bf16 v[148:151], v[100:103], v[28:31], v[148:151]
    v_mfma_f32_16x16x32_bf16 v[172:175], v[100:103], v[32:35], v[172:175]
    ds_read_b64_tr_b16 v[100:101], v125 offset:14336
    ds_read_b64_tr_b16 v[102:103], v125 offset:14592
    s_waitcnt lgkmcnt(15)
    v_mfma_f32_16x16x32_bf16 v[152:155], v[28:31], v[104:107], v[152:155]
    v_mfma_f32_16x16x32_bf16 v[176:179], v[32:35], v[104:107], v[176:179]
    ds_read_b64_tr_b16 v[104:105], v124 offset:16384
    ds_read_b64_tr_b16 v[106:107], v124 offset:16640
    v_mfma_f32_16x16x32_bf16 v[156:159], v[28:31], v[108:111], v[156:159]
    v_mfma_f32_16x16x32_bf16 v[180:183], v[32:35], v[108:111], v[180:183]
    ds_read_b64_tr_b16 v[108:109], v125 offset:16384
    ds_read_b64_tr_b16 v[110:111], v125 offset:16640
    s_waitcnt lgkmcnt(15)
    v_mfma_f32_16x16x32_bf16 v[184:187], v[112:115], v[36:39], v[184:187]
    ds_read_b64_tr_b16 v[112:113], v126 offset:12288
    ds_read_b64_tr_b16 v[114:115], v126 offset:12544
    v_mfma_f32_16x16x32_bf16 v[188:191], v[116:119], v[36:39], v[188:191]
    ds_read_b64_tr_b16 v[116:117], v127 offset:12288
    ds_read_b64_tr_b16 v[118:119], v127 offset:12544
    s_waitcnt lgkmcnt(15)
    v_dot2c_f32_bf16 v224, s5, v16
    v_dot2c_f32_bf16 v225, v16, v16
    v_dot2c_f32_bf16 v226, s5, v20
    v_dot2c_f32_bf16 v227, v20, v20
    v_dot2c_f32_bf16 v228, s5, v24
    v_dot2c_f32_bf16 v229, v24, v24
    v_dot2c_f32_bf16 v224, s5, v17
    v_dot2c_f32_bf16 v225, v17, v17
    v_dot2c_f32_bf16 v226, s5, v21
    v_dot2c_f32_bf16 v227, v21, v21
    v_dot2c_f32_bf16 v228, s5, v25
    v_dot2c_f32_bf16 v229, v25, v25
    v_dot2c_f32_bf16 v224, s5, v18
    v_dot2c_f32_bf16 v225, v18, v18
    v_dot2c_f32_bf16 v226, s5, v22
    v_dot2c_f32_bf16 v227, v22, v22
    v_dot2c_f32_bf16 v228, s5, v26
    v_dot2c_f32_bf16 v229, v26, v26
    v_dot2c_f32_bf16 v224, s5, v19
    v_dot2c_f32_bf16 v225, v19, v19
    v_dot2c_f32_bf16 v226, s5, v23
    v_dot2c_f32_bf16 v227, v23, v23
    v_dot2c_f32_bf16 v228, s5, v27
    v_dot2c_f32_bf16 v229, v27, v27
    ds_read_b128 v[28:31], v129 offset:18432
    ds_read_b128 v[32:35], v129 offset:20480
    ds_read_b128 v[36:39], v131 offset:18432
    s_waitcnt lgkmcnt(15)
    v_mfma_f32_16x16x32_bf16 v[136:139], v[88:91], v[16:19], v[136:139]
    v_mfma_f32_16x16x32_bf16 v[160:163], v[88:91], v[20:23], v[160:163]
    ds_read_b64_tr_b16 v[88:89], v124 offset:18432
    ds_read_b64_tr_b16 v[90:91], v124 offset:18688
    v_mfma_f32_16x16x32_bf16 v[140:143], v[92:95], v[16:19], v[140:143]
    v_mfma_f32_16x16x32_bf16 v[164:167], v[92:95], v[20:23], v[164:167]
    ds_read_b64_tr_b16 v[92:93], v125 offset:18432
    ds_read_b64_tr_b16 v[94:95], v125 offset:18688
    s_waitcnt lgkmcnt(15)
    v_mfma_f32_16x16x32_bf16 v[144:147], v[96:99], v[16:19], v[144:147]
    v_mfma_f32_16x16x32_bf16 v[168:171], v[96:99], v[20:23], v[168:171]
    ds_read_b64_tr_b16 v[96:97], v124 offset:20480
    ds_read_b64_tr_b16 v[98:99], v124 offset:20736
    v_mfma_f32_16x16x32_bf16 v[148:151], v[100:103], v[16:19], v[148:151]
    v_mfma_f32_16x16x32_bf16 v[172:175], v[100:103], v[20:23], v[172:175]
    ds_read_b64_tr_b16 v[100:101], v125 offset:20480
    ds_read_b64_tr_b16 v[102:103], v125 offset:20736
    s_waitcnt lgkmcnt(15)
    v_mfma_f32_16x16x32_bf16 v[152:155], v[16:19], v[104:107], v[152:155]
    v_mfma_f32_16x16x32_bf16 v[176:179], v[20:23], v[104:107], v[176:179]
    ds_read_b64_tr_b16 v[104:105], v124 offset:22528
    ds_read_b64_tr_b16 v[106:107], v124 offset:22784
    v_mfma_f32_16x16x32_bf16 v[156:159], v[16:19], v[108:111], v[156:159]
    v_mfma_f32_16x16x32_bf16 v[180:183], v[20:23], v[108:111], v[180:183]
    ds_read_b64_tr_b16 v[108:109], v125 offset:22528
    ds_read_b64_tr_b16 v[110:111], v125 offset:22784
    s_waitcnt lgkmcnt(15)
    v_mfma_f32_16x16x32_bf16 v[184:187], v[112:115], v[24:27], v[184:187]
    ds_read_b64_tr_b16 v[112:113], v126 offset:18432
    ds_read_b64_tr_b16 v[114:115], v126 offset:18688
    v_mfma_f32_16x16x32_bf16 v[188:191], v[116:119], v[24:27], v[188:191]
    ds_read_b64_tr_b16 v[116:117], v127 offset:18432
    ds_read_b64_tr_b16 v[118:119], v127 offset:18688
    s_waitcnt vmcnt(8)
    s_barrier
    s_add_u32 m0, s51, 12288
    s_mov_b32 s53, 688128
    buffer_load_dwordx4 v123, s[12:15], s53 offen lds
    s_add_u32 m0, s51, 14336
    s_mov_b32 s53, 689024
    buffer_load_dwordx4 v123, s[12:15], s53 offen lds
    s_add_u32 m0, s51, 16384
    s_mov_b32 s53, 689920
    buffer_load_dwordx4 v123, s[12:15], s53 offen lds
    s_add_u32 m0, s52, 36864
    s_mov_b32 s53, 512
    buffer_load_dwordx4 v120, s[8:11], s53 offen lds
    s_add_u32 m0, s52, 37888
    s_mov_b32 s53, 512
    buffer_load_dwordx4 v121, s[8:11], s53 offen lds
    s_add_u32 m0, s52, 38912
    s_mov_b32 s53, 14848
    buffer_load_dwordx4 v120, s[8:11], s53 offen lds
    s_add_u32 m0, s52, 39936
    s_mov_b32 s53, 14848
    buffer_load_dwordx4 v121, s[8:11], s53 offen lds
    s_add_u32 m0, s78, 98304
    s_mov_b32 s53, 512
    s_mov_b64 exec, s[54:55]
    buffer_load_dwordx4 v122, s[8:11], s53 offen lds
    s_mov_b64 exec, -1
    s_waitcnt lgkmcnt(15)
    v_dot2c_f32_bf16 v224, s5, v28
    v_dot2c_f32_bf16 v225, v28, v28
    v_dot2c_f32_bf16 v226, s5, v32
    v_dot2c_f32_bf16 v227, v32, v32
    v_dot2c_f32_bf16 v228, s5, v36
    v_dot2c_f32_bf16 v229, v36, v36
    v_dot2c_f32_bf16 v224, s5, v29
    v_dot2c_f32_bf16 v225, v29, v29
    v_dot2c_f32_bf16 v226, s5, v33
    v_dot2c_f32_bf16 v227, v33, v33
    v_dot2c_f32_bf16 v228, s5, v37
    v_dot2c_f32_bf16 v229, v37, v37
    v_dot2c_f32_bf16 v224, s5, v30
    v_dot2c_f32_bf16 v225, v30, v30
    v_dot2c_f32_bf16 v226, s5, v34
    v_dot2c_f32_bf16 v227, v34, v34
    v_dot2c_f32_bf16 v228, s5, v38
    v_dot2c_f32_bf16 v229, v38, v38
    v_dot2c_f32_bf16 v224, s5, v31
    v_dot2c_f32_bf16 v225, v31, v31
    v_dot2c_f32_bf16 v226, s5, v35
    v_dot2c_f32_bf16 v227, v35, v35
    v_dot2c_f32_bf16 v228, s5, v39
    v_dot2c_f32_bf16 v229, v39, v39
    ds_read_b128 v[16:19], v128 offset:0
    ds_read_b128 v[20:23], v128 offset:2048
    ds_read_b128 v[24:27], v130 offset:0
    s_waitcnt lgkmcnt(15)
    v_mfma_f32_16x16x32_bf16 v[136:139], v[88:91], v[28:31], v[136:139]
    v_mfma_f32_16x16x32_bf16 v[160:163], v[88:91], v[32:35], v[160:163]
    ds_read_b64_tr_b16 v[88:89], v124 offset:24576
    ds_read_b64_tr_b16 v[90:91], v124 offset:24832
    v_mfma_f32_16x16x32_bf16 v[140:143], v[92:95], v[28:31], v[140:143]
    v_mfma_f32_16x16x32_bf16 v[164:167], v[92:95], v[32:35], v[164:167]
    ds_read_b64_tr_b16 v[92:93], v125 offset:24576
    ds_read_b64_tr_b16 v[94:95], v125 offset:24832
    s_waitcnt lgkmcnt(15)
    v_mfma_f32_16x16x32_bf16 v[144:147], v[96:99], v[28:31], v[144:147]
    v_mfma_f32_16x16x32_bf16 v[168:171], v[96:99], v[32:35], v[168:171]
    ds_read_b64_tr_b16 v[96:97], v124 offset:26624
    ds_read_b64_tr_b16 v[98:99], v124 offset:26880
    v_mfma_f32_16x16x32_bf16 v[148:151], v[100:103], v[28:31], v[148:151]
    v_mfma_f32_16x16x32_bf16 v[172:175], v[100:103], v[32:35], v[172:175]
    ds_read_b64_tr_b16 v[100:101], v125 offset:26624
    ds_read_b64_tr_b16 v[102:103], v125 offset:26880
    s_waitcnt lgkmcnt(15)
    v_mfma_f32_16x16x32_bf16 v[152:155], v[28:31], v[104:107], v[152:155]
    v_mfma_f32_16x16x32_bf16 v[176:179], v[32:35], v[104:107], v[176:179]
    ds_read_b64_tr_b16 v[104:105], v124 offset:28672
    ds_read_b64_tr_b16 v[106:107], v124 offset:28928
    v_mfma_f32_16x16x32_bf16 v[156:159], v[28:31], v[108:111], v[156:159]
    v_mfma_f32_16x16x32_bf16 v[180:183], v[32:35], v[108:111], v[180:183]
    ds_read_b64_tr_b16 v[108:109], v125 offset:28672
    ds_read_b64_tr_b16 v[110:111], v125 offset:28928
    s_waitcnt lgkmcnt(15)
    v_mfma_f32_16x16x32_bf16 v[184:187], v[112:115], v[36:39], v[184:187]
    ds_read_b64_tr_b16 v[112:113], v126 offset:24576
    ds_read_b64_tr_b16 v[114:115], v126 offset:24832
    v_mfma_f32_16x16x32_bf16 v[188:191], v[116:119], v[36:39], v[188:191]
    ds_read_b64_tr_b16 v[116:117], v127 offset:24576
    ds_read_b64_tr_b16 v[118:119], v127 offset:24832
    s_waitcnt lgkmcnt(15)
    v_dot2c_f32_bf16 v224, s5, v16
    v_dot2c_f32_bf16 v225, v16, v16
    v_dot2c_f32_bf16 v226, s5, v20
    v_dot2c_f32_bf16 v227, v20, v20
    v_dot2c_f32_bf16 v228, s5, v24
    v_dot2c_f32_bf16 v229, v24, v24
    v_dot2c_f32_bf16 v224, s5, v17
    v_dot2c_f32_bf16 v225, v17, v17
    v_dot2c_f32_bf16 v226, s5, v21
    v_dot2c_f32_bf16 v227, v21, v21
    v_dot2c_f32_bf16 v228, s5, v25
    v_dot2c_f32_bf16 v229, v25, v25
    v_dot2c_f32_bf16 v224, s5, v18
    v_dot2c_f32_bf16 v225, v18, v18
    v_dot2c_f32_bf16 v226, s5, v22
    v_dot2c_f32_bf16 v227, v22, v22
    v_dot2c_f32_bf16 v228, s5, v26
    v_dot2c_f32_bf16 v229, v26, v26
    v_dot2c_f32_bf16 v224, s5, v19
    v_dot2c_f32_bf16 v225, v19, v19
    v_dot2c_f32_bf16 v226, s5, v23
    v_dot2c_f32_bf16 v227, v23, v23
    v_dot2c_f32_bf16 v228, s5, v27
    v_dot2c_f32_bf16 v229, v27, v27
    ds_read_b128 v[28:31], v129 offset:0
    ds_read_b128 v[32:35], v129 offset:2048
    ds_read_b128 v[36:39], v131 offset:0
    s_waitcnt lgkmcnt(15)
    v_mfma_f32_16x16x32_bf16 v[136:139], v[88:91], v[16:19], v[136:139]
    v_mfma_f32_16x16x32_bf16 v[160:163], v[88:91], v[20:23], v[160:163]
    ds_read_b64_tr_b16 v[88:89], v124 offset:30720
    ds_read_b64_tr_b16 v[90:91], v124 offset:30976
    v_mfma_f32_16x16x32_bf16 v[140:143], v[92:95], v[16:19], v[140:143]
    v_mfma_f32_16x16x32_bf16 v[164:167], v[92:95], v[20:23], v[164:167]
    ds_read_b64_tr_b16 v[92:93], v125 offset:30720
    ds_read_b64_tr_b16 v[94:95], v125 offset:30976
    s_waitcnt lgkmcnt(15)
    v_mfma_f32_16x16x32_bf16 v[144:147], v[96:99], v[16:19], v[144:147]
    v_mfma_f32_16x16x32_bf16 v[168:171], v[96:99], v[20:23], v[168:171]
    ds_read_b64_tr_b16 v[96:97], v124 offset:32768
    ds_read_b64_tr_b16 v[98:99], v124 offset:33024
    v_mfma_f32_16x16x32_bf16 v[148:151], v[100:103], v[16:19], v[148:151]
    v_mfma_f32_16x16x32_bf16 v[172:175], v[100:103], v[20:23], v[172:175]
    ds_read_b64_tr_b16 v[100:101], v125 offset:32768
    ds_read_b64_tr_b16 v[102:103], v125 offset:33024
    s_waitcnt lgkmcnt(15)
    v_mfma_f32_16x16x32_bf16 v[152:155], v[16:19], v[104:107], v[152:155]
    v_mfma_f32_16x16x32_bf16 v[176:179], v[20:23], v[104:107], v[176:179]
    ds_read_b64_tr_b16 v[104:105], v124 offset:34816
    ds_read_b64_tr_b16 v[106:107], v124 offset:35072
    v_mfma_f32_16x16x32_bf16 v[156:159], v[16:19], v[108:111], v[156:159]
    v_mfma_f32_16x16x32_bf16 v[180:183], v[20:23], v[108:111], v[180:183]
    ds_read_b64_tr_b16 v[108:109], v125 offset:34816
    ds_read_b64_tr_b16 v[110:111], v125 offset:35072
    s_waitcnt lgkmcnt(15)
    v_mfma_f32_16x16x32_bf16 v[184:187], v[112:115], v[24:27], v[184:187]
    ds_read_b64_tr_b16 v[112:113], v126 offset:30720
    ds_read_b64_tr_b16 v[114:115], v126 offset:30976
    v_mfma_f32_16x16x32_bf16 v[188:191], v[116:119], v[24:27], v[188:191]
    ds_read_b64_tr_b16 v[116:117], v127 offset:30720
    ds_read_b64_tr_b16 v[118:119], v127 offset:30976
    s_waitcnt vmcnt(8)
    s_barrier
    s_add_u32 m0, s51, 24576
    s_mov_b32 s53, 860160
    buffer_load_dwordx4 v123, s[12:15], s53 offen lds
    s_add_u32 m0, s51, 26624
    s_mov_b32 s53, 861056
    buffer_load_dwordx4 v123, s[12:15], s53 offen lds
    s_add_u32 m0, s51, 28672
    s_mov_b32 s53, 861952
    buffer_load_dwordx4 v123, s[12:15], s53 offen lds
    s_add_u32 m0, s52, 18432
    s_mov_b32 s53, 640
    buffer_load_dwordx4 v120, s[8:11], s53 offen lds
    s_add_u32 m0, s52, 19456
    s_mov_b32 s53, 640
    buffer_load_dwordx4 v121, s[8:11], s53 offen lds
    s_add_u32 m0, s52, 20480
    s_mov_b32 s53, 14976
    buffer_load_dwordx4 v120, s[8:11], s53 offen lds
    s_add_u32 m0, s52, 21504
    s_mov_b32 s53, 14976
    buffer_load_dwordx4 v121, s[8:11], s53 offen lds
    s_add_u32 m0, s78, 79872
    s_mov_b32 s53, 640
    s_mov_b64 exec, s[54:55]
    buffer_load_dwordx4 v122, s[8:11], s53 offen lds
    s_mov_b64 exec, -1
    s_waitcnt lgkmcnt(15)
    v_dot2c_f32_bf16 v224, s5, v28
    v_dot2c_f32_bf16 v225, v28, v28
    v_dot2c_f32_bf16 v226, s5, v32
    v_dot2c_f32_bf16 v227, v32, v32
    v_dot2c_f32_bf16 v228, s5, v36
    v_dot2c_f32_bf16 v229, v36, v36
    v_dot2c_f32_bf16 v224, s5, v29
    v_dot2c_f32_bf16 v225, v29, v29
    v_dot2c_f32_bf16 v226, s5, v33
    v_dot2c_f32_bf16 v227, v33, v33
    v_dot2c_f32_bf16 v228, s5, v37
    v_dot2c_f32_bf16 v229, v37, v37
    v_dot2c_f32_bf16 v224, s5, v30
    v_dot2c_f32_bf16 v225, v30, v30
    v_dot2c_f32_bf16 v226, s5, v34
    v_dot2c_f32_bf16 v227, v34, v34
    v_dot2c_f32_bf16 v228, s5, v38
    v_dot2c_f32_bf16 v229, v38, v38
    v_dot2c_f32_bf16 v224, s5, v31
    v_dot2c_f32_bf16 v225, v31, v31
    v_dot2c_f32_bf16 v226, s5, v35
    v_dot2c_f32_bf16 v227, v35, v35
    v_dot2c_f32_bf16 v228, s5, v39
    v_dot2c_f32_bf16 v229, v39, v39
    ds_read_b128 v[16:19], v128 offset:55296
    ds_read_b128 v[20:23], v128 offset:57344
    ds_read_b128 v[24:27], v130 offset:55296
    s_waitcnt lgkmcnt(15)
    v_mfma_f32_16x16x32_bf16 v[136:139], v[88:91], v[28:31], v[136:139]
    v_mfma_f32_16x16x32_bf16 v[160:163], v[88:91], v[32:35], v[160:163]
    ds_read_b64_tr_b16 v[88:89], v124 offset:36864
    ds_read_b64_tr_b16 v[90:91], v124 offset:37120
    v_mfma_f32_16x16x32_bf16 v[140:143], v[92:95], v[28:31], v[140:143]
    v_mfma_f32_16x16x32_bf16 v[164:167], v[92:95], v[32:35], v[164:167]
    ds_read_b64_tr_b16 v[92:93], v125 offset:36864
    ds_read_b64_tr_b16 v[94:95], v125 offset:37120
    s_waitcnt lgkmcnt(15)
    v_mfma_f32_16x16x32_bf16 v[144:147], v[96:99], v[28:31], v[144:147]
    v_mfma_f32_16x16x32_bf16 v[168:171], v[96:99], v[32:35], v[168:171]
    ds_read_b64_tr_b16 v[96:97], v124 offset:38912
    ds_read_b64_tr_b16 v[98:99], v124 offset:39168
    v_mfma_f32_16x16x32_bf16 v[148:151], v[100:103], v[28:31], v[148:151]
    v_mfma_f32_16x16x32_bf16 v[172:175], v[100:103], v[32:35], v[172:175]
    ds_read_b64_tr_b16 v[100:101], v125 offset:38912
    ds_read_b64_tr_b16 v[102:103], v125 offset:39168
    s_waitcnt lgkmcnt(15)
    v_mfma_f32_16x16x32_bf16 v[152:155], v[28:31], v[104:107], v[152:155]
    v_mfma_f32_16x16x32_bf16 v[176:179], v[32:35], v[104:107], v[176:179]
    ds_read_b64_tr_b16 v[104:105], v124 offset:40960
    ds_read_b64_tr_b16 v[106:107], v124 offset:41216
    v_mfma_f32_16x16x32_bf16 v[156:159], v[28:31], v[108:111], v[156:159]
    v_mfma_f32_16x16x32_bf16 v[180:183], v[32:35], v[108:111], v[180:183]
    ds_read_b64_tr_b16 v[108:109], v125 offset:40960
    ds_read_b64_tr_b16 v[110:111], v125 offset:41216
    s_waitcnt lgkmcnt(15)
    v_mfma_f32_16x16x32_bf16 v[184:187], v[112:115], v[36:39], v[184:187]
    ds_read_b64_tr_b16 v[112:113], v126 offset:36864
    ds_read_b64_tr_b16 v[114:115], v126 offset:37120
    v_mfma_f32_16x16x32_bf16 v[188:191], v[116:119], v[36:39], v[188:191]
    ds_read_b64_tr_b16 v[116:117], v127 offset:36864
    ds_read_b64_tr_b16 v[118:119], v127 offset:37120
    s_waitcnt lgkmcnt(15)
    v_dot2c_f32_bf16 v224, s5, v16
    v_dot2c_f32_bf16 v225, v16, v16
    v_dot2c_f32_bf16 v226, s5, v20
    v_dot2c_f32_bf16 v227, v20, v20
    v_dot2c_f32_bf16 v228, s5, v24
    v_dot2c_f32_bf16 v229, v24, v24
    v_dot2c_f32_bf16 v224, s5, v17
    v_dot2c_f32_bf16 v225, v17, v17
    v_dot2c_f32_bf16 v226, s5, v21
    v_dot2c_f32_bf16 v227, v21, v21
    v_dot2c_f32_bf16 v228, s5, v25
    v_dot2c_f32_bf16 v229, v25, v25
    v_dot2c_f32_bf16 v224, s5, v18
    v_dot2c_f32_bf16 v225, v18, v18
    v_dot2c_f32_bf16 v226, s5, v22
    v_dot2c_f32_bf16 v227, v22, v22
    v_dot2c_f32_bf16 v228, s5, v26
    v_dot2c_f32_bf16 v229, v26, v26
    v_dot2c_f32_bf16 v224, s5, v19
    v_dot2c_f32_bf16 v225, v19, v19
    v_dot2c_f32_bf16 v226, s5, v23
    v_dot2c_f32_bf16 v227, v23, v23
    v_dot2c_f32_bf16 v228, s5, v27
    v_dot2c_f32_bf16 v229, v27, v27
    ds_read_b128 v[28:31], v129 offset:55296
    ds_read_b128 v[32:35], v129 offset:57344
    ds_read_b128 v[36:39], v131 offset:55296
    s_waitcnt lgkmcnt(15)
    v_mfma_f32_16x16x32_bf16 v[136:139], v[88:91], v[16:19], v[136:139]
    v_mfma_f32_16x16x32_bf16 v[160:163], v[88:91], v[20:23], v[160:163]
    ds_read_b64_tr_b16 v[88:89], v124 offset:43008
    ds_read_b64_tr_b16 v[90:91], v124 offset:43264
    v_mfma_f32_16x16x32_bf16 v[140:143], v[92:95], v[16:19], v[140:143]
    v_mfma_f32_16x16x32_bf16 v[164:167], v[92:95], v[20:23], v[164:167]
    ds_read_b64_tr_b16 v[92:93], v125 offset:43008
    ds_read_b64_tr_b16 v[94:95], v125 offset:43264
    s_waitcnt lgkmcnt(15)
    v_mfma_f32_16x16x32_bf16 v[144:147], v[96:99], v[16:19], v[144:147]
    v_mfma_f32_16x16x32_bf16 v[168:171], v[96:99], v[20:23], v[168:171]
    ds_read_b64_tr_b16 v[96:97], v124 offset:45056
    ds_read_b64_tr_b16 v[98:99], v124 offset:45312
    v_mfma_f32_16x16x32_bf16 v[148:151], v[100:103], v[16:19], v[148:151]
    v_mfma_f32_16x16x32_bf16 v[172:175], v[100:103], v[20:23], v[172:175]
    ds_read_b64_tr_b16 v[100:101], v125 offset:45056
    ds_read_b64_tr_b16 v[102:103], v125 offset:45312
    s_waitcnt lgkmcnt(15)
    v_mfma_f32_16x16x32_bf16 v[152:155], v[16:19], v[104:107], v[152:155]
    v_mfma_f32_16x16x32_bf16 v[176:179], v[20:23], v[104:107], v[176:179]
    ds_read_b64_tr_b16 v[104:105], v124 offset:47104
    ds_read_b64_tr_b16 v[106:107], v124 offset:47360
    v_mfma_f32_16x16x32_bf16 v[156:159], v[16:19], v[108:111], v[156:159]
    v_mfma_f32_16x16x32_bf16 v[180:183], v[20:23], v[108:111], v[180:183]
    ds_read_b64_tr_b16 v[108:109], v125 offset:47104
    ds_read_b64_tr_b16 v[110:111], v125 offset:47360
    s_waitcnt lgkmcnt(15)
    v_mfma_f32_16x16x32_bf16 v[184:187], v[112:115], v[24:27], v[184:187]
    ds_read_b64_tr_b16 v[112:113], v126 offset:43008
    ds_read_b64_tr_b16 v[114:115], v126 offset:43264
    v_mfma_f32_16x16x32_bf16 v[188:191], v[116:119], v[24:27], v[188:191]
    ds_read_b64_tr_b16 v[116:117], v127 offset:43008
    ds_read_b64_tr_b16 v[118:119], v127 offset:43264
    s_waitcnt vmcnt(8)
    s_barrier
    s_add_u32 m0, s51, 36864
    s_mov_b32 s53, 1032192
    buffer_load_dwordx4 v123, s[12:15], s53 offen lds
    s_add_u32 m0, s51, 38912
    s_mov_b32 s53, 1033088
    buffer_load_dwordx4 v123, s[12:15], s53 offen lds
    s_add_u32 m0, s51, 40960
    s_mov_b32 s53, 1033984
    buffer_load_dwordx4 v123, s[12:15], s53 offen lds
    s_add_u32 m0, s52, 0
    s_mov_b32 s53, 768
    buffer_load_dwordx4 v120, s[8:11], s53 offen lds
    s_add_u32 m0, s52, 1024
    s_mov_b32 s53, 768
    buffer_load_dwordx4 v121, s[8:11], s53 offen lds
    s_add_u32 m0, s52, 2048
    s_mov_b32 s53, 15104
    buffer_load_dwordx4 v120, s[8:11], s53 offen lds
    s_add_u32 m0, s52, 3072
    s_mov_b32 s53, 15104
    buffer_load_dwordx4 v121, s[8:11], s53 offen lds
    s_add_u32 m0, s78, 61440
    s_mov_b32 s53, 768
    s_mov_b64 exec, s[54:55]
    buffer_load_dwordx4 v122, s[8:11], s53 offen lds
    s_mov_b64 exec, -1
    s_waitcnt lgkmcnt(15)
    v_dot2c_f32_bf16 v224, s5, v28
    v_dot2c_f32_bf16 v225, v28, v28
    v_dot2c_f32_bf16 v226, s5, v32
    v_dot2c_f32_bf16 v227, v32, v32
    v_dot2c_f32_bf16 v228, s5, v36
    v_dot2c_f32_bf16 v229, v36, v36
    v_dot2c_f32_bf16 v224, s5, v29
    v_dot2c_f32_bf16 v225, v29, v29
    v_dot2c_f32_bf16 v226, s5, v33
    v_dot2c_f32_bf16 v227, v33, v33
    v_dot2c_f32_bf16 v228, s5, v37
    v_dot2c_f32_bf16 v229, v37, v37
    v_dot2c_f32_bf16 v224, s5, v30
    v_dot2c_f32_bf16 v225, v30, v30
    v_dot2c_f32_bf16 v226, s5, v34
    v_dot2c_f32_bf16 v227, v34, v34
    v_dot2c_f32_bf16 v228, s5, v38
    v_dot2c_f32_bf16 v229, v38, v38
    v_dot2c_f32_bf16 v224, s5, v31
    v_dot2c_f32_bf16 v225, v31, v31
    v_dot2c_f32_bf16 v226, s5, v35
    v_dot2c_f32_bf16 v227, v35, v35
    v_dot2c_f32_bf16 v228, s5, v39
    v_dot2c_f32_bf16 v229, v39, v39
    ds_read_b128 v[16:19], v128 offset:36864
    ds_read_b128 v[20:23], v128 offset:38912
    ds_read_b128 v[24:27], v130 offset:36864
    s_waitcnt lgkmcnt(15)
    v_mfma_f32_16x16x32_bf16 v[136:139], v[88:91], v[28:31], v[136:139]
    v_mfma_f32_16x16x32_bf16 v[160:163], v[88:91], v[32:35], v[160:163]
    ds_read_b64_tr_b16 v[88:89], v124 offset:0
    ds_read_b64_tr_b16 v[90:91], v124 offset:256
    v_mfma_f32_16x16x32_bf16 v[140:143], v[92:95], v[28:31], v[140:143]
    v_mfma_f32_16x16x32_bf16 v[164:167], v[92:95], v[32:35], v[164:167]
    ds_read_b64_tr_b16 v[92:93], v125 offset:0
    ds_read_b64_tr_b16 v[94:95], v125 offset:256
    s_waitcnt lgkmcnt(15)
    v_mfma_f32_16x16x32_bf16 v[144:147], v[96:99], v[28:31], v[144:147]
    v_mfma_f32_16x16x32_bf16 v[168:171], v[96:99], v[32:35], v[168:171]
    ds_read_b64_tr_b16 v[96:97], v124 offset:2048
    ds_read_b64_tr_b16 v[98:99], v124 offset:2304
    v_mfma_f32_16x16x32_bf16 v[148:151], v[100:103], v[28:31], v[148:151]
    v_mfma_f32_16x16x32_bf16 v[172:175], v[100:103], v[32:35], v[172:175]
    ds_read_b64_tr_b16 v[100:101], v125 offset:2048
    ds_read_b64_tr_b16 v[102:103], v125 offset:2304
    s_waitcnt lgkmcnt(15)
    v_mfma_f32_16x16x32_bf16 v[152:155], v[28:31], v[104:107], v[152:155]
    v_mfma_f32_16x16x32_bf16 v[176:179], v[32:35], v[104:107], v[176:179]
    ds_read_b64_tr_b16 v[104:105], v124 offset:4096
    ds_read_b64_tr_b16 v[106:107], v124 offset:4352
    v_mfma_f32_16x16x32_bf16 v[156:159], v[28:31], v[108:111], v[156:159]
    v_mfma_f32_16x16x32_bf16 v[180:183], v[32:35], v[108:111], v[180:183]
    ds_read_b64_tr_b16 v[108:109], v125 offset:4096
    ds_read_b64_tr_b16 v[110:111], v125 offset:4352
    s_waitcnt lgkmcnt(15)
    v_mfma_f32_16x16x32_bf16 v[184:187], v[112:115], v[36:39], v[184:187]
    ds_read_b64_tr_b16 v[112:113], v126 offset:0
    ds_read_b64_tr_b16 v[114:115], v126 offset:256
    v_mfma_f32_16x16x32_bf16 v[188:191], v[116:119], v[36:39], v[188:191]
    ds_read_b64_tr_b16 v[116:117], v127 offset:0
    ds_read_b64_tr_b16 v[118:119], v127 offset:256
    s_waitcnt lgkmcnt(15)
    v_dot2c_f32_bf16 v224, s5, v16
    v_dot2c_f32_bf16 v225, v16, v16
    v_dot2c_f32_bf16 v226, s5, v20
    v_dot2c_f32_bf16 v227, v20, v20
    v_dot2c_f32_bf16 v228, s5, v24
    v_dot2c_f32_bf16 v229, v24, v24
    v_dot2c_f32_bf16 v224, s5, v17
    v_dot2c_f32_bf16 v225, v17, v17
    v_dot2c_f32_bf16 v226, s5, v21
    v_dot2c_f32_bf16 v227, v21, v21
    v_dot2c_f32_bf16 v228, s5, v25
    v_dot2c_f32_bf16 v229, v25, v25
    v_dot2c_f32_bf16 v224, s5, v18
    v_dot2c_f32_bf16 v225, v18, v18
    v_dot2c_f32_bf16 v226, s5, v22
    v_dot2c_f32_bf16 v227, v22, v22
    v_dot2c_f32_bf16 v228, s5, v26
    v_dot2c_f32_bf16 v229, v26, v26
    v_dot2c_f32_bf16 v224, s5, v19
    v_dot2c_f32_bf16 v225, v19, v19
    v_dot2c_f32_bf16 v226, s5, v23
    v_dot2c_f32_bf16 v227, v23, v23
    v_dot2c_f32_bf16 v228, s5, v27
    v_dot2c_f32_bf16 v229, v27, v27
    ds_read_b128 v[28:31], v129 offset:36864
    ds_read_b128 v[32:35], v129 offset:38912
    ds_read_b128 v[36:39], v131 offset:36864
    s_waitcnt lgkmcnt(15)
    v_mfma_f32_16x16x32_bf16 v[136:139], v[88:91], v[16:19], v[136:139]
    v_mfma_f32_16x16x32_bf16 v[160:163], v[88:91], v[20:23], v[160:163]
    ds_read_b64_tr_b16 v[88:89], v124 offset:6144
    ds_read_b64_tr_b16 v[90:91], v124 offset:6400
    v_mfma_f32_16x16x32_bf16 v[140:143], v[92:95], v[16:19], v[140:143]
    v_mfma_f32_16x16x32_bf16 v[164:167], v[92:95], v[20:23], v[164:167]
    ds_read_b64_tr_b16 v[92:93], v125 offset:6144
    ds_read_b64_tr_b16 v[94:95], v125 offset:6400
    s_waitcnt lgkmcnt(15)
    v_mfma_f32_16x16x32_bf16 v[144:147], v[96:99], v[16:19], v[144:147]
    v_mfma_f32_16x16x32_bf16 v[168:171], v[96:99], v[20:23], v[168:171]
    ds_read_b64_tr_b16 v[96:97], v124 offset:8192
    ds_read_b64_tr_b16 v[98:99], v124 offset:8448
    v_mfma_f32_16x16x32_bf16 v[148:151], v[100:103], v[16:19], v[148:151]
    v_mfma_f32_16x16x32_bf16 v[172:175], v[100:103], v[20:23], v[172:175]
    ds_read_b64_tr_b16 v[100:101], v125 offset:8192
    ds_read_b64_tr_b16 v[102:103], v125 offset:8448
    s_waitcnt lgkmcnt(15)
    v_mfma_f32_16x16x32_bf16 v[152:155], v[16:19], v[104:107], v[152:155]
    v_mfma_f32_16x16x32_bf16 v[176:179], v[20:23], v[104:107], v[176:179]
    ds_read_b64_tr_b16 v[104:105], v124 offset:10240
    ds_read_b64_tr_b16 v[106:107], v124 offset:10496
    v_mfma_f32_16x16x32_bf16 v[156:159], v[16:19], v[108:111], v[156:159]
    v_mfma_f32_16x16x32_bf16 v[180:183], v[20:23], v[108:111], v[180:183]
    ds_read_b64_tr_b16 v[108:109], v125 offset:10240
    ds_read_b64_tr_b16 v[110:111], v125 offset:10496
    s_waitcnt lgkmcnt(15)
    v_mfma_f32_16x16x32_bf16 v[184:187], v[112:115], v[24:27], v[184:187]
    ds_read_b64_tr_b16 v[112:113], v126 offset:6144
    ds_read_b64_tr_b16 v[114:115], v126 offset:6400
    v_mfma_f32_16x16x32_bf16 v[188:191], v[116:119], v[24:27], v[188:191]
    ds_read_b64_tr_b16 v[116:117], v127 offset:6144
    ds_read_b64_tr_b16 v[118:119], v127 offset:6400
    v_mov_b32 v7, 0
    buffer_load_dword v6, v7, s[44:47], 0 offen sc1
    s_add_u32 m0, s59, 135168
    s_mov_b32 s58, 0
    buffer_load_dwordx4 v208, s[16:19], s58 offen lds
    s_add_u32 m0, s59, 136192
    s_mov_b32 s58, 14336
    buffer_load_dwordx4 v208, s[16:19], s58 offen lds
    s_add_u32 m0, s59, 137216
    s_mov_b32 s58, 28672
    buffer_load_dwordx4 v208, s[16:19], s58 offen lds
    s_add_u32 m0, s59, 138240
    s_mov_b32 s58, 43008
    buffer_load_dwordx4 v208, s[16:19], s58 offen lds
    s_add_u32 m0, s59, 139264
    s_mov_b32 s58, 57344
    buffer_load_dwordx4 v208, s[16:19], s58 offen lds
    s_add_u32 m0, s59, 140288
    s_mov_b32 s58, 71680
    buffer_load_dwordx4 v208, s[16:19], s58 offen lds
    s_add_u32 m0, s59, 141312
    s_mov_b32 s58, 86016
    buffer_load_dwordx4 v208, s[16:19], s58 offen lds
    s_waitcnt vmcnt(16)
    s_barrier
    s_waitcnt lgkmcnt(15)
    v_dot2c_f32_bf16 v224, s5, v28
    v_dot2c_f32_bf16 v225, v28, v28
    v_dot2c_f32_bf16 v226, s5, v32
    v_dot2c_f32_bf16 v227, v32, v32
    v_dot2c_f32_bf16 v228, s5, v36
    v_dot2c_f32_bf16 v229, v36, v36
    v_dot2c_f32_bf16 v224, s5, v29
    v_dot2c_f32_bf16 v225, v29, v29
    v_dot2c_f32_bf16 v226, s5, v33
    v_dot2c_f32_bf16 v227, v33, v33
    v_dot2c_f32_bf16 v228, s5, v37
    v_dot2c_f32_bf16 v229, v37, v37
    v_dot2c_f32_bf16 v224, s5, v30
    v_dot2c_f32_bf16 v225, v30, v30
    v_dot2c_f32_bf16 v226, s5, v34
    v_dot2c_f32_bf16 v227, v34, v34
    v_dot2c_f32_bf16 v228, s5, v38
    v_dot2c_f32_bf16 v229, v38, v38
    v_dot2c_f32_bf16 v224, s5, v31
    v_dot2c_f32_bf16 v225, v31, v31
    v_dot2c_f32_bf16 v226, s5, v35
    v_dot2c_f32_bf16 v227, v35, v35
    v_dot2c_f32_bf16 v228, s5, v39
    v_dot2c_f32_bf16 v229, v39, v39
    ds_read_b128 v[16:19], v128 offset:18432
    ds_read_b128 v[20:23], v128 offset:20480
    ds_read_b128 v[24:27], v130 offset:18432
    s_waitcnt lgkmcnt(15)
    v_mfma_f32_16x16x32_bf16 v[136:139], v[88:91], v[28:31], v[136:139]
    v_mfma_f32_16x16x32_bf16 v[160:163], v[88:91], v[32:35], v[160:163]
    ds_read_b64_tr_b16 v[88:89], v124 offset:12288
    ds_read_b64_tr_b16 v[90:91], v124 offset:12544
    v_mfma_f32_16x16x32_bf16 v[140:143], v[92:95], v[28:31], v[140:143]
    v_mfma_f32_16x16x32_bf16 v[164:167], v[92:95], v[32:35], v[164:167]
    ds_read_b64_tr_b16 v[92:93], v125 offset:12288
    ds_read_b64_tr_b16 v[94:95], v125 offset:12544
    s_waitcnt lgkmcnt(15)
    v_mfma_f32_16x16x32_bf16 v[144:147], v[96:99], v[28:31], v[144:147]
    v_mfma_f32_16x16x32_bf16 v[168:171], v[96:99], v[32:35], v[168:171]
    ds_read_b64_tr_b16 v[96:97], v124 offset:14336
    ds_read_b64_tr_b16 v[98:99], v124 offset:14592
    v_mfma_f32_16x16x32_bf16 v[148:151], v[100:103], v[28:31], v[148:151]
    v_mfma_f32_16x16x32_bf16 v[172:175], v[100:103], v[32:35], v[172:175]
    ds_read_b64_tr_b16 v[100:101], v125 offset:14336
    ds_read_b64_tr_b16 v[102:103], v125 offset:14592
    s_waitcnt lgkmcnt(15)
    v_mfma_f32_16x16x32_bf16 v[152:155], v[28:31], v[104:107], v[152:155]
    v_mfma_f32_16x16x32_bf16 v[176:179], v[32:35], v[104:107], v[176:179]
    ds_read_b64_tr_b16 v[104:105], v124 offset:16384
    ds_read_b64_tr_b16 v[106:107], v124 offset:16640
    v_mfma_f32_16x16x32_bf16 v[156:159], v[28:31], v[108:111], v[156:159]
    v_mfma_f32_16x16x32_bf16 v[180:183], v[32:35], v[108:111], v[180:183]
    ds_read_b64_tr_b16 v[108:109], v125 offset:16384
    ds_read_b64_tr_b16 v[110:111], v125 offset:16640
    s_waitcnt lgkmcnt(15)
    v_mfma_f32_16x16x32_bf16 v[184:187], v[112:115], v[36:39], v[184:187]
    ds_read_b64_tr_b16 v[112:113], v126 offset:12288
    ds_read_b64_tr_b16 v[114:115], v126 offset:12544
    v_mfma_f32_16x16x32_bf16 v[188:191], v[116:119], v[36:39], v[188:191]
    ds_read_b64_tr_b16 v[116:117], v127 offset:12288
    ds_read_b64_tr_b16 v[118:119], v127 offset:12544
    v_mul_u32_u24 v221, 3584, v3
    v_lshl_add_u32 v221, v2, 1, v221
    s_mul_i32 s58, s56, 28672
    s_mul_i32 s60, s57, 224
    s_add_u32 s58, s58, s60
    s_lshl_b32 s60, s3, 6
    s_add_u32 s58, s58, s60
    s_add_u32 s60, s58, 14336
    buffer_load_ushort v192, v221, s[8:11], s58 offen offset:0
    buffer_load_ushort v193, v221, s[8:11], s58 offen offset:896
    buffer_load_ushort v194, v221, s[8:11], s58 offen offset:1792
    buffer_load_ushort v195, v221, s[8:11], s58 offen offset:2688
    buffer_load_ushort v196, v221, s[8:11], s58 offen offset:32
    buffer_load_ushort v197, v221, s[8:11], s58 offen offset:928
    buffer_load_ushort v198, v221, s[8:11], s58 offen offset:1824
    buffer_load_ushort v199, v221, s[8:11], s58 offen offset:2720
    buffer_load_ushort v200, v221, s[8:11], s60 offen offset:0
    buffer_load_ushort v201, v221, s[8:11], s60 offen offset:896
    buffer_load_ushort v202, v221, s[8:11], s60 offen offset:1792
    buffer_load_ushort v203, v221, s[8:11], s60 offen offset:2688
    buffer_load_ushort v204, v221, s[8:11], s60 offen offset:32
    buffer_load_ushort v205, v221, s[8:11], s60 offen offset:928
    buffer_load_ushort v206, v221, s[8:11], s60 offen offset:1824
    buffer_load_ushort v207, v221, s[8:11], s60 offen offset:2720
    s_waitcnt lgkmcnt(15)
    v_dot2c_f32_bf16 v224, s5, v16
    v_dot2c_f32_bf16 v225, v16, v16
    v_dot2c_f32_bf16 v226, s5, v20
    v_dot2c_f32_bf16 v227, v20, v20
    v_dot2c_f32_bf16 v228, s5, v24
    v_dot2c_f32_bf16 v229, v24, v24
    v_dot2c_f32_bf16 v224, s5, v17
    v_dot2c_f32_bf16 v225, v17, v17
    v_dot2c_f32_bf16 v226, s5, v21
    v_dot2c_f32_bf16 v227, v21, v21
    v_dot2c_f32_bf16 v228, s5, v25
    v_dot2c_f32_bf16 v229, v25, v25
    v_dot2c_f32_bf16 v224, s5, v18
    v_dot2c_f32_bf16 v225, v18, v18
    v_dot2c_f32_bf16 v226, s5, v22
    v_dot2c_f32_bf16 v227, v22, v22
    v_dot2c_f32_bf16 v228, s5, v26
    v_dot2c_f32_bf16 v229, v26, v26
    v_dot2c_f32_bf16 v224, s5, v19
    v_dot2c_f32_bf16 v225, v19, v19
    v_dot2c_f32_bf16 v226, s5, v23
    v_dot2c_f32_bf16 v227, v23, v23
    v_dot2c_f32_bf16 v228, s5, v27
    v_dot2c_f32_bf16 v229, v27, v27
    ds_read_b128 v[28:31], v129 offset:18432
    ds_read_b128 v[32:35], v129 offset:20480
    ds_read_b128 v[36:39], v131 offset:18432
    s_waitcnt lgkmcnt(15)
    v_mfma_f32_16x16x32_bf16 v[136:139], v[88:91], v[16:19], v[136:139]
    v_mfma_f32_16x16x32_bf16 v[160:163], v[88:91], v[20:23], v[160:163]
    ds_read_b64_tr_b16 v[88:89], v124 offset:18432
    ds_read_b64_tr_b16 v[90:91], v124 offset:18688
    v_mfma_f32_16x16x32_bf16 v[140:143], v[92:95], v[16:19], v[140:143]
    v_mfma_f32_16x16x32_bf16 v[164:167], v[92:95], v[20:23], v[164:167]
    ds_read_b64_tr_b16 v[92:93], v125 offset:18432
    ds_read_b64_tr_b16 v[94:95], v125 offset:18688
    s_waitcnt lgkmcnt(15)
    v_mfma_f32_16x16x32_bf16 v[144:147], v[96:99], v[16:19], v[144:147]
    v_mfma_f32_16x16x32_bf16 v[168:171], v[96:99], v[20:23], v[168:171]
    ds_read_b64_tr_b16 v[96:97], v124 offset:20480
    ds_read_b64_tr_b16 v[98:99], v124 offset:20736
    v_mfma_f32_16x16x32_bf16 v[148:151], v[100:103], v[16:19], v[148:151]
    v_mfma_f32_16x16x32_bf16 v[172:175], v[100:103], v[20:23], v[172:175]
    ds_read_b64_tr_b16 v[100:101], v125 offset:20480
    ds_read_b64_tr_b16 v[102:103], v125 offset:20736
    s_waitcnt lgkmcnt(15)
    v_mfma_f32_16x16x32_bf16 v[152:155], v[16:19], v[104:107], v[152:155]
    v_mfma_f32_16x16x32_bf16 v[176:179], v[20:23], v[104:107], v[176:179]
    ds_read_b64_tr_b16 v[104:105], v124 offset:22528
    ds_read_b64_tr_b16 v[106:107], v124 offset:22784
    v_mfma_f32_16x16x32_bf16 v[156:159], v[16:19], v[108:111], v[156:159]
    v_mfma_f32_16x16x32_bf16 v[180:183], v[20:23], v[108:111], v[180:183]
    ds_read_b64_tr_b16 v[108:109], v125 offset:22528
    ds_read_b64_tr_b16 v[110:111], v125 offset:22784
    s_waitcnt lgkmcnt(15)
    v_mfma_f32_16x16x32_bf16 v[184:187], v[112:115], v[24:27], v[184:187]
    ds_read_b64_tr_b16 v[112:113], v126 offset:18432
    ds_read_b64_tr_b16 v[114:115], v126 offset:18688
    v_mfma_f32_16x16x32_bf16 v[188:191], v[116:119], v[24:27], v[188:191]
    ds_read_b64_tr_b16 v[116:117], v127 offset:18432
    ds_read_b64_tr_b16 v[118:119], v127 offset:18688
    s_waitcnt vmcnt(24)
    s_barrier
    s_waitcnt lgkmcnt(15)
    v_dot2c_f32_bf16 v224, s5, v28
    v_dot2c_f32_bf16 v225, v28, v28
    v_dot2c_f32_bf16 v226, s5, v32
    v_dot2c_f32_bf16 v227, v32, v32
    v_dot2c_f32_bf16 v228, s5, v36
    v_dot2c_f32_bf16 v229, v36, v36
    v_dot2c_f32_bf16 v224, s5, v29
    v_dot2c_f32_bf16 v225, v29, v29
    v_dot2c_f32_bf16 v226, s5, v33
    v_dot2c_f32_bf16 v227, v33, v33
    v_dot2c_f32_bf16 v228, s5, v37
    v_dot2c_f32_bf16 v229, v37, v37
    v_dot2c_f32_bf16 v224, s5, v30
    v_dot2c_f32_bf16 v225, v30, v30
    v_dot2c_f32_bf16 v226, s5, v34
    v_dot2c_f32_bf16 v227, v34, v34
    v_dot2c_f32_bf16 v228, s5, v38
    v_dot2c_f32_bf16 v229, v38, v38
    v_dot2c_f32_bf16 v224, s5, v31
    v_dot2c_f32_bf16 v225, v31, v31
    v_dot2c_f32_bf16 v226, s5, v35
    v_dot2c_f32_bf16 v227, v35, v35
    v_dot2c_f32_bf16 v228, s5, v39
    v_dot2c_f32_bf16 v229, v39, v39
    ds_read_b128 v[16:19], v128 offset:0
    ds_read_b128 v[20:23], v128 offset:2048
    ds_read_b128 v[24:27], v130 offset:0
    s_waitcnt lgkmcnt(15)
    v_mfma_f32_16x16x32_bf16 v[136:139], v[88:91], v[28:31], v[136:139]
    v_mfma_f32_16x16x32_bf16 v[160:163], v[88:91], v[32:35], v[160:163]
    ds_read_b64_tr_b16 v[88:89], v124 offset:24576
    ds_read_b64_tr_b16 v[90:91], v124 offset:24832
    v_mfma_f32_16x16x32_bf16 v[140:143], v[92:95], v[28:31], v[140:143]
    v_mfma_f32_16x16x32_bf16 v[164:167], v[92:95], v[32:35], v[164:167]
    ds_read_b64_tr_b16 v[92:93], v125 offset:24576
    ds_read_b64_tr_b16 v[94:95], v125 offset:24832
    s_waitcnt lgkmcnt(15)
    v_mfma_f32_16x16x32_bf16 v[144:147], v[96:99], v[28:31], v[144:147]
    v_mfma_f32_16x16x32_bf16 v[168:171], v[96:99], v[32:35], v[168:171]
    ds_read_b64_tr_b16 v[96:97], v124 offset:26624
    ds_read_b64_tr_b16 v[98:99], v124 offset:26880
    v_mfma_f32_16x16x32_bf16 v[148:151], v[100:103], v[28:31], v[148:151]
    v_mfma_f32_16x16x32_bf16 v[172:175], v[100:103], v[32:35], v[172:175]
    ds_read_b64_tr_b16 v[100:101], v125 offset:26624
    ds_read_b64_tr_b16 v[102:103], v125 offset:26880
    s_waitcnt lgkmcnt(15)
    v_mfma_f32_16x16x32_bf16 v[152:155], v[28:31], v[104:107], v[152:155]
    v_mfma_f32_16x16x32_bf16 v[176:179], v[32:35], v[104:107], v[176:179]
    ds_read_b64_tr_b16 v[104:105], v124 offset:28672
    ds_read_b64_tr_b16 v[106:107], v124 offset:28928
    v_mfma_f32_16x16x32_bf16 v[156:159], v[28:31], v[108:111], v[156:159]
    v_mfma_f32_16x16x32_bf16 v[180:183], v[32:35], v[108:111], v[180:183]
    ds_read_b64_tr_b16 v[108:109], v125 offset:28672
    ds_read_b64_tr_b16 v[110:111], v125 offset:28928
    s_waitcnt lgkmcnt(15)
    v_mfma_f32_16x16x32_bf16 v[184:187], v[112:115], v[36:39], v[184:187]
    ds_read_b64_tr_b16 v[112:113], v126 offset:24576
    ds_read_b64_tr_b16 v[114:115], v126 offset:24832
    v_mfma_f32_16x16x32_bf16 v[188:191], v[116:119], v[36:39], v[188:191]
    ds_read_b64_tr_b16 v[116:117], v127 offset:24576
    ds_read_b64_tr_b16 v[118:119], v127 offset:24832
    s_add_u32 m0, s59, 98304
    s_mov_b32 s58, 100352
    buffer_load_dwordx4 v208, s[16:19], s58 offen lds
    s_add_u32 m0, s59, 99328
    s_mov_b32 s58, 114688
    buffer_load_dwordx4 v208, s[16:19], s58 offen lds
    s_add_u32 m0, s59, 100352
    s_mov_b32 s58, 129024
    buffer_load_dwordx4 v208, s[16:19], s58 offen lds
    s_add_u32 m0, s59, 101376
    s_mov_b32 s58, 143360
    buffer_load_dwordx4 v208, s[16:19], s58 offen lds
    s_add_u32 m0, s59, 102400
    s_mov_b32 s58, 157696
    buffer_load_dwordx4 v208, s[16:19], s58 offen lds
    s_add_u32 m0, s59, 103424
    s_mov_b32 s58, 172032
    buffer_load_dwordx4 v208, s[16:19], s58 offen lds
    s_add_u32 m0, s59, 104448
    s_mov_b32 s58, 186368
    buffer_load_dwordx4 v208, s[16:19], s58 offen lds
    s_waitcnt lgkmcnt(15)
    v_dot2c_f32_bf16 v224, s5, v16
    v_dot2c_f32_bf16 v225, v16, v16
    v_dot2c_f32_bf16 v226, s5, v20
    v_dot2c_f32_bf16 v227, v20, v20
    v_dot2c_f32_bf16 v228, s5, v24
    v_dot2c_f32_bf16 v229, v24, v24
    v_dot2c_f32_bf16 v224, s5, v17
    v_dot2c_f32_bf16 v225, v17, v17
    v_dot2c_f32_bf16 v226, s5, v21
    v_dot2c_f32_bf16 v227, v21, v21
    v_dot2c_f32_bf16 v228, s5, v25
    v_dot2c_f32_bf16 v229, v25, v25
    v_dot2c_f32_bf16 v224, s5, v18
    v_dot2c_f32_bf16 v225, v18, v18
    v_dot2c_f32_bf16 v226, s5, v22
    v_dot2c_f32_bf16 v227, v22, v22
    v_dot2c_f32_bf16 v228, s5, v26
    v_dot2c_f32_bf16 v229, v26, v26
    v_dot2c_f32_bf16 v224, s5, v19
    v_dot2c_f32_bf16 v225, v19, v19
    v_dot2c_f32_bf16 v226, s5, v23
    v_dot2c_f32_bf16 v227, v23, v23
    v_dot2c_f32_bf16 v228, s5, v27
    v_dot2c_f32_bf16 v229, v27, v27
    ds_read_b128 v[28:31], v129 offset:0
    ds_read_b128 v[32:35], v129 offset:2048
    ds_read_b128 v[36:39], v131 offset:0
    s_waitcnt lgkmcnt(15)
    v_mfma_f32_16x16x32_bf16 v[136:139], v[88:91], v[16:19], v[136:139]
    v_mfma_f32_16x16x32_bf16 v[160:163], v[88:91], v[20:23], v[160:163]
    ds_read_b64_tr_b16 v[88:89], v124 offset:30720
    ds_read_b64_tr_b16 v[90:91], v124 offset:30976
    v_mfma_f32_16x16x32_bf16 v[140:143], v[92:95], v[16:19], v[140:143]
    v_mfma_f32_16x16x32_bf16 v[164:167], v[92:95], v[20:23], v[164:167]
    ds_read_b64_tr_b16 v[92:93], v125 offset:30720
    ds_read_b64_tr_b16 v[94:95], v125 offset:30976
    s_waitcnt lgkmcnt(15)
    v_mfma_f32_16x16x32_bf16 v[144:147], v[96:99], v[16:19], v[144:147]
    v_mfma_f32_16x16x32_bf16 v[168:171], v[96:99], v[20:23], v[168:171]
    ds_read_b64_tr_b16 v[96:97], v124 offset:32768
    ds_read_b64_tr_b16 v[98:99], v124 offset:33024
    v_mfma_f32_16x16x32_bf16 v[148:151], v[100:103], v[16:19], v[148:151]
    v_mfma_f32_16x16x32_bf16 v[172:175], v[100:103], v[20:23], v[172:175]
    ds_read_b64_tr_b16 v[100:101], v125 offset:32768
    ds_read_b64_tr_b16 v[102:103], v125 offset:33024
    s_waitcnt lgkmcnt(15)
    v_mfma_f32_16x16x32_bf16 v[152:155], v[16:19], v[104:107], v[152:155]
    v_mfma_f32_16x16x32_bf16 v[176:179], v[20:23], v[104:107], v[176:179]
    ds_read_b64_tr_b16 v[104:105], v124 offset:34816
    ds_read_b64_tr_b16 v[106:107], v124 offset:35072
    v_mfma_f32_16x16x32_bf16 v[156:159], v[16:19], v[108:111], v[156:159]
    v_mfma_f32_16x16x32_bf16 v[180:183], v[20:23], v[108:111], v[180:183]
    ds_read_b64_tr_b16 v[108:109], v125 offset:34816
    ds_read_b64_tr_b16 v[110:111], v125 offset:35072
    s_waitcnt lgkmcnt(15)
    v_mfma_f32_16x16x32_bf16 v[184:187], v[112:115], v[24:27], v[184:187]
    ds_read_b64_tr_b16 v[112:113], v126 offset:30720
    ds_read_b64_tr_b16 v[114:115], v126 offset:30976
    v_mfma_f32_16x16x32_bf16 v[188:191], v[116:119], v[24:27], v[188:191]
    ds_read_b64_tr_b16 v[116:117], v127 offset:30720
    ds_read_b64_tr_b16 v[118:119], v127 offset:30976
    s_waitcnt lgkmcnt(15)
    v_dot2c_f32_bf16 v224, s5, v28
    v_dot2c_f32_bf16 v225, v28, v28
    v_dot2c_f32_bf16 v226, s5, v32
    v_dot2c_f32_bf16 v227, v32, v32
    v_dot2c_f32_bf16 v228, s5, v36
    v_dot2c_f32_bf16 v229, v36, v36
    v_dot2c_f32_bf16 v224, s5, v29
    v_dot2c_f32_bf16 v225, v29, v29
    v_dot2c_f32_bf16 v226, s5, v33
    v_dot2c_f32_bf16 v227, v33, v33
    v_dot2c_f32_bf16 v228, s5, v37
    v_dot2c_f32_bf16 v229, v37, v37
    v_dot2c_f32_bf16 v224, s5, v30
    v_dot2c_f32_bf16 v225, v30, v30
    v_dot2c_f32_bf16 v226, s5, v34
    v_dot2c_f32_bf16 v227, v34, v34
    v_dot2c_f32_bf16 v228, s5, v38
    v_dot2c_f32_bf16 v229, v38, v38
    v_dot2c_f32_bf16 v224, s5, v31
    v_dot2c_f32_bf16 v225, v31, v31
    v_dot2c_f32_bf16 v226, s5, v35
    v_dot2c_f32_bf16 v227, v35, v35
    v_dot2c_f32_bf16 v228, s5, v39
    v_dot2c_f32_bf16 v229, v39, v39
    s_waitcnt lgkmcnt(14)
    v_mfma_f32_16x16x32_bf16 v[136:139], v[88:91], v[28:31], v[136:139]
    v_mfma_f32_16x16x32_bf16 v[160:163], v[88:91], v[32:35], v[160:163]
    s_waitcnt lgkmcnt(12)
    v_mfma_f32_16x16x32_bf16 v[140:143], v[92:95], v[28:31], v[140:143]
    v_mfma_f32_16x16x32_bf16 v[164:167], v[92:95], v[32:35], v[164:167]
    s_waitcnt lgkmcnt(10)
    v_mfma_f32_16x16x32_bf16 v[144:147], v[96:99], v[28:31], v[144:147]
    v_mfma_f32_16x16x32_bf16 v[168:171], v[96:99], v[32:35], v[168:171]
    s_waitcnt lgkmcnt(8)
    v_mfma_f32_16x16x32_bf16 v[148:151], v[100:103], v[28:31], v[148:151]
    v_mfma_f32_16x16x32_bf16 v[172:175], v[100:103], v[32:35], v[172:175]
    s_waitcnt lgkmcnt(6)
    v_mfma_f32_16x16x32_bf16 v[152:155], v[28:31], v[104:107], v[152:155]
    v_mfma_f32_16x16x32_bf16 v[176:179], v[32:35], v[104:107], v[176:179]
    s_waitcnt lgkmcnt(4)
    v_mfma_f32_16x16x32_bf16 v[156:159], v[28:31], v[108:111], v[156:159]
    v_mfma_f32_16x16x32_bf16 v[180:183], v[32:35], v[108:111], v[180:183]
    s_waitcnt lgkmcnt(2)
    v_mfma_f32_16x16x32_bf16 v[184:187], v[112:115], v[36:39], v[184:187]
    s_waitcnt lgkmcnt(0)
    v_mfma_f32_16x16x32_bf16 v[188:191], v[116:119], v[36:39], v[188:191]
    s_mov_b32 s54, 0xfffefffe
    s_mov_b32 s55, 0xfffefffe
    v_mov_b32 v16, v224
    v_mov_b32 v17, v225
    v_mov_b32 v18, v226
    v_mov_b32 v19, v227
    v_mov_b32 v20, v228
    v_mov_b32 v21, v229
    v_permlane32_swap_b32 v224, v16
    v_permlane32_swap_b32 v225, v17
    v_permlane32_swap_b32 v226, v18
    v_permlane32_swap_b32 v227, v19
    v_permlane32_swap_b32 v228, v20
    v_permlane32_swap_b32 v229, v21
    v_add_f32 v224, v224, v16
    v_add_f32 v225, v225, v17
    v_add_f32 v226, v226, v18
    v_add_f32 v227, v227, v19
    v_add_f32 v228, v228, v20
    v_add_f32 v229, v229, v21
    v_mov_b32 v16, v224
    v_mov_b32 v17, v225
    v_mov_b32 v18, v226
    v_mov_b32 v19, v227
    v_mov_b32 v20, v228
    v_mov_b32 v21, v229
    v_permlane16_swap_b32 v224, v16
    v_permlane16_swap_b32 v225, v17
    v_permlane16_swap_b32 v226, v18
    v_permlane16_swap_b32 v227, v19
    v_permlane16_swap_b32 v228, v20
    v_permlane16_swap_b32 v229, v21
    v_add_f32 v224, v224, v16
    v_add_f32 v225, v225, v17
    v_add_f32 v226, v226, v18
    v_add_f32 v227, v227, v19
    v_add_f32 v228, v228, v20
    v_add_f32 v229, v229, v21
    v_mul_f32 v25, 0x3b124925, v224
    v_mul_f32 v24, v25, v25
    v_mul_f32 v225, 0x3b124925, v225
    v_sub_f32 v24, v225, v24
    v_max_f32 v24, 0, v24
    v_add_f32 v24, 0x3727c5ac, v24
    v_rsq_f32 v24, v24
    v_mul_f32 v27, 0x3b124925, v226
    v_mul_f32 v26, v27, v27
    v_mul_f32 v227, 0x3b124925, v227
    v_sub_f32 v26, v227, v26
    v_max_f32 v26, 0, v26
    v_add_f32 v26, 0x3727c5ac, v26
    v_rsq_f32 v26, v26
    v_mul_f32 v29, 0x3b124925, v228
    v_mul_f32 v28, v29, v29
    v_mul_f32 v229, 0x3b124925, v229
    v_sub_f32 v28, v229, v28
    v_max_f32 v28, 0, v28
    v_add_f32 v28, 0x3727c5ac, v28
    v_rsq_f32 v28, v28
    v_lshlrev_b32 v32, 4, v3
    s_lshl_b32 s53, s3, 6
    v_add_u32 v33, s53, v32
    s_and_b32 s53, s53, 64
    v_add_u32 v34, s53, v32
    s_not_b64 exec, s[54:55]
    ds_write_b128 v33, v[184:187] offset:128
    ds_write_b128 v34, v[188:191] offset:0
    s_mov_b64 exec, 0xffff
    s_lshl_b32 s53, s3, 8
    v_lshl_add_u32 v35, v2, 2, s53
    ds_write_b32 v35, v24 offset:512
    ds_write_b32 v35, v25 offset:576
    ds_write_b32 v35, v26 offset:640
    ds_write_b32 v35, v27 offset:704
    s_mov_b64 exec, -1
    v_mov_b32_dpp v40, v184 row_newbcast:0 row_mask:0xf bank_mask:0xf
    v_mov_b32_dpp v41, v185 row_newbcast:0 row_mask:0xf bank_mask:0xf
    v_mov_b32_dpp v42, v186 row_newbcast:0 row_mask:0xf bank_mask:0xf
    v_mov_b32_dpp v43, v187 row_newbcast:0 row_mask:0xf bank_mask:0xf
    v_fma_f32 v40, -v29, v40, v184
    v_fma_f32 v41, -v29, v41, v185
    v_fma_f32 v42, -v29, v42, v186
    v_fma_f32 v43, -v29, v43, v187
    v_mul_f32 v40, v28, v40
    v_mul_f32 v41, v28, v41
    v_mul_f32 v42, v28, v42
    v_mul_f32 v43, v28, v43
    v_cvt_pk_bf16_f32 v40, v40, v41
    v_cvt_pk_bf16_f32 v42, v42, v43
    s_and_b32 s53, s3, 1
    s_lshl_b32 s53, s53, 3
    v_add_u32 v44, s53, v4
    v_lshrrev_b32 v45, 2, v2
    v_lshlrev_b32 v45, 8, v45
    v_lshl_add_u32 v45, v3, 6, v45
    v_and_b32 v46, 3, v2
    v_lshl_add_u32 v45, v46, 1, v45
    v_add_u32 v45, s53, v45
    v_add_u32 v45, 1024, v45
    s_cmp_lt_u32 s3, 2
    s_cselect_b64 vcc, -1, 0
    s_cselect_b32 s53, 2, 16
    v_cndmask_b32 v44, v45, v44, vcc
    v_add_u32 v45, s53, v44
    v_add_u32 v46, s53, v45
    v_add_u32 v47, s53, v46
    ds_write_b16 v44, v40 offset:2048
    ds_write_b16_d16_hi v45, v40 offset:2048
    ds_write_b16 v46, v42 offset:2048
    ds_write_b16_d16_hi v47, v42 offset:2048
    s_waitcnt lgkmcnt(0)
    s_barrier
    s_add_u32 m0, s59, 69632
    s_mov_b32 s58, 200704
    buffer_load_dwordx4 v208, s[16:19], s58 offen lds
    s_add_u32 m0, s59, 70656
    s_mov_b32 s58, 215040
    buffer_load_dwordx4 v208, s[16:19], s58 offen lds
    s_add_u32 m0, s59, 71680
    s_mov_b32 s58, 229376
    buffer_load_dwordx4 v208, s[16:19], s58 offen lds
    s_add_u32 m0, s59, 72704
    s_mov_b32 s58, 243712
    buffer_load_dwordx4 v208, s[16:19], s58 offen lds
    s_add_u32 m0, s59, 73728
    s_mov_b32 s58, 258048
    buffer_load_dwordx4 v208, s[16:19], s58 offen lds
    s_add_u32 m0, s59, 74752
    s_mov_b32 s58, 272384
    buffer_load_dwordx4 v208, s[16:19], s58 offen lds
    s_add_u32 m0, s59, 75776
    s_mov_b32 s58, 286720
    buffer_load_dwordx4 v208, s[16:19], s58 offen lds
    s_add_u32 m0, s59, 40960
    s_mov_b32 s58, 301056
    buffer_load_dwordx4 v208, s[16:19], s58 offen lds
    s_add_u32 m0, s59, 41984
    s_mov_b32 s58, 315392
    buffer_load_dwordx4 v208, s[16:19], s58 offen lds
    s_add_u32 m0, s59, 43008
    s_mov_b32 s58, 329728
    buffer_load_dwordx4 v208, s[16:19], s58 offen lds
    s_add_u32 m0, s59, 44032
    s_mov_b32 s58, 344064
    buffer_load_dwordx4 v208, s[16:19], s58 offen lds
    s_add_u32 m0, s59, 45056
    s_mov_b32 s58, 358400
    buffer_load_dwordx4 v208, s[16:19], s58 offen lds
    s_add_u32 m0, s59, 46080
    s_mov_b32 s58, 372736
    buffer_load_dwordx4 v208, s[16:19], s58 offen lds
    s_add_u32 m0, s59, 47104
    s_mov_b32 s58, 387072
    buffer_load_dwordx4 v208, s[16:19], s58 offen lds
    ds_read_b128 v[48:51], v32 offset:0
    ds_read_b128 v[52:55], v32 offset:64
    ds_read_b128 v[56:59], v32 offset:128
    ds_read_b128 v[60:63], v32 offset:192
    v_lshlrev_b32 v33, 2, v2
    ds_read_b32 v64, v33 offset:256
    ds_read_b32 v65, v33 offset:320
    s_lshl_b32 s53, s3, 8
    v_add_u32 v34, s53, v32
    ds_read_b128 v[68:71], v34 offset:512
    ds_read_b128 v[72:75], v34 offset:576
    ds_read_b128 v[76:79], v34 offset:640
    ds_read_b128 v[80:83], v34 offset:704
    v_cmp_ne_u32 vcc, 3, v3
    v_mul_f32 v84, 0x3e8b97f6, v24
    v_mul_f32 v86, 0x3e8b97f6, v26
    v_cndmask_b32 v85, 0, v84, vcc
    v_cndmask_b32 v87, 0, v86, vcc
    s_waitcnt lgkmcnt(7)
    v_fma_f32 v168, -v27, v56, v168
    v_fma_f32 v169, -v27, v57, v169
    v_fma_f32 v170, -v27, v58, v170
    v_fma_f32 v171, -v27, v59, v171
    v_mul_f32 v168, v26, v168
    v_mul_f32 v169, v26, v169
    v_mul_f32 v170, v26, v170
    v_mul_f32 v171, v26, v171
    v_cvt_pk_bf16_f32 v104, v168, v169
    v_cvt_pk_bf16_f32 v105, v170, v171
    s_waitcnt lgkmcnt(6)
    v_fma_f32 v172, -v27, v60, v172
    v_fma_f32 v173, -v27, v61, v173
    v_fma_f32 v174, -v27, v62, v174
    v_fma_f32 v175, -v27, v63, v175
    v_mul_f32 v172, v26, v172
    v_mul_f32 v173, v26, v173
    v_mul_f32 v174, v26, v174
    v_mul_f32 v175, v26, v175
    v_cvt_pk_bf16_f32 v106, v172, v173
    v_cvt_pk_bf16_f32 v107, v174, v175
    s_waitcnt lgkmcnt(0)
    v_fma_f32 v176, -v80, v64, v176
    v_fma_f32 v177, -v81, v64, v177
    v_fma_f32 v178, -v82, v64, v178
    v_fma_f32 v179, -v83, v64, v179
    v_mul_f32 v176, v76, v176
    v_mul_f32 v177, v77, v177
    v_mul_f32 v178, v78, v178
    v_mul_f32 v179, v79, v179
    v_cvt_pk_bf16_f32 v112, v176, v177
    v_cvt_pk_bf16_f32 v113, v178, v179
    v_fma_f32 v180, -v80, v65, v180
    v_fma_f32 v181, -v81, v65, v181
    v_fma_f32 v182, -v82, v65, v182
    v_fma_f32 v183, -v83, v65, v183
    v_mul_f32 v180, v76, v180
    v_mul_f32 v181, v77, v181
    v_mul_f32 v182, v78, v182
    v_mul_f32 v183, v79, v183
    v_cvt_pk_bf16_f32 v118, v180, v181
    v_cvt_pk_bf16_f32 v119, v182, v183
    s_lshl_b32 s53, s3, 11
    v_add_u32 v35, s53, v4
    ds_write_b128 v35, v[104:107] offset:4096
    ds_write_b64 v35, v[112:113] offset:5120
    ds_write_b64 v35, v[118:119] offset:5128
    v_fma_f32 v144, -v25, v56, v144
    v_fma_f32 v145, -v25, v57, v145
    v_fma_f32 v146, -v25, v58, v146
    v_fma_f32 v147, -v25, v59, v147
    v_mul_f32 v144, v24, v144
    v_mul_f32 v145, v24, v145
    v_mul_f32 v146, v24, v146
    v_mul_f32 v147, v24, v147
    v_cvt_pk_bf16_f32 v100, v144, v145
    v_cvt_pk_bf16_f32 v101, v146, v147
    v_fma_f32 v148, -v25, v60, v148
    v_fma_f32 v149, -v25, v61, v149
    v_fma_f32 v150, -v25, v62, v150
    v_fma_f32 v151, -v25, v63, v151
    v_mul_f32 v148, v24, v148
    v_mul_f32 v149, v24, v149
    v_mul_f32 v150, v24, v150
    v_mul_f32 v151, v24, v151
    v_cvt_pk_bf16_f32 v102, v148, v149
    v_cvt_pk_bf16_f32 v103, v150, v151
    v_fma_f32 v160, -v27, v48, v160
    v_fma_f32 v161, -v27, v49, v161
    v_fma_f32 v162, -v27, v50, v162
    v_fma_f32 v163, -v27, v51, v163
    v_mul_f32 v160, v86, v160
    v_mul_f32 v161, v86, v161
    v_mul_f32 v162, v86, v162
    v_mul_f32 v163, v86, v163
    v_cvt_pk_bf16_f32 v92, v160, v161
    v_cvt_pk_bf16_f32 v93, v162, v163
    v_fma_f32 v164, -v27, v52, v164
    v_fma_f32 v165, -v27, v53, v165
    v_fma_f32 v166, -v27, v54, v166
    v_fma_f32 v167, -v27, v55, v167
    v_mul_f32 v164, v87, v164
    v_mul_f32 v165, v87, v165
    v_mul_f32 v166, v87, v166
    v_mul_f32 v167, v87, v167
    v_cvt_pk_bf16_f32 v94, v164, v165
    v_cvt_pk_bf16_f32 v95, v166, v167
    s_waitcnt lgkmcnt(0)
    s_barrier
    ds_read_b128 v[96:99], v35 offset:2048
    ds_read_b64 v[108:109], v35 offset:3072
    ds_read_b64 v[114:115], v35 offset:3080
    v_mfma_f32_16x16x32_bf16 v[128:131], v[100:103], v[92:95], v[240:243]
    v_mfma_f32_16x16x32_bf16 v[132:135], v[104:107], v[92:95], v[244:247]
    v_fma_f32 v136, -v25, v48, v136
    v_fma_f32 v137, -v25, v49, v137
    v_fma_f32 v138, -v25, v50, v138
    v_fma_f32 v139, -v25, v51, v139
    v_mul_f32 v136, v84, v136
    v_mul_f32 v137, v84, v137
    v_mul_f32 v138, v84, v138
    v_mul_f32 v139, v84, v139
    v_cvt_pk_bf16_f32 v88, v136, v137
    v_cvt_pk_bf16_f32 v89, v138, v139
    v_fma_f32 v140, -v25, v52, v140
    v_fma_f32 v141, -v25, v53, v141
    v_fma_f32 v142, -v25, v54, v142
    v_fma_f32 v143, -v25, v55, v143
    v_mul_f32 v140, v85, v140
    v_mul_f32 v141, v85, v141
    v_mul_f32 v142, v85, v142
    v_mul_f32 v143, v85, v143
    v_cvt_pk_bf16_f32 v90, v140, v141
    v_cvt_pk_bf16_f32 v91, v142, v143
    v_fma_f32 v152, -v72, v64, v152
    v_fma_f32 v153, -v73, v64, v153
    v_fma_f32 v154, -v74, v64, v154
    v_fma_f32 v155, -v75, v64, v155
    v_mul_f32 v152, v68, v152
    v_mul_f32 v153, v69, v153
    v_mul_f32 v154, v70, v154
    v_mul_f32 v155, v71, v155
    v_cvt_pk_bf16_f32 v110, v152, v153
    v_cvt_pk_bf16_f32 v111, v154, v155
    v_fma_f32 v156, -v72, v65, v156
    v_fma_f32 v157, -v73, v65, v157
    v_fma_f32 v158, -v74, v65, v158
    v_fma_f32 v159, -v75, v65, v159
    v_mul_f32 v156, v68, v156
    v_mul_f32 v157, v69, v157
    v_mul_f32 v158, v70, v158
    v_mul_f32 v159, v71, v159
    v_cvt_pk_bf16_f32 v116, v156, v157
    v_cvt_pk_bf16_f32 v117, v158, v159
    s_waitcnt lgkmcnt(2)
    v_mfma_f32_16x16x32_bf16 v[120:123], v[96:99], v[88:91], v[248:251]
    v_mfma_f32_16x16x32_bf16 v[124:127], v[100:103], v[88:91], v[244:247]
    v_max3_f32 v137, v128, v129, v130
    v_max3_f32 v139, v131, v132, v133
    v_max3_f32 v137, v137, v134, v135
    v_max_f32 v137, v137, v139
    s_nop 2
    v_max3_f32 v136, v120, v121, v122
    v_max3_f32 v138, v123, v124, v125
    v_max3_f32 v136, v136, v126, v127
    v_max_f32 v136, v136, v138
    v_mov_b32 v138, v136
    v_mov_b32 v139, v137
    s_nop 0
    v_permlane32_swap_b32 v136, v138
    v_permlane32_swap_b32 v137, v139
    v_max_f32 v136, v136, v138
    v_max_f32 v137, v137, v139
    v_mov_b32 v138, v136
    v_mov_b32 v139, v137
    s_nop 0
    v_permlane16_swap_b32 v136, v138
    v_permlane16_swap_b32 v137, v139
    v_max_f32 v136, v136, v138
    v_max_f32 v137, v137, v139
    v_sub_f32 v128, v128, v137
    v_sub_f32 v129, v129, v137
    v_sub_f32 v130, v130, v137
    v_sub_f32 v131, v131, v137
    v_sub_f32 v132, v132, v137
    v_sub_f32 v133, v133, v137
    v_sub_f32 v134, v134, v137
    v_sub_f32 v135, v135, v137
    v_exp_f32 v128, v128
    v_exp_f32 v129, v129
    v_exp_f32 v130, v130
    v_exp_f32 v131, v131
    v_exp_f32 v132, v132
    v_exp_f32 v133, v133
    v_exp_f32 v134, v134
    v_exp_f32 v135, v135
    v_cvt_pk_bf16_f32 v148, v128, v129
    v_cvt_pk_bf16_f32 v149, v130, v131
    v_cvt_pk_bf16_f32 v150, v132, v133
    v_cvt_pk_bf16_f32 v151, v134, v135
    v_sub_f32 v120, v120, v136
    v_sub_f32 v121, v121, v136
    v_sub_f32 v122, v122, v136
    v_sub_f32 v123, v123, v136
    v_sub_f32 v124, v124, v136
    v_sub_f32 v125, v125, v136
    v_sub_f32 v126, v126, v136
    v_sub_f32 v127, v127, v136
    v_exp_f32 v120, v120
    v_exp_f32 v121, v121
    v_exp_f32 v122, v122
    v_exp_f32 v123, v123
    v_exp_f32 v124, v124
    v_exp_f32 v125, v125
    v_exp_f32 v126, v126
    v_exp_f32 v127, v127
    v_cvt_pk_bf16_f32 v144, v120, v121
    v_cvt_pk_bf16_f32 v145, v122, v123
    v_cvt_pk_bf16_f32 v146, v124, v125
    v_cvt_pk_bf16_f32 v147, v126, v127
    v_mfma_f32_16x16x32_bf16 v[160:163], v[110:113], v[148:151], 0
    v_mfma_f32_16x16x32_bf16 v[164:167], v[116:119], v[148:151], 0
    s_waitcnt lgkmcnt(1)
    v_mfma_f32_16x16x32_bf16 v[152:155], v[108:111], v[144:147], 0
    s_waitcnt lgkmcnt(0)
    v_mfma_f32_16x16x32_bf16 v[156:159], v[114:117], v[144:147], 0
    v_add_f32 v140, v120, v121
    v_add_f32 v138, v122, v123
    v_add_f32 v140, v140, v124
    v_add_f32 v138, v138, v125
    v_add_f32 v140, v140, v126
    v_add_f32 v138, v138, v127
    v_add_f32 v140, v140, v138
    v_add_f32 v141, v128, v129
    v_add_f32 v139, v130, v131
    v_add_f32 v141, v141, v132
    v_add_f32 v139, v139, v133
    v_add_f32 v141, v141, v134
    v_add_f32 v139, v139, v135
    v_add_f32 v141, v141, v139
    v_mov_b32 v138, v140
    v_mov_b32 v139, v141
    s_nop 0
    v_permlane32_swap_b32 v140, v138
    v_permlane32_swap_b32 v141, v139
    v_add_f32 v140, v140, v138
    v_add_f32 v141, v141, v139
    v_mov_b32 v138, v140
    v_mov_b32 v139, v141
    s_nop 0
    v_permlane16_swap_b32 v140, v138
    v_permlane16_swap_b32 v141, v139
    v_add_f32 v140, v140, v138
    v_add_f32 v141, v141, v139
    v_cmp_ne_u32 vcc, 3, v3
    v_rcp_f32 v140, v140
    v_rcp_f32 v141, v141
    v_cndmask_b32 v138, 0, v140, vcc
    v_cndmask_b32 v139, 0, v141, vcc
    s_lshl_b32 s53, s48, 3
    s_lshl_b32 s50, s3, 1
    s_add_u32 s53, s53, s50
    s_lshl_b32 s53, s53, 4
    s_add_u32 s53, s53, s49
    s_lshl_b32 s53, s53, 10
    s_add_u32 s50, s53, 16384
    v_mul_f32 v152, v140, v152
    v_mul_f32 v153, v140, v153
    v_mul_f32 v154, v140, v154
    v_mul_f32 v155, v140, v155
    v_mul_f32 v156, v138, v156
    v_mul_f32 v157, v138, v157
    v_mul_f32 v158, v138, v158
    v_mul_f32 v159, v138, v159
    v_cvt_pk_bf16_f32 v144, v152, v153
    v_cvt_pk_bf16_f32 v145, v154, v155
    v_cvt_pk_bf16_f32 v146, v156, v157
    v_cvt_pk_bf16_f32 v147, v158, v159
    buffer_store_dwordx4 v[144:147], v4, s[40:43], s53 offen sc1
    v_mul_f32 v160, v141, v160
    v_mul_f32 v161, v141, v161
    v_mul_f32 v162, v141, v162
    v_mul_f32 v163, v141, v163
    v_mul_f32 v164, v139, v164
    v_mul_f32 v165, v139, v165
    v_mul_f32 v166, v139, v166
    v_mul_f32 v167, v139, v167
    v_cvt_pk_bf16_f32 v148, v160, v161
    v_cvt_pk_bf16_f32 v149, v162, v163
    v_cvt_pk_bf16_f32 v150, v164, v165
    v_cvt_pk_bf16_f32 v151, v166, v167
    buffer_store_dwordx4 v[148:151], v4, s[40:43], s50 offen sc1
    v_add_u32 v209, 0x21000, v209
    v_add_u32 v210, 0x21000, v210
    v_add_u32 v211, 0x21000, v211
    v_add_u32 v212, 0x21000, v212
    s_waitcnt vmcnt(39)
    ds_read_b64_tr_b16 a[0:1], v209 offset:0
    ds_read_b64_tr_b16 a[2:3], v211 offset:0
    ds_read_b64_tr_b16 a[4:5], v210 offset:0
    ds_read_b64_tr_b16 a[6:7], v212 offset:0
    ds_read_b64_tr_b16 a[8:9], v210 offset:1792
    ds_read_b64_tr_b16 a[10:11], v212 offset:1792
    ds_read_b64_tr_b16 a[12:13], v209 offset:1792
    ds_read_b64_tr_b16 a[14:15], v211 offset:1792
    ds_read_b64_tr_b16 a[16:17], v209 offset:3584
    ds_read_b64_tr_b16 a[18:19], v211 offset:3584
    ds_read_b64_tr_b16 a[20:21], v210 offset:3584
    ds_read_b64_tr_b16 a[22:23], v212 offset:3584
    ds_read_b64_tr_b16 a[24:25], v210 offset:5376
    ds_read_b64_tr_b16 a[26:27], v212 offset:5376
    ds_read_b64_tr_b16 a[28:29], v209 offset:5376
    ds_read_b64_tr_b16 a[30:31], v211 offset:5376
    v_add_u32 v209, 0xffff7000, v209
    v_add_u32 v210, 0xffff7000, v210
    v_add_u32 v211, 0xffff7000, v211
    v_add_u32 v212, 0xffff7000, v212
    s_waitcnt vmcnt(16)
    ds_read_b64_tr_b16 a[32:33], v209 offset:0
    ds_read_b64_tr_b16 a[34:35], v211 offset:0
    ds_read_b64_tr_b16 a[36:37], v210 offset:0
    ds_read_b64_tr_b16 a[38:39], v212 offset:0
    ds_read_b64_tr_b16 a[40:41], v210 offset:1792
    ds_read_b64_tr_b16 a[42:43], v212 offset:1792
    ds_read_b64_tr_b16 a[44:45], v209 offset:1792
    ds_read_b64_tr_b16 a[46:47], v211 offset:1792
    ds_read_b64_tr_b16 a[48:49], v209 offset:3584
    ds_read_b64_tr_b16 a[50:51], v211 offset:3584
    ds_read_b64_tr_b16 a[52:53], v210 offset:3584
    ds_read_b64_tr_b16 a[54:55], v212 offset:3584
    ds_read_b64_tr_b16 a[56:57], v210 offset:5376
    ds_read_b64_tr_b16 a[58:59], v212 offset:5376
    ds_read_b64_tr_b16 a[60:61], v209 offset:5376
    ds_read_b64_tr_b16 a[62:63], v211 offset:5376
    v_add_u32 v209, 0xffff9000, v209
    v_add_u32 v210, 0xffff9000, v210
    v_add_u32 v211, 0xffff9000, v211
    v_add_u32 v212, 0xffff9000, v212
    s_waitcnt vmcnt(9)
    ds_read_b64_tr_b16 a[64:65], v209 offset:0
    ds_read_b64_tr_b16 a[66:67], v211 offset:0
    ds_read_b64_tr_b16 a[68:69], v210 offset:0
    ds_read_b64_tr_b16 a[70:71], v212 offset:0
    ds_read_b64_tr_b16 a[72:73], v210 offset:1792
    ds_read_b64_tr_b16 a[74:75], v212 offset:1792
    ds_read_b64_tr_b16 a[76:77], v209 offset:1792
    ds_read_b64_tr_b16 a[78:79], v211 offset:1792
    ds_read_b64_tr_b16 a[80:81], v209 offset:3584
    ds_read_b64_tr_b16 a[82:83], v211 offset:3584
    ds_read_b64_tr_b16 a[84:85], v210 offset:3584
    ds_read_b64_tr_b16 a[86:87], v212 offset:3584
    ds_read_b64_tr_b16 a[88:89], v210 offset:5376
    ds_read_b64_tr_b16 a[90:91], v212 offset:5376
    ds_read_b64_tr_b16 a[92:93], v209 offset:5376
    ds_read_b64_tr_b16 a[94:95], v211 offset:5376
    v_add_u32 v209, 0xffff9000, v209
    v_add_u32 v210, 0xffff9000, v210
    v_add_u32 v211, 0xffff9000, v211
    v_add_u32 v212, 0xffff9000, v212
    s_waitcnt vmcnt(2)
    ds_read_b64_tr_b16 a[96:97], v209 offset:0
    ds_read_b64_tr_b16 a[98:99], v211 offset:0
    ds_read_b64_tr_b16 a[100:101], v210 offset:0
    ds_read_b64_tr_b16 a[102:103], v212 offset:0
    ds_read_b64_tr_b16 a[104:105], v210 offset:1792
    ds_read_b64_tr_b16 a[106:107], v212 offset:1792
    ds_read_b64_tr_b16 a[108:109], v209 offset:1792
    ds_read_b64_tr_b16 a[110:111], v211 offset:1792
    ds_read_b64_tr_b16 a[112:113], v209 offset:3584
    ds_read_b64_tr_b16 a[114:115], v211 offset:3584
    ds_read_b64_tr_b16 a[116:117], v210 offset:3584
    ds_read_b64_tr_b16 a[118:119], v212 offset:3584
    ds_read_b64_tr_b16 a[120:121], v210 offset:5376
    ds_read_b64_tr_b16 a[122:123], v212 offset:5376
    ds_read_b64_tr_b16 a[124:125], v209 offset:5376
    ds_read_b64_tr_b16 a[126:127], v211 offset:5376
    v_lshlrev_b32 v192, 16, v192
    v_lshlrev_b32 v193, 16, v193
    v_lshlrev_b32 v194, 16, v194
    v_lshlrev_b32 v195, 16, v195
    v_lshlrev_b32 v196, 16, v196
    v_lshlrev_b32 v197, 16, v197
    v_lshlrev_b32 v198, 16, v198
    v_lshlrev_b32 v199, 16, v199
    v_lshlrev_b32 v200, 16, v200
    v_lshlrev_b32 v201, 16, v201
    v_lshlrev_b32 v202, 16, v202
    v_lshlrev_b32 v203, 16, v203
    v_lshlrev_b32 v204, 16, v204
    v_lshlrev_b32 v205, 16, v205
    v_lshlrev_b32 v206, 16, v206
    v_lshlrev_b32 v207, 16, v207
    v_readfirstlane_b32 s4, v6
    s_nop 1
    s_cmp_lg_u32 s4, 0
    s_cbranch_scc1 Lepd_P_2
    s_nop 0
Lepg_P_1:
    s_sub_u32 s6, s6, 1
    s_cbranch_scc1 L_end_P
    buffer_load_dword v6, v7, s[44:47], 0 offen sc1
    s_waitcnt vmcnt(0)
    v_readfirstlane_b32 s4, v6
    s_nop 1
    s_cmp_eq_u32 s4, 0
    s_cbranch_scc1 Lepg_P_1
Lepd_P_2:
    s_waitcnt vmcnt(0)
    v_mov_b32 v8, s4
    s_mov_b64 exec, 1
    buffer_store_dword v8, v9, s[40:43], s80 offen sc1
    s_mov_b64 exec, -1
    s_waitcnt lgkmcnt(0)
    s_barrier
    s_add_u32 m0, s70, 0
    s_mov_b32 s68, 0
    buffer_load_dwordx4 v213, s[20:23], s68 offen lds
    s_add_u32 m0, s70, 1024
    s_mov_b32 s68, 28672
    buffer_load_dwordx4 v213, s[20:23], s68 offen lds
    s_add_u32 m0, s70, 2048
    s_mov_b32 s68, 57344
    buffer_load_dwordx4 v213, s[20:23], s68 offen lds
    s_add_u32 m0, s70, 3072
    s_mov_b32 s68, 86016
    buffer_load_dwordx4 v213, s[20:23], s68 offen lds
    s_add_u32 m0, s70, 4096
    s_mov_b32 s68, 114688
    buffer_load_dwordx4 v213, s[20:23], s68 offen lds
    s_add_u32 m0, s70, 5120
    s_mov_b32 s68, 143360
    buffer_load_dwordx4 v213, s[20:23], s68 offen lds
    s_add_u32 m0, s70, 6144
    s_mov_b32 s68, 172032
    buffer_load_dwordx4 v213, s[20:23], s68 offen lds
    s_add_u32 m0, s70, 7168
    s_mov_b32 s68, 200704
    buffer_load_dwordx4 v213, s[20:23], s68 offen lds
    s_add_u32 m0, s70, 8192
    s_mov_b32 s68, 229376
    buffer_load_dwordx4 v213, s[20:23], s68 offen lds
    s_add_u32 m0, s70, 9216
    s_mov_b32 s68, 258048
    buffer_load_dwordx4 v213, s[20:23], s68 offen lds
    s_add_u32 m0, s70, 10240
    s_mov_b32 s68, 286720
    buffer_load_dwordx4 v213, s[20:23], s68 offen lds
    s_add_u32 m0, s70, 11264
    s_mov_b32 s68, 315392
    buffer_load_dwordx4 v213, s[20:23], s68 offen lds
    s_add_u32 m0, s70, 12288
    s_mov_b32 s68, 344064
    buffer_load_dwordx4 v213, s[20:23], s68 offen lds
    s_add_u32 m0, s70, 13312
    s_mov_b32 s68, 372736
    buffer_load_dwordx4 v213, s[20:23], s68 offen lds
    s_add_u32 m0, s70, 14336
    s_mov_b32 s68, 401408
    buffer_load_dwordx4 v213, s[20:23], s68 offen lds
    s_add_u32 m0, s70, 15360
    s_mov_b32 s68, 430080
    buffer_load_dwordx4 v213, s[20:23], s68 offen lds
    s_add_u32 m0, s70, 16384
    s_mov_b32 s68, 458752
    buffer_load_dwordx4 v213, s[20:23], s68 offen lds
    s_add_u32 m0, s70, 17408
    s_mov_b32 s68, 487424
    buffer_load_dwordx4 v213, s[20:23], s68 offen lds
    s_add_u32 m0, s70, 18432
    s_mov_b32 s68, 516096
    buffer_load_dwordx4 v213, s[20:23], s68 offen lds
    s_add_u32 m0, s70, 19456
    s_mov_b32 s68, 544768
    buffer_load_dwordx4 v213, s[20:23], s68 offen lds
    s_add_u32 m0, s70, 20480
    s_mov_b32 s68, 573440
    buffer_load_dwordx4 v213, s[20:23], s68 offen lds
    s_add_u32 m0, s70, 21504
    s_mov_b32 s68, 602112
    buffer_load_dwordx4 v213, s[20:23], s68 offen lds
    s_add_u32 m0, s70, 22528
    s_mov_b32 s68, 630784
    buffer_load_dwordx4 v213, s[20:23], s68 offen lds
    s_add_u32 m0, s70, 23552
    s_mov_b32 s68, 659456
    buffer_load_dwordx4 v213, s[20:23], s68 offen lds
    s_nop 1
Lpoll_P_3:
    s_sub_u32 s6, s6, 1
    s_cbranch_scc1 L_end_P
    buffer_load_dword v8, v10, s[40:43], s83 offen sc1
    s_waitcnt vmcnt(0)
    v_cmp_ne_u32 vcc, s4, v8
    s_nop 1
    s_cbranch_vccnz Lpoll_P_3
    s_lshl_b32 s58, s56, 15
    s_lshl_b32 s60, s3, 13
    s_add_u32 s58, s58, s60
    s_add_u32 m0, s60, 12288
    s_nop 0
    buffer_load_dwordx4 v4, s[40:43], s58 offen offset:0 sc1 lds
    buffer_load_dwordx4 v4, s[40:43], s58 offen offset:1024 sc1 lds
    buffer_load_dwordx4 v4, s[40:43], s58 offen offset:2048 sc1 lds
    buffer_load_dwordx4 v4, s[40:43], s58 offen offset:3072 sc1 lds
    s_add_u32 m0, s60, 16384
    s_add_u32 s58, s58, 4096
    buffer_load_dwordx4 v4, s[40:43], s58 offen offset:0 sc1 lds
    buffer_load_dwordx4 v4, s[40:43], s58 offen offset:1024 sc1 lds
    buffer_load_dwordx4 v4, s[40:43], s58 offen offset:2048 sc1 lds
    buffer_load_dwordx4 v4, s[40:43], s58 offen offset:3072 sc1 lds
    v_add_u32 v64, 12288, v4
    s_cmp_lg_u32 s3, 3
    s_cselect_b32 s61, 1.0, 0
    ds_read_b64_tr_b16 a[128:129], v215 offset:0
    ds_read_b64_tr_b16 a[130:131], v215 offset:512
    ds_read_b64_tr_b16 a[132:133], v216 offset:0
    ds_read_b64_tr_b16 a[134:135], v216 offset:512
    ds_read_b64_tr_b16 a[136:137], v215 offset:2048
    ds_read_b64_tr_b16 a[138:139], v215 offset:2560
    ds_read_b64_tr_b16 a[140:141], v216 offset:2048
    ds_read_b64_tr_b16 a[142:143], v216 offset:2560
    ds_read_b64_tr_b16 a[144:145], v215 offset:4096
    ds_read_b64_tr_b16 a[146:147], v215 offset:4608
    ds_read_b64_tr_b16 a[148:149], v216 offset:4096
    ds_read_b64_tr_b16 a[150:151], v216 offset:4608
    ds_read_b64_tr_b16 a[152:153], v215 offset:6144
    ds_read_b64_tr_b16 a[154:155], v215 offset:6656
    ds_read_b64_tr_b16 a[156:157], v216 offset:6144
    ds_read_b64_tr_b16 a[158:159], v216 offset:6656
    ds_read_b64_tr_b16 a[160:161], v215 offset:8192
    ds_read_b64_tr_b16 a[162:163], v215 offset:8704
    ds_read_b64_tr_b16 a[164:165], v216 offset:8192
    ds_read_b64_tr_b16 a[166:167], v216 offset:8704
    ds_read_b64_tr_b16 a[168:169], v215 offset:10240
    ds_read_b64_tr_b16 a[170:171], v215 offset:10752
    ds_read_b64_tr_b16 a[172:173], v216 offset:10240
    ds_read_b64_tr_b16 a[174:175], v216 offset:10752
    ds_read_b64_tr_b16 a[176:177], v215 offset:12288
    ds_read_b64_tr_b16 a[178:179], v215 offset:12800
    ds_read_b64_tr_b16 a[180:181], v216 offset:12288
    ds_read_b64_tr_b16 a[182:183], v216 offset:12800
    ds_read_b64_tr_b16 a[184:185], v215 offset:14336
    ds_read_b64_tr_b16 a[186:187], v215 offset:14848
    ds_read_b64_tr_b16 a[188:189], v216 offset:14336
    ds_read_b64_tr_b16 a[190:191], v216 offset:14848
    ds_read_b64_tr_b16 a[192:193], v215 offset:16384
    ds_read_b64_tr_b16 a[194:195], v215 offset:16896
    ds_read_b64_tr_b16 a[196:197], v216 offset:16384
    ds_read_b64_tr_b16 a[198:199], v216 offset:16896
    ds_read_b64_tr_b16 a[200:201], v215 offset:18432
    ds_read_b64_tr_b16 a[202:203], v215 offset:18944
    ds_read_b64_tr_b16 a[204:205], v216 offset:18432
    ds_read_b64_tr_b16 a[206:207], v216 offset:18944
    ds_read_b64_tr_b16 a[208:209], v215 offset:20480
    ds_read_b64_tr_b16 a[210:211], v215 offset:20992
    ds_read_b64_tr_b16 a[212:213], v216 offset:20480
    ds_read_b64_tr_b16 a[214:215], v216 offset:20992
    ds_read_b64_tr_b16 a[216:217], v215 offset:22528
    ds_read_b64_tr_b16 a[218:219], v215 offset:23040
    ds_read_b64_tr_b16 a[220:221], v216 offset:22528
    ds_read_b64_tr_b16 a[222:223], v216 offset:23040
    s_waitcnt lgkmcnt(0)
    s_add_u32 m0, s70, 0
    s_mov_b32 s68, 688128
    buffer_load_dwordx4 v213, s[20:23], s68 offen lds
    s_add_u32 m0, s70, 1024
    s_mov_b32 s68, 716800
    buffer_load_dwordx4 v213, s[20:23], s68 offen lds
    s_add_u32 m0, s70, 2048
    s_mov_b32 s68, 745472
    buffer_load_dwordx4 v213, s[20:23], s68 offen lds
    s_add_u32 m0, s70, 3072
    s_mov_b32 s68, 774144
    buffer_load_dwordx4 v213, s[20:23], s68 offen lds
    s_add_u32 m0, s70, 4096
    s_mov_b32 s68, 802816
    buffer_load_dwordx4 v213, s[20:23], s68 offen lds
    s_add_u32 m0, s70, 5120
    s_mov_b32 s68, 831488
    buffer_load_dwordx4 v213, s[20:23], s68 offen lds
    s_add_u32 m0, s70, 6144
    s_mov_b32 s68, 860160
    buffer_load_dwordx4 v213, s[20:23], s68 offen lds
    s_add_u32 m0, s70, 7168
    s_mov_b32 s68, 888832
    buffer_load_dwordx4 v213, s[20:23], s68 offen lds
    s_add_u32 m0, s70, 8192
    s_mov_b32 s68, 917504
    buffer_load_dwordx4 v213, s[20:23], s68 offen lds
    s_add_u32 m0, s70, 9216
    s_mov_b32 s68, 946176
    buffer_load_dwordx4 v213, s[20:23], s68 offen lds
    s_add_u32 m0, s70, 10240
    s_mov_b32 s68, 974848
    buffer_load_dwordx4 v213, s[20:23], s68 offen lds
    s_add_u32 m0, s70, 11264
    s_mov_b32 s68, 1003520
    buffer_load_dwordx4 v213, s[20:23], s68 offen lds
    s_add_u32 m0, s70, 12288
    s_mov_b32 s68, 1032192
    buffer_load_dwordx4 v213, s[20:23], s68 offen lds
    s_add_u32 m0, s70, 13312
    s_mov_b32 s68, 1060864
    buffer_load_dwordx4 v213, s[20:23], s68 offen lds
    s_add_u32 m0, s70, 14336
    s_mov_b32 s68, 1089536
    buffer_load_dwordx4 v213, s[20:23], s68 offen lds
    s_add_u32 m0, s70, 15360
    s_mov_b32 s68, 1118208
    buffer_load_dwordx4 v213, s[20:23], s68 offen lds
    s_add_u32 m0, s70, 16384
    s_mov_b32 s68, 1146880
    buffer_load_dwordx4 v213, s[20:23], s68 offen lds
    s_add_u32 m0, s70, 17408
    s_mov_b32 s68, 1175552
    buffer_load_dwordx4 v213, s[20:23], s68 offen lds
    s_add_u32 m0, s70, 18432
    s_mov_b32 s68, 1204224
    buffer_load_dwordx4 v213, s[20:23], s68 offen lds
    s_add_u32 m0, s70, 19456
    s_mov_b32 s68, 1232896
    buffer_load_dwordx4 v213, s[20:23], s68 offen lds
    s_add_u32 m0, s70, 20480
    s_mov_b32 s68, 1261568
    buffer_load_dwordx4 v213, s[20:23], s68 offen lds
    s_add_u32 m0, s70, 21504
    s_mov_b32 s68, 1290240
    buffer_load_dwordx4 v213, s[20:23], s68 offen lds
    s_add_u32 m0, s70, 22528
    s_mov_b32 s68, 1318912
    buffer_load_dwordx4 v213, s[20:23], s68 offen lds
    s_add_u32 m0, s70, 23552
    s_mov_b32 s68, 1347584
    buffer_load_dwordx4 v213, s[20:23], s68 offen lds
    s_waitcnt vmcnt(24)
    s_barrier
    ds_read_b128 v[32:35], v64 offset:0
    ds_read_b128 v[36:39], v64 offset:16384
    ds_read_b128 v[40:43], v64 offset:1024
    ds_read_b128 v[44:47], v64 offset:17408
    ds_read_b128 v[48:51], v64 offset:2048
    ds_read_b128 v[52:55], v64 offset:18432
    ds_read_b128 v[56:59], v64 offset:3072
    ds_read_b128 v[60:63], v64 offset:19456
    s_waitcnt lgkmcnt(7)
    v_mfma_f32_16x16x32_bf16 v[192:195], v[32:35], a[0:3], v[192:195]
    v_mfma_f32_16x16x32_bf16 v[196:199], v[32:35], a[4:7], v[196:199]
    ds_read_b128 v[32:35], v64 offset:4096
    s_waitcnt lgkmcnt(7)
    v_mfma_f32_16x16x32_bf16 v[200:203], v[36:39], a[0:3], v[200:203]
    v_mfma_f32_16x16x32_bf16 v[204:207], v[36:39], a[4:7], v[204:207]
    ds_read_b128 v[36:39], v64 offset:20480
    s_waitcnt lgkmcnt(7)
    v_mfma_f32_16x16x32_bf16 v[192:195], v[40:43], a[8:11], v[192:195]
    v_mfma_f32_16x16x32_bf16 v[196:199], v[40:43], a[12:15], v[196:199]
    ds_read_b128 v[40:43], v64 offset:5120
    s_waitcnt lgkmcnt(7)
    v_mfma_f32_16x16x32_bf16 v[200:203], v[44:47], a[8:11], v[200:203]
    v_mfma_f32_16x16x32_bf16 v[204:207], v[44:47], a[12:15], v[204:207]
    ds_read_b128 v[44:47], v64 offset:21504
    s_waitcnt lgkmcnt(7)
    v_mfma_f32_16x16x32_bf16 v[192:195], v[48:51], a[16:19], v[192:195]
    v_mfma_f32_16x16x32_bf16 v[196:199], v[48:51], a[20:23], v[196:199]
    ds_read_b128 v[48:51], v64 offset:6144
    s_waitcnt lgkmcnt(7)
    v_mfma_f32_16x16x32_bf16 v[200:203], v[52:55], a[16:19], v[200:203]
    v_mfma_f32_16x16x32_bf16 v[204:207], v[52:55], a[20:23], v[204:207]
    ds_read_b128 v[52:55], v64 offset:22528
    s_waitcnt lgkmcnt(7)
    v_mfma_f32_16x16x32_bf16 v[192:195], v[56:59], a[24:27], v[192:195]
    v_mfma_f32_16x16x32_bf16 v[196:199], v[56:59], a[28:31], v[196:199]
    ds_read_b128 v[56:59], v64 offset:7168
    s_waitcnt lgkmcnt(7)
    v_mfma_f32_16x16x32_bf16 v[200:203], v[60:63], a[24:27], v[200:203]
    v_mfma_f32_16x16x32_bf16 v[204:207], v[60:63], a[28:31], v[204:207]
    ds_read_b128 v[60:63], v64 offset:23552
    s_waitcnt lgkmcnt(7)
    v_mfma_f32_16x16x32_bf16 v[192:195], v[32:35], a[32:35], v[192:195]
    v_mfma_f32_16x16x32_bf16 v[196:199], v[32:35], a[36:39], v[196:199]
    ds_read_b128 v[32:35], v64 offset:8192
    s_waitcnt lgkmcnt(7)
    v_mfma_f32_16x16x32_bf16 v[200:203], v[36:39], a[32:35], v[200:203]
    v_mfma_f32_16x16x32_bf16 v[204:207], v[36:39], a[36:39], v[204:207]
    ds_read_b128 v[36:39], v64 offset:24576
    s_waitcnt lgkmcnt(7)
    v_mfma_f32_16x16x32_bf16 v[192:195], v[40:43], a[40:43], v[192:195]
    v_mfma_f32_16x16x32_bf16 v[196:199], v[40:43], a[44:47], v[196:199]
    ds_read_b128 v[40:43], v64 offset:9216
    s_waitcnt lgkmcnt(7)
    v_mfma_f32_16x16x32_bf16 v[200:203], v[44:47], a[40:43], v[200:203]
    v_mfma_f32_16x16x32_bf16 v[204:207], v[44:47], a[44:47], v[204:207]
    ds_read_b128 v[44:47], v64 offset:25600
    s_waitcnt lgkmcnt(7)
    v_mfma_f32_16x16x32_bf16 v[192:195], v[48:51], a[48:51], v[192:195]
    v_mfma_f32_16x16x32_bf16 v[196:199], v[48:51], a[52:55], v[196:199]
    ds_read_b128 v[48:51], v64 offset:10240
    s_waitcnt lgkmcnt(7)
    v_mfma_f32_16x16x32_bf16 v[200:203], v[52:55], a[48:51], v[200:203]
    v_mfma_f32_16x16x32_bf16 v[204:207], v[52:55], a[52:55], v[204:207]
    ds_read_b128 v[52:55], v64 offset:26624
    s_waitcnt lgkmcnt(7)
    v_mfma_f32_16x16x32_bf16 v[192:195], v[56:59], a[56:59], v[192:195]
    v_mfma_f32_16x16x32_bf16 v[196:199], v[56:59], a[60:63], v[196:199]
    ds_read_b128 v[56:59], v64 offset:11264
    s_waitcnt lgkmcnt(7)
    v_mfma_f32_16x16x32_bf16 v[200:203], v[60:63], a[56:59], v[200:203]
    v_mfma_f32_16x16x32_bf16 v[204:207], v[60:63], a[60:63], v[204:207]
    ds_read_b128 v[60:63], v64 offset:27648
    s_waitcnt lgkmcnt(7)
    v_mfma_f32_16x16x32_bf16 v[192:195], v[32:35], a[64:67], v[192:195]
    v_mfma_f32_16x16x32_bf16 v[196:199], v[32:35], a[68:71], v[196:199]
    ds_read_b128 v[32:35], v64 offset:12288
    s_waitcnt lgkmcnt(7)
    v_mfma_f32_16x16x32_bf16 v[200:203], v[36:39], a[64:67], v[200:203]
    v_mfma_f32_16x16x32_bf16 v[204:207], v[36:39], a[68:71], v[204:207]
    ds_read_b128 v[36:39], v64 offset:28672
    s_waitcnt lgkmcnt(7)
    v_mfma_f32_16x16x32_bf16 v[192:195], v[40:43], a[72:75], v[192:195]
    v_mfma_f32_16x16x32_bf16 v[196:199], v[40:43], a[76:79], v[196:199]
    ds_read_b128 v[40:43], v64 offset:13312
    s_waitcnt lgkmcnt(7)
    v_mfma_f32_16x16x32_bf16 v[200:203], v[44:47], a[72:75], v[200:203]
    v_mfma_f32_16x16x32_bf16 v[204:207], v[44:47], a[76:79], v[204:207]
    ds_read_b128 v[44:47], v64 offset:29696
    s_waitcnt lgkmcnt(7)
    v_mfma_f32_16x16x32_bf16 v[192:195], v[48:51], a[80:83], v[192:195]
    v_mfma_f32_16x16x32_bf16 v[196:199], v[48:51], a[84:87], v[196:199]
    ds_read_b128 v[48:51], v64 offset:14336
    s_waitcnt lgkmcnt(7)
    v_mfma_f32_16x16x32_bf16 v[200:203], v[52:55], a[80:83], v[200:203]
    v_mfma_f32_16x16x32_bf16 v[204:207], v[52:55], a[84:87], v[204:207]
    ds_read_b128 v[52:55], v64 offset:30720
    s_waitcnt lgkmcnt(7)
    v_mfma_f32_16x16x32_bf16 v[192:195], v[56:59], a[88:91], v[192:195]
    v_mfma_f32_16x16x32_bf16 v[196:199], v[56:59], a[92:95], v[196:199]
    ds_read_b128 v[56:59], v64 offset:15360
    s_waitcnt lgkmcnt(7)
    v_mfma_f32_16x16x32_bf16 v[200:203], v[60:63], a[88:91], v[200:203]
    v_mfma_f32_16x16x32_bf16 v[204:207], v[60:63], a[92:95], v[204:207]
    ds_read_b128 v[60:63], v64 offset:31744
    s_waitcnt lgkmcnt(7)
    v_mfma_f32_16x16x32_bf16 v[192:195], v[32:35], a[96:99], v[192:195]
    v_mfma_f32_16x16x32_bf16 v[196:199], v[32:35], a[100:103], v[196:199]
    s_waitcnt lgkmcnt(6)
    v_mfma_f32_16x16x32_bf16 v[200:203], v[36:39], a[96:99], v[200:203]
    v_mfma_f32_16x16x32_bf16 v[204:207], v[36:39], a[100:103], v[204:207]
    s_waitcnt lgkmcnt(5)
    v_mfma_f32_16x16x32_bf16 v[192:195], v[40:43], a[104:107], v[192:195]
    v_mfma_f32_16x16x32_bf16 v[196:199], v[40:43], a[108:111], v[196:199]
    s_waitcnt lgkmcnt(4)
    v_mfma_f32_16x16x32_bf16 v[200:203], v[44:47], a[104:107], v[200:203]
    v_mfma_f32_16x16x32_bf16 v[204:207], v[44:47], a[108:111], v[204:207]
    s_waitcnt lgkmcnt(3)
    v_mfma_f32_16x16x32_bf16 v[192:195], v[48:51], a[112:115], v[192:195]
    v_mfma_f32_16x16x32_bf16 v[196:199], v[48:51], a[116:119], v[196:199]
    s_waitcnt lgkmcnt(2)
    v_mfma_f32_16x16x32_bf16 v[200:203], v[52:55], a[112:115], v[200:203]
    v_mfma_f32_16x16x32_bf16 v[204:207], v[52:55], a[116:119], v[204:207]
    s_waitcnt lgkmcnt(1)
    v_mfma_f32_16x16x32_bf16 v[192:195], v[56:59], a[120:123], v[192:195]
    v_mfma_f32_16x16x32_bf16 v[196:199], v[56:59], a[124:127], v[196:199]
    s_waitcnt lgkmcnt(0)
    v_mfma_f32_16x16x32_bf16 v[200:203], v[60:63], a[120:123], v[200:203]
    v_mfma_f32_16x16x32_bf16 v[204:207], v[60:63], a[124:127], v[204:207]
    s_nop 4
    v_mul_f32 v84, s61, v196
    v_mul_f32 v85, s61, v197
    v_mul_f32 v86, s61, v198
    v_mul_f32 v87, s61, v199
    v_mul_f32 v88, s61, v204
    v_mul_f32 v89, s61, v205
    v_mul_f32 v90, s61, v206
    v_mul_f32 v91, s61, v207
    v_add_f32 v68, v192, v84
    v_mul_f32 v72, v192, v192
    v_add_f32 v70, v193, v85
    v_mul_f32 v74, v193, v193
    v_add_f32 v69, v194, v86
    v_mul_f32 v73, v194, v194
    v_add_f32 v71, v195, v87
    v_mul_f32 v75, v195, v195
    v_fmac_f32 v72, v84, v84
    v_fmac_f32 v74, v85, v85
    v_fmac_f32 v73, v86, v86
    v_fmac_f32 v75, v87, v87
    v_add_f32 v76, v200, v88
    v_mul_f32 v80, v200, v200
    v_add_f32 v78, v201, v89
    v_mul_f32 v82, v201, v201
    v_add_f32 v77, v202, v90
    v_mul_f32 v81, v202, v202
    v_add_f32 v79, v203, v91
    v_mul_f32 v83, v203, v203
    v_fmac_f32 v80, v88, v88
    v_fmac_f32 v82, v89, v89
    v_fmac_f32 v81, v90, v90
    v_fmac_f32 v83, v91, v91
    v_add_f32_dpp v68, v68, v68 row_mirror row_mask:0xf bank_mask:0x3
    v_add_f32_dpp v70, v70, v70 row_mirror row_mask:0xf bank_mask:0x3
    v_add_f32_dpp v72, v72, v72 row_mirror row_mask:0xf bank_mask:0x3
    v_add_f32_dpp v74, v74, v74 row_mirror row_mask:0xf bank_mask:0x3
    v_add_f32_dpp v76, v76, v76 row_mirror row_mask:0xf bank_mask:0x3
    v_add_f32_dpp v78, v78, v78 row_mirror row_mask:0xf bank_mask:0x3
    v_add_f32_dpp v80, v80, v80 row_mirror row_mask:0xf bank_mask:0x3
    v_add_f32_dpp v82, v82, v82 row_mirror row_mask:0xf bank_mask:0x3
    v_add_f32_dpp v68, v69, v69 row_mirror row_mask:0xf bank_mask:0xc
    v_add_f32_dpp v70, v71, v71 row_mirror row_mask:0xf bank_mask:0xc
    v_add_f32_dpp v72, v73, v73 row_mirror row_mask:0xf bank_mask:0xc
    v_add_f32_dpp v74, v75, v75 row_mirror row_mask:0xf bank_mask:0xc
    v_add_f32_dpp v76, v77, v77 row_mirror row_mask:0xf bank_mask:0xc
    v_add_f32_dpp v78, v79, v79 row_mirror row_mask:0xf bank_mask:0xc
    v_add_f32_dpp v80, v81, v81 row_mirror row_mask:0xf bank_mask:0xc
    v_add_f32_dpp v82, v83, v83 row_mirror row_mask:0xf bank_mask:0xc
    v_add_f32_dpp v68, v68, v68 row_half_mirror row_mask:0xf bank_mask:0x5
    v_add_f32_dpp v72, v72, v72 row_half_mirror row_mask:0xf bank_mask:0x5
    v_add_f32_dpp v76, v76, v76 row_half_mirror row_mask:0xf bank_mask:0x5
    v_add_f32_dpp v80, v80, v80 row_half_mirror row_mask:0xf bank_mask:0x5
    v_add_f32_dpp v68, v70, v70 row_half_mirror row_mask:0xf bank_mask:0xa
    v_add_f32_dpp v72, v74, v74 row_half_mirror row_mask:0xf bank_mask:0xa
    v_add_f32_dpp v76, v78, v78 row_half_mirror row_mask:0xf bank_mask:0xa
    v_add_f32_dpp v80, v82, v82 row_half_mirror row_mask:0xf bank_mask:0xa
    v_add_f32_dpp v69, v68, v68 quad_perm:[1,0,3,2] row_mask:0xf bank_mask:0xf
    v_add_f32_dpp v73, v72, v72 quad_perm:[1,0,3,2] row_mask:0xf bank_mask:0xf
    v_add_f32_dpp v77, v76, v76 quad_perm:[1,0,3,2] row_mask:0xf bank_mask:0xf
    v_add_f32_dpp v81, v80, v80 quad_perm:[1,0,3,2] row_mask:0xf bank_mask:0xf
    v_add_f32_dpp v84, v69, v69 quad_perm:[2,3,0,1] row_mask:0xf bank_mask:0xf
    v_add_f32_dpp v85, v73, v73 quad_perm:[2,3,0,1] row_mask:0xf bank_mask:0xf
    v_add_f32_dpp v86, v77, v77 quad_perm:[2,3,0,1] row_mask:0xf bank_mask:0xf
    v_add_f32_dpp v87, v81, v81 quad_perm:[2,3,0,1] row_mask:0xf bank_mask:0xf
    v_lshrrev_b32 v65, 2, v1
    s_lshl_b32 s58, s3, 8
    v_lshl_add_u32 v65, v65, 3, s58
    ds_write_b64 v65, v[84:85] offset:0
    ds_write_b64 v65, v[86:87] offset:128
    v_and_b32 v67, 31, v1
    v_lshrrev_b32 v66, 5, v1
    v_lshlrev_b32 v66, 9, v66
    v_lshl_add_u32 v65, v67, 4, v66
    v_lshl_add_u32 v66, v67, 3, v66
    s_lshl_b32 s58, s56, 11
    s_add_u32 s58, s58, 0x800000
    s_lshl_b32 s60, s57, 9
    s_add_u32 s60, s60, s58
    s_waitcnt lgkmcnt(0)
    s_barrier
    ds_read_b64 v[68:69], v66 offset:0
    ds_read_b64 v[70:71], v66 offset:256
    s_waitcnt lgkmcnt(0)
    v_add_f32 v72, v68, v70
    v_add_f32 v74, v69, v71
    v_mov_b32 v68, v72
    v_mov_b32 v69, v74
    s_nop 0
    v_permlane32_swap_b32 v72, v68
    v_permlane32_swap_b32 v74, v69
    v_add_f32 v72, v72, v68
    v_add_f32 v74, v74, v69
    v_mov_b32 v73, s4
    v_mov_b32 v75, s4
    s_cmp_eq_u32 s3, 0
    s_cselect_b32 exec_lo, -1, 0
    s_mov_b32 exec_hi, 0
    buffer_store_dwordx4 v[72:75], v65, s[40:43], s60 offen sc1
    s_mov_b64 exec, -1
    v_lshrrev_b32 v92, 1, v3
    v_lshlrev_b32 v92, 5, v92
    v_add_u32 v92, v92, v2
    v_lshlrev_b32 v92, 4, v92
    v_and_b32 v93, 1, v3
    v_lshl_add_u32 v92, v93, 3, v92
    s_cmp_eq_u32 s3, 3
    s_cselect_b32 s62, 0x40000000, 0
    v_add_u32 v93, s62, v92
    s_mul_i32 s62, s57, 7
    s_lshl_b32 s60, s3, 1
    s_add_u32 s62, s62, s60
    s_and_b32 s60, s62, 1
    s_lshl_b32 s60, s60, 8
    s_lshr_b32 s62, s62, 1
    s_lshl_b32 s62, s62, 17
    s_add_u32 s62, s62, s60
    s_lshl_b32 s60, s56, 11
    s_add_u32 s62, s62, s60
    s_add_u32 s62, s62, 0x400000
    s_mul_i32 s63, s57, 7
    s_lshl_b32 s60, s3, 1
    s_add_u32 s63, s63, s60
    s_add_u32 s63, s63, 1
    s_and_b32 s60, s63, 1
    s_lshl_b32 s60, s60, 8
    s_lshr_b32 s63, s63, 1
    s_lshl_b32 s63, s63, 17
    s_add_u32 s63, s63, s60
    s_lshl_b32 s60, s56, 11
    s_add_u32 s63, s63, s60
    s_add_u32 s63, s63, 0x400000
    v_cvt_pk_bf16_f32 v76, v192, v193
    v_cvt_pk_bf16_f32 v77, v194, v195
    buffer_store_dwordx2 v[76:77], v92, s[40:43], s62 offen offset:0 sc1
    v_cvt_pk_bf16_f32 v78, v196, v197
    v_cvt_pk_bf16_f32 v79, v198, v199
    buffer_store_dwordx2 v[78:79], v93, s[40:43], s63 offen offset:0 sc1
    v_cvt_pk_bf16_f32 v80, v200, v201
    v_cvt_pk_bf16_f32 v81, v202, v203
    buffer_store_dwordx2 v[80:81], v92, s[40:43], s62 offen offset:1024 sc1
    v_cvt_pk_bf16_f32 v82, v204, v205
    v_cvt_pk_bf16_f32 v83, v206, v207
    buffer_store_dwordx2 v[82:83], v93, s[40:43], s63 offen offset:1024 sc1
    s_sub_u32 s62, s62, 0x200000
    s_sub_u32 s63, s63, 0x200000
    s_waitcnt vmcnt(5)
    ds_read_b64_tr_b16 a[224:225], v215 offset:0
    ds_read_b64_tr_b16 a[226:227], v215 offset:512
    ds_read_b64_tr_b16 a[228:229], v216 offset:0
    ds_read_b64_tr_b16 a[230:231], v216 offset:512
    ds_read_b64_tr_b16 a[232:233], v215 offset:2048
    ds_read_b64_tr_b16 a[234:235], v215 offset:2560
    ds_read_b64_tr_b16 a[236:237], v216 offset:2048
    ds_read_b64_tr_b16 a[238:239], v216 offset:2560
    ds_read_b64_tr_b16 a[240:241], v215 offset:4096
    ds_read_b64_tr_b16 a[242:243], v215 offset:4608
    ds_read_b64_tr_b16 a[244:245], v216 offset:4096
    ds_read_b64_tr_b16 a[246:247], v216 offset:4608
    ds_read_b64_tr_b16 a[248:249], v215 offset:6144
    ds_read_b64_tr_b16 a[250:251], v215 offset:6656
    ds_read_b64_tr_b16 a[252:253], v216 offset:6144
    ds_read_b64_tr_b16 a[254:255], v216 offset:6656
    ds_read_b64_tr_b16 a[0:1], v215 offset:8192
    ds_read_b64_tr_b16 a[2:3], v215 offset:8704
    ds_read_b64_tr_b16 a[4:5], v216 offset:8192
    ds_read_b64_tr_b16 a[6:7], v216 offset:8704
    ds_read_b64_tr_b16 a[8:9], v215 offset:10240
    ds_read_b64_tr_b16 a[10:11], v215 offset:10752
    ds_read_b64_tr_b16 a[12:13], v216 offset:10240
    ds_read_b64_tr_b16 a[14:15], v216 offset:10752
    ds_read_b64_tr_b16 a[16:17], v215 offset:12288
    ds_read_b64_tr_b16 a[18:19], v215 offset:12800
    ds_read_b64_tr_b16 a[20:21], v216 offset:12288
    ds_read_b64_tr_b16 a[22:23], v216 offset:12800
    ds_read_b64_tr_b16 a[24:25], v215 offset:14336
    ds_read_b64_tr_b16 a[26:27], v215 offset:14848
    ds_read_b64_tr_b16 a[28:29], v216 offset:14336
    ds_read_b64_tr_b16 a[30:31], v216 offset:14848
    ds_read_b64_tr_b16 a[32:33], v215 offset:16384
    ds_read_b64_tr_b16 a[34:35], v215 offset:16896
    ds_read_b64_tr_b16 a[36:37], v216 offset:16384
    ds_read_b64_tr_b16 a[38:39], v216 offset:16896
    ds_read_b64_tr_b16 a[40:41], v215 offset:18432
    ds_read_b64_tr_b16 a[42:43], v215 offset:18944
    ds_read_b64_tr_b16 a[44:45], v216 offset:18432
    ds_read_b64_tr_b16 a[46:47], v216 offset:18944
    ds_read_b64_tr_b16 a[48:49], v215 offset:20480
    ds_read_b64_tr_b16 a[50:51], v215 offset:20992
    ds_read_b64_tr_b16 a[52:53], v216 offset:20480
    ds_read_b64_tr_b16 a[54:55], v216 offset:20992
    ds_read_b64_tr_b16 a[56:57], v215 offset:22528
    ds_read_b64_tr_b16 a[58:59], v215 offset:23040
    ds_read_b64_tr_b16 a[60:61], v216 offset:22528
    ds_read_b64_tr_b16 a[62:63], v216 offset:23040
    s_waitcnt lgkmcnt(0)
    s_add_u32 m0, s70, 0
    s_mov_b32 s68, 1376256
    buffer_load_dwordx4 v213, s[20:23], s68 offen lds
    s_add_u32 m0, s70, 1024
    s_mov_b32 s68, 1404928
    buffer_load_dwordx4 v213, s[20:23], s68 offen lds
    s_add_u32 m0, s70, 2048
    s_mov_b32 s68, 1433600
    buffer_load_dwordx4 v213, s[20:23], s68 offen lds
    s_add_u32 m0, s70, 3072
    s_mov_b32 s68, 1462272
    buffer_load_dwordx4 v213, s[20:23], s68 offen lds
    s_add_u32 m0, s70, 4096
    s_mov_b32 s68, 1490944
    buffer_load_dwordx4 v213, s[20:23], s68 offen lds
    s_add_u32 m0, s70, 5120
    s_mov_b32 s68, 1519616
    buffer_load_dwordx4 v213, s[20:23], s68 offen lds
    s_add_u32 m0, s70, 6144
    s_mov_b32 s68, 1548288
    buffer_load_dwordx4 v213, s[20:23], s68 offen lds
    s_add_u32 m0, s70, 7168
    s_mov_b32 s68, 1576960
    buffer_load_dwordx4 v213, s[20:23], s68 offen lds
    s_add_u32 m0, s70, 8192
    s_mov_b32 s68, 1605632
    buffer_load_dwordx4 v213, s[20:23], s68 offen lds
    s_add_u32 m0, s70, 9216
    s_mov_b32 s68, 1634304
    buffer_load_dwordx4 v213, s[20:23], s68 offen lds
    s_add_u32 m0, s70, 10240
    s_mov_b32 s68, 1662976
    buffer_load_dwordx4 v213, s[20:23], s68 offen lds
    s_add_u32 m0, s70, 11264
    s_mov_b32 s68, 1691648
    buffer_load_dwordx4 v213, s[20:23], s68 offen lds
    s_add_u32 m0, s70, 12288
    s_mov_b32 s68, 1720320
    buffer_load_dwordx4 v213, s[20:23], s68 offen lds
    s_add_u32 m0, s70, 13312
    s_mov_b32 s68, 1748992
    buffer_load_dwordx4 v213, s[20:23], s68 offen lds
    s_add_u32 m0, s70, 14336
    s_mov_b32 s68, 1777664
    buffer_load_dwordx4 v213, s[20:23], s68 offen lds
    s_add_u32 m0, s70, 15360
    s_mov_b32 s68, 1806336
    buffer_load_dwordx4 v213, s[20:23], s68 offen lds
    s_nop 1
Lst_P_4:
    s_sub_u32 s6, s6, 1
    s_cbranch_scc1 L_end_P
    buffer_load_dwordx4 v[96:99], v65, s[40:43], s58 offen sc1
    buffer_load_dwordx4 v[100:103], v65, s[40:43], s58 offen offset:1024 sc1
    s_waitcnt vmcnt(0)
    v_xor_b32 v97, s4, v97
    v_xor_b32 v99, s4, v99
    v_xor_b32 v101, s4, v101
    v_xor_b32 v103, s4, v103
    v_or3_b32 v97, v97, v99, v101
    v_or_b32 v97, v97, v103
    v_cmp_ne_u32 vcc, 0, v97
    s_nop 1
    s_cbranch_vccnz Lst_P_4
    v_add_f32 v96, v96, v100
    v_add_f32 v98, v98, v102
    v_mov_b32 v100, v96
    v_mov_b32 v102, v98
    s_nop 0
    v_permlane32_swap_b32 v96, v100
    v_permlane32_swap_b32 v98, v102
    v_add_f32 v96, v96, v100
    v_add_f32 v98, v98, v102
    v_mul_f32 v97, 0x3b124925, v96
    v_mul_f32 v98, 0x3b124925, v98
    v_fma_f32 v98, -v97, v97, v98
    v_max_f32 v98, 0, v98
    v_add_f32 v99, 0x3727c5ac, v98
    v_rsq_f32 v99, v99
    s_nop 0
    v_mul_f32 v98, v98, v99
    v_fmaak_f32 v98, v98, v99, 0x3727c5ac
    v_rsq_f32 v98, v98
    s_nop 0
    v_mul_f32 v99, v99, v98
    s_lshl_b32 s60, s3, 8
    v_lshl_add_u32 v66, v67, 2, s60
    ds_write_b32 v66, v97 offset:1024
    ds_write_b32 v66, v99 offset:1152
    v_lshl_add_u32 v66, v3, 4, s60
    s_waitcnt lgkmcnt(0)
    ds_read_b128 v[104:107], v66 offset:1024
    ds_read_b128 v[108:111], v66 offset:1152
    ds_read_b128 v[112:115], v66 offset:1088
    ds_read_b128 v[116:119], v66 offset:1216
    s_waitcnt lgkmcnt(3)
    v_pk_add_f32 v[192:193], v[192:193], v[104:105] neg_lo:[0,1] neg_hi:[0,1]
    v_pk_add_f32 v[194:195], v[194:195], v[106:107] neg_lo:[0,1] neg_hi:[0,1]
    s_waitcnt lgkmcnt(2)
    v_pk_mul_f32 v[192:193], v[192:193], v[108:109]
    v_pk_mul_f32 v[194:195], v[194:195], v[110:111]
    v_cvt_pk_bf16_f32 v76, v192, v193
    v_cvt_pk_bf16_f32 v77, v194, v195
    buffer_store_dwordx2 v[76:77], v92, s[40:43], s62 offen offset:0 sc1
    v_pk_add_f32 v[196:197], v[196:197], v[104:105] neg_lo:[0,1] neg_hi:[0,1]
    v_pk_add_f32 v[198:199], v[198:199], v[106:107] neg_lo:[0,1] neg_hi:[0,1]
    v_pk_mul_f32 v[196:197], v[196:197], v[108:109]
    v_pk_mul_f32 v[198:199], v[198:199], v[110:111]
    v_cvt_pk_bf16_f32 v78, v196, v197
    v_cvt_pk_bf16_f32 v79, v198, v199
    buffer_store_dwordx2 v[78:79], v93, s[40:43], s63 offen offset:0 sc1
    s_waitcnt lgkmcnt(1)
    v_pk_add_f32 v[200:201], v[200:201], v[112:113] neg_lo:[0,1] neg_hi:[0,1]
    v_pk_add_f32 v[202:203], v[202:203], v[114:115] neg_lo:[0,1] neg_hi:[0,1]
    s_waitcnt lgkmcnt(0)
    v_pk_mul_f32 v[200:201], v[200:201], v[116:117]
    v_pk_mul_f32 v[202:203], v[202:203], v[118:119]
    v_cvt_pk_bf16_f32 v80, v200, v201
    v_cvt_pk_bf16_f32 v81, v202, v203
    buffer_store_dwordx2 v[80:81], v92, s[40:43], s62 offen offset:1024 sc1
    v_pk_add_f32 v[204:205], v[204:205], v[112:113] neg_lo:[0,1] neg_hi:[0,1]
    v_pk_add_f32 v[206:207], v[206:207], v[114:115] neg_lo:[0,1] neg_hi:[0,1]
    v_pk_mul_f32 v[204:205], v[204:205], v[116:117]
    v_pk_mul_f32 v[206:207], v[206:207], v[118:119]
    v_cvt_pk_bf16_f32 v82, v204, v205
    v_cvt_pk_bf16_f32 v83, v206, v207
    buffer_store_dwordx2 v[82:83], v93, s[40:43], s63 offen offset:1024 sc1
    ds_read_b64_tr_b16 a[64:65], v215 offset:0
    ds_read_b64_tr_b16 a[66:67], v215 offset:512
    ds_read_b64_tr_b16 a[68:69], v216 offset:0
    ds_read_b64_tr_b16 a[70:71], v216 offset:512
    ds_read_b64_tr_b16 a[72:73], v215 offset:2048
    ds_read_b64_tr_b16 a[74:75], v215 offset:2560
    ds_read_b64_tr_b16 a[76:77], v216 offset:2048
    ds_read_b64_tr_b16 a[78:79], v216 offset:2560
    ds_read_b64_tr_b16 a[80:81], v215 offset:4096
    ds_read_b64_tr_b16 a[82:83], v215 offset:4608
    ds_read_b64_tr_b16 a[84:85], v216 offset:4096
    ds_read_b64_tr_b16 a[86:87], v216 offset:4608
    ds_read_b64_tr_b16 a[88:89], v215 offset:6144
    ds_read_b64_tr_b16 a[90:91], v215 offset:6656
    ds_read_b64_tr_b16 a[92:93], v216 offset:6144
    ds_read_b64_tr_b16 a[94:95], v216 offset:6656
    ds_read_b64_tr_b16 a[96:97], v215 offset:8192
    ds_read_b64_tr_b16 a[98:99], v215 offset:8704
    ds_read_b64_tr_b16 a[100:101], v216 offset:8192
    ds_read_b64_tr_b16 a[102:103], v216 offset:8704
    ds_read_b64_tr_b16 a[104:105], v215 offset:10240
    ds_read_b64_tr_b16 a[106:107], v215 offset:10752
    ds_read_b64_tr_b16 a[108:109], v216 offset:10240
    ds_read_b64_tr_b16 a[110:111], v216 offset:10752
    ds_read_b64_tr_b16 a[112:113], v215 offset:12288
    ds_read_b64_tr_b16 a[114:115], v215 offset:12800
    ds_read_b64_tr_b16 a[116:117], v216 offset:12288
    ds_read_b64_tr_b16 a[118:119], v216 offset:12800
    ds_read_b64_tr_b16 a[120:121], v215 offset:14336
    ds_read_b64_tr_b16 a[122:123], v215 offset:14848
    ds_read_b64_tr_b16 a[124:125], v216 offset:14336
    ds_read_b64_tr_b16 a[126:127], v216 offset:14848
    s_waitcnt vmcnt(0)
    v_mov_b32 v8, s4
    s_mov_b64 exec, 1
    buffer_store_dword v8, v9, s[40:43], s81 offen sc1
    s_mov_b64 exec, -1
    s_waitcnt lgkmcnt(0)
    s_add_u32 m0, s70, 0
    s_mov_b32 s68, 0
    buffer_load_dwordx4 v214, s[24:27], s68 offen lds
    s_add_u32 m0, s70, 1024
    s_mov_b32 s68, 32768
    buffer_load_dwordx4 v214, s[24:27], s68 offen lds
    s_add_u32 m0, s70, 2048
    s_mov_b32 s68, 65536
    buffer_load_dwordx4 v214, s[24:27], s68 offen lds
    s_add_u32 m0, s70, 3072
    s_mov_b32 s68, 98304
    buffer_load_dwordx4 v214, s[24:27], s68 offen lds
    s_add_u32 m0, s70, 4096
    s_mov_b32 s68, 131072
    buffer_load_dwordx4 v214, s[24:27], s68 offen lds
    s_add_u32 m0, s70, 5120
    s_mov_b32 s68, 163840
    buffer_load_dwordx4 v214, s[24:27], s68 offen lds
    s_add_u32 m0, s70, 6144
    s_mov_b32 s68, 196608
    buffer_load_dwordx4 v214, s[24:27], s68 offen lds
    s_add_u32 m0, s70, 7168
    s_mov_b32 s68, 229376
    buffer_load_dwordx4 v214, s[24:27], s68 offen lds
    s_add_u32 m0, s70, 8192
    s_mov_b32 s68, 262144
    buffer_load_dwordx4 v214, s[24:27], s68 offen lds
    s_add_u32 m0, s70, 9216
    s_mov_b32 s68, 294912
    buffer_load_dwordx4 v214, s[24:27], s68 offen lds
    s_add_u32 m0, s70, 10240
    s_mov_b32 s68, 327680
    buffer_load_dwordx4 v214, s[24:27], s68 offen lds
    s_add_u32 m0, s70, 11264
    s_mov_b32 s68, 360448
    buffer_load_dwordx4 v214, s[24:27], s68 offen lds
    s_add_u32 m0, s70, 12288
    s_mov_b32 s68, 393216
    buffer_load_dwordx4 v214, s[24:27], s68 offen lds
    s_add_u32 m0, s70, 13312
    s_mov_b32 s68, 425984
    buffer_load_dwordx4 v214, s[24:27], s68 offen lds
    s_add_u32 m0, s70, 14336
    s_mov_b32 s68, 458752
    buffer_load_dwordx4 v214, s[24:27], s68 offen lds
    s_add_u32 m0, s70, 15360
    s_mov_b32 s68, 491520
    buffer_load_dwordx4 v214, s[24:27], s68 offen lds
    s_add_u32 m0, s70, 16384
    s_mov_b32 s68, 524288
    buffer_load_dwordx4 v214, s[24:27], s68 offen lds
    s_add_u32 m0, s70, 17408
    s_mov_b32 s68, 557056
    buffer_load_dwordx4 v214, s[24:27], s68 offen lds
    s_add_u32 m0, s70, 18432
    s_mov_b32 s68, 589824
    buffer_load_dwordx4 v214, s[24:27], s68 offen lds
    s_add_u32 m0, s70, 19456
    s_mov_b32 s68, 622592
    buffer_load_dwordx4 v214, s[24:27], s68 offen lds
    s_add_u32 m0, s70, 20480
    s_mov_b32 s68, 655360
    buffer_load_dwordx4 v214, s[24:27], s68 offen lds
    s_add_u32 m0, s70, 21504
    s_mov_b32 s68, 688128
    buffer_load_dwordx4 v214, s[24:27], s68 offen lds
    s_add_u32 m0, s70, 22528
    s_mov_b32 s68, 720896
    buffer_load_dwordx4 v214, s[24:27], s68 offen lds
    s_add_u32 m0, s70, 23552
    s_mov_b32 s68, 753664
    buffer_load_dwordx4 v214, s[24:27], s68 offen lds
    v_lshrrev_b32 v220, 5, v1
    v_lshlrev_b32 v220, 3, v220
    s_lshl_b32 s68, s65, 7
    s_lshr_b32 s69, s3, 1
    s_lshl_b32 s69, s69, 6
    s_add_u32 s68, s68, s69
    buffer_load_dwordx2 v[222:223], v220, s[28:31], s68 offen offset:0
    buffer_load_dwordx2 v[224:225], v220, s[28:31], s68 offen offset:16
    buffer_load_dwordx2 v[226:227], v220, s[28:31], s68 offen offset:32
    buffer_load_dwordx2 v[228:229], v220, s[28:31], s68 offen offset:48
    s_lshl_b32 s68, s64, 1
    s_and_b32 s69, s3, 1
    s_add_u32 s71, s68, s69
    s_xor_b32 s72, s71, 1
    s_mul_i32 s68, s3, 32768
    s_add_u32 s68, s68, 0x200000
    s_mul_i32 s71, s71, 131072
    s_add_u32 s71, s71, s68
    s_mul_i32 s72, s72, 131072
    s_add_u32 s72, s72, s68
    s_nop 1
Lpoll_P_5:
    s_sub_u32 s6, s6, 1
    s_cbranch_scc1 L_end_P
    buffer_load_dword v8, v11, s[40:43], s84 offen sc1
    s_waitcnt vmcnt(0)
    v_cmp_ne_u32 vcc, s4, v8
    s_nop 1
    s_cbranch_vccnz Lpoll_P_5
    buffer_load_dwordx4 v[80:83], v5, s[40:43], s71 offen offset:0 sc1
    buffer_load_dwordx4 v[84:87], v5, s[40:43], s72 offen offset:0 sc1
    buffer_load_dwordx4 v[88:91], v5, s[40:43], s71 offen offset:1024 sc1
    buffer_load_dwordx4 v[92:95], v5, s[40:43], s72 offen offset:1024 sc1
    buffer_load_dwordx4 v[96:99], v5, s[40:43], s71 offen offset:2048 sc1
    buffer_load_dwordx4 v[100:103], v5, s[40:43], s72 offen offset:2048 sc1
    buffer_load_dwordx4 v[104:107], v5, s[40:43], s71 offen offset:3072 sc1
    buffer_load_dwordx4 v[108:111], v5, s[40:43], s72 offen offset:3072 sc1
    v_lshlrev_b32 v16, 16, v222
    v_and_b32 v17, 0xffff0000, v222
    v_lshlrev_b32 v18, 16, v223
    v_and_b32 v19, 0xffff0000, v223
    v_lshlrev_b32 v20, 16, v224
    v_and_b32 v21, 0xffff0000, v224
    v_lshlrev_b32 v22, 16, v225
    v_and_b32 v23, 0xffff0000, v225
    v_lshlrev_b32 v24, 16, v226
    v_and_b32 v25, 0xffff0000, v226
    v_lshlrev_b32 v26, 16, v227
    v_and_b32 v27, 0xffff0000, v227
    v_lshlrev_b32 v28, 16, v228
    v_and_b32 v29, 0xffff0000, v228
    v_lshlrev_b32 v30, 16, v229
    v_and_b32 v31, 0xffff0000, v229
    s_add_u32 s71, s71, 4096
    s_add_u32 s72, s72, 4096
    buffer_load_dwordx4 v[112:115], v5, s[40:43], s71 offen offset:0 sc1
    buffer_load_dwordx4 v[116:119], v5, s[40:43], s72 offen offset:0 sc1
    buffer_load_dwordx4 v[120:123], v5, s[40:43], s71 offen offset:1024 sc1
    buffer_load_dwordx4 v[124:127], v5, s[40:43], s72 offen offset:1024 sc1
    buffer_load_dwordx4 v[128:131], v5, s[40:43], s71 offen offset:2048 sc1
    buffer_load_dwordx4 v[132:135], v5, s[40:43], s72 offen offset:2048 sc1
    buffer_load_dwordx4 v[136:139], v5, s[40:43], s71 offen offset:3072 sc1
    buffer_load_dwordx4 v[140:143], v5, s[40:43], s72 offen offset:3072 sc1
    s_add_u32 s71, s71, 4096
    s_add_u32 s72, s72, 4096
    buffer_load_dwordx4 v[144:147], v5, s[40:43], s71 offen offset:0 sc1
    buffer_load_dwordx4 v[148:151], v5, s[40:43], s72 offen offset:0 sc1
    buffer_load_dwordx4 v[152:155], v5, s[40:43], s71 offen offset:1024 sc1
    buffer_load_dwordx4 v[156:159], v5, s[40:43], s72 offen offset:1024 sc1
    buffer_load_dwordx4 v[160:163], v5, s[40:43], s71 offen offset:2048 sc1
    buffer_load_dwordx4 v[164:167], v5, s[40:43], s72 offen offset:2048 sc1
    buffer_load_dwordx4 v[168:171], v5, s[40:43], s71 offen offset:3072 sc1
    buffer_load_dwordx4 v[172:175], v5, s[40:43], s72 offen offset:3072 sc1
    s_add_u32 s71, s71, 4096
    s_add_u32 s72, s72, 4096
    buffer_load_dwordx4 v[176:179], v5, s[40:43], s71 offen offset:0 sc1
    buffer_load_dwordx4 v[180:183], v5, s[40:43], s72 offen offset:0 sc1
    buffer_load_dwordx4 v[184:187], v5, s[40:43], s71 offen offset:1024 sc1
    buffer_load_dwordx4 v[188:191], v5, s[40:43], s72 offen offset:1024 sc1
    buffer_load_dwordx4 v[192:195], v5, s[40:43], s71 offen offset:2048 sc1
    buffer_load_dwordx4 v[196:199], v5, s[40:43], s72 offen offset:2048 sc1
    buffer_load_dwordx4 v[200:203], v5, s[40:43], s71 offen offset:3072 sc1
    buffer_load_dwordx4 v[204:207], v5, s[40:43], s72 offen offset:3072 sc1
    s_waitcnt vmcnt(31)
    v_mfma_f32_32x32x16_bf16 v[16:31], a[128:131], v[80:83], v[16:31]
    s_waitcnt vmcnt(30)
    v_mfma_f32_32x32x16_bf16 v[32:47], a[128:131], v[84:87], 0
    v_mfma_f32_32x32x16_bf16 v[48:63], a[132:135], v[80:83], 0
    v_mfma_f32_32x32x16_bf16 v[64:79], a[132:135], v[84:87], 0
    ds_read_b64_tr_b16 a[128:129], v217 offset:0
    ds_read_b64_tr_b16 a[130:131], v217 offset:1024
    ds_read_b64_tr_b16 a[132:133], v218 offset:0
    ds_read_b64_tr_b16 a[134:135], v218 offset:1024
    s_add_u32 s71, s71, 4096
    s_add_u32 s72, s72, 4096
    buffer_load_dwordx4 v[80:83], v5, s[40:43], s71 offen offset:0 sc1
    buffer_load_dwordx4 v[84:87], v5, s[40:43], s72 offen offset:0 sc1
    s_waitcnt vmcnt(31)
    v_mfma_f32_32x32x16_bf16 v[16:31], a[136:139], v[88:91], v[16:31]
    s_waitcnt vmcnt(30)
    v_mfma_f32_32x32x16_bf16 v[32:47], a[136:139], v[92:95], v[32:47]
    v_mfma_f32_32x32x16_bf16 v[48:63], a[140:143], v[88:91], v[48:63]
    v_mfma_f32_32x32x16_bf16 v[64:79], a[140:143], v[92:95], v[64:79]
    ds_read_b64_tr_b16 a[136:137], v217 offset:2048
    ds_read_b64_tr_b16 a[138:139], v217 offset:3072
    ds_read_b64_tr_b16 a[140:141], v218 offset:2048
    ds_read_b64_tr_b16 a[142:143], v218 offset:3072
    buffer_load_dwordx4 v[88:91], v5, s[40:43], s71 offen offset:1024 sc1
    buffer_load_dwordx4 v[92:95], v5, s[40:43], s72 offen offset:1024 sc1
    s_waitcnt vmcnt(31)
    v_mfma_f32_32x32x16_bf16 v[16:31], a[144:147], v[96:99], v[16:31]
    s_waitcnt vmcnt(30)
    v_mfma_f32_32x32x16_bf16 v[32:47], a[144:147], v[100:103], v[32:47]
    v_mfma_f32_32x32x16_bf16 v[48:63], a[148:151], v[96:99], v[48:63]
    v_mfma_f32_32x32x16_bf16 v[64:79], a[148:151], v[100:103], v[64:79]
    ds_read_b64_tr_b16 a[144:145], v217 offset:4096
    ds_read_b64_tr_b16 a[146:147], v217 offset:5120
    ds_read_b64_tr_b16 a[148:149], v218 offset:4096
    ds_read_b64_tr_b16 a[150:151], v218 offset:5120
    buffer_load_dwordx4 v[96:99], v5, s[40:43], s71 offen offset:2048 sc1
    buffer_load_dwordx4 v[100:103], v5, s[40:43], s72 offen offset:2048 sc1
    s_waitcnt vmcnt(31)
    v_mfma_f32_32x32x16_bf16 v[16:31], a[152:155], v[104:107], v[16:31]
    s_waitcnt vmcnt(30)
    v_mfma_f32_32x32x16_bf16 v[32:47], a[152:155], v[108:111], v[32:47]
    v_mfma_f32_32x32x16_bf16 v[48:63], a[156:159], v[104:107], v[48:63]
    v_mfma_f32_32x32x16_bf16 v[64:79], a[156:159], v[108:111], v[64:79]
    ds_read_b64_tr_b16 a[152:153], v217 offset:6144
    ds_read_b64_tr_b16 a[154:155], v217 offset:7168
    ds_read_b64_tr_b16 a[156:157], v218 offset:6144
    ds_read_b64_tr_b16 a[158:159], v218 offset:7168
    buffer_load_dwordx4 v[104:107], v5, s[40:43], s71 offen offset:3072 sc1
    buffer_load_dwordx4 v[108:111], v5, s[40:43], s72 offen offset:3072 sc1
    s_waitcnt vmcnt(31)
    v_mfma_f32_32x32x16_bf16 v[16:31], a[160:163], v[112:115], v[16:31]
    s_waitcnt vmcnt(30)
    v_mfma_f32_32x32x16_bf16 v[32:47], a[160:163], v[116:119], v[32:47]
    v_mfma_f32_32x32x16_bf16 v[48:63], a[164:167], v[112:115], v[48:63]
    v_mfma_f32_32x32x16_bf16 v[64:79], a[164:167], v[116:119], v[64:79]
    ds_read_b64_tr_b16 a[160:161], v217 offset:8192
    ds_read_b64_tr_b16 a[162:163], v217 offset:9216
    ds_read_b64_tr_b16 a[164:165], v218 offset:8192
    ds_read_b64_tr_b16 a[166:167], v218 offset:9216
    s_add_u32 s71, s71, 4096
    s_add_u32 s72, s72, 4096
    buffer_load_dwordx4 v[112:115], v5, s[40:43], s71 offen offset:0 sc1
    buffer_load_dwordx4 v[116:119], v5, s[40:43], s72 offen offset:0 sc1
    s_waitcnt vmcnt(31)
    v_mfma_f32_32x32x16_bf16 v[16:31], a[168:171], v[120:123], v[16:31]
    s_waitcnt vmcnt(30)
    v_mfma_f32_32x32x16_bf16 v[32:47], a[168:171], v[124:127], v[32:47]
    v_mfma_f32_32x32x16_bf16 v[48:63], a[172:175], v[120:123], v[48:63]
    v_mfma_f32_32x32x16_bf16 v[64:79], a[172:175], v[124:127], v[64:79]
    ds_read_b64_tr_b16 a[168:169], v217 offset:10240
    ds_read_b64_tr_b16 a[170:171], v217 offset:11264
    ds_read_b64_tr_b16 a[172:173], v218 offset:10240
    ds_read_b64_tr_b16 a[174:175], v218 offset:11264
    buffer_load_dwordx4 v[120:123], v5, s[40:43], s71 offen offset:1024 sc1
    buffer_load_dwordx4 v[124:127], v5, s[40:43], s72 offen offset:1024 sc1
    s_waitcnt vmcnt(31)
    v_mfma_f32_32x32x16_bf16 v[16:31], a[176:179], v[128:131], v[16:31]
    s_waitcnt vmcnt(30)
    v_mfma_f32_32x32x16_bf16 v[32:47], a[176:179], v[132:135], v[32:47]
    v_mfma_f32_32x32x16_bf16 v[48:63], a[180:183], v[128:131], v[48:63]
    v_mfma_f32_32x32x16_bf16 v[64:79], a[180:183], v[132:135], v[64:79]
    ds_read_b64_tr_b16 a[176:177], v217 offset:12288
    ds_read_b64_tr_b16 a[178:179], v217 offset:13312
    ds_read_b64_tr_b16 a[180:181], v218 offset:12288
    ds_read_b64_tr_b16 a[182:183], v218 offset:13312
    buffer_load_dwordx4 v[128:131], v5, s[40:43], s71 offen offset:2048 sc1
    buffer_load_dwordx4 v[132:135], v5, s[40:43], s72 offen offset:2048 sc1
    s_waitcnt vmcnt(31)
    v_mfma_f32_32x32x16_bf16 v[16:31], a[184:187], v[136:139], v[16:31]
    s_waitcnt vmcnt(30)
    v_mfma_f32_32x32x16_bf16 v[32:47], a[184:187], v[140:143], v[32:47]
    v_mfma_f32_32x32x16_bf16 v[48:63], a[188:191], v[136:139], v[48:63]
    v_mfma_f32_32x32x16_bf16 v[64:79], a[188:191], v[140:143], v[64:79]
    ds_read_b64_tr_b16 a[184:185], v217 offset:14336
    ds_read_b64_tr_b16 a[186:187], v217 offset:15360
    ds_read_b64_tr_b16 a[188:189], v218 offset:14336
    ds_read_b64_tr_b16 a[190:191], v218 offset:15360
    buffer_load_dwordx4 v[136:139], v5, s[40:43], s71 offen offset:3072 sc1
    buffer_load_dwordx4 v[140:143], v5, s[40:43], s72 offen offset:3072 sc1
    s_waitcnt vmcnt(31)
    v_mfma_f32_32x32x16_bf16 v[16:31], a[192:195], v[144:147], v[16:31]
    s_waitcnt vmcnt(30)
    v_mfma_f32_32x32x16_bf16 v[32:47], a[192:195], v[148:151], v[32:47]
    v_mfma_f32_32x32x16_bf16 v[48:63], a[196:199], v[144:147], v[48:63]
    v_mfma_f32_32x32x16_bf16 v[64:79], a[196:199], v[148:151], v[64:79]
    ds_read_b64_tr_b16 a[192:193], v217 offset:16384
    ds_read_b64_tr_b16 a[194:195], v217 offset:17408
    ds_read_b64_tr_b16 a[196:197], v218 offset:16384
    ds_read_b64_tr_b16 a[198:199], v218 offset:17408
    s_add_u32 s71, s71, 4096
    s_add_u32 s72, s72, 4096
    buffer_load_dwordx4 v[144:147], v5, s[40:43], s71 offen offset:0 sc1
    buffer_load_dwordx4 v[148:151], v5, s[40:43], s72 offen offset:0 sc1
    s_waitcnt vmcnt(31)
    v_mfma_f32_32x32x16_bf16 v[16:31], a[200:203], v[152:155], v[16:31]
    s_waitcnt vmcnt(30)
    v_mfma_f32_32x32x16_bf16 v[32:47], a[200:203], v[156:159], v[32:47]
    v_mfma_f32_32x32x16_bf16 v[48:63], a[204:207], v[152:155], v[48:63]
    v_mfma_f32_32x32x16_bf16 v[64:79], a[204:207], v[156:159], v[64:79]
    ds_read_b64_tr_b16 a[200:201], v217 offset:18432
    ds_read_b64_tr_b16 a[202:203], v217 offset:19456
    ds_read_b64_tr_b16 a[204:205], v218 offset:18432
    ds_read_b64_tr_b16 a[206:207], v218 offset:19456
    buffer_load_dwordx4 v[152:155], v5, s[40:43], s71 offen offset:1024 sc1
    buffer_load_dwordx4 v[156:159], v5, s[40:43], s72 offen offset:1024 sc1
    s_waitcnt vmcnt(31)
    v_mfma_f32_32x32x16_bf16 v[16:31], a[208:211], v[160:163], v[16:31]
    s_waitcnt vmcnt(30)
    v_mfma_f32_32x32x16_bf16 v[32:47], a[208:211], v[164:167], v[32:47]
    v_mfma_f32_32x32x16_bf16 v[48:63], a[212:215], v[160:163], v[48:63]
    v_mfma_f32_32x32x16_bf16 v[64:79], a[212:215], v[164:167], v[64:79]
    ds_read_b64_tr_b16 a[208:209], v217 offset:20480
    ds_read_b64_tr_b16 a[210:211], v217 offset:21504
    ds_read_b64_tr_b16 a[212:213], v218 offset:20480
    ds_read_b64_tr_b16 a[214:215], v218 offset:21504
    buffer_load_dwordx4 v[160:163], v5, s[40:43], s71 offen offset:2048 sc1
    buffer_load_dwordx4 v[164:167], v5, s[40:43], s72 offen offset:2048 sc1
    s_waitcnt vmcnt(31)
    v_mfma_f32_32x32x16_bf16 v[16:31], a[216:219], v[168:171], v[16:31]
    s_waitcnt vmcnt(30)
    v_mfma_f32_32x32x16_bf16 v[32:47], a[216:219], v[172:175], v[32:47]
    v_mfma_f32_32x32x16_bf16 v[48:63], a[220:223], v[168:171], v[48:63]
    v_mfma_f32_32x32x16_bf16 v[64:79], a[220:223], v[172:175], v[64:79]
    ds_read_b64_tr_b16 a[216:217], v217 offset:22528
    ds_read_b64_tr_b16 a[218:219], v217 offset:23552
    ds_read_b64_tr_b16 a[220:221], v218 offset:22528
    ds_read_b64_tr_b16 a[222:223], v218 offset:23552
    buffer_load_dwordx4 v[168:171], v5, s[40:43], s71 offen offset:3072 sc1
    buffer_load_dwordx4 v[172:175], v5, s[40:43], s72 offen offset:3072 sc1
    s_waitcnt vmcnt(31)
    v_mfma_f32_32x32x16_bf16 v[16:31], a[224:227], v[176:179], v[16:31]
    s_waitcnt vmcnt(30)
    v_mfma_f32_32x32x16_bf16 v[32:47], a[224:227], v[180:183], v[32:47]
    v_mfma_f32_32x32x16_bf16 v[48:63], a[228:231], v[176:179], v[48:63]
    v_mfma_f32_32x32x16_bf16 v[64:79], a[228:231], v[180:183], v[64:79]
    s_add_u32 s71, s71, 4096
    s_add_u32 s72, s72, 4096
    buffer_load_dwordx4 v[176:179], v5, s[40:43], s71 offen offset:0 sc1
    buffer_load_dwordx4 v[180:183], v5, s[40:43], s72 offen offset:0 sc1
    s_waitcnt vmcnt(31)
    v_mfma_f32_32x32x16_bf16 v[16:31], a[232:235], v[184:187], v[16:31]
    s_waitcnt vmcnt(30)
    v_mfma_f32_32x32x16_bf16 v[32:47], a[232:235], v[188:191], v[32:47]
    v_mfma_f32_32x32x16_bf16 v[48:63], a[236:239], v[184:187], v[48:63]
    v_mfma_f32_32x32x16_bf16 v[64:79], a[236:239], v[188:191], v[64:79]
    buffer_load_dwordx4 v[184:187], v5, s[40:43], s71 offen offset:1024 sc1
    buffer_load_dwordx4 v[188:191], v5, s[40:43], s72 offen offset:1024 sc1
    s_waitcnt vmcnt(31)
    v_mfma_f32_32x32x16_bf16 v[16:31], a[240:243], v[192:195], v[16:31]
    s_waitcnt vmcnt(30)
    v_mfma_f32_32x32x16_bf16 v[32:47], a[240:243], v[196:199], v[32:47]
    v_mfma_f32_32x32x16_bf16 v[48:63], a[244:247], v[192:195], v[48:63]
    v_mfma_f32_32x32x16_bf16 v[64:79], a[244:247], v[196:199], v[64:79]
    buffer_load_dwordx4 v[192:195], v5, s[40:43], s71 offen offset:2048 sc1
    buffer_load_dwordx4 v[196:199], v5, s[40:43], s72 offen offset:2048 sc1
    s_waitcnt vmcnt(31)
    v_mfma_f32_32x32x16_bf16 v[16:31], a[248:251], v[200:203], v[16:31]
    s_waitcnt vmcnt(30)
    v_mfma_f32_32x32x16_bf16 v[32:47], a[248:251], v[204:207], v[32:47]
    v_mfma_f32_32x32x16_bf16 v[48:63], a[252:255], v[200:203], v[48:63]
    v_mfma_f32_32x32x16_bf16 v[64:79], a[252:255], v[204:207], v[64:79]
    buffer_load_dwordx4 v[200:203], v5, s[40:43], s71 offen offset:3072 sc1
    buffer_load_dwordx4 v[204:207], v5, s[40:43], s72 offen offset:3072 sc1
    s_waitcnt vmcnt(31)
    v_mfma_f32_32x32x16_bf16 v[16:31], a[0:3], v[80:83], v[16:31]
    s_waitcnt vmcnt(30)
    v_mfma_f32_32x32x16_bf16 v[32:47], a[0:3], v[84:87], v[32:47]
    v_mfma_f32_32x32x16_bf16 v[48:63], a[4:7], v[80:83], v[48:63]
    v_mfma_f32_32x32x16_bf16 v[64:79], a[4:7], v[84:87], v[64:79]
    s_waitcnt lgkmcnt(0)
    s_add_u32 m0, s70, 0
    s_mov_b32 s68, 786432
    buffer_load_dwordx4 v214, s[24:27], s68 offen lds
    s_add_u32 m0, s70, 1024
    s_mov_b32 s68, 819200
    buffer_load_dwordx4 v214, s[24:27], s68 offen lds
    s_waitcnt vmcnt(31)
    v_mfma_f32_32x32x16_bf16 v[16:31], a[8:11], v[88:91], v[16:31]
    s_waitcnt vmcnt(30)
    v_mfma_f32_32x32x16_bf16 v[32:47], a[8:11], v[92:95], v[32:47]
    v_mfma_f32_32x32x16_bf16 v[48:63], a[12:15], v[88:91], v[48:63]
    v_mfma_f32_32x32x16_bf16 v[64:79], a[12:15], v[92:95], v[64:79]
    s_add_u32 m0, s70, 2048
    s_mov_b32 s68, 851968
    buffer_load_dwordx4 v214, s[24:27], s68 offen lds
    s_add_u32 m0, s70, 3072
    s_mov_b32 s68, 884736
    buffer_load_dwordx4 v214, s[24:27], s68 offen lds
    s_waitcnt vmcnt(31)
    v_mfma_f32_32x32x16_bf16 v[16:31], a[16:19], v[96:99], v[16:31]
    s_waitcnt vmcnt(30)
    v_mfma_f32_32x32x16_bf16 v[32:47], a[16:19], v[100:103], v[32:47]
    v_mfma_f32_32x32x16_bf16 v[48:63], a[20:23], v[96:99], v[48:63]
    v_mfma_f32_32x32x16_bf16 v[64:79], a[20:23], v[100:103], v[64:79]
    s_add_u32 m0, s70, 4096
    s_mov_b32 s68, 917504
    buffer_load_dwordx4 v214, s[24:27], s68 offen lds
    s_add_u32 m0, s70, 5120
    s_mov_b32 s68, 950272
    buffer_load_dwordx4 v214, s[24:27], s68 offen lds
    s_waitcnt vmcnt(31)
    v_mfma_f32_32x32x16_bf16 v[16:31], a[24:27], v[104:107], v[16:31]
    s_waitcnt vmcnt(30)
    v_mfma_f32_32x32x16_bf16 v[32:47], a[24:27], v[108:111], v[32:47]
    v_mfma_f32_32x32x16_bf16 v[48:63], a[28:31], v[104:107], v[48:63]
    v_mfma_f32_32x32x16_bf16 v[64:79], a[28:31], v[108:111], v[64:79]
    s_add_u32 m0, s70, 6144
    s_mov_b32 s68, 983040
    buffer_load_dwordx4 v214, s[24:27], s68 offen lds
    s_add_u32 m0, s70, 7168
    s_mov_b32 s68, 1015808
    buffer_load_dwordx4 v214, s[24:27], s68 offen lds
    s_waitcnt vmcnt(31)
    v_mfma_f32_32x32x16_bf16 v[16:31], a[32:35], v[112:115], v[16:31]
    s_waitcnt vmcnt(30)
    v_mfma_f32_32x32x16_bf16 v[32:47], a[32:35], v[116:119], v[32:47]
    v_mfma_f32_32x32x16_bf16 v[48:63], a[36:39], v[112:115], v[48:63]
    v_mfma_f32_32x32x16_bf16 v[64:79], a[36:39], v[116:119], v[64:79]
    s_add_u32 m0, s70, 8192
    s_mov_b32 s68, 1048576
    buffer_load_dwordx4 v214, s[24:27], s68 offen lds
    s_add_u32 m0, s70, 9216
    s_mov_b32 s68, 1081344
    buffer_load_dwordx4 v214, s[24:27], s68 offen lds
    s_waitcnt vmcnt(31)
    v_mfma_f32_32x32x16_bf16 v[16:31], a[40:43], v[120:123], v[16:31]
    s_waitcnt vmcnt(30)
    v_mfma_f32_32x32x16_bf16 v[32:47], a[40:43], v[124:127], v[32:47]
    v_mfma_f32_32x32x16_bf16 v[48:63], a[44:47], v[120:123], v[48:63]
    v_mfma_f32_32x32x16_bf16 v[64:79], a[44:47], v[124:127], v[64:79]
    s_add_u32 m0, s70, 10240
    s_mov_b32 s68, 1114112
    buffer_load_dwordx4 v214, s[24:27], s68 offen lds
    s_add_u32 m0, s70, 11264
    s_mov_b32 s68, 1146880
    buffer_load_dwordx4 v214, s[24:27], s68 offen lds
    s_waitcnt vmcnt(31)
    v_mfma_f32_32x32x16_bf16 v[16:31], a[48:51], v[128:131], v[16:31]
    s_waitcnt vmcnt(30)
    v_mfma_f32_32x32x16_bf16 v[32:47], a[48:51], v[132:135], v[32:47]
    v_mfma_f32_32x32x16_bf16 v[48:63], a[52:55], v[128:131], v[48:63]
    v_mfma_f32_32x32x16_bf16 v[64:79], a[52:55], v[132:135], v[64:79]
    s_add_u32 m0, s70, 12288
    s_mov_b32 s68, 1179648
    buffer_load_dwordx4 v214, s[24:27], s68 offen lds
    s_add_u32 m0, s70, 13312
    s_mov_b32 s68, 1212416
    buffer_load_dwordx4 v214, s[24:27], s68 offen lds
    s_waitcnt vmcnt(31)
    v_mfma_f32_32x32x16_bf16 v[16:31], a[56:59], v[136:139], v[16:31]
    s_waitcnt vmcnt(30)
    v_mfma_f32_32x32x16_bf16 v[32:47], a[56:59], v[140:143], v[32:47]
    v_mfma_f32_32x32x16_bf16 v[48:63], a[60:63], v[136:139], v[48:63]
    v_mfma_f32_32x32x16_bf16 v[64:79], a[60:63], v[140:143], v[64:79]
    s_add_u32 m0, s70, 14336
    s_mov_b32 s68, 1245184
    buffer_load_dwordx4 v214, s[24:27], s68 offen lds
    s_add_u32 m0, s70, 15360
    s_mov_b32 s68, 1277952
    buffer_load_dwordx4 v214, s[24:27], s68 offen lds
    s_waitcnt vmcnt(31)
    v_mfma_f32_32x32x16_bf16 v[16:31], a[64:67], v[144:147], v[16:31]
    s_waitcnt vmcnt(30)
    v_mfma_f32_32x32x16_bf16 v[32:47], a[64:67], v[148:151], v[32:47]
    v_mfma_f32_32x32x16_bf16 v[48:63], a[68:71], v[144:147], v[48:63]
    v_mfma_f32_32x32x16_bf16 v[64:79], a[68:71], v[148:151], v[64:79]
    s_add_u32 m0, s70, 16384
    s_mov_b32 s68, 1310720
    buffer_load_dwordx4 v214, s[24:27], s68 offen lds
    s_add_u32 m0, s70, 17408
    s_mov_b32 s68, 1343488
    buffer_load_dwordx4 v214, s[24:27], s68 offen lds
    s_waitcnt vmcnt(31)
    v_mfma_f32_32x32x16_bf16 v[16:31], a[72:75], v[152:155], v[16:31]
    s_waitcnt vmcnt(30)
    v_mfma_f32_32x32x16_bf16 v[32:47], a[72:75], v[156:159], v[32:47]
    v_mfma_f32_32x32x16_bf16 v[48:63], a[76:79], v[152:155], v[48:63]
    v_mfma_f32_32x32x16_bf16 v[64:79], a[76:79], v[156:159], v[64:79]
    s_add_u32 m0, s70, 18432
    s_mov_b32 s68, 1376256
    buffer_load_dwordx4 v214, s[24:27], s68 offen lds
    s_add_u32 m0, s70, 19456
    s_mov_b32 s68, 1409024
    buffer_load_dwordx4 v214, s[24:27], s68 offen lds
    s_waitcnt vmcnt(31)
    v_mfma_f32_32x32x16_bf16 v[16:31], a[80:83], v[160:163], v[16:31]
    s_waitcnt vmcnt(30)
    v_mfma_f32_32x32x16_bf16 v[32:47], a[80:83], v[164:167], v[32:47]
    v_mfma_f32_32x32x16_bf16 v[48:63], a[84:87], v[160:163], v[48:63]
    v_mfma_f32_32x32x16_bf16 v[64:79], a[84:87], v[164:167], v[64:79]
    s_add_u32 m0, s70, 20480
    s_mov_b32 s68, 1441792
    buffer_load_dwordx4 v214, s[24:27], s68 offen lds
    s_add_u32 m0, s70, 21504
    s_mov_b32 s68, 1474560
    buffer_load_dwordx4 v214, s[24:27], s68 offen lds
    s_waitcnt vmcnt(31)
    v_mfma_f32_32x32x16_bf16 v[16:31], a[88:91], v[168:171], v[16:31]
    s_waitcnt vmcnt(30)
    v_mfma_f32_32x32x16_bf16 v[32:47], a[88:91], v[172:175], v[32:47]
    v_mfma_f32_32x32x16_bf16 v[48:63], a[92:95], v[168:171], v[48:63]
    v_mfma_f32_32x32x16_bf16 v[64:79], a[92:95], v[172:175], v[64:79]
    s_add_u32 m0, s70, 22528
    s_mov_b32 s68, 1507328
    buffer_load_dwordx4 v214, s[24:27], s68 offen lds
    s_add_u32 m0, s70, 23552
    s_mov_b32 s68, 1540096
    buffer_load_dwordx4 v214, s[24:27], s68 offen lds
    s_waitcnt vmcnt(31)
    v_mfma_f32_32x32x16_bf16 v[16:31], a[96:99], v[176:179], v[16:31]
    s_waitcnt vmcnt(30)
    v_mfma_f32_32x32x16_bf16 v[32:47], a[96:99], v[180:183], v[32:47]
    v_mfma_f32_32x32x16_bf16 v[48:63], a[100:103], v[176:179], v[48:63]
    v_mfma_f32_32x32x16_bf16 v[64:79], a[100:103], v[180:183], v[64:79]
    s_waitcnt vmcnt(29)
    v_mfma_f32_32x32x16_bf16 v[16:31], a[104:107], v[184:187], v[16:31]
    s_waitcnt vmcnt(28)
    v_mfma_f32_32x32x16_bf16 v[32:47], a[104:107], v[188:191], v[32:47]
    v_mfma_f32_32x32x16_bf16 v[48:63], a[108:111], v[184:187], v[48:63]
    v_mfma_f32_32x32x16_bf16 v[64:79], a[108:111], v[188:191], v[64:79]
    s_waitcnt vmcnt(27)
    v_mfma_f32_32x32x16_bf16 v[16:31], a[112:115], v[192:195], v[16:31]
    s_waitcnt vmcnt(26)
    v_mfma_f32_32x32x16_bf16 v[32:47], a[112:115], v[196:199], v[32:47]
    v_mfma_f32_32x32x16_bf16 v[48:63], a[116:119], v[192:195], v[48:63]
    v_mfma_f32_32x32x16_bf16 v[64:79], a[116:119], v[196:199], v[64:79]
    s_waitcnt vmcnt(25)
    v_mfma_f32_32x32x16_bf16 v[16:31], a[120:123], v[200:203], v[16:31]
    s_waitcnt vmcnt(24)
    v_mfma_f32_32x32x16_bf16 v[32:47], a[120:123], v[204:207], v[32:47]
    v_mfma_f32_32x32x16_bf16 v[48:63], a[124:127], v[200:203], v[48:63]
    v_mfma_f32_32x32x16_bf16 v[64:79], a[124:127], v[204:207], v[64:79]
    s_xor_b32 s68, s3, 1
    s_mul_i32 s68, s68, 12288
    s_add_u32 s68, s68, 12288
    v_add_u32 v221, s68, v4
    s_xor_b32 s68, s3, 2
    s_mul_i32 s68, s68, 12288
    s_add_u32 s68, s68, 16384
    v_add_u32 v222, s68, v4
    s_xor_b32 s68, s3, 3
    s_mul_i32 s68, s68, 12288
    s_add_u32 s68, s68, 20480
    v_add_u32 v223, s68, v4
    ds_write_b128 v221, v[32:35] offset:0
    ds_write_b128 v221, v[36:39] offset:1024
    ds_write_b128 v221, v[40:43] offset:2048
    ds_write_b128 v221, v[44:47] offset:3072
    ds_write_b128 v222, v[48:51] offset:0
    ds_write_b128 v222, v[52:55] offset:1024
    ds_write_b128 v222, v[56:59] offset:2048
    ds_write_b128 v222, v[60:63] offset:3072
    ds_write_b128 v223, v[64:67] offset:0
    ds_write_b128 v223, v[68:71] offset:1024
    ds_write_b128 v223, v[72:75] offset:2048
    ds_write_b128 v223, v[76:79] offset:3072
    s_mul_i32 s68, s3, 12288
    s_add_u32 s68, s68, 12288
    v_add_u32 v220, s68, v4
    s_lshl_b32 s68, s64, 1
    s_and_b32 s69, s3, 1
    s_add_u32 s68, s68, s69
    s_mul_i32 s68, s68, 112
    s_lshl_b32 s69, s65, 2
    s_add_u32 s68, s68, s69
    s_and_b32 s69, s3, 2
    s_add_u32 s68, s68, s69
    s_lshl_b32 s68, s68, 10
    s_add_u32 s68, s68, 0x600000
    s_waitcnt lgkmcnt(0)
    s_barrier
    ds_read_b128 v[32:35], v220 offset:0
    ds_read_b128 v[48:51], v220 offset:4096
    ds_read_b128 v[64:67], v220 offset:8192
    ds_read_b128 v[36:39], v220 offset:1024
    ds_read_b128 v[52:55], v220 offset:5120
    ds_read_b128 v[68:71], v220 offset:9216
    ds_read_b128 v[40:43], v220 offset:2048
    ds_read_b128 v[56:59], v220 offset:6144
    ds_read_b128 v[72:75], v220 offset:10240
    ds_read_b128 v[44:47], v220 offset:3072
    ds_read_b128 v[60:63], v220 offset:7168
    ds_read_b128 v[76:79], v220 offset:11264
    s_mov_b32 s74, 0xc0135761
    s_mov_b32 s76, 0xbdd2d3e8
    v_mov_b32 v224, s74
    v_mov_b32 v225, s74
    s_waitcnt lgkmcnt(10)
    v_pk_add_f32 v[32:33], v[32:33], v[48:49]
    s_waitcnt lgkmcnt(9)
    v_pk_add_f32 v[16:17], v[16:17], v[64:65]
    v_pk_add_f32 v[34:35], v[34:35], v[50:51]
    v_pk_add_f32 v[18:19], v[18:19], v[66:67]
    s_waitcnt lgkmcnt(7)
    v_pk_add_f32 v[36:37], v[36:37], v[52:53]
    s_waitcnt lgkmcnt(6)
    v_pk_add_f32 v[20:21], v[20:21], v[68:69]
    v_pk_add_f32 v[38:39], v[38:39], v[54:55]
    v_pk_add_f32 v[22:23], v[22:23], v[70:71]
    v_pk_add_f32 v[16:17], v[16:17], v[32:33]
    v_pk_add_f32 v[18:19], v[18:19], v[34:35]
    v_pk_add_f32 v[20:21], v[20:21], v[36:37]
    v_pk_add_f32 v[22:23], v[22:23], v[38:39]
    v_pk_mul_f32 v[80:81], v[16:17], v[16:17]
    v_pk_mul_f32 v[82:83], v[18:19], v[18:19]
    v_pk_mul_f32 v[84:85], v[20:21], v[20:21]
    v_pk_mul_f32 v[86:87], v[22:23], v[22:23]
    v_pk_fma_f32 v[80:81], v[80:81], s[76:77], v[224:225] op_sel_hi:[1,0,1]
    v_pk_fma_f32 v[82:83], v[82:83], s[76:77], v[224:225] op_sel_hi:[1,0,1]
    v_pk_fma_f32 v[84:85], v[84:85], s[76:77], v[224:225] op_sel_hi:[1,0,1]
    v_pk_fma_f32 v[86:87], v[86:87], s[76:77], v[224:225] op_sel_hi:[1,0,1]
    v_pk_mul_f32 v[80:81], v[80:81], v[16:17]
    v_pk_mul_f32 v[82:83], v[82:83], v[18:19]
    v_pk_mul_f32 v[84:85], v[84:85], v[20:21]
    v_pk_mul_f32 v[86:87], v[86:87], v[22:23]
    v_exp_f32 v80, v80
    v_exp_f32 v81, v81
    v_exp_f32 v82, v82
    v_exp_f32 v83, v83
    v_exp_f32 v84, v84
    v_exp_f32 v85, v85
    v_exp_f32 v86, v86
    v_exp_f32 v87, v87
    v_pk_add_f32 v[80:81], v[80:81], 1.0 op_sel_hi:[1,0]
    v_pk_add_f32 v[82:83], v[82:83], 1.0 op_sel_hi:[1,0]
    v_pk_add_f32 v[84:85], v[84:85], 1.0 op_sel_hi:[1,0]
    v_pk_add_f32 v[86:87], v[86:87], 1.0 op_sel_hi:[1,0]
    v_rcp_f32 v80, v80
    v_rcp_f32 v81, v81
    v_rcp_f32 v82, v82
    v_rcp_f32 v83, v83
    v_rcp_f32 v84, v84
    v_rcp_f32 v85, v85
    v_rcp_f32 v86, v86
    v_rcp_f32 v87, v87
    v_pk_mul_f32 v[80:81], v[80:81], v[16:17]
    v_pk_mul_f32 v[82:83], v[82:83], v[18:19]
    v_pk_mul_f32 v[84:85], v[84:85], v[20:21]
    v_pk_mul_f32 v[86:87], v[86:87], v[22:23]
    v_cvt_pk_bf16_f32 v96, v80, v81
    v_cvt_pk_bf16_f32 v97, v82, v83
    v_cvt_pk_bf16_f32 v98, v84, v85
    v_cvt_pk_bf16_f32 v99, v86, v87
    buffer_store_dwordx4 v[96:99], v5, s[40:43], s68 offen offset:0 sc1
    s_waitcnt lgkmcnt(4)
    v_pk_add_f32 v[40:41], v[40:41], v[56:57]
    s_waitcnt lgkmcnt(3)
    v_pk_add_f32 v[24:25], v[24:25], v[72:73]
    v_pk_add_f32 v[42:43], v[42:43], v[58:59]
    v_pk_add_f32 v[26:27], v[26:27], v[74:75]
    s_waitcnt lgkmcnt(1)
    v_pk_add_f32 v[44:45], v[44:45], v[60:61]
    s_waitcnt lgkmcnt(0)
    v_pk_add_f32 v[28:29], v[28:29], v[76:77]
    v_pk_add_f32 v[46:47], v[46:47], v[62:63]
    v_pk_add_f32 v[30:31], v[30:31], v[78:79]
    v_pk_add_f32 v[24:25], v[24:25], v[40:41]
    v_pk_add_f32 v[26:27], v[26:27], v[42:43]
    v_pk_add_f32 v[28:29], v[28:29], v[44:45]
    v_pk_add_f32 v[30:31], v[30:31], v[46:47]
    v_pk_mul_f32 v[88:89], v[24:25], v[24:25]
    v_pk_mul_f32 v[90:91], v[26:27], v[26:27]
    v_pk_mul_f32 v[92:93], v[28:29], v[28:29]
    v_pk_mul_f32 v[94:95], v[30:31], v[30:31]
    v_pk_fma_f32 v[88:89], v[88:89], s[76:77], v[224:225] op_sel_hi:[1,0,1]
    v_pk_fma_f32 v[90:91], v[90:91], s[76:77], v[224:225] op_sel_hi:[1,0,1]
    v_pk_fma_f32 v[92:93], v[92:93], s[76:77], v[224:225] op_sel_hi:[1,0,1]
    v_pk_fma_f32 v[94:95], v[94:95], s[76:77], v[224:225] op_sel_hi:[1,0,1]
    v_pk_mul_f32 v[88:89], v[88:89], v[24:25]
    v_pk_mul_f32 v[90:91], v[90:91], v[26:27]
    v_pk_mul_f32 v[92:93], v[92:93], v[28:29]
    v_pk_mul_f32 v[94:95], v[94:95], v[30:31]
    v_exp_f32 v88, v88
    v_exp_f32 v89, v89
    v_exp_f32 v90, v90
    v_exp_f32 v91, v91
    v_exp_f32 v92, v92
    v_exp_f32 v93, v93
    v_exp_f32 v94, v94
    v_exp_f32 v95, v95
    v_pk_add_f32 v[88:89], v[88:89], 1.0 op_sel_hi:[1,0]
    v_pk_add_f32 v[90:91], v[90:91], 1.0 op_sel_hi:[1,0]
    v_pk_add_f32 v[92:93], v[92:93], 1.0 op_sel_hi:[1,0]
    v_pk_add_f32 v[94:95], v[94:95], 1.0 op_sel_hi:[1,0]
    v_rcp_f32 v88, v88
    v_rcp_f32 v89, v89
    v_rcp_f32 v90, v90
    v_rcp_f32 v91, v91
    v_rcp_f32 v92, v92
    v_rcp_f32 v93, v93
    v_rcp_f32 v94, v94
    v_rcp_f32 v95, v95
    v_pk_mul_f32 v[88:89], v[88:89], v[24:25]
    v_pk_mul_f32 v[90:91], v[90:91], v[26:27]
    v_pk_mul_f32 v[92:93], v[92:93], v[28:29]
    v_pk_mul_f32 v[94:95], v[94:95], v[30:31]
    v_cvt_pk_bf16_f32 v100, v88, v89
    v_cvt_pk_bf16_f32 v101, v90, v91
    v_cvt_pk_bf16_f32 v102, v92, v93
    v_cvt_pk_bf16_f32 v103, v94, v95
    buffer_store_dwordx4 v[100:103], v5, s[40:43], s68 offen offset:1024 sc1
    v_mov_b32 v9, v5
    s_waitcnt vmcnt(0)
    v_mov_b32 v8, s4
    s_mov_b64 exec, 1
    buffer_store_dword v8, v9, s[40:43], s82 offen sc1
    s_mov_b64 exec, -1
    s_cmp_ge_u32 s67, 99
    s_cbranch_scc1 L_end_P
    ds_read_b64_tr_b16 a[224:225], v217 offset:0
    ds_read_b64_tr_b16 a[226:227], v217 offset:1024
    ds_read_b64_tr_b16 a[228:229], v218 offset:0
    ds_read_b64_tr_b16 a[230:231], v218 offset:1024
    ds_read_b64_tr_b16 a[232:233], v217 offset:2048
    ds_read_b64_tr_b16 a[234:235], v217 offset:3072
    ds_read_b64_tr_b16 a[236:237], v218 offset:2048
    ds_read_b64_tr_b16 a[238:239], v218 offset:3072
    ds_read_b64_tr_b16 a[240:241], v217 offset:4096
    ds_read_b64_tr_b16 a[242:243], v217 offset:5120
    ds_read_b64_tr_b16 a[244:245], v218 offset:4096
    ds_read_b64_tr_b16 a[246:247], v218 offset:5120
    ds_read_b64_tr_b16 a[248:249], v217 offset:6144
    ds_read_b64_tr_b16 a[250:251], v217 offset:7168
    ds_read_b64_tr_b16 a[252:253], v218 offset:6144
    ds_read_b64_tr_b16 a[254:255], v218 offset:7168
    ds_read_b64_tr_b16 a[0:1], v217 offset:8192
    ds_read_b64_tr_b16 a[2:3], v217 offset:9216
    ds_read_b64_tr_b16 a[4:5], v218 offset:8192
    ds_read_b64_tr_b16 a[6:7], v218 offset:9216
    ds_read_b64_tr_b16 a[8:9], v217 offset:10240
    ds_read_b64_tr_b16 a[10:11], v217 offset:11264
    ds_read_b64_tr_b16 a[12:13], v218 offset:10240
    ds_read_b64_tr_b16 a[14:15], v218 offset:11264
    ds_read_b64_tr_b16 a[16:17], v217 offset:12288
    ds_read_b64_tr_b16 a[18:19], v217 offset:13312
    ds_read_b64_tr_b16 a[20:21], v218 offset:12288
    ds_read_b64_tr_b16 a[22:23], v218 offset:13312
    ds_read_b64_tr_b16 a[24:25], v217 offset:14336
    ds_read_b64_tr_b16 a[26:27], v217 offset:15360
    ds_read_b64_tr_b16 a[28:29], v218 offset:14336
    ds_read_b64_tr_b16 a[30:31], v218 offset:15360
    ds_read_b64_tr_b16 a[32:33], v217 offset:16384
    ds_read_b64_tr_b16 a[34:35], v217 offset:17408
    ds_read_b64_tr_b16 a[36:37], v218 offset:16384
    ds_read_b64_tr_b16 a[38:39], v218 offset:17408
    ds_read_b64_tr_b16 a[40:41], v217 offset:18432
    ds_read_b64_tr_b16 a[42:43], v217 offset:19456
    ds_read_b64_tr_b16 a[44:45], v218 offset:18432
    ds_read_b64_tr_b16 a[46:47], v218 offset:19456
    ds_read_b64_tr_b16 a[48:49], v217 offset:20480
    ds_read_b64_tr_b16 a[50:51], v217 offset:21504
    ds_read_b64_tr_b16 a[52:53], v218 offset:20480
    ds_read_b64_tr_b16 a[54:55], v218 offset:21504
    ds_read_b64_tr_b16 a[56:57], v217 offset:22528
    ds_read_b64_tr_b16 a[58:59], v217 offset:23552
    ds_read_b64_tr_b16 a[60:61], v218 offset:22528
    ds_read_b64_tr_b16 a[62:63], v218 offset:23552
    v_lshrrev_b32 v220, 5, v1
    v_lshlrev_b32 v220, 3, v220
    s_lshl_b32 s68, s67, 7
    s_lshr_b32 s69, s3, 1
    s_lshl_b32 s69, s69, 6
    s_add_u32 s68, s68, s69
    buffer_load_dwordx2 v[222:223], v220, s[32:35], s68 offen offset:0
    buffer_load_dwordx2 v[224:225], v220, s[32:35], s68 offen offset:16
    buffer_load_dwordx2 v[226:227], v220, s[32:35], s68 offen offset:32
    buffer_load_dwordx2 v[228:229], v220, s[32:35], s68 offen offset:48
    v_and_b32 v221, 31, v1
    v_lshl_add_u32 v221, v221, 4, v220
    s_lshl_b32 s68, s66, 1
    s_and_b32 s69, s3, 1
    s_add_u32 s68, s68, s69
    s_lshl_b32 s68, s68, 7
    s_lshl_b32 s69, s67, 2
    s_add_u32 s68, s68, s69
    s_and_b32 s69, s3, 2
    s_add_u32 s68, s68, s69
    s_lshl_b32 s68, s68, 10
    s_add_u32 s68, s68, 0x400000
    buffer_load_dwordx2 v[230:231], v221, s[40:43], s68 offen offset:0 sc1
    buffer_load_dwordx2 v[232:233], v221, s[40:43], s68 offen offset:512 sc1
    buffer_load_dwordx2 v[234:235], v221, s[40:43], s68 offen offset:1024 sc1
    buffer_load_dwordx2 v[236:237], v221, s[40:43], s68 offen offset:1536 sc1
    s_waitcnt lgkmcnt(0)
    s_add_u32 m0, s70, 0
    s_mov_b32 s68, 1572864
    buffer_load_dwordx4 v214, s[24:27], s68 offen lds
    s_add_u32 m0, s70, 1024
    s_mov_b32 s68, 1605632
    buffer_load_dwordx4 v214, s[24:27], s68 offen lds
    s_add_u32 m0, s70, 2048
    s_mov_b32 s68, 1638400
    buffer_load_dwordx4 v214, s[24:27], s68 offen lds
    s_add_u32 m0, s70, 3072
    s_mov_b32 s68, 1671168
    buffer_load_dwordx4 v214, s[24:27], s68 offen lds
    s_add_u32 m0, s70, 4096
    s_mov_b32 s68, 1703936
    buffer_load_dwordx4 v214, s[24:27], s68 offen lds
    s_add_u32 m0, s70, 5120
    s_mov_b32 s68, 1736704
    buffer_load_dwordx4 v214, s[24:27], s68 offen lds
    s_add_u32 m0, s70, 6144
    s_mov_b32 s68, 1769472
    buffer_load_dwordx4 v214, s[24:27], s68 offen lds
    s_add_u32 m0, s70, 7168
    s_mov_b32 s68, 1802240
    buffer_load_dwordx4 v214, s[24:27], s68 offen lds
    s_lshl_b32 s68, s66, 1
    s_and_b32 s69, s3, 1
    s_add_u32 s71, s68, s69
    s_xor_b32 s72, s71, 1
    s_mul_i32 s68, s3, 28672
    s_add_u32 s68, s68, 0x600000
    s_mul_i32 s71, s71, 114688
    s_add_u32 s71, s71, s68
    s_mul_i32 s72, s72, 114688
    s_add_u32 s72, s72, s68
    s_nop 1
Lpoll_P_6:
    s_sub_u32 s6, s6, 1
    s_cbranch_scc1 L_end_P
    buffer_load_dword v8, v12, s[40:43], s85 offen sc1
    s_waitcnt vmcnt(0)
    v_cmp_ne_u32 vcc, s4, v8
    s_nop 1
    s_cbranch_vccnz Lpoll_P_6
    buffer_load_dwordx4 v[80:83], v4, s[40:43], s71 offen offset:0 sc1
    buffer_load_dwordx4 v[84:87], v4, s[40:43], s72 offen offset:0 sc1
    buffer_load_dwordx4 v[88:91], v4, s[40:43], s71 offen offset:1024 sc1
    buffer_load_dwordx4 v[92:95], v4, s[40:43], s72 offen offset:1024 sc1
    buffer_load_dwordx4 v[96:99], v4, s[40:43], s71 offen offset:2048 sc1
    buffer_load_dwordx4 v[100:103], v4, s[40:43], s72 offen offset:2048 sc1
    buffer_load_dwordx4 v[104:107], v4, s[40:43], s71 offen offset:3072 sc1
    buffer_load_dwordx4 v[108:111], v4, s[40:43], s72 offen offset:3072 sc1
    ds_read_b64_tr_b16 a[64:65], v217 offset:0
    ds_read_b64_tr_b16 a[66:67], v217 offset:1024
    ds_read_b64_tr_b16 a[68:69], v218 offset:0
    ds_read_b64_tr_b16 a[70:71], v218 offset:1024
    ds_read_b64_tr_b16 a[72:73], v217 offset:2048
    ds_read_b64_tr_b16 a[74:75], v217 offset:3072
    ds_read_b64_tr_b16 a[76:77], v218 offset:2048
    ds_read_b64_tr_b16 a[78:79], v218 offset:3072
    ds_read_b64_tr_b16 a[80:81], v217 offset:4096
    ds_read_b64_tr_b16 a[82:83], v217 offset:5120
    ds_read_b64_tr_b16 a[84:85], v218 offset:4096
    ds_read_b64_tr_b16 a[86:87], v218 offset:5120
    ds_read_b64_tr_b16 a[88:89], v217 offset:6144
    ds_read_b64_tr_b16 a[90:91], v217 offset:7168
    ds_read_b64_tr_b16 a[92:93], v218 offset:6144
    ds_read_b64_tr_b16 a[94:95], v218 offset:7168
    v_lshlrev_b32 v16, 16, v222
    v_and_b32 v17, 0xffff0000, v222
    v_lshlrev_b32 v238, 16, v230
    v_and_b32 v239, 0xffff0000, v230
    v_pk_add_f32 v[16:17], v[16:17], v[238:239]
    v_lshlrev_b32 v18, 16, v223
    v_and_b32 v19, 0xffff0000, v223
    v_lshlrev_b32 v238, 16, v231
    v_and_b32 v239, 0xffff0000, v231
    v_pk_add_f32 v[18:19], v[18:19], v[238:239]
    v_lshlrev_b32 v20, 16, v224
    v_and_b32 v21, 0xffff0000, v224
    v_lshlrev_b32 v238, 16, v232
    v_and_b32 v239, 0xffff0000, v232
    v_pk_add_f32 v[20:21], v[20:21], v[238:239]
    v_lshlrev_b32 v22, 16, v225
    v_and_b32 v23, 0xffff0000, v225
    v_lshlrev_b32 v238, 16, v233
    v_and_b32 v239, 0xffff0000, v233
    v_pk_add_f32 v[22:23], v[22:23], v[238:239]
    v_lshlrev_b32 v24, 16, v226
    v_and_b32 v25, 0xffff0000, v226
    v_lshlrev_b32 v238, 16, v234
    v_and_b32 v239, 0xffff0000, v234
    v_pk_add_f32 v[24:25], v[24:25], v[238:239]
    v_lshlrev_b32 v26, 16, v227
    v_and_b32 v27, 0xffff0000, v227
    v_lshlrev_b32 v238, 16, v235
    v_and_b32 v239, 0xffff0000, v235
    v_pk_add_f32 v[26:27], v[26:27], v[238:239]
    v_lshlrev_b32 v28, 16, v228
    v_and_b32 v29, 0xffff0000, v228
    v_lshlrev_b32 v238, 16, v236
    v_and_b32 v239, 0xffff0000, v236
    v_pk_add_f32 v[28:29], v[28:29], v[238:239]
    v_lshlrev_b32 v30, 16, v229
    v_and_b32 v31, 0xffff0000, v229
    v_lshlrev_b32 v238, 16, v237
    v_and_b32 v239, 0xffff0000, v237
    v_pk_add_f32 v[30:31], v[30:31], v[238:239]
    s_add_u32 s71, s71, 4096
    s_add_u32 s72, s72, 4096
    buffer_load_dwordx4 v[112:115], v4, s[40:43], s71 offen offset:0 sc1
    buffer_load_dwordx4 v[116:119], v4, s[40:43], s72 offen offset:0 sc1
    buffer_load_dwordx4 v[120:123], v4, s[40:43], s71 offen offset:1024 sc1
    buffer_load_dwordx4 v[124:127], v4, s[40:43], s72 offen offset:1024 sc1
    buffer_load_dwordx4 v[128:131], v4, s[40:43], s71 offen offset:2048 sc1
    buffer_load_dwordx4 v[132:135], v4, s[40:43], s72 offen offset:2048 sc1
    buffer_load_dwordx4 v[136:139], v4, s[40:43], s71 offen offset:3072 sc1
    buffer_load_dwordx4 v[140:143], v4, s[40:43], s72 offen offset:3072 sc1
    s_add_u32 s71, s71, 4096
    s_add_u32 s72, s72, 4096
    buffer_load_dwordx4 v[144:147], v4, s[40:43], s71 offen offset:0 sc1
    buffer_load_dwordx4 v[148:151], v4, s[40:43], s72 offen offset:0 sc1
    buffer_load_dwordx4 v[152:155], v4, s[40:43], s71 offen offset:1024 sc1
    buffer_load_dwordx4 v[156:159], v4, s[40:43], s72 offen offset:1024 sc1
    buffer_load_dwordx4 v[160:163], v4, s[40:43], s71 offen offset:2048 sc1
    buffer_load_dwordx4 v[164:167], v4, s[40:43], s72 offen offset:2048 sc1
    buffer_load_dwordx4 v[168:171], v4, s[40:43], s71 offen offset:3072 sc1
    buffer_load_dwordx4 v[172:175], v4, s[40:43], s72 offen offset:3072 sc1
    s_add_u32 s71, s71, 4096
    s_add_u32 s72, s72, 4096
    buffer_load_dwordx4 v[176:179], v4, s[40:43], s71 offen offset:0 sc1
    buffer_load_dwordx4 v[180:183], v4, s[40:43], s72 offen offset:0 sc1
    buffer_load_dwordx4 v[184:187], v4, s[40:43], s71 offen offset:1024 sc1
    buffer_load_dwordx4 v[188:191], v4, s[40:43], s72 offen offset:1024 sc1
    buffer_load_dwordx4 v[192:195], v4, s[40:43], s71 offen offset:2048 sc1
    buffer_load_dwordx4 v[196:199], v4, s[40:43], s72 offen offset:2048 sc1
    buffer_load_dwordx4 v[200:203], v4, s[40:43], s71 offen offset:3072 sc1
    buffer_load_dwordx4 v[204:207], v4, s[40:43], s72 offen offset:3072 sc1
    v_lshrrev_b32 v220, 5, v1
    v_lshlrev_b32 v220, 10, v220
    v_and_b32 v221, 31, v1
    v_lshl_add_u32 v220, v221, 2, v220
    s_lshr_b32 s69, s3, 1
    s_lshl_b32 s68, s69, 13
    s_and_b32 s69, s3, 1
    s_lshl_b32 s69, s69, 7
    s_add_u32 s68, s68, s69
    v_add_u32 v220, s68, v220
    v_xor_b32 v221, 128, v220
    v_xor_b32 v222, 0x2000, v220
    v_xor_b32 v223, 0x2080, v220
    s_mul_i32 s68, s3, 24576
    s_add_u32 s68, s68, 65536
    v_add_u32 v220, s68, v220
    v_add_u32 v221, s68, v221
    v_add_u32 v222, s68, v222
    v_add_u32 v223, s68, v223
    s_lshl_b32 s68, s3, 12
    s_add_u32 s68, s68, 65536
    v_add_u32 v224, s68, v4
    v_add_u32 v226, 49152, v224
    v_mul_u32_u24 v225, 896, v3
    v_lshl_add_u32 v225, v2, 3, v225
    s_lshl_b32 s68, s67, 2
    s_add_u32 s68, s68, s3
    s_mul_i32 s68, s68, 14336
    s_lshl_b32 s69, s66, 7
    s_add_u32 s68, s68, s69
    s_add_u32 s69, s68, 7168
    s_waitcnt vmcnt(31)
    v_mfma_f32_32x32x16_bf16 v[16:31], a[128:131], v[80:83], v[16:31]
    s_waitcnt vmcnt(30)
    v_mfma_f32_32x32x16_bf16 v[32:47], a[128:131], v[84:87], 0
    v_mfma_f32_32x32x16_bf16 v[48:63], a[132:135], v[80:83], 0
    v_mfma_f32_32x32x16_bf16 v[64:79], a[132:135], v[84:87], 0
    s_add_u32 s71, s71, 4096
    s_add_u32 s72, s72, 4096
    buffer_load_dwordx4 v[80:83], v4, s[40:43], s71 offen offset:0 sc1
    buffer_load_dwordx4 v[84:87], v4, s[40:43], s72 offen offset:0 sc1
    s_waitcnt vmcnt(31)
    v_mfma_f32_32x32x16_bf16 v[16:31], a[136:139], v[88:91], v[16:31]
    s_waitcnt vmcnt(30)
    v_mfma_f32_32x32x16_bf16 v[32:47], a[136:139], v[92:95], v[32:47]
    v_mfma_f32_32x32x16_bf16 v[48:63], a[140:143], v[88:91], v[48:63]
    v_mfma_f32_32x32x16_bf16 v[64:79], a[140:143], v[92:95], v[64:79]
    buffer_load_dwordx4 v[88:91], v4, s[40:43], s71 offen offset:1024 sc1
    buffer_load_dwordx4 v[92:95], v4, s[40:43], s72 offen offset:1024 sc1
    s_waitcnt vmcnt(31)
    v_mfma_f32_32x32x16_bf16 v[16:31], a[144:147], v[96:99], v[16:31]
    s_waitcnt vmcnt(30)
    v_mfma_f32_32x32x16_bf16 v[32:47], a[144:147], v[100:103], v[32:47]
    v_mfma_f32_32x32x16_bf16 v[48:63], a[148:151], v[96:99], v[48:63]
    v_mfma_f32_32x32x16_bf16 v[64:79], a[148:151], v[100:103], v[64:79]
    buffer_load_dwordx4 v[96:99], v4, s[40:43], s71 offen offset:2048 sc1
    buffer_load_dwordx4 v[100:103], v4, s[40:43], s72 offen offset:2048 sc1
    s_waitcnt vmcnt(31)
    v_mfma_f32_32x32x16_bf16 v[16:31], a[152:155], v[104:107], v[16:31]
    s_waitcnt vmcnt(30)
    v_mfma_f32_32x32x16_bf16 v[32:47], a[152:155], v[108:111], v[32:47]
    v_mfma_f32_32x32x16_bf16 v[48:63], a[156:159], v[104:107], v[48:63]
    v_mfma_f32_32x32x16_bf16 v[64:79], a[156:159], v[108:111], v[64:79]
    buffer_load_dwordx4 v[104:107], v4, s[40:43], s71 offen offset:3072 sc1
    buffer_load_dwordx4 v[108:111], v4, s[40:43], s72 offen offset:3072 sc1
    s_waitcnt vmcnt(31)
    v_mfma_f32_32x32x16_bf16 v[16:31], a[160:163], v[112:115], v[16:31]
    s_waitcnt vmcnt(30)
    v_mfma_f32_32x32x16_bf16 v[32:47], a[160:163], v[116:119], v[32:47]
    v_mfma_f32_32x32x16_bf16 v[48:63], a[164:167], v[112:115], v[48:63]
    v_mfma_f32_32x32x16_bf16 v[64:79], a[164:167], v[116:119], v[64:79]
    s_add_u32 s71, s71, 4096
    s_add_u32 s72, s72, 4096
    buffer_load_dwordx4 v[112:115], v4, s[40:43], s71 offen offset:0 sc1
    buffer_load_dwordx4 v[116:119], v4, s[40:43], s72 offen offset:0 sc1
    s_waitcnt vmcnt(31)
    v_mfma_f32_32x32x16_bf16 v[16:31], a[168:171], v[120:123], v[16:31]
    s_waitcnt vmcnt(30)
    v_mfma_f32_32x32x16_bf16 v[32:47], a[168:171], v[124:127], v[32:47]
    v_mfma_f32_32x32x16_bf16 v[48:63], a[172:175], v[120:123], v[48:63]
    v_mfma_f32_32x32x16_bf16 v[64:79], a[172:175], v[124:127], v[64:79]
    buffer_load_dwordx4 v[120:123], v4, s[40:43], s71 offen offset:1024 sc1
    buffer_load_dwordx4 v[124:127], v4, s[40:43], s72 offen offset:1024 sc1
    s_waitcnt vmcnt(31)
    v_mfma_f32_32x32x16_bf16 v[16:31], a[176:179], v[128:131], v[16:31]
    s_waitcnt vmcnt(30)
    v_mfma_f32_32x32x16_bf16 v[32:47], a[176:179], v[132:135], v[32:47]
    v_mfma_f32_32x32x16_bf16 v[48:63], a[180:183], v[128:131], v[48:63]
    v_mfma_f32_32x32x16_bf16 v[64:79], a[180:183], v[132:135], v[64:79]
    buffer_load_dwordx4 v[128:131], v4, s[40:43], s71 offen offset:2048 sc1
    buffer_load_dwordx4 v[132:135], v4, s[40:43], s72 offen offset:2048 sc1
    s_waitcnt vmcnt(31)
    v_mfma_f32_32x32x16_bf16 v[16:31], a[184:187], v[136:139], v[16:31]
    s_waitcnt vmcnt(30)
    v_mfma_f32_32x32x16_bf16 v[32:47], a[184:187], v[140:143], v[32:47]
    v_mfma_f32_32x32x16_bf16 v[48:63], a[188:191], v[136:139], v[48:63]
    v_mfma_f32_32x32x16_bf16 v[64:79], a[188:191], v[140:143], v[64:79]
    buffer_load_dwordx4 v[136:139], v4, s[40:43], s71 offen offset:3072 sc1
    buffer_load_dwordx4 v[140:143], v4, s[40:43], s72 offen offset:3072 sc1
    s_waitcnt vmcnt(31)
    v_mfma_f32_32x32x16_bf16 v[16:31], a[192:195], v[144:147], v[16:31]
    s_waitcnt vmcnt(30)
    v_mfma_f32_32x32x16_bf16 v[32:47], a[192:195], v[148:151], v[32:47]
    v_mfma_f32_32x32x16_bf16 v[48:63], a[196:199], v[144:147], v[48:63]
    v_mfma_f32_32x32x16_bf16 v[64:79], a[196:199], v[148:151], v[64:79]
    s_add_u32 s71, s71, 4096
    s_add_u32 s72, s72, 4096
    buffer_load_dwordx4 v[144:147], v4, s[40:43], s71 offen offset:0 sc1
    buffer_load_dwordx4 v[148:151], v4, s[40:43], s72 offen offset:0 sc1
    s_waitcnt vmcnt(31)
    v_mfma_f32_32x32x16_bf16 v[16:31], a[200:203], v[152:155], v[16:31]
    s_waitcnt vmcnt(30)
    v_mfma_f32_32x32x16_bf16 v[32:47], a[200:203], v[156:159], v[32:47]
    v_mfma_f32_32x32x16_bf16 v[48:63], a[204:207], v[152:155], v[48:63]
    v_mfma_f32_32x32x16_bf16 v[64:79], a[204:207], v[156:159], v[64:79]
    buffer_load_dwordx4 v[152:155], v4, s[40:43], s71 offen offset:1024 sc1
    buffer_load_dwordx4 v[156:159], v4, s[40:43], s72 offen offset:1024 sc1
    s_waitcnt vmcnt(31)
    v_mfma_f32_32x32x16_bf16 v[16:31], a[208:211], v[160:163], v[16:31]
    s_waitcnt vmcnt(30)
    v_mfma_f32_32x32x16_bf16 v[32:47], a[208:211], v[164:167], v[32:47]
    v_mfma_f32_32x32x16_bf16 v[48:63], a[212:215], v[160:163], v[48:63]
    v_mfma_f32_32x32x16_bf16 v[64:79], a[212:215], v[164:167], v[64:79]
    buffer_load_dwordx4 v[160:163], v4, s[40:43], s71 offen offset:2048 sc1
    buffer_load_dwordx4 v[164:167], v4, s[40:43], s72 offen offset:2048 sc1
    s_waitcnt vmcnt(31)
    v_mfma_f32_32x32x16_bf16 v[16:31], a[216:219], v[168:171], v[16:31]
    s_waitcnt vmcnt(30)
    v_mfma_f32_32x32x16_bf16 v[32:47], a[216:219], v[172:175], v[32:47]
    v_mfma_f32_32x32x16_bf16 v[48:63], a[220:223], v[168:171], v[48:63]
    v_mfma_f32_32x32x16_bf16 v[64:79], a[220:223], v[172:175], v[64:79]
    buffer_load_dwordx4 v[168:171], v4, s[40:43], s71 offen offset:3072 sc1
    buffer_load_dwordx4 v[172:175], v4, s[40:43], s72 offen offset:3072 sc1
    s_waitcnt vmcnt(31)
    v_mfma_f32_32x32x16_bf16 v[16:31], a[224:227], v[176:179], v[16:31]
    s_waitcnt vmcnt(30)
    v_mfma_f32_32x32x16_bf16 v[32:47], a[224:227], v[180:183], v[32:47]
    v_mfma_f32_32x32x16_bf16 v[48:63], a[228:231], v[176:179], v[48:63]
    v_mfma_f32_32x32x16_bf16 v[64:79], a[228:231], v[180:183], v[64:79]
    s_waitcnt vmcnt(29)
    v_mfma_f32_32x32x16_bf16 v[16:31], a[232:235], v[184:187], v[16:31]
    s_waitcnt vmcnt(28)
    v_mfma_f32_32x32x16_bf16 v[32:47], a[232:235], v[188:191], v[32:47]
    v_mfma_f32_32x32x16_bf16 v[48:63], a[236:239], v[184:187], v[48:63]
    v_mfma_f32_32x32x16_bf16 v[64:79], a[236:239], v[188:191], v[64:79]
    s_waitcnt vmcnt(27)
    v_mfma_f32_32x32x16_bf16 v[16:31], a[240:243], v[192:195], v[16:31]
    s_waitcnt vmcnt(26)
    v_mfma_f32_32x32x16_bf16 v[32:47], a[240:243], v[196:199], v[32:47]
    v_mfma_f32_32x32x16_bf16 v[48:63], a[244:247], v[192:195], v[48:63]
    v_mfma_f32_32x32x16_bf16 v[64:79], a[244:247], v[196:199], v[64:79]
    s_waitcnt vmcnt(25)
    v_mfma_f32_32x32x16_bf16 v[16:31], a[248:251], v[200:203], v[16:31]
    s_waitcnt vmcnt(24)
    v_mfma_f32_32x32x16_bf16 v[32:47], a[248:251], v[204:207], v[32:47]
    v_mfma_f32_32x32x16_bf16 v[48:63], a[252:255], v[200:203], v[48:63]
    v_mfma_f32_32x32x16_bf16 v[64:79], a[252:255], v[204:207], v[64:79]
    s_waitcnt vmcnt(23)
    v_mfma_f32_32x32x16_bf16 v[16:31], a[0:3], v[80:83], v[16:31]
    s_waitcnt vmcnt(22)
    v_mfma_f32_32x32x16_bf16 v[32:47], a[0:3], v[84:87], v[32:47]
    v_mfma_f32_32x32x16_bf16 v[48:63], a[4:7], v[80:83], v[48:63]
    v_mfma_f32_32x32x16_bf16 v[64:79], a[4:7], v[84:87], v[64:79]
    s_waitcnt vmcnt(21)
    v_mfma_f32_32x32x16_bf16 v[16:31], a[8:11], v[88:91], v[16:31]
    s_waitcnt vmcnt(20)
    v_mfma_f32_32x32x16_bf16 v[32:47], a[8:11], v[92:95], v[32:47]
    v_mfma_f32_32x32x16_bf16 v[48:63], a[12:15], v[88:91], v[48:63]
    v_mfma_f32_32x32x16_bf16 v[64:79], a[12:15], v[92:95], v[64:79]
    s_waitcnt vmcnt(19)
    v_mfma_f32_32x32x16_bf16 v[16:31], a[16:19], v[96:99], v[16:31]
    s_waitcnt vmcnt(18)
    v_mfma_f32_32x32x16_bf16 v[32:47], a[16:19], v[100:103], v[32:47]
    v_mfma_f32_32x32x16_bf16 v[48:63], a[20:23], v[96:99], v[48:63]
    v_mfma_f32_32x32x16_bf16 v[64:79], a[20:23], v[100:103], v[64:79]
    s_waitcnt vmcnt(17)
    v_mfma_f32_32x32x16_bf16 v[16:31], a[24:27], v[104:107], v[16:31]
    s_waitcnt vmcnt(16)
    v_mfma_f32_32x32x16_bf16 v[32:47], a[24:27], v[108:111], v[32:47]
    v_mfma_f32_32x32x16_bf16 v[48:63], a[28:31], v[104:107], v[48:63]
    v_mfma_f32_32x32x16_bf16 v[64:79], a[28:31], v[108:111], v[64:79]
    s_waitcnt vmcnt(15)
    v_mfma_f32_32x32x16_bf16 v[16:31], a[32:35], v[112:115], v[16:31]
    s_waitcnt vmcnt(14)
    v_mfma_f32_32x32x16_bf16 v[32:47], a[32:35], v[116:119], v[32:47]
    v_mfma_f32_32x32x16_bf16 v[48:63], a[36:39], v[112:115], v[48:63]
    v_mfma_f32_32x32x16_bf16 v[64:79], a[36:39], v[116:119], v[64:79]
    s_waitcnt vmcnt(13)
    v_mfma_f32_32x32x16_bf16 v[16:31], a[40:43], v[120:123], v[16:31]
    s_waitcnt vmcnt(12)
    v_mfma_f32_32x32x16_bf16 v[32:47], a[40:43], v[124:127], v[32:47]
    v_mfma_f32_32x32x16_bf16 v[48:63], a[44:47], v[120:123], v[48:63]
    v_mfma_f32_32x32x16_bf16 v[64:79], a[44:47], v[124:127], v[64:79]
    s_waitcnt vmcnt(11)
    v_mfma_f32_32x32x16_bf16 v[16:31], a[48:51], v[128:131], v[16:31]
    s_waitcnt vmcnt(10)
    v_mfma_f32_32x32x16_bf16 v[32:47], a[48:51], v[132:135], v[32:47]
    v_mfma_f32_32x32x16_bf16 v[48:63], a[52:55], v[128:131], v[48:63]
    v_mfma_f32_32x32x16_bf16 v[64:79], a[52:55], v[132:135], v[64:79]
    s_waitcnt vmcnt(9)
    v_mfma_f32_32x32x16_bf16 v[16:31], a[56:59], v[136:139], v[16:31]
    s_waitcnt vmcnt(8)
    v_mfma_f32_32x32x16_bf16 v[32:47], a[56:59], v[140:143], v[32:47]
    v_mfma_f32_32x32x16_bf16 v[48:63], a[60:63], v[136:139], v[48:63]
    v_mfma_f32_32x32x16_bf16 v[64:79], a[60:63], v[140:143], v[64:79]
    s_waitcnt vmcnt(7) lgkmcnt(14)
    v_mfma_f32_32x32x16_bf16 v[16:31], a[64:67], v[144:147], v[16:31]
    s_waitcnt vmcnt(6)
    v_mfma_f32_32x32x16_bf16 v[32:47], a[64:67], v[148:151], v[32:47]
    s_waitcnt lgkmcnt(12)
    v_mfma_f32_32x32x16_bf16 v[48:63], a[68:71], v[144:147], v[48:63]
    v_mfma_f32_32x32x16_bf16 v[64:79], a[68:71], v[148:151], v[64:79]
    s_waitcnt vmcnt(5) lgkmcnt(10)
    v_mfma_f32_32x32x16_bf16 v[16:31], a[72:75], v[152:155], v[16:31]
    s_waitcnt vmcnt(4)
    v_mfma_f32_32x32x16_bf16 v[32:47], a[72:75], v[156:159], v[32:47]
    s_waitcnt lgkmcnt(8)
    v_mfma_f32_32x32x16_bf16 v[48:63], a[76:79], v[152:155], v[48:63]
    v_mfma_f32_32x32x16_bf16 v[64:79], a[76:79], v[156:159], v[64:79]
    s_waitcnt vmcnt(3) lgkmcnt(6)
    v_mfma_f32_32x32x16_bf16 v[16:31], a[80:83], v[160:163], v[16:31]
    s_waitcnt vmcnt(2)
    v_mfma_f32_32x32x16_bf16 v[32:47], a[80:83], v[164:167], v[32:47]
    s_waitcnt lgkmcnt(4)
    v_mfma_f32_32x32x16_bf16 v[48:63], a[84:87], v[160:163], v[48:63]
    v_mfma_f32_32x32x16_bf16 v[64:79], a[84:87], v[164:167], v[64:79]
    s_waitcnt vmcnt(1) lgkmcnt(2)
    v_mfma_f32_32x32x16_bf16 v[16:31], a[88:91], v[168:171], v[16:31]
    s_waitcnt vmcnt(0)
    v_mfma_f32_32x32x16_bf16 v[32:47], a[88:91], v[172:175], v[32:47]
    s_waitcnt lgkmcnt(0)
    v_mfma_f32_32x32x16_bf16 v[48:63], a[92:95], v[168:171], v[48:63]
    v_mfma_f32_32x32x16_bf16 v[64:79], a[92:95], v[172:175], v[64:79]
    s_nop 6
    ds_write2st64_b32 v220, v16, v17 offset0:0 offset1:1
    ds_write2st64_b32 v220, v18, v19 offset0:2 offset1:3
    ds_write2st64_b32 v220, v20, v21 offset0:8 offset1:9
    ds_write2st64_b32 v220, v22, v23 offset0:10 offset1:11
    ds_write2st64_b32 v220, v24, v25 offset0:16 offset1:17
    ds_write2st64_b32 v220, v26, v27 offset0:18 offset1:19
    ds_write2st64_b32 v220, v28, v29 offset0:24 offset1:25
    ds_write2st64_b32 v220, v30, v31 offset0:26 offset1:27
    ds_write2st64_b32 v221, v32, v33 offset0:0 offset1:1
    ds_write2st64_b32 v221, v34, v35 offset0:2 offset1:3
    ds_write2st64_b32 v221, v36, v37 offset0:8 offset1:9
    ds_write2st64_b32 v221, v38, v39 offset0:10 offset1:11
    ds_write2st64_b32 v221, v40, v41 offset0:16 offset1:17
    ds_write2st64_b32 v221, v42, v43 offset0:18 offset1:19
    ds_write2st64_b32 v221, v44, v45 offset0:24 offset1:25
    ds_write2st64_b32 v221, v46, v47 offset0:26 offset1:27
    ds_write2st64_b32 v222, v48, v49 offset0:0 offset1:1
    ds_write2st64_b32 v222, v50, v51 offset0:2 offset1:3
    ds_write2st64_b32 v222, v52, v53 offset0:8 offset1:9
    ds_write2st64_b32 v222, v54, v55 offset0:10 offset1:11
    ds_write2st64_b32 v222, v56, v57 offset0:16 offset1:17
    ds_write2st64_b32 v222, v58, v59 offset0:18 offset1:19
    ds_write2st64_b32 v222, v60, v61 offset0:24 offset1:25
    ds_write2st64_b32 v222, v62, v63 offset0:26 offset1:27
    ds_write2st64_b32 v223, v64, v65 offset0:0 offset1:1
    ds_write2st64_b32 v223, v66, v67 offset0:2 offset1:3
    ds_write2st64_b32 v223, v68, v69 offset0:8 offset1:9
    ds_write2st64_b32 v223, v70, v71 offset0:10 offset1:11
    ds_write2st64_b32 v223, v72, v73 offset0:16 offset1:17
    ds_write2st64_b32 v223, v74, v75 offset0:18 offset1:19
    ds_write2st64_b32 v223, v76, v77 offset0:24 offset1:25
    ds_write2st64_b32 v223, v78, v79 offset0:26 offset1:27
    s_waitcnt lgkmcnt(0)
    s_barrier
    ds_read_b128 v[16:19], v224 offset:0
    ds_read_b128 v[20:23], v224 offset:24576
    ds_read_b128 v[24:27], v226 offset:0
    ds_read_b128 v[28:31], v226 offset:24576
    ds_read_b128 v[32:35], v224 offset:1024
    ds_read_b128 v[36:39], v224 offset:25600
    ds_read_b128 v[40:43], v226 offset:1024
    ds_read_b128 v[44:47], v226 offset:25600
    ds_read_b128 v[48:51], v224 offset:2048
    ds_read_b128 v[52:55], v224 offset:26624
    ds_read_b128 v[56:59], v226 offset:2048
    ds_read_b128 v[60:63], v226 offset:26624
    ds_read_b128 v[64:67], v224 offset:3072
    ds_read_b128 v[68:71], v224 offset:27648
    ds_read_b128 v[72:75], v226 offset:3072
    ds_read_b128 v[76:79], v226 offset:27648
    s_waitcnt lgkmcnt(14)
    v_pk_add_f32 v[16:17], v[16:17], v[20:21]
    s_waitcnt lgkmcnt(12)
    v_pk_add_f32 v[24:25], v[24:25], v[28:29]
    v_pk_add_f32 v[18:19], v[18:19], v[22:23]
    v_pk_add_f32 v[26:27], v[26:27], v[30:31]
    v_pk_add_f32 v[16:17], v[16:17], v[24:25]
    v_pk_add_f32 v[18:19], v[18:19], v[26:27]
    v_cvt_pk_bf16_f32 v20, v16, v17
    v_cvt_pk_bf16_f32 v21, v18, v19
    buffer_store_dwordx2 v[20:21], v225, s[36:39], s68 offen offset:0
    s_waitcnt lgkmcnt(10)
    v_pk_add_f32 v[32:33], v[32:33], v[36:37]
    s_waitcnt lgkmcnt(8)
    v_pk_add_f32 v[40:41], v[40:41], v[44:45]
    v_pk_add_f32 v[34:35], v[34:35], v[38:39]
    v_pk_add_f32 v[42:43], v[42:43], v[46:47]
    v_pk_add_f32 v[32:33], v[32:33], v[40:41]
    v_pk_add_f32 v[34:35], v[34:35], v[42:43]
    v_cvt_pk_bf16_f32 v36, v32, v33
    v_cvt_pk_bf16_f32 v37, v34, v35
    buffer_store_dwordx2 v[36:37], v225, s[36:39], s68 offen offset:3584
    s_waitcnt lgkmcnt(6)
    v_pk_add_f32 v[48:49], v[48:49], v[52:53]
    s_waitcnt lgkmcnt(4)
    v_pk_add_f32 v[56:57], v[56:57], v[60:61]
    v_pk_add_f32 v[50:51], v[50:51], v[54:55]
    v_pk_add_f32 v[58:59], v[58:59], v[62:63]
    v_pk_add_f32 v[48:49], v[48:49], v[56:57]
    v_pk_add_f32 v[50:51], v[50:51], v[58:59]
    v_cvt_pk_bf16_f32 v52, v48, v49
    v_cvt_pk_bf16_f32 v53, v50, v51
    buffer_store_dwordx2 v[52:53], v225, s[36:39], s69 offen offset:0
    s_waitcnt lgkmcnt(2)
    v_pk_add_f32 v[64:65], v[64:65], v[68:69]
    s_waitcnt lgkmcnt(0)
    v_pk_add_f32 v[72:73], v[72:73], v[76:77]
    v_pk_add_f32 v[66:67], v[66:67], v[70:71]
    v_pk_add_f32 v[74:75], v[74:75], v[78:79]
    v_pk_add_f32 v[64:65], v[64:65], v[72:73]
    v_pk_add_f32 v[66:67], v[66:67], v[74:75]
    v_cvt_pk_bf16_f32 v68, v64, v65
    v_cvt_pk_bf16_f32 v69, v66, v67
    buffer_store_dwordx2 v[68:69], v225, s[36:39], s69 offen offset:3584
L_end_P:
    s_endpgm

.section .rodata,"a"
.p2align 6
.amdhsa_kernel sequential_preLN__sliding_local_dilated__mixer_token_mlp__prompt_kernel
  .amdhsa_next_free_vgpr 508
  .amdhsa_next_free_sgpr 102
  .amdhsa_accum_offset 252
  .amdhsa_group_segment_fixed_size 0
  .amdhsa_kernarg_size 88
  .amdhsa_user_sgpr_count 2
  .amdhsa_user_sgpr_kernarg_segment_ptr 1
  .amdhsa_system_sgpr_workgroup_id_x 1
.end_amdhsa_kernel
```

```asm
; @launch grid=(256,1,1) block=(256,1,1) lds=163840
.amdgcn_target "amdgcn-amd-amdhsa--gfx950"
.text
.globl sequential_preLN__sliding_local_dilated__mixer_token_mlp__prompt_kernel
.p2align 8
.type sequential_preLN__sliding_local_dilated__mixer_token_mlp__prompt_kernel,@function
sequential_preLN__sliding_local_dilated__mixer_token_mlp__prompt_kernel:
    s_cmp_ge_u32 s2, 256
    s_cbranch_scc1 L_end_P
    s_load_dwordx2 s[8:9], s[0:1], 0
    s_load_dwordx2 s[12:13], s[0:1], 8
    s_load_dwordx2 s[44:45], s[0:1], 72
    s_load_dwordx2 s[40:41], s[0:1], 80
    s_load_dwordx2 s[16:17], s[0:1], 16
    s_load_dwordx2 s[20:21], s[0:1], 32
    s_load_dwordx2 s[24:25], s[0:1], 48
    s_load_dwordx2 s[28:29], s[0:1], 40
    s_load_dwordx2 s[32:33], s[0:1], 56
    s_load_dwordx2 s[36:37], s[0:1], 64
    v_lshrrev_b32 v1, 6, v0
    s_nop 0
    v_readfirstlane_b32 s3, v1
    v_and_b32 v1, 63, v0
    v_and_b32 v2, 15, v0
    v_lshrrev_b32 v3, 4, v1
    v_lshlrev_b32 v4, 4, v1
    s_mov_b32 s10, 0x1c0000
    s_mov_b32 s11, 0x00020000
    s_mov_b32 s14, 0x126000
    s_mov_b32 s15, 0x00020000
    s_mov_b32 s46, 0x100
    s_mov_b32 s47, 0x00020000
    s_mov_b32 s42, 0x590000
    s_mov_b32 s43, 0x00020000
    s_mov_b32 s18, 0x62000
    s_mov_b32 s19, 0x00020000
    s_mov_b32 s22, 0x700000
    s_mov_b32 s23, 0x00020000
    s_mov_b32 s26, 0x700000
    s_mov_b32 s27, 0x00020000
    s_mov_b32 s30, 0xe00
    s_mov_b32 s31, 0x00020000
    s_mov_b32 s34, 0x1000
    s_mov_b32 s35, 0x00020000
    s_mov_b32 s38, 0x1c0000
    s_mov_b32 s39, 0x00020000
    s_mov_b32 s5, 0x3f803f80
    s_mov_b32 s6, 0x40000
    s_bfe_u32 s48, s2, 0x20001
    s_lshl_b32 s48, s48, 2
    s_lshr_b32 s53, s2, 6
    s_add_u32 s48, s48, s53
    s_bfe_u32 s49, s2, 0x30003
    s_and_b32 s53, s2, 1
    s_lshl_b32 s53, s53, 3
    s_add_u32 s49, s49, s53
    v_lshrrev_b32 v237, 2, v1
    v_mul_u32_u24 v123, 2688, v237
    v_lshrrev_b32 v237, 5, v1
    v_lshlrev_b32 v237, 1, v237
    v_and_b32 v238, 3, v1
    v_xor_b32 v237, v237, v238
    v_lshl_add_u32 v123, v237, 4, v123
    s_mul_i32 s53, s49, 56
    s_min_u32 s53, s53, 832
    s_mul_i32 s51, s3, 43008
    s_add_u32 s53, s53, s51
    v_add_u32 v123, s53, v123
    s_lshr_b32 s53, s3, 1
    s_mul_i32 s51, s53, 6144
    s_and_b32 s53, s3, 1
    s_lshl_b32 s53, s53, 10
    s_add_u32 s51, s51, s53
    v_lshrrev_b32 v237, 3, v1
    v_mul_u32_u24 v122, 896, v237
    v_and_b32 v237, 7, v1
    v_xor_b32 v237, v237, v3
    v_lshl_add_u32 v120, v237, 4, v122
    s_lshl_b32 s50, s48, 7
    s_lshl_b32 s53, s3, 5
    s_add_u32 s53, s53, s50
    s_mul_i32 s53, s53, 896
    v_xor_b32 v121, 64, v120
    v_add_u32 v120, s53, v120
    s_add_u32 s53, s53, 7168
    v_add_u32 v121, s53, v121
    s_lshl_b32 s53, s3, 1
    v_xor_b32 v237, s53, v237
    v_lshl_add_u32 v122, v237, 4, v122
    s_lshl_b32 s53, s3, 2
    s_add_u32 s53, s53, s50
    s_sub_u32 s53, s53, 16
    s_mul_i32 s53, s53, 896
    s_cmp_eq_u32 s48, 0
    s_cselect_b32 s53, 0x40000000, s53
    v_add_u32 v122, s53, v122
    s_lshl_b32 s52, s3, 12
    s_add_u32 s52, s52, 63488
    s_lshl_b32 s7, s3, 9
    s_cmp_eq_u32 s3, 0
    s_cselect_b32 s54, 0xffffff00, -1
    s_mov_b32 s55, 0
    s_memrealtime s[86:87]
    v_mov_b32 v7, 0
    s_waitcnt lgkmcnt(0)
    s_or_b32 s86, s86, 1
    v_mov_b32 v6, s86
    s_or_b32 s86, s2, s3
    s_cmp_eq_u32 s86, 0
    s_cselect_b64 exec, 1, 0
    buffer_store_dword v6, v7, s[44:47], 0 offen sc1
    s_mov_b64 exec, -1
    s_add_u32 m0, s51, 12288
    s_mov_b32 s73, 0
    buffer_load_dwordx4 v123, s[12:15], s73 offen lds
    s_add_u32 m0, s51, 14336
    s_mov_b32 s73, 896
    buffer_load_dwordx4 v123, s[12:15], s73 offen lds
    s_add_u32 m0, s51, 16384
    s_mov_b32 s73, 1792
    buffer_load_dwordx4 v123, s[12:15], s73 offen lds
    s_add_u32 m0, s52, 36864
    s_mov_b32 s73, 0
    buffer_load_dwordx4 v120, s[8:11], s73 offen lds
    s_add_u32 m0, s52, 37888
    s_mov_b32 s73, 0
    buffer_load_dwordx4 v121, s[8:11], s73 offen lds
    s_add_u32 m0, s52, 38912
    s_mov_b32 s73, 14336
    buffer_load_dwordx4 v120, s[8:11], s73 offen lds
    s_add_u32 m0, s52, 39936
    s_mov_b32 s73, 14336
    buffer_load_dwordx4 v121, s[8:11], s73 offen lds
    s_add_u32 m0, s7, 98304
    s_mov_b32 s73, 0
    s_mov_b64 exec, s[54:55]
    buffer_load_dwordx4 v122, s[8:11], s73 offen lds
    s_mov_b64 exec, -1
    s_add_u32 m0, s51, 24576
    s_mov_b32 s73, 172032
    buffer_load_dwordx4 v123, s[12:15], s73 offen lds
    s_add_u32 m0, s51, 26624
    s_mov_b32 s73, 172928
    buffer_load_dwordx4 v123, s[12:15], s73 offen lds
    s_add_u32 m0, s51, 28672
    s_mov_b32 s73, 173824
    buffer_load_dwordx4 v123, s[12:15], s73 offen lds
    s_add_u32 m0, s52, 18432
    s_mov_b32 s73, 128
    buffer_load_dwordx4 v120, s[8:11], s73 offen lds
    s_add_u32 m0, s52, 19456
    s_mov_b32 s73, 128
    buffer_load_dwordx4 v121, s[8:11], s73 offen lds
    s_add_u32 m0, s52, 20480
    s_mov_b32 s73, 14464
    buffer_load_dwordx4 v120, s[8:11], s73 offen lds
    s_add_u32 m0, s52, 21504
    s_mov_b32 s73, 14464
    buffer_load_dwordx4 v121, s[8:11], s73 offen lds
    s_add_u32 m0, s7, 79872
    s_mov_b32 s73, 128
    s_mov_b64 exec, s[54:55]
    buffer_load_dwordx4 v122, s[8:11], s73 offen lds
    s_mov_b64 exec, -1
    s_lshr_b32 s53, s2, 3
    s_lshl_b32 s53, s53, 2
    s_add_u32 s53, s53, s3
    s_mul_i32 s86, s53, 30
    v_add_u32 v237, s86, v1
    v_mul_u32_u24 v238, 43691, v237
    v_lshrrev_b32 v238, 19, v238
    v_mul_u32_u24 v239, 12, v238
    v_sub_u32 v239, v237, v239
    v_lshrrev_b32 v239, 2, v239
    v_mul_u32_u24 v239, 896, v239
    v_mul_u32_u24 v238, 2688, v238
    v_and_b32 v237, 3, v237
    v_lshlrev_b32 v237, 7, v237
    v_add3_u32 v237, v237, v238, v239
    s_and_b32 s86, s2, 1
    s_mul_i32 s86, s86, 384
    s_add_u32 s86, s86, 344064
    s_mov_b64 exec, 0x3fffffff
    buffer_load_dword v232, v237, s[12:15], s86 offen
    s_mov_b64 exec, -1
    v_lshlrev_b32 v237, 7, v1
    s_mul_i32 s86, s53, 3712
    s_bfe_u32 s87, s2, 0x20001
    s_mul_i32 s87, s87, 458752
    s_add_u32 s86, s86, s87
    s_max_u32 s86, s86, 14336
    s_sub_u32 s86, s86, 14336
    s_mov_b64 exec, 0x1fffffff
    buffer_load_dword v233, v237, s[8:11], s86 offen
    s_mov_b64 exec, -1
    s_mul_i32 s86, s53, 14
    v_add_u32 v237, s86, v1
    v_lshrrev_b32 v238, 2, v237
    v_mul_u32_u24 v238, 896, v238
    v_and_b32 v237, 3, v237
    v_lshl_add_u32 v237, v237, 7, v238
    s_and_b32 s86, s2, 1
    s_lshl_b32 s86, s86, 9
    s_mov_b64 exec, 0x3fff
    buffer_load_dword v234, v237, s[16:19], s86 offen
    s_mov_b64 exec, -1
    v_mul_u32_u24 v237, 18432, v3
    v_lshl_add_u32 v237, v2, 3, v237
    v_mov_b32 v238, s5
    v_add_u32 v237, 61440, v237
    ds_write2_b32 v237, v238, v238 offset0:0 offset1:1
    s_lshr_b32 s68, s2, 3
    s_mul_i32 s69, s68, 86
    s_lshr_b32 s69, s69, 8
    s_lshr_b32 s71, s68, 2
    s_and_b32 s72, s2, 1
    s_cmp_eq_u32 s72, 1
    s_cselect_b32 s69, s69, s71
    s_sub_u32 s71, 4, s72
    s_mul_i32 s71, s71, s69
    s_sub_u32 s64, s68, s71
    s_lshl_b32 s72, s72, 2
    s_add_u32 s64, s64, s72
    s_mov_b32 s66, s64
    s_bfe_u32 s68, s2, 0x20001
    s_lshl_b32 s67, s68, 3
    s_add_u32 s67, s67, s69
    s_sub_u32 s65, s67, s68
    s_cmp_ge_u32 s69, 8
    s_cselect_b32 s67, 99, s67
    s_cmp_ge_u32 s69, 7
    s_cselect_b32 s65, 99, s65
    v_lshrrev_b32 v219, 3, v1
    v_mul_u32_u24 v208, 896, v219
    v_and_b32 v219, 1, v3
    v_lshlrev_b32 v219, 2, v219
    v_and_b32 v220, 7, v1
    v_xor_b32 v219, v219, v220
    v_lshl_add_u32 v208, v219, 4, v208
    s_lshl_b32 s58, s66, 7
    s_mul_i32 s60, s3, 100352
    s_add_u32 s58, s58, s60
    v_add_u32 v208, s58, v208
    s_mul_i32 s59, s3, 14336
    s_add_u32 s59, s59, 106496
    v_lshrrev_b32 v219, 5, v1
    v_lshlrev_b32 v209, 9, v219
    v_bfe_u32 v219, v1, 2, 2
    v_lshl_add_u32 v209, v219, 7, v209
    v_lshrrev_b32 v219, 1, v219
    s_and_b32 s58, s3, 1
    v_xor_b32 v219, s58, v219
    v_lshl_add_u32 v209, v219, 6, v209
    v_and_b32 v219, 1, v3
    v_lshl_add_u32 v209, v219, 5, v209
    v_and_b32 v219, 3, v1
    v_lshl_add_u32 v209, v219, 3, v209
    v_add_u32 v209, 106496, v209
    s_mul_i32 s70, s3, 20480
    s_add_u32 s70, s70, 77824
    v_lshrrev_b32 v219, 3, v1
    v_mul_u32_u24 v213, 3584, v219
    v_and_b32 v219, 1, v3
    v_lshlrev_b32 v219, 2, v219
    v_and_b32 v220, 7, v1
    v_xor_b32 v219, v219, v220
    v_lshl_add_u32 v213, v219, 4, v213
    s_mul_i32 s68, s3, 1835008
    s_lshl_b32 s69, s65, 7
    s_add_u32 s68, s68, s69
    s_cmp_ge_u32 s65, 99
    s_cselect_b32 s68, 0x40000000, s68
    v_add_u32 v213, s68, v213
    s_cselect_b32 s68, 0x40000000, 0
    v_add_u32 v5, s68, v4
    v_lshrrev_b32 v219, 5, v1
    v_lshlrev_b32 v215, 9, v219
    v_bfe_u32 v219, v1, 2, 2
    v_lshl_add_u32 v215, v219, 7, v215
    v_lshrrev_b32 v219, 1, v219
    s_lshr_b32 s68, s3, 1
    v_xor_b32 v219, s68, v219
    v_lshl_add_u32 v215, v219, 6, v215
    v_and_b32 v219, 1, v3
    v_lshl_add_u32 v215, v219, 5, v215
    v_and_b32 v219, 3, v1
    v_lshl_add_u32 v215, v219, 3, v215
    v_add_u32 v215, s70, v215
    v_xor_b32 v216, 64, v215
    s_mul_i32 s70, s3, 20480
    s_add_u32 s70, s70, 77824
    v_lshrrev_b32 v219, 3, v1
    v_mul_u32_u24 v214, 4096, v219
    v_and_b32 v219, 1, v3
    v_lshlrev_b32 v219, 2, v219
    v_and_b32 v220, 7, v1
    v_xor_b32 v219, v219, v220
    v_lshl_add_u32 v214, v219, 4, v214
    s_mul_i32 s68, s3, 1835008
    s_lshl_b32 s69, s67, 7
    s_add_u32 s68, s68, s69
    s_cmp_ge_u32 s67, 99
    s_cselect_b32 s68, 0x40000000, s68
    v_add_u32 v214, s68, v214
    v_lshrrev_b32 v219, 5, v1
    v_lshlrev_b32 v217, 9, v219
    v_bfe_u32 v219, v1, 2, 2
    v_lshl_add_u32 v217, v219, 7, v217
    v_lshrrev_b32 v219, 1, v219
    s_lshr_b32 s68, s3, 1
    v_xor_b32 v219, s68, v219
    v_lshl_add_u32 v217, v219, 6, v217
    v_and_b32 v219, 1, v3
    v_lshl_add_u32 v217, v219, 5, v217
    v_and_b32 v219, 3, v1
    v_lshl_add_u32 v217, v219, 3, v217
    v_add_u32 v217, s70, v217
    v_xor_b32 v218, 64, v217
    s_lshl_b32 s80, s48, 2
    s_add_u32 s80, s80, s3
    s_lshl_b32 s80, s80, 4
    s_add_u32 s80, s80, s49
    s_lshl_b32 s80, s80, 2
    s_add_u32 s80, s80, 0x588000
    s_lshl_b32 s83, s67, 1
    s_lshr_b32 s79, s3, 1
    s_add_u32 s83, s83, s79
    s_lshl_b32 s83, s83, 6
    s_add_u32 s83, s83, 0x588000
    v_lshlrev_b32 v10, 2, v2
    s_lshl_b32 s84, s64, 9
    s_add_u32 s84, s84, 0x589000
    s_lshl_b32 s81, s67, 2
    s_add_u32 s81, s81, s3
    s_lshl_b32 s81, s81, 2
    s_add_u32 s81, s81, s84
    s_lshl_b32 s79, s3, 7
    s_add_u32 s84, s84, s79
    v_and_b32 v11, 31, v1
    v_lshlrev_b32 v11, 2, v11
    s_lshl_b32 s85, s64, 9
    s_add_u32 s85, s85, 0x58a000
    s_lshl_b32 s82, s65, 2
    s_add_u32 s82, s82, s3
    s_lshl_b32 s82, s82, 2
    s_add_u32 s82, s82, s85
    s_mul_i32 s79, s3, 112
    s_add_u32 s85, s85, s79
    v_min_u32 v12, 27, v1
    v_lshlrev_b32 v12, 2, v12
    v_mov_b32 v9, 0
    v_lshlrev_b32 v124, 9, v3
    v_bfe_u32 v237, v1, 2, 2
    v_lshl_add_u32 v124, v237, 6, v124
    v_and_b32 v237, 3, v1
    v_lshl_add_u32 v124, v237, 3, v124
    v_and_b32 v237, 1, v3
    v_lshlrev_b32 v237, 5, v237
    v_add_u32 v124, v124, v237
    v_add_u32 v124, 12288, v124
    v_xor_b32 v125, 32, v124
    s_and_b32 s53, s3, 1
    s_lshl_b32 s53, s53, 5
    v_xor_b32 v127, s53, v124
    s_lshr_b32 s53, s3, 1
    s_lshl_b32 s53, s53, 11
    s_add_u32 s53, s53, 2048
    v_add_u32 v126, s53, v127
    v_lshrrev_b32 v237, 1, v2
    v_xor_b32 v237, v237, v3
    v_lshlrev_b32 v237, 4, v237
    v_lshl_add_u32 v237, v2, 7, v237
    v_add_u32 v130, 61440, v237
    v_xor_b32 v131, 64, v130
    v_add_u32 v128, s52, v237
    v_xor_b32 v129, 64, v128
    v_lshlrev_b32 v237, 2, v3
    v_sub_u32 v237, v2, v237
    v_mov_b32 v239, 0xf149f2ca
    v_add_u32 v238, 16, v237
    v_and_b32 v238, 0xfffffff1, v238
    v_cmp_eq_u32 vcc, 0, v238
    s_nop 1
    v_cndmask_b32 v240, v239, 0, vcc
    v_add_u32 v238, 15, v237
    v_and_b32 v238, 0xfffffff1, v238
    v_cmp_eq_u32 vcc, 0, v238
    s_nop 1
    v_cndmask_b32 v241, v239, 0, vcc
    v_add_u32 v238, 14, v237
    v_and_b32 v238, 0xfffffff1, v238
    v_cmp_eq_u32 vcc, 0, v238
    s_nop 1
    v_cndmask_b32 v242, v239, 0, vcc
    v_add_u32 v238, 13, v237
    v_and_b32 v238, 0xfffffff1, v238
    v_cmp_eq_u32 vcc, 0, v238
    s_nop 1
    v_cndmask_b32 v243, v239, 0, vcc
    v_add_u32 v238, 0, v237
    v_and_b32 v238, 0xfffffff1, v238
    v_cmp_eq_u32 vcc, 0, v238
    s_nop 1
    v_cndmask_b32 v244, v239, 0, vcc
    v_add_u32 v238, -1, v237
    v_and_b32 v238, 0xfffffff1, v238
    v_cmp_eq_u32 vcc, 0, v238
    s_nop 1
    v_cndmask_b32 v245, v239, 0, vcc
    v_add_u32 v238, -2, v237
    v_and_b32 v238, 0xfffffff1, v238
    v_cmp_eq_u32 vcc, 0, v238
    s_nop 1
    v_cndmask_b32 v246, v239, 0, vcc
    v_add_u32 v238, -3, v237
    v_and_b32 v238, 0xfffffff1, v238
    v_cmp_eq_u32 vcc, 0, v238
    s_nop 1
    v_cndmask_b32 v247, v239, 0, vcc
    s_or_b32 s53, s48, s3
    s_cmp_eq_u32 s53, 0
    s_cselect_b64 vcc, -1, 0
    v_cndmask_b32 v248, v240, v239, vcc
    v_cndmask_b32 v249, v241, v239, vcc
    v_cndmask_b32 v250, v242, v239, vcc
    v_cndmask_b32 v251, v243, v239, vcc
    v_mov_b32 v40, s5
    v_mov_b32 v41, s5
    v_mov_b32 v42, s5
    v_mov_b32 v43, s5
    s_waitcnt vmcnt(11)
    s_waitcnt lgkmcnt(0)
    s_barrier
    ds_read_b128 v[16:19], v128 offset:36864
    ds_read_b128 v[20:23], v128 offset:38912
    ds_read_b128 v[24:27], v130 offset:36864
    ds_read_b64_tr_b16 v[88:89], v124 offset:0
    ds_read_b64_tr_b16 v[90:91], v124 offset:256
    ds_read_b64_tr_b16 v[92:93], v125 offset:0
    ds_read_b64_tr_b16 v[94:95], v125 offset:256
    ds_read_b64_tr_b16 v[96:97], v124 offset:2048
    ds_read_b64_tr_b16 v[98:99], v124 offset:2304
    ds_read_b64_tr_b16 v[100:101], v125 offset:2048
    ds_read_b64_tr_b16 v[102:103], v125 offset:2304
    ds_read_b64_tr_b16 v[104:105], v124 offset:4096
    ds_read_b64_tr_b16 v[106:107], v124 offset:4352
    ds_read_b64_tr_b16 v[108:109], v125 offset:4096
    ds_read_b64_tr_b16 v[110:111], v125 offset:4352
    ds_read_b64_tr_b16 v[112:113], v126 offset:0
    ds_read_b64_tr_b16 v[114:115], v126 offset:256
    ds_read_b64_tr_b16 v[116:117], v127 offset:0
    ds_read_b64_tr_b16 v[118:119], v127 offset:256
    s_waitcnt lgkmcnt(8)
    v_mfma_f32_16x16x32_bf16 v[136:139], v[88:91], v[16:19], 0
    ds_read_b128 v[28:31], v129 offset:36864
    v_mfma_f32_16x16x32_bf16 v[160:163], v[88:91], v[20:23], 0
    ds_read_b128 v[32:35], v129 offset:38912
    v_mfma_f32_16x16x32_bf16 v[140:143], v[92:95], v[16:19], 0
    ds_read_b128 v[36:39], v131 offset:36864
    v_mfma_f32_16x16x32_bf16 v[164:167], v[92:95], v[20:23], 0
    ds_read_b64_tr_b16 v[88:89], v124 offset:6144
    v_mfma_f32_16x16x32_bf16 v[144:147], v[96:99], v[16:19], 0
    ds_read_b64_tr_b16 v[90:91], v124 offset:6400
    s_add_u32 m0, s51, 36864
    s_mov_b32 s73, 344064
    buffer_load_dwordx4 v123, s[12:15], s73 offen lds
    v_mfma_f32_16x16x32_bf16 v[168:171], v[96:99], v[20:23], 0
    ds_read_b64_tr_b16 v[92:93], v125 offset:6144
    v_mfma_f32_16x16x32_bf16 v[148:151], v[100:103], v[16:19], 0
    ds_read_b64_tr_b16 v[94:95], v125 offset:6400
    v_mfma_f32_16x16x32_bf16 v[172:175], v[100:103], v[20:23], 0
    ds_read_b64_tr_b16 v[96:97], v124 offset:8192
    s_waitcnt lgkmcnt(8)
    v_mfma_f32_16x16x32_bf16 v[152:155], v[16:19], v[104:107], 0
    ds_read_b64_tr_b16 v[98:99], v124 offset:8448
    v_mfma_f32_16x16x32_bf16 v[176:179], v[20:23], v[104:107], 0
    ds_read_b64_tr_b16 v[100:101], v125 offset:8192
    s_add_u32 m0, s51, 38912
    s_mov_b32 s73, 344960
    buffer_load_dwordx4 v123, s[12:15], s73 offen lds
    v_mfma_f32_16x16x32_bf16 v[156:159], v[16:19], v[108:111], 0
    ds_read_b64_tr_b16 v[102:103], v125 offset:8448
    v_mfma_f32_16x16x32_bf16 v[180:183], v[20:23], v[108:111], 0
    ds_read_b64_tr_b16 v[104:105], v124 offset:10240
    v_mfma_f32_16x16x32_bf16 v[184:187], v[112:115], v[24:27], 0
    ds_read_b64_tr_b16 v[106:107], v124 offset:10496
    v_mfma_f32_16x16x32_bf16 v[188:191], v[116:119], v[24:27], 0
    ds_read_b64_tr_b16 v[108:109], v125 offset:10240
    v_mfma_f32_16x16x32_bf16 v[48:51], v[16:19], v[16:19], 0
    ds_read_b64_tr_b16 v[110:111], v125 offset:10496
    s_add_u32 m0, s51, 40960
    s_mov_b32 s73, 345856
    buffer_load_dwordx4 v123, s[12:15], s73 offen lds
    v_mfma_f32_16x16x32_bf16 v[52:55], v[20:23], v[20:23], 0
    ds_read_b64_tr_b16 v[112:113], v126 offset:6144
    v_mfma_f32_16x16x32_bf16 v[56:59], v[24:27], v[24:27], 0
    ds_read_b64_tr_b16 v[114:115], v126 offset:6400
    v_mfma_f32_16x16x32_bf16 v[60:63], v[40:43], v[16:19], 0
    ds_read_b64_tr_b16 v[116:117], v127 offset:6144
    v_mfma_f32_16x16x32_bf16 v[64:67], v[40:43], v[20:23], 0
    ds_read_b64_tr_b16 v[118:119], v127 offset:6400
    v_mfma_f32_16x16x32_bf16 v[68:71], v[40:43], v[24:27], 0
    s_add_u32 m0, s52, 0
    s_mov_b32 s73, 256
    buffer_load_dwordx4 v120, s[8:11], s73 offen lds
    s_add_u32 m0, s52, 1024
    s_mov_b32 s73, 256
    buffer_load_dwordx4 v121, s[8:11], s73 offen lds
    s_add_u32 m0, s52, 2048
    s_mov_b32 s73, 14592
    buffer_load_dwordx4 v120, s[8:11], s73 offen lds
    s_add_u32 m0, s52, 3072
    s_mov_b32 s73, 14592
    buffer_load_dwordx4 v121, s[8:11], s73 offen lds
    s_add_u32 m0, s7, 61440
    s_mov_b32 s73, 256
    s_mov_b64 exec, s[54:55]
    buffer_load_dwordx4 v122, s[8:11], s73 offen lds
    s_mov_b64 exec, -1
    s_waitcnt vmcnt(11)
    s_barrier
    s_waitcnt lgkmcnt(8)
    v_mfma_f32_16x16x32_bf16 v[136:139], v[88:91], v[28:31], v[136:139]
    ds_read_b128 v[16:19], v128 offset:18432
    v_mfma_f32_16x16x32_bf16 v[160:163], v[88:91], v[32:35], v[160:163]
    ds_read_b128 v[20:23], v128 offset:20480
    v_mfma_f32_16x16x32_bf16 v[140:143], v[92:95], v[28:31], v[140:143]
    ds_read_b128 v[24:27], v130 offset:18432
    v_mfma_f32_16x16x32_bf16 v[164:167], v[92:95], v[32:35], v[164:167]
    ds_read_b64_tr_b16 v[88:89], v124 offset:12288
    v_mfma_f32_16x16x32_bf16 v[144:147], v[96:99], v[28:31], v[144:147]
    ds_read_b64_tr_b16 v[90:91], v124 offset:12544
    s_add_u32 m0, s51, 49152
    s_mov_b32 s73, 516096
    buffer_load_dwordx4 v123, s[12:15], s73 offen lds
    v_mfma_f32_16x16x32_bf16 v[168:171], v[96:99], v[32:35], v[168:171]
    ds_read_b64_tr_b16 v[92:93], v125 offset:12288
    v_mfma_f32_16x16x32_bf16 v[148:151], v[100:103], v[28:31], v[148:151]
    ds_read_b64_tr_b16 v[94:95], v125 offset:12544
    v_mfma_f32_16x16x32_bf16 v[172:175], v[100:103], v[32:35], v[172:175]
    ds_read_b64_tr_b16 v[96:97], v124 offset:14336
    s_waitcnt lgkmcnt(8)
    v_mfma_f32_16x16x32_bf16 v[152:155], v[28:31], v[104:107], v[152:155]
    ds_read_b64_tr_b16 v[98:99], v124 offset:14592
    v_mfma_f32_16x16x32_bf16 v[176:179], v[32:35], v[104:107], v[176:179]
    ds_read_b64_tr_b16 v[100:101], v125 offset:14336
    s_add_u32 m0, s51, 51200
    s_mov_b32 s73, 516992
    buffer_load_dwordx4 v123, s[12:15], s73 offen lds
    v_mfma_f32_16x16x32_bf16 v[156:159], v[28:31], v[108:111], v[156:159]
    ds_read_b64_tr_b16 v[102:103], v125 offset:14592
    v_mfma_f32_16x16x32_bf16 v[180:183], v[32:35], v[108:111], v[180:183]
    ds_read_b64_tr_b16 v[104:105], v124 offset:16384
    v_mfma_f32_16x16x32_bf16 v[184:187], v[112:115], v[36:39], v[184:187]
    ds_read_b64_tr_b16 v[106:107], v124 offset:16640
    v_mfma_f32_16x16x32_bf16 v[188:191], v[116:119], v[36:39], v[188:191]
    ds_read_b64_tr_b16 v[108:109], v125 offset:16384
    v_mfma_f32_16x16x32_bf16 v[48:51], v[28:31], v[28:31], v[48:51]
    ds_read_b64_tr_b16 v[110:111], v125 offset:16640
    s_add_u32 m0, s51, 53248
    s_mov_b32 s73, 517888
    buffer_load_dwordx4 v123, s[12:15], s73 offen lds
    v_mfma_f32_16x16x32_bf16 v[52:55], v[32:35], v[32:35], v[52:55]
    ds_read_b64_tr_b16 v[112:113], v126 offset:12288
    v_mfma_f32_16x16x32_bf16 v[56:59], v[36:39], v[36:39], v[56:59]
    ds_read_b64_tr_b16 v[114:115], v126 offset:12544
    v_mfma_f32_16x16x32_bf16 v[60:63], v[40:43], v[28:31], v[60:63]
    ds_read_b64_tr_b16 v[116:117], v127 offset:12288
    v_mfma_f32_16x16x32_bf16 v[64:67], v[40:43], v[32:35], v[64:67]
    ds_read_b64_tr_b16 v[118:119], v127 offset:12544
    v_mfma_f32_16x16x32_bf16 v[68:71], v[40:43], v[36:39], v[68:71]
    s_add_u32 m0, s52, 55296
    s_mov_b32 s73, 384
    buffer_load_dwordx4 v120, s[8:11], s73 offen lds
    s_waitcnt lgkmcnt(8)
    v_mfma_f32_16x16x32_bf16 v[136:139], v[88:91], v[16:19], v[136:139]
    ds_read_b128 v[28:31], v129 offset:18432
    v_mfma_f32_16x16x32_bf16 v[160:163], v[88:91], v[20:23], v[160:163]
    ds_read_b128 v[32:35], v129 offset:20480
    v_mfma_f32_16x16x32_bf16 v[140:143], v[92:95], v[16:19], v[140:143]
    ds_read_b128 v[36:39], v131 offset:18432
    v_mfma_f32_16x16x32_bf16 v[164:167], v[92:95], v[20:23], v[164:167]
    ds_read_b64_tr_b16 v[88:89], v124 offset:18432
    v_mfma_f32_16x16x32_bf16 v[144:147], v[96:99], v[16:19], v[144:147]
    ds_read_b64_tr_b16 v[90:91], v124 offset:18688
    s_add_u32 m0, s52, 56320
    s_mov_b32 s73, 384
    buffer_load_dwordx4 v121, s[8:11], s73 offen lds
    v_mfma_f32_16x16x32_bf16 v[168:171], v[96:99], v[20:23], v[168:171]
    ds_read_b64_tr_b16 v[92:93], v125 offset:18432
    v_mfma_f32_16x16x32_bf16 v[148:151], v[100:103], v[16:19], v[148:151]
    ds_read_b64_tr_b16 v[94:95], v125 offset:18688
    v_mfma_f32_16x16x32_bf16 v[172:175], v[100:103], v[20:23], v[172:175]
    ds_read_b64_tr_b16 v[96:97], v124 offset:20480
    s_waitcnt lgkmcnt(8)
    v_mfma_f32_16x16x32_bf16 v[152:155], v[16:19], v[104:107], v[152:155]
    ds_read_b64_tr_b16 v[98:99], v124 offset:20736
    v_mfma_f32_16x16x32_bf16 v[176:179], v[20:23], v[104:107], v[176:179]
    ds_read_b64_tr_b16 v[100:101], v125 offset:20480
    s_add_u32 m0, s52, 57344
    s_mov_b32 s73, 14720
    buffer_load_dwordx4 v120, s[8:11], s73 offen lds
    v_mfma_f32_16x16x32_bf16 v[156:159], v[16:19], v[108:111], v[156:159]
    ds_read_b64_tr_b16 v[102:103], v125 offset:20736
    v_mfma_f32_16x16x32_bf16 v[180:183], v[20:23], v[108:111], v[180:183]
    ds_read_b64_tr_b16 v[104:105], v124 offset:22528
    v_mfma_f32_16x16x32_bf16 v[184:187], v[112:115], v[24:27], v[184:187]
    ds_read_b64_tr_b16 v[106:107], v124 offset:22784
    v_mfma_f32_16x16x32_bf16 v[188:191], v[116:119], v[24:27], v[188:191]
    ds_read_b64_tr_b16 v[108:109], v125 offset:22528
    v_mfma_f32_16x16x32_bf16 v[48:51], v[16:19], v[16:19], v[48:51]
    ds_read_b64_tr_b16 v[110:111], v125 offset:22784
    s_add_u32 m0, s52, 58368
    s_mov_b32 s73, 14720
    buffer_load_dwordx4 v121, s[8:11], s73 offen lds
    v_mfma_f32_16x16x32_bf16 v[52:55], v[20:23], v[20:23], v[52:55]
    ds_read_b64_tr_b16 v[112:113], v126 offset:18432
    v_mfma_f32_16x16x32_bf16 v[56:59], v[24:27], v[24:27], v[56:59]
    ds_read_b64_tr_b16 v[114:115], v126 offset:18688
    v_mfma_f32_16x16x32_bf16 v[60:63], v[40:43], v[16:19], v[60:63]
    ds_read_b64_tr_b16 v[116:117], v127 offset:18432
    v_mfma_f32_16x16x32_bf16 v[64:67], v[40:43], v[20:23], v[64:67]
    ds_read_b64_tr_b16 v[118:119], v127 offset:18688
    v_mfma_f32_16x16x32_bf16 v[68:71], v[40:43], v[24:27], v[68:71]
    s_add_u32 m0, s7, 116736
    s_mov_b32 s73, 384
    s_mov_b64 exec, s[54:55]
    buffer_load_dwordx4 v122, s[8:11], s73 offen lds
    s_mov_b64 exec, -1
    s_waitcnt vmcnt(8)
    s_barrier
    s_waitcnt lgkmcnt(8)
    v_mfma_f32_16x16x32_bf16 v[136:139], v[88:91], v[28:31], v[136:139]
    ds_read_b128 v[16:19], v128 offset:0
    v_mfma_f32_16x16x32_bf16 v[160:163], v[88:91], v[32:35], v[160:163]
    ds_read_b128 v[20:23], v128 offset:2048
    v_mfma_f32_16x16x32_bf16 v[140:143], v[92:95], v[28:31], v[140:143]
    ds_read_b128 v[24:27], v130 offset:0
    v_mfma_f32_16x16x32_bf16 v[164:167], v[92:95], v[32:35], v[164:167]
    ds_read_b64_tr_b16 v[88:89], v124 offset:24576
    v_mfma_f32_16x16x32_bf16 v[144:147], v[96:99], v[28:31], v[144:147]
    ds_read_b64_tr_b16 v[90:91], v124 offset:24832
    s_add_u32 m0, s51, 12288
    s_mov_b32 s73, 688128
    buffer_load_dwordx4 v123, s[12:15], s73 offen lds
    v_mfma_f32_16x16x32_bf16 v[168:171], v[96:99], v[32:35], v[168:171]
    ds_read_b64_tr_b16 v[92:93], v125 offset:24576
    v_mfma_f32_16x16x32_bf16 v[148:151], v[100:103], v[28:31], v[148:151]
    ds_read_b64_tr_b16 v[94:95], v125 offset:24832
    v_mfma_f32_16x16x32_bf16 v[172:175], v[100:103], v[32:35], v[172:175]
    ds_read_b64_tr_b16 v[96:97], v124 offset:26624
    s_waitcnt lgkmcnt(8)
    v_mfma_f32_16x16x32_bf16 v[152:155], v[28:31], v[104:107], v[152:155]
    ds_read_b64_tr_b16 v[98:99], v124 offset:26880
    v_mfma_f32_16x16x32_bf16 v[176:179], v[32:35], v[104:107], v[176:179]
    ds_read_b64_tr_b16 v[100:101], v125 offset:26624
    s_add_u32 m0, s51, 14336
    s_mov_b32 s73, 689024
    buffer_load_dwordx4 v123, s[12:15], s73 offen lds
    v_mfma_f32_16x16x32_bf16 v[156:159], v[28:31], v[108:111], v[156:159]
    ds_read_b64_tr_b16 v[102:103], v125 offset:26880
    v_mfma_f32_16x16x32_bf16 v[180:183], v[32:35], v[108:111], v[180:183]
    ds_read_b64_tr_b16 v[104:105], v124 offset:28672
    v_mfma_f32_16x16x32_bf16 v[184:187], v[112:115], v[36:39], v[184:187]
    ds_read_b64_tr_b16 v[106:107], v124 offset:28928
    v_mfma_f32_16x16x32_bf16 v[188:191], v[116:119], v[36:39], v[188:191]
    ds_read_b64_tr_b16 v[108:109], v125 offset:28672
    v_mfma_f32_16x16x32_bf16 v[48:51], v[28:31], v[28:31], v[48:51]
    ds_read_b64_tr_b16 v[110:111], v125 offset:28928
    s_add_u32 m0, s51, 16384
    s_mov_b32 s73, 689920
    buffer_load_dwordx4 v123, s[12:15], s73 offen lds
    v_mfma_f32_16x16x32_bf16 v[52:55], v[32:35], v[32:35], v[52:55]
    ds_read_b64_tr_b16 v[112:113], v126 offset:24576
    v_mfma_f32_16x16x32_bf16 v[56:59], v[36:39], v[36:39], v[56:59]
    ds_read_b64_tr_b16 v[114:115], v126 offset:24832
    v_mfma_f32_16x16x32_bf16 v[60:63], v[40:43], v[28:31], v[60:63]
    ds_read_b64_tr_b16 v[116:117], v127 offset:24576
    v_mfma_f32_16x16x32_bf16 v[64:67], v[40:43], v[32:35], v[64:67]
    ds_read_b64_tr_b16 v[118:119], v127 offset:24832
    v_mfma_f32_16x16x32_bf16 v[68:71], v[40:43], v[36:39], v[68:71]
    s_add_u32 m0, s52, 36864
    s_mov_b32 s73, 512
    buffer_load_dwordx4 v120, s[8:11], s73 offen lds
    s_waitcnt lgkmcnt(8)
    v_mfma_f32_16x16x32_bf16 v[136:139], v[88:91], v[16:19], v[136:139]
    ds_read_b128 v[28:31], v129 offset:0
    v_mfma_f32_16x16x32_bf16 v[160:163], v[88:91], v[20:23], v[160:163]
    ds_read_b128 v[32:35], v129 offset:2048
    v_mfma_f32_16x16x32_bf16 v[140:143], v[92:95], v[16:19], v[140:143]
    ds_read_b128 v[36:39], v131 offset:0
    v_mfma_f32_16x16x32_bf16 v[164:167], v[92:95], v[20:23], v[164:167]
    ds_read_b64_tr_b16 v[88:89], v124 offset:30720
    v_mfma_f32_16x16x32_bf16 v[144:147], v[96:99], v[16:19], v[144:147]
    ds_read_b64_tr_b16 v[90:91], v124 offset:30976
    s_add_u32 m0, s52, 37888
    s_mov_b32 s73, 512
    buffer_load_dwordx4 v121, s[8:11], s73 offen lds
    v_mfma_f32_16x16x32_bf16 v[168:171], v[96:99], v[20:23], v[168:171]
    ds_read_b64_tr_b16 v[92:93], v125 offset:30720
    v_mfma_f32_16x16x32_bf16 v[148:151], v[100:103], v[16:19], v[148:151]
    ds_read_b64_tr_b16 v[94:95], v125 offset:30976
    v_mfma_f32_16x16x32_bf16 v[172:175], v[100:103], v[20:23], v[172:175]
    ds_read_b64_tr_b16 v[96:97], v124 offset:32768
    s_waitcnt lgkmcnt(8)
    v_mfma_f32_16x16x32_bf16 v[152:155], v[16:19], v[104:107], v[152:155]
    ds_read_b64_tr_b16 v[98:99], v124 offset:33024
    v_mfma_f32_16x16x32_bf16 v[176:179], v[20:23], v[104:107], v[176:179]
    ds_read_b64_tr_b16 v[100:101], v125 offset:32768
    s_add_u32 m0, s52, 38912
    s_mov_b32 s73, 14848
    buffer_load_dwordx4 v120, s[8:11], s73 offen lds
    v_mfma_f32_16x16x32_bf16 v[156:159], v[16:19], v[108:111], v[156:159]
    ds_read_b64_tr_b16 v[102:103], v125 offset:33024
    v_mfma_f32_16x16x32_bf16 v[180:183], v[20:23], v[108:111], v[180:183]
    ds_read_b64_tr_b16 v[104:105], v124 offset:34816
    v_mfma_f32_16x16x32_bf16 v[184:187], v[112:115], v[24:27], v[184:187]
    ds_read_b64_tr_b16 v[106:107], v124 offset:35072
    v_mfma_f32_16x16x32_bf16 v[188:191], v[116:119], v[24:27], v[188:191]
    ds_read_b64_tr_b16 v[108:109], v125 offset:34816
    v_mfma_f32_16x16x32_bf16 v[48:51], v[16:19], v[16:19], v[48:51]
    ds_read_b64_tr_b16 v[110:111], v125 offset:35072
    s_add_u32 m0, s52, 39936
    s_mov_b32 s73, 14848
    buffer_load_dwordx4 v121, s[8:11], s73 offen lds
    v_mfma_f32_16x16x32_bf16 v[52:55], v[20:23], v[20:23], v[52:55]
    ds_read_b64_tr_b16 v[112:113], v126 offset:30720
    v_mfma_f32_16x16x32_bf16 v[56:59], v[24:27], v[24:27], v[56:59]
    ds_read_b64_tr_b16 v[114:115], v126 offset:30976
    v_mfma_f32_16x16x32_bf16 v[60:63], v[40:43], v[16:19], v[60:63]
    ds_read_b64_tr_b16 v[116:117], v127 offset:30720
    v_mfma_f32_16x16x32_bf16 v[64:67], v[40:43], v[20:23], v[64:67]
    ds_read_b64_tr_b16 v[118:119], v127 offset:30976
    v_mfma_f32_16x16x32_bf16 v[68:71], v[40:43], v[24:27], v[68:71]
    s_add_u32 m0, s7, 98304
    s_mov_b32 s73, 512
    s_mov_b64 exec, s[54:55]
    buffer_load_dwordx4 v122, s[8:11], s73 offen lds
    s_mov_b64 exec, -1
    s_waitcnt vmcnt(8)
    s_barrier
    s_waitcnt lgkmcnt(8)
    v_mfma_f32_16x16x32_bf16 v[136:139], v[88:91], v[28:31], v[136:139]
    ds_read_b128 v[16:19], v128 offset:55296
    v_mfma_f32_16x16x32_bf16 v[160:163], v[88:91], v[32:35], v[160:163]
    ds_read_b128 v[20:23], v128 offset:57344
    v_mfma_f32_16x16x32_bf16 v[140:143], v[92:95], v[28:31], v[140:143]
    ds_read_b128 v[24:27], v130 offset:55296
    v_mfma_f32_16x16x32_bf16 v[164:167], v[92:95], v[32:35], v[164:167]
    ds_read_b64_tr_b16 v[88:89], v124 offset:36864
    v_mfma_f32_16x16x32_bf16 v[144:147], v[96:99], v[28:31], v[144:147]
    ds_read_b64_tr_b16 v[90:91], v124 offset:37120
    s_add_u32 m0, s51, 24576
    s_mov_b32 s73, 860160
    buffer_load_dwordx4 v123, s[12:15], s73 offen lds
    v_mfma_f32_16x16x32_bf16 v[168:171], v[96:99], v[32:35], v[168:171]
    ds_read_b64_tr_b16 v[92:93], v125 offset:36864
    v_mfma_f32_16x16x32_bf16 v[148:151], v[100:103], v[28:31], v[148:151]
    ds_read_b64_tr_b16 v[94:95], v125 offset:37120
    v_mfma_f32_16x16x32_bf16 v[172:175], v[100:103], v[32:35], v[172:175]
    ds_read_b64_tr_b16 v[96:97], v124 offset:38912
    s_waitcnt lgkmcnt(8)
    v_mfma_f32_16x16x32_bf16 v[152:155], v[28:31], v[104:107], v[152:155]
    ds_read_b64_tr_b16 v[98:99], v124 offset:39168
    v_mfma_f32_16x16x32_bf16 v[176:179], v[32:35], v[104:107], v[176:179]
    ds_read_b64_tr_b16 v[100:101], v125 offset:38912
    s_add_u32 m0, s51, 26624
    s_mov_b32 s73, 861056
    buffer_load_dwordx4 v123, s[12:15], s73 offen lds
    v_mfma_f32_16x16x32_bf16 v[156:159], v[28:31], v[108:111], v[156:159]
    ds_read_b64_tr_b16 v[102:103], v125 offset:39168
    v_mfma_f32_16x16x32_bf16 v[180:183], v[32:35], v[108:111], v[180:183]
    ds_read_b64_tr_b16 v[104:105], v124 offset:40960
    v_mfma_f32_16x16x32_bf16 v[184:187], v[112:115], v[36:39], v[184:187]
    ds_read_b64_tr_b16 v[106:107], v124 offset:41216
    v_mfma_f32_16x16x32_bf16 v[188:191], v[116:119], v[36:39], v[188:191]
    ds_read_b64_tr_b16 v[108:109], v125 offset:40960
    v_mfma_f32_16x16x32_bf16 v[48:51], v[28:31], v[28:31], v[48:51]
    ds_read_b64_tr_b16 v[110:111], v125 offset:41216
    s_add_u32 m0, s51, 28672
    s_mov_b32 s73, 861952
    buffer_load_dwordx4 v123, s[12:15], s73 offen lds
    v_mfma_f32_16x16x32_bf16 v[52:55], v[32:35], v[32:35], v[52:55]
    ds_read_b64_tr_b16 v[112:113], v126 offset:36864
    v_mfma_f32_16x16x32_bf16 v[56:59], v[36:39], v[36:39], v[56:59]
    ds_read_b64_tr_b16 v[114:115], v126 offset:37120
    v_mfma_f32_16x16x32_bf16 v[60:63], v[40:43], v[28:31], v[60:63]
    ds_read_b64_tr_b16 v[116:117], v127 offset:36864
    v_mfma_f32_16x16x32_bf16 v[64:67], v[40:43], v[32:35], v[64:67]
    ds_read_b64_tr_b16 v[118:119], v127 offset:37120
    v_mfma_f32_16x16x32_bf16 v[68:71], v[40:43], v[36:39], v[68:71]
    s_add_u32 m0, s52, 18432
    s_mov_b32 s73, 640
    buffer_load_dwordx4 v120, s[8:11], s73 offen lds
    s_waitcnt lgkmcnt(8)
    v_mfma_f32_16x16x32_bf16 v[136:139], v[88:91], v[16:19], v[136:139]
    ds_read_b128 v[28:31], v129 offset:55296
    v_mfma_f32_16x16x32_bf16 v[160:163], v[88:91], v[20:23], v[160:163]
    ds_read_b128 v[32:35], v129 offset:57344
    v_mfma_f32_16x16x32_bf16 v[140:143], v[92:95], v[16:19], v[140:143]
    ds_read_b128 v[36:39], v131 offset:55296
    v_mfma_f32_16x16x32_bf16 v[164:167], v[92:95], v[20:23], v[164:167]
    ds_read_b64_tr_b16 v[88:89], v124 offset:43008
    v_mfma_f32_16x16x32_bf16 v[144:147], v[96:99], v[16:19], v[144:147]
    ds_read_b64_tr_b16 v[90:91], v124 offset:43264
    s_add_u32 m0, s52, 19456
    s_mov_b32 s73, 640
    buffer_load_dwordx4 v121, s[8:11], s73 offen lds
    v_mfma_f32_16x16x32_bf16 v[168:171], v[96:99], v[20:23], v[168:171]
    ds_read_b64_tr_b16 v[92:93], v125 offset:43008
    v_mfma_f32_16x16x32_bf16 v[148:151], v[100:103], v[16:19], v[148:151]
    ds_read_b64_tr_b16 v[94:95], v125 offset:43264
    v_mfma_f32_16x16x32_bf16 v[172:175], v[100:103], v[20:23], v[172:175]
    ds_read_b64_tr_b16 v[96:97], v124 offset:45056
    s_waitcnt lgkmcnt(8)
    v_mfma_f32_16x16x32_bf16 v[152:155], v[16:19], v[104:107], v[152:155]
    ds_read_b64_tr_b16 v[98:99], v124 offset:45312
    v_mfma_f32_16x16x32_bf16 v[176:179], v[20:23], v[104:107], v[176:179]
    ds_read_b64_tr_b16 v[100:101], v125 offset:45056
    s_add_u32 m0, s52, 20480
    s_mov_b32 s73, 14976
    buffer_load_dwordx4 v120, s[8:11], s73 offen lds
    v_mfma_f32_16x16x32_bf16 v[156:159], v[16:19], v[108:111], v[156:159]
    ds_read_b64_tr_b16 v[102:103], v125 offset:45312
    v_mfma_f32_16x16x32_bf16 v[180:183], v[20:23], v[108:111], v[180:183]
    ds_read_b64_tr_b16 v[104:105], v124 offset:47104
    v_mfma_f32_16x16x32_bf16 v[184:187], v[112:115], v[24:27], v[184:187]
    ds_read_b64_tr_b16 v[106:107], v124 offset:47360
    v_mfma_f32_16x16x32_bf16 v[188:191], v[116:119], v[24:27], v[188:191]
    ds_read_b64_tr_b16 v[108:109], v125 offset:47104
    v_mfma_f32_16x16x32_bf16 v[48:51], v[16:19], v[16:19], v[48:51]
    ds_read_b64_tr_b16 v[110:111], v125 offset:47360
    s_add_u32 m0, s52, 21504
    s_mov_b32 s73, 14976
    buffer_load_dwordx4 v121, s[8:11], s73 offen lds
    v_mfma_f32_16x16x32_bf16 v[52:55], v[20:23], v[20:23], v[52:55]
    ds_read_b64_tr_b16 v[112:113], v126 offset:43008
    v_mfma_f32_16x16x32_bf16 v[56:59], v[24:27], v[24:27], v[56:59]
    ds_read_b64_tr_b16 v[114:115], v126 offset:43264
    v_mfma_f32_16x16x32_bf16 v[60:63], v[40:43], v[16:19], v[60:63]
    ds_read_b64_tr_b16 v[116:117], v127 offset:43008
    v_mfma_f32_16x16x32_bf16 v[64:67], v[40:43], v[20:23], v[64:67]
    ds_read_b64_tr_b16 v[118:119], v127 offset:43264
    v_mfma_f32_16x16x32_bf16 v[68:71], v[40:43], v[24:27], v[68:71]
    s_add_u32 m0, s7, 79872
    s_mov_b32 s73, 640
    s_mov_b64 exec, s[54:55]
    buffer_load_dwordx4 v122, s[8:11], s73 offen lds
    s_mov_b64 exec, -1
    s_waitcnt vmcnt(8)
    s_barrier
    s_waitcnt lgkmcnt(8)
    v_mfma_f32_16x16x32_bf16 v[136:139], v[88:91], v[28:31], v[136:139]
    ds_read_b128 v[16:19], v128 offset:36864
    v_mfma_f32_16x16x32_bf16 v[160:163], v[88:91], v[32:35], v[160:163]
    ds_read_b128 v[20:23], v128 offset:38912
    v_mfma_f32_16x16x32_bf16 v[140:143], v[92:95], v[28:31], v[140:143]
    ds_read_b128 v[24:27], v130 offset:36864
    v_mfma_f32_16x16x32_bf16 v[164:167], v[92:95], v[32:35], v[164:167]
    ds_read_b64_tr_b16 v[88:89], v124 offset:0
    v_mfma_f32_16x16x32_bf16 v[144:147], v[96:99], v[28:31], v[144:147]
    ds_read_b64_tr_b16 v[90:91], v124 offset:256
    s_add_u32 m0, s51, 36864
    s_mov_b32 s73, 1032192
    buffer_load_dwordx4 v123, s[12:15], s73 offen lds
    v_mfma_f32_16x16x32_bf16 v[168:171], v[96:99], v[32:35], v[168:171]
    ds_read_b64_tr_b16 v[92:93], v125 offset:0
    v_mfma_f32_16x16x32_bf16 v[148:151], v[100:103], v[28:31], v[148:151]
    ds_read_b64_tr_b16 v[94:95], v125 offset:256
    v_mfma_f32_16x16x32_bf16 v[172:175], v[100:103], v[32:35], v[172:175]
    ds_read_b64_tr_b16 v[96:97], v124 offset:2048
    s_waitcnt lgkmcnt(8)
    v_mfma_f32_16x16x32_bf16 v[152:155], v[28:31], v[104:107], v[152:155]
    ds_read_b64_tr_b16 v[98:99], v124 offset:2304
    v_mfma_f32_16x16x32_bf16 v[176:179], v[32:35], v[104:107], v[176:179]
    ds_read_b64_tr_b16 v[100:101], v125 offset:2048
    s_add_u32 m0, s51, 38912
    s_mov_b32 s73, 1033088
    buffer_load_dwordx4 v123, s[12:15], s73 offen lds
    v_mfma_f32_16x16x32_bf16 v[156:159], v[28:31], v[108:111], v[156:159]
    ds_read_b64_tr_b16 v[102:103], v125 offset:2304
    v_mfma_f32_16x16x32_bf16 v[180:183], v[32:35], v[108:111], v[180:183]
    ds_read_b64_tr_b16 v[104:105], v124 offset:4096
    v_mfma_f32_16x16x32_bf16 v[184:187], v[112:115], v[36:39], v[184:187]
    ds_read_b64_tr_b16 v[106:107], v124 offset:4352
    v_mfma_f32_16x16x32_bf16 v[188:191], v[116:119], v[36:39], v[188:191]
    ds_read_b64_tr_b16 v[108:109], v125 offset:4096
    v_mfma_f32_16x16x32_bf16 v[48:51], v[28:31], v[28:31], v[48:51]
    ds_read_b64_tr_b16 v[110:111], v125 offset:4352
    s_add_u32 m0, s51, 40960
    s_mov_b32 s73, 1033984
    buffer_load_dwordx4 v123, s[12:15], s73 offen lds
    v_mfma_f32_16x16x32_bf16 v[52:55], v[32:35], v[32:35], v[52:55]
    ds_read_b64_tr_b16 v[112:113], v126 offset:0
    v_mfma_f32_16x16x32_bf16 v[56:59], v[36:39], v[36:39], v[56:59]
    ds_read_b64_tr_b16 v[114:115], v126 offset:256
    v_mfma_f32_16x16x32_bf16 v[60:63], v[40:43], v[28:31], v[60:63]
    ds_read_b64_tr_b16 v[116:117], v127 offset:0
    v_mfma_f32_16x16x32_bf16 v[64:67], v[40:43], v[32:35], v[64:67]
    ds_read_b64_tr_b16 v[118:119], v127 offset:256
    v_mfma_f32_16x16x32_bf16 v[68:71], v[40:43], v[36:39], v[68:71]
    s_add_u32 m0, s52, 0
    s_mov_b32 s73, 768
    buffer_load_dwordx4 v120, s[8:11], s73 offen lds
    s_waitcnt lgkmcnt(8)
    v_mfma_f32_16x16x32_bf16 v[136:139], v[88:91], v[16:19], v[136:139]
    ds_read_b128 v[28:31], v129 offset:36864
    v_mfma_f32_16x16x32_bf16 v[160:163], v[88:91], v[20:23], v[160:163]
    ds_read_b128 v[32:35], v129 offset:38912
    v_mfma_f32_16x16x32_bf16 v[140:143], v[92:95], v[16:19], v[140:143]
    ds_read_b128 v[36:39], v131 offset:36864
    v_mfma_f32_16x16x32_bf16 v[164:167], v[92:95], v[20:23], v[164:167]
    ds_read_b64_tr_b16 v[88:89], v124 offset:6144
    v_mfma_f32_16x16x32_bf16 v[144:147], v[96:99], v[16:19], v[144:147]
    ds_read_b64_tr_b16 v[90:91], v124 offset:6400
    s_add_u32 m0, s52, 1024
    s_mov_b32 s73, 768
    buffer_load_dwordx4 v121, s[8:11], s73 offen lds
    v_mfma_f32_16x16x32_bf16 v[168:171], v[96:99], v[20:23], v[168:171]
    ds_read_b64_tr_b16 v[92:93], v125 offset:6144
    v_mfma_f32_16x16x32_bf16 v[148:151], v[100:103], v[16:19], v[148:151]
    ds_read_b64_tr_b16 v[94:95], v125 offset:6400
    v_mfma_f32_16x16x32_bf16 v[172:175], v[100:103], v[20:23], v[172:175]
    ds_read_b64_tr_b16 v[96:97], v124 offset:8192
    s_waitcnt lgkmcnt(8)
    v_mfma_f32_16x16x32_bf16 v[152:155], v[16:19], v[104:107], v[152:155]
    ds_read_b64_tr_b16 v[98:99], v124 offset:8448
    v_mfma_f32_16x16x32_bf16 v[176:179], v[20:23], v[104:107], v[176:179]
    ds_read_b64_tr_b16 v[100:101], v125 offset:8192
    s_add_u32 m0, s52, 2048
    s_mov_b32 s73, 15104
    buffer_load_dwordx4 v120, s[8:11], s73 offen lds
    v_mfma_f32_16x16x32_bf16 v[156:159], v[16:19], v[108:111], v[156:159]
    ds_read_b64_tr_b16 v[102:103], v125 offset:8448
    v_mfma_f32_16x16x32_bf16 v[180:183], v[20:23], v[108:111], v[180:183]
    ds_read_b64_tr_b16 v[104:105], v124 offset:10240
    v_mfma_f32_16x16x32_bf16 v[184:187], v[112:115], v[24:27], v[184:187]
    ds_read_b64_tr_b16 v[106:107], v124 offset:10496
    v_mfma_f32_16x16x32_bf16 v[188:191], v[116:119], v[24:27], v[188:191]
    ds_read_b64_tr_b16 v[108:109], v125 offset:10240
    v_mfma_f32_16x16x32_bf16 v[48:51], v[16:19], v[16:19], v[48:51]
    ds_read_b64_tr_b16 v[110:111], v125 offset:10496
    s_add_u32 m0, s52, 3072
    s_mov_b32 s73, 15104
    buffer_load_dwordx4 v121, s[8:11], s73 offen lds
    v_mfma_f32_16x16x32_bf16 v[52:55], v[20:23], v[20:23], v[52:55]
    ds_read_b64_tr_b16 v[112:113], v126 offset:6144
    v_mfma_f32_16x16x32_bf16 v[56:59], v[24:27], v[24:27], v[56:59]
    ds_read_b64_tr_b16 v[114:115], v126 offset:6400
    v_mfma_f32_16x16x32_bf16 v[60:63], v[40:43], v[16:19], v[60:63]
    ds_read_b64_tr_b16 v[116:117], v127 offset:6144
    v_mfma_f32_16x16x32_bf16 v[64:67], v[40:43], v[20:23], v[64:67]
    ds_read_b64_tr_b16 v[118:119], v127 offset:6400
    v_mfma_f32_16x16x32_bf16 v[68:71], v[40:43], v[24:27], v[68:71]
    s_add_u32 m0, s7, 61440
    s_mov_b32 s73, 768
    s_mov_b64 exec, s[54:55]
    buffer_load_dwordx4 v122, s[8:11], s73 offen lds
    s_mov_b64 exec, -1
    v_mov_b32 v7, 0
    buffer_load_dword v6, v7, s[44:47], 0 offen sc1
    v_lshrrev_b32 v221, 5, v1
    v_mul_u32_u24 v221, 3584, v221
    v_and_b32 v222, 31, v1
    v_lshl_add_u32 v221, v222, 1, v221
    s_lshl_b32 s58, s67, 1
    s_lshr_b32 s60, s3, 1
    s_add_u32 s58, s58, s60
    s_mul_i32 s58, s58, 28672
    s_lshl_b32 s60, s66, 7
    s_add_u32 s58, s58, s60
    s_and_b32 s60, s3, 1
    s_lshl_b32 s60, s60, 6
    s_add_u32 s58, s58, s60
    buffer_load_ushort v192, v221, s[8:11], s58 offen offset:0
    buffer_load_ushort v193, v221, s[8:11], s58 offen offset:896
    buffer_load_ushort v194, v221, s[8:11], s58 offen offset:1792
    buffer_load_ushort v195, v221, s[8:11], s58 offen offset:2688
    s_add_u32 s58, s58, 7168
    buffer_load_ushort v196, v221, s[8:11], s58 offen offset:0
    buffer_load_ushort v197, v221, s[8:11], s58 offen offset:896
    buffer_load_ushort v198, v221, s[8:11], s58 offen offset:1792
    buffer_load_ushort v199, v221, s[8:11], s58 offen offset:2688
    s_add_u32 s58, s58, 7168
    buffer_load_ushort v200, v221, s[8:11], s58 offen offset:0
    buffer_load_ushort v201, v221, s[8:11], s58 offen offset:896
    buffer_load_ushort v202, v221, s[8:11], s58 offen offset:1792
    buffer_load_ushort v203, v221, s[8:11], s58 offen offset:2688
    s_add_u32 s58, s58, 7168
    buffer_load_ushort v204, v221, s[8:11], s58 offen offset:0
    buffer_load_ushort v205, v221, s[8:11], s58 offen offset:896
    buffer_load_ushort v206, v221, s[8:11], s58 offen offset:1792
    buffer_load_ushort v207, v221, s[8:11], s58 offen offset:2688
    s_lshr_b32 s68, s2, 3
    s_lshl_b32 s68, s68, 2
    s_add_u32 s68, s68, s3
    v_lshrrev_b32 v219, 3, v1
    v_mul_u32_u24 v219, 3584, v219
    v_and_b32 v220, 7, v1
    v_lshl_add_u32 v219, v220, 7, v219
    s_and_b32 s86, s2, 1
    s_lshl_b32 s86, s86, 7
    s_add_u32 s86, s86, s68
    s_mul_i32 s86, s86, 28672
    s_bfe_u32 s87, s2, 0x20001
    s_mul_i32 s87, s87, 896
    s_add_u32 s86, s86, s87
    s_mov_b32 exec_lo, 0x7f7f7f7f
    s_mov_b32 exec_hi, 0x7f7f7f7f
    buffer_load_dword v235, v219, s[20:23], s86 offen
    s_mov_b64 exec, -1
    s_waitcnt vmcnt(26)
    s_barrier
    s_waitcnt lgkmcnt(8)
    v_mfma_f32_16x16x32_bf16 v[136:139], v[88:91], v[28:31], v[136:139]
    ds_read_b128 v[16:19], v128 offset:18432
    v_mfma_f32_16x16x32_bf16 v[160:163], v[88:91], v[32:35], v[160:163]
    ds_read_b128 v[20:23], v128 offset:20480
    v_mfma_f32_16x16x32_bf16 v[140:143], v[92:95], v[28:31], v[140:143]
    ds_read_b128 v[24:27], v130 offset:18432
    v_mfma_f32_16x16x32_bf16 v[164:167], v[92:95], v[32:35], v[164:167]
    ds_read_b64_tr_b16 v[88:89], v124 offset:12288
    v_mfma_f32_16x16x32_bf16 v[144:147], v[96:99], v[28:31], v[144:147]
    ds_read_b64_tr_b16 v[90:91], v124 offset:12544
    v_mfma_f32_16x16x32_bf16 v[168:171], v[96:99], v[32:35], v[168:171]
    ds_read_b64_tr_b16 v[92:93], v125 offset:12288
    v_mfma_f32_16x16x32_bf16 v[148:151], v[100:103], v[28:31], v[148:151]
    ds_read_b64_tr_b16 v[94:95], v125 offset:12544
    v_mfma_f32_16x16x32_bf16 v[172:175], v[100:103], v[32:35], v[172:175]
    ds_read_b64_tr_b16 v[96:97], v124 offset:14336
    s_waitcnt lgkmcnt(8)
    v_mfma_f32_16x16x32_bf16 v[152:155], v[28:31], v[104:107], v[152:155]
    ds_read_b64_tr_b16 v[98:99], v124 offset:14592
    v_mfma_f32_16x16x32_bf16 v[176:179], v[32:35], v[104:107], v[176:179]
    ds_read_b64_tr_b16 v[100:101], v125 offset:14336
    v_mfma_f32_16x16x32_bf16 v[156:159], v[28:31], v[108:111], v[156:159]
    ds_read_b64_tr_b16 v[102:103], v125 offset:14592
    v_mfma_f32_16x16x32_bf16 v[180:183], v[32:35], v[108:111], v[180:183]
    ds_read_b64_tr_b16 v[104:105], v124 offset:16384
    v_mfma_f32_16x16x32_bf16 v[184:187], v[112:115], v[36:39], v[184:187]
    ds_read_b64_tr_b16 v[106:107], v124 offset:16640
    v_mfma_f32_16x16x32_bf16 v[188:191], v[116:119], v[36:39], v[188:191]
    ds_read_b64_tr_b16 v[108:109], v125 offset:16384
    v_mfma_f32_16x16x32_bf16 v[48:51], v[28:31], v[28:31], v[48:51]
    ds_read_b64_tr_b16 v[110:111], v125 offset:16640
    v_mfma_f32_16x16x32_bf16 v[52:55], v[32:35], v[32:35], v[52:55]
    ds_read_b64_tr_b16 v[112:113], v126 offset:12288
    v_mfma_f32_16x16x32_bf16 v[56:59], v[36:39], v[36:39], v[56:59]
    ds_read_b64_tr_b16 v[114:115], v126 offset:12544
    v_mfma_f32_16x16x32_bf16 v[60:63], v[40:43], v[28:31], v[60:63]
    ds_read_b64_tr_b16 v[116:117], v127 offset:12288
    v_mfma_f32_16x16x32_bf16 v[64:67], v[40:43], v[32:35], v[64:67]
    ds_read_b64_tr_b16 v[118:119], v127 offset:12544
    v_mfma_f32_16x16x32_bf16 v[68:71], v[40:43], v[36:39], v[68:71]
    s_waitcnt lgkmcnt(8)
    v_mfma_f32_16x16x32_bf16 v[136:139], v[88:91], v[16:19], v[136:139]
    ds_read_b128 v[28:31], v129 offset:18432
    v_mfma_f32_16x16x32_bf16 v[160:163], v[88:91], v[20:23], v[160:163]
    ds_read_b128 v[32:35], v129 offset:20480
    v_mfma_f32_16x16x32_bf16 v[140:143], v[92:95], v[16:19], v[140:143]
    ds_read_b128 v[36:39], v131 offset:18432
    v_mfma_f32_16x16x32_bf16 v[164:167], v[92:95], v[20:23], v[164:167]
    ds_read_b64_tr_b16 v[88:89], v124 offset:18432
    v_mfma_f32_16x16x32_bf16 v[144:147], v[96:99], v[16:19], v[144:147]
    ds_read_b64_tr_b16 v[90:91], v124 offset:18688
    v_mfma_f32_16x16x32_bf16 v[168:171], v[96:99], v[20:23], v[168:171]
    ds_read_b64_tr_b16 v[92:93], v125 offset:18432
    v_mfma_f32_16x16x32_bf16 v[148:151], v[100:103], v[16:19], v[148:151]
    ds_read_b64_tr_b16 v[94:95], v125 offset:18688
    v_mfma_f32_16x16x32_bf16 v[172:175], v[100:103], v[20:23], v[172:175]
    ds_read_b64_tr_b16 v[96:97], v124 offset:20480
    s_waitcnt lgkmcnt(8)
    v_mfma_f32_16x16x32_bf16 v[152:155], v[16:19], v[104:107], v[152:155]
    ds_read_b64_tr_b16 v[98:99], v124 offset:20736
    v_mfma_f32_16x16x32_bf16 v[176:179], v[20:23], v[104:107], v[176:179]
    ds_read_b64_tr_b16 v[100:101], v125 offset:20480
    v_mfma_f32_16x16x32_bf16 v[156:159], v[16:19], v[108:111], v[156:159]
    ds_read_b64_tr_b16 v[102:103], v125 offset:20736
    v_mfma_f32_16x16x32_bf16 v[180:183], v[20:23], v[108:111], v[180:183]
    ds_read_b64_tr_b16 v[104:105], v124 offset:22528
    v_mfma_f32_16x16x32_bf16 v[184:187], v[112:115], v[24:27], v[184:187]
    ds_read_b64_tr_b16 v[106:107], v124 offset:22784
    v_mfma_f32_16x16x32_bf16 v[188:191], v[116:119], v[24:27], v[188:191]
    ds_read_b64_tr_b16 v[108:109], v125 offset:22528
    v_mfma_f32_16x16x32_bf16 v[48:51], v[16:19], v[16:19], v[48:51]
    ds_read_b64_tr_b16 v[110:111], v125 offset:22784
    v_mfma_f32_16x16x32_bf16 v[52:55], v[20:23], v[20:23], v[52:55]
    ds_read_b64_tr_b16 v[112:113], v126 offset:18432
    v_mfma_f32_16x16x32_bf16 v[56:59], v[24:27], v[24:27], v[56:59]
    ds_read_b64_tr_b16 v[114:115], v126 offset:18688
    v_mfma_f32_16x16x32_bf16 v[60:63], v[40:43], v[16:19], v[60:63]
    ds_read_b64_tr_b16 v[116:117], v127 offset:18432
    v_mfma_f32_16x16x32_bf16 v[64:67], v[40:43], v[20:23], v[64:67]
    ds_read_b64_tr_b16 v[118:119], v127 offset:18688
    v_mfma_f32_16x16x32_bf16 v[68:71], v[40:43], v[24:27], v[68:71]
    s_waitcnt vmcnt(18)
    s_barrier
    s_waitcnt lgkmcnt(8)
    v_mfma_f32_16x16x32_bf16 v[136:139], v[88:91], v[28:31], v[136:139]
    ds_read_b128 v[16:19], v128 offset:0
    v_mfma_f32_16x16x32_bf16 v[160:163], v[88:91], v[32:35], v[160:163]
    ds_read_b128 v[20:23], v128 offset:2048
    v_mfma_f32_16x16x32_bf16 v[140:143], v[92:95], v[28:31], v[140:143]
    ds_read_b128 v[24:27], v130 offset:0
    v_mfma_f32_16x16x32_bf16 v[164:167], v[92:95], v[32:35], v[164:167]
    ds_read_b64_tr_b16 v[88:89], v124 offset:24576
    v_mfma_f32_16x16x32_bf16 v[144:147], v[96:99], v[28:31], v[144:147]
    ds_read_b64_tr_b16 v[90:91], v124 offset:24832
    v_mfma_f32_16x16x32_bf16 v[168:171], v[96:99], v[32:35], v[168:171]
    ds_read_b64_tr_b16 v[92:93], v125 offset:24576
    v_mfma_f32_16x16x32_bf16 v[148:151], v[100:103], v[28:31], v[148:151]
    ds_read_b64_tr_b16 v[94:95], v125 offset:24832
    v_mfma_f32_16x16x32_bf16 v[172:175], v[100:103], v[32:35], v[172:175]
    ds_read_b64_tr_b16 v[96:97], v124 offset:26624
    s_waitcnt lgkmcnt(8)
    v_mfma_f32_16x16x32_bf16 v[152:155], v[28:31], v[104:107], v[152:155]
    ds_read_b64_tr_b16 v[98:99], v124 offset:26880
    v_mfma_f32_16x16x32_bf16 v[176:179], v[32:35], v[104:107], v[176:179]
    ds_read_b64_tr_b16 v[100:101], v125 offset:26624
    v_mfma_f32_16x16x32_bf16 v[156:159], v[28:31], v[108:111], v[156:159]
    ds_read_b64_tr_b16 v[102:103], v125 offset:26880
    v_mfma_f32_16x16x32_bf16 v[180:183], v[32:35], v[108:111], v[180:183]
    ds_read_b64_tr_b16 v[104:105], v124 offset:28672
    v_mfma_f32_16x16x32_bf16 v[184:187], v[112:115], v[36:39], v[184:187]
    ds_read_b64_tr_b16 v[106:107], v124 offset:28928
    v_mfma_f32_16x16x32_bf16 v[188:191], v[116:119], v[36:39], v[188:191]
    ds_read_b64_tr_b16 v[108:109], v125 offset:28672
    v_mfma_f32_16x16x32_bf16 v[48:51], v[28:31], v[28:31], v[48:51]
    ds_read_b64_tr_b16 v[110:111], v125 offset:28928
    v_mfma_f32_16x16x32_bf16 v[52:55], v[32:35], v[32:35], v[52:55]
    ds_read_b64_tr_b16 v[112:113], v126 offset:24576
    v_mfma_f32_16x16x32_bf16 v[56:59], v[36:39], v[36:39], v[56:59]
    ds_read_b64_tr_b16 v[114:115], v126 offset:24832
    v_mfma_f32_16x16x32_bf16 v[60:63], v[40:43], v[28:31], v[60:63]
    ds_read_b64_tr_b16 v[116:117], v127 offset:24576
    v_mfma_f32_16x16x32_bf16 v[64:67], v[40:43], v[32:35], v[64:67]
    ds_read_b64_tr_b16 v[118:119], v127 offset:24832
    v_mfma_f32_16x16x32_bf16 v[68:71], v[40:43], v[36:39], v[68:71]
    s_waitcnt lgkmcnt(8)
    v_mfma_f32_16x16x32_bf16 v[136:139], v[88:91], v[16:19], v[136:139]
    ds_read_b128 v[28:31], v129 offset:0
    v_mfma_f32_16x16x32_bf16 v[160:163], v[88:91], v[20:23], v[160:163]
    ds_read_b128 v[32:35], v129 offset:2048
    v_mfma_f32_16x16x32_bf16 v[140:143], v[92:95], v[16:19], v[140:143]
    ds_read_b128 v[36:39], v131 offset:0
    v_mfma_f32_16x16x32_bf16 v[164:167], v[92:95], v[20:23], v[164:167]
    ds_read_b64_tr_b16 v[88:89], v124 offset:30720
    v_mfma_f32_16x16x32_bf16 v[144:147], v[96:99], v[16:19], v[144:147]
    ds_read_b64_tr_b16 v[90:91], v124 offset:30976
    v_mfma_f32_16x16x32_bf16 v[168:171], v[96:99], v[20:23], v[168:171]
    ds_read_b64_tr_b16 v[92:93], v125 offset:30720
    v_mfma_f32_16x16x32_bf16 v[148:151], v[100:103], v[16:19], v[148:151]
    ds_read_b64_tr_b16 v[94:95], v125 offset:30976
    v_mfma_f32_16x16x32_bf16 v[172:175], v[100:103], v[20:23], v[172:175]
    ds_read_b64_tr_b16 v[96:97], v124 offset:32768
    s_waitcnt lgkmcnt(8)
    v_mfma_f32_16x16x32_bf16 v[152:155], v[16:19], v[104:107], v[152:155]
    ds_read_b64_tr_b16 v[98:99], v124 offset:33024
    v_mfma_f32_16x16x32_bf16 v[176:179], v[20:23], v[104:107], v[176:179]
    ds_read_b64_tr_b16 v[100:101], v125 offset:32768
    v_mfma_f32_16x16x32_bf16 v[156:159], v[16:19], v[108:111], v[156:159]
    ds_read_b64_tr_b16 v[102:103], v125 offset:33024
    v_mfma_f32_16x16x32_bf16 v[180:183], v[20:23], v[108:111], v[180:183]
    ds_read_b64_tr_b16 v[104:105], v124 offset:34816
    v_mfma_f32_16x16x32_bf16 v[184:187], v[112:115], v[24:27], v[184:187]
    ds_read_b64_tr_b16 v[106:107], v124 offset:35072
    v_mfma_f32_16x16x32_bf16 v[188:191], v[116:119], v[24:27], v[188:191]
    ds_read_b64_tr_b16 v[108:109], v125 offset:34816
    v_mfma_f32_16x16x32_bf16 v[48:51], v[16:19], v[16:19], v[48:51]
    ds_read_b64_tr_b16 v[110:111], v125 offset:35072
    v_mfma_f32_16x16x32_bf16 v[52:55], v[20:23], v[20:23], v[52:55]
    ds_read_b64_tr_b16 v[112:113], v126 offset:30720
    v_mfma_f32_16x16x32_bf16 v[56:59], v[24:27], v[24:27], v[56:59]
    ds_read_b64_tr_b16 v[114:115], v126 offset:30976
    v_mfma_f32_16x16x32_bf16 v[60:63], v[40:43], v[16:19], v[60:63]
    ds_read_b64_tr_b16 v[116:117], v127 offset:30720
    v_mfma_f32_16x16x32_bf16 v[64:67], v[40:43], v[20:23], v[64:67]
    ds_read_b64_tr_b16 v[118:119], v127 offset:30976
    v_mfma_f32_16x16x32_bf16 v[68:71], v[40:43], v[24:27], v[68:71]
    s_waitcnt lgkmcnt(8)
    v_mfma_f32_16x16x32_bf16 v[136:139], v[88:91], v[28:31], v[136:139]
    v_mfma_f32_16x16x32_bf16 v[160:163], v[88:91], v[32:35], v[160:163]
    v_mfma_f32_16x16x32_bf16 v[140:143], v[92:95], v[28:31], v[140:143]
    v_mfma_f32_16x16x32_bf16 v[164:167], v[92:95], v[32:35], v[164:167]
    v_mfma_f32_16x16x32_bf16 v[144:147], v[96:99], v[28:31], v[144:147]
    v_mfma_f32_16x16x32_bf16 v[168:171], v[96:99], v[32:35], v[168:171]
    v_mfma_f32_16x16x32_bf16 v[148:151], v[100:103], v[28:31], v[148:151]
    v_mfma_f32_16x16x32_bf16 v[172:175], v[100:103], v[32:35], v[172:175]
    s_waitcnt lgkmcnt(6)
    v_mfma_f32_16x16x32_bf16 v[152:155], v[28:31], v[104:107], v[152:155]
    v_mfma_f32_16x16x32_bf16 v[176:179], v[32:35], v[104:107], v[176:179]
    s_waitcnt lgkmcnt(4)
    v_mfma_f32_16x16x32_bf16 v[156:159], v[28:31], v[108:111], v[156:159]
    v_mfma_f32_16x16x32_bf16 v[180:183], v[32:35], v[108:111], v[180:183]
    s_waitcnt lgkmcnt(2)
    v_mfma_f32_16x16x32_bf16 v[184:187], v[112:115], v[36:39], v[184:187]
    s_waitcnt lgkmcnt(0)
    v_mfma_f32_16x16x32_bf16 v[188:191], v[116:119], v[36:39], v[188:191]
    v_mfma_f32_16x16x32_bf16 v[48:51], v[28:31], v[28:31], v[48:51]
    v_mfma_f32_16x16x32_bf16 v[52:55], v[32:35], v[32:35], v[52:55]
    v_mfma_f32_16x16x32_bf16 v[56:59], v[36:39], v[36:39], v[56:59]
    v_mfma_f32_16x16x32_bf16 v[60:63], v[40:43], v[28:31], v[60:63]
    v_mfma_f32_16x16x32_bf16 v[64:67], v[40:43], v[32:35], v[64:67]
    v_mfma_f32_16x16x32_bf16 v[68:71], v[40:43], v[36:39], v[68:71]
    s_mov_b32 s88, 0x22222222
    s_mov_b32 s89, 0x22222222
    s_mov_b32 s90, 0x44444444
    s_mov_b32 s91, 0x44444444
    s_mov_b32 s92, 0x88888888
    s_mov_b32 s93, 0x88888888
    v_lshlrev_b32 v32, 4, v3
    s_lshl_b32 s53, s3, 6
    v_add_u32 v33, s53, v32
    s_and_b32 s53, s53, 64
    v_add_u32 v34, s53, v32
    s_mul_i32 s53, s3, 384
    v_lshl_add_u32 v35, v2, 2, s53
    v_add_u32 v36, s53, v32
    s_mov_b32 exec_lo, 0x00010001
    s_mov_b32 exec_hi, 0x00010001
    ds_write_b128 v33, v[184:187] offset:128
    ds_write_b128 v34, v[188:191] offset:0
    s_mov_b64 exec, -1
    v_cndmask_b32 v48, v48, v49, s[88:89]
    v_cndmask_b32 v52, v52, v53, s[88:89]
    v_cndmask_b32 v56, v56, v57, s[88:89]
    v_cndmask_b32 v48, v48, v50, s[90:91]
    v_cndmask_b32 v52, v52, v54, s[90:91]
    v_cndmask_b32 v56, v56, v58, s[90:91]
    v_cndmask_b32 v48, v48, v51, s[92:93]
    v_cndmask_b32 v52, v52, v55, s[92:93]
    v_cndmask_b32 v56, v56, v59, s[92:93]
    v_mul_f32 v25, 0x3b124925, v60
    v_mul_f32 v27, 0x3b124925, v64
    v_mul_f32 v29, 0x3b124925, v68
    v_mul_f32 v24, v25, v25
    v_mul_f32 v26, v27, v27
    v_mul_f32 v28, v29, v29
    v_mul_f32 v48, 0x3b124925, v48
    v_mul_f32 v52, 0x3b124925, v52
    v_mul_f32 v56, 0x3b124925, v56
    v_sub_f32 v24, v48, v24
    v_sub_f32 v26, v52, v26
    v_sub_f32 v28, v56, v28
    v_max_f32 v24, 0, v24
    v_max_f32 v26, 0, v26
    v_max_f32 v28, 0, v28
    v_add_f32 v24, 0x3727c5ac, v24
    v_add_f32 v26, 0x3727c5ac, v26
    v_add_f32 v28, 0x3727c5ac, v28
    v_rsq_f32 v24, v24
    v_rsq_f32 v26, v26
    v_rsq_f32 v28, v28
    s_mov_b32 exec_lo, 0x00f0000f
    s_mov_b32 exec_hi, 0xf0000f00
    ds_write2_b32 v35, v24, v25 offset0:128 offset1:144
    ds_write2_b32 v35, v26, v27 offset0:160 offset1:176
    ds_write2_b32 v35, v28, v29 offset0:192 offset1:208
    s_mov_b64 exec, -1
    v_mov_b32_dpp v40, v184 row_newbcast:0 row_mask:0xf bank_mask:0xf
    v_mov_b32_dpp v41, v185 row_newbcast:0 row_mask:0xf bank_mask:0xf
    v_mov_b32_dpp v42, v186 row_newbcast:0 row_mask:0xf bank_mask:0xf
    v_mov_b32_dpp v43, v187 row_newbcast:0 row_mask:0xf bank_mask:0xf
    s_and_b32 s53, s3, 1
    s_lshl_b32 s53, s53, 3
    v_add_u32 v44, s53, v4
    v_lshrrev_b32 v45, 2, v2
    v_lshlrev_b32 v45, 8, v45
    v_lshl_add_u32 v45, v3, 6, v45
    v_and_b32 v46, 3, v2
    v_lshl_add_u32 v45, v46, 1, v45
    v_add_u32 v45, s53, v45
    v_add_u32 v45, 1024, v45
    s_cmp_lt_u32 s3, 2
    s_cselect_b64 vcc, -1, 0
    s_cselect_b32 s53, 2, 16
    v_cndmask_b32 v44, v45, v44, vcc
    v_add_u32 v45, s53, v44
    v_add_u32 v46, s53, v45
    v_add_u32 v47, s53, v46
    v_pk_fma_f32 v[40:41], v[40:41], v[28:29], v[184:185] op_sel:[0,1,0] op_sel_hi:[1,1,1] neg_lo:[0,1,0] neg_hi:[0,1,0]
    v_pk_fma_f32 v[42:43], v[42:43], v[28:29], v[186:187] op_sel:[0,1,0] op_sel_hi:[1,1,1] neg_lo:[0,1,0] neg_hi:[0,1,0]
    v_lshlrev_b32 v33, 2, v2
    s_lshl_b32 s53, s3, 11
    v_add_u32 v34, s53, v4
    s_cmp_eq_u32 s49, 15
    s_cselect_b32 s88, 0xffff0000, -1
    s_mov_b32 s89, -1
    s_mov_b32 s90, -1
    s_cselect_b32 s91, -1, 0xffff
    s_waitcnt lgkmcnt(0)
    s_barrier
    ds_read_b32 v26, v35 offset:640
    ds_read_b32 v28, v35 offset:768
    ds_read_b32 v24, v35 offset:512
    ds_read_b128 v[56:59], v32 offset:128
    ds_read_b128 v[60:63], v32 offset:192
    ds_read_b32 v64, v33 offset:256
    ds_read_b32 v65, v33 offset:320
    ds_read_b128 v[80:83], v36 offset:704
    ds_read_b128 v[76:79], v36 offset:640
    ds_read_b128 v[72:75], v36 offset:576
    ds_read_b128 v[68:71], v36 offset:512
    ds_read_b128 v[48:51], v32 offset:0
    ds_read_b128 v[52:55], v32 offset:64
    s_waitcnt lgkmcnt(9)
    v_pk_fma_f32 v[168:169], v[56:57], v[26:27], v[168:169] op_sel:[0,1,0] op_sel_hi:[1,1,1] neg_lo:[0,1,0] neg_hi:[0,1,0]
    v_pk_fma_f32 v[170:171], v[58:59], v[26:27], v[170:171] op_sel:[0,1,0] op_sel_hi:[1,1,1] neg_lo:[0,1,0] neg_hi:[0,1,0]
    v_pk_mul_f32 v[168:169], v[168:169], v[26:27] op_sel:[0,0] op_sel_hi:[1,0]
    v_pk_mul_f32 v[170:171], v[170:171], v[26:27] op_sel:[0,0] op_sel_hi:[1,0]
    v_cvt_pk_bf16_f32 v104, v168, v169
    v_cvt_pk_bf16_f32 v105, v170, v171
    s_waitcnt lgkmcnt(8)
    v_pk_fma_f32 v[172:173], v[60:61], v[26:27], v[172:173] op_sel:[0,1,0] op_sel_hi:[1,1,1] neg_lo:[0,1,0] neg_hi:[0,1,0]
    v_pk_fma_f32 v[174:175], v[62:63], v[26:27], v[174:175] op_sel:[0,1,0] op_sel_hi:[1,1,1] neg_lo:[0,1,0] neg_hi:[0,1,0]
    v_pk_mul_f32 v[172:173], v[172:173], v[26:27] op_sel:[0,0] op_sel_hi:[1,0]
    v_pk_mul_f32 v[174:175], v[174:175], v[26:27] op_sel:[0,0] op_sel_hi:[1,0]
    v_cvt_pk_bf16_f32 v106, v172, v173
    v_cvt_pk_bf16_f32 v107, v174, v175
    ds_write_b128 v34, v[104:107] offset:4096
    v_pk_mul_f32 v[40:41], v[40:41], v[28:29] op_sel_hi:[1,0]
    v_pk_mul_f32 v[42:43], v[42:43], v[28:29] op_sel_hi:[1,0]
    v_cvt_pk_bf16_f32 v40, v40, v41
    v_cvt_pk_bf16_f32 v42, v42, v43
    ds_write_b16 v44, v40 offset:2048
    ds_write_b16_d16_hi v45, v40 offset:2048
    ds_write_b16 v46, v42 offset:2048
    ds_write_b16_d16_hi v47, v42 offset:2048
    s_waitcnt lgkmcnt(10)
    v_pk_fma_f32 v[176:177], v[80:81], v[64:65], v[176:177] op_sel:[0,0,0] op_sel_hi:[1,0,1] neg_lo:[0,1,0] neg_hi:[0,1,0]
    v_pk_fma_f32 v[178:179], v[82:83], v[64:65], v[178:179] op_sel:[0,0,0] op_sel_hi:[1,0,1] neg_lo:[0,1,0] neg_hi:[0,1,0]
    s_waitcnt lgkmcnt(9)
    v_pk_mul_f32 v[176:177], v[176:177], v[76:77]
    v_pk_mul_f32 v[178:179], v[178:179], v[78:79]
    v_cvt_pk_bf16_f32 v112, v176, v177
    v_cvt_pk_bf16_f32 v113, v178, v179
    v_pk_fma_f32 v[180:181], v[80:81], v[64:65], v[180:181] op_sel:[0,1,0] op_sel_hi:[1,1,1] neg_lo:[0,1,0] neg_hi:[0,1,0]
    v_pk_fma_f32 v[182:183], v[82:83], v[64:65], v[182:183] op_sel:[0,1,0] op_sel_hi:[1,1,1] neg_lo:[0,1,0] neg_hi:[0,1,0]
    v_pk_mul_f32 v[180:181], v[180:181], v[76:77]
    v_pk_mul_f32 v[182:183], v[182:183], v[78:79]
    v_cvt_pk_bf16_f32 v118, v180, v181
    v_cvt_pk_bf16_f32 v119, v182, v183
    ds_write_b64 v34, v[112:113] offset:5120
    ds_write_b64 v34, v[118:119] offset:5128
    v_mul_f32 v84, 0x3e8b97f6, v24
    v_mul_f32 v86, 0x3e8b97f6, v26
    v_cndmask_b32 v85, 0, v84, s[90:91]
    v_cndmask_b32 v84, 0, v84, s[88:89]
    v_cndmask_b32 v87, 0, v86, s[90:91]
    v_cndmask_b32 v86, 0, v86, s[88:89]
    v_pk_fma_f32 v[144:145], v[56:57], v[24:25], v[144:145] op_sel:[0,1,0] op_sel_hi:[1,1,1] neg_lo:[0,1,0] neg_hi:[0,1,0]
    v_pk_fma_f32 v[146:147], v[58:59], v[24:25], v[146:147] op_sel:[0,1,0] op_sel_hi:[1,1,1] neg_lo:[0,1,0] neg_hi:[0,1,0]
    v_pk_mul_f32 v[144:145], v[144:145], v[24:25] op_sel:[0,0] op_sel_hi:[1,0]
    v_pk_mul_f32 v[146:147], v[146:147], v[24:25] op_sel:[0,0] op_sel_hi:[1,0]
    v_cvt_pk_bf16_f32 v100, v144, v145
    v_cvt_pk_bf16_f32 v101, v146, v147
    v_pk_fma_f32 v[148:149], v[60:61], v[24:25], v[148:149] op_sel:[0,1,0] op_sel_hi:[1,1,1] neg_lo:[0,1,0] neg_hi:[0,1,0]
    v_pk_fma_f32 v[150:151], v[62:63], v[24:25], v[150:151] op_sel:[0,1,0] op_sel_hi:[1,1,1] neg_lo:[0,1,0] neg_hi:[0,1,0]
    v_pk_mul_f32 v[148:149], v[148:149], v[24:25] op_sel:[0,0] op_sel_hi:[1,0]
    v_pk_mul_f32 v[150:151], v[150:151], v[24:25] op_sel:[0,0] op_sel_hi:[1,0]
    v_cvt_pk_bf16_f32 v102, v148, v149
    v_cvt_pk_bf16_f32 v103, v150, v151
    s_waitcnt lgkmcnt(0)
    s_barrier
    ds_read_b128 v[96:99], v34 offset:2048
    ds_read_b64 v[108:109], v34 offset:3072
    ds_read_b64 v[114:115], v34 offset:3080
    v_pk_fma_f32 v[160:161], v[48:49], v[26:27], v[160:161] op_sel:[0,1,0] op_sel_hi:[1,1,1] neg_lo:[0,1,0] neg_hi:[0,1,0]
    v_pk_fma_f32 v[162:163], v[50:51], v[26:27], v[162:163] op_sel:[0,1,0] op_sel_hi:[1,1,1] neg_lo:[0,1,0] neg_hi:[0,1,0]
    v_pk_mul_f32 v[160:161], v[160:161], v[86:87] op_sel:[0,0] op_sel_hi:[1,0]
    v_pk_mul_f32 v[162:163], v[162:163], v[86:87] op_sel:[0,0] op_sel_hi:[1,0]
    v_cvt_pk_bf16_f32 v92, v160, v161
    v_cvt_pk_bf16_f32 v93, v162, v163
    v_pk_fma_f32 v[164:165], v[52:53], v[26:27], v[164:165] op_sel:[0,1,0] op_sel_hi:[1,1,1] neg_lo:[0,1,0] neg_hi:[0,1,0]
    v_pk_fma_f32 v[166:167], v[54:55], v[26:27], v[166:167] op_sel:[0,1,0] op_sel_hi:[1,1,1] neg_lo:[0,1,0] neg_hi:[0,1,0]
    v_pk_mul_f32 v[164:165], v[164:165], v[86:87] op_sel:[0,1] op_sel_hi:[1,1]
    v_pk_mul_f32 v[166:167], v[166:167], v[86:87] op_sel:[0,1] op_sel_hi:[1,1]
    v_cvt_pk_bf16_f32 v94, v164, v165
    v_cvt_pk_bf16_f32 v95, v166, v167
    s_nop 1
    v_mfma_f32_16x16x32_bf16 v[128:131], v[100:103], v[92:95], v[240:243]
    v_mfma_f32_16x16x32_bf16 v[132:135], v[104:107], v[92:95], v[244:247]
    v_pk_fma_f32 v[136:137], v[48:49], v[24:25], v[136:137] op_sel:[0,1,0] op_sel_hi:[1,1,1] neg_lo:[0,1,0] neg_hi:[0,1,0]
    v_pk_fma_f32 v[138:139], v[50:51], v[24:25], v[138:139] op_sel:[0,1,0] op_sel_hi:[1,1,1] neg_lo:[0,1,0] neg_hi:[0,1,0]
    v_pk_mul_f32 v[136:137], v[136:137], v[84:85] op_sel:[0,0] op_sel_hi:[1,0]
    v_pk_mul_f32 v[138:139], v[138:139], v[84:85] op_sel:[0,0] op_sel_hi:[1,0]
    v_cvt_pk_bf16_f32 v88, v136, v137
    v_cvt_pk_bf16_f32 v89, v138, v139
    v_pk_fma_f32 v[140:141], v[52:53], v[24:25], v[140:141] op_sel:[0,1,0] op_sel_hi:[1,1,1] neg_lo:[0,1,0] neg_hi:[0,1,0]
    v_pk_fma_f32 v[142:143], v[54:55], v[24:25], v[142:143] op_sel:[0,1,0] op_sel_hi:[1,1,1] neg_lo:[0,1,0] neg_hi:[0,1,0]
    v_pk_mul_f32 v[140:141], v[140:141], v[84:85] op_sel:[0,1] op_sel_hi:[1,1]
    v_pk_mul_f32 v[142:143], v[142:143], v[84:85] op_sel:[0,1] op_sel_hi:[1,1]
    v_cvt_pk_bf16_f32 v90, v140, v141
    v_cvt_pk_bf16_f32 v91, v142, v143
    s_waitcnt lgkmcnt(2)
    s_nop 0
    v_mfma_f32_16x16x32_bf16 v[120:123], v[96:99], v[88:91], v[248:251]
    v_mfma_f32_16x16x32_bf16 v[124:127], v[100:103], v[88:91], v[244:247]
    v_pk_fma_f32 v[152:153], v[72:73], v[64:65], v[152:153] op_sel:[0,0,0] op_sel_hi:[1,0,1] neg_lo:[0,1,0] neg_hi:[0,1,0]
    v_pk_fma_f32 v[154:155], v[74:75], v[64:65], v[154:155] op_sel:[0,0,0] op_sel_hi:[1,0,1] neg_lo:[0,1,0] neg_hi:[0,1,0]
    v_pk_mul_f32 v[152:153], v[152:153], v[68:69]
    v_pk_mul_f32 v[154:155], v[154:155], v[70:71]
    v_cvt_pk_bf16_f32 v110, v152, v153
    v_cvt_pk_bf16_f32 v111, v154, v155
    v_pk_fma_f32 v[156:157], v[72:73], v[64:65], v[156:157] op_sel:[0,1,0] op_sel_hi:[1,1,1] neg_lo:[0,1,0] neg_hi:[0,1,0]
    v_pk_fma_f32 v[158:159], v[74:75], v[64:65], v[158:159] op_sel:[0,1,0] op_sel_hi:[1,1,1] neg_lo:[0,1,0] neg_hi:[0,1,0]
    v_pk_mul_f32 v[156:157], v[156:157], v[68:69]
    v_pk_mul_f32 v[158:159], v[158:159], v[70:71]
    v_cvt_pk_bf16_f32 v116, v156, v157
    v_cvt_pk_bf16_f32 v117, v158, v159
    v_max3_f32 v137, v128, v129, v130
    v_max3_f32 v139, v131, v132, v133
    v_max3_f32 v137, v137, v134, v135
    v_max_f32 v137, v137, v139
    v_max3_f32 v136, v120, v121, v122
    v_max3_f32 v138, v123, v124, v125
    v_max3_f32 v136, v136, v126, v127
    v_max_f32 v136, v136, v138
    v_mov_b32 v138, v136
    v_mov_b32 v139, v137
    s_nop 0
    v_permlane32_swap_b32 v136, v138
    v_permlane32_swap_b32 v137, v139
    v_max_f32 v136, v136, v138
    v_max_f32 v137, v137, v139
    v_mov_b32 v138, v136
    v_mov_b32 v139, v137
    s_nop 0
    v_permlane16_swap_b32 v136, v138
    v_permlane16_swap_b32 v137, v139
    v_max_f32 v136, v136, v138
    v_max_f32 v137, v137, v139
    v_pk_add_f32 v[128:129], v[128:129], v[136:137] op_sel:[0,1] op_sel_hi:[1,1] neg_lo:[0,1] neg_hi:[0,1]
    v_pk_add_f32 v[130:131], v[130:131], v[136:137] op_sel:[0,1] op_sel_hi:[1,1] neg_lo:[0,1] neg_hi:[0,1]
    v_pk_add_f32 v[132:133], v[132:133], v[136:137] op_sel:[0,1] op_sel_hi:[1,1] neg_lo:[0,1] neg_hi:[0,1]
    v_pk_add_f32 v[134:135], v[134:135], v[136:137] op_sel:[0,1] op_sel_hi:[1,1] neg_lo:[0,1] neg_hi:[0,1]
    v_exp_f32 v128, v128
    v_exp_f32 v129, v129
    v_exp_f32 v130, v130
    v_exp_f32 v131, v131
    v_exp_f32 v132, v132
    v_exp_f32 v133, v133
    v_exp_f32 v134, v134
    v_exp_f32 v135, v135
    v_cvt_pk_bf16_f32 v148, v128, v129
    v_cvt_pk_bf16_f32 v149, v130, v131
    v_cvt_pk_bf16_f32 v150, v132, v133
    v_cvt_pk_bf16_f32 v151, v134, v135
    s_nop 1
    v_mfma_f32_16x16x32_bf16 v[160:163], v[110:113], v[148:151], 0
    v_mfma_f32_16x16x32_bf16 v[164:167], v[116:119], v[148:151], 0
    v_pk_add_f32 v[120:121], v[120:121], v[136:137] op_sel:[0,0] op_sel_hi:[1,0] neg_lo:[0,1] neg_hi:[0,1]
    v_pk_add_f32 v[122:123], v[122:123], v[136:137] op_sel:[0,0] op_sel_hi:[1,0] neg_lo:[0,1] neg_hi:[0,1]
    v_pk_add_f32 v[124:125], v[124:125], v[136:137] op_sel:[0,0] op_sel_hi:[1,0] neg_lo:[0,1] neg_hi:[0,1]
    v_pk_add_f32 v[126:127], v[126:127], v[136:137] op_sel:[0,0] op_sel_hi:[1,0] neg_lo:[0,1] neg_hi:[0,1]
    v_exp_f32 v120, v120
    v_exp_f32 v121, v121
    v_exp_f32 v122, v122
    v_exp_f32 v123, v123
    v_exp_f32 v124, v124
    v_exp_f32 v125, v125
    v_exp_f32 v126, v126
    v_exp_f32 v127, v127
    v_cvt_pk_bf16_f32 v144, v120, v121
    v_cvt_pk_bf16_f32 v145, v122, v123
    v_cvt_pk_bf16_f32 v146, v124, v125
    v_cvt_pk_bf16_f32 v147, v126, v127
    s_waitcnt lgkmcnt(1)
    s_nop 0
    v_mfma_f32_16x16x32_bf16 v[152:155], v[108:111], v[144:147], 0
    s_waitcnt lgkmcnt(0)
    v_mfma_f32_16x16x32_bf16 v[156:159], v[114:117], v[144:147], 0
    v_pk_add_f32 v[120:121], v[120:121], v[122:123]
    v_pk_add_f32 v[124:125], v[124:125], v[126:127]
    v_pk_add_f32 v[128:129], v[128:129], v[130:131]
    v_pk_add_f32 v[132:133], v[132:133], v[134:135]
    v_pk_add_f32 v[120:121], v[120:121], v[124:125]
    v_pk_add_f32 v[128:129], v[128:129], v[132:133]
    v_add_f32 v140, v120, v121
    v_add_f32 v142, v128, v129
    v_mov_b32 v138, v140
    v_mov_b32 v139, v142
    s_nop 0
    v_permlane32_swap_b32 v140, v138
    v_permlane32_swap_b32 v142, v139
    v_add_f32 v140, v140, v138
    v_add_f32 v142, v142, v139
    v_mov_b32 v138, v140
    v_mov_b32 v139, v142
    s_nop 0
    v_permlane16_swap_b32 v140, v138
    v_permlane16_swap_b32 v142, v139
    v_add_f32 v140, v140, v138
    v_add_f32 v142, v142, v139
    v_rcp_f32 v140, v140
    v_rcp_f32 v142, v142
    v_cndmask_b32 v141, 0, v140, s[90:91]
    v_cndmask_b32 v140, 0, v140, s[88:89]
    v_cndmask_b32 v143, 0, v142, s[90:91]
    v_cndmask_b32 v142, 0, v142, s[88:89]
    s_lshl_b32 s53, s48, 3
    s_lshl_b32 s50, s3, 1
    s_add_u32 s53, s53, s50
    s_lshl_b32 s53, s53, 4
    s_add_u32 s53, s53, s49
    s_lshl_b32 s53, s53, 10
    s_add_u32 s50, s53, 16384
    v_pk_mul_f32 v[152:153], v[152:153], v[140:141] op_sel_hi:[1,0]
    v_pk_mul_f32 v[154:155], v[154:155], v[140:141] op_sel_hi:[1,0]
    v_pk_mul_f32 v[156:157], v[156:157], v[140:141] op_sel:[0,1] op_sel_hi:[1,1]
    v_pk_mul_f32 v[158:159], v[158:159], v[140:141] op_sel:[0,1] op_sel_hi:[1,1]
    v_cvt_pk_bf16_f32 v144, v152, v153
    v_cvt_pk_bf16_f32 v145, v154, v155
    v_cvt_pk_bf16_f32 v146, v156, v157
    v_cvt_pk_bf16_f32 v147, v158, v159
    buffer_store_dwordx4 v[144:147], v4, s[40:43], s53 offen sc1
    v_pk_mul_f32 v[160:161], v[160:161], v[142:143] op_sel_hi:[1,0]
    v_pk_mul_f32 v[162:163], v[162:163], v[142:143] op_sel_hi:[1,0]
    v_pk_mul_f32 v[164:165], v[164:165], v[142:143] op_sel:[0,1] op_sel_hi:[1,1]
    v_pk_mul_f32 v[166:167], v[166:167], v[142:143] op_sel:[0,1] op_sel_hi:[1,1]
    v_cvt_pk_bf16_f32 v148, v160, v161
    v_cvt_pk_bf16_f32 v149, v162, v163
    v_cvt_pk_bf16_f32 v150, v164, v165
    v_cvt_pk_bf16_f32 v151, v166, v167
    buffer_store_dwordx4 v[148:151], v4, s[40:43], s50 offen sc1
    s_add_u32 m0, s59, 0
    s_mov_b32 s73, 0
    buffer_load_dwordx4 v208, s[16:19], s73 offen lds
    s_add_u32 m0, s59, 1024
    s_mov_b32 s73, 7168
    buffer_load_dwordx4 v208, s[16:19], s73 offen lds
    s_add_u32 m0, s59, 2048
    s_mov_b32 s73, 14336
    buffer_load_dwordx4 v208, s[16:19], s73 offen lds
    s_add_u32 m0, s59, 3072
    s_mov_b32 s73, 21504
    buffer_load_dwordx4 v208, s[16:19], s73 offen lds
    s_add_u32 m0, s59, 4096
    s_mov_b32 s73, 28672
    buffer_load_dwordx4 v208, s[16:19], s73 offen lds
    s_add_u32 m0, s59, 5120
    s_mov_b32 s73, 35840
    buffer_load_dwordx4 v208, s[16:19], s73 offen lds
    s_add_u32 m0, s59, 6144
    s_mov_b32 s73, 43008
    buffer_load_dwordx4 v208, s[16:19], s73 offen lds
    s_add_u32 m0, s59, 7168
    s_mov_b32 s73, 50176
    buffer_load_dwordx4 v208, s[16:19], s73 offen lds
    s_add_u32 m0, s59, 8192
    s_mov_b32 s73, 57344
    buffer_load_dwordx4 v208, s[16:19], s73 offen lds
    s_add_u32 m0, s59, 9216
    s_mov_b32 s73, 64512
    buffer_load_dwordx4 v208, s[16:19], s73 offen lds
    s_add_u32 m0, s59, 10240
    s_mov_b32 s73, 71680
    buffer_load_dwordx4 v208, s[16:19], s73 offen lds
    s_add_u32 m0, s59, 11264
    s_mov_b32 s73, 78848
    buffer_load_dwordx4 v208, s[16:19], s73 offen lds
    s_add_u32 m0, s59, 12288
    s_mov_b32 s73, 86016
    buffer_load_dwordx4 v208, s[16:19], s73 offen lds
    s_add_u32 m0, s59, 13312
    s_mov_b32 s73, 93184
    buffer_load_dwordx4 v208, s[16:19], s73 offen lds
    s_waitcnt vmcnt(33)
    v_readfirstlane_b32 s4, v6
    s_nop 1
    s_cmp_lg_u32 s4, 0
    s_cbranch_scc1 Lepd_P_2
    s_nop 0
Lepg_P_1:
    s_sub_u32 s6, s6, 1
    s_cbranch_scc1 L_end_P
    buffer_load_dword v6, v7, s[44:47], 0 offen sc1
    s_waitcnt vmcnt(0)
    v_readfirstlane_b32 s4, v6
    s_nop 1
    s_cmp_eq_u32 s4, 0
    s_cbranch_scc1 Lepg_P_1
Lepd_P_2:
    s_waitcnt vmcnt(32)
    v_lshlrev_b32 v192, 16, v192
    s_waitcnt vmcnt(31)
    v_lshlrev_b32 v193, 16, v193
    s_waitcnt vmcnt(30)
    v_lshlrev_b32 v194, 16, v194
    s_waitcnt vmcnt(29)
    v_lshlrev_b32 v195, 16, v195
    s_waitcnt vmcnt(28)
    v_lshlrev_b32 v196, 16, v196
    s_waitcnt vmcnt(27)
    v_lshlrev_b32 v197, 16, v197
    s_waitcnt vmcnt(26)
    v_lshlrev_b32 v198, 16, v198
    s_waitcnt vmcnt(25)
    v_lshlrev_b32 v199, 16, v199
    s_waitcnt vmcnt(24)
    v_lshlrev_b32 v200, 16, v200
    s_waitcnt vmcnt(23)
    v_lshlrev_b32 v201, 16, v201
    s_waitcnt vmcnt(22)
    v_lshlrev_b32 v202, 16, v202
    s_waitcnt vmcnt(21)
    v_lshlrev_b32 v203, 16, v203
    s_waitcnt vmcnt(20)
    v_lshlrev_b32 v204, 16, v204
    s_waitcnt vmcnt(19)
    v_lshlrev_b32 v205, 16, v205
    s_waitcnt vmcnt(18)
    v_lshlrev_b32 v206, 16, v206
    s_waitcnt vmcnt(17)
    v_lshlrev_b32 v207, 16, v207
    s_waitcnt vmcnt(14)
    v_mov_b32 v8, s4
    s_mov_b64 exec, 1
    buffer_store_dword v8, v9, s[40:43], s80 offen sc1
    s_mov_b64 exec, -1
    s_cmp_lt_u32 s67, 99
    s_cbranch_scc1 Lnotag_P_3
    s_lshr_b32 s68, s2, 3
    s_bfe_u32 s69, s2, 0x20001
    s_lshl_b32 s69, s69, 3
    s_add_u32 s68, s68, s69
    s_sub_u32 s68, s68, 24
    s_lshl_b32 s68, s68, 2
    s_add_u32 s68, s68, s3
    s_mul_i32 s68, s68, 57344
    v_lshlrev_b32 v16, 7, v1
    buffer_load_dword v17, v16, s[24:27], s68 offen
    s_add_u32 s68, s68, 8192
    buffer_load_dword v18, v16, s[24:27], s68 offen
    s_add_u32 s68, s68, 8192
    buffer_load_dword v19, v16, s[24:27], s68 offen
    s_add_u32 s68, s68, 8192
    buffer_load_dword v20, v16, s[24:27], s68 offen
    s_add_u32 s68, s68, 8192
    buffer_load_dword v21, v16, s[24:27], s68 offen
    s_add_u32 s68, s68, 8192
    buffer_load_dword v22, v16, s[24:27], s68 offen
    s_add_u32 s68, s68, 8192
    buffer_load_dword v23, v16, s[24:27], s68 offen
    s_add_u32 s68, s68, 8192
    s_waitcnt vmcnt(0)
    s_branch L_end_P
Lnotag_P_3:
    s_waitcnt vmcnt(1)
    s_barrier
    ds_read_b64_tr_b16 a[0:1], v209 offset:0
    ds_read_b64_tr_b16 a[2:3], v209 offset:2048
    ds_read_b64_tr_b16 a[4:5], v209 offset:1024
    ds_read_b64_tr_b16 a[6:7], v209 offset:3072
    ds_read_b64_tr_b16 a[8:9], v209 offset:3584
    ds_read_b64_tr_b16 a[10:11], v209 offset:5632
    ds_read_b64_tr_b16 a[12:13], v209 offset:4608
    ds_read_b64_tr_b16 a[14:15], v209 offset:6656
    ds_read_b64_tr_b16 a[16:17], v209 offset:7168
    ds_read_b64_tr_b16 a[18:19], v209 offset:9216
    ds_read_b64_tr_b16 a[20:21], v209 offset:8192
    ds_read_b64_tr_b16 a[22:23], v209 offset:10240
    ds_read_b64_tr_b16 a[24:25], v209 offset:10752
    ds_read_b64_tr_b16 a[26:27], v209 offset:12800
    ds_read_b64_tr_b16 a[28:29], v209 offset:11776
    ds_read_b64_tr_b16 a[30:31], v209 offset:13824
    ds_read_b64_tr_b16 a[32:33], v209 offset:14336
    ds_read_b64_tr_b16 a[34:35], v209 offset:16384
    ds_read_b64_tr_b16 a[36:37], v209 offset:15360
    ds_read_b64_tr_b16 a[38:39], v209 offset:17408
    ds_read_b64_tr_b16 a[40:41], v209 offset:17920
    ds_read_b64_tr_b16 a[42:43], v209 offset:19968
    ds_read_b64_tr_b16 a[44:45], v209 offset:18944
    ds_read_b64_tr_b16 a[46:47], v209 offset:20992
    ds_read_b64_tr_b16 a[48:49], v209 offset:21504
    ds_read_b64_tr_b16 a[50:51], v209 offset:23552
    ds_read_b64_tr_b16 a[52:53], v209 offset:22528
    ds_read_b64_tr_b16 a[54:55], v209 offset:24576
    ds_read_b64_tr_b16 a[56:57], v209 offset:25088
    ds_read_b64_tr_b16 a[58:59], v209 offset:27136
    ds_read_b64_tr_b16 a[60:61], v209 offset:26112
    ds_read_b64_tr_b16 a[62:63], v209 offset:28160
    ds_read_b64_tr_b16 a[64:65], v209 offset:28672
    ds_read_b64_tr_b16 a[66:67], v209 offset:30720
    ds_read_b64_tr_b16 a[68:69], v209 offset:29696
    ds_read_b64_tr_b16 a[70:71], v209 offset:31744
    ds_read_b64_tr_b16 a[72:73], v209 offset:32256
    ds_read_b64_tr_b16 a[74:75], v209 offset:34304
    ds_read_b64_tr_b16 a[76:77], v209 offset:33280
    ds_read_b64_tr_b16 a[78:79], v209 offset:35328
    ds_read_b64_tr_b16 a[80:81], v209 offset:35840
    ds_read_b64_tr_b16 a[82:83], v209 offset:37888
    ds_read_b64_tr_b16 a[84:85], v209 offset:36864
    ds_read_b64_tr_b16 a[86:87], v209 offset:38912
    ds_read_b64_tr_b16 a[88:89], v209 offset:39424
    ds_read_b64_tr_b16 a[90:91], v209 offset:41472
    ds_read_b64_tr_b16 a[92:93], v209 offset:40448
    ds_read_b64_tr_b16 a[94:95], v209 offset:42496
    ds_read_b64_tr_b16 a[96:97], v209 offset:43008
    ds_read_b64_tr_b16 a[98:99], v209 offset:45056
    ds_read_b64_tr_b16 a[100:101], v209 offset:44032
    ds_read_b64_tr_b16 a[102:103], v209 offset:46080
    ds_read_b64_tr_b16 a[104:105], v209 offset:46592
    ds_read_b64_tr_b16 a[106:107], v209 offset:48640
    ds_read_b64_tr_b16 a[108:109], v209 offset:47616
    ds_read_b64_tr_b16 a[110:111], v209 offset:49664
    ds_read_b64_tr_b16 a[112:113], v209 offset:50176
    ds_read_b64_tr_b16 a[114:115], v209 offset:52224
    ds_read_b64_tr_b16 a[116:117], v209 offset:51200
    ds_read_b64_tr_b16 a[118:119], v209 offset:53248
    ds_read_b64_tr_b16 a[120:121], v209 offset:53248
    ds_read_b64_tr_b16 a[122:123], v209 offset:55296
    ds_read_b64_tr_b16 a[124:125], v209 offset:54272
    ds_read_b64_tr_b16 a[126:127], v209 offset:56320
    s_waitcnt lgkmcnt(0)
    s_barrier
    s_add_u32 m0, s70, 0
    s_mov_b32 s73, 0
    buffer_load_dwordx4 v213, s[20:23], s73 offen lds
    s_add_u32 m0, s70, 1024
    s_mov_b32 s73, 28672
    buffer_load_dwordx4 v213, s[20:23], s73 offen lds
    s_add_u32 m0, s70, 2048
    s_mov_b32 s73, 57344
    buffer_load_dwordx4 v213, s[20:23], s73 offen lds
    s_add_u32 m0, s70, 3072
    s_mov_b32 s73, 86016
    buffer_load_dwordx4 v213, s[20:23], s73 offen lds
    s_add_u32 m0, s70, 4096
    s_mov_b32 s73, 114688
    buffer_load_dwordx4 v213, s[20:23], s73 offen lds
    s_add_u32 m0, s70, 5120
    s_mov_b32 s73, 143360
    buffer_load_dwordx4 v213, s[20:23], s73 offen lds
    s_add_u32 m0, s70, 6144
    s_mov_b32 s73, 172032
    buffer_load_dwordx4 v213, s[20:23], s73 offen lds
    s_add_u32 m0, s70, 7168
    s_mov_b32 s73, 200704
    buffer_load_dwordx4 v213, s[20:23], s73 offen lds
    s_add_u32 m0, s70, 8192
    s_mov_b32 s73, 229376
    buffer_load_dwordx4 v213, s[20:23], s73 offen lds
    s_add_u32 m0, s70, 9216
    s_mov_b32 s73, 258048
    buffer_load_dwordx4 v213, s[20:23], s73 offen lds
    s_add_u32 m0, s70, 10240
    s_mov_b32 s73, 286720
    buffer_load_dwordx4 v213, s[20:23], s73 offen lds
    s_add_u32 m0, s70, 11264
    s_mov_b32 s73, 315392
    buffer_load_dwordx4 v213, s[20:23], s73 offen lds
    s_nop 1
Lpoll_P_4:
    s_sub_u32 s6, s6, 1
    s_cbranch_scc1 L_end_P
    buffer_load_dword v8, v10, s[40:43], s83 offen sc1
    s_waitcnt vmcnt(0)
    v_cmp_ne_u32 vcc, s4, v8
    s_nop 1
    s_cbranch_vccnz Lpoll_P_4
    s_lshl_b32 s58, s67, 16
    s_lshl_b32 s60, s3, 14
    s_add_u32 s58, s58, s60
    s_add_u32 m0, s60, 12288
    s_nop 0
    buffer_load_dwordx4 v4, s[40:43], s58 offen offset:0 sc1 lds
    buffer_load_dwordx4 v4, s[40:43], s58 offen offset:1024 sc1 lds
    buffer_load_dwordx4 v4, s[40:43], s58 offen offset:2048 sc1 lds
    buffer_load_dwordx4 v4, s[40:43], s58 offen offset:3072 sc1 lds
    s_add_u32 m0, s60, 16384
    s_add_u32 s58, s58, 4096
    buffer_load_dwordx4 v4, s[40:43], s58 offen offset:0 sc1 lds
    buffer_load_dwordx4 v4, s[40:43], s58 offen offset:1024 sc1 lds
    buffer_load_dwordx4 v4, s[40:43], s58 offen offset:2048 sc1 lds
    buffer_load_dwordx4 v4, s[40:43], s58 offen offset:3072 sc1 lds
    s_add_u32 m0, s60, 20480
    s_add_u32 s58, s58, 4096
    buffer_load_dwordx4 v4, s[40:43], s58 offen offset:0 sc1 lds
    buffer_load_dwordx4 v4, s[40:43], s58 offen offset:1024 sc1 lds
    buffer_load_dwordx4 v4, s[40:43], s58 offen offset:2048 sc1 lds
    buffer_load_dwordx4 v4, s[40:43], s58 offen offset:3072 sc1 lds
    s_add_u32 m0, s60, 24576
    s_add_u32 s58, s58, 4096
    buffer_load_dwordx4 v4, s[40:43], s58 offen offset:0 sc1 lds
    buffer_load_dwordx4 v4, s[40:43], s58 offen offset:1024 sc1 lds
    buffer_load_dwordx4 v4, s[40:43], s58 offen offset:2048 sc1 lds
    buffer_load_dwordx4 v4, s[40:43], s58 offen offset:3072 sc1 lds
    v_and_b32 v64, 1, v3
    v_lshlrev_b32 v64, 14, v64
    v_lshl_add_u32 v64, v2, 4, v64
    v_lshrrev_b32 v65, 5, v1
    v_lshl_add_u32 v64, v65, 8, v64
    s_lshr_b32 s60, s3, 1
    s_lshl_b32 s60, s60, 15
    s_add_u32 s60, s60, 12288
    v_add_u32 v64, s60, v64
    ds_read_b64_tr_b16 a[128:129], v215 offset:0
    ds_read_b64_tr_b16 a[130:131], v215 offset:1024
    ds_read_b64_tr_b16 a[132:133], v216 offset:0
    ds_read_b64_tr_b16 a[134:135], v216 offset:1024
    ds_read_b64_tr_b16 a[136:137], v215 offset:2048
    ds_read_b64_tr_b16 a[138:139], v215 offset:3072
    ds_read_b64_tr_b16 a[140:141], v216 offset:2048
    ds_read_b64_tr_b16 a[142:143], v216 offset:3072
    ds_read_b64_tr_b16 a[144:145], v215 offset:4096
    ds_read_b64_tr_b16 a[146:147], v215 offset:5120
    ds_read_b64_tr_b16 a[148:149], v216 offset:4096
    ds_read_b64_tr_b16 a[150:151], v216 offset:5120
    ds_read_b64_tr_b16 a[152:153], v215 offset:6144
    ds_read_b64_tr_b16 a[154:155], v215 offset:7168
    ds_read_b64_tr_b16 a[156:157], v216 offset:6144
    ds_read_b64_tr_b16 a[158:159], v216 offset:7168
    ds_read_b64_tr_b16 a[160:161], v215 offset:8192
    ds_read_b64_tr_b16 a[162:163], v215 offset:9216
    ds_read_b64_tr_b16 a[164:165], v216 offset:8192
    ds_read_b64_tr_b16 a[166:167], v216 offset:9216
    ds_read_b64_tr_b16 a[168:169], v215 offset:10240
    ds_read_b64_tr_b16 a[170:171], v215 offset:11264
    ds_read_b64_tr_b16 a[172:173], v216 offset:10240
    ds_read_b64_tr_b16 a[174:175], v216 offset:11264
    s_waitcnt vmcnt(8)
    s_barrier
    ds_read_b128 v[32:35], v64 offset:0
    ds_read_b128 v[36:39], v64 offset:512
    ds_read_b128 v[40:43], v64 offset:1024
    ds_read_b128 v[44:47], v64 offset:1536
    ds_read_b128 v[48:51], v64 offset:2048
    ds_read_b128 v[52:55], v64 offset:2560
    s_waitcnt lgkmcnt(5)
    v_mfma_f32_32x32x16_bf16 v[192:207], v[32:35], a[0:3], v[192:207]
    ds_read_b128 v[56:59], v64 offset:3072
    s_add_u32 m0, s70, 12288
    s_mov_b32 s73, 344064
    buffer_load_dwordx4 v213, s[20:23], s73 offen lds
    s_waitcnt lgkmcnt(5)
    v_mfma_f32_32x32x16_bf16 v[192:207], v[36:39], a[4:7], v[192:207]
    ds_read_b128 v[60:63], v64 offset:3584
    s_add_u32 m0, s70, 13312
    s_mov_b32 s73, 372736
    buffer_load_dwordx4 v213, s[20:23], s73 offen lds
    s_waitcnt lgkmcnt(5)
    v_mfma_f32_32x32x16_bf16 v[192:207], v[40:43], a[8:11], v[192:207]
    ds_read_b128 v[32:35], v64 offset:4096
    s_add_u32 m0, s70, 14336
    s_mov_b32 s73, 401408
    buffer_load_dwordx4 v213, s[20:23], s73 offen lds
    s_waitcnt lgkmcnt(5)
    v_mfma_f32_32x32x16_bf16 v[192:207], v[44:47], a[12:15], v[192:207]
    ds_read_b128 v[36:39], v64 offset:4608
    s_add_u32 m0, s70, 15360
    s_mov_b32 s73, 430080
    buffer_load_dwordx4 v213, s[20:23], s73 offen lds
    s_waitcnt lgkmcnt(5)
    v_mfma_f32_32x32x16_bf16 v[192:207], v[48:51], a[16:19], v[192:207]
    ds_read_b128 v[40:43], v64 offset:5120
    s_add_u32 m0, s70, 16384
    s_mov_b32 s73, 458752
    buffer_load_dwordx4 v213, s[20:23], s73 offen lds
    s_waitcnt lgkmcnt(5)
    v_mfma_f32_32x32x16_bf16 v[192:207], v[52:55], a[20:23], v[192:207]
    ds_read_b128 v[44:47], v64 offset:5632
    s_add_u32 m0, s70, 17408
    s_mov_b32 s73, 487424
    buffer_load_dwordx4 v213, s[20:23], s73 offen lds
    s_waitcnt lgkmcnt(5)
    v_mfma_f32_32x32x16_bf16 v[192:207], v[56:59], a[24:27], v[192:207]
    ds_read_b128 v[48:51], v64 offset:6144
    s_add_u32 m0, s70, 18432
    s_mov_b32 s73, 516096
    buffer_load_dwordx4 v213, s[20:23], s73 offen lds
    s_waitcnt lgkmcnt(5)
    v_mfma_f32_32x32x16_bf16 v[192:207], v[60:63], a[28:31], v[192:207]
    ds_read_b128 v[52:55], v64 offset:6656
    s_add_u32 m0, s70, 19456
    s_mov_b32 s73, 544768
    buffer_load_dwordx4 v213, s[20:23], s73 offen lds
    s_waitcnt lgkmcnt(5)
    v_mfma_f32_32x32x16_bf16 v[192:207], v[32:35], a[32:35], v[192:207]
    ds_read_b128 v[56:59], v64 offset:7168
    s_add_u32 m0, s70, 0
    s_mov_b32 s73, 573440
    buffer_load_dwordx4 v213, s[20:23], s73 offen lds
    s_waitcnt lgkmcnt(5)
    v_mfma_f32_32x32x16_bf16 v[192:207], v[36:39], a[36:39], v[192:207]
    ds_read_b128 v[60:63], v64 offset:7680
    s_add_u32 m0, s70, 1024
    s_mov_b32 s73, 602112
    buffer_load_dwordx4 v213, s[20:23], s73 offen lds
    s_waitcnt lgkmcnt(5)
    v_mfma_f32_32x32x16_bf16 v[192:207], v[40:43], a[40:43], v[192:207]
    s_add_u32 m0, s70, 2048
    s_mov_b32 s73, 630784
    buffer_load_dwordx4 v213, s[20:23], s73 offen lds
    s_waitcnt lgkmcnt(4)
    v_mfma_f32_32x32x16_bf16 v[192:207], v[44:47], a[44:47], v[192:207]
    s_add_u32 m0, s70, 3072
    s_mov_b32 s73, 659456
    buffer_load_dwordx4 v213, s[20:23], s73 offen lds
    s_waitcnt vmcnt(12)
    s_barrier
    ds_read_b128 v[32:35], v64 offset:8192
    ds_read_b128 v[36:39], v64 offset:8704
    s_waitcnt lgkmcnt(5)
    v_mfma_f32_32x32x16_bf16 v[192:207], v[48:51], a[48:51], v[192:207]
    ds_read_b128 v[40:43], v64 offset:9216
    s_add_u32 m0, s70, 4096
    s_mov_b32 s73, 688128
    buffer_load_dwordx4 v213, s[20:23], s73 offen lds
    s_waitcnt lgkmcnt(5)
    v_mfma_f32_32x32x16_bf16 v[192:207], v[52:55], a[52:55], v[192:207]
    ds_read_b128 v[44:47], v64 offset:9728
    s_add_u32 m0, s70, 5120
    s_mov_b32 s73, 716800
    buffer_load_dwordx4 v213, s[20:23], s73 offen lds
    s_waitcnt lgkmcnt(5)
    v_mfma_f32_32x32x16_bf16 v[192:207], v[56:59], a[56:59], v[192:207]
    ds_read_b128 v[48:51], v64 offset:10240
    s_add_u32 m0, s70, 6144
    s_mov_b32 s73, 745472
    buffer_load_dwordx4 v213, s[20:23], s73 offen lds
    s_waitcnt lgkmcnt(5)
    v_mfma_f32_32x32x16_bf16 v[192:207], v[60:63], a[60:63], v[192:207]
    ds_read_b128 v[52:55], v64 offset:10752
    s_add_u32 m0, s70, 7168
    s_mov_b32 s73, 774144
    buffer_load_dwordx4 v213, s[20:23], s73 offen lds
    s_waitcnt lgkmcnt(5)
    v_mfma_f32_32x32x16_bf16 v[192:207], v[32:35], a[64:67], v[192:207]
    ds_read_b128 v[56:59], v64 offset:11264
    s_add_u32 m0, s70, 8192
    s_mov_b32 s73, 802816
    buffer_load_dwordx4 v213, s[20:23], s73 offen lds
    s_waitcnt lgkmcnt(5)
    v_mfma_f32_32x32x16_bf16 v[192:207], v[36:39], a[68:71], v[192:207]
    ds_read_b128 v[60:63], v64 offset:11776
    s_add_u32 m0, s70, 9216
    s_mov_b32 s73, 831488
    buffer_load_dwordx4 v213, s[20:23], s73 offen lds
    s_waitcnt lgkmcnt(5)
    v_mfma_f32_32x32x16_bf16 v[192:207], v[40:43], a[72:75], v[192:207]
    ds_read_b128 v[32:35], v64 offset:12288
    s_add_u32 m0, s70, 10240
    s_mov_b32 s73, 860160
    buffer_load_dwordx4 v213, s[20:23], s73 offen lds
    s_waitcnt lgkmcnt(5)
    v_mfma_f32_32x32x16_bf16 v[192:207], v[44:47], a[76:79], v[192:207]
    ds_read_b128 v[36:39], v64 offset:12800
    s_add_u32 m0, s70, 11264
    s_mov_b32 s73, 888832
    buffer_load_dwordx4 v213, s[20:23], s73 offen lds
    s_waitcnt lgkmcnt(5)
    v_mfma_f32_32x32x16_bf16 v[192:207], v[48:51], a[80:83], v[192:207]
    ds_read_b128 v[40:43], v64 offset:13312
    s_waitcnt lgkmcnt(5)
    v_mfma_f32_32x32x16_bf16 v[192:207], v[52:55], a[84:87], v[192:207]
    ds_read_b128 v[44:47], v64 offset:13824
    s_waitcnt lgkmcnt(5)
    v_mfma_f32_32x32x16_bf16 v[192:207], v[56:59], a[88:91], v[192:207]
    ds_read_b128 v[48:51], v64 offset:14336
    s_waitcnt lgkmcnt(5)
    v_mfma_f32_32x32x16_bf16 v[192:207], v[60:63], a[92:95], v[192:207]
    ds_read_b128 v[52:55], v64 offset:14848
    s_waitcnt lgkmcnt(5)
    v_mfma_f32_32x32x16_bf16 v[192:207], v[32:35], a[96:99], v[192:207]
    ds_read_b128 v[56:59], v64 offset:15360
    s_waitcnt lgkmcnt(5)
    v_mfma_f32_32x32x16_bf16 v[192:207], v[36:39], a[100:103], v[192:207]
    ds_read_b128 v[60:63], v64 offset:15872
    s_waitcnt lgkmcnt(5)
    v_mfma_f32_32x32x16_bf16 v[192:207], v[40:43], a[104:107], v[192:207]
    s_waitcnt lgkmcnt(4)
    v_mfma_f32_32x32x16_bf16 v[192:207], v[44:47], a[108:111], v[192:207]
    s_waitcnt lgkmcnt(3)
    v_mfma_f32_32x32x16_bf16 v[192:207], v[48:51], a[112:115], v[192:207]
    s_waitcnt lgkmcnt(2)
    v_mfma_f32_32x32x16_bf16 v[192:207], v[52:55], a[116:119], v[192:207]
    s_waitcnt lgkmcnt(1)
    v_mfma_f32_32x32x16_bf16 v[192:207], v[56:59], a[120:123], v[192:207]
    s_waitcnt lgkmcnt(0)
    v_mfma_f32_32x32x16_bf16 v[192:207], v[60:63], a[124:127], v[192:207]
    s_nop 11
    v_pk_mul_f32 v[68:69], v[192:193], v[192:193]
    v_pk_mul_f32 v[70:71], v[194:195], v[194:195]
    v_pk_mul_f32 v[72:73], v[196:197], v[196:197]
    v_pk_mul_f32 v[74:75], v[198:199], v[198:199]
    v_pk_mul_f32 v[76:77], v[200:201], v[200:201]
    v_pk_mul_f32 v[78:79], v[202:203], v[202:203]
    v_pk_mul_f32 v[80:81], v[204:205], v[204:205]
    v_pk_mul_f32 v[82:83], v[206:207], v[206:207]
    v_add_f32_dpp v84, v192, v192 row_mirror row_mask:0xf bank_mask:0x3
    v_add_f32_dpp v85, v193, v193 row_mirror row_mask:0xf bank_mask:0x3
    v_add_f32_dpp v86, v196, v196 row_mirror row_mask:0xf bank_mask:0x3
    v_add_f32_dpp v87, v197, v197 row_mirror row_mask:0xf bank_mask:0x3
    v_add_f32_dpp v88, v200, v200 row_mirror row_mask:0xf bank_mask:0x3
    v_add_f32_dpp v89, v201, v201 row_mirror row_mask:0xf bank_mask:0x3
    v_add_f32_dpp v90, v204, v204 row_mirror row_mask:0xf bank_mask:0x3
    v_add_f32_dpp v91, v205, v205 row_mirror row_mask:0xf bank_mask:0x3
    v_add_f32_dpp v92, v68, v68 row_mirror row_mask:0xf bank_mask:0x3
    v_add_f32_dpp v93, v69, v69 row_mirror row_mask:0xf bank_mask:0x3
    v_add_f32_dpp v94, v72, v72 row_mirror row_mask:0xf bank_mask:0x3
    v_add_f32_dpp v95, v73, v73 row_mirror row_mask:0xf bank_mask:0x3
    v_add_f32_dpp v96, v76, v76 row_mirror row_mask:0xf bank_mask:0x3
    v_add_f32_dpp v97, v77, v77 row_mirror row_mask:0xf bank_mask:0x3
    v_add_f32_dpp v98, v80, v80 row_mirror row_mask:0xf bank_mask:0x3
    v_add_f32_dpp v99, v81, v81 row_mirror row_mask:0xf bank_mask:0x3
    v_add_f32_dpp v84, v194, v194 row_mirror row_mask:0xf bank_mask:0xc
    v_add_f32_dpp v85, v195, v195 row_mirror row_mask:0xf bank_mask:0xc
    v_add_f32_dpp v86, v198, v198 row_mirror row_mask:0xf bank_mask:0xc
    v_add_f32_dpp v87, v199, v199 row_mirror row_mask:0xf bank_mask:0xc
    v_add_f32_dpp v88, v202, v202 row_mirror row_mask:0xf bank_mask:0xc
    v_add_f32_dpp v89, v203, v203 row_mirror row_mask:0xf bank_mask:0xc
    v_add_f32_dpp v90, v206, v206 row_mirror row_mask:0xf bank_mask:0xc
    v_add_f32_dpp v91, v207, v207 row_mirror row_mask:0xf bank_mask:0xc
    v_add_f32_dpp v92, v70, v70 row_mirror row_mask:0xf bank_mask:0xc
    v_add_f32_dpp v93, v71, v71 row_mirror row_mask:0xf bank_mask:0xc
    v_add_f32_dpp v94, v74, v74 row_mirror row_mask:0xf bank_mask:0xc
    v_add_f32_dpp v95, v75, v75 row_mirror row_mask:0xf bank_mask:0xc
    v_add_f32_dpp v96, v78, v78 row_mirror row_mask:0xf bank_mask:0xc
    v_add_f32_dpp v97, v79, v79 row_mirror row_mask:0xf bank_mask:0xc
    v_add_f32_dpp v98, v82, v82 row_mirror row_mask:0xf bank_mask:0xc
    v_add_f32_dpp v99, v83, v83 row_mirror row_mask:0xf bank_mask:0xc
    v_add_f32_dpp v84, v84, v84 row_half_mirror row_mask:0xf bank_mask:0x5
    v_add_f32_dpp v86, v86, v86 row_half_mirror row_mask:0xf bank_mask:0x5
    v_add_f32_dpp v88, v88, v88 row_half_mirror row_mask:0xf bank_mask:0x5
    v_add_f32_dpp v90, v90, v90 row_half_mirror row_mask:0xf bank_mask:0x5
    v_add_f32_dpp v92, v92, v92 row_half_mirror row_mask:0xf bank_mask:0x5
    v_add_f32_dpp v94, v94, v94 row_half_mirror row_mask:0xf bank_mask:0x5
    v_add_f32_dpp v96, v96, v96 row_half_mirror row_mask:0xf bank_mask:0x5
    v_add_f32_dpp v98, v98, v98 row_half_mirror row_mask:0xf bank_mask:0x5
    v_add_f32_dpp v84, v85, v85 row_half_mirror row_mask:0xf bank_mask:0xa
    v_add_f32_dpp v86, v87, v87 row_half_mirror row_mask:0xf bank_mask:0xa
    v_add_f32_dpp v88, v89, v89 row_half_mirror row_mask:0xf bank_mask:0xa
    v_add_f32_dpp v90, v91, v91 row_half_mirror row_mask:0xf bank_mask:0xa
    v_add_f32_dpp v92, v93, v93 row_half_mirror row_mask:0xf bank_mask:0xa
    v_add_f32_dpp v94, v95, v95 row_half_mirror row_mask:0xf bank_mask:0xa
    v_add_f32_dpp v96, v97, v97 row_half_mirror row_mask:0xf bank_mask:0xa
    v_add_f32_dpp v98, v99, v99 row_half_mirror row_mask:0xf bank_mask:0xa
    v_add_f32_dpp v85, v84, v84 quad_perm:[1,0,3,2] row_mask:0xf bank_mask:0xf
    v_add_f32_dpp v87, v86, v86 quad_perm:[1,0,3,2] row_mask:0xf bank_mask:0xf
    v_add_f32_dpp v89, v88, v88 quad_perm:[1,0,3,2] row_mask:0xf bank_mask:0xf
    v_add_f32_dpp v91, v90, v90 quad_perm:[1,0,3,2] row_mask:0xf bank_mask:0xf
    v_add_f32_dpp v93, v92, v92 quad_perm:[1,0,3,2] row_mask:0xf bank_mask:0xf
    v_add_f32_dpp v95, v94, v94 quad_perm:[1,0,3,2] row_mask:0xf bank_mask:0xf
    v_add_f32_dpp v97, v96, v96 quad_perm:[1,0,3,2] row_mask:0xf bank_mask:0xf
    v_add_f32_dpp v99, v98, v98 quad_perm:[1,0,3,2] row_mask:0xf bank_mask:0xf
    v_add_f32_dpp v68, v85, v85 quad_perm:[2,3,0,1] row_mask:0xf bank_mask:0xf
    v_add_f32_dpp v69, v87, v87 quad_perm:[2,3,0,1] row_mask:0xf bank_mask:0xf
    v_add_f32_dpp v70, v89, v89 quad_perm:[2,3,0,1] row_mask:0xf bank_mask:0xf
    v_add_f32_dpp v71, v91, v91 quad_perm:[2,3,0,1] row_mask:0xf bank_mask:0xf
    v_add_f32_dpp v72, v93, v93 quad_perm:[2,3,0,1] row_mask:0xf bank_mask:0xf
    v_add_f32_dpp v73, v95, v95 quad_perm:[2,3,0,1] row_mask:0xf bank_mask:0xf
    v_add_f32_dpp v74, v97, v97 quad_perm:[2,3,0,1] row_mask:0xf bank_mask:0xf
    v_add_f32_dpp v75, v99, v99 quad_perm:[2,3,0,1] row_mask:0xf bank_mask:0xf
    v_permlane16_swap_b32 v68, v69
    v_permlane16_swap_b32 v70, v71
    v_permlane16_swap_b32 v72, v73
    v_permlane16_swap_b32 v74, v75
    v_add_f32 v84, v68, v69
    v_add_f32 v85, v72, v73
    v_add_f32 v86, v70, v71
    v_add_f32 v87, v74, v75
    v_and_b32 v65, 1, v3
    v_lshlrev_b32 v65, 6, v65
    v_lshrrev_b32 v66, 5, v1
    v_lshl_add_u32 v65, v66, 5, v65
    v_bfe_u32 v67, v1, 2, 2
    v_lshl_add_u32 v65, v67, 3, v65
    s_lshl_b32 s58, s3, 8
    v_add_u32 v65, s58, v65
    ds_write_b64 v65, v[84:85] offset:0
    ds_write_b64 v65, v[86:87] offset:128
    v_and_b32 v67, 31, v1
    v_lshlrev_b32 v65, 9, v66
    v_lshl_add_u32 v65, v67, 4, v65
    v_lshlrev_b32 v66, 8, v66
    v_lshl_add_u32 v66, v67, 3, v66
    s_and_b32 s58, s58, 512
    v_add_u32 v66, s58, v66
    s_lshl_b32 s58, s67, 1
    s_lshr_b32 s60, s3, 1
    s_add_u32 s58, s58, s60
    s_lshl_b32 s58, s58, 12
    s_add_u32 s58, s58, 0x548000
    s_lshl_b32 s60, s66, 9
    s_add_u32 s60, s60, s58
    s_waitcnt lgkmcnt(0)
    s_barrier
    ds_read_b64 v[84:85], v66 offset:0
    v_mov_b32 v89, s4
    v_mov_b32 v91, s4
    s_waitcnt lgkmcnt(0)
    v_mov_b32 v88, v84
    v_mov_b32 v90, v85
    s_nop 0
    v_permlane32_swap_b32 v88, v84
    v_permlane32_swap_b32 v90, v85
    v_add_f32 v88, v88, v84
    v_add_f32 v90, v90, v85
    s_bitcmp0_b32 s3, 0
    s_cselect_b32 exec_lo, -1, 0
    s_mov_b32 exec_hi, 0
    buffer_store_dwordx4 v[88:91], v65, s[40:43], s60 offen sc1
    s_mov_b64 exec, -1
    v_cvt_pk_bf16_f32 v240, v192, v193
    v_cvt_pk_bf16_f32 v241, v194, v195
    v_cvt_pk_bf16_f32 v242, v196, v197
    v_cvt_pk_bf16_f32 v243, v198, v199
    v_cvt_pk_bf16_f32 v244, v200, v201
    v_cvt_pk_bf16_f32 v245, v202, v203
    v_cvt_pk_bf16_f32 v246, v204, v205
    v_cvt_pk_bf16_f32 v247, v206, v207
    s_lshl_b32 s61, s66, 1
    s_and_b32 s60, s3, 1
    s_add_u32 s61, s61, s60
    s_lshl_b32 s61, s61, 7
    s_lshl_b32 s60, s67, 2
    s_add_u32 s61, s61, s60
    s_and_b32 s60, s3, 2
    s_add_u32 s61, s61, s60
    s_lshl_b32 s61, s61, 10
    s_add_u32 s61, s61, 0x200000
    v_lshlrev_b32 v66, 4, v67
    v_cmp_gt_u32 s[86:87], 32, v1
    s_waitcnt vmcnt(19)
    ds_read_b64_tr_b16 a[176:177], v215 offset:12288
    ds_read_b64_tr_b16 a[178:179], v215 offset:13312
    ds_read_b64_tr_b16 a[180:181], v216 offset:12288
    ds_read_b64_tr_b16 a[182:183], v216 offset:13312
    s_waitcnt vmcnt(17)
    ds_read_b64_tr_b16 a[184:185], v215 offset:14336
    ds_read_b64_tr_b16 a[186:187], v215 offset:15360
    ds_read_b64_tr_b16 a[188:189], v216 offset:14336
    ds_read_b64_tr_b16 a[190:191], v216 offset:15360
    s_waitcnt vmcnt(15)
    ds_read_b64_tr_b16 a[192:193], v215 offset:16384
    ds_read_b64_tr_b16 a[194:195], v215 offset:17408
    ds_read_b64_tr_b16 a[196:197], v216 offset:16384
    ds_read_b64_tr_b16 a[198:199], v216 offset:17408
    s_waitcnt vmcnt(13)
    ds_read_b64_tr_b16 a[200:201], v215 offset:18432
    ds_read_b64_tr_b16 a[202:203], v215 offset:19456
    ds_read_b64_tr_b16 a[204:205], v216 offset:18432
    ds_read_b64_tr_b16 a[206:207], v216 offset:19456
    s_waitcnt vmcnt(11)
    ds_read_b64_tr_b16 a[208:209], v215 offset:0
    ds_read_b64_tr_b16 a[210:211], v215 offset:1024
    ds_read_b64_tr_b16 a[212:213], v216 offset:0
    ds_read_b64_tr_b16 a[214:215], v216 offset:1024
    s_waitcnt vmcnt(9)
    ds_read_b64_tr_b16 a[216:217], v215 offset:2048
    ds_read_b64_tr_b16 a[218:219], v215 offset:3072
    ds_read_b64_tr_b16 a[220:221], v216 offset:2048
    ds_read_b64_tr_b16 a[222:223], v216 offset:3072
    s_waitcnt vmcnt(7)
    ds_read_b64_tr_b16 a[224:225], v215 offset:4096
    ds_read_b64_tr_b16 a[226:227], v215 offset:5120
    ds_read_b64_tr_b16 a[228:229], v216 offset:4096
    ds_read_b64_tr_b16 a[230:231], v216 offset:5120
    s_waitcnt vmcnt(5)
    ds_read_b64_tr_b16 a[232:233], v215 offset:6144
    ds_read_b64_tr_b16 a[234:235], v215 offset:7168
    ds_read_b64_tr_b16 a[236:237], v216 offset:6144
    ds_read_b64_tr_b16 a[238:239], v216 offset:7168
    s_waitcnt vmcnt(3)
    ds_read_b64_tr_b16 a[240:241], v215 offset:8192
    ds_read_b64_tr_b16 a[242:243], v215 offset:9216
    ds_read_b64_tr_b16 a[244:245], v216 offset:8192
    ds_read_b64_tr_b16 a[246:247], v216 offset:9216
    s_waitcnt vmcnt(1)
    ds_read_b64_tr_b16 a[248:249], v215 offset:10240
    ds_read_b64_tr_b16 a[250:251], v215 offset:11264
    ds_read_b64_tr_b16 a[252:253], v216 offset:10240
    ds_read_b64_tr_b16 a[254:255], v216 offset:11264
    s_waitcnt lgkmcnt(15)
    s_add_u32 m0, s70, 0
    s_mov_b32 s73, 917504
    buffer_load_dwordx4 v213, s[20:23], s73 offen lds
    s_add_u32 m0, s70, 1024
    s_mov_b32 s73, 946176
    buffer_load_dwordx4 v213, s[20:23], s73 offen lds
    s_add_u32 m0, s70, 2048
    s_mov_b32 s73, 974848
    buffer_load_dwordx4 v213, s[20:23], s73 offen lds
    s_add_u32 m0, s70, 3072
    s_mov_b32 s73, 1003520
    buffer_load_dwordx4 v213, s[20:23], s73 offen lds
    s_waitcnt lgkmcnt(12)
    s_add_u32 m0, s70, 4096
    s_mov_b32 s73, 1032192
    buffer_load_dwordx4 v213, s[20:23], s73 offen lds
    s_add_u32 m0, s70, 5120
    s_mov_b32 s73, 1060864
    buffer_load_dwordx4 v213, s[20:23], s73 offen lds
    s_waitcnt lgkmcnt(8)
    s_add_u32 m0, s70, 6144
    s_mov_b32 s73, 1089536
    buffer_load_dwordx4 v213, s[20:23], s73 offen lds
    s_add_u32 m0, s70, 7168
    s_mov_b32 s73, 1118208
    buffer_load_dwordx4 v213, s[20:23], s73 offen lds
    s_waitcnt lgkmcnt(4)
    s_add_u32 m0, s70, 8192
    s_mov_b32 s73, 1146880
    buffer_load_dwordx4 v213, s[20:23], s73 offen lds
    s_add_u32 m0, s70, 9216
    s_mov_b32 s73, 1175552
    buffer_load_dwordx4 v213, s[20:23], s73 offen lds
    s_waitcnt lgkmcnt(0)
    s_add_u32 m0, s70, 10240
    s_mov_b32 s73, 1204224
    buffer_load_dwordx4 v213, s[20:23], s73 offen lds
    s_add_u32 m0, s70, 11264
    s_mov_b32 s73, 1232896
    buffer_load_dwordx4 v213, s[20:23], s73 offen lds
    s_add_u32 m0, s70, 12288
    s_mov_b32 s73, 1261568
    buffer_load_dwordx4 v213, s[20:23], s73 offen lds
    s_add_u32 m0, s70, 13312
    s_mov_b32 s73, 1290240
    buffer_load_dwordx4 v213, s[20:23], s73 offen lds
    s_add_u32 m0, s70, 14336
    s_mov_b32 s73, 1318912
    buffer_load_dwordx4 v213, s[20:23], s73 offen lds
    s_add_u32 m0, s70, 15360
    s_mov_b32 s73, 1347584
    buffer_load_dwordx4 v213, s[20:23], s73 offen lds
    s_add_u32 m0, s70, 16384
    s_mov_b32 s73, 1376256
    buffer_load_dwordx4 v213, s[20:23], s73 offen lds
    s_add_u32 m0, s70, 17408
    s_mov_b32 s73, 1404928
    buffer_load_dwordx4 v213, s[20:23], s73 offen lds
    s_add_u32 m0, s70, 18432
    s_mov_b32 s73, 1433600
    buffer_load_dwordx4 v213, s[20:23], s73 offen lds
    s_add_u32 m0, s70, 19456
    s_mov_b32 s73, 1462272
    buffer_load_dwordx4 v213, s[20:23], s73 offen lds
    s_nop 1
Lst_P_5:
    s_sub_u32 s6, s6, 1
    s_cbranch_scc1 L_end_P
    buffer_load_dwordx4 v[96:99], v65, s[40:43], s58 offen offset:0 sc1
    buffer_load_dwordx4 v[100:103], v65, s[40:43], s58 offen offset:1024 sc1
    buffer_load_dwordx4 v[104:107], v65, s[40:43], s58 offen offset:2048 sc1
    buffer_load_dwordx4 v[108:111], v66, s[40:43], s58 offen offset:3072 sc1
    s_waitcnt vmcnt(0)
    v_xor_b32 v97, s4, v97
    v_xor_b32 v99, s4, v99
    v_xor_b32 v101, s4, v101
    v_xor_b32 v103, s4, v103
    v_xor_b32 v105, s4, v105
    v_xor_b32 v107, s4, v107
    v_xor_b32 v109, s4, v109
    v_xor_b32 v111, s4, v111
    v_or3_b32 v97, v97, v99, v101
    v_or3_b32 v103, v103, v105, v107
    v_or3_b32 v97, v97, v109, v111
    v_or_b32 v97, v97, v103
    v_cmp_ne_u32 vcc, 0, v97
    s_nop 1
    s_cbranch_vccnz Lst_P_5
    v_cndmask_b32 v108, 0, v108, s[86:87]
    v_cndmask_b32 v110, 0, v110, s[86:87]
    v_add_f32 v96, v96, v100
    v_add_f32 v104, v104, v108
    v_add_f32 v98, v98, v102
    v_add_f32 v106, v106, v110
    v_add_f32 v96, v96, v104
    v_add_f32 v98, v98, v106
    v_mov_b32 v100, v96
    v_mov_b32 v102, v98
    s_nop 0
    v_permlane32_swap_b32 v96, v100
    v_permlane32_swap_b32 v98, v102
    v_add_f32 v96, v96, v100
    v_add_f32 v98, v98, v102
    v_mul_f32 v97, 0x3b124925, v96
    v_mul_f32 v98, 0x3b124925, v98
    v_fma_f32 v98, -v97, v97, v98
    v_max_f32 v98, 0, v98
    v_add_f32 v99, 0x3727c5ac, v98
    v_rsq_f32 v99, v99
    s_nop 0
    v_mul_f32 v98, v98, v99
    v_fmaak_f32 v98, v98, v99, 0x3727c5ac
    v_rsq_f32 v98, v98
    s_nop 0
    v_mul_f32 v99, v99, v98
    s_lshl_b32 s60, s3, 8
    v_lshl_add_u32 v66, v67, 2, s60
    ds_write_b32 v66, v97 offset:1024
    ds_write_b32 v66, v99 offset:1152
    v_lshrrev_b32 v66, 5, v1
    v_lshl_add_u32 v66, v66, 4, s60
    s_waitcnt lgkmcnt(0)
    ds_read_b128 v[112:115], v66 offset:1024
    ds_read_b128 v[128:131], v66 offset:1152
    ds_read_b128 v[116:119], v66 offset:1056
    ds_read_b128 v[132:135], v66 offset:1184
    ds_read_b128 v[120:123], v66 offset:1088
    ds_read_b128 v[136:139], v66 offset:1216
    ds_read_b128 v[124:127], v66 offset:1120
    ds_read_b128 v[140:143], v66 offset:1248
    s_waitcnt lgkmcnt(7)
    v_pk_add_f32 v[192:193], v[192:193], v[112:113] neg_lo:[0,1] neg_hi:[0,1]
    v_pk_add_f32 v[194:195], v[194:195], v[114:115] neg_lo:[0,1] neg_hi:[0,1]
    s_waitcnt lgkmcnt(5)
    v_pk_add_f32 v[196:197], v[196:197], v[116:117] neg_lo:[0,1] neg_hi:[0,1]
    v_pk_add_f32 v[198:199], v[198:199], v[118:119] neg_lo:[0,1] neg_hi:[0,1]
    v_pk_mul_f32 v[192:193], v[192:193], v[128:129]
    v_pk_mul_f32 v[194:195], v[194:195], v[130:131]
    s_waitcnt lgkmcnt(4)
    v_pk_mul_f32 v[196:197], v[196:197], v[132:133]
    v_pk_mul_f32 v[198:199], v[198:199], v[134:135]
    v_cvt_pk_bf16_f32 v84, v192, v193
    v_cvt_pk_bf16_f32 v85, v194, v195
    v_cvt_pk_bf16_f32 v86, v196, v197
    v_cvt_pk_bf16_f32 v87, v198, v199
    buffer_store_dwordx4 v[84:87], v4, s[40:43], s61 offen offset:0 sc1
    s_waitcnt lgkmcnt(3)
    v_pk_add_f32 v[200:201], v[200:201], v[120:121] neg_lo:[0,1] neg_hi:[0,1]
    v_pk_add_f32 v[202:203], v[202:203], v[122:123] neg_lo:[0,1] neg_hi:[0,1]
    s_waitcnt lgkmcnt(1)
    v_pk_add_f32 v[204:205], v[204:205], v[124:125] neg_lo:[0,1] neg_hi:[0,1]
    v_pk_add_f32 v[206:207], v[206:207], v[126:127] neg_lo:[0,1] neg_hi:[0,1]
    v_pk_mul_f32 v[200:201], v[200:201], v[136:137]
    v_pk_mul_f32 v[202:203], v[202:203], v[138:139]
    s_waitcnt lgkmcnt(0)
    v_pk_mul_f32 v[204:205], v[204:205], v[140:141]
    v_pk_mul_f32 v[206:207], v[206:207], v[142:143]
    v_cvt_pk_bf16_f32 v88, v200, v201
    v_cvt_pk_bf16_f32 v89, v202, v203
    v_cvt_pk_bf16_f32 v90, v204, v205
    v_cvt_pk_bf16_f32 v91, v206, v207
    buffer_store_dwordx4 v[88:91], v4, s[40:43], s61 offen offset:1024 sc1
    ds_read_b64_tr_b16 a[0:1], v215 offset:0
    ds_read_b64_tr_b16 a[2:3], v215 offset:1024
    ds_read_b64_tr_b16 a[4:5], v216 offset:0
    ds_read_b64_tr_b16 a[6:7], v216 offset:1024
    ds_read_b64_tr_b16 a[8:9], v215 offset:2048
    ds_read_b64_tr_b16 a[10:11], v215 offset:3072
    ds_read_b64_tr_b16 a[12:13], v216 offset:2048
    ds_read_b64_tr_b16 a[14:15], v216 offset:3072
    ds_read_b64_tr_b16 a[16:17], v215 offset:4096
    ds_read_b64_tr_b16 a[18:19], v215 offset:5120
    ds_read_b64_tr_b16 a[20:21], v216 offset:4096
    ds_read_b64_tr_b16 a[22:23], v216 offset:5120
    ds_read_b64_tr_b16 a[24:25], v215 offset:6144
    ds_read_b64_tr_b16 a[26:27], v215 offset:7168
    ds_read_b64_tr_b16 a[28:29], v216 offset:6144
    ds_read_b64_tr_b16 a[30:31], v216 offset:7168
    ds_read_b64_tr_b16 a[32:33], v215 offset:8192
    ds_read_b64_tr_b16 a[34:35], v215 offset:9216
    ds_read_b64_tr_b16 a[36:37], v216 offset:8192
    ds_read_b64_tr_b16 a[38:39], v216 offset:9216
    ds_read_b64_tr_b16 a[40:41], v215 offset:10240
    ds_read_b64_tr_b16 a[42:43], v215 offset:11264
    ds_read_b64_tr_b16 a[44:45], v216 offset:10240
    ds_read_b64_tr_b16 a[46:47], v216 offset:11264
    ds_read_b64_tr_b16 a[48:49], v215 offset:12288
    ds_read_b64_tr_b16 a[50:51], v215 offset:13312
    ds_read_b64_tr_b16 a[52:53], v216 offset:12288
    ds_read_b64_tr_b16 a[54:55], v216 offset:13312
    ds_read_b64_tr_b16 a[56:57], v215 offset:14336
    ds_read_b64_tr_b16 a[58:59], v215 offset:15360
    ds_read_b64_tr_b16 a[60:61], v216 offset:14336
    ds_read_b64_tr_b16 a[62:63], v216 offset:15360
    ds_read_b64_tr_b16 a[64:65], v215 offset:16384
    ds_read_b64_tr_b16 a[66:67], v215 offset:17408
    ds_read_b64_tr_b16 a[68:69], v216 offset:16384
    ds_read_b64_tr_b16 a[70:71], v216 offset:17408
    ds_read_b64_tr_b16 a[72:73], v215 offset:18432
    ds_read_b64_tr_b16 a[74:75], v215 offset:19456
    ds_read_b64_tr_b16 a[76:77], v216 offset:18432
    ds_read_b64_tr_b16 a[78:79], v216 offset:19456
    s_waitcnt vmcnt(0)
    v_mov_b32 v8, s4
    s_mov_b64 exec, 1
    buffer_store_dword v8, v9, s[40:43], s81 offen sc1
    s_mov_b64 exec, -1
    s_waitcnt lgkmcnt(15)
    s_add_u32 m0, s70, 0
    s_mov_b32 s73, 1490944
    buffer_load_dwordx4 v213, s[20:23], s73 offen lds
    s_add_u32 m0, s70, 1024
    s_mov_b32 s73, 1519616
    buffer_load_dwordx4 v213, s[20:23], s73 offen lds
    s_add_u32 m0, s70, 2048
    s_mov_b32 s73, 1548288
    buffer_load_dwordx4 v213, s[20:23], s73 offen lds
    s_add_u32 m0, s70, 3072
    s_mov_b32 s73, 1576960
    buffer_load_dwordx4 v213, s[20:23], s73 offen lds
    s_add_u32 m0, s70, 4096
    s_mov_b32 s73, 1605632
    buffer_load_dwordx4 v213, s[20:23], s73 offen lds
    s_add_u32 m0, s70, 5120
    s_mov_b32 s73, 1634304
    buffer_load_dwordx4 v213, s[20:23], s73 offen lds
    s_add_u32 m0, s70, 6144
    s_mov_b32 s73, 1662976
    buffer_load_dwordx4 v213, s[20:23], s73 offen lds
    s_add_u32 m0, s70, 7168
    s_mov_b32 s73, 1691648
    buffer_load_dwordx4 v213, s[20:23], s73 offen lds
    s_add_u32 m0, s70, 8192
    s_mov_b32 s73, 1720320
    buffer_load_dwordx4 v213, s[20:23], s73 offen lds
    s_add_u32 m0, s70, 9216
    s_mov_b32 s73, 1748992
    buffer_load_dwordx4 v213, s[20:23], s73 offen lds
    s_add_u32 m0, s70, 10240
    s_mov_b32 s73, 1777664
    buffer_load_dwordx4 v213, s[20:23], s73 offen lds
    s_add_u32 m0, s70, 11264
    s_mov_b32 s73, 1806336
    buffer_load_dwordx4 v213, s[20:23], s73 offen lds
    v_lshrrev_b32 v220, 5, v1
    v_lshlrev_b32 v220, 3, v220
    s_lshl_b32 s68, s65, 7
    s_lshr_b32 s69, s3, 1
    s_lshl_b32 s69, s69, 6
    s_add_u32 s68, s68, s69
    buffer_load_dwordx2 v[222:223], v220, s[28:31], s68 offen offset:0
    buffer_load_dwordx2 v[224:225], v220, s[28:31], s68 offen offset:16
    buffer_load_dwordx2 v[226:227], v220, s[28:31], s68 offen offset:32
    buffer_load_dwordx2 v[228:229], v220, s[28:31], s68 offen offset:48
    s_lshl_b32 s68, s64, 1
    s_and_b32 s69, s3, 1
    s_add_u32 s71, s68, s69
    s_xor_b32 s72, s71, 1
    s_mul_i32 s68, s3, 32768
    s_add_u32 s68, s68, 0x200000
    s_mul_i32 s71, s71, 131072
    s_add_u32 s71, s71, s68
    s_mul_i32 s72, s72, 131072
    s_add_u32 s72, s72, s68
    s_nop 1
Lpoll_P_6:
    s_sub_u32 s6, s6, 1
    s_cbranch_scc1 L_end_P
    buffer_load_dword v8, v11, s[40:43], s84 offen sc1
    s_waitcnt vmcnt(0)
    v_cmp_ne_u32 vcc, s4, v8
    s_nop 1
    s_cbranch_vccnz Lpoll_P_6
    buffer_load_dwordx4 v[80:83], v5, s[40:43], s71 offen offset:0 sc1
    buffer_load_dwordx4 v[84:87], v5, s[40:43], s72 offen offset:0 sc1
    buffer_load_dwordx4 v[88:91], v5, s[40:43], s71 offen offset:1024 sc1
    buffer_load_dwordx4 v[92:95], v5, s[40:43], s72 offen offset:1024 sc1
    buffer_load_dwordx4 v[96:99], v5, s[40:43], s71 offen offset:2048 sc1
    buffer_load_dwordx4 v[100:103], v5, s[40:43], s72 offen offset:2048 sc1
    buffer_load_dwordx4 v[104:107], v5, s[40:43], s71 offen offset:3072 sc1
    buffer_load_dwordx4 v[108:111], v5, s[40:43], s72 offen offset:3072 sc1
    s_add_u32 s71, s71, 4096
    s_add_u32 s72, s72, 4096
    buffer_load_dwordx4 v[112:115], v5, s[40:43], s71 offen offset:0 sc1
    buffer_load_dwordx4 v[116:119], v5, s[40:43], s72 offen offset:0 sc1
    buffer_load_dwordx4 v[120:123], v5, s[40:43], s71 offen offset:1024 sc1
    buffer_load_dwordx4 v[124:127], v5, s[40:43], s72 offen offset:1024 sc1
    ds_read_b64_tr_b16 a[80:81], v215 offset:0
    ds_read_b64_tr_b16 a[82:83], v215 offset:1024
    ds_read_b64_tr_b16 a[84:85], v216 offset:0
    ds_read_b64_tr_b16 a[86:87], v216 offset:1024
    ds_read_b64_tr_b16 a[88:89], v215 offset:2048
    ds_read_b64_tr_b16 a[90:91], v215 offset:3072
    ds_read_b64_tr_b16 a[92:93], v216 offset:2048
    ds_read_b64_tr_b16 a[94:95], v216 offset:3072
    ds_read_b64_tr_b16 a[96:97], v215 offset:4096
    ds_read_b64_tr_b16 a[98:99], v215 offset:5120
    ds_read_b64_tr_b16 a[100:101], v216 offset:4096
    ds_read_b64_tr_b16 a[102:103], v216 offset:5120
    ds_read_b64_tr_b16 a[104:105], v215 offset:6144
    ds_read_b64_tr_b16 a[106:107], v215 offset:7168
    ds_read_b64_tr_b16 a[108:109], v216 offset:6144
    ds_read_b64_tr_b16 a[110:111], v216 offset:7168
    ds_read_b64_tr_b16 a[112:113], v215 offset:8192
    ds_read_b64_tr_b16 a[114:115], v215 offset:9216
    ds_read_b64_tr_b16 a[116:117], v216 offset:8192
    ds_read_b64_tr_b16 a[118:119], v216 offset:9216
    ds_read_b64_tr_b16 a[120:121], v215 offset:10240
    ds_read_b64_tr_b16 a[122:123], v215 offset:11264
    ds_read_b64_tr_b16 a[124:125], v216 offset:10240
    ds_read_b64_tr_b16 a[126:127], v216 offset:11264
    v_lshlrev_b32 v16, 16, v222
    v_and_b32 v17, 0xffff0000, v222
    v_lshlrev_b32 v18, 16, v223
    v_and_b32 v19, 0xffff0000, v223
    v_lshlrev_b32 v20, 16, v224
    v_and_b32 v21, 0xffff0000, v224
    v_lshlrev_b32 v22, 16, v225
    v_and_b32 v23, 0xffff0000, v225
    v_lshlrev_b32 v24, 16, v226
    v_and_b32 v25, 0xffff0000, v226
    v_lshlrev_b32 v26, 16, v227
    v_and_b32 v27, 0xffff0000, v227
    v_lshlrev_b32 v28, 16, v228
    v_and_b32 v29, 0xffff0000, v228
    v_lshlrev_b32 v30, 16, v229
    v_and_b32 v31, 0xffff0000, v229
    buffer_load_dwordx4 v[128:131], v5, s[40:43], s71 offen offset:2048 sc1
    buffer_load_dwordx4 v[132:135], v5, s[40:43], s72 offen offset:2048 sc1
    buffer_load_dwordx4 v[136:139], v5, s[40:43], s71 offen offset:3072 sc1
    buffer_load_dwordx4 v[140:143], v5, s[40:43], s72 offen offset:3072 sc1
    s_waitcnt vmcnt(15)
    v_mfma_f32_32x32x16_bf16 v[16:31], a[128:131], v[80:83], v[16:31]
    s_waitcnt vmcnt(14)
    v_mfma_f32_32x32x16_bf16 v[32:47], a[128:131], v[84:87], 0
    v_mfma_f32_32x32x16_bf16 v[48:63], a[132:135], v[80:83], 0
    v_mfma_f32_32x32x16_bf16 v[64:79], a[132:135], v[84:87], 0
    s_add_u32 s71, s71, 4096
    s_add_u32 s72, s72, 4096
    buffer_load_dwordx4 v[144:147], v5, s[40:43], s71 offen offset:0 sc1
    buffer_load_dwordx4 v[148:151], v5, s[40:43], s72 offen offset:0 sc1
    buffer_load_dwordx4 v[152:155], v5, s[40:43], s71 offen offset:1024 sc1
    buffer_load_dwordx4 v[156:159], v5, s[40:43], s72 offen offset:1024 sc1
    s_waitcnt vmcnt(17)
    v_mfma_f32_32x32x16_bf16 v[16:31], a[136:139], v[88:91], v[16:31]
    s_waitcnt vmcnt(16)
    v_mfma_f32_32x32x16_bf16 v[32:47], a[136:139], v[92:95], v[32:47]
    v_mfma_f32_32x32x16_bf16 v[48:63], a[140:143], v[88:91], v[48:63]
    v_mfma_f32_32x32x16_bf16 v[64:79], a[140:143], v[92:95], v[64:79]
    buffer_load_dwordx4 v[160:163], v5, s[40:43], s71 offen offset:2048 sc1
    buffer_load_dwordx4 v[164:167], v5, s[40:43], s72 offen offset:2048 sc1
    buffer_load_dwordx4 v[168:171], v5, s[40:43], s71 offen offset:3072 sc1
    buffer_load_dwordx4 v[172:175], v5, s[40:43], s72 offen offset:3072 sc1
    s_waitcnt vmcnt(19)
    v_mfma_f32_32x32x16_bf16 v[16:31], a[144:147], v[96:99], v[16:31]
    s_waitcnt vmcnt(18)
    v_mfma_f32_32x32x16_bf16 v[32:47], a[144:147], v[100:103], v[32:47]
    v_mfma_f32_32x32x16_bf16 v[48:63], a[148:151], v[96:99], v[48:63]
    v_mfma_f32_32x32x16_bf16 v[64:79], a[148:151], v[100:103], v[64:79]
    s_add_u32 s71, s71, 4096
    s_add_u32 s72, s72, 4096
    buffer_load_dwordx4 v[176:179], v5, s[40:43], s71 offen offset:0 sc1
    buffer_load_dwordx4 v[180:183], v5, s[40:43], s72 offen offset:0 sc1
    buffer_load_dwordx4 v[184:187], v5, s[40:43], s71 offen offset:1024 sc1
    buffer_load_dwordx4 v[188:191], v5, s[40:43], s72 offen offset:1024 sc1
    s_waitcnt vmcnt(21)
    v_mfma_f32_32x32x16_bf16 v[16:31], a[152:155], v[104:107], v[16:31]
    s_waitcnt vmcnt(20)
    v_mfma_f32_32x32x16_bf16 v[32:47], a[152:155], v[108:111], v[32:47]
    v_mfma_f32_32x32x16_bf16 v[48:63], a[156:159], v[104:107], v[48:63]
    v_mfma_f32_32x32x16_bf16 v[64:79], a[156:159], v[108:111], v[64:79]
    buffer_load_dwordx4 v[192:195], v5, s[40:43], s71 offen offset:2048 sc1
    buffer_load_dwordx4 v[196:199], v5, s[40:43], s72 offen offset:2048 sc1
    buffer_load_dwordx4 v[200:203], v5, s[40:43], s71 offen offset:3072 sc1
    buffer_load_dwordx4 v[204:207], v5, s[40:43], s72 offen offset:3072 sc1
    s_waitcnt vmcnt(23)
    v_mfma_f32_32x32x16_bf16 v[16:31], a[160:163], v[112:115], v[16:31]
    s_waitcnt vmcnt(22)
    v_mfma_f32_32x32x16_bf16 v[32:47], a[160:163], v[116:119], v[32:47]
    v_mfma_f32_32x32x16_bf16 v[48:63], a[164:167], v[112:115], v[48:63]
    v_mfma_f32_32x32x16_bf16 v[64:79], a[164:167], v[116:119], v[64:79]
    s_add_u32 s71, s71, 4096
    s_add_u32 s72, s72, 4096
    buffer_load_dwordx4 v[80:83], v5, s[40:43], s71 offen offset:0 sc1
    buffer_load_dwordx4 v[84:87], v5, s[40:43], s72 offen offset:0 sc1
    buffer_load_dwordx4 v[88:91], v5, s[40:43], s71 offen offset:1024 sc1
    buffer_load_dwordx4 v[92:95], v5, s[40:43], s72 offen offset:1024 sc1
    s_waitcnt vmcnt(25)
    v_mfma_f32_32x32x16_bf16 v[16:31], a[168:171], v[120:123], v[16:31]
    s_waitcnt vmcnt(24)
    v_mfma_f32_32x32x16_bf16 v[32:47], a[168:171], v[124:127], v[32:47]
    v_mfma_f32_32x32x16_bf16 v[48:63], a[172:175], v[120:123], v[48:63]
    v_mfma_f32_32x32x16_bf16 v[64:79], a[172:175], v[124:127], v[64:79]
    buffer_load_dwordx4 v[96:99], v5, s[40:43], s71 offen offset:2048 sc1
    buffer_load_dwordx4 v[100:103], v5, s[40:43], s72 offen offset:2048 sc1
    buffer_load_dwordx4 v[104:107], v5, s[40:43], s71 offen offset:3072 sc1
    buffer_load_dwordx4 v[108:111], v5, s[40:43], s72 offen offset:3072 sc1
    s_waitcnt vmcnt(27)
    v_mfma_f32_32x32x16_bf16 v[16:31], a[176:179], v[128:131], v[16:31]
    s_waitcnt vmcnt(26)
    v_mfma_f32_32x32x16_bf16 v[32:47], a[176:179], v[132:135], v[32:47]
    v_mfma_f32_32x32x16_bf16 v[48:63], a[180:183], v[128:131], v[48:63]
    v_mfma_f32_32x32x16_bf16 v[64:79], a[180:183], v[132:135], v[64:79]
    s_add_u32 s71, s71, 4096
    s_add_u32 s72, s72, 4096
    buffer_load_dwordx4 v[112:115], v5, s[40:43], s71 offen offset:0 sc1
    buffer_load_dwordx4 v[116:119], v5, s[40:43], s72 offen offset:0 sc1
    buffer_load_dwordx4 v[120:123], v5, s[40:43], s71 offen offset:1024 sc1
    buffer_load_dwordx4 v[124:127], v5, s[40:43], s72 offen offset:1024 sc1
    s_waitcnt vmcnt(29)
    v_mfma_f32_32x32x16_bf16 v[16:31], a[184:187], v[136:139], v[16:31]
    s_waitcnt vmcnt(28)
    v_mfma_f32_32x32x16_bf16 v[32:47], a[184:187], v[140:143], v[32:47]
    v_mfma_f32_32x32x16_bf16 v[48:63], a[188:191], v[136:139], v[48:63]
    v_mfma_f32_32x32x16_bf16 v[64:79], a[188:191], v[140:143], v[64:79]
    buffer_load_dwordx4 v[128:131], v5, s[40:43], s71 offen offset:2048 sc1
    buffer_load_dwordx4 v[132:135], v5, s[40:43], s72 offen offset:2048 sc1
    buffer_load_dwordx4 v[136:139], v5, s[40:43], s71 offen offset:3072 sc1
    buffer_load_dwordx4 v[140:143], v5, s[40:43], s72 offen offset:3072 sc1
    s_waitcnt vmcnt(31)
    v_mfma_f32_32x32x16_bf16 v[16:31], a[192:195], v[144:147], v[16:31]
    s_waitcnt vmcnt(30)
    v_mfma_f32_32x32x16_bf16 v[32:47], a[192:195], v[148:151], v[32:47]
    v_mfma_f32_32x32x16_bf16 v[48:63], a[196:199], v[144:147], v[48:63]
    v_mfma_f32_32x32x16_bf16 v[64:79], a[196:199], v[148:151], v[64:79]
    s_add_u32 s71, s71, 4096
    s_add_u32 s72, s72, 4096
    buffer_load_dwordx4 v[144:147], v5, s[40:43], s71 offen offset:0 sc1
    buffer_load_dwordx4 v[148:151], v5, s[40:43], s72 offen offset:0 sc1
    s_waitcnt vmcnt(31)
    v_mfma_f32_32x32x16_bf16 v[16:31], a[200:203], v[152:155], v[16:31]
    s_waitcnt vmcnt(30)
    v_mfma_f32_32x32x16_bf16 v[32:47], a[200:203], v[156:159], v[32:47]
    v_mfma_f32_32x32x16_bf16 v[48:63], a[204:207], v[152:155], v[48:63]
    v_mfma_f32_32x32x16_bf16 v[64:79], a[204:207], v[156:159], v[64:79]
    buffer_load_dwordx4 v[152:155], v5, s[40:43], s71 offen offset:1024 sc1
    buffer_load_dwordx4 v[156:159], v5, s[40:43], s72 offen offset:1024 sc1
    s_waitcnt vmcnt(31)
    v_mfma_f32_32x32x16_bf16 v[16:31], a[208:211], v[160:163], v[16:31]
    s_waitcnt vmcnt(30)
    v_mfma_f32_32x32x16_bf16 v[32:47], a[208:211], v[164:167], v[32:47]
    v_mfma_f32_32x32x16_bf16 v[48:63], a[212:215], v[160:163], v[48:63]
    v_mfma_f32_32x32x16_bf16 v[64:79], a[212:215], v[164:167], v[64:79]
    buffer_load_dwordx4 v[160:163], v5, s[40:43], s71 offen offset:2048 sc1
    buffer_load_dwordx4 v[164:167], v5, s[40:43], s72 offen offset:2048 sc1
    s_waitcnt vmcnt(31)
    v_mfma_f32_32x32x16_bf16 v[16:31], a[216:219], v[168:171], v[16:31]
    s_waitcnt vmcnt(30)
    v_mfma_f32_32x32x16_bf16 v[32:47], a[216:219], v[172:175], v[32:47]
    v_mfma_f32_32x32x16_bf16 v[48:63], a[220:223], v[168:171], v[48:63]
    v_mfma_f32_32x32x16_bf16 v[64:79], a[220:223], v[172:175], v[64:79]
    buffer_load_dwordx4 v[168:171], v5, s[40:43], s71 offen offset:3072 sc1
    buffer_load_dwordx4 v[172:175], v5, s[40:43], s72 offen offset:3072 sc1
    s_waitcnt vmcnt(31)
    v_mfma_f32_32x32x16_bf16 v[16:31], a[224:227], v[176:179], v[16:31]
    s_waitcnt vmcnt(30)
    v_mfma_f32_32x32x16_bf16 v[32:47], a[224:227], v[180:183], v[32:47]
    v_mfma_f32_32x32x16_bf16 v[48:63], a[228:231], v[176:179], v[48:63]
    v_mfma_f32_32x32x16_bf16 v[64:79], a[228:231], v[180:183], v[64:79]
    s_add_u32 s71, s71, 4096
    s_add_u32 s72, s72, 4096
    buffer_load_dwordx4 v[176:179], v5, s[40:43], s71 offen offset:0 sc1
    buffer_load_dwordx4 v[180:183], v5, s[40:43], s72 offen offset:0 sc1
    s_waitcnt vmcnt(31)
    v_mfma_f32_32x32x16_bf16 v[16:31], a[232:235], v[184:187], v[16:31]
    s_waitcnt vmcnt(30)
    v_mfma_f32_32x32x16_bf16 v[32:47], a[232:235], v[188:191], v[32:47]
    v_mfma_f32_32x32x16_bf16 v[48:63], a[236:239], v[184:187], v[48:63]
    v_mfma_f32_32x32x16_bf16 v[64:79], a[236:239], v[188:191], v[64:79]
    buffer_load_dwordx4 v[184:187], v5, s[40:43], s71 offen offset:1024 sc1
    buffer_load_dwordx4 v[188:191], v5, s[40:43], s72 offen offset:1024 sc1
    s_waitcnt vmcnt(31)
    v_mfma_f32_32x32x16_bf16 v[16:31], a[240:243], v[192:195], v[16:31]
    s_waitcnt vmcnt(30)
    v_mfma_f32_32x32x16_bf16 v[32:47], a[240:243], v[196:199], v[32:47]
    v_mfma_f32_32x32x16_bf16 v[48:63], a[244:247], v[192:195], v[48:63]
    v_mfma_f32_32x32x16_bf16 v[64:79], a[244:247], v[196:199], v[64:79]
    buffer_load_dwordx4 v[192:195], v5, s[40:43], s71 offen offset:2048 sc1
    buffer_load_dwordx4 v[196:199], v5, s[40:43], s72 offen offset:2048 sc1
    s_waitcnt vmcnt(31)
    v_mfma_f32_32x32x16_bf16 v[16:31], a[248:251], v[200:203], v[16:31]
    s_waitcnt vmcnt(30)
    v_mfma_f32_32x32x16_bf16 v[32:47], a[248:251], v[204:207], v[32:47]
    v_mfma_f32_32x32x16_bf16 v[48:63], a[252:255], v[200:203], v[48:63]
    v_mfma_f32_32x32x16_bf16 v[64:79], a[252:255], v[204:207], v[64:79]
    buffer_load_dwordx4 v[200:203], v5, s[40:43], s71 offen offset:3072 sc1
    buffer_load_dwordx4 v[204:207], v5, s[40:43], s72 offen offset:3072 sc1
    s_waitcnt vmcnt(31)
    v_mfma_f32_32x32x16_bf16 v[16:31], a[0:3], v[80:83], v[16:31]
    s_waitcnt vmcnt(30)
    v_mfma_f32_32x32x16_bf16 v[32:47], a[0:3], v[84:87], v[32:47]
    v_mfma_f32_32x32x16_bf16 v[48:63], a[4:7], v[80:83], v[48:63]
    v_mfma_f32_32x32x16_bf16 v[64:79], a[4:7], v[84:87], v[64:79]
    s_waitcnt lgkmcnt(15)
    s_add_u32 m0, s70, 0
    s_mov_b32 s73, 0
    buffer_load_dwordx4 v214, s[24:27], s73 offen lds
    s_add_u32 m0, s70, 1024
    s_mov_b32 s73, 32768
    buffer_load_dwordx4 v214, s[24:27], s73 offen lds
    s_waitcnt vmcnt(31)
    v_mfma_f32_32x32x16_bf16 v[16:31], a[8:11], v[88:91], v[16:31]
    s_waitcnt vmcnt(30)
    v_mfma_f32_32x32x16_bf16 v[32:47], a[8:11], v[92:95], v[32:47]
    v_mfma_f32_32x32x16_bf16 v[48:63], a[12:15], v[88:91], v[48:63]
    v_mfma_f32_32x32x16_bf16 v[64:79], a[12:15], v[92:95], v[64:79]
    s_add_u32 m0, s70, 2048
    s_mov_b32 s73, 65536
    buffer_load_dwordx4 v214, s[24:27], s73 offen lds
    s_add_u32 m0, s70, 3072
    s_mov_b32 s73, 98304
    buffer_load_dwordx4 v214, s[24:27], s73 offen lds
    s_waitcnt vmcnt(31)
    v_mfma_f32_32x32x16_bf16 v[16:31], a[16:19], v[96:99], v[16:31]
    s_waitcnt vmcnt(30)
    v_mfma_f32_32x32x16_bf16 v[32:47], a[16:19], v[100:103], v[32:47]
    v_mfma_f32_32x32x16_bf16 v[48:63], a[20:23], v[96:99], v[48:63]
    v_mfma_f32_32x32x16_bf16 v[64:79], a[20:23], v[100:103], v[64:79]
    s_waitcnt lgkmcnt(12)
    s_add_u32 m0, s70, 4096
    s_mov_b32 s73, 131072
    buffer_load_dwordx4 v214, s[24:27], s73 offen lds
    s_add_u32 m0, s70, 5120
    s_mov_b32 s73, 163840
    buffer_load_dwordx4 v214, s[24:27], s73 offen lds
    s_waitcnt vmcnt(31)
    v_mfma_f32_32x32x16_bf16 v[16:31], a[24:27], v[104:107], v[16:31]
    s_waitcnt vmcnt(30)
    v_mfma_f32_32x32x16_bf16 v[32:47], a[24:27], v[108:111], v[32:47]
    v_mfma_f32_32x32x16_bf16 v[48:63], a[28:31], v[104:107], v[48:63]
    v_mfma_f32_32x32x16_bf16 v[64:79], a[28:31], v[108:111], v[64:79]
    s_waitcnt lgkmcnt(8)
    s_add_u32 m0, s70, 6144
    s_mov_b32 s73, 196608
    buffer_load_dwordx4 v214, s[24:27], s73 offen lds
    s_add_u32 m0, s70, 7168
    s_mov_b32 s73, 229376
    buffer_load_dwordx4 v214, s[24:27], s73 offen lds
    s_waitcnt vmcnt(31)
    v_mfma_f32_32x32x16_bf16 v[16:31], a[32:35], v[112:115], v[16:31]
    s_waitcnt vmcnt(30)
    v_mfma_f32_32x32x16_bf16 v[32:47], a[32:35], v[116:119], v[32:47]
    v_mfma_f32_32x32x16_bf16 v[48:63], a[36:39], v[112:115], v[48:63]
    v_mfma_f32_32x32x16_bf16 v[64:79], a[36:39], v[116:119], v[64:79]
    s_waitcnt lgkmcnt(4)
    s_add_u32 m0, s70, 8192
    s_mov_b32 s73, 262144
    buffer_load_dwordx4 v214, s[24:27], s73 offen lds
    s_add_u32 m0, s70, 9216
    s_mov_b32 s73, 294912
    buffer_load_dwordx4 v214, s[24:27], s73 offen lds
    s_waitcnt vmcnt(31)
    v_mfma_f32_32x32x16_bf16 v[16:31], a[40:43], v[120:123], v[16:31]
    s_waitcnt vmcnt(30)
    v_mfma_f32_32x32x16_bf16 v[32:47], a[40:43], v[124:127], v[32:47]
    v_mfma_f32_32x32x16_bf16 v[48:63], a[44:47], v[120:123], v[48:63]
    v_mfma_f32_32x32x16_bf16 v[64:79], a[44:47], v[124:127], v[64:79]
    s_waitcnt lgkmcnt(0)
    s_add_u32 m0, s70, 10240
    s_mov_b32 s73, 327680
    buffer_load_dwordx4 v214, s[24:27], s73 offen lds
    s_add_u32 m0, s70, 11264
    s_mov_b32 s73, 360448
    buffer_load_dwordx4 v214, s[24:27], s73 offen lds
    s_waitcnt vmcnt(31)
    v_mfma_f32_32x32x16_bf16 v[16:31], a[48:51], v[128:131], v[16:31]
    s_waitcnt vmcnt(30)
    v_mfma_f32_32x32x16_bf16 v[32:47], a[48:51], v[132:135], v[32:47]
    v_mfma_f32_32x32x16_bf16 v[48:63], a[52:55], v[128:131], v[48:63]
    v_mfma_f32_32x32x16_bf16 v[64:79], a[52:55], v[132:135], v[64:79]
    s_add_u32 m0, s70, 12288
    s_mov_b32 s73, 393216
    buffer_load_dwordx4 v214, s[24:27], s73 offen lds
    s_add_u32 m0, s70, 13312
    s_mov_b32 s73, 425984
    buffer_load_dwordx4 v214, s[24:27], s73 offen lds
    s_waitcnt vmcnt(31)
    v_mfma_f32_32x32x16_bf16 v[16:31], a[56:59], v[136:139], v[16:31]
    s_waitcnt vmcnt(30)
    v_mfma_f32_32x32x16_bf16 v[32:47], a[56:59], v[140:143], v[32:47]
    v_mfma_f32_32x32x16_bf16 v[48:63], a[60:63], v[136:139], v[48:63]
    v_mfma_f32_32x32x16_bf16 v[64:79], a[60:63], v[140:143], v[64:79]
    s_add_u32 m0, s70, 14336
    s_mov_b32 s73, 458752
    buffer_load_dwordx4 v214, s[24:27], s73 offen lds
    s_add_u32 m0, s70, 15360
    s_mov_b32 s73, 491520
    buffer_load_dwordx4 v214, s[24:27], s73 offen lds
    s_waitcnt vmcnt(31)
    v_mfma_f32_32x32x16_bf16 v[16:31], a[64:67], v[144:147], v[16:31]
    s_waitcnt vmcnt(30)
    v_mfma_f32_32x32x16_bf16 v[32:47], a[64:67], v[148:151], v[32:47]
    v_mfma_f32_32x32x16_bf16 v[48:63], a[68:71], v[144:147], v[48:63]
    v_mfma_f32_32x32x16_bf16 v[64:79], a[68:71], v[148:151], v[64:79]
    s_add_u32 m0, s70, 16384
    s_mov_b32 s73, 524288
    buffer_load_dwordx4 v214, s[24:27], s73 offen lds
    s_add_u32 m0, s70, 17408
    s_mov_b32 s73, 557056
    buffer_load_dwordx4 v214, s[24:27], s73 offen lds
    s_waitcnt vmcnt(31)
    v_mfma_f32_32x32x16_bf16 v[16:31], a[72:75], v[152:155], v[16:31]
    s_waitcnt vmcnt(30)
    v_mfma_f32_32x32x16_bf16 v[32:47], a[72:75], v[156:159], v[32:47]
    v_mfma_f32_32x32x16_bf16 v[48:63], a[76:79], v[152:155], v[48:63]
    v_mfma_f32_32x32x16_bf16 v[64:79], a[76:79], v[156:159], v[64:79]
    s_add_u32 m0, s70, 18432
    s_mov_b32 s73, 589824
    buffer_load_dwordx4 v214, s[24:27], s73 offen lds
    s_add_u32 m0, s70, 19456
    s_mov_b32 s73, 622592
    buffer_load_dwordx4 v214, s[24:27], s73 offen lds
    s_waitcnt vmcnt(31)
    v_mfma_f32_32x32x16_bf16 v[16:31], a[80:83], v[160:163], v[16:31]
    s_waitcnt vmcnt(30)
    v_mfma_f32_32x32x16_bf16 v[32:47], a[80:83], v[164:167], v[32:47]
    v_mfma_f32_32x32x16_bf16 v[48:63], a[84:87], v[160:163], v[48:63]
    v_mfma_f32_32x32x16_bf16 v[64:79], a[84:87], v[164:167], v[64:79]
    s_waitcnt vmcnt(29)
    v_mfma_f32_32x32x16_bf16 v[16:31], a[88:91], v[168:171], v[16:31]
    s_waitcnt vmcnt(28)
    v_mfma_f32_32x32x16_bf16 v[32:47], a[88:91], v[172:175], v[32:47]
    v_mfma_f32_32x32x16_bf16 v[48:63], a[92:95], v[168:171], v[48:63]
    v_mfma_f32_32x32x16_bf16 v[64:79], a[92:95], v[172:175], v[64:79]
    s_waitcnt vmcnt(27)
    v_mfma_f32_32x32x16_bf16 v[16:31], a[96:99], v[176:179], v[16:31]
    s_waitcnt vmcnt(26)
    v_mfma_f32_32x32x16_bf16 v[32:47], a[96:99], v[180:183], v[32:47]
    v_mfma_f32_32x32x16_bf16 v[48:63], a[100:103], v[176:179], v[48:63]
    v_mfma_f32_32x32x16_bf16 v[64:79], a[100:103], v[180:183], v[64:79]
    s_waitcnt vmcnt(25)
    v_mfma_f32_32x32x16_bf16 v[16:31], a[104:107], v[184:187], v[16:31]
    s_waitcnt vmcnt(24)
    v_mfma_f32_32x32x16_bf16 v[32:47], a[104:107], v[188:191], v[32:47]
    v_mfma_f32_32x32x16_bf16 v[48:63], a[108:111], v[184:187], v[48:63]
    v_mfma_f32_32x32x16_bf16 v[64:79], a[108:111], v[188:191], v[64:79]
    s_waitcnt vmcnt(23)
    v_mfma_f32_32x32x16_bf16 v[16:31], a[112:115], v[192:195], v[16:31]
    s_waitcnt vmcnt(22)
    v_mfma_f32_32x32x16_bf16 v[32:47], a[112:115], v[196:199], v[32:47]
    v_mfma_f32_32x32x16_bf16 v[48:63], a[116:119], v[192:195], v[48:63]
    v_mfma_f32_32x32x16_bf16 v[64:79], a[116:119], v[196:199], v[64:79]
    s_waitcnt vmcnt(21)
    v_mfma_f32_32x32x16_bf16 v[16:31], a[120:123], v[200:203], v[16:31]
    s_waitcnt vmcnt(20)
    v_mfma_f32_32x32x16_bf16 v[32:47], a[120:123], v[204:207], v[32:47]
    v_mfma_f32_32x32x16_bf16 v[48:63], a[124:127], v[200:203], v[48:63]
    v_mfma_f32_32x32x16_bf16 v[64:79], a[124:127], v[204:207], v[64:79]
    s_xor_b32 s68, s3, 1
    s_mul_i32 s68, s68, 12288
    s_add_u32 s68, s68, 12288
    v_add_u32 v221, s68, v4
    s_xor_b32 s68, s3, 2
    s_mul_i32 s68, s68, 12288
    s_add_u32 s68, s68, 16384
    v_add_u32 v222, s68, v4
    s_xor_b32 s68, s3, 3
    s_mul_i32 s68, s68, 12288
    s_add_u32 s68, s68, 20480
    v_add_u32 v223, s68, v4
    ds_write_b128 v221, v[32:35] offset:0
    ds_write_b128 v221, v[36:39] offset:1024
    ds_write_b128 v221, v[40:43] offset:2048
    ds_write_b128 v221, v[44:47] offset:3072
    ds_write_b128 v222, v[48:51] offset:0
    ds_write_b128 v222, v[52:55] offset:1024
    ds_write_b128 v222, v[56:59] offset:2048
    ds_write_b128 v222, v[60:63] offset:3072
    ds_write_b128 v223, v[64:67] offset:0
    ds_write_b128 v223, v[68:71] offset:1024
    ds_write_b128 v223, v[72:75] offset:2048
    ds_write_b128 v223, v[76:79] offset:3072
    s_mul_i32 s68, s3, 12288
    s_add_u32 s68, s68, 12288
    v_add_u32 v220, s68, v4
    s_lshl_b32 s68, s64, 1
    s_and_b32 s69, s3, 1
    s_add_u32 s68, s68, s69
    s_mul_i32 s68, s68, 112
    s_lshl_b32 s69, s65, 2
    s_add_u32 s68, s68, s69
    s_and_b32 s69, s3, 2
    s_add_u32 s68, s68, s69
    s_lshl_b32 s68, s68, 10
    s_add_u32 s68, s68, 0x3c0000
    s_waitcnt lgkmcnt(0)
    s_barrier
    ds_read_b128 v[32:35], v220 offset:0
    ds_read_b128 v[48:51], v220 offset:4096
    ds_read_b128 v[64:67], v220 offset:8192
    ds_read_b128 v[36:39], v220 offset:1024
    ds_read_b128 v[52:55], v220 offset:5120
    ds_read_b128 v[68:71], v220 offset:9216
    ds_read_b128 v[40:43], v220 offset:2048
    ds_read_b128 v[56:59], v220 offset:6144
    ds_read_b128 v[72:75], v220 offset:10240
    ds_read_b128 v[44:47], v220 offset:3072
    ds_read_b128 v[60:63], v220 offset:7168
    ds_read_b128 v[76:79], v220 offset:11264
    s_mov_b32 s88, 0xc0135761
    s_mov_b32 s90, 0xbdd2d3e8
    v_mov_b32 v224, s88
    v_mov_b32 v225, s88
    s_waitcnt lgkmcnt(10)
    v_pk_add_f32 v[32:33], v[32:33], v[48:49]
    s_waitcnt lgkmcnt(9)
    v_pk_add_f32 v[16:17], v[16:17], v[64:65]
    v_pk_add_f32 v[34:35], v[34:35], v[50:51]
    v_pk_add_f32 v[18:19], v[18:19], v[66:67]
    s_waitcnt lgkmcnt(7)
    v_pk_add_f32 v[36:37], v[36:37], v[52:53]
    s_waitcnt lgkmcnt(6)
    v_pk_add_f32 v[20:21], v[20:21], v[68:69]
    v_pk_add_f32 v[38:39], v[38:39], v[54:55]
    v_pk_add_f32 v[22:23], v[22:23], v[70:71]
    v_pk_add_f32 v[16:17], v[16:17], v[32:33]
    v_pk_add_f32 v[18:19], v[18:19], v[34:35]
    v_pk_add_f32 v[20:21], v[20:21], v[36:37]
    v_pk_add_f32 v[22:23], v[22:23], v[38:39]
    v_pk_mul_f32 v[80:81], v[16:17], v[16:17]
    v_pk_mul_f32 v[82:83], v[18:19], v[18:19]
    v_pk_mul_f32 v[84:85], v[20:21], v[20:21]
    v_pk_mul_f32 v[86:87], v[22:23], v[22:23]
    v_pk_fma_f32 v[80:81], v[80:81], s[90:91], v[224:225] op_sel_hi:[1,0,1]
    v_pk_fma_f32 v[82:83], v[82:83], s[90:91], v[224:225] op_sel_hi:[1,0,1]
    v_pk_fma_f32 v[84:85], v[84:85], s[90:91], v[224:225] op_sel_hi:[1,0,1]
    v_pk_fma_f32 v[86:87], v[86:87], s[90:91], v[224:225] op_sel_hi:[1,0,1]
    v_pk_mul_f32 v[80:81], v[80:81], v[16:17]
    v_pk_mul_f32 v[82:83], v[82:83], v[18:19]
    v_pk_mul_f32 v[84:85], v[84:85], v[20:21]
    v_pk_mul_f32 v[86:87], v[86:87], v[22:23]
    v_exp_f32 v80, v80
    v_exp_f32 v81, v81
    v_exp_f32 v82, v82
    v_exp_f32 v83, v83
    v_exp_f32 v84, v84
    v_exp_f32 v85, v85
    v_exp_f32 v86, v86
    v_exp_f32 v87, v87
    v_pk_add_f32 v[80:81], v[80:81], 1.0 op_sel_hi:[1,0]
    v_pk_add_f32 v[82:83], v[82:83], 1.0 op_sel_hi:[1,0]
    v_pk_add_f32 v[84:85], v[84:85], 1.0 op_sel_hi:[1,0]
    v_pk_add_f32 v[86:87], v[86:87], 1.0 op_sel_hi:[1,0]
    v_rcp_f32 v80, v80
    v_rcp_f32 v81, v81
    v_rcp_f32 v82, v82
    v_rcp_f32 v83, v83
    v_rcp_f32 v84, v84
    v_rcp_f32 v85, v85
    v_rcp_f32 v86, v86
    v_rcp_f32 v87, v87
    v_pk_mul_f32 v[80:81], v[80:81], v[16:17]
    v_pk_mul_f32 v[82:83], v[82:83], v[18:19]
    v_pk_mul_f32 v[84:85], v[84:85], v[20:21]
    v_pk_mul_f32 v[86:87], v[86:87], v[22:23]
    v_cvt_pk_bf16_f32 v96, v80, v81
    v_cvt_pk_bf16_f32 v97, v82, v83
    v_cvt_pk_bf16_f32 v98, v84, v85
    v_cvt_pk_bf16_f32 v99, v86, v87
    buffer_store_dwordx4 v[96:99], v5, s[40:43], s68 offen offset:0 sc1
    s_waitcnt lgkmcnt(4)
    v_pk_add_f32 v[40:41], v[40:41], v[56:57]
    s_waitcnt lgkmcnt(3)
    v_pk_add_f32 v[24:25], v[24:25], v[72:73]
    v_pk_add_f32 v[42:43], v[42:43], v[58:59]
    v_pk_add_f32 v[26:27], v[26:27], v[74:75]
    s_waitcnt lgkmcnt(1)
    v_pk_add_f32 v[44:45], v[44:45], v[60:61]
    s_waitcnt lgkmcnt(0)
    v_pk_add_f32 v[28:29], v[28:29], v[76:77]
    v_pk_add_f32 v[46:47], v[46:47], v[62:63]
    v_pk_add_f32 v[30:31], v[30:31], v[78:79]
    v_pk_add_f32 v[24:25], v[24:25], v[40:41]
    v_pk_add_f32 v[26:27], v[26:27], v[42:43]
    v_pk_add_f32 v[28:29], v[28:29], v[44:45]
    v_pk_add_f32 v[30:31], v[30:31], v[46:47]
    v_pk_mul_f32 v[88:89], v[24:25], v[24:25]
    v_pk_mul_f32 v[90:91], v[26:27], v[26:27]
    v_pk_mul_f32 v[92:93], v[28:29], v[28:29]
    v_pk_mul_f32 v[94:95], v[30:31], v[30:31]
    v_pk_fma_f32 v[88:89], v[88:89], s[90:91], v[224:225] op_sel_hi:[1,0,1]
    v_pk_fma_f32 v[90:91], v[90:91], s[90:91], v[224:225] op_sel_hi:[1,0,1]
    v_pk_fma_f32 v[92:93], v[92:93], s[90:91], v[224:225] op_sel_hi:[1,0,1]
    v_pk_fma_f32 v[94:95], v[94:95], s[90:91], v[224:225] op_sel_hi:[1,0,1]
    v_pk_mul_f32 v[88:89], v[88:89], v[24:25]
    v_pk_mul_f32 v[90:91], v[90:91], v[26:27]
    v_pk_mul_f32 v[92:93], v[92:93], v[28:29]
    v_pk_mul_f32 v[94:95], v[94:95], v[30:31]
    v_exp_f32 v88, v88
    v_exp_f32 v89, v89
    v_exp_f32 v90, v90
    v_exp_f32 v91, v91
    v_exp_f32 v92, v92
    v_exp_f32 v93, v93
    v_exp_f32 v94, v94
    v_exp_f32 v95, v95
    v_pk_add_f32 v[88:89], v[88:89], 1.0 op_sel_hi:[1,0]
    v_pk_add_f32 v[90:91], v[90:91], 1.0 op_sel_hi:[1,0]
    v_pk_add_f32 v[92:93], v[92:93], 1.0 op_sel_hi:[1,0]
    v_pk_add_f32 v[94:95], v[94:95], 1.0 op_sel_hi:[1,0]
    v_rcp_f32 v88, v88
    v_rcp_f32 v89, v89
    v_rcp_f32 v90, v90
    v_rcp_f32 v91, v91
    v_rcp_f32 v92, v92
    v_rcp_f32 v93, v93
    v_rcp_f32 v94, v94
    v_rcp_f32 v95, v95
    v_pk_mul_f32 v[88:89], v[88:89], v[24:25]
    v_pk_mul_f32 v[90:91], v[90:91], v[26:27]
    v_pk_mul_f32 v[92:93], v[92:93], v[28:29]
    v_pk_mul_f32 v[94:95], v[94:95], v[30:31]
    v_cvt_pk_bf16_f32 v100, v88, v89
    v_cvt_pk_bf16_f32 v101, v90, v91
    v_cvt_pk_bf16_f32 v102, v92, v93
    v_cvt_pk_bf16_f32 v103, v94, v95
    buffer_store_dwordx4 v[100:103], v5, s[40:43], s68 offen offset:1024 sc1
    v_mov_b32 v9, v5
    s_waitcnt vmcnt(20)
    ds_read_b64_tr_b16 a[128:129], v217 offset:0
    ds_read_b64_tr_b16 a[130:131], v217 offset:1024
    ds_read_b64_tr_b16 a[132:133], v218 offset:0
    ds_read_b64_tr_b16 a[134:135], v218 offset:1024
    s_waitcnt vmcnt(18)
    ds_read_b64_tr_b16 a[136:137], v217 offset:2048
    ds_read_b64_tr_b16 a[138:139], v217 offset:3072
    ds_read_b64_tr_b16 a[140:141], v218 offset:2048
    ds_read_b64_tr_b16 a[142:143], v218 offset:3072
    s_waitcnt vmcnt(16)
    ds_read_b64_tr_b16 a[144:145], v217 offset:4096
    ds_read_b64_tr_b16 a[146:147], v217 offset:5120
    ds_read_b64_tr_b16 a[148:149], v218 offset:4096
    ds_read_b64_tr_b16 a[150:151], v218 offset:5120
    s_waitcnt vmcnt(14)
    ds_read_b64_tr_b16 a[152:153], v217 offset:6144
    ds_read_b64_tr_b16 a[154:155], v217 offset:7168
    ds_read_b64_tr_b16 a[156:157], v218 offset:6144
    ds_read_b64_tr_b16 a[158:159], v218 offset:7168
    s_waitcnt vmcnt(12)
    ds_read_b64_tr_b16 a[160:161], v217 offset:8192
    ds_read_b64_tr_b16 a[162:163], v217 offset:9216
    ds_read_b64_tr_b16 a[164:165], v218 offset:8192
    ds_read_b64_tr_b16 a[166:167], v218 offset:9216
    s_waitcnt vmcnt(10)
    ds_read_b64_tr_b16 a[168:169], v217 offset:10240
    ds_read_b64_tr_b16 a[170:171], v217 offset:11264
    ds_read_b64_tr_b16 a[172:173], v218 offset:10240
    ds_read_b64_tr_b16 a[174:175], v218 offset:11264
    s_waitcnt vmcnt(8)
    ds_read_b64_tr_b16 a[176:177], v217 offset:12288
    ds_read_b64_tr_b16 a[178:179], v217 offset:13312
    ds_read_b64_tr_b16 a[180:181], v218 offset:12288
    ds_read_b64_tr_b16 a[182:183], v218 offset:13312
    s_waitcnt vmcnt(6)
    ds_read_b64_tr_b16 a[184:185], v217 offset:14336
    ds_read_b64_tr_b16 a[186:187], v217 offset:15360
    ds_read_b64_tr_b16 a[188:189], v218 offset:14336
    ds_read_b64_tr_b16 a[190:191], v218 offset:15360
    s_waitcnt vmcnt(4)
    ds_read_b64_tr_b16 a[192:193], v217 offset:16384
    ds_read_b64_tr_b16 a[194:195], v217 offset:17408
    ds_read_b64_tr_b16 a[196:197], v218 offset:16384
    ds_read_b64_tr_b16 a[198:199], v218 offset:17408
    s_waitcnt vmcnt(2)
    ds_read_b64_tr_b16 a[200:201], v217 offset:18432
    ds_read_b64_tr_b16 a[202:203], v217 offset:19456
    ds_read_b64_tr_b16 a[204:205], v218 offset:18432
    ds_read_b64_tr_b16 a[206:207], v218 offset:19456
    s_waitcnt vmcnt(0)
    v_mov_b32 v8, s4
    s_mov_b64 exec, 1
    buffer_store_dword v8, v9, s[40:43], s82 offen sc1
    s_mov_b64 exec, -1
    v_lshrrev_b32 v220, 5, v1
    v_lshlrev_b32 v220, 3, v220
    s_lshl_b32 s68, s67, 7
    s_lshr_b32 s69, s3, 1
    s_lshl_b32 s69, s69, 6
    s_add_u32 s68, s68, s69
    buffer_load_dwordx2 v[222:223], v220, s[32:35], s68 offen offset:0
    buffer_load_dwordx2 v[224:225], v220, s[32:35], s68 offen offset:16
    buffer_load_dwordx2 v[226:227], v220, s[32:35], s68 offen offset:32
    buffer_load_dwordx2 v[228:229], v220, s[32:35], s68 offen offset:48
    s_waitcnt lgkmcnt(15)
    s_add_u32 m0, s70, 0
    s_mov_b32 s73, 655360
    buffer_load_dwordx4 v214, s[24:27], s73 offen lds
    s_add_u32 m0, s70, 1024
    s_mov_b32 s73, 688128
    buffer_load_dwordx4 v214, s[24:27], s73 offen lds
    s_add_u32 m0, s70, 2048
    s_mov_b32 s73, 720896
    buffer_load_dwordx4 v214, s[24:27], s73 offen lds
    s_add_u32 m0, s70, 3072
    s_mov_b32 s73, 753664
    buffer_load_dwordx4 v214, s[24:27], s73 offen lds
    s_add_u32 m0, s70, 4096
    s_mov_b32 s73, 786432
    buffer_load_dwordx4 v214, s[24:27], s73 offen lds
    s_add_u32 m0, s70, 5120
    s_mov_b32 s73, 819200
    buffer_load_dwordx4 v214, s[24:27], s73 offen lds
    s_add_u32 m0, s70, 6144
    s_mov_b32 s73, 851968
    buffer_load_dwordx4 v214, s[24:27], s73 offen lds
    s_add_u32 m0, s70, 7168
    s_mov_b32 s73, 884736
    buffer_load_dwordx4 v214, s[24:27], s73 offen lds
    s_add_u32 m0, s70, 8192
    s_mov_b32 s73, 917504
    buffer_load_dwordx4 v214, s[24:27], s73 offen lds
    s_add_u32 m0, s70, 9216
    s_mov_b32 s73, 950272
    buffer_load_dwordx4 v214, s[24:27], s73 offen lds
    s_add_u32 m0, s70, 10240
    s_mov_b32 s73, 983040
    buffer_load_dwordx4 v214, s[24:27], s73 offen lds
    s_add_u32 m0, s70, 11264
    s_mov_b32 s73, 1015808
    buffer_load_dwordx4 v214, s[24:27], s73 offen lds
    s_waitcnt lgkmcnt(12)
    s_add_u32 m0, s70, 12288
    s_mov_b32 s73, 1048576
    buffer_load_dwordx4 v214, s[24:27], s73 offen lds
    s_add_u32 m0, s70, 13312
    s_mov_b32 s73, 1081344
    buffer_load_dwordx4 v214, s[24:27], s73 offen lds
    s_waitcnt lgkmcnt(8)
    s_add_u32 m0, s70, 14336
    s_mov_b32 s73, 1114112
    buffer_load_dwordx4 v214, s[24:27], s73 offen lds
    s_add_u32 m0, s70, 15360
    s_mov_b32 s73, 1146880
    buffer_load_dwordx4 v214, s[24:27], s73 offen lds
    s_waitcnt lgkmcnt(4)
    s_add_u32 m0, s70, 16384
    s_mov_b32 s73, 1179648
    buffer_load_dwordx4 v214, s[24:27], s73 offen lds
    s_add_u32 m0, s70, 17408
    s_mov_b32 s73, 1212416
    buffer_load_dwordx4 v214, s[24:27], s73 offen lds
    s_waitcnt lgkmcnt(0)
    s_add_u32 m0, s70, 18432
    s_mov_b32 s73, 1245184
    buffer_load_dwordx4 v214, s[24:27], s73 offen lds
    s_add_u32 m0, s70, 19456
    s_mov_b32 s73, 1277952
    buffer_load_dwordx4 v214, s[24:27], s73 offen lds
    s_lshl_b32 s68, s66, 1
    s_and_b32 s69, s3, 1
    s_add_u32 s71, s68, s69
    s_xor_b32 s72, s71, 1
    s_mul_i32 s68, s3, 28672
    s_add_u32 s68, s68, 0x3c0000
    s_mul_i32 s71, s71, 114688
    s_add_u32 s71, s71, s68
    s_mul_i32 s72, s72, 114688
    s_add_u32 s72, s72, s68
    s_nop 1
Lpoll_P_7:
    s_sub_u32 s6, s6, 1
    s_cbranch_scc1 L_end_P
    buffer_load_dword v8, v12, s[40:43], s85 offen sc1
    s_waitcnt vmcnt(0)
    v_cmp_ne_u32 vcc, s4, v8
    s_nop 1
    s_cbranch_vccnz Lpoll_P_7
    buffer_load_dwordx4 v[80:83], v4, s[40:43], s71 offen offset:0 sc1
    buffer_load_dwordx4 v[84:87], v4, s[40:43], s72 offen offset:0 sc1
    buffer_load_dwordx4 v[88:91], v4, s[40:43], s71 offen offset:1024 sc1
    buffer_load_dwordx4 v[92:95], v4, s[40:43], s72 offen offset:1024 sc1
    buffer_load_dwordx4 v[96:99], v4, s[40:43], s71 offen offset:2048 sc1
    buffer_load_dwordx4 v[100:103], v4, s[40:43], s72 offen offset:2048 sc1
    buffer_load_dwordx4 v[104:107], v4, s[40:43], s71 offen offset:3072 sc1
    buffer_load_dwordx4 v[108:111], v4, s[40:43], s72 offen offset:3072 sc1
    s_add_u32 s71, s71, 4096
    s_add_u32 s72, s72, 4096
    buffer_load_dwordx4 v[112:115], v4, s[40:43], s71 offen offset:0 sc1
    buffer_load_dwordx4 v[116:119], v4, s[40:43], s72 offen offset:0 sc1
    buffer_load_dwordx4 v[120:123], v4, s[40:43], s71 offen offset:1024 sc1
    buffer_load_dwordx4 v[124:127], v4, s[40:43], s72 offen offset:1024 sc1
    v_lshlrev_b32 v16, 16, v222
    v_and_b32 v17, 0xffff0000, v222
    v_lshlrev_b32 v238, 16, v240
    v_and_b32 v239, 0xffff0000, v240
    v_pk_add_f32 v[16:17], v[16:17], v[238:239]
    v_lshlrev_b32 v18, 16, v223
    v_and_b32 v19, 0xffff0000, v223
    v_lshlrev_b32 v238, 16, v241
    v_and_b32 v239, 0xffff0000, v241
    v_pk_add_f32 v[18:19], v[18:19], v[238:239]
    v_lshlrev_b32 v20, 16, v224
    v_and_b32 v21, 0xffff0000, v224
    v_lshlrev_b32 v238, 16, v242
    v_and_b32 v239, 0xffff0000, v242
    v_pk_add_f32 v[20:21], v[20:21], v[238:239]
    v_lshlrev_b32 v22, 16, v225
    v_and_b32 v23, 0xffff0000, v225
    v_lshlrev_b32 v238, 16, v243
    v_and_b32 v239, 0xffff0000, v243
    v_pk_add_f32 v[22:23], v[22:23], v[238:239]
    v_lshlrev_b32 v24, 16, v226
    v_and_b32 v25, 0xffff0000, v226
    v_lshlrev_b32 v238, 16, v244
    v_and_b32 v239, 0xffff0000, v244
    v_pk_add_f32 v[24:25], v[24:25], v[238:239]
    v_lshlrev_b32 v26, 16, v227
    v_and_b32 v27, 0xffff0000, v227
    v_lshlrev_b32 v238, 16, v245
    v_and_b32 v239, 0xffff0000, v245
    v_pk_add_f32 v[26:27], v[26:27], v[238:239]
    v_lshlrev_b32 v28, 16, v228
    v_and_b32 v29, 0xffff0000, v228
    v_lshlrev_b32 v238, 16, v246
    v_and_b32 v239, 0xffff0000, v246
    v_pk_add_f32 v[28:29], v[28:29], v[238:239]
    v_lshlrev_b32 v30, 16, v229
    v_and_b32 v31, 0xffff0000, v229
    v_lshlrev_b32 v238, 16, v247
    v_and_b32 v239, 0xffff0000, v247
    v_pk_add_f32 v[30:31], v[30:31], v[238:239]
    buffer_load_dwordx4 v[128:131], v4, s[40:43], s71 offen offset:2048 sc1
    buffer_load_dwordx4 v[132:135], v4, s[40:43], s72 offen offset:2048 sc1
    buffer_load_dwordx4 v[136:139], v4, s[40:43], s71 offen offset:3072 sc1
    buffer_load_dwordx4 v[140:143], v4, s[40:43], s72 offen offset:3072 sc1
    s_waitcnt vmcnt(15)
    v_mfma_f32_32x32x16_bf16 v[16:31], a[128:131], v[80:83], v[16:31]
    s_waitcnt vmcnt(14)
    v_mfma_f32_32x32x16_bf16 v[32:47], a[128:131], v[84:87], 0
    v_mfma_f32_32x32x16_bf16 v[48:63], a[132:135], v[80:83], 0
    v_mfma_f32_32x32x16_bf16 v[64:79], a[132:135], v[84:87], 0
    ds_read_b64_tr_b16 a[208:209], v217 offset:0
    ds_read_b64_tr_b16 a[210:211], v217 offset:1024
    ds_read_b64_tr_b16 a[212:213], v218 offset:0
    ds_read_b64_tr_b16 a[214:215], v218 offset:1024
    ds_read_b64_tr_b16 a[216:217], v217 offset:2048
    ds_read_b64_tr_b16 a[218:219], v217 offset:3072
    ds_read_b64_tr_b16 a[220:221], v218 offset:2048
    ds_read_b64_tr_b16 a[222:223], v218 offset:3072
    s_add_u32 s71, s71, 4096
    s_add_u32 s72, s72, 4096
    buffer_load_dwordx4 v[144:147], v4, s[40:43], s71 offen offset:0 sc1
    buffer_load_dwordx4 v[148:151], v4, s[40:43], s72 offen offset:0 sc1
    buffer_load_dwordx4 v[152:155], v4, s[40:43], s71 offen offset:1024 sc1
    buffer_load_dwordx4 v[156:159], v4, s[40:43], s72 offen offset:1024 sc1
    s_waitcnt vmcnt(17)
    v_mfma_f32_32x32x16_bf16 v[16:31], a[136:139], v[88:91], v[16:31]
    s_waitcnt vmcnt(16)
    v_mfma_f32_32x32x16_bf16 v[32:47], a[136:139], v[92:95], v[32:47]
    v_mfma_f32_32x32x16_bf16 v[48:63], a[140:143], v[88:91], v[48:63]
    v_mfma_f32_32x32x16_bf16 v[64:79], a[140:143], v[92:95], v[64:79]
    ds_read_b64_tr_b16 a[224:225], v217 offset:4096
    ds_read_b64_tr_b16 a[226:227], v217 offset:5120
    ds_read_b64_tr_b16 a[228:229], v218 offset:4096
    ds_read_b64_tr_b16 a[230:231], v218 offset:5120
    ds_read_b64_tr_b16 a[232:233], v217 offset:6144
    ds_read_b64_tr_b16 a[234:235], v217 offset:7168
    ds_read_b64_tr_b16 a[236:237], v218 offset:6144
    ds_read_b64_tr_b16 a[238:239], v218 offset:7168
    buffer_load_dwordx4 v[160:163], v4, s[40:43], s71 offen offset:2048 sc1
    buffer_load_dwordx4 v[164:167], v4, s[40:43], s72 offen offset:2048 sc1
    buffer_load_dwordx4 v[168:171], v4, s[40:43], s71 offen offset:3072 sc1
    buffer_load_dwordx4 v[172:175], v4, s[40:43], s72 offen offset:3072 sc1
    s_waitcnt vmcnt(19)
    v_mfma_f32_32x32x16_bf16 v[16:31], a[144:147], v[96:99], v[16:31]
    s_waitcnt vmcnt(18)
    v_mfma_f32_32x32x16_bf16 v[32:47], a[144:147], v[100:103], v[32:47]
    v_mfma_f32_32x32x16_bf16 v[48:63], a[148:151], v[96:99], v[48:63]
    v_mfma_f32_32x32x16_bf16 v[64:79], a[148:151], v[100:103], v[64:79]
    ds_read_b64_tr_b16 a[240:241], v217 offset:8192
    ds_read_b64_tr_b16 a[242:243], v217 offset:9216
    ds_read_b64_tr_b16 a[244:245], v218 offset:8192
    ds_read_b64_tr_b16 a[246:247], v218 offset:9216
    ds_read_b64_tr_b16 a[248:249], v217 offset:10240
    ds_read_b64_tr_b16 a[250:251], v217 offset:11264
    ds_read_b64_tr_b16 a[252:253], v218 offset:10240
    ds_read_b64_tr_b16 a[254:255], v218 offset:11264
    s_add_u32 s71, s71, 4096
    s_add_u32 s72, s72, 4096
    buffer_load_dwordx4 v[176:179], v4, s[40:43], s71 offen offset:0 sc1
    buffer_load_dwordx4 v[180:183], v4, s[40:43], s72 offen offset:0 sc1
    buffer_load_dwordx4 v[184:187], v4, s[40:43], s71 offen offset:1024 sc1
    buffer_load_dwordx4 v[188:191], v4, s[40:43], s72 offen offset:1024 sc1
    s_waitcnt vmcnt(21)
    v_mfma_f32_32x32x16_bf16 v[16:31], a[152:155], v[104:107], v[16:31]
    s_waitcnt vmcnt(20)
    v_mfma_f32_32x32x16_bf16 v[32:47], a[152:155], v[108:111], v[32:47]
    v_mfma_f32_32x32x16_bf16 v[48:63], a[156:159], v[104:107], v[48:63]
    v_mfma_f32_32x32x16_bf16 v[64:79], a[156:159], v[108:111], v[64:79]
    ds_read_b64_tr_b16 a[0:1], v217 offset:12288
    ds_read_b64_tr_b16 a[2:3], v217 offset:13312
    ds_read_b64_tr_b16 a[4:5], v218 offset:12288
    ds_read_b64_tr_b16 a[6:7], v218 offset:13312
    ds_read_b64_tr_b16 a[8:9], v217 offset:14336
    ds_read_b64_tr_b16 a[10:11], v217 offset:15360
    ds_read_b64_tr_b16 a[12:13], v218 offset:14336
    ds_read_b64_tr_b16 a[14:15], v218 offset:15360
    buffer_load_dwordx4 v[192:195], v4, s[40:43], s71 offen offset:2048 sc1
    buffer_load_dwordx4 v[196:199], v4, s[40:43], s72 offen offset:2048 sc1
    buffer_load_dwordx4 v[200:203], v4, s[40:43], s71 offen offset:3072 sc1
    buffer_load_dwordx4 v[204:207], v4, s[40:43], s72 offen offset:3072 sc1
    s_waitcnt vmcnt(23)
    v_mfma_f32_32x32x16_bf16 v[16:31], a[160:163], v[112:115], v[16:31]
    s_waitcnt vmcnt(22)
    v_mfma_f32_32x32x16_bf16 v[32:47], a[160:163], v[116:119], v[32:47]
    v_mfma_f32_32x32x16_bf16 v[48:63], a[164:167], v[112:115], v[48:63]
    v_mfma_f32_32x32x16_bf16 v[64:79], a[164:167], v[116:119], v[64:79]
    ds_read_b64_tr_b16 a[16:17], v217 offset:16384
    ds_read_b64_tr_b16 a[18:19], v217 offset:17408
    ds_read_b64_tr_b16 a[20:21], v218 offset:16384
    ds_read_b64_tr_b16 a[22:23], v218 offset:17408
    ds_read_b64_tr_b16 a[24:25], v217 offset:18432
    ds_read_b64_tr_b16 a[26:27], v217 offset:19456
    ds_read_b64_tr_b16 a[28:29], v218 offset:18432
    ds_read_b64_tr_b16 a[30:31], v218 offset:19456
    s_add_u32 s71, s71, 4096
    s_add_u32 s72, s72, 4096
    buffer_load_dwordx4 v[80:83], v4, s[40:43], s71 offen offset:0 sc1
    buffer_load_dwordx4 v[84:87], v4, s[40:43], s72 offen offset:0 sc1
    buffer_load_dwordx4 v[88:91], v4, s[40:43], s71 offen offset:1024 sc1
    buffer_load_dwordx4 v[92:95], v4, s[40:43], s72 offen offset:1024 sc1
    s_waitcnt vmcnt(25)
    v_mfma_f32_32x32x16_bf16 v[16:31], a[168:171], v[120:123], v[16:31]
    s_waitcnt vmcnt(24)
    v_mfma_f32_32x32x16_bf16 v[32:47], a[168:171], v[124:127], v[32:47]
    v_mfma_f32_32x32x16_bf16 v[48:63], a[172:175], v[120:123], v[48:63]
    v_mfma_f32_32x32x16_bf16 v[64:79], a[172:175], v[124:127], v[64:79]
    buffer_load_dwordx4 v[96:99], v4, s[40:43], s71 offen offset:2048 sc1
    buffer_load_dwordx4 v[100:103], v4, s[40:43], s72 offen offset:2048 sc1
    buffer_load_dwordx4 v[104:107], v4, s[40:43], s71 offen offset:3072 sc1
    buffer_load_dwordx4 v[108:111], v4, s[40:43], s72 offen offset:3072 sc1
    s_waitcnt vmcnt(27)
    v_mfma_f32_32x32x16_bf16 v[16:31], a[176:179], v[128:131], v[16:31]
    s_waitcnt vmcnt(26)
    v_mfma_f32_32x32x16_bf16 v[32:47], a[176:179], v[132:135], v[32:47]
    v_mfma_f32_32x32x16_bf16 v[48:63], a[180:183], v[128:131], v[48:63]
    v_mfma_f32_32x32x16_bf16 v[64:79], a[180:183], v[132:135], v[64:79]
    s_waitcnt lgkmcnt(15)
    s_add_u32 m0, s70, 0
    s_mov_b32 s73, 1310720
    buffer_load_dwordx4 v214, s[24:27], s73 offen lds
    s_add_u32 m0, s70, 1024
    s_mov_b32 s73, 1343488
    buffer_load_dwordx4 v214, s[24:27], s73 offen lds
    s_add_u32 s71, s71, 4096
    s_add_u32 s72, s72, 4096
    buffer_load_dwordx4 v[112:115], v4, s[40:43], s71 offen offset:0 sc1
    buffer_load_dwordx4 v[116:119], v4, s[40:43], s72 offen offset:0 sc1
    buffer_load_dwordx4 v[120:123], v4, s[40:43], s71 offen offset:1024 sc1
    buffer_load_dwordx4 v[124:127], v4, s[40:43], s72 offen offset:1024 sc1
    s_waitcnt vmcnt(31)
    v_mfma_f32_32x32x16_bf16 v[16:31], a[184:187], v[136:139], v[16:31]
    s_waitcnt vmcnt(30)
    v_mfma_f32_32x32x16_bf16 v[32:47], a[184:187], v[140:143], v[32:47]
    v_mfma_f32_32x32x16_bf16 v[48:63], a[188:191], v[136:139], v[48:63]
    v_mfma_f32_32x32x16_bf16 v[64:79], a[188:191], v[140:143], v[64:79]
    s_add_u32 m0, s70, 2048
    s_mov_b32 s73, 1376256
    buffer_load_dwordx4 v214, s[24:27], s73 offen lds
    s_add_u32 m0, s70, 3072
    s_mov_b32 s73, 1409024
    buffer_load_dwordx4 v214, s[24:27], s73 offen lds
    buffer_load_dwordx4 v[128:131], v4, s[40:43], s71 offen offset:2048 sc1
    buffer_load_dwordx4 v[132:135], v4, s[40:43], s72 offen offset:2048 sc1
    buffer_load_dwordx4 v[136:139], v4, s[40:43], s71 offen offset:3072 sc1
    buffer_load_dwordx4 v[140:143], v4, s[40:43], s72 offen offset:3072 sc1
    s_waitcnt vmcnt(35)
    v_mfma_f32_32x32x16_bf16 v[16:31], a[192:195], v[144:147], v[16:31]
    s_waitcnt vmcnt(34)
    v_mfma_f32_32x32x16_bf16 v[32:47], a[192:195], v[148:151], v[32:47]
    v_mfma_f32_32x32x16_bf16 v[48:63], a[196:199], v[144:147], v[48:63]
    v_mfma_f32_32x32x16_bf16 v[64:79], a[196:199], v[148:151], v[64:79]
    s_add_u32 m0, s70, 4096
    s_mov_b32 s73, 1441792
    buffer_load_dwordx4 v214, s[24:27], s73 offen lds
    s_add_u32 m0, s70, 5120
    s_mov_b32 s73, 1474560
    buffer_load_dwordx4 v214, s[24:27], s73 offen lds
    s_add_u32 s71, s71, 4096
    s_add_u32 s72, s72, 4096
    buffer_load_dwordx4 v[144:147], v4, s[40:43], s71 offen offset:0 sc1
    buffer_load_dwordx4 v[148:151], v4, s[40:43], s72 offen offset:0 sc1
    s_waitcnt vmcnt(37)
    v_mfma_f32_32x32x16_bf16 v[16:31], a[200:203], v[152:155], v[16:31]
    s_waitcnt vmcnt(36)
    v_mfma_f32_32x32x16_bf16 v[32:47], a[200:203], v[156:159], v[32:47]
    v_mfma_f32_32x32x16_bf16 v[48:63], a[204:207], v[152:155], v[48:63]
    v_mfma_f32_32x32x16_bf16 v[64:79], a[204:207], v[156:159], v[64:79]
    s_add_u32 m0, s70, 6144
    s_mov_b32 s73, 1507328
    buffer_load_dwordx4 v214, s[24:27], s73 offen lds
    s_add_u32 m0, s70, 7168
    s_mov_b32 s73, 1540096
    buffer_load_dwordx4 v214, s[24:27], s73 offen lds
    v_lshrrev_b32 v220, 5, v1
    v_lshlrev_b32 v220, 10, v220
    v_and_b32 v221, 31, v1
    v_lshl_add_u32 v220, v221, 2, v220
    s_lshr_b32 s69, s3, 1
    s_lshl_b32 s68, s69, 13
    s_and_b32 s69, s3, 1
    s_lshl_b32 s69, s69, 7
    s_add_u32 s68, s68, s69
    v_add_u32 v220, s68, v220
    v_xor_b32 v221, 128, v220
    v_xor_b32 v222, 0x2000, v220
    v_xor_b32 v223, 0x2080, v220
    s_mul_i32 s68, s3, 20480
    s_add_u32 s68, s68, 77824
    v_add_u32 v220, s68, v220
    v_add_u32 v221, s68, v221
    v_add_u32 v222, s68, v222
    v_add_u32 v223, s68, v223
    s_lshl_b32 s68, s3, 12
    s_add_u32 s68, s68, 77824
    v_add_u32 v224, s68, v4
    v_add_u32 v226, 40960, v224
    v_mul_u32_u24 v225, 896, v3
    v_lshl_add_u32 v225, v2, 3, v225
    s_lshl_b32 s68, s67, 2
    s_add_u32 s68, s68, s3
    s_mul_i32 s68, s68, 14336
    s_lshl_b32 s69, s66, 7
    s_add_u32 s68, s68, s69
    s_add_u32 s69, s68, 7168
    buffer_load_dwordx4 v[152:155], v4, s[40:43], s71 offen offset:1024 sc1
    buffer_load_dwordx4 v[156:159], v4, s[40:43], s72 offen offset:1024 sc1
    s_waitcnt vmcnt(39)
    v_mfma_f32_32x32x16_bf16 v[16:31], a[208:211], v[160:163], v[16:31]
    s_waitcnt vmcnt(38)
    v_mfma_f32_32x32x16_bf16 v[32:47], a[208:211], v[164:167], v[32:47]
    v_mfma_f32_32x32x16_bf16 v[48:63], a[212:215], v[160:163], v[48:63]
    v_mfma_f32_32x32x16_bf16 v[64:79], a[212:215], v[164:167], v[64:79]
    s_add_u32 m0, s70, 8192
    s_mov_b32 s73, 1572864
    buffer_load_dwordx4 v214, s[24:27], s73 offen lds
    s_add_u32 m0, s70, 9216
    s_mov_b32 s73, 1605632
    buffer_load_dwordx4 v214, s[24:27], s73 offen lds
    buffer_load_dwordx4 v[160:163], v4, s[40:43], s71 offen offset:2048 sc1
    buffer_load_dwordx4 v[164:167], v4, s[40:43], s72 offen offset:2048 sc1
    s_waitcnt vmcnt(41)
    v_mfma_f32_32x32x16_bf16 v[16:31], a[216:219], v[168:171], v[16:31]
    s_waitcnt vmcnt(40)
    v_mfma_f32_32x32x16_bf16 v[32:47], a[216:219], v[172:175], v[32:47]
    v_mfma_f32_32x32x16_bf16 v[48:63], a[220:223], v[168:171], v[48:63]
    v_mfma_f32_32x32x16_bf16 v[64:79], a[220:223], v[172:175], v[64:79]
    s_add_u32 m0, s70, 10240
    s_mov_b32 s73, 1638400
    buffer_load_dwordx4 v214, s[24:27], s73 offen lds
    s_add_u32 m0, s70, 11264
    s_mov_b32 s73, 1671168
    buffer_load_dwordx4 v214, s[24:27], s73 offen lds
    buffer_load_dwordx4 v[168:171], v4, s[40:43], s71 offen offset:3072 sc1
    buffer_load_dwordx4 v[172:175], v4, s[40:43], s72 offen offset:3072 sc1
    s_waitcnt vmcnt(43)
    v_mfma_f32_32x32x16_bf16 v[16:31], a[224:227], v[176:179], v[16:31]
    s_waitcnt vmcnt(42)
    v_mfma_f32_32x32x16_bf16 v[32:47], a[224:227], v[180:183], v[32:47]
    v_mfma_f32_32x32x16_bf16 v[48:63], a[228:231], v[176:179], v[48:63]
    v_mfma_f32_32x32x16_bf16 v[64:79], a[228:231], v[180:183], v[64:79]
    s_waitcnt lgkmcnt(12)
    s_add_u32 m0, s70, 12288
    s_mov_b32 s73, 1703936
    buffer_load_dwordx4 v214, s[24:27], s73 offen lds
    s_add_u32 m0, s70, 13312
    s_mov_b32 s73, 1736704
    buffer_load_dwordx4 v214, s[24:27], s73 offen lds
    s_waitcnt vmcnt(43)
    v_mfma_f32_32x32x16_bf16 v[16:31], a[232:235], v[184:187], v[16:31]
    s_waitcnt vmcnt(42)
    v_mfma_f32_32x32x16_bf16 v[32:47], a[232:235], v[188:191], v[32:47]
    v_mfma_f32_32x32x16_bf16 v[48:63], a[236:239], v[184:187], v[48:63]
    v_mfma_f32_32x32x16_bf16 v[64:79], a[236:239], v[188:191], v[64:79]
    s_waitcnt lgkmcnt(8)
    s_add_u32 m0, s70, 14336
    s_mov_b32 s73, 1769472
    buffer_load_dwordx4 v214, s[24:27], s73 offen lds
    s_add_u32 m0, s70, 15360
    s_mov_b32 s73, 1802240
    buffer_load_dwordx4 v214, s[24:27], s73 offen lds
    s_waitcnt vmcnt(43)
    v_mfma_f32_32x32x16_bf16 v[16:31], a[240:243], v[192:195], v[16:31]
    s_waitcnt vmcnt(42)
    v_mfma_f32_32x32x16_bf16 v[32:47], a[240:243], v[196:199], v[32:47]
    v_mfma_f32_32x32x16_bf16 v[48:63], a[244:247], v[192:195], v[48:63]
    v_mfma_f32_32x32x16_bf16 v[64:79], a[244:247], v[196:199], v[64:79]
    s_waitcnt vmcnt(41)
    v_mfma_f32_32x32x16_bf16 v[16:31], a[248:251], v[200:203], v[16:31]
    s_waitcnt vmcnt(40)
    v_mfma_f32_32x32x16_bf16 v[32:47], a[248:251], v[204:207], v[32:47]
    v_mfma_f32_32x32x16_bf16 v[48:63], a[252:255], v[200:203], v[48:63]
    v_mfma_f32_32x32x16_bf16 v[64:79], a[252:255], v[204:207], v[64:79]
    s_waitcnt vmcnt(39)
    v_mfma_f32_32x32x16_bf16 v[16:31], a[0:3], v[80:83], v[16:31]
    s_waitcnt vmcnt(38)
    v_mfma_f32_32x32x16_bf16 v[32:47], a[0:3], v[84:87], v[32:47]
    v_mfma_f32_32x32x16_bf16 v[48:63], a[4:7], v[80:83], v[48:63]
    v_mfma_f32_32x32x16_bf16 v[64:79], a[4:7], v[84:87], v[64:79]
    s_waitcnt vmcnt(37)
    v_mfma_f32_32x32x16_bf16 v[16:31], a[8:11], v[88:91], v[16:31]
    s_waitcnt vmcnt(36)
    v_mfma_f32_32x32x16_bf16 v[32:47], a[8:11], v[92:95], v[32:47]
    v_mfma_f32_32x32x16_bf16 v[48:63], a[12:15], v[88:91], v[48:63]
    v_mfma_f32_32x32x16_bf16 v[64:79], a[12:15], v[92:95], v[64:79]
    s_waitcnt vmcnt(30)
    ds_read_b64_tr_b16 a[32:33], v217 offset:0
    ds_read_b64_tr_b16 a[34:35], v217 offset:1024
    ds_read_b64_tr_b16 a[36:37], v218 offset:0
    ds_read_b64_tr_b16 a[38:39], v218 offset:1024
    s_waitcnt vmcnt(24)
    ds_read_b64_tr_b16 a[40:41], v217 offset:2048
    ds_read_b64_tr_b16 a[42:43], v217 offset:3072
    ds_read_b64_tr_b16 a[44:45], v218 offset:2048
    ds_read_b64_tr_b16 a[46:47], v218 offset:3072
    s_waitcnt vmcnt(18)
    ds_read_b64_tr_b16 a[48:49], v217 offset:4096
    ds_read_b64_tr_b16 a[50:51], v217 offset:5120
    ds_read_b64_tr_b16 a[52:53], v218 offset:4096
    ds_read_b64_tr_b16 a[54:55], v218 offset:5120
    s_waitcnt vmcnt(14)
    ds_read_b64_tr_b16 a[56:57], v217 offset:6144
    ds_read_b64_tr_b16 a[58:59], v217 offset:7168
    ds_read_b64_tr_b16 a[60:61], v218 offset:6144
    ds_read_b64_tr_b16 a[62:63], v218 offset:7168
    s_waitcnt vmcnt(10)
    ds_read_b64_tr_b16 a[64:65], v217 offset:8192
    ds_read_b64_tr_b16 a[66:67], v217 offset:9216
    ds_read_b64_tr_b16 a[68:69], v218 offset:8192
    ds_read_b64_tr_b16 a[70:71], v218 offset:9216
    s_waitcnt vmcnt(6)
    ds_read_b64_tr_b16 a[72:73], v217 offset:10240
    ds_read_b64_tr_b16 a[74:75], v217 offset:11264
    ds_read_b64_tr_b16 a[76:77], v218 offset:10240
    ds_read_b64_tr_b16 a[78:79], v218 offset:11264
    s_waitcnt vmcnt(2)
    ds_read_b64_tr_b16 a[80:81], v217 offset:12288
    ds_read_b64_tr_b16 a[82:83], v217 offset:13312
    ds_read_b64_tr_b16 a[84:85], v218 offset:12288
    ds_read_b64_tr_b16 a[86:87], v218 offset:13312
    s_waitcnt vmcnt(0)
    ds_read_b64_tr_b16 a[88:89], v217 offset:14336
    ds_read_b64_tr_b16 a[90:91], v217 offset:15360
    ds_read_b64_tr_b16 a[92:93], v218 offset:14336
    ds_read_b64_tr_b16 a[94:95], v218 offset:15360
    s_waitcnt lgkmcnt(15)
    v_mfma_f32_32x32x16_bf16 v[16:31], a[16:19], v[96:99], v[16:31]
    v_mfma_f32_32x32x16_bf16 v[32:47], a[16:19], v[100:103], v[32:47]
    v_mfma_f32_32x32x16_bf16 v[48:63], a[20:23], v[96:99], v[48:63]
    v_mfma_f32_32x32x16_bf16 v[64:79], a[20:23], v[100:103], v[64:79]
    v_mfma_f32_32x32x16_bf16 v[16:31], a[24:27], v[104:107], v[16:31]
    v_mfma_f32_32x32x16_bf16 v[32:47], a[24:27], v[108:111], v[32:47]
    v_mfma_f32_32x32x16_bf16 v[48:63], a[28:31], v[104:107], v[48:63]
    v_mfma_f32_32x32x16_bf16 v[64:79], a[28:31], v[108:111], v[64:79]
    v_mfma_f32_32x32x16_bf16 v[16:31], a[32:35], v[112:115], v[16:31]
    v_mfma_f32_32x32x16_bf16 v[32:47], a[32:35], v[116:119], v[32:47]
    v_mfma_f32_32x32x16_bf16 v[48:63], a[36:39], v[112:115], v[48:63]
    v_mfma_f32_32x32x16_bf16 v[64:79], a[36:39], v[116:119], v[64:79]
    v_mfma_f32_32x32x16_bf16 v[16:31], a[40:43], v[120:123], v[16:31]
    v_mfma_f32_32x32x16_bf16 v[32:47], a[40:43], v[124:127], v[32:47]
    v_mfma_f32_32x32x16_bf16 v[48:63], a[44:47], v[120:123], v[48:63]
    v_mfma_f32_32x32x16_bf16 v[64:79], a[44:47], v[124:127], v[64:79]
    v_mfma_f32_32x32x16_bf16 v[16:31], a[48:51], v[128:131], v[16:31]
    v_mfma_f32_32x32x16_bf16 v[32:47], a[48:51], v[132:135], v[32:47]
    v_mfma_f32_32x32x16_bf16 v[48:63], a[52:55], v[128:131], v[48:63]
    v_mfma_f32_32x32x16_bf16 v[64:79], a[52:55], v[132:135], v[64:79]
    v_mfma_f32_32x32x16_bf16 v[16:31], a[56:59], v[136:139], v[16:31]
    v_mfma_f32_32x32x16_bf16 v[32:47], a[56:59], v[140:143], v[32:47]
    v_mfma_f32_32x32x16_bf16 v[48:63], a[60:63], v[136:139], v[48:63]
    v_mfma_f32_32x32x16_bf16 v[64:79], a[60:63], v[140:143], v[64:79]
    s_waitcnt lgkmcnt(14)
    v_mfma_f32_32x32x16_bf16 v[16:31], a[64:67], v[144:147], v[16:31]
    v_mfma_f32_32x32x16_bf16 v[32:47], a[64:67], v[148:151], v[32:47]
    s_waitcnt lgkmcnt(12)
    v_mfma_f32_32x32x16_bf16 v[48:63], a[68:71], v[144:147], v[48:63]
    v_mfma_f32_32x32x16_bf16 v[64:79], a[68:71], v[148:151], v[64:79]
    s_waitcnt lgkmcnt(10)
    v_mfma_f32_32x32x16_bf16 v[16:31], a[72:75], v[152:155], v[16:31]
    v_mfma_f32_32x32x16_bf16 v[32:47], a[72:75], v[156:159], v[32:47]
    s_waitcnt lgkmcnt(8)
    v_mfma_f32_32x32x16_bf16 v[48:63], a[76:79], v[152:155], v[48:63]
    v_mfma_f32_32x32x16_bf16 v[64:79], a[76:79], v[156:159], v[64:79]
    s_waitcnt lgkmcnt(6)
    v_mfma_f32_32x32x16_bf16 v[16:31], a[80:83], v[160:163], v[16:31]
    v_mfma_f32_32x32x16_bf16 v[32:47], a[80:83], v[164:167], v[32:47]
    s_waitcnt lgkmcnt(4)
    v_mfma_f32_32x32x16_bf16 v[48:63], a[84:87], v[160:163], v[48:63]
    v_mfma_f32_32x32x16_bf16 v[64:79], a[84:87], v[164:167], v[64:79]
    s_waitcnt lgkmcnt(2)
    v_mfma_f32_32x32x16_bf16 v[16:31], a[88:91], v[168:171], v[16:31]
    v_mfma_f32_32x32x16_bf16 v[32:47], a[88:91], v[172:175], v[32:47]
    s_waitcnt lgkmcnt(0)
    v_mfma_f32_32x32x16_bf16 v[48:63], a[92:95], v[168:171], v[48:63]
    v_mfma_f32_32x32x16_bf16 v[64:79], a[92:95], v[172:175], v[64:79]
    s_nop 7
    ds_write2st64_b32 v220, v16, v17 offset0:0 offset1:1
    ds_write2st64_b32 v220, v18, v19 offset0:2 offset1:3
    ds_write2st64_b32 v220, v20, v21 offset0:8 offset1:9
    ds_write2st64_b32 v220, v22, v23 offset0:10 offset1:11
    ds_write2st64_b32 v220, v24, v25 offset0:16 offset1:17
    ds_write2st64_b32 v220, v26, v27 offset0:18 offset1:19
    ds_write2st64_b32 v220, v28, v29 offset0:24 offset1:25
    ds_write2st64_b32 v220, v30, v31 offset0:26 offset1:27
    ds_write2st64_b32 v221, v32, v33 offset0:0 offset1:1
    ds_write2st64_b32 v221, v34, v35 offset0:2 offset1:3
    ds_write2st64_b32 v221, v36, v37 offset0:8 offset1:9
    ds_write2st64_b32 v221, v38, v39 offset0:10 offset1:11
    ds_write2st64_b32 v221, v40, v41 offset0:16 offset1:17
    ds_write2st64_b32 v221, v42, v43 offset0:18 offset1:19
    ds_write2st64_b32 v221, v44, v45 offset0:24 offset1:25
    ds_write2st64_b32 v221, v46, v47 offset0:26 offset1:27
    ds_write2st64_b32 v222, v48, v49 offset0:0 offset1:1
    ds_write2st64_b32 v222, v50, v51 offset0:2 offset1:3
    ds_write2st64_b32 v222, v52, v53 offset0:8 offset1:9
    ds_write2st64_b32 v222, v54, v55 offset0:10 offset1:11
    ds_write2st64_b32 v222, v56, v57 offset0:16 offset1:17
    ds_write2st64_b32 v222, v58, v59 offset0:18 offset1:19
    ds_write2st64_b32 v222, v60, v61 offset0:24 offset1:25
    ds_write2st64_b32 v222, v62, v63 offset0:26 offset1:27
    ds_write2st64_b32 v223, v64, v65 offset0:0 offset1:1
    ds_write2st64_b32 v223, v66, v67 offset0:2 offset1:3
    ds_write2st64_b32 v223, v68, v69 offset0:8 offset1:9
    ds_write2st64_b32 v223, v70, v71 offset0:10 offset1:11
    ds_write2st64_b32 v223, v72, v73 offset0:16 offset1:17
    ds_write2st64_b32 v223, v74, v75 offset0:18 offset1:19
    ds_write2st64_b32 v223, v76, v77 offset0:24 offset1:25
    ds_write2st64_b32 v223, v78, v79 offset0:26 offset1:27
    s_waitcnt lgkmcnt(0)
    s_barrier
    ds_read_b128 v[16:19], v224 offset:0
    ds_read_b128 v[20:23], v224 offset:20480
    ds_read_b128 v[24:27], v226 offset:0
    ds_read_b128 v[28:31], v226 offset:20480
    ds_read_b128 v[32:35], v224 offset:1024
    ds_read_b128 v[36:39], v224 offset:21504
    ds_read_b128 v[40:43], v226 offset:1024
    ds_read_b128 v[44:47], v226 offset:21504
    ds_read_b128 v[48:51], v224 offset:2048
    ds_read_b128 v[52:55], v224 offset:22528
    ds_read_b128 v[56:59], v226 offset:2048
    ds_read_b128 v[60:63], v226 offset:22528
    ds_read_b128 v[64:67], v224 offset:3072
    ds_read_b128 v[68:71], v224 offset:23552
    ds_read_b128 v[72:75], v226 offset:3072
    ds_read_b128 v[76:79], v226 offset:23552
    s_waitcnt lgkmcnt(14)
    v_pk_add_f32 v[16:17], v[16:17], v[20:21]
    s_waitcnt lgkmcnt(12)
    v_pk_add_f32 v[24:25], v[24:25], v[28:29]
    v_pk_add_f32 v[18:19], v[18:19], v[22:23]
    v_pk_add_f32 v[26:27], v[26:27], v[30:31]
    v_pk_add_f32 v[16:17], v[16:17], v[24:25]
    v_pk_add_f32 v[18:19], v[18:19], v[26:27]
    v_cvt_pk_bf16_f32 v20, v16, v17
    v_cvt_pk_bf16_f32 v21, v18, v19
    buffer_store_dwordx2 v[20:21], v225, s[36:39], s68 offen offset:0
    s_waitcnt lgkmcnt(10)
    v_pk_add_f32 v[32:33], v[32:33], v[36:37]
    s_waitcnt lgkmcnt(8)
    v_pk_add_f32 v[40:41], v[40:41], v[44:45]
    v_pk_add_f32 v[34:35], v[34:35], v[38:39]
    v_pk_add_f32 v[42:43], v[42:43], v[46:47]
    v_pk_add_f32 v[32:33], v[32:33], v[40:41]
    v_pk_add_f32 v[34:35], v[34:35], v[42:43]
    v_cvt_pk_bf16_f32 v36, v32, v33
    v_cvt_pk_bf16_f32 v37, v34, v35
    buffer_store_dwordx2 v[36:37], v225, s[36:39], s68 offen offset:3584
    s_waitcnt lgkmcnt(6)
    v_pk_add_f32 v[48:49], v[48:49], v[52:53]
    s_waitcnt lgkmcnt(4)
    v_pk_add_f32 v[56:57], v[56:57], v[60:61]
    v_pk_add_f32 v[50:51], v[50:51], v[54:55]
    v_pk_add_f32 v[58:59], v[58:59], v[62:63]
    v_pk_add_f32 v[48:49], v[48:49], v[56:57]
    v_pk_add_f32 v[50:51], v[50:51], v[58:59]
    v_cvt_pk_bf16_f32 v52, v48, v49
    v_cvt_pk_bf16_f32 v53, v50, v51
    buffer_store_dwordx2 v[52:53], v225, s[36:39], s69 offen offset:0
    s_waitcnt lgkmcnt(2)
    v_pk_add_f32 v[64:65], v[64:65], v[68:69]
    s_waitcnt lgkmcnt(0)
    v_pk_add_f32 v[72:73], v[72:73], v[76:77]
    v_pk_add_f32 v[66:67], v[66:67], v[70:71]
    v_pk_add_f32 v[74:75], v[74:75], v[78:79]
    v_pk_add_f32 v[64:65], v[64:65], v[72:73]
    v_pk_add_f32 v[66:67], v[66:67], v[74:75]
    v_cvt_pk_bf16_f32 v68, v64, v65
    v_cvt_pk_bf16_f32 v69, v66, v67
    buffer_store_dwordx2 v[68:69], v225, s[36:39], s69 offen offset:3584
L_end_P:
    s_endpgm

.section .rodata,"a"
.p2align 6
.amdhsa_kernel sequential_preLN__sliding_local_dilated__mixer_token_mlp__prompt_kernel
  .amdhsa_next_free_vgpr 508
  .amdhsa_next_free_sgpr 102
  .amdhsa_accum_offset 252
  .amdhsa_group_segment_fixed_size 0
  .amdhsa_kernarg_size 88
  .amdhsa_user_sgpr_count 2
  .amdhsa_user_sgpr_kernarg_segment_ptr 1
  .amdhsa_system_sgpr_workgroup_id_x 1
.end_amdhsa_kernel
```

```asm
; @launch grid=(256,1,1) block=(256,1,1) lds=163840
.amdgcn_target "amdgcn-amd-amdhsa--gfx950"
.text
.globl sequential_preLN__sliding_local_dilated__mixer_token_mlp__prompt_kernel
.p2align 8
.type sequential_preLN__sliding_local_dilated__mixer_token_mlp__prompt_kernel,@function
sequential_preLN__sliding_local_dilated__mixer_token_mlp__prompt_kernel:
    s_cmp_ge_u32 s2, 256
    s_cbranch_scc1 L_end_P
    s_load_dwordx2 s[8:9], s[0:1], 0
    s_load_dwordx2 s[12:13], s[0:1], 8
    s_load_dwordx2 s[44:45], s[0:1], 72
    s_load_dwordx2 s[40:41], s[0:1], 80
    s_load_dwordx2 s[16:17], s[0:1], 16
    s_load_dwordx2 s[20:21], s[0:1], 32
    s_load_dwordx2 s[24:25], s[0:1], 48
    s_load_dwordx2 s[28:29], s[0:1], 40
    s_load_dwordx2 s[32:33], s[0:1], 56
    s_load_dwordx2 s[36:37], s[0:1], 64
    v_lshrrev_b32 v1, 6, v0
    s_nop 0
    v_readfirstlane_b32 s3, v1
    v_and_b32 v1, 63, v0
    v_and_b32 v2, 15, v0
    v_lshrrev_b32 v3, 4, v1
    v_lshlrev_b32 v4, 4, v1
    s_mov_b32 s10, 0x1c0000
    s_mov_b32 s11, 0x00020000
    s_mov_b32 s14, 0x126000
    s_mov_b32 s15, 0x00020000
    s_mov_b32 s46, 0x100
    s_mov_b32 s47, 0x00020000
    s_mov_b32 s42, 0x590000
    s_mov_b32 s43, 0x00020000
    s_mov_b32 s18, 0x62000
    s_mov_b32 s19, 0x00020000
    s_mov_b32 s22, 0x700000
    s_mov_b32 s23, 0x00020000
    s_mov_b32 s26, 0x700000
    s_mov_b32 s27, 0x00020000
    s_mov_b32 s30, 0xe00
    s_mov_b32 s31, 0x00020000
    s_mov_b32 s34, 0x1000
    s_mov_b32 s35, 0x00020000
    s_mov_b32 s38, 0x1c0000
    s_mov_b32 s39, 0x00020000
    s_mov_b32 s5, 0x3f803f80
    s_mov_b32 s6, 0x40000
    s_bfe_u32 s48, s2, 0x20001
    s_lshl_b32 s48, s48, 2
    s_lshr_b32 s53, s2, 6
    s_add_u32 s48, s48, s53
    s_bfe_u32 s49, s2, 0x30003
    s_and_b32 s53, s2, 1
    s_lshl_b32 s53, s53, 3
    s_add_u32 s49, s49, s53
    v_lshrrev_b32 v237, 2, v1
    v_mul_u32_u24 v123, 2688, v237
    v_lshrrev_b32 v237, 5, v1
    v_lshlrev_b32 v237, 1, v237
    v_and_b32 v238, 3, v1
    v_xor_b32 v237, v237, v238
    v_lshl_add_u32 v123, v237, 4, v123
    s_mul_i32 s53, s49, 56
    s_min_u32 s53, s53, 832
    s_mul_i32 s51, s3, 43008
    s_add_u32 s53, s53, s51
    v_add_u32 v123, s53, v123
    s_lshr_b32 s53, s3, 1
    s_mul_i32 s51, s53, 6144
    s_and_b32 s53, s3, 1
    s_lshl_b32 s53, s53, 10
    s_add_u32 s51, s51, s53
    v_lshrrev_b32 v237, 3, v1
    v_mul_u32_u24 v122, 896, v237
    v_and_b32 v237, 7, v1
    v_xor_b32 v237, v237, v3
    v_lshl_add_u32 v120, v237, 4, v122
    s_lshl_b32 s50, s48, 7
    s_lshl_b32 s53, s3, 5
    s_add_u32 s53, s53, s50
    s_mul_i32 s53, s53, 896
    v_xor_b32 v121, 64, v120
    v_add_u32 v120, s53, v120
    s_add_u32 s53, s53, 7168
    v_add_u32 v121, s53, v121
    s_lshl_b32 s53, s3, 1
    v_xor_b32 v237, s53, v237
    v_lshl_add_u32 v122, v237, 4, v122
    s_lshl_b32 s53, s3, 2
    s_add_u32 s53, s53, s50
    s_sub_u32 s53, s53, 16
    s_mul_i32 s53, s53, 896
    s_cmp_eq_u32 s48, 0
    s_cselect_b32 s53, 0x40000000, s53
    v_add_u32 v122, s53, v122
    s_lshl_b32 s52, s3, 12
    s_add_u32 s52, s52, 63488
    s_lshl_b32 s7, s3, 9
    s_cmp_eq_u32 s3, 0
    s_cselect_b32 s54, 0xffffff00, -1
    s_mov_b32 s55, 0
    s_memrealtime s[86:87]
    v_mov_b32 v7, 0
    s_waitcnt lgkmcnt(0)
    s_or_b32 s86, s86, 1
    v_mov_b32 v6, s86
    s_or_b32 s86, s2, s3
    s_cmp_eq_u32 s86, 0
    s_cselect_b64 exec, 1, 0
    buffer_store_dword v6, v7, s[44:47], 0 offen sc1
    s_mov_b64 exec, -1
    s_add_u32 m0, s51, 12288
    s_mov_b32 s73, 0
    buffer_load_dwordx4 v123, s[12:15], s73 offen lds
    s_add_u32 m0, s51, 14336
    s_mov_b32 s73, 896
    buffer_load_dwordx4 v123, s[12:15], s73 offen lds
    s_add_u32 m0, s51, 16384
    s_mov_b32 s73, 1792
    buffer_load_dwordx4 v123, s[12:15], s73 offen lds
    s_add_u32 m0, s52, 36864
    s_mov_b32 s73, 0
    buffer_load_dwordx4 v120, s[8:11], s73 offen lds
    s_add_u32 m0, s52, 37888
    s_mov_b32 s73, 0
    buffer_load_dwordx4 v121, s[8:11], s73 offen lds
    s_add_u32 m0, s52, 38912
    s_mov_b32 s73, 14336
    buffer_load_dwordx4 v120, s[8:11], s73 offen lds
    s_add_u32 m0, s52, 39936
    s_mov_b32 s73, 14336
    buffer_load_dwordx4 v121, s[8:11], s73 offen lds
    s_add_u32 m0, s7, 98304
    s_mov_b32 s73, 0
    s_mov_b64 exec, s[54:55]
    buffer_load_dwordx4 v122, s[8:11], s73 offen lds
    s_mov_b64 exec, -1
    s_add_u32 m0, s51, 24576
    s_mov_b32 s73, 172032
    buffer_load_dwordx4 v123, s[12:15], s73 offen lds
    s_add_u32 m0, s51, 26624
    s_mov_b32 s73, 172928
    buffer_load_dwordx4 v123, s[12:15], s73 offen lds
    s_add_u32 m0, s51, 28672
    s_mov_b32 s73, 173824
    buffer_load_dwordx4 v123, s[12:15], s73 offen lds
    s_add_u32 m0, s52, 18432
    s_mov_b32 s73, 128
    buffer_load_dwordx4 v120, s[8:11], s73 offen lds
    s_add_u32 m0, s52, 19456
    s_mov_b32 s73, 128
    buffer_load_dwordx4 v121, s[8:11], s73 offen lds
    s_add_u32 m0, s52, 20480
    s_mov_b32 s73, 14464
    buffer_load_dwordx4 v120, s[8:11], s73 offen lds
    s_add_u32 m0, s52, 21504
    s_mov_b32 s73, 14464
    buffer_load_dwordx4 v121, s[8:11], s73 offen lds
    s_add_u32 m0, s7, 79872
    s_mov_b32 s73, 128
    s_mov_b64 exec, s[54:55]
    buffer_load_dwordx4 v122, s[8:11], s73 offen lds
    s_mov_b64 exec, -1
    s_lshr_b32 s53, s2, 3
    s_lshl_b32 s53, s53, 2
    s_add_u32 s53, s53, s3
    s_mul_i32 s86, s53, 30
    v_add_u32 v237, s86, v1
    v_mul_u32_u24 v238, 43691, v237
    v_lshrrev_b32 v238, 19, v238
    v_mul_u32_u24 v239, 12, v238
    v_sub_u32 v239, v237, v239
    v_lshrrev_b32 v239, 2, v239
    v_mul_u32_u24 v239, 896, v239
    v_mul_u32_u24 v238, 2688, v238
    v_and_b32 v237, 3, v237
    v_lshlrev_b32 v237, 7, v237
    v_add3_u32 v237, v237, v238, v239
    s_and_b32 s86, s2, 1
    s_mul_i32 s86, s86, 384
    s_add_u32 s86, s86, 344064
    s_mov_b64 exec, 0x3fffffff
    buffer_load_dword v232, v237, s[12:15], s86 offen
    s_mov_b64 exec, -1
    v_lshlrev_b32 v237, 7, v1
    s_mul_i32 s86, s53, 3712
    s_bfe_u32 s87, s2, 0x20001
    s_mul_i32 s87, s87, 458752
    s_add_u32 s86, s86, s87
    s_max_u32 s86, s86, 14336
    s_sub_u32 s86, s86, 14336
    s_mov_b64 exec, 0x1fffffff
    buffer_load_dword v233, v237, s[8:11], s86 offen
    s_mov_b64 exec, -1
    s_getpc_b64 s[86:87]
Lpc_P:
    v_lshlrev_b32 v237, 7, v1
    s_lshl_b32 s53, s53, 8
    v_add_u32 v237, s53, v237
    v_min_u32 v237, L_end_P-Lpc_P, v237
    s_mov_b64 exec, 3
    global_load_dword v236, v237, s[86:87]
    s_mov_b64 exec, -1
    v_mul_u32_u24 v237, 18432, v3
    v_lshl_add_u32 v237, v2, 3, v237
    v_mov_b32 v238, s5
    v_add_u32 v237, 61440, v237
    ds_write2_b32 v237, v238, v238 offset0:0 offset1:1
    s_lshr_b32 s68, s2, 3
    s_mul_i32 s69, s68, 37
    s_lshr_b32 s69, s69, 8
    s_mul_i32 s64, s69, 7
    s_sub_u32 s64, s68, s64
    s_mov_b32 s66, s64
    s_and_b32 s68, s2, 7
    s_lshl_b32 s67, s68, 2
    s_add_u32 s67, s67, s69
    s_cmp_ge_u32 s69, 4
    s_cselect_b32 s67, 99, s67
    s_mul_i32 s71, s68, 3
    s_add_u32 s71, s71, 4
    s_lshl_b32 s72, s68, 2
    s_cmp_lt_u32 s68, 4
    s_cselect_b32 s65, s72, s71
    s_cselect_b32 s71, 4, 3
    s_add_u32 s65, s65, s69
    s_cmp_ge_u32 s69, s71
    s_cselect_b32 s65, 99, s65
    v_lshrrev_b32 v219, 3, v1
    v_mul_u32_u24 v208, 896, v219
    v_and_b32 v219, 1, v3
    v_lshlrev_b32 v219, 2, v219
    v_and_b32 v220, 7, v1
    v_xor_b32 v219, v219, v220
    v_lshl_add_u32 v208, v219, 4, v208
    s_lshl_b32 s58, s66, 7
    s_mul_i32 s60, s3, 100352
    s_add_u32 s58, s58, s60
    v_add_u32 v208, s58, v208
    s_mul_i32 s59, s3, 14336
    s_add_u32 s59, s59, 106496
    v_lshrrev_b32 v219, 5, v1
    v_lshlrev_b32 v209, 9, v219
    v_bfe_u32 v219, v1, 2, 2
    v_lshl_add_u32 v209, v219, 7, v209
    v_lshrrev_b32 v219, 1, v219
    s_and_b32 s58, s3, 1
    v_xor_b32 v219, s58, v219
    v_lshl_add_u32 v209, v219, 6, v209
    v_and_b32 v219, 1, v3
    v_lshl_add_u32 v209, v219, 5, v209
    v_and_b32 v219, 3, v1
    v_lshl_add_u32 v209, v219, 3, v209
    v_add_u32 v209, 106496, v209
    s_mul_i32 s70, s3, 36864
    s_add_u32 s70, s70, 12288
    v_lshrrev_b32 v219, 3, v1
    v_mul_u32_u24 v213, 3584, v219
    v_and_b32 v219, 1, v3
    v_lshlrev_b32 v219, 2, v219
    v_and_b32 v220, 7, v1
    v_xor_b32 v219, v219, v220
    v_lshl_add_u32 v213, v219, 4, v213
    s_mul_i32 s68, s3, 1835008
    s_lshl_b32 s69, s65, 7
    s_add_u32 s68, s68, s69
    s_cmp_ge_u32 s65, 99
    s_cselect_b32 s68, 0x40000000, s68
    v_add_u32 v213, s68, v213
    s_cselect_b32 s68, 0x40000000, 0
    v_add_u32 v5, s68, v4
    v_lshrrev_b32 v219, 5, v1
    v_lshlrev_b32 v215, 9, v219
    v_bfe_u32 v219, v1, 2, 2
    v_lshl_add_u32 v215, v219, 7, v215
    v_lshrrev_b32 v219, 1, v219
    s_lshr_b32 s68, s3, 1
    v_xor_b32 v219, s68, v219
    v_lshl_add_u32 v215, v219, 6, v215
    v_and_b32 v219, 1, v3
    v_lshl_add_u32 v215, v219, 5, v215
    v_and_b32 v219, 3, v1
    v_lshl_add_u32 v215, v219, 3, v215
    v_add_u32 v215, s70, v215
    v_xor_b32 v216, 64, v215
    s_mul_i32 s70, s3, 36864
    s_add_u32 s70, s70, 12288
    v_lshrrev_b32 v219, 3, v1
    v_mul_u32_u24 v214, 4096, v219
    v_and_b32 v219, 1, v3
    v_lshlrev_b32 v219, 2, v219
    v_and_b32 v220, 7, v1
    v_xor_b32 v219, v219, v220
    v_lshl_add_u32 v214, v219, 4, v214
    s_mul_i32 s68, s3, 1835008
    s_lshl_b32 s69, s67, 7
    s_add_u32 s68, s68, s69
    s_cmp_ge_u32 s67, 99
    s_cselect_b32 s68, 0x40000000, s68
    v_add_u32 v214, s68, v214
    v_lshrrev_b32 v219, 5, v1
    v_lshlrev_b32 v217, 9, v219
    v_bfe_u32 v219, v1, 2, 2
    v_lshl_add_u32 v217, v219, 7, v217
    v_lshrrev_b32 v219, 1, v219
    s_lshr_b32 s68, s3, 1
    v_xor_b32 v219, s68, v219
    v_lshl_add_u32 v217, v219, 6, v217
    v_and_b32 v219, 1, v3
    v_lshl_add_u32 v217, v219, 5, v217
    v_and_b32 v219, 3, v1
    v_lshl_add_u32 v217, v219, 3, v217
    v_add_u32 v217, s70, v217
    v_xor_b32 v218, 64, v217
    s_lshl_b32 s80, s48, 2
    s_add_u32 s80, s80, s3
    s_lshl_b32 s80, s80, 4
    s_add_u32 s80, s80, s49
    s_lshl_b32 s80, s80, 2
    s_add_u32 s80, s80, 0x588000
    s_lshl_b32 s83, s67, 1
    s_lshr_b32 s79, s3, 1
    s_add_u32 s83, s83, s79
    s_lshl_b32 s83, s83, 6
    s_add_u32 s83, s83, 0x588000
    v_lshlrev_b32 v10, 2, v2
    s_lshl_b32 s84, s64, 9
    s_add_u32 s84, s84, 0x589000
    s_lshl_b32 s81, s67, 2
    s_add_u32 s81, s81, s3
    s_lshl_b32 s81, s81, 2
    s_add_u32 s81, s81, s84
    s_lshl_b32 s79, s3, 7
    s_add_u32 s84, s84, s79
    v_and_b32 v11, 31, v1
    v_lshlrev_b32 v11, 2, v11
    s_lshl_b32 s85, s64, 9
    s_add_u32 s85, s85, 0x58a000
    s_lshl_b32 s82, s65, 2
    s_add_u32 s82, s82, s3
    s_lshl_b32 s82, s82, 2
    s_add_u32 s82, s82, s85
    s_mul_i32 s79, s3, 112
    s_add_u32 s85, s85, s79
    v_min_u32 v12, 27, v1
    v_lshlrev_b32 v12, 2, v12
    v_mov_b32 v9, 0
    v_lshlrev_b32 v124, 9, v3
    v_bfe_u32 v237, v1, 2, 2
    v_lshl_add_u32 v124, v237, 6, v124
    v_and_b32 v237, 3, v1
    v_lshl_add_u32 v124, v237, 3, v124
    v_and_b32 v237, 1, v3
    v_lshlrev_b32 v237, 5, v237
    v_add_u32 v124, v124, v237
    v_add_u32 v124, 12288, v124
    v_xor_b32 v125, 32, v124
    s_and_b32 s53, s3, 1
    s_lshl_b32 s53, s53, 5
    v_xor_b32 v127, s53, v124
    s_lshr_b32 s53, s3, 1
    s_lshl_b32 s53, s53, 11
    s_add_u32 s53, s53, 2048
    v_add_u32 v126, s53, v127
    v_lshrrev_b32 v237, 1, v2
    v_xor_b32 v237, v237, v3
    v_lshlrev_b32 v237, 4, v237
    v_lshl_add_u32 v237, v2, 7, v237
    v_add_u32 v130, 61440, v237
    v_xor_b32 v131, 64, v130
    v_add_u32 v128, s52, v237
    v_xor_b32 v129, 64, v128
    v_lshlrev_b32 v237, 2, v3
    v_sub_u32 v237, v2, v237
    v_mov_b32 v239, 0xf149f2ca
    v_add_u32 v238, 16, v237
    v_and_b32 v238, 0xfffffff1, v238
    v_cmp_eq_u32 vcc, 0, v238
    s_nop 1
    v_cndmask_b32 v240, v239, 0, vcc
    v_add_u32 v238, 15, v237
    v_and_b32 v238, 0xfffffff1, v238
    v_cmp_eq_u32 vcc, 0, v238
    s_nop 1
    v_cndmask_b32 v241, v239, 0, vcc
    v_add_u32 v238, 14, v237
    v_and_b32 v238, 0xfffffff1, v238
    v_cmp_eq_u32 vcc, 0, v238
    s_nop 1
    v_cndmask_b32 v242, v239, 0, vcc
    v_add_u32 v238, 13, v237
    v_and_b32 v238, 0xfffffff1, v238
    v_cmp_eq_u32 vcc, 0, v238
    s_nop 1
    v_cndmask_b32 v243, v239, 0, vcc
    v_add_u32 v238, 0, v237
    v_and_b32 v238, 0xfffffff1, v238
    v_cmp_eq_u32 vcc, 0, v238
    s_nop 1
    v_cndmask_b32 v244, v239, 0, vcc
    v_add_u32 v238, -1, v237
    v_and_b32 v238, 0xfffffff1, v238
    v_cmp_eq_u32 vcc, 0, v238
    s_nop 1
    v_cndmask_b32 v245, v239, 0, vcc
    v_add_u32 v238, -2, v237
    v_and_b32 v238, 0xfffffff1, v238
    v_cmp_eq_u32 vcc, 0, v238
    s_nop 1
    v_cndmask_b32 v246, v239, 0, vcc
    v_add_u32 v238, -3, v237
    v_and_b32 v238, 0xfffffff1, v238
    v_cmp_eq_u32 vcc, 0, v238
    s_nop 1
    v_cndmask_b32 v247, v239, 0, vcc
    s_or_b32 s53, s48, s3
    s_cmp_eq_u32 s53, 0
    s_cselect_b64 vcc, -1, 0
    v_cndmask_b32 v248, v240, v239, vcc
    v_cndmask_b32 v249, v241, v239, vcc
    v_cndmask_b32 v250, v242, v239, vcc
    v_cndmask_b32 v251, v243, v239, vcc
    v_mov_b32 v40, s5
    v_mov_b32 v41, s5
    v_mov_b32 v42, s5
    v_mov_b32 v43, s5
    s_waitcnt vmcnt(11)
    s_waitcnt lgkmcnt(0)
    s_barrier
    ds_read_b128 v[16:19], v128 offset:36864
    ds_read_b128 v[20:23], v128 offset:38912
    ds_read_b128 v[24:27], v130 offset:36864
    ds_read_b64_tr_b16 v[88:89], v124 offset:0
    ds_read_b64_tr_b16 v[90:91], v124 offset:256
    ds_read_b64_tr_b16 v[92:93], v125 offset:0
    ds_read_b64_tr_b16 v[94:95], v125 offset:256
    ds_read_b64_tr_b16 v[96:97], v124 offset:2048
    ds_read_b64_tr_b16 v[98:99], v124 offset:2304
    ds_read_b64_tr_b16 v[100:101], v125 offset:2048
    ds_read_b64_tr_b16 v[102:103], v125 offset:2304
    ds_read_b64_tr_b16 v[104:105], v124 offset:4096
    ds_read_b64_tr_b16 v[106:107], v124 offset:4352
    ds_read_b64_tr_b16 v[108:109], v125 offset:4096
    ds_read_b64_tr_b16 v[110:111], v125 offset:4352
    ds_read_b64_tr_b16 v[112:113], v126 offset:0
    ds_read_b64_tr_b16 v[114:115], v126 offset:256
    ds_read_b64_tr_b16 v[116:117], v127 offset:0
    ds_read_b64_tr_b16 v[118:119], v127 offset:256
    s_waitcnt lgkmcnt(8)
    v_mfma_f32_16x16x32_bf16 v[136:139], v[88:91], v[16:19], 0
    ds_read_b128 v[28:31], v129 offset:36864
    v_mfma_f32_16x16x32_bf16 v[160:163], v[88:91], v[20:23], 0
    ds_read_b128 v[32:35], v129 offset:38912
    v_mfma_f32_16x16x32_bf16 v[140:143], v[92:95], v[16:19], 0
    ds_read_b128 v[36:39], v131 offset:36864
    v_mfma_f32_16x16x32_bf16 v[164:167], v[92:95], v[20:23], 0
    ds_read_b64_tr_b16 v[88:89], v124 offset:6144
    v_mfma_f32_16x16x32_bf16 v[144:147], v[96:99], v[16:19], 0
    ds_read_b64_tr_b16 v[90:91], v124 offset:6400
    s_add_u32 m0, s51, 36864
    s_mov_b32 s73, 344064
    buffer_load_dwordx4 v123, s[12:15], s73 offen lds
    v_mfma_f32_16x16x32_bf16 v[168:171], v[96:99], v[20:23], 0
    ds_read_b64_tr_b16 v[92:93], v125 offset:6144
    v_mfma_f32_16x16x32_bf16 v[148:151], v[100:103], v[16:19], 0
    ds_read_b64_tr_b16 v[94:95], v125 offset:6400
    v_mfma_f32_16x16x32_bf16 v[172:175], v[100:103], v[20:23], 0
    ds_read_b64_tr_b16 v[96:97], v124 offset:8192
    s_waitcnt lgkmcnt(8)
    v_mfma_f32_16x16x32_bf16 v[152:155], v[16:19], v[104:107], 0
    ds_read_b64_tr_b16 v[98:99], v124 offset:8448
    v_mfma_f32_16x16x32_bf16 v[176:179], v[20:23], v[104:107], 0
    ds_read_b64_tr_b16 v[100:101], v125 offset:8192
    s_add_u32 m0, s51, 38912
    s_mov_b32 s73, 344960
    buffer_load_dwordx4 v123, s[12:15], s73 offen lds
    v_mfma_f32_16x16x32_bf16 v[156:159], v[16:19], v[108:111], 0
    ds_read_b64_tr_b16 v[102:103], v125 offset:8448
    v_mfma_f32_16x16x32_bf16 v[180:183], v[20:23], v[108:111], 0
    ds_read_b64_tr_b16 v[104:105], v124 offset:10240
    v_mfma_f32_16x16x32_bf16 v[184:187], v[112:115], v[24:27], 0
    ds_read_b64_tr_b16 v[106:107], v124 offset:10496
    v_mfma_f32_16x16x32_bf16 v[188:191], v[116:119], v[24:27], 0
    ds_read_b64_tr_b16 v[108:109], v125 offset:10240
    v_mfma_f32_16x16x32_bf16 v[48:51], v[16:19], v[16:19], 0
    ds_read_b64_tr_b16 v[110:111], v125 offset:10496
    s_add_u32 m0, s51, 40960
    s_mov_b32 s73, 345856
    buffer_load_dwordx4 v123, s[12:15], s73 offen lds
    v_mfma_f32_16x16x32_bf16 v[52:55], v[20:23], v[20:23], 0
    ds_read_b64_tr_b16 v[112:113], v126 offset:6144
    v_mfma_f32_16x16x32_bf16 v[56:59], v[24:27], v[24:27], 0
    ds_read_b64_tr_b16 v[114:115], v126 offset:6400
    v_mfma_f32_16x16x32_bf16 v[60:63], v[40:43], v[16:19], 0
    ds_read_b64_tr_b16 v[116:117], v127 offset:6144
    v_mfma_f32_16x16x32_bf16 v[64:67], v[40:43], v[20:23], 0
    ds_read_b64_tr_b16 v[118:119], v127 offset:6400
    v_mfma_f32_16x16x32_bf16 v[68:71], v[40:43], v[24:27], 0
    s_add_u32 m0, s52, 0
    s_mov_b32 s73, 256
    buffer_load_dwordx4 v120, s[8:11], s73 offen lds
    s_add_u32 m0, s52, 1024
    s_mov_b32 s73, 256
    buffer_load_dwordx4 v121, s[8:11], s73 offen lds
    s_add_u32 m0, s52, 2048
    s_mov_b32 s73, 14592
    buffer_load_dwordx4 v120, s[8:11], s73 offen lds
    s_add_u32 m0, s52, 3072
    s_mov_b32 s73, 14592
    buffer_load_dwordx4 v121, s[8:11], s73 offen lds
    s_add_u32 m0, s7, 61440
    s_mov_b32 s73, 256
    s_mov_b64 exec, s[54:55]
    buffer_load_dwordx4 v122, s[8:11], s73 offen lds
    s_mov_b64 exec, -1
    s_waitcnt vmcnt(11)
    s_barrier
    s_waitcnt lgkmcnt(8)
    v_mfma_f32_16x16x32_bf16 v[136:139], v[88:91], v[28:31], v[136:139]
    ds_read_b128 v[16:19], v128 offset:18432
    v_mfma_f32_16x16x32_bf16 v[160:163], v[88:91], v[32:35], v[160:163]
    ds_read_b128 v[20:23], v128 offset:20480
    v_mfma_f32_16x16x32_bf16 v[140:143], v[92:95], v[28:31], v[140:143]
    ds_read_b128 v[24:27], v130 offset:18432
    v_mfma_f32_16x16x32_bf16 v[164:167], v[92:95], v[32:35], v[164:167]
    ds_read_b64_tr_b16 v[88:89], v124 offset:12288
    v_mfma_f32_16x16x32_bf16 v[144:147], v[96:99], v[28:31], v[144:147]
    ds_read_b64_tr_b16 v[90:91], v124 offset:12544
    s_add_u32 m0, s51, 49152
    s_mov_b32 s73, 516096
    buffer_load_dwordx4 v123, s[12:15], s73 offen lds
    v_mfma_f32_16x16x32_bf16 v[168:171], v[96:99], v[32:35], v[168:171]
    ds_read_b64_tr_b16 v[92:93], v125 offset:12288
    v_mfma_f32_16x16x32_bf16 v[148:151], v[100:103], v[28:31], v[148:151]
    ds_read_b64_tr_b16 v[94:95], v125 offset:12544
    v_mfma_f32_16x16x32_bf16 v[172:175], v[100:103], v[32:35], v[172:175]
    ds_read_b64_tr_b16 v[96:97], v124 offset:14336
    s_waitcnt lgkmcnt(8)
    v_mfma_f32_16x16x32_bf16 v[152:155], v[28:31], v[104:107], v[152:155]
    ds_read_b64_tr_b16 v[98:99], v124 offset:14592
    v_mfma_f32_16x16x32_bf16 v[176:179], v[32:35], v[104:107], v[176:179]
    ds_read_b64_tr_b16 v[100:101], v125 offset:14336
    s_add_u32 m0, s51, 51200
    s_mov_b32 s73, 516992
    buffer_load_dwordx4 v123, s[12:15], s73 offen lds
    v_mfma_f32_16x16x32_bf16 v[156:159], v[28:31], v[108:111], v[156:159]
    ds_read_b64_tr_b16 v[102:103], v125 offset:14592
    v_mfma_f32_16x16x32_bf16 v[180:183], v[32:35], v[108:111], v[180:183]
    ds_read_b64_tr_b16 v[104:105], v124 offset:16384
    v_mfma_f32_16x16x32_bf16 v[184:187], v[112:115], v[36:39], v[184:187]
    ds_read_b64_tr_b16 v[106:107], v124 offset:16640
    v_mfma_f32_16x16x32_bf16 v[188:191], v[116:119], v[36:39], v[188:191]
    ds_read_b64_tr_b16 v[108:109], v125 offset:16384
    v_mfma_f32_16x16x32_bf16 v[48:51], v[28:31], v[28:31], v[48:51]
    ds_read_b64_tr_b16 v[110:111], v125 offset:16640
    s_add_u32 m0, s51, 53248
    s_mov_b32 s73, 517888
    buffer_load_dwordx4 v123, s[12:15], s73 offen lds
    v_mfma_f32_16x16x32_bf16 v[52:55], v[32:35], v[32:35], v[52:55]
    ds_read_b64_tr_b16 v[112:113], v126 offset:12288
    v_mfma_f32_16x16x32_bf16 v[56:59], v[36:39], v[36:39], v[56:59]
    ds_read_b64_tr_b16 v[114:115], v126 offset:12544
    v_mfma_f32_16x16x32_bf16 v[60:63], v[40:43], v[28:31], v[60:63]
    ds_read_b64_tr_b16 v[116:117], v127 offset:12288
    v_mfma_f32_16x16x32_bf16 v[64:67], v[40:43], v[32:35], v[64:67]
    ds_read_b64_tr_b16 v[118:119], v127 offset:12544
    v_mfma_f32_16x16x32_bf16 v[68:71], v[40:43], v[36:39], v[68:71]
    s_add_u32 m0, s52, 55296
    s_mov_b32 s73, 384
    buffer_load_dwordx4 v120, s[8:11], s73 offen lds
    s_waitcnt lgkmcnt(8)
    v_mfma_f32_16x16x32_bf16 v[136:139], v[88:91], v[16:19], v[136:139]
    ds_read_b128 v[28:31], v129 offset:18432
    v_mfma_f32_16x16x32_bf16 v[160:163], v[88:91], v[20:23], v[160:163]
    ds_read_b128 v[32:35], v129 offset:20480
    v_mfma_f32_16x16x32_bf16 v[140:143], v[92:95], v[16:19], v[140:143]
    ds_read_b128 v[36:39], v131 offset:18432
    v_mfma_f32_16x16x32_bf16 v[164:167], v[92:95], v[20:23], v[164:167]
    ds_read_b64_tr_b16 v[88:89], v124 offset:18432
    v_mfma_f32_16x16x32_bf16 v[144:147], v[96:99], v[16:19], v[144:147]
    ds_read_b64_tr_b16 v[90:91], v124 offset:18688
    s_add_u32 m0, s52, 56320
    s_mov_b32 s73, 384
    buffer_load_dwordx4 v121, s[8:11], s73 offen lds
    v_mfma_f32_16x16x32_bf16 v[168:171], v[96:99], v[20:23], v[168:171]
    ds_read_b64_tr_b16 v[92:93], v125 offset:18432
    v_mfma_f32_16x16x32_bf16 v[148:151], v[100:103], v[16:19], v[148:151]
    ds_read_b64_tr_b16 v[94:95], v125 offset:18688
    v_mfma_f32_16x16x32_bf16 v[172:175], v[100:103], v[20:23], v[172:175]
    ds_read_b64_tr_b16 v[96:97], v124 offset:20480
    s_waitcnt lgkmcnt(8)
    v_mfma_f32_16x16x32_bf16 v[152:155], v[16:19], v[104:107], v[152:155]
    ds_read_b64_tr_b16 v[98:99], v124 offset:20736
    v_mfma_f32_16x16x32_bf16 v[176:179], v[20:23], v[104:107], v[176:179]
    ds_read_b64_tr_b16 v[100:101], v125 offset:20480
    s_add_u32 m0, s52, 57344
    s_mov_b32 s73, 14720
    buffer_load_dwordx4 v120, s[8:11], s73 offen lds
    v_mfma_f32_16x16x32_bf16 v[156:159], v[16:19], v[108:111], v[156:159]
    ds_read_b64_tr_b16 v[102:103], v125 offset:20736
    v_mfma_f32_16x16x32_bf16 v[180:183], v[20:23], v[108:111], v[180:183]
    ds_read_b64_tr_b16 v[104:105], v124 offset:22528
    v_mfma_f32_16x16x32_bf16 v[184:187], v[112:115], v[24:27], v[184:187]
    ds_read_b64_tr_b16 v[106:107], v124 offset:22784
    v_mfma_f32_16x16x32_bf16 v[188:191], v[116:119], v[24:27], v[188:191]
    ds_read_b64_tr_b16 v[108:109], v125 offset:22528
    v_mfma_f32_16x16x32_bf16 v[48:51], v[16:19], v[16:19], v[48:51]
    ds_read_b64_tr_b16 v[110:111], v125 offset:22784
    s_add_u32 m0, s52, 58368
    s_mov_b32 s73, 14720
    buffer_load_dwordx4 v121, s[8:11], s73 offen lds
    v_mfma_f32_16x16x32_bf16 v[52:55], v[20:23], v[20:23], v[52:55]
    ds_read_b64_tr_b16 v[112:113], v126 offset:18432
    v_mfma_f32_16x16x32_bf16 v[56:59], v[24:27], v[24:27], v[56:59]
    ds_read_b64_tr_b16 v[114:115], v126 offset:18688
    v_mfma_f32_16x16x32_bf16 v[60:63], v[40:43], v[16:19], v[60:63]
    ds_read_b64_tr_b16 v[116:117], v127 offset:18432
    v_mfma_f32_16x16x32_bf16 v[64:67], v[40:43], v[20:23], v[64:67]
    ds_read_b64_tr_b16 v[118:119], v127 offset:18688
    v_mfma_f32_16x16x32_bf16 v[68:71], v[40:43], v[24:27], v[68:71]
    s_add_u32 m0, s7, 116736
    s_mov_b32 s73, 384
    s_mov_b64 exec, s[54:55]
    buffer_load_dwordx4 v122, s[8:11], s73 offen lds
    s_mov_b64 exec, -1
    s_waitcnt vmcnt(8)
    s_barrier
    s_waitcnt lgkmcnt(8)
    v_mfma_f32_16x16x32_bf16 v[136:139], v[88:91], v[28:31], v[136:139]
    ds_read_b128 v[16:19], v128 offset:0
    v_mfma_f32_16x16x32_bf16 v[160:163], v[88:91], v[32:35], v[160:163]
    ds_read_b128 v[20:23], v128 offset:2048
    v_mfma_f32_16x16x32_bf16 v[140:143], v[92:95], v[28:31], v[140:143]
    ds_read_b128 v[24:27], v130 offset:0
    v_mfma_f32_16x16x32_bf16 v[164:167], v[92:95], v[32:35], v[164:167]
    ds_read_b64_tr_b16 v[88:89], v124 offset:24576
    v_mfma_f32_16x16x32_bf16 v[144:147], v[96:99], v[28:31], v[144:147]
    ds_read_b64_tr_b16 v[90:91], v124 offset:24832
    s_add_u32 m0, s51, 12288
    s_mov_b32 s73, 688128
    buffer_load_dwordx4 v123, s[12:15], s73 offen lds
    v_mfma_f32_16x16x32_bf16 v[168:171], v[96:99], v[32:35], v[168:171]
    ds_read_b64_tr_b16 v[92:93], v125 offset:24576
    v_mfma_f32_16x16x32_bf16 v[148:151], v[100:103], v[28:31], v[148:151]
    ds_read_b64_tr_b16 v[94:95], v125 offset:24832
    v_mfma_f32_16x16x32_bf16 v[172:175], v[100:103], v[32:35], v[172:175]
    ds_read_b64_tr_b16 v[96:97], v124 offset:26624
    s_waitcnt lgkmcnt(8)
    v_mfma_f32_16x16x32_bf16 v[152:155], v[28:31], v[104:107], v[152:155]
    ds_read_b64_tr_b16 v[98:99], v124 offset:26880
    v_mfma_f32_16x16x32_bf16 v[176:179], v[32:35], v[104:107], v[176:179]
    ds_read_b64_tr_b16 v[100:101], v125 offset:26624
    s_add_u32 m0, s51, 14336
    s_mov_b32 s73, 689024
    buffer_load_dwordx4 v123, s[12:15], s73 offen lds
    v_mfma_f32_16x16x32_bf16 v[156:159], v[28:31], v[108:111], v[156:159]
    ds_read_b64_tr_b16 v[102:103], v125 offset:26880
    v_mfma_f32_16x16x32_bf16 v[180:183], v[32:35], v[108:111], v[180:183]
    ds_read_b64_tr_b16 v[104:105], v124 offset:28672
    v_mfma_f32_16x16x32_bf16 v[184:187], v[112:115], v[36:39], v[184:187]
    ds_read_b64_tr_b16 v[106:107], v124 offset:28928
    v_mfma_f32_16x16x32_bf16 v[188:191], v[116:119], v[36:39], v[188:191]
    ds_read_b64_tr_b16 v[108:109], v125 offset:28672
    v_mfma_f32_16x16x32_bf16 v[48:51], v[28:31], v[28:31], v[48:51]
    ds_read_b64_tr_b16 v[110:111], v125 offset:28928
    s_add_u32 m0, s51, 16384
    s_mov_b32 s73, 689920
    buffer_load_dwordx4 v123, s[12:15], s73 offen lds
    v_mfma_f32_16x16x32_bf16 v[52:55], v[32:35], v[32:35], v[52:55]
    ds_read_b64_tr_b16 v[112:113], v126 offset:24576
    v_mfma_f32_16x16x32_bf16 v[56:59], v[36:39], v[36:39], v[56:59]
    ds_read_b64_tr_b16 v[114:115], v126 offset:24832
    v_mfma_f32_16x16x32_bf16 v[60:63], v[40:43], v[28:31], v[60:63]
    ds_read_b64_tr_b16 v[116:117], v127 offset:24576
    v_mfma_f32_16x16x32_bf16 v[64:67], v[40:43], v[32:35], v[64:67]
    ds_read_b64_tr_b16 v[118:119], v127 offset:24832
    v_mfma_f32_16x16x32_bf16 v[68:71], v[40:43], v[36:39], v[68:71]
    s_add_u32 m0, s52, 36864
    s_mov_b32 s73, 512
    buffer_load_dwordx4 v120, s[8:11], s73 offen lds
    s_waitcnt lgkmcnt(8)
    v_mfma_f32_16x16x32_bf16 v[136:139], v[88:91], v[16:19], v[136:139]
    ds_read_b128 v[28:31], v129 offset:0
    v_mfma_f32_16x16x32_bf16 v[160:163], v[88:91], v[20:23], v[160:163]
    ds_read_b128 v[32:35], v129 offset:2048
    v_mfma_f32_16x16x32_bf16 v[140:143], v[92:95], v[16:19], v[140:143]
    ds_read_b128 v[36:39], v131 offset:0
    v_mfma_f32_16x16x32_bf16 v[164:167], v[92:95], v[20:23], v[164:167]
    ds_read_b64_tr_b16 v[88:89], v124 offset:30720
    v_mfma_f32_16x16x32_bf16 v[144:147], v[96:99], v[16:19], v[144:147]
    ds_read_b64_tr_b16 v[90:91], v124 offset:30976
    s_add_u32 m0, s52, 37888
    s_mov_b32 s73, 512
    buffer_load_dwordx4 v121, s[8:11], s73 offen lds
    v_mfma_f32_16x16x32_bf16 v[168:171], v[96:99], v[20:23], v[168:171]
    ds_read_b64_tr_b16 v[92:93], v125 offset:30720
    v_mfma_f32_16x16x32_bf16 v[148:151], v[100:103], v[16:19], v[148:151]
    ds_read_b64_tr_b16 v[94:95], v125 offset:30976
    v_mfma_f32_16x16x32_bf16 v[172:175], v[100:103], v[20:23], v[172:175]
    ds_read_b64_tr_b16 v[96:97], v124 offset:32768
    s_waitcnt lgkmcnt(8)
    v_mfma_f32_16x16x32_bf16 v[152:155], v[16:19], v[104:107], v[152:155]
    ds_read_b64_tr_b16 v[98:99], v124 offset:33024
    v_mfma_f32_16x16x32_bf16 v[176:179], v[20:23], v[104:107], v[176:179]
    ds_read_b64_tr_b16 v[100:101], v125 offset:32768
    s_add_u32 m0, s52, 38912
    s_mov_b32 s73, 14848
    buffer_load_dwordx4 v120, s[8:11], s73 offen lds
    v_mfma_f32_16x16x32_bf16 v[156:159], v[16:19], v[108:111], v[156:159]
    ds_read_b64_tr_b16 v[102:103], v125 offset:33024
    v_mfma_f32_16x16x32_bf16 v[180:183], v[20:23], v[108:111], v[180:183]
    ds_read_b64_tr_b16 v[104:105], v124 offset:34816
    v_mfma_f32_16x16x32_bf16 v[184:187], v[112:115], v[24:27], v[184:187]
    ds_read_b64_tr_b16 v[106:107], v124 offset:35072
    v_mfma_f32_16x16x32_bf16 v[188:191], v[116:119], v[24:27], v[188:191]
    ds_read_b64_tr_b16 v[108:109], v125 offset:34816
    v_mfma_f32_16x16x32_bf16 v[48:51], v[16:19], v[16:19], v[48:51]
    ds_read_b64_tr_b16 v[110:111], v125 offset:35072
    s_add_u32 m0, s52, 39936
    s_mov_b32 s73, 14848
    buffer_load_dwordx4 v121, s[8:11], s73 offen lds
    v_mfma_f32_16x16x32_bf16 v[52:55], v[20:23], v[20:23], v[52:55]
    ds_read_b64_tr_b16 v[112:113], v126 offset:30720
    v_mfma_f32_16x16x32_bf16 v[56:59], v[24:27], v[24:27], v[56:59]
    ds_read_b64_tr_b16 v[114:115], v126 offset:30976
    v_mfma_f32_16x16x32_bf16 v[60:63], v[40:43], v[16:19], v[60:63]
    ds_read_b64_tr_b16 v[116:117], v127 offset:30720
    v_mfma_f32_16x16x32_bf16 v[64:67], v[40:43], v[20:23], v[64:67]
    ds_read_b64_tr_b16 v[118:119], v127 offset:30976
    v_mfma_f32_16x16x32_bf16 v[68:71], v[40:43], v[24:27], v[68:71]
    s_add_u32 m0, s7, 98304
    s_mov_b32 s73, 512
    s_mov_b64 exec, s[54:55]
    buffer_load_dwordx4 v122, s[8:11], s73 offen lds
    s_mov_b64 exec, -1
    s_waitcnt vmcnt(8)
    s_barrier
    s_waitcnt lgkmcnt(8)
    v_mfma_f32_16x16x32_bf16 v[136:139], v[88:91], v[28:31], v[136:139]
    ds_read_b128 v[16:19], v128 offset:55296
    v_mfma_f32_16x16x32_bf16 v[160:163], v[88:91], v[32:35], v[160:163]
    ds_read_b128 v[20:23], v128 offset:57344
    v_mfma_f32_16x16x32_bf16 v[140:143], v[92:95], v[28:31], v[140:143]
    ds_read_b128 v[24:27], v130 offset:55296
    v_mfma_f32_16x16x32_bf16 v[164:167], v[92:95], v[32:35], v[164:167]
    ds_read_b64_tr_b16 v[88:89], v124 offset:36864
    v_mfma_f32_16x16x32_bf16 v[144:147], v[96:99], v[28:31], v[144:147]
    ds_read_b64_tr_b16 v[90:91], v124 offset:37120
    s_add_u32 m0, s51, 24576
    s_mov_b32 s73, 860160
    buffer_load_dwordx4 v123, s[12:15], s73 offen lds
    v_mfma_f32_16x16x32_bf16 v[168:171], v[96:99], v[32:35], v[168:171]
    ds_read_b64_tr_b16 v[92:93], v125 offset:36864
    v_mfma_f32_16x16x32_bf16 v[148:151], v[100:103], v[28:31], v[148:151]
    ds_read_b64_tr_b16 v[94:95], v125 offset:37120
    v_mfma_f32_16x16x32_bf16 v[172:175], v[100:103], v[32:35], v[172:175]
    ds_read_b64_tr_b16 v[96:97], v124 offset:38912
    s_waitcnt lgkmcnt(8)
    v_mfma_f32_16x16x32_bf16 v[152:155], v[28:31], v[104:107], v[152:155]
    ds_read_b64_tr_b16 v[98:99], v124 offset:39168
    v_mfma_f32_16x16x32_bf16 v[176:179], v[32:35], v[104:107], v[176:179]
    ds_read_b64_tr_b16 v[100:101], v125 offset:38912
    s_add_u32 m0, s51, 26624
    s_mov_b32 s73, 861056
    buffer_load_dwordx4 v123, s[12:15], s73 offen lds
    v_mfma_f32_16x16x32_bf16 v[156:159], v[28:31], v[108:111], v[156:159]
    ds_read_b64_tr_b16 v[102:103], v125 offset:39168
    v_mfma_f32_16x16x32_bf16 v[180:183], v[32:35], v[108:111], v[180:183]
    ds_read_b64_tr_b16 v[104:105], v124 offset:40960
    v_mfma_f32_16x16x32_bf16 v[184:187], v[112:115], v[36:39], v[184:187]
    ds_read_b64_tr_b16 v[106:107], v124 offset:41216
    v_mfma_f32_16x16x32_bf16 v[188:191], v[116:119], v[36:39], v[188:191]
    ds_read_b64_tr_b16 v[108:109], v125 offset:40960
    v_mfma_f32_16x16x32_bf16 v[48:51], v[28:31], v[28:31], v[48:51]
    ds_read_b64_tr_b16 v[110:111], v125 offset:41216
    s_add_u32 m0, s51, 28672
    s_mov_b32 s73, 861952
    buffer_load_dwordx4 v123, s[12:15], s73 offen lds
    v_mfma_f32_16x16x32_bf16 v[52:55], v[32:35], v[32:35], v[52:55]
    ds_read_b64_tr_b16 v[112:113], v126 offset:36864
    v_mfma_f32_16x16x32_bf16 v[56:59], v[36:39], v[36:39], v[56:59]
    ds_read_b64_tr_b16 v[114:115], v126 offset:37120
    v_mfma_f32_16x16x32_bf16 v[60:63], v[40:43], v[28:31], v[60:63]
    ds_read_b64_tr_b16 v[116:117], v127 offset:36864
    v_mfma_f32_16x16x32_bf16 v[64:67], v[40:43], v[32:35], v[64:67]
    ds_read_b64_tr_b16 v[118:119], v127 offset:37120
    v_mfma_f32_16x16x32_bf16 v[68:71], v[40:43], v[36:39], v[68:71]
    s_add_u32 m0, s52, 18432
    s_mov_b32 s73, 640
    buffer_load_dwordx4 v120, s[8:11], s73 offen lds
    s_waitcnt lgkmcnt(8)
    v_mfma_f32_16x16x32_bf16 v[136:139], v[88:91], v[16:19], v[136:139]
    ds_read_b128 v[28:31], v129 offset:55296
    v_mfma_f32_16x16x32_bf16 v[160:163], v[88:91], v[20:23], v[160:163]
    ds_read_b128 v[32:35], v129 offset:57344
    v_mfma_f32_16x16x32_bf16 v[140:143], v[92:95], v[16:19], v[140:143]
    ds_read_b128 v[36:39], v131 offset:55296
    v_mfma_f32_16x16x32_bf16 v[164:167], v[92:95], v[20:23], v[164:167]
    ds_read_b64_tr_b16 v[88:89], v124 offset:43008
    v_mfma_f32_16x16x32_bf16 v[144:147], v[96:99], v[16:19], v[144:147]
    ds_read_b64_tr_b16 v[90:91], v124 offset:43264
    s_add_u32 m0, s52, 19456
    s_mov_b32 s73, 640
    buffer_load_dwordx4 v121, s[8:11], s73 offen lds
    v_mfma_f32_16x16x32_bf16 v[168:171], v[96:99], v[20:23], v[168:171]
    ds_read_b64_tr_b16 v[92:93], v125 offset:43008
    v_mfma_f32_16x16x32_bf16 v[148:151], v[100:103], v[16:19], v[148:151]
    ds_read_b64_tr_b16 v[94:95], v125 offset:43264
    v_mfma_f32_16x16x32_bf16 v[172:175], v[100:103], v[20:23], v[172:175]
    ds_read_b64_tr_b16 v[96:97], v124 offset:45056
    s_waitcnt lgkmcnt(8)
    v_mfma_f32_16x16x32_bf16 v[152:155], v[16:19], v[104:107], v[152:155]
    ds_read_b64_tr_b16 v[98:99], v124 offset:45312
    v_mfma_f32_16x16x32_bf16 v[176:179], v[20:23], v[104:107], v[176:179]
    ds_read_b64_tr_b16 v[100:101], v125 offset:45056
    s_add_u32 m0, s52, 20480
    s_mov_b32 s73, 14976
    buffer_load_dwordx4 v120, s[8:11], s73 offen lds
    v_mfma_f32_16x16x32_bf16 v[156:159], v[16:19], v[108:111], v[156:159]
    ds_read_b64_tr_b16 v[102:103], v125 offset:45312
    v_mfma_f32_16x16x32_bf16 v[180:183], v[20:23], v[108:111], v[180:183]
    ds_read_b64_tr_b16 v[104:105], v124 offset:47104
    v_mfma_f32_16x16x32_bf16 v[184:187], v[112:115], v[24:27], v[184:187]
    ds_read_b64_tr_b16 v[106:107], v124 offset:47360
    v_mfma_f32_16x16x32_bf16 v[188:191], v[116:119], v[24:27], v[188:191]
    ds_read_b64_tr_b16 v[108:109], v125 offset:47104
    v_mfma_f32_16x16x32_bf16 v[48:51], v[16:19], v[16:19], v[48:51]
    ds_read_b64_tr_b16 v[110:111], v125 offset:47360
    s_add_u32 m0, s52, 21504
    s_mov_b32 s73, 14976
    buffer_load_dwordx4 v121, s[8:11], s73 offen lds
    v_mfma_f32_16x16x32_bf16 v[52:55], v[20:23], v[20:23], v[52:55]
    ds_read_b64_tr_b16 v[112:113], v126 offset:43008
    v_mfma_f32_16x16x32_bf16 v[56:59], v[24:27], v[24:27], v[56:59]
    ds_read_b64_tr_b16 v[114:115], v126 offset:43264
    v_mfma_f32_16x16x32_bf16 v[60:63], v[40:43], v[16:19], v[60:63]
    ds_read_b64_tr_b16 v[116:117], v127 offset:43008
    v_mfma_f32_16x16x32_bf16 v[64:67], v[40:43], v[20:23], v[64:67]
    ds_read_b64_tr_b16 v[118:119], v127 offset:43264
    v_mfma_f32_16x16x32_bf16 v[68:71], v[40:43], v[24:27], v[68:71]
    s_add_u32 m0, s7, 79872
    s_mov_b32 s73, 640
    s_mov_b64 exec, s[54:55]
    buffer_load_dwordx4 v122, s[8:11], s73 offen lds
    s_mov_b64 exec, -1
    s_waitcnt vmcnt(8)
    s_barrier
    s_waitcnt lgkmcnt(8)
    v_mfma_f32_16x16x32_bf16 v[136:139], v[88:91], v[28:31], v[136:139]
    ds_read_b128 v[16:19], v128 offset:36864
    v_mfma_f32_16x16x32_bf16 v[160:163], v[88:91], v[32:35], v[160:163]
    ds_read_b128 v[20:23], v128 offset:38912
    v_mfma_f32_16x16x32_bf16 v[140:143], v[92:95], v[28:31], v[140:143]
    ds_read_b128 v[24:27], v130 offset:36864
    v_mfma_f32_16x16x32_bf16 v[164:167], v[92:95], v[32:35], v[164:167]
    ds_read_b64_tr_b16 v[88:89], v124 offset:0
    v_mfma_f32_16x16x32_bf16 v[144:147], v[96:99], v[28:31], v[144:147]
    ds_read_b64_tr_b16 v[90:91], v124 offset:256
    s_add_u32 m0, s51, 36864
    s_mov_b32 s73, 1032192
    buffer_load_dwordx4 v123, s[12:15], s73 offen lds
    v_mfma_f32_16x16x32_bf16 v[168:171], v[96:99], v[32:35], v[168:171]
    ds_read_b64_tr_b16 v[92:93], v125 offset:0
    v_mfma_f32_16x16x32_bf16 v[148:151], v[100:103], v[28:31], v[148:151]
    ds_read_b64_tr_b16 v[94:95], v125 offset:256
    v_mfma_f32_16x16x32_bf16 v[172:175], v[100:103], v[32:35], v[172:175]
    ds_read_b64_tr_b16 v[96:97], v124 offset:2048
    s_waitcnt lgkmcnt(8)
    v_mfma_f32_16x16x32_bf16 v[152:155], v[28:31], v[104:107], v[152:155]
    ds_read_b64_tr_b16 v[98:99], v124 offset:2304
    v_mfma_f32_16x16x32_bf16 v[176:179], v[32:35], v[104:107], v[176:179]
    ds_read_b64_tr_b16 v[100:101], v125 offset:2048
    s_add_u32 m0, s51, 38912
    s_mov_b32 s73, 1033088
    buffer_load_dwordx4 v123, s[12:15], s73 offen lds
    v_mfma_f32_16x16x32_bf16 v[156:159], v[28:31], v[108:111], v[156:159]
    ds_read_b64_tr_b16 v[102:103], v125 offset:2304
    v_mfma_f32_16x16x32_bf16 v[180:183], v[32:35], v[108:111], v[180:183]
    ds_read_b64_tr_b16 v[104:105], v124 offset:4096
    v_mfma_f32_16x16x32_bf16 v[184:187], v[112:115], v[36:39], v[184:187]
    ds_read_b64_tr_b16 v[106:107], v124 offset:4352
    v_mfma_f32_16x16x32_bf16 v[188:191], v[116:119], v[36:39], v[188:191]
    ds_read_b64_tr_b16 v[108:109], v125 offset:4096
    v_mfma_f32_16x16x32_bf16 v[48:51], v[28:31], v[28:31], v[48:51]
    ds_read_b64_tr_b16 v[110:111], v125 offset:4352
    s_add_u32 m0, s51, 40960
    s_mov_b32 s73, 1033984
    buffer_load_dwordx4 v123, s[12:15], s73 offen lds
    v_mfma_f32_16x16x32_bf16 v[52:55], v[32:35], v[32:35], v[52:55]
    ds_read_b64_tr_b16 v[112:113], v126 offset:0
    v_mfma_f32_16x16x32_bf16 v[56:59], v[36:39], v[36:39], v[56:59]
    ds_read_b64_tr_b16 v[114:115], v126 offset:256
    v_mfma_f32_16x16x32_bf16 v[60:63], v[40:43], v[28:31], v[60:63]
    ds_read_b64_tr_b16 v[116:117], v127 offset:0
    v_mfma_f32_16x16x32_bf16 v[64:67], v[40:43], v[32:35], v[64:67]
    ds_read_b64_tr_b16 v[118:119], v127 offset:256
    v_mfma_f32_16x16x32_bf16 v[68:71], v[40:43], v[36:39], v[68:71]
    s_add_u32 m0, s52, 0
    s_mov_b32 s73, 768
    buffer_load_dwordx4 v120, s[8:11], s73 offen lds
    s_waitcnt lgkmcnt(8)
    v_mfma_f32_16x16x32_bf16 v[136:139], v[88:91], v[16:19], v[136:139]
    ds_read_b128 v[28:31], v129 offset:36864
    v_mfma_f32_16x16x32_bf16 v[160:163], v[88:91], v[20:23], v[160:163]
    ds_read_b128 v[32:35], v129 offset:38912
    v_mfma_f32_16x16x32_bf16 v[140:143], v[92:95], v[16:19], v[140:143]
    ds_read_b128 v[36:39], v131 offset:36864
    v_mfma_f32_16x16x32_bf16 v[164:167], v[92:95], v[20:23], v[164:167]
    ds_read_b64_tr_b16 v[88:89], v124 offset:6144
    v_mfma_f32_16x16x32_bf16 v[144:147], v[96:99], v[16:19], v[144:147]
    ds_read_b64_tr_b16 v[90:91], v124 offset:6400
    s_add_u32 m0, s52, 1024
    s_mov_b32 s73, 768
    buffer_load_dwordx4 v121, s[8:11], s73 offen lds
    v_mfma_f32_16x16x32_bf16 v[168:171], v[96:99], v[20:23], v[168:171]
    ds_read_b64_tr_b16 v[92:93], v125 offset:6144
    v_mfma_f32_16x16x32_bf16 v[148:151], v[100:103], v[16:19], v[148:151]
    ds_read_b64_tr_b16 v[94:95], v125 offset:6400
    v_mfma_f32_16x16x32_bf16 v[172:175], v[100:103], v[20:23], v[172:175]
    ds_read_b64_tr_b16 v[96:97], v124 offset:8192
    s_waitcnt lgkmcnt(8)
    v_mfma_f32_16x16x32_bf16 v[152:155], v[16:19], v[104:107], v[152:155]
    ds_read_b64_tr_b16 v[98:99], v124 offset:8448
    v_mfma_f32_16x16x32_bf16 v[176:179], v[20:23], v[104:107], v[176:179]
    ds_read_b64_tr_b16 v[100:101], v125 offset:8192
    s_add_u32 m0, s52, 2048
    s_mov_b32 s73, 15104
    buffer_load_dwordx4 v120, s[8:11], s73 offen lds
    v_mfma_f32_16x16x32_bf16 v[156:159], v[16:19], v[108:111], v[156:159]
    ds_read_b64_tr_b16 v[102:103], v125 offset:8448
    v_mfma_f32_16x16x32_bf16 v[180:183], v[20:23], v[108:111], v[180:183]
    ds_read_b64_tr_b16 v[104:105], v124 offset:10240
    v_mfma_f32_16x16x32_bf16 v[184:187], v[112:115], v[24:27], v[184:187]
    ds_read_b64_tr_b16 v[106:107], v124 offset:10496
    v_mfma_f32_16x16x32_bf16 v[188:191], v[116:119], v[24:27], v[188:191]
    ds_read_b64_tr_b16 v[108:109], v125 offset:10240
    v_mfma_f32_16x16x32_bf16 v[48:51], v[16:19], v[16:19], v[48:51]
    ds_read_b64_tr_b16 v[110:111], v125 offset:10496
    s_add_u32 m0, s52, 3072
    s_mov_b32 s73, 15104
    buffer_load_dwordx4 v121, s[8:11], s73 offen lds
    v_mfma_f32_16x16x32_bf16 v[52:55], v[20:23], v[20:23], v[52:55]
    ds_read_b64_tr_b16 v[112:113], v126 offset:6144
    v_mfma_f32_16x16x32_bf16 v[56:59], v[24:27], v[24:27], v[56:59]
    ds_read_b64_tr_b16 v[114:115], v126 offset:6400
    v_mfma_f32_16x16x32_bf16 v[60:63], v[40:43], v[16:19], v[60:63]
    ds_read_b64_tr_b16 v[116:117], v127 offset:6144
    v_mfma_f32_16x16x32_bf16 v[64:67], v[40:43], v[20:23], v[64:67]
    ds_read_b64_tr_b16 v[118:119], v127 offset:6400
    v_mfma_f32_16x16x32_bf16 v[68:71], v[40:43], v[24:27], v[68:71]
    s_add_u32 m0, s7, 61440
    s_mov_b32 s73, 768
    s_mov_b64 exec, s[54:55]
    buffer_load_dwordx4 v122, s[8:11], s73 offen lds
    s_mov_b64 exec, -1
    v_mov_b32 v7, 0
    buffer_load_dword v6, v7, s[44:47], 0 offen sc1
    v_lshrrev_b32 v221, 5, v1
    v_mul_u32_u24 v221, 3584, v221
    v_and_b32 v222, 31, v1
    v_lshl_add_u32 v221, v222, 1, v221
    s_lshl_b32 s58, s67, 1
    s_lshr_b32 s60, s3, 1
    s_add_u32 s58, s58, s60
    s_mul_i32 s58, s58, 28672
    s_lshl_b32 s60, s66, 7
    s_add_u32 s58, s58, s60
    s_and_b32 s60, s3, 1
    s_lshl_b32 s60, s60, 6
    s_add_u32 s58, s58, s60
    buffer_load_ushort v192, v221, s[8:11], s58 offen offset:0
    buffer_load_ushort v193, v221, s[8:11], s58 offen offset:896
    buffer_load_ushort v194, v221, s[8:11], s58 offen offset:1792
    buffer_load_ushort v195, v221, s[8:11], s58 offen offset:2688
    s_add_u32 s58, s58, 7168
    buffer_load_ushort v196, v221, s[8:11], s58 offen offset:0
    buffer_load_ushort v197, v221, s[8:11], s58 offen offset:896
    buffer_load_ushort v198, v221, s[8:11], s58 offen offset:1792
    buffer_load_ushort v199, v221, s[8:11], s58 offen offset:2688
    s_add_u32 s58, s58, 7168
    buffer_load_ushort v200, v221, s[8:11], s58 offen offset:0
    buffer_load_ushort v201, v221, s[8:11], s58 offen offset:896
    buffer_load_ushort v202, v221, s[8:11], s58 offen offset:1792
    buffer_load_ushort v203, v221, s[8:11], s58 offen offset:2688
    s_add_u32 s58, s58, 7168
    buffer_load_ushort v204, v221, s[8:11], s58 offen offset:0
    buffer_load_ushort v205, v221, s[8:11], s58 offen offset:896
    buffer_load_ushort v206, v221, s[8:11], s58 offen offset:1792
    buffer_load_ushort v207, v221, s[8:11], s58 offen offset:2688
    s_lshr_b32 s68, s2, 3
    s_lshl_b32 s68, s68, 2
    s_add_u32 s68, s68, s3
    v_lshlrev_b32 v219, 7, v1
    s_mul_i32 s86, s68, 3200
    s_mov_b64 exec, 0x1ffffff
    buffer_load_dword v234, v219, s[16:19], s86 offen
    s_mov_b64 exec, -1
    v_lshrrev_b32 v219, 2, v1
    v_mul_u32_u24 v219, 3584, v219
    v_and_b32 v220, 3, v1
    v_lshl_add_u32 v219, v220, 7, v219
    s_mul_i32 s68, s68, 57344
    s_and_b32 s69, s2, 7
    s_mul_i32 s86, s69, 3
    s_add_u32 s86, s86, 4
    s_lshl_b32 s87, s69, 2
    s_min_u32 s86, s86, s87
    s_lshl_b32 s86, s86, 7
    s_add_u32 s86, s86, s68
    s_cmp_lt_u32 s69, 4
    s_cselect_b32 exec_lo, -1, 0x77777777
    s_cselect_b32 exec_hi, -1, 0x77777777
    buffer_load_dword v235, v219, s[20:23], s86 offen
    s_mov_b64 exec, -1
    s_waitcnt vmcnt(27)
    s_barrier
    s_waitcnt lgkmcnt(8)
    v_mfma_f32_16x16x32_bf16 v[136:139], v[88:91], v[28:31], v[136:139]
    ds_read_b128 v[16:19], v128 offset:18432
    v_mfma_f32_16x16x32_bf16 v[160:163], v[88:91], v[32:35], v[160:163]
    ds_read_b128 v[20:23], v128 offset:20480
    v_mfma_f32_16x16x32_bf16 v[140:143], v[92:95], v[28:31], v[140:143]
    ds_read_b128 v[24:27], v130 offset:18432
    v_mfma_f32_16x16x32_bf16 v[164:167], v[92:95], v[32:35], v[164:167]
    ds_read_b64_tr_b16 v[88:89], v124 offset:12288
    v_mfma_f32_16x16x32_bf16 v[144:147], v[96:99], v[28:31], v[144:147]
    ds_read_b64_tr_b16 v[90:91], v124 offset:12544
    v_mfma_f32_16x16x32_bf16 v[168:171], v[96:99], v[32:35], v[168:171]
    ds_read_b64_tr_b16 v[92:93], v125 offset:12288
    v_mfma_f32_16x16x32_bf16 v[148:151], v[100:103], v[28:31], v[148:151]
    ds_read_b64_tr_b16 v[94:95], v125 offset:12544
    v_mfma_f32_16x16x32_bf16 v[172:175], v[100:103], v[32:35], v[172:175]
    ds_read_b64_tr_b16 v[96:97], v124 offset:14336
    s_waitcnt lgkmcnt(8)
    v_mfma_f32_16x16x32_bf16 v[152:155], v[28:31], v[104:107], v[152:155]
    ds_read_b64_tr_b16 v[98:99], v124 offset:14592
    v_mfma_f32_16x16x32_bf16 v[176:179], v[32:35], v[104:107], v[176:179]
    ds_read_b64_tr_b16 v[100:101], v125 offset:14336
    v_mfma_f32_16x16x32_bf16 v[156:159], v[28:31], v[108:111], v[156:159]
    ds_read_b64_tr_b16 v[102:103], v125 offset:14592
    v_mfma_f32_16x16x32_bf16 v[180:183], v[32:35], v[108:111], v[180:183]
    ds_read_b64_tr_b16 v[104:105], v124 offset:16384
    v_mfma_f32_16x16x32_bf16 v[184:187], v[112:115], v[36:39], v[184:187]
    ds_read_b64_tr_b16 v[106:107], v124 offset:16640
    v_mfma_f32_16x16x32_bf16 v[188:191], v[116:119], v[36:39], v[188:191]
    ds_read_b64_tr_b16 v[108:109], v125 offset:16384
    v_mfma_f32_16x16x32_bf16 v[48:51], v[28:31], v[28:31], v[48:51]
    ds_read_b64_tr_b16 v[110:111], v125 offset:16640
    v_mfma_f32_16x16x32_bf16 v[52:55], v[32:35], v[32:35], v[52:55]
    ds_read_b64_tr_b16 v[112:113], v126 offset:12288
    v_mfma_f32_16x16x32_bf16 v[56:59], v[36:39], v[36:39], v[56:59]
    ds_read_b64_tr_b16 v[114:115], v126 offset:12544
    v_mfma_f32_16x16x32_bf16 v[60:63], v[40:43], v[28:31], v[60:63]
    ds_read_b64_tr_b16 v[116:117], v127 offset:12288
    v_mfma_f32_16x16x32_bf16 v[64:67], v[40:43], v[32:35], v[64:67]
    ds_read_b64_tr_b16 v[118:119], v127 offset:12544
    v_mfma_f32_16x16x32_bf16 v[68:71], v[40:43], v[36:39], v[68:71]
    s_waitcnt lgkmcnt(8)
    v_mfma_f32_16x16x32_bf16 v[136:139], v[88:91], v[16:19], v[136:139]
    ds_read_b128 v[28:31], v129 offset:18432
    v_mfma_f32_16x16x32_bf16 v[160:163], v[88:91], v[20:23], v[160:163]
    ds_read_b128 v[32:35], v129 offset:20480
    v_mfma_f32_16x16x32_bf16 v[140:143], v[92:95], v[16:19], v[140:143]
    ds_read_b128 v[36:39], v131 offset:18432
    v_mfma_f32_16x16x32_bf16 v[164:167], v[92:95], v[20:23], v[164:167]
    ds_read_b64_tr_b16 v[88:89], v124 offset:18432
    v_mfma_f32_16x16x32_bf16 v[144:147], v[96:99], v[16:19], v[144:147]
    ds_read_b64_tr_b16 v[90:91], v124 offset:18688
    v_mfma_f32_16x16x32_bf16 v[168:171], v[96:99], v[20:23], v[168:171]
    ds_read_b64_tr_b16 v[92:93], v125 offset:18432
    v_mfma_f32_16x16x32_bf16 v[148:151], v[100:103], v[16:19], v[148:151]
    ds_read_b64_tr_b16 v[94:95], v125 offset:18688
    v_mfma_f32_16x16x32_bf16 v[172:175], v[100:103], v[20:23], v[172:175]
    ds_read_b64_tr_b16 v[96:97], v124 offset:20480
    s_waitcnt lgkmcnt(8)
    v_mfma_f32_16x16x32_bf16 v[152:155], v[16:19], v[104:107], v[152:155]
    ds_read_b64_tr_b16 v[98:99], v124 offset:20736
    v_mfma_f32_16x16x32_bf16 v[176:179], v[20:23], v[104:107], v[176:179]
    ds_read_b64_tr_b16 v[100:101], v125 offset:20480
    v_mfma_f32_16x16x32_bf16 v[156:159], v[16:19], v[108:111], v[156:159]
    ds_read_b64_tr_b16 v[102:103], v125 offset:20736
    v_mfma_f32_16x16x32_bf16 v[180:183], v[20:23], v[108:111], v[180:183]
    ds_read_b64_tr_b16 v[104:105], v124 offset:22528
    v_mfma_f32_16x16x32_bf16 v[184:187], v[112:115], v[24:27], v[184:187]
    ds_read_b64_tr_b16 v[106:107], v124 offset:22784
    v_mfma_f32_16x16x32_bf16 v[188:191], v[116:119], v[24:27], v[188:191]
    ds_read_b64_tr_b16 v[108:109], v125 offset:22528
    v_mfma_f32_16x16x32_bf16 v[48:51], v[16:19], v[16:19], v[48:51]
    ds_read_b64_tr_b16 v[110:111], v125 offset:22784
    v_mfma_f32_16x16x32_bf16 v[52:55], v[20:23], v[20:23], v[52:55]
    ds_read_b64_tr_b16 v[112:113], v126 offset:18432
    v_mfma_f32_16x16x32_bf16 v[56:59], v[24:27], v[24:27], v[56:59]
    ds_read_b64_tr_b16 v[114:115], v126 offset:18688
    v_mfma_f32_16x16x32_bf16 v[60:63], v[40:43], v[16:19], v[60:63]
    ds_read_b64_tr_b16 v[116:117], v127 offset:18432
    v_mfma_f32_16x16x32_bf16 v[64:67], v[40:43], v[20:23], v[64:67]
    ds_read_b64_tr_b16 v[118:119], v127 offset:18688
    v_mfma_f32_16x16x32_bf16 v[68:71], v[40:43], v[24:27], v[68:71]
    s_waitcnt vmcnt(19)
    s_barrier
    s_waitcnt lgkmcnt(8)
    v_mfma_f32_16x16x32_bf16 v[136:139], v[88:91], v[28:31], v[136:139]
    ds_read_b128 v[16:19], v128 offset:0
    v_mfma_f32_16x16x32_bf16 v[160:163], v[88:91], v[32:35], v[160:163]
    ds_read_b128 v[20:23], v128 offset:2048
    v_mfma_f32_16x16x32_bf16 v[140:143], v[92:95], v[28:31], v[140:143]
    ds_read_b128 v[24:27], v130 offset:0
    v_mfma_f32_16x16x32_bf16 v[164:167], v[92:95], v[32:35], v[164:167]
    ds_read_b64_tr_b16 v[88:89], v124 offset:24576
    v_mfma_f32_16x16x32_bf16 v[144:147], v[96:99], v[28:31], v[144:147]
    ds_read_b64_tr_b16 v[90:91], v124 offset:24832
    v_mfma_f32_16x16x32_bf16 v[168:171], v[96:99], v[32:35], v[168:171]
    ds_read_b64_tr_b16 v[92:93], v125 offset:24576
    v_mfma_f32_16x16x32_bf16 v[148:151], v[100:103], v[28:31], v[148:151]
    ds_read_b64_tr_b16 v[94:95], v125 offset:24832
    v_mfma_f32_16x16x32_bf16 v[172:175], v[100:103], v[32:35], v[172:175]
    ds_read_b64_tr_b16 v[96:97], v124 offset:26624
    s_waitcnt lgkmcnt(8)
    v_mfma_f32_16x16x32_bf16 v[152:155], v[28:31], v[104:107], v[152:155]
    ds_read_b64_tr_b16 v[98:99], v124 offset:26880
    v_mfma_f32_16x16x32_bf16 v[176:179], v[32:35], v[104:107], v[176:179]
    ds_read_b64_tr_b16 v[100:101], v125 offset:26624
    v_mfma_f32_16x16x32_bf16 v[156:159], v[28:31], v[108:111], v[156:159]
    ds_read_b64_tr_b16 v[102:103], v125 offset:26880
    v_mfma_f32_16x16x32_bf16 v[180:183], v[32:35], v[108:111], v[180:183]
    ds_read_b64_tr_b16 v[104:105], v124 offset:28672
    v_mfma_f32_16x16x32_bf16 v[184:187], v[112:115], v[36:39], v[184:187]
    ds_read_b64_tr_b16 v[106:107], v124 offset:28928
    v_mfma_f32_16x16x32_bf16 v[188:191], v[116:119], v[36:39], v[188:191]
    ds_read_b64_tr_b16 v[108:109], v125 offset:28672
    v_mfma_f32_16x16x32_bf16 v[48:51], v[28:31], v[28:31], v[48:51]
    ds_read_b64_tr_b16 v[110:111], v125 offset:28928
    v_mfma_f32_16x16x32_bf16 v[52:55], v[32:35], v[32:35], v[52:55]
    ds_read_b64_tr_b16 v[112:113], v126 offset:24576
    v_mfma_f32_16x16x32_bf16 v[56:59], v[36:39], v[36:39], v[56:59]
    ds_read_b64_tr_b16 v[114:115], v126 offset:24832
    v_mfma_f32_16x16x32_bf16 v[60:63], v[40:43], v[28:31], v[60:63]
    ds_read_b64_tr_b16 v[116:117], v127 offset:24576
    v_mfma_f32_16x16x32_bf16 v[64:67], v[40:43], v[32:35], v[64:67]
    ds_read_b64_tr_b16 v[118:119], v127 offset:24832
    v_mfma_f32_16x16x32_bf16 v[68:71], v[40:43], v[36:39], v[68:71]
    s_waitcnt lgkmcnt(8)
    v_mfma_f32_16x16x32_bf16 v[136:139], v[88:91], v[16:19], v[136:139]
    ds_read_b128 v[28:31], v129 offset:0
    v_mfma_f32_16x16x32_bf16 v[160:163], v[88:91], v[20:23], v[160:163]
    ds_read_b128 v[32:35], v129 offset:2048
    v_mfma_f32_16x16x32_bf16 v[140:143], v[92:95], v[16:19], v[140:143]
    ds_read_b128 v[36:39], v131 offset:0
    v_mfma_f32_16x16x32_bf16 v[164:167], v[92:95], v[20:23], v[164:167]
    ds_read_b64_tr_b16 v[88:89], v124 offset:30720
    v_mfma_f32_16x16x32_bf16 v[144:147], v[96:99], v[16:19], v[144:147]
    ds_read_b64_tr_b16 v[90:91], v124 offset:30976
    v_mfma_f32_16x16x32_bf16 v[168:171], v[96:99], v[20:23], v[168:171]
    ds_read_b64_tr_b16 v[92:93], v125 offset:30720
    v_mfma_f32_16x16x32_bf16 v[148:151], v[100:103], v[16:19], v[148:151]
    ds_read_b64_tr_b16 v[94:95], v125 offset:30976
    v_mfma_f32_16x16x32_bf16 v[172:175], v[100:103], v[20:23], v[172:175]
    ds_read_b64_tr_b16 v[96:97], v124 offset:32768
    s_waitcnt lgkmcnt(8)
    v_mfma_f32_16x16x32_bf16 v[152:155], v[16:19], v[104:107], v[152:155]
    ds_read_b64_tr_b16 v[98:99], v124 offset:33024
    v_mfma_f32_16x16x32_bf16 v[176:179], v[20:23], v[104:107], v[176:179]
    ds_read_b64_tr_b16 v[100:101], v125 offset:32768
    v_mfma_f32_16x16x32_bf16 v[156:159], v[16:19], v[108:111], v[156:159]
    ds_read_b64_tr_b16 v[102:103], v125 offset:33024
    v_mfma_f32_16x16x32_bf16 v[180:183], v[20:23], v[108:111], v[180:183]
    ds_read_b64_tr_b16 v[104:105], v124 offset:34816
    v_mfma_f32_16x16x32_bf16 v[184:187], v[112:115], v[24:27], v[184:187]
    ds_read_b64_tr_b16 v[106:107], v124 offset:35072
    v_mfma_f32_16x16x32_bf16 v[188:191], v[116:119], v[24:27], v[188:191]
    ds_read_b64_tr_b16 v[108:109], v125 offset:34816
    v_mfma_f32_16x16x32_bf16 v[48:51], v[16:19], v[16:19], v[48:51]
    ds_read_b64_tr_b16 v[110:111], v125 offset:35072
    v_mfma_f32_16x16x32_bf16 v[52:55], v[20:23], v[20:23], v[52:55]
    ds_read_b64_tr_b16 v[112:113], v126 offset:30720
    v_mfma_f32_16x16x32_bf16 v[56:59], v[24:27], v[24:27], v[56:59]
    ds_read_b64_tr_b16 v[114:115], v126 offset:30976
    v_mfma_f32_16x16x32_bf16 v[60:63], v[40:43], v[16:19], v[60:63]
    ds_read_b64_tr_b16 v[116:117], v127 offset:30720
    v_mfma_f32_16x16x32_bf16 v[64:67], v[40:43], v[20:23], v[64:67]
    ds_read_b64_tr_b16 v[118:119], v127 offset:30976
    v_mfma_f32_16x16x32_bf16 v[68:71], v[40:43], v[24:27], v[68:71]
    s_waitcnt lgkmcnt(8)
    v_mfma_f32_16x16x32_bf16 v[136:139], v[88:91], v[28:31], v[136:139]
    v_mfma_f32_16x16x32_bf16 v[160:163], v[88:91], v[32:35], v[160:163]
    v_mfma_f32_16x16x32_bf16 v[140:143], v[92:95], v[28:31], v[140:143]
    v_mfma_f32_16x16x32_bf16 v[164:167], v[92:95], v[32:35], v[164:167]
    v_mfma_f32_16x16x32_bf16 v[144:147], v[96:99], v[28:31], v[144:147]
    v_mfma_f32_16x16x32_bf16 v[168:171], v[96:99], v[32:35], v[168:171]
    v_mfma_f32_16x16x32_bf16 v[148:151], v[100:103], v[28:31], v[148:151]
    v_mfma_f32_16x16x32_bf16 v[172:175], v[100:103], v[32:35], v[172:175]
    s_waitcnt lgkmcnt(6)
    v_mfma_f32_16x16x32_bf16 v[152:155], v[28:31], v[104:107], v[152:155]
    v_mfma_f32_16x16x32_bf16 v[176:179], v[32:35], v[104:107], v[176:179]
    s_waitcnt lgkmcnt(4)
    v_mfma_f32_16x16x32_bf16 v[156:159], v[28:31], v[108:111], v[156:159]
    v_mfma_f32_16x16x32_bf16 v[180:183], v[32:35], v[108:111], v[180:183]
    s_waitcnt lgkmcnt(2)
    v_mfma_f32_16x16x32_bf16 v[184:187], v[112:115], v[36:39], v[184:187]
    s_waitcnt lgkmcnt(0)
    v_mfma_f32_16x16x32_bf16 v[188:191], v[116:119], v[36:39], v[188:191]
    v_mfma_f32_16x16x32_bf16 v[48:51], v[28:31], v[28:31], v[48:51]
    v_mfma_f32_16x16x32_bf16 v[52:55], v[32:35], v[32:35], v[52:55]
    v_mfma_f32_16x16x32_bf16 v[56:59], v[36:39], v[36:39], v[56:59]
    v_mfma_f32_16x16x32_bf16 v[60:63], v[40:43], v[28:31], v[60:63]
    v_mfma_f32_16x16x32_bf16 v[64:67], v[40:43], v[32:35], v[64:67]
    v_mfma_f32_16x16x32_bf16 v[68:71], v[40:43], v[36:39], v[68:71]
    s_mov_b32 s88, 0x22222222
    s_mov_b32 s89, 0x22222222
    s_mov_b32 s90, 0x44444444
    s_mov_b32 s91, 0x44444444
    s_mov_b32 s92, 0x88888888
    s_mov_b32 s93, 0x88888888
    v_lshlrev_b32 v32, 4, v3
    s_lshl_b32 s53, s3, 6
    v_add_u32 v33, s53, v32
    s_and_b32 s53, s53, 64
    v_add_u32 v34, s53, v32
    s_mul_i32 s53, s3, 384
    v_lshl_add_u32 v35, v2, 2, s53
    v_add_u32 v36, s53, v32
    s_mov_b32 exec_lo, 0x00010001
    s_mov_b32 exec_hi, 0x00010001
    ds_write_b128 v33, v[184:187] offset:128
    ds_write_b128 v34, v[188:191] offset:0
    s_mov_b64 exec, -1
    v_cndmask_b32 v48, v48, v49, s[88:89]
    v_cndmask_b32 v52, v52, v53, s[88:89]
    v_cndmask_b32 v56, v56, v57, s[88:89]
    v_cndmask_b32 v48, v48, v50, s[90:91]
    v_cndmask_b32 v52, v52, v54, s[90:91]
    v_cndmask_b32 v56, v56, v58, s[90:91]
    v_cndmask_b32 v48, v48, v51, s[92:93]
    v_cndmask_b32 v52, v52, v55, s[92:93]
    v_cndmask_b32 v56, v56, v59, s[92:93]
    v_mul_f32 v25, 0x3b124925, v60
    v_mul_f32 v27, 0x3b124925, v64
    v_mul_f32 v29, 0x3b124925, v68
    v_mul_f32 v24, v25, v25
    v_mul_f32 v26, v27, v27
    v_mul_f32 v28, v29, v29
    v_mul_f32 v48, 0x3b124925, v48
    v_mul_f32 v52, 0x3b124925, v52
    v_mul_f32 v56, 0x3b124925, v56
    v_sub_f32 v24, v48, v24
    v_sub_f32 v26, v52, v26
    v_sub_f32 v28, v56, v28
    v_max_f32 v24, 0, v24
    v_max_f32 v26, 0, v26
    v_max_f32 v28, 0, v28
    v_add_f32 v24, 0x3727c5ac, v24
    v_add_f32 v26, 0x3727c5ac, v26
    v_add_f32 v28, 0x3727c5ac, v28
    v_rsq_f32 v24, v24
    v_rsq_f32 v26, v26
    v_rsq_f32 v28, v28
    s_mov_b32 exec_lo, 0x00f0000f
    s_mov_b32 exec_hi, 0xf0000f00
    ds_write2_b32 v35, v24, v25 offset0:128 offset1:144
    ds_write2_b32 v35, v26, v27 offset0:160 offset1:176
    ds_write2_b32 v35, v28, v29 offset0:192 offset1:208
    s_mov_b64 exec, -1
    v_mov_b32_dpp v40, v184 row_newbcast:0 row_mask:0xf bank_mask:0xf
    v_mov_b32_dpp v41, v185 row_newbcast:0 row_mask:0xf bank_mask:0xf
    v_mov_b32_dpp v42, v186 row_newbcast:0 row_mask:0xf bank_mask:0xf
    v_mov_b32_dpp v43, v187 row_newbcast:0 row_mask:0xf bank_mask:0xf
    s_and_b32 s53, s3, 1
    s_lshl_b32 s53, s53, 3
    v_add_u32 v44, s53, v4
    v_lshrrev_b32 v45, 2, v2
    v_lshlrev_b32 v45, 8, v45
    v_lshl_add_u32 v45, v3, 6, v45
    v_and_b32 v46, 3, v2
    v_lshl_add_u32 v45, v46, 1, v45
    v_add_u32 v45, s53, v45
    v_add_u32 v45, 1024, v45
    s_cmp_lt_u32 s3, 2
    s_cselect_b64 vcc, -1, 0
    s_cselect_b32 s53, 2, 16
    v_cndmask_b32 v44, v45, v44, vcc
    v_add_u32 v45, s53, v44
    v_add_u32 v46, s53, v45
    v_add_u32 v47, s53, v46
    v_pk_fma_f32 v[40:41], v[40:41], v[28:29], v[184:185] op_sel:[0,1,0] op_sel_hi:[1,1,1] neg_lo:[0,1,0] neg_hi:[0,1,0]
    v_pk_fma_f32 v[42:43], v[42:43], v[28:29], v[186:187] op_sel:[0,1,0] op_sel_hi:[1,1,1] neg_lo:[0,1,0] neg_hi:[0,1,0]
    v_lshlrev_b32 v33, 2, v2
    s_lshl_b32 s53, s3, 11
    v_add_u32 v34, s53, v4
    s_cmp_eq_u32 s49, 15
    s_cselect_b32 s88, 0xffff0000, -1
    s_mov_b32 s89, -1
    s_mov_b32 s90, -1
    s_cselect_b32 s91, -1, 0xffff
    s_waitcnt lgkmcnt(0)
    s_barrier
    ds_read_b32 v26, v35 offset:640
    ds_read_b32 v28, v35 offset:768
    ds_read_b32 v24, v35 offset:512
    ds_read_b128 v[56:59], v32 offset:128
    ds_read_b128 v[60:63], v32 offset:192
    ds_read_b32 v64, v33 offset:256
    ds_read_b32 v65, v33 offset:320
    ds_read_b128 v[80:83], v36 offset:704
    ds_read_b128 v[76:79], v36 offset:640
    ds_read_b128 v[72:75], v36 offset:576
    ds_read_b128 v[68:71], v36 offset:512
    ds_read_b128 v[48:51], v32 offset:0
    ds_read_b128 v[52:55], v32 offset:64
    s_waitcnt lgkmcnt(9)
    v_pk_fma_f32 v[168:169], v[56:57], v[26:27], v[168:169] op_sel:[0,1,0] op_sel_hi:[1,1,1] neg_lo:[0,1,0] neg_hi:[0,1,0]
    v_pk_fma_f32 v[170:171], v[58:59], v[26:27], v[170:171] op_sel:[0,1,0] op_sel_hi:[1,1,1] neg_lo:[0,1,0] neg_hi:[0,1,0]
    v_pk_mul_f32 v[168:169], v[168:169], v[26:27] op_sel:[0,0] op_sel_hi:[1,0]
    v_pk_mul_f32 v[170:171], v[170:171], v[26:27] op_sel:[0,0] op_sel_hi:[1,0]
    v_cvt_pk_bf16_f32 v104, v168, v169
    v_cvt_pk_bf16_f32 v105, v170, v171
    s_waitcnt lgkmcnt(8)
    v_pk_fma_f32 v[172:173], v[60:61], v[26:27], v[172:173] op_sel:[0,1,0] op_sel_hi:[1,1,1] neg_lo:[0,1,0] neg_hi:[0,1,0]
    v_pk_fma_f32 v[174:175], v[62:63], v[26:27], v[174:175] op_sel:[0,1,0] op_sel_hi:[1,1,1] neg_lo:[0,1,0] neg_hi:[0,1,0]
    v_pk_mul_f32 v[172:173], v[172:173], v[26:27] op_sel:[0,0] op_sel_hi:[1,0]
    v_pk_mul_f32 v[174:175], v[174:175], v[26:27] op_sel:[0,0] op_sel_hi:[1,0]
    v_cvt_pk_bf16_f32 v106, v172, v173
    v_cvt_pk_bf16_f32 v107, v174, v175
    ds_write_b128 v34, v[104:107] offset:4096
    v_pk_mul_f32 v[40:41], v[40:41], v[28:29] op_sel_hi:[1,0]
    v_pk_mul_f32 v[42:43], v[42:43], v[28:29] op_sel_hi:[1,0]
    v_cvt_pk_bf16_f32 v40, v40, v41
    v_cvt_pk_bf16_f32 v42, v42, v43
    ds_write_b16 v44, v40 offset:2048
    ds_write_b16_d16_hi v45, v40 offset:2048
    ds_write_b16 v46, v42 offset:2048
    ds_write_b16_d16_hi v47, v42 offset:2048
    s_waitcnt lgkmcnt(10)
    v_pk_fma_f32 v[176:177], v[80:81], v[64:65], v[176:177] op_sel:[0,0,0] op_sel_hi:[1,0,1] neg_lo:[0,1,0] neg_hi:[0,1,0]
    v_pk_fma_f32 v[178:179], v[82:83], v[64:65], v[178:179] op_sel:[0,0,0] op_sel_hi:[1,0,1] neg_lo:[0,1,0] neg_hi:[0,1,0]
    s_waitcnt lgkmcnt(9)
    v_pk_mul_f32 v[176:177], v[176:177], v[76:77]
    v_pk_mul_f32 v[178:179], v[178:179], v[78:79]
    v_cvt_pk_bf16_f32 v112, v176, v177
    v_cvt_pk_bf16_f32 v113, v178, v179
    v_pk_fma_f32 v[180:181], v[80:81], v[64:65], v[180:181] op_sel:[0,1,0] op_sel_hi:[1,1,1] neg_lo:[0,1,0] neg_hi:[0,1,0]
    v_pk_fma_f32 v[182:183], v[82:83], v[64:65], v[182:183] op_sel:[0,1,0] op_sel_hi:[1,1,1] neg_lo:[0,1,0] neg_hi:[0,1,0]
    v_pk_mul_f32 v[180:181], v[180:181], v[76:77]
    v_pk_mul_f32 v[182:183], v[182:183], v[78:79]
    v_cvt_pk_bf16_f32 v118, v180, v181
    v_cvt_pk_bf16_f32 v119, v182, v183
    ds_write_b64 v34, v[112:113] offset:5120
    ds_write_b64 v34, v[118:119] offset:5128
    v_mul_f32 v84, 0x3e8b97f6, v24
    v_mul_f32 v86, 0x3e8b97f6, v26
    v_cndmask_b32 v85, 0, v84, s[90:91]
    v_cndmask_b32 v84, 0, v84, s[88:89]
    v_cndmask_b32 v87, 0, v86, s[90:91]
    v_cndmask_b32 v86, 0, v86, s[88:89]
    v_pk_fma_f32 v[144:145], v[56:57], v[24:25], v[144:145] op_sel:[0,1,0] op_sel_hi:[1,1,1] neg_lo:[0,1,0] neg_hi:[0,1,0]
    v_pk_fma_f32 v[146:147], v[58:59], v[24:25], v[146:147] op_sel:[0,1,0] op_sel_hi:[1,1,1] neg_lo:[0,1,0] neg_hi:[0,1,0]
    v_pk_mul_f32 v[144:145], v[144:145], v[24:25] op_sel:[0,0] op_sel_hi:[1,0]
    v_pk_mul_f32 v[146:147], v[146:147], v[24:25] op_sel:[0,0] op_sel_hi:[1,0]
    v_cvt_pk_bf16_f32 v100, v144, v145
    v_cvt_pk_bf16_f32 v101, v146, v147
    v_pk_fma_f32 v[148:149], v[60:61], v[24:25], v[148:149] op_sel:[0,1,0] op_sel_hi:[1,1,1] neg_lo:[0,1,0] neg_hi:[0,1,0]
    v_pk_fma_f32 v[150:151], v[62:63], v[24:25], v[150:151] op_sel:[0,1,0] op_sel_hi:[1,1,1] neg_lo:[0,1,0] neg_hi:[0,1,0]
    v_pk_mul_f32 v[148:149], v[148:149], v[24:25] op_sel:[0,0] op_sel_hi:[1,0]
    v_pk_mul_f32 v[150:151], v[150:151], v[24:25] op_sel:[0,0] op_sel_hi:[1,0]
    v_cvt_pk_bf16_f32 v102, v148, v149
    v_cvt_pk_bf16_f32 v103, v150, v151
    s_waitcnt lgkmcnt(0)
    s_barrier
    ds_read_b128 v[96:99], v34 offset:2048
    ds_read_b64 v[108:109], v34 offset:3072
    ds_read_b64 v[114:115], v34 offset:3080
    v_pk_fma_f32 v[160:161], v[48:49], v[26:27], v[160:161] op_sel:[0,1,0] op_sel_hi:[1,1,1] neg_lo:[0,1,0] neg_hi:[0,1,0]
    v_pk_fma_f32 v[162:163], v[50:51], v[26:27], v[162:163] op_sel:[0,1,0] op_sel_hi:[1,1,1] neg_lo:[0,1,0] neg_hi:[0,1,0]
    v_pk_mul_f32 v[160:161], v[160:161], v[86:87] op_sel:[0,0] op_sel_hi:[1,0]
    v_pk_mul_f32 v[162:163], v[162:163], v[86:87] op_sel:[0,0] op_sel_hi:[1,0]
    v_cvt_pk_bf16_f32 v92, v160, v161
    v_cvt_pk_bf16_f32 v93, v162, v163
    v_pk_fma_f32 v[164:165], v[52:53], v[26:27], v[164:165] op_sel:[0,1,0] op_sel_hi:[1,1,1] neg_lo:[0,1,0] neg_hi:[0,1,0]
    v_pk_fma_f32 v[166:167], v[54:55], v[26:27], v[166:167] op_sel:[0,1,0] op_sel_hi:[1,1,1] neg_lo:[0,1,0] neg_hi:[0,1,0]
    v_pk_mul_f32 v[164:165], v[164:165], v[86:87] op_sel:[0,1] op_sel_hi:[1,1]
    v_pk_mul_f32 v[166:167], v[166:167], v[86:87] op_sel:[0,1] op_sel_hi:[1,1]
    v_cvt_pk_bf16_f32 v94, v164, v165
    v_cvt_pk_bf16_f32 v95, v166, v167
    s_nop 1
    v_mfma_f32_16x16x32_bf16 v[128:131], v[100:103], v[92:95], v[240:243]
    v_mfma_f32_16x16x32_bf16 v[132:135], v[104:107], v[92:95], v[244:247]
    v_pk_fma_f32 v[136:137], v[48:49], v[24:25], v[136:137] op_sel:[0,1,0] op_sel_hi:[1,1,1] neg_lo:[0,1,0] neg_hi:[0,1,0]
    v_pk_fma_f32 v[138:139], v[50:51], v[24:25], v[138:139] op_sel:[0,1,0] op_sel_hi:[1,1,1] neg_lo:[0,1,0] neg_hi:[0,1,0]
    v_pk_mul_f32 v[136:137], v[136:137], v[84:85] op_sel:[0,0] op_sel_hi:[1,0]
    v_pk_mul_f32 v[138:139], v[138:139], v[84:85] op_sel:[0,0] op_sel_hi:[1,0]
    v_cvt_pk_bf16_f32 v88, v136, v137
    v_cvt_pk_bf16_f32 v89, v138, v139
    v_pk_fma_f32 v[140:141], v[52:53], v[24:25], v[140:141] op_sel:[0,1,0] op_sel_hi:[1,1,1] neg_lo:[0,1,0] neg_hi:[0,1,0]
    v_pk_fma_f32 v[142:143], v[54:55], v[24:25], v[142:143] op_sel:[0,1,0] op_sel_hi:[1,1,1] neg_lo:[0,1,0] neg_hi:[0,1,0]
    v_pk_mul_f32 v[140:141], v[140:141], v[84:85] op_sel:[0,1] op_sel_hi:[1,1]
    v_pk_mul_f32 v[142:143], v[142:143], v[84:85] op_sel:[0,1] op_sel_hi:[1,1]
    v_cvt_pk_bf16_f32 v90, v140, v141
    v_cvt_pk_bf16_f32 v91, v142, v143
    s_waitcnt lgkmcnt(2)
    s_nop 0
    v_mfma_f32_16x16x32_bf16 v[120:123], v[96:99], v[88:91], v[248:251]
    v_mfma_f32_16x16x32_bf16 v[124:127], v[100:103], v[88:91], v[244:247]
    v_pk_fma_f32 v[152:153], v[72:73], v[64:65], v[152:153] op_sel:[0,0,0] op_sel_hi:[1,0,1] neg_lo:[0,1,0] neg_hi:[0,1,0]
    v_pk_fma_f32 v[154:155], v[74:75], v[64:65], v[154:155] op_sel:[0,0,0] op_sel_hi:[1,0,1] neg_lo:[0,1,0] neg_hi:[0,1,0]
    v_pk_mul_f32 v[152:153], v[152:153], v[68:69]
    v_pk_mul_f32 v[154:155], v[154:155], v[70:71]
    v_cvt_pk_bf16_f32 v110, v152, v153
    v_cvt_pk_bf16_f32 v111, v154, v155
    v_pk_fma_f32 v[156:157], v[72:73], v[64:65], v[156:157] op_sel:[0,1,0] op_sel_hi:[1,1,1] neg_lo:[0,1,0] neg_hi:[0,1,0]
    v_pk_fma_f32 v[158:159], v[74:75], v[64:65], v[158:159] op_sel:[0,1,0] op_sel_hi:[1,1,1] neg_lo:[0,1,0] neg_hi:[0,1,0]
    v_pk_mul_f32 v[156:157], v[156:157], v[68:69]
    v_pk_mul_f32 v[158:159], v[158:159], v[70:71]
    v_cvt_pk_bf16_f32 v116, v156, v157
    v_cvt_pk_bf16_f32 v117, v158, v159
    v_max3_f32 v137, v128, v129, v130
    v_max3_f32 v139, v131, v132, v133
    v_max3_f32 v137, v137, v134, v135
    v_max_f32 v137, v137, v139
    v_max3_f32 v136, v120, v121, v122
    v_max3_f32 v138, v123, v124, v125
    v_max3_f32 v136, v136, v126, v127
    v_max_f32 v136, v136, v138
    v_mov_b32 v138, v136
    v_mov_b32 v139, v137
    s_nop 0
    v_permlane32_swap_b32 v136, v138
    v_permlane32_swap_b32 v137, v139
    v_max_f32 v136, v136, v138
    v_max_f32 v137, v137, v139
    v_mov_b32 v138, v136
    v_mov_b32 v139, v137
    s_nop 0
    v_permlane16_swap_b32 v136, v138
    v_permlane16_swap_b32 v137, v139
    v_max_f32 v136, v136, v138
    v_max_f32 v137, v137, v139
    v_pk_add_f32 v[128:129], v[128:129], v[136:137] op_sel:[0,1] op_sel_hi:[1,1] neg_lo:[0,1] neg_hi:[0,1]
    v_pk_add_f32 v[130:131], v[130:131], v[136:137] op_sel:[0,1] op_sel_hi:[1,1] neg_lo:[0,1] neg_hi:[0,1]
    v_pk_add_f32 v[132:133], v[132:133], v[136:137] op_sel:[0,1] op_sel_hi:[1,1] neg_lo:[0,1] neg_hi:[0,1]
    v_pk_add_f32 v[134:135], v[134:135], v[136:137] op_sel:[0,1] op_sel_hi:[1,1] neg_lo:[0,1] neg_hi:[0,1]
    v_exp_f32 v128, v128
    v_exp_f32 v129, v129
    v_exp_f32 v130, v130
    v_exp_f32 v131, v131
    v_exp_f32 v132, v132
    v_exp_f32 v133, v133
    v_exp_f32 v134, v134
    v_exp_f32 v135, v135
    v_cvt_pk_bf16_f32 v148, v128, v129
    v_cvt_pk_bf16_f32 v149, v130, v131
    v_cvt_pk_bf16_f32 v150, v132, v133
    v_cvt_pk_bf16_f32 v151, v134, v135
    s_nop 1
    v_mfma_f32_16x16x32_bf16 v[160:163], v[110:113], v[148:151], 0
    v_mfma_f32_16x16x32_bf16 v[164:167], v[116:119], v[148:151], 0
    v_pk_add_f32 v[120:121], v[120:121], v[136:137] op_sel:[0,0] op_sel_hi:[1,0] neg_lo:[0,1] neg_hi:[0,1]
    v_pk_add_f32 v[122:123], v[122:123], v[136:137] op_sel:[0,0] op_sel_hi:[1,0] neg_lo:[0,1] neg_hi:[0,1]
    v_pk_add_f32 v[124:125], v[124:125], v[136:137] op_sel:[0,0] op_sel_hi:[1,0] neg_lo:[0,1] neg_hi:[0,1]
    v_pk_add_f32 v[126:127], v[126:127], v[136:137] op_sel:[0,0] op_sel_hi:[1,0] neg_lo:[0,1] neg_hi:[0,1]
    v_exp_f32 v120, v120
    v_exp_f32 v121, v121
    v_exp_f32 v122, v122
    v_exp_f32 v123, v123
    v_exp_f32 v124, v124
    v_exp_f32 v125, v125
    v_exp_f32 v126, v126
    v_exp_f32 v127, v127
    v_cvt_pk_bf16_f32 v144, v120, v121
    v_cvt_pk_bf16_f32 v145, v122, v123
    v_cvt_pk_bf16_f32 v146, v124, v125
    v_cvt_pk_bf16_f32 v147, v126, v127
    s_waitcnt lgkmcnt(1)
    s_nop 0
    v_mfma_f32_16x16x32_bf16 v[152:155], v[108:111], v[144:147], 0
    s_waitcnt lgkmcnt(0)
    v_mfma_f32_16x16x32_bf16 v[156:159], v[114:117], v[144:147], 0
    v_pk_add_f32 v[120:121], v[120:121], v[122:123]
    v_pk_add_f32 v[124:125], v[124:125], v[126:127]
    v_pk_add_f32 v[128:129], v[128:129], v[130:131]
    v_pk_add_f32 v[132:133], v[132:133], v[134:135]
    v_pk_add_f32 v[120:121], v[120:121], v[124:125]
    v_pk_add_f32 v[128:129], v[128:129], v[132:133]
    v_add_f32 v140, v120, v121
    v_add_f32 v142, v128, v129
    v_mov_b32 v138, v140
    v_mov_b32 v139, v142
    s_nop 0
    v_permlane32_swap_b32 v140, v138
    v_permlane32_swap_b32 v142, v139
    v_add_f32 v140, v140, v138
    v_add_f32 v142, v142, v139
    v_mov_b32 v138, v140
    v_mov_b32 v139, v142
    s_nop 0
    v_permlane16_swap_b32 v140, v138
    v_permlane16_swap_b32 v142, v139
    v_add_f32 v140, v140, v138
    v_add_f32 v142, v142, v139
    v_rcp_f32 v140, v140
    v_rcp_f32 v142, v142
    v_cndmask_b32 v141, 0, v140, s[90:91]
    v_cndmask_b32 v140, 0, v140, s[88:89]
    v_cndmask_b32 v143, 0, v142, s[90:91]
    v_cndmask_b32 v142, 0, v142, s[88:89]
    s_lshl_b32 s53, s48, 3
    s_lshl_b32 s50, s3, 1
    s_add_u32 s53, s53, s50
    s_lshl_b32 s53, s53, 4
    s_add_u32 s53, s53, s49
    s_lshl_b32 s53, s53, 10
    s_add_u32 s50, s53, 16384
    v_pk_mul_f32 v[152:153], v[152:153], v[140:141] op_sel_hi:[1,0]
    v_pk_mul_f32 v[154:155], v[154:155], v[140:141] op_sel_hi:[1,0]
    v_pk_mul_f32 v[156:157], v[156:157], v[140:141] op_sel:[0,1] op_sel_hi:[1,1]
    v_pk_mul_f32 v[158:159], v[158:159], v[140:141] op_sel:[0,1] op_sel_hi:[1,1]
    v_cvt_pk_bf16_f32 v144, v152, v153
    v_cvt_pk_bf16_f32 v145, v154, v155
    v_cvt_pk_bf16_f32 v146, v156, v157
    v_cvt_pk_bf16_f32 v147, v158, v159
    buffer_store_dwordx4 v[144:147], v4, s[40:43], s53 offen sc1
    v_pk_mul_f32 v[160:161], v[160:161], v[142:143] op_sel_hi:[1,0]
    v_pk_mul_f32 v[162:163], v[162:163], v[142:143] op_sel_hi:[1,0]
    v_pk_mul_f32 v[164:165], v[164:165], v[142:143] op_sel:[0,1] op_sel_hi:[1,1]
    v_pk_mul_f32 v[166:167], v[166:167], v[142:143] op_sel:[0,1] op_sel_hi:[1,1]
    v_cvt_pk_bf16_f32 v148, v160, v161
    v_cvt_pk_bf16_f32 v149, v162, v163
    v_cvt_pk_bf16_f32 v150, v164, v165
    v_cvt_pk_bf16_f32 v151, v166, v167
    buffer_store_dwordx4 v[148:151], v4, s[40:43], s50 offen sc1
    s_add_u32 m0, s59, 0
    s_mov_b32 s73, 0
    buffer_load_dwordx4 v208, s[16:19], s73 offen lds
    s_add_u32 m0, s59, 1024
    s_mov_b32 s73, 7168
    buffer_load_dwordx4 v208, s[16:19], s73 offen lds
    s_add_u32 m0, s59, 2048
    s_mov_b32 s73, 14336
    buffer_load_dwordx4 v208, s[16:19], s73 offen lds
    s_add_u32 m0, s59, 3072
    s_mov_b32 s73, 21504
    buffer_load_dwordx4 v208, s[16:19], s73 offen lds
    s_add_u32 m0, s59, 4096
    s_mov_b32 s73, 28672
    buffer_load_dwordx4 v208, s[16:19], s73 offen lds
    s_add_u32 m0, s59, 5120
    s_mov_b32 s73, 35840
    buffer_load_dwordx4 v208, s[16:19], s73 offen lds
    s_add_u32 m0, s59, 6144
    s_mov_b32 s73, 43008
    buffer_load_dwordx4 v208, s[16:19], s73 offen lds
    s_add_u32 m0, s59, 7168
    s_mov_b32 s73, 50176
    buffer_load_dwordx4 v208, s[16:19], s73 offen lds
    s_add_u32 m0, s59, 8192
    s_mov_b32 s73, 57344
    buffer_load_dwordx4 v208, s[16:19], s73 offen lds
    s_add_u32 m0, s59, 9216
    s_mov_b32 s73, 64512
    buffer_load_dwordx4 v208, s[16:19], s73 offen lds
    s_add_u32 m0, s59, 10240
    s_mov_b32 s73, 71680
    buffer_load_dwordx4 v208, s[16:19], s73 offen lds
    s_add_u32 m0, s59, 11264
    s_mov_b32 s73, 78848
    buffer_load_dwordx4 v208, s[16:19], s73 offen lds
    s_add_u32 m0, s59, 12288
    s_mov_b32 s73, 86016
    buffer_load_dwordx4 v208, s[16:19], s73 offen lds
    s_add_u32 m0, s59, 13312
    s_mov_b32 s73, 93184
    buffer_load_dwordx4 v208, s[16:19], s73 offen lds
    s_waitcnt vmcnt(34)
    v_readfirstlane_b32 s4, v6
    s_nop 1
    s_cmp_lg_u32 s4, 0
    s_cbranch_scc1 Lepd_P_2
    s_nop 0
Lepg_P_1:
    s_sub_u32 s6, s6, 1
    s_cbranch_scc1 L_end_P
    buffer_load_dword v6, v7, s[44:47], 0 offen sc1
    s_waitcnt vmcnt(0)
    v_readfirstlane_b32 s4, v6
    s_nop 1
    s_cmp_eq_u32 s4, 0
    s_cbranch_scc1 Lepg_P_1
Lepd_P_2:
    s_waitcnt vmcnt(33)
    v_lshlrev_b32 v192, 16, v192
    s_waitcnt vmcnt(32)
    v_lshlrev_b32 v193, 16, v193
    s_waitcnt vmcnt(31)
    v_lshlrev_b32 v194, 16, v194
    s_waitcnt vmcnt(30)
    v_lshlrev_b32 v195, 16, v195
    s_waitcnt vmcnt(29)
    v_lshlrev_b32 v196, 16, v196
    s_waitcnt vmcnt(28)
    v_lshlrev_b32 v197, 16, v197
    s_waitcnt vmcnt(27)
    v_lshlrev_b32 v198, 16, v198
    s_waitcnt vmcnt(26)
    v_lshlrev_b32 v199, 16, v199
    s_waitcnt vmcnt(25)
    v_lshlrev_b32 v200, 16, v200
    s_waitcnt vmcnt(24)
    v_lshlrev_b32 v201, 16, v201
    s_waitcnt vmcnt(23)
    v_lshlrev_b32 v202, 16, v202
    s_waitcnt vmcnt(22)
    v_lshlrev_b32 v203, 16, v203
    s_waitcnt vmcnt(21)
    v_lshlrev_b32 v204, 16, v204
    s_waitcnt vmcnt(20)
    v_lshlrev_b32 v205, 16, v205
    s_waitcnt vmcnt(19)
    v_lshlrev_b32 v206, 16, v206
    s_waitcnt vmcnt(18)
    v_lshlrev_b32 v207, 16, v207
    s_waitcnt vmcnt(14)
    v_mov_b32 v8, s4
    s_mov_b64 exec, 1
    buffer_store_dword v8, v9, s[40:43], s80 offen sc1
    s_mov_b64 exec, -1
    s_cmp_lt_u32 s67, 99
    s_cbranch_scc1 Lnotag_P_3
    s_lshr_b32 s68, s2, 3
    s_sub_u32 s68, s68, 28
    s_lshl_b32 s68, s68, 2
    s_add_u32 s68, s68, s3
    s_lshl_b32 s68, s68, 16
    s_and_b32 s69, s2, 7
    s_lshl_b32 s69, s69, 9
    s_add_u32 s68, s68, s69
    v_lshrrev_b32 v16, 2, v1
    v_lshlrev_b32 v16, 12, v16
    v_and_b32 v17, 3, v1
    v_lshl_add_u32 v16, v17, 7, v16
    buffer_load_dword v18, v16, s[24:27], s68 offen
    s_add_u32 s68, s68, 0x100000
    s_waitcnt vmcnt(3)
    buffer_load_dword v19, v16, s[24:27], s68 offen
    s_add_u32 s68, s68, 0x100000
    s_waitcnt vmcnt(3)
    buffer_load_dword v20, v16, s[24:27], s68 offen
    s_add_u32 s68, s68, 0x100000
    s_waitcnt vmcnt(3)
    buffer_load_dword v21, v16, s[24:27], s68 offen
    s_add_u32 s68, s68, 0x100000
    s_waitcnt vmcnt(3)
    buffer_load_dword v22, v16, s[24:27], s68 offen
    s_add_u32 s68, s68, 0x100000
    s_waitcnt vmcnt(3)
    buffer_load_dword v23, v16, s[24:27], s68 offen
    s_add_u32 s68, s68, 0x100000
    s_waitcnt vmcnt(3)
    buffer_load_dword v24, v16, s[24:27], s68 offen
    s_add_u32 s68, s68, 0x100000
    s_waitcnt vmcnt(3)
    s_waitcnt vmcnt(0)
    s_branch L_end_P
Lnotag_P_3:
    s_waitcnt vmcnt(1)
    s_barrier
    ds_read_b64_tr_b16 a[0:1], v209 offset:0
    ds_read_b64_tr_b16 a[2:3], v209 offset:2048
    ds_read_b64_tr_b16 a[4:5], v209 offset:1024
    ds_read_b64_tr_b16 a[6:7], v209 offset:3072
    ds_read_b64_tr_b16 a[8:9], v209 offset:3584
    ds_read_b64_tr_b16 a[10:11], v209 offset:5632
    ds_read_b64_tr_b16 a[12:13], v209 offset:4608
    ds_read_b64_tr_b16 a[14:15], v209 offset:6656
    ds_read_b64_tr_b16 a[16:17], v209 offset:7168
    ds_read_b64_tr_b16 a[18:19], v209 offset:9216
    ds_read_b64_tr_b16 a[20:21], v209 offset:8192
    ds_read_b64_tr_b16 a[22:23], v209 offset:10240
    ds_read_b64_tr_b16 a[24:25], v209 offset:10752
    ds_read_b64_tr_b16 a[26:27], v209 offset:12800
    ds_read_b64_tr_b16 a[28:29], v209 offset:11776
    ds_read_b64_tr_b16 a[30:31], v209 offset:13824
    ds_read_b64_tr_b16 a[32:33], v209 offset:14336
    ds_read_b64_tr_b16 a[34:35], v209 offset:16384
    ds_read_b64_tr_b16 a[36:37], v209 offset:15360
    ds_read_b64_tr_b16 a[38:39], v209 offset:17408
    ds_read_b64_tr_b16 a[40:41], v209 offset:17920
    ds_read_b64_tr_b16 a[42:43], v209 offset:19968
    ds_read_b64_tr_b16 a[44:45], v209 offset:18944
    ds_read_b64_tr_b16 a[46:47], v209 offset:20992
    ds_read_b64_tr_b16 a[48:49], v209 offset:21504
    ds_read_b64_tr_b16 a[50:51], v209 offset:23552
    ds_read_b64_tr_b16 a[52:53], v209 offset:22528
    ds_read_b64_tr_b16 a[54:55], v209 offset:24576
    ds_read_b64_tr_b16 a[56:57], v209 offset:25088
    ds_read_b64_tr_b16 a[58:59], v209 offset:27136
    ds_read_b64_tr_b16 a[60:61], v209 offset:26112
    ds_read_b64_tr_b16 a[62:63], v209 offset:28160
    ds_read_b64_tr_b16 a[64:65], v209 offset:28672
    ds_read_b64_tr_b16 a[66:67], v209 offset:30720
    ds_read_b64_tr_b16 a[68:69], v209 offset:29696
    ds_read_b64_tr_b16 a[70:71], v209 offset:31744
    ds_read_b64_tr_b16 a[72:73], v209 offset:32256
    ds_read_b64_tr_b16 a[74:75], v209 offset:34304
    ds_read_b64_tr_b16 a[76:77], v209 offset:33280
    ds_read_b64_tr_b16 a[78:79], v209 offset:35328
    ds_read_b64_tr_b16 a[80:81], v209 offset:35840
    ds_read_b64_tr_b16 a[82:83], v209 offset:37888
    ds_read_b64_tr_b16 a[84:85], v209 offset:36864
    ds_read_b64_tr_b16 a[86:87], v209 offset:38912
    ds_read_b64_tr_b16 a[88:89], v209 offset:39424
    ds_read_b64_tr_b16 a[90:91], v209 offset:41472
    ds_read_b64_tr_b16 a[92:93], v209 offset:40448
    ds_read_b64_tr_b16 a[94:95], v209 offset:42496
    ds_read_b64_tr_b16 a[96:97], v209 offset:43008
    ds_read_b64_tr_b16 a[98:99], v209 offset:45056
    ds_read_b64_tr_b16 a[100:101], v209 offset:44032
    ds_read_b64_tr_b16 a[102:103], v209 offset:46080
    ds_read_b64_tr_b16 a[104:105], v209 offset:46592
    ds_read_b64_tr_b16 a[106:107], v209 offset:48640
    ds_read_b64_tr_b16 a[108:109], v209 offset:47616
    ds_read_b64_tr_b16 a[110:111], v209 offset:49664
    ds_read_b64_tr_b16 a[112:113], v209 offset:50176
    ds_read_b64_tr_b16 a[114:115], v209 offset:52224
    ds_read_b64_tr_b16 a[116:117], v209 offset:51200
    ds_read_b64_tr_b16 a[118:119], v209 offset:53248
    ds_read_b64_tr_b16 a[120:121], v209 offset:53248
    ds_read_b64_tr_b16 a[122:123], v209 offset:55296
    ds_read_b64_tr_b16 a[124:125], v209 offset:54272
    ds_read_b64_tr_b16 a[126:127], v209 offset:56320
    s_waitcnt lgkmcnt(0)
    s_barrier
    s_add_u32 m0, s70, 16384
    s_mov_b32 s73, 0
    buffer_load_dwordx4 v213, s[20:23], s73 offen lds
    s_add_u32 m0, s70, 17408
    s_mov_b32 s73, 28672
    buffer_load_dwordx4 v213, s[20:23], s73 offen lds
    s_add_u32 m0, s70, 18432
    s_mov_b32 s73, 57344
    buffer_load_dwordx4 v213, s[20:23], s73 offen lds
    s_add_u32 m0, s70, 19456
    s_mov_b32 s73, 86016
    buffer_load_dwordx4 v213, s[20:23], s73 offen lds
    s_add_u32 m0, s70, 20480
    s_mov_b32 s73, 114688
    buffer_load_dwordx4 v213, s[20:23], s73 offen lds
    s_add_u32 m0, s70, 21504
    s_mov_b32 s73, 143360
    buffer_load_dwordx4 v213, s[20:23], s73 offen lds
    s_add_u32 m0, s70, 22528
    s_mov_b32 s73, 172032
    buffer_load_dwordx4 v213, s[20:23], s73 offen lds
    s_add_u32 m0, s70, 23552
    s_mov_b32 s73, 200704
    buffer_load_dwordx4 v213, s[20:23], s73 offen lds
    s_add_u32 m0, s70, 24576
    s_mov_b32 s73, 229376
    buffer_load_dwordx4 v213, s[20:23], s73 offen lds
    s_add_u32 m0, s70, 25600
    s_mov_b32 s73, 258048
    buffer_load_dwordx4 v213, s[20:23], s73 offen lds
    s_add_u32 m0, s70, 26624
    s_mov_b32 s73, 286720
    buffer_load_dwordx4 v213, s[20:23], s73 offen lds
    s_add_u32 m0, s70, 27648
    s_mov_b32 s73, 315392
    buffer_load_dwordx4 v213, s[20:23], s73 offen lds
    s_add_u32 m0, s70, 28672
    s_mov_b32 s73, 344064
    buffer_load_dwordx4 v213, s[20:23], s73 offen lds
    s_add_u32 m0, s70, 29696
    s_mov_b32 s73, 372736
    buffer_load_dwordx4 v213, s[20:23], s73 offen lds
    s_add_u32 m0, s70, 30720
    s_mov_b32 s73, 401408
    buffer_load_dwordx4 v213, s[20:23], s73 offen lds
    s_add_u32 m0, s70, 31744
    s_mov_b32 s73, 430080
    buffer_load_dwordx4 v213, s[20:23], s73 offen lds
    s_add_u32 m0, s70, 32768
    s_mov_b32 s73, 458752
    buffer_load_dwordx4 v213, s[20:23], s73 offen lds
    s_add_u32 m0, s70, 33792
    s_mov_b32 s73, 487424
    buffer_load_dwordx4 v213, s[20:23], s73 offen lds
    s_add_u32 m0, s70, 34816
    s_mov_b32 s73, 516096
    buffer_load_dwordx4 v213, s[20:23], s73 offen lds
    s_add_u32 m0, s70, 35840
    s_mov_b32 s73, 544768
    buffer_load_dwordx4 v213, s[20:23], s73 offen lds
    buffer_load_dword v249, v10, s[40:43], s83 offen sc1
    s_sleep 3
    buffer_load_dword v250, v10, s[40:43], s83 offen sc1
    s_sleep 3
    s_nop 0
Lpoll_P_4:
    s_sub_u32 s6, s6, 1
    s_cbranch_scc1 L_end_P
    buffer_load_dword v251, v10, s[40:43], s83 offen sc1
    s_waitcnt vmcnt(2)
    v_cmp_ne_u32 vcc, s4, v249
    s_nop 1
    s_cbranch_vccz Lpd_P_5
    buffer_load_dword v249, v10, s[40:43], s83 offen sc1
    s_waitcnt vmcnt(2)
    v_cmp_ne_u32 vcc, s4, v250
    s_nop 1
    s_cbranch_vccz Lpd_P_5
    buffer_load_dword v250, v10, s[40:43], s83 offen sc1
    s_waitcnt vmcnt(2)
    v_cmp_ne_u32 vcc, s4, v251
    s_nop 1
    s_cbranch_vccnz Lpoll_P_4
    s_nop 1
Lpd_P_5:
    s_lshl_b32 s58, s67, 16
    s_lshl_b32 s60, s3, 14
    s_add_u32 s58, s58, s60
    s_add_u32 m0, s70, 0
    s_nop 0
    buffer_load_dwordx4 v4, s[40:43], s58 offen offset:0 sc1 lds
    buffer_load_dwordx4 v4, s[40:43], s58 offen offset:1024 sc1 lds
    buffer_load_dwordx4 v4, s[40:43], s58 offen offset:2048 sc1 lds
    buffer_load_dwordx4 v4, s[40:43], s58 offen offset:3072 sc1 lds
    s_add_u32 m0, s70, 4096
    s_add_u32 s58, s58, 4096
    buffer_load_dwordx4 v4, s[40:43], s58 offen offset:0 sc1 lds
    buffer_load_dwordx4 v4, s[40:43], s58 offen offset:1024 sc1 lds
    buffer_load_dwordx4 v4, s[40:43], s58 offen offset:2048 sc1 lds
    buffer_load_dwordx4 v4, s[40:43], s58 offen offset:3072 sc1 lds
    s_add_u32 m0, s70, 8192
    s_add_u32 s58, s58, 4096
    buffer_load_dwordx4 v4, s[40:43], s58 offen offset:0 sc1 lds
    buffer_load_dwordx4 v4, s[40:43], s58 offen offset:1024 sc1 lds
    buffer_load_dwordx4 v4, s[40:43], s58 offen offset:2048 sc1 lds
    buffer_load_dwordx4 v4, s[40:43], s58 offen offset:3072 sc1 lds
    s_add_u32 m0, s70, 12288
    s_add_u32 s58, s58, 4096
    buffer_load_dwordx4 v4, s[40:43], s58 offen offset:0 sc1 lds
    buffer_load_dwordx4 v4, s[40:43], s58 offen offset:1024 sc1 lds
    buffer_load_dwordx4 v4, s[40:43], s58 offen offset:2048 sc1 lds
    buffer_load_dwordx4 v4, s[40:43], s58 offen offset:3072 sc1 lds
    v_and_b32 v64, 1, v3
    v_mul_u32_u24 v64, 36864, v64
    v_lshl_add_u32 v64, v2, 4, v64
    v_lshrrev_b32 v65, 5, v1
    v_lshl_add_u32 v64, v65, 8, v64
    s_lshr_b32 s60, s3, 1
    s_mul_i32 s60, s60, 73728
    s_add_u32 s60, s60, 12288
    v_add_u32 v64, s60, v64
    ds_read_b64_tr_b16 a[128:129], v215 offset:16384
    ds_read_b64_tr_b16 a[130:131], v215 offset:17408
    ds_read_b64_tr_b16 a[132:133], v216 offset:16384
    ds_read_b64_tr_b16 a[134:135], v216 offset:17408
    ds_read_b64_tr_b16 a[136:137], v215 offset:18432
    ds_read_b64_tr_b16 a[138:139], v215 offset:19456
    ds_read_b64_tr_b16 a[140:141], v216 offset:18432
    ds_read_b64_tr_b16 a[142:143], v216 offset:19456
    ds_read_b64_tr_b16 a[144:145], v215 offset:20480
    ds_read_b64_tr_b16 a[146:147], v215 offset:21504
    ds_read_b64_tr_b16 a[148:149], v216 offset:20480
    ds_read_b64_tr_b16 a[150:151], v216 offset:21504
    ds_read_b64_tr_b16 a[152:153], v215 offset:22528
    ds_read_b64_tr_b16 a[154:155], v215 offset:23552
    ds_read_b64_tr_b16 a[156:157], v216 offset:22528
    ds_read_b64_tr_b16 a[158:159], v216 offset:23552
    ds_read_b64_tr_b16 a[160:161], v215 offset:24576
    ds_read_b64_tr_b16 a[162:163], v215 offset:25600
    ds_read_b64_tr_b16 a[164:165], v216 offset:24576
    ds_read_b64_tr_b16 a[166:167], v216 offset:25600
    ds_read_b64_tr_b16 a[168:169], v215 offset:26624
    ds_read_b64_tr_b16 a[170:171], v215 offset:27648
    ds_read_b64_tr_b16 a[172:173], v216 offset:26624
    ds_read_b64_tr_b16 a[174:175], v216 offset:27648
    ds_read_b64_tr_b16 a[176:177], v215 offset:28672
    ds_read_b64_tr_b16 a[178:179], v215 offset:29696
    ds_read_b64_tr_b16 a[180:181], v216 offset:28672
    ds_read_b64_tr_b16 a[182:183], v216 offset:29696
    ds_read_b64_tr_b16 a[184:185], v215 offset:30720
    ds_read_b64_tr_b16 a[186:187], v215 offset:31744
    ds_read_b64_tr_b16 a[188:189], v216 offset:30720
    ds_read_b64_tr_b16 a[190:191], v216 offset:31744
    ds_read_b64_tr_b16 a[192:193], v215 offset:32768
    ds_read_b64_tr_b16 a[194:195], v215 offset:33792
    ds_read_b64_tr_b16 a[196:197], v216 offset:32768
    ds_read_b64_tr_b16 a[198:199], v216 offset:33792
    ds_read_b64_tr_b16 a[200:201], v215 offset:34816
    ds_read_b64_tr_b16 a[202:203], v215 offset:35840
    ds_read_b64_tr_b16 a[204:205], v216 offset:34816
    ds_read_b64_tr_b16 a[206:207], v216 offset:35840
    s_waitcnt vmcnt(8)
    s_barrier
    ds_read_b128 v[32:35], v64 offset:0
    ds_read_b128 v[36:39], v64 offset:512
    ds_read_b128 v[40:43], v64 offset:1024
    ds_read_b128 v[44:47], v64 offset:1536
    ds_read_b128 v[48:51], v64 offset:2048
    ds_read_b128 v[52:55], v64 offset:2560
    s_waitcnt lgkmcnt(5)
    v_mfma_f32_32x32x16_bf16 v[192:207], v[32:35], a[0:3], v[192:207]
    ds_read_b128 v[56:59], v64 offset:3072
    s_add_u32 m0, s70, 16384
    s_mov_b32 s73, 573440
    buffer_load_dwordx4 v213, s[20:23], s73 offen lds
    s_waitcnt lgkmcnt(5)
    v_mfma_f32_32x32x16_bf16 v[192:207], v[36:39], a[4:7], v[192:207]
    ds_read_b128 v[60:63], v64 offset:3584
    s_waitcnt lgkmcnt(5)
    v_mfma_f32_32x32x16_bf16 v[192:207], v[40:43], a[8:11], v[192:207]
    ds_read_b128 v[32:35], v64 offset:4096
    s_waitcnt lgkmcnt(5)
    v_mfma_f32_32x32x16_bf16 v[192:207], v[44:47], a[12:15], v[192:207]
    ds_read_b128 v[36:39], v64 offset:4608
    s_add_u32 m0, s70, 17408
    s_mov_b32 s73, 602112
    buffer_load_dwordx4 v213, s[20:23], s73 offen lds
    s_waitcnt lgkmcnt(5)
    v_mfma_f32_32x32x16_bf16 v[192:207], v[48:51], a[16:19], v[192:207]
    ds_read_b128 v[40:43], v64 offset:5120
    s_waitcnt lgkmcnt(5)
    v_mfma_f32_32x32x16_bf16 v[192:207], v[52:55], a[20:23], v[192:207]
    ds_read_b128 v[44:47], v64 offset:5632
    s_waitcnt lgkmcnt(5)
    v_mfma_f32_32x32x16_bf16 v[192:207], v[56:59], a[24:27], v[192:207]
    ds_read_b128 v[48:51], v64 offset:6144
    s_add_u32 m0, s70, 18432
    s_mov_b32 s73, 630784
    buffer_load_dwordx4 v213, s[20:23], s73 offen lds
    s_waitcnt lgkmcnt(5)
    v_mfma_f32_32x32x16_bf16 v[192:207], v[60:63], a[28:31], v[192:207]
    ds_read_b128 v[52:55], v64 offset:6656
    s_waitcnt lgkmcnt(5)
    v_mfma_f32_32x32x16_bf16 v[192:207], v[32:35], a[32:35], v[192:207]
    ds_read_b128 v[56:59], v64 offset:7168
    s_waitcnt lgkmcnt(5)
    v_mfma_f32_32x32x16_bf16 v[192:207], v[36:39], a[36:39], v[192:207]
    ds_read_b128 v[60:63], v64 offset:7680
    s_add_u32 m0, s70, 19456
    s_mov_b32 s73, 659456
    buffer_load_dwordx4 v213, s[20:23], s73 offen lds
    s_waitcnt lgkmcnt(5)
    v_mfma_f32_32x32x16_bf16 v[192:207], v[40:43], a[40:43], v[192:207]
    s_waitcnt lgkmcnt(4)
    v_mfma_f32_32x32x16_bf16 v[192:207], v[44:47], a[44:47], v[192:207]
    s_waitcnt vmcnt(4)
    s_barrier
    ds_read_b128 v[32:35], v64 offset:8192
    ds_read_b128 v[36:39], v64 offset:8704
    s_waitcnt lgkmcnt(5)
    v_mfma_f32_32x32x16_bf16 v[192:207], v[48:51], a[48:51], v[192:207]
    ds_read_b128 v[40:43], v64 offset:9216
    s_add_u32 m0, s70, 20480
    s_mov_b32 s73, 688128
    buffer_load_dwordx4 v213, s[20:23], s73 offen lds
    s_waitcnt lgkmcnt(5)
    v_mfma_f32_32x32x16_bf16 v[192:207], v[52:55], a[52:55], v[192:207]
    ds_read_b128 v[44:47], v64 offset:9728
    s_waitcnt lgkmcnt(5)
    v_mfma_f32_32x32x16_bf16 v[192:207], v[56:59], a[56:59], v[192:207]
    ds_read_b128 v[48:51], v64 offset:10240
    s_waitcnt lgkmcnt(5)
    v_mfma_f32_32x32x16_bf16 v[192:207], v[60:63], a[60:63], v[192:207]
    ds_read_b128 v[52:55], v64 offset:10752
    s_add_u32 m0, s70, 21504
    s_mov_b32 s73, 716800
    buffer_load_dwordx4 v213, s[20:23], s73 offen lds
    s_waitcnt lgkmcnt(5)
    v_mfma_f32_32x32x16_bf16 v[192:207], v[32:35], a[64:67], v[192:207]
    ds_read_b128 v[56:59], v64 offset:11264
    s_waitcnt lgkmcnt(5)
    v_mfma_f32_32x32x16_bf16 v[192:207], v[36:39], a[68:71], v[192:207]
    ds_read_b128 v[60:63], v64 offset:11776
    s_waitcnt lgkmcnt(5)
    v_mfma_f32_32x32x16_bf16 v[192:207], v[40:43], a[72:75], v[192:207]
    ds_read_b128 v[32:35], v64 offset:12288
    s_add_u32 m0, s70, 22528
    s_mov_b32 s73, 745472
    buffer_load_dwordx4 v213, s[20:23], s73 offen lds
    s_waitcnt lgkmcnt(5)
    v_mfma_f32_32x32x16_bf16 v[192:207], v[44:47], a[76:79], v[192:207]
    ds_read_b128 v[36:39], v64 offset:12800
    s_waitcnt lgkmcnt(5)
    v_mfma_f32_32x32x16_bf16 v[192:207], v[48:51], a[80:83], v[192:207]
    ds_read_b128 v[40:43], v64 offset:13312
    s_waitcnt lgkmcnt(5)
    v_mfma_f32_32x32x16_bf16 v[192:207], v[52:55], a[84:87], v[192:207]
    ds_read_b128 v[44:47], v64 offset:13824
    s_add_u32 m0, s70, 23552
    s_mov_b32 s73, 774144
    buffer_load_dwordx4 v213, s[20:23], s73 offen lds
    s_waitcnt lgkmcnt(5)
    v_mfma_f32_32x32x16_bf16 v[192:207], v[56:59], a[88:91], v[192:207]
    ds_read_b128 v[48:51], v64 offset:14336
    s_waitcnt lgkmcnt(5)
    v_mfma_f32_32x32x16_bf16 v[192:207], v[60:63], a[92:95], v[192:207]
    ds_read_b128 v[52:55], v64 offset:14848
    s_waitcnt lgkmcnt(5)
    v_mfma_f32_32x32x16_bf16 v[192:207], v[32:35], a[96:99], v[192:207]
    ds_read_b128 v[56:59], v64 offset:15360
    s_waitcnt lgkmcnt(5)
    v_mfma_f32_32x32x16_bf16 v[192:207], v[36:39], a[100:103], v[192:207]
    ds_read_b128 v[60:63], v64 offset:15872
    s_waitcnt lgkmcnt(5)
    v_mfma_f32_32x32x16_bf16 v[192:207], v[40:43], a[104:107], v[192:207]
    s_waitcnt lgkmcnt(4)
    v_mfma_f32_32x32x16_bf16 v[192:207], v[44:47], a[108:111], v[192:207]
    s_waitcnt lgkmcnt(3)
    v_mfma_f32_32x32x16_bf16 v[192:207], v[48:51], a[112:115], v[192:207]
    s_waitcnt lgkmcnt(2)
    v_mfma_f32_32x32x16_bf16 v[192:207], v[52:55], a[116:119], v[192:207]
    s_waitcnt lgkmcnt(1)
    v_mfma_f32_32x32x16_bf16 v[192:207], v[56:59], a[120:123], v[192:207]
    s_waitcnt lgkmcnt(0)
    v_mfma_f32_32x32x16_bf16 v[192:207], v[60:63], a[124:127], v[192:207]
    s_nop 11
    v_pk_mul_f32 v[68:69], v[192:193], v[192:193]
    v_pk_mul_f32 v[70:71], v[194:195], v[194:195]
    v_pk_mul_f32 v[72:73], v[196:197], v[196:197]
    v_pk_mul_f32 v[74:75], v[198:199], v[198:199]
    v_pk_mul_f32 v[76:77], v[200:201], v[200:201]
    v_pk_mul_f32 v[78:79], v[202:203], v[202:203]
    v_pk_mul_f32 v[80:81], v[204:205], v[204:205]
    v_pk_mul_f32 v[82:83], v[206:207], v[206:207]
    v_add_f32_dpp v84, v192, v192 row_mirror row_mask:0xf bank_mask:0x3
    v_add_f32_dpp v85, v193, v193 row_mirror row_mask:0xf bank_mask:0x3
    v_add_f32_dpp v86, v196, v196 row_mirror row_mask:0xf bank_mask:0x3
    v_add_f32_dpp v87, v197, v197 row_mirror row_mask:0xf bank_mask:0x3
    v_add_f32_dpp v88, v200, v200 row_mirror row_mask:0xf bank_mask:0x3
    v_add_f32_dpp v89, v201, v201 row_mirror row_mask:0xf bank_mask:0x3
    v_add_f32_dpp v90, v204, v204 row_mirror row_mask:0xf bank_mask:0x3
    v_add_f32_dpp v91, v205, v205 row_mirror row_mask:0xf bank_mask:0x3
    v_add_f32_dpp v92, v68, v68 row_mirror row_mask:0xf bank_mask:0x3
    v_add_f32_dpp v93, v69, v69 row_mirror row_mask:0xf bank_mask:0x3
    v_add_f32_dpp v94, v72, v72 row_mirror row_mask:0xf bank_mask:0x3
    v_add_f32_dpp v95, v73, v73 row_mirror row_mask:0xf bank_mask:0x3
    v_add_f32_dpp v96, v76, v76 row_mirror row_mask:0xf bank_mask:0x3
    v_add_f32_dpp v97, v77, v77 row_mirror row_mask:0xf bank_mask:0x3
    v_add_f32_dpp v98, v80, v80 row_mirror row_mask:0xf bank_mask:0x3
    v_add_f32_dpp v99, v81, v81 row_mirror row_mask:0xf bank_mask:0x3
    v_add_f32_dpp v84, v194, v194 row_mirror row_mask:0xf bank_mask:0xc
    v_add_f32_dpp v85, v195, v195 row_mirror row_mask:0xf bank_mask:0xc
    v_add_f32_dpp v86, v198, v198 row_mirror row_mask:0xf bank_mask:0xc
    v_add_f32_dpp v87, v199, v199 row_mirror row_mask:0xf bank_mask:0xc
    v_add_f32_dpp v88, v202, v202 row_mirror row_mask:0xf bank_mask:0xc
    v_add_f32_dpp v89, v203, v203 row_mirror row_mask:0xf bank_mask:0xc
    v_add_f32_dpp v90, v206, v206 row_mirror row_mask:0xf bank_mask:0xc
    v_add_f32_dpp v91, v207, v207 row_mirror row_mask:0xf bank_mask:0xc
    v_add_f32_dpp v92, v70, v70 row_mirror row_mask:0xf bank_mask:0xc
    v_add_f32_dpp v93, v71, v71 row_mirror row_mask:0xf bank_mask:0xc
    v_add_f32_dpp v94, v74, v74 row_mirror row_mask:0xf bank_mask:0xc
    v_add_f32_dpp v95, v75, v75 row_mirror row_mask:0xf bank_mask:0xc
    v_add_f32_dpp v96, v78, v78 row_mirror row_mask:0xf bank_mask:0xc
    v_add_f32_dpp v97, v79, v79 row_mirror row_mask:0xf bank_mask:0xc
    v_add_f32_dpp v98, v82, v82 row_mirror row_mask:0xf bank_mask:0xc
    v_add_f32_dpp v99, v83, v83 row_mirror row_mask:0xf bank_mask:0xc
    v_add_f32_dpp v84, v84, v84 row_half_mirror row_mask:0xf bank_mask:0x5
    v_add_f32_dpp v86, v86, v86 row_half_mirror row_mask:0xf bank_mask:0x5
    v_add_f32_dpp v88, v88, v88 row_half_mirror row_mask:0xf bank_mask:0x5
    v_add_f32_dpp v90, v90, v90 row_half_mirror row_mask:0xf bank_mask:0x5
    v_add_f32_dpp v92, v92, v92 row_half_mirror row_mask:0xf bank_mask:0x5
    v_add_f32_dpp v94, v94, v94 row_half_mirror row_mask:0xf bank_mask:0x5
    v_add_f32_dpp v96, v96, v96 row_half_mirror row_mask:0xf bank_mask:0x5
    v_add_f32_dpp v98, v98, v98 row_half_mirror row_mask:0xf bank_mask:0x5
    v_add_f32_dpp v84, v85, v85 row_half_mirror row_mask:0xf bank_mask:0xa
    v_add_f32_dpp v86, v87, v87 row_half_mirror row_mask:0xf bank_mask:0xa
    v_add_f32_dpp v88, v89, v89 row_half_mirror row_mask:0xf bank_mask:0xa
    v_add_f32_dpp v90, v91, v91 row_half_mirror row_mask:0xf bank_mask:0xa
    v_add_f32_dpp v92, v93, v93 row_half_mirror row_mask:0xf bank_mask:0xa
    v_add_f32_dpp v94, v95, v95 row_half_mirror row_mask:0xf bank_mask:0xa
    v_add_f32_dpp v96, v97, v97 row_half_mirror row_mask:0xf bank_mask:0xa
    v_add_f32_dpp v98, v99, v99 row_half_mirror row_mask:0xf bank_mask:0xa
    v_add_f32_dpp v85, v84, v84 quad_perm:[1,0,3,2] row_mask:0xf bank_mask:0xf
    v_add_f32_dpp v87, v86, v86 quad_perm:[1,0,3,2] row_mask:0xf bank_mask:0xf
    v_add_f32_dpp v89, v88, v88 quad_perm:[1,0,3,2] row_mask:0xf bank_mask:0xf
    v_add_f32_dpp v91, v90, v90 quad_perm:[1,0,3,2] row_mask:0xf bank_mask:0xf
    v_add_f32_dpp v93, v92, v92 quad_perm:[1,0,3,2] row_mask:0xf bank_mask:0xf
    v_add_f32_dpp v95, v94, v94 quad_perm:[1,0,3,2] row_mask:0xf bank_mask:0xf
    v_add_f32_dpp v97, v96, v96 quad_perm:[1,0,3,2] row_mask:0xf bank_mask:0xf
    v_add_f32_dpp v99, v98, v98 quad_perm:[1,0,3,2] row_mask:0xf bank_mask:0xf
    v_add_f32_dpp v68, v85, v85 quad_perm:[2,3,0,1] row_mask:0xf bank_mask:0xf
    v_add_f32_dpp v69, v87, v87 quad_perm:[2,3,0,1] row_mask:0xf bank_mask:0xf
    v_add_f32_dpp v70, v89, v89 quad_perm:[2,3,0,1] row_mask:0xf bank_mask:0xf
    v_add_f32_dpp v71, v91, v91 quad_perm:[2,3,0,1] row_mask:0xf bank_mask:0xf
    v_add_f32_dpp v72, v93, v93 quad_perm:[2,3,0,1] row_mask:0xf bank_mask:0xf
    v_add_f32_dpp v73, v95, v95 quad_perm:[2,3,0,1] row_mask:0xf bank_mask:0xf
    v_add_f32_dpp v74, v97, v97 quad_perm:[2,3,0,1] row_mask:0xf bank_mask:0xf
    v_add_f32_dpp v75, v99, v99 quad_perm:[2,3,0,1] row_mask:0xf bank_mask:0xf
    v_permlane16_swap_b32 v68, v69
    v_permlane16_swap_b32 v70, v71
    v_permlane16_swap_b32 v72, v73
    v_permlane16_swap_b32 v74, v75
    v_add_f32 v84, v68, v69
    v_add_f32 v85, v72, v73
    v_add_f32 v86, v70, v71
    v_add_f32 v87, v74, v75
    v_and_b32 v65, 1, v3
    v_lshlrev_b32 v65, 6, v65
    v_lshrrev_b32 v66, 5, v1
    v_lshl_add_u32 v65, v66, 5, v65
    v_bfe_u32 v67, v1, 2, 2
    v_lshl_add_u32 v65, v67, 3, v65
    s_lshl_b32 s58, s3, 8
    v_add_u32 v65, s58, v65
    ds_write_b64 v65, v[84:85] offset:0
    ds_write_b64 v65, v[86:87] offset:128
    v_and_b32 v67, 31, v1
    v_lshlrev_b32 v65, 9, v66
    v_lshl_add_u32 v65, v67, 4, v65
    v_lshlrev_b32 v66, 8, v66
    v_lshl_add_u32 v66, v67, 3, v66
    s_and_b32 s58, s58, 512
    v_add_u32 v66, s58, v66
    s_lshl_b32 s58, s67, 1
    s_lshr_b32 s60, s3, 1
    s_add_u32 s58, s58, s60
    s_lshl_b32 s58, s58, 12
    s_add_u32 s58, s58, 0x548000
    s_lshl_b32 s60, s66, 9
    s_add_u32 s60, s60, s58
    s_waitcnt lgkmcnt(0)
    s_barrier
    ds_read_b64 v[84:85], v66 offset:0
    v_mov_b32 v89, s4
    v_mov_b32 v91, s4
    s_waitcnt lgkmcnt(0)
    v_mov_b32 v88, v84
    v_mov_b32 v90, v85
    s_nop 0
    v_permlane32_swap_b32 v88, v84
    v_permlane32_swap_b32 v90, v85
    v_add_f32 v88, v88, v84
    v_add_f32 v90, v90, v85
    s_bitcmp0_b32 s3, 0
    s_cselect_b32 exec_lo, -1, 0
    s_mov_b32 exec_hi, 0
    buffer_store_dwordx4 v[88:91], v65, s[40:43], s60 offen sc1
    s_mov_b64 exec, -1
    v_cvt_pk_bf16_f32 v240, v192, v193
    v_cvt_pk_bf16_f32 v241, v194, v195
    v_cvt_pk_bf16_f32 v242, v196, v197
    v_cvt_pk_bf16_f32 v243, v198, v199
    v_cvt_pk_bf16_f32 v244, v200, v201
    v_cvt_pk_bf16_f32 v245, v202, v203
    v_cvt_pk_bf16_f32 v246, v204, v205
    v_cvt_pk_bf16_f32 v247, v206, v207
    s_lshl_b32 s61, s66, 1
    s_and_b32 s60, s3, 1
    s_add_u32 s61, s61, s60
    s_lshl_b32 s61, s61, 7
    s_lshl_b32 s60, s67, 2
    s_add_u32 s61, s61, s60
    s_and_b32 s60, s3, 2
    s_add_u32 s61, s61, s60
    s_lshl_b32 s61, s61, 10
    s_add_u32 s61, s61, 0x200000
    v_lshlrev_b32 v66, 4, v67
    v_cmp_gt_u32 s[86:87], 32, v1
    s_add_u32 m0, s70, 0
    s_mov_b32 s73, 802816
    buffer_load_dwordx4 v213, s[20:23], s73 offen lds
    s_add_u32 m0, s70, 1024
    s_mov_b32 s73, 831488
    buffer_load_dwordx4 v213, s[20:23], s73 offen lds
    s_add_u32 m0, s70, 2048
    s_mov_b32 s73, 860160
    buffer_load_dwordx4 v213, s[20:23], s73 offen lds
    s_add_u32 m0, s70, 3072
    s_mov_b32 s73, 888832
    buffer_load_dwordx4 v213, s[20:23], s73 offen lds
    s_add_u32 m0, s70, 4096
    s_mov_b32 s73, 917504
    buffer_load_dwordx4 v213, s[20:23], s73 offen lds
    s_add_u32 m0, s70, 5120
    s_mov_b32 s73, 946176
    buffer_load_dwordx4 v213, s[20:23], s73 offen lds
    s_add_u32 m0, s70, 6144
    s_mov_b32 s73, 974848
    buffer_load_dwordx4 v213, s[20:23], s73 offen lds
    s_add_u32 m0, s70, 7168
    s_mov_b32 s73, 1003520
    buffer_load_dwordx4 v213, s[20:23], s73 offen lds
    s_add_u32 m0, s70, 8192
    s_mov_b32 s73, 1032192
    buffer_load_dwordx4 v213, s[20:23], s73 offen lds
    s_add_u32 m0, s70, 9216
    s_mov_b32 s73, 1060864
    buffer_load_dwordx4 v213, s[20:23], s73 offen lds
    s_add_u32 m0, s70, 10240
    s_mov_b32 s73, 1089536
    buffer_load_dwordx4 v213, s[20:23], s73 offen lds
    s_add_u32 m0, s70, 11264
    s_mov_b32 s73, 1118208
    buffer_load_dwordx4 v213, s[20:23], s73 offen lds
    s_add_u32 m0, s70, 12288
    s_mov_b32 s73, 1146880
    buffer_load_dwordx4 v213, s[20:23], s73 offen lds
    s_add_u32 m0, s70, 13312
    s_mov_b32 s73, 1175552
    buffer_load_dwordx4 v213, s[20:23], s73 offen lds
    s_add_u32 m0, s70, 14336
    s_mov_b32 s73, 1204224
    buffer_load_dwordx4 v213, s[20:23], s73 offen lds
    s_add_u32 m0, s70, 15360
    s_mov_b32 s73, 1232896
    buffer_load_dwordx4 v213, s[20:23], s73 offen lds
    buffer_load_dwordx4 v[96:99], v65, s[40:43], s58 offen offset:0 sc1
    buffer_load_dwordx4 v[100:103], v65, s[40:43], s58 offen offset:1024 sc1
    buffer_load_dwordx4 v[104:107], v65, s[40:43], s58 offen offset:2048 sc1
    buffer_load_dwordx4 v[108:111], v66, s[40:43], s58 offen offset:3072 sc1
    s_sleep 5
    s_nop 0
Lst_P_6:
    s_sub_u32 s6, s6, 1
    s_cbranch_scc1 L_end_P
    buffer_load_dwordx4 v[112:115], v65, s[40:43], s58 offen offset:0 sc1
    buffer_load_dwordx4 v[116:119], v65, s[40:43], s58 offen offset:1024 sc1
    buffer_load_dwordx4 v[120:123], v65, s[40:43], s58 offen offset:2048 sc1
    buffer_load_dwordx4 v[124:127], v66, s[40:43], s58 offen offset:3072 sc1
    s_waitcnt vmcnt(4)
    v_xor_b32 v97, s4, v97
    v_xor_b32 v99, s4, v99
    v_xor_b32 v101, s4, v101
    v_xor_b32 v103, s4, v103
    v_xor_b32 v105, s4, v105
    v_xor_b32 v107, s4, v107
    v_xor_b32 v109, s4, v109
    v_xor_b32 v111, s4, v111
    v_cndmask_b32 v108, 0, v108, s[86:87]
    v_cndmask_b32 v110, 0, v110, s[86:87]
    v_or3_b32 v97, v97, v99, v101
    v_or3_b32 v103, v103, v105, v107
    v_or3_b32 v97, v97, v109, v111
    v_or_b32 v97, v97, v103
    v_cmp_ne_u32 vcc, 0, v97
    v_add_f32 v128, v96, v100
    v_add_f32 v129, v104, v108
    v_add_f32 v130, v98, v102
    v_add_f32 v131, v106, v110
    s_cbranch_vccz Lstd_P_7
    buffer_load_dwordx4 v[96:99], v65, s[40:43], s58 offen offset:0 sc1
    buffer_load_dwordx4 v[100:103], v65, s[40:43], s58 offen offset:1024 sc1
    buffer_load_dwordx4 v[104:107], v65, s[40:43], s58 offen offset:2048 sc1
    buffer_load_dwordx4 v[108:111], v66, s[40:43], s58 offen offset:3072 sc1
    s_waitcnt vmcnt(4)
    v_xor_b32 v113, s4, v113
    v_xor_b32 v115, s4, v115
    v_xor_b32 v117, s4, v117
    v_xor_b32 v119, s4, v119
    v_xor_b32 v121, s4, v121
    v_xor_b32 v123, s4, v123
    v_xor_b32 v125, s4, v125
    v_xor_b32 v127, s4, v127
    v_cndmask_b32 v124, 0, v124, s[86:87]
    v_cndmask_b32 v126, 0, v126, s[86:87]
    v_or3_b32 v113, v113, v115, v117
    v_or3_b32 v119, v119, v121, v123
    v_or3_b32 v113, v113, v125, v127
    v_or_b32 v113, v113, v119
    v_cmp_ne_u32 vcc, 0, v113
    v_add_f32 v128, v112, v116
    v_add_f32 v129, v120, v124
    v_add_f32 v130, v114, v118
    v_add_f32 v131, v122, v126
    s_cbranch_vccnz Lst_P_6
    s_nop 3
Lstd_P_7:
    v_add_f32 v128, v128, v129
    v_add_f32 v130, v130, v131
    v_mov_b32 v136, v128
    v_mov_b32 v138, v130
    s_nop 0
    v_permlane32_swap_b32 v128, v136
    v_permlane32_swap_b32 v130, v138
    v_add_f32 v128, v128, v136
    v_add_f32 v130, v130, v138
    v_mul_f32 v133, 0x3b124925, v128
    v_mul_f32 v130, 0x3b124925, v130
    v_fma_f32 v130, -v133, v133, v130
    v_max_f32 v130, 0, v130
    v_add_f32 v135, 0x3727c5ac, v130
    v_rsq_f32 v135, v135
    s_nop 0
    v_mul_f32 v130, v130, v135
    v_fmaak_f32 v130, v130, v135, 0x3727c5ac
    v_rsq_f32 v130, v130
    s_nop 0
    v_mul_f32 v135, v135, v130
    s_lshl_b32 s60, s3, 8
    v_lshl_add_u32 v66, v67, 2, s60
    ds_write_b32 v66, v133 offset:1024
    ds_write_b32 v66, v135 offset:1152
    v_lshrrev_b32 v66, 5, v1
    v_lshl_add_u32 v66, v66, 4, s60
    s_waitcnt lgkmcnt(0)
    ds_read_b128 v[140:143], v66 offset:1024
    ds_read_b128 v[156:159], v66 offset:1152
    ds_read_b128 v[144:147], v66 offset:1056
    ds_read_b128 v[160:163], v66 offset:1184
    ds_read_b128 v[148:151], v66 offset:1088
    ds_read_b128 v[164:167], v66 offset:1216
    ds_read_b128 v[152:155], v66 offset:1120
    ds_read_b128 v[168:171], v66 offset:1248
    s_waitcnt lgkmcnt(7)
    v_pk_add_f32 v[192:193], v[192:193], v[140:141] neg_lo:[0,1] neg_hi:[0,1]
    v_pk_add_f32 v[194:195], v[194:195], v[142:143] neg_lo:[0,1] neg_hi:[0,1]
    s_waitcnt lgkmcnt(5)
    v_pk_add_f32 v[196:197], v[196:197], v[144:145] neg_lo:[0,1] neg_hi:[0,1]
    v_pk_add_f32 v[198:199], v[198:199], v[146:147] neg_lo:[0,1] neg_hi:[0,1]
    v_pk_mul_f32 v[192:193], v[192:193], v[156:157]
    v_pk_mul_f32 v[194:195], v[194:195], v[158:159]
    s_waitcnt lgkmcnt(4)
    v_pk_mul_f32 v[196:197], v[196:197], v[160:161]
    v_pk_mul_f32 v[198:199], v[198:199], v[162:163]
    v_cvt_pk_bf16_f32 v84, v192, v193
    v_cvt_pk_bf16_f32 v85, v194, v195
    v_cvt_pk_bf16_f32 v86, v196, v197
    v_cvt_pk_bf16_f32 v87, v198, v199
    buffer_store_dwordx4 v[84:87], v4, s[40:43], s61 offen offset:0 sc1
    s_waitcnt lgkmcnt(3)
    v_pk_add_f32 v[200:201], v[200:201], v[148:149] neg_lo:[0,1] neg_hi:[0,1]
    v_pk_add_f32 v[202:203], v[202:203], v[150:151] neg_lo:[0,1] neg_hi:[0,1]
    s_waitcnt lgkmcnt(1)
    v_pk_add_f32 v[204:205], v[204:205], v[152:153] neg_lo:[0,1] neg_hi:[0,1]
    v_pk_add_f32 v[206:207], v[206:207], v[154:155] neg_lo:[0,1] neg_hi:[0,1]
    v_pk_mul_f32 v[200:201], v[200:201], v[164:165]
    v_pk_mul_f32 v[202:203], v[202:203], v[166:167]
    s_waitcnt lgkmcnt(0)
    v_pk_mul_f32 v[204:205], v[204:205], v[168:169]
    v_pk_mul_f32 v[206:207], v[206:207], v[170:171]
    v_cvt_pk_bf16_f32 v88, v200, v201
    v_cvt_pk_bf16_f32 v89, v202, v203
    v_cvt_pk_bf16_f32 v90, v204, v205
    v_cvt_pk_bf16_f32 v91, v206, v207
    buffer_store_dwordx4 v[88:91], v4, s[40:43], s61 offen offset:1024 sc1
    ds_read_b64_tr_b16 a[208:209], v215 offset:16384
    ds_read_b64_tr_b16 a[210:211], v215 offset:17408
    ds_read_b64_tr_b16 a[212:213], v216 offset:16384
    ds_read_b64_tr_b16 a[214:215], v216 offset:17408
    ds_read_b64_tr_b16 a[216:217], v215 offset:18432
    ds_read_b64_tr_b16 a[218:219], v215 offset:19456
    ds_read_b64_tr_b16 a[220:221], v216 offset:18432
    ds_read_b64_tr_b16 a[222:223], v216 offset:19456
    ds_read_b64_tr_b16 a[224:225], v215 offset:20480
    ds_read_b64_tr_b16 a[226:227], v215 offset:21504
    ds_read_b64_tr_b16 a[228:229], v216 offset:20480
    ds_read_b64_tr_b16 a[230:231], v216 offset:21504
    ds_read_b64_tr_b16 a[232:233], v215 offset:22528
    ds_read_b64_tr_b16 a[234:235], v215 offset:23552
    ds_read_b64_tr_b16 a[236:237], v216 offset:22528
    ds_read_b64_tr_b16 a[238:239], v216 offset:23552
    ds_read_b64_tr_b16 a[240:241], v215 offset:0
    ds_read_b64_tr_b16 a[242:243], v215 offset:1024
    ds_read_b64_tr_b16 a[244:245], v216 offset:0
    ds_read_b64_tr_b16 a[246:247], v216 offset:1024
    ds_read_b64_tr_b16 a[248:249], v215 offset:2048
    ds_read_b64_tr_b16 a[250:251], v215 offset:3072
    ds_read_b64_tr_b16 a[252:253], v216 offset:2048
    ds_read_b64_tr_b16 a[254:255], v216 offset:3072
    ds_read_b64_tr_b16 a[0:1], v215 offset:4096
    ds_read_b64_tr_b16 a[2:3], v215 offset:5120
    ds_read_b64_tr_b16 a[4:5], v216 offset:4096
    ds_read_b64_tr_b16 a[6:7], v216 offset:5120
    ds_read_b64_tr_b16 a[8:9], v215 offset:6144
    ds_read_b64_tr_b16 a[10:11], v215 offset:7168
    ds_read_b64_tr_b16 a[12:13], v216 offset:6144
    ds_read_b64_tr_b16 a[14:15], v216 offset:7168
    ds_read_b64_tr_b16 a[16:17], v215 offset:8192
    ds_read_b64_tr_b16 a[18:19], v215 offset:9216
    ds_read_b64_tr_b16 a[20:21], v216 offset:8192
    ds_read_b64_tr_b16 a[22:23], v216 offset:9216
    ds_read_b64_tr_b16 a[24:25], v215 offset:10240
    ds_read_b64_tr_b16 a[26:27], v215 offset:11264
    ds_read_b64_tr_b16 a[28:29], v216 offset:10240
    ds_read_b64_tr_b16 a[30:31], v216 offset:11264
    ds_read_b64_tr_b16 a[32:33], v215 offset:12288
    ds_read_b64_tr_b16 a[34:35], v215 offset:13312
    ds_read_b64_tr_b16 a[36:37], v216 offset:12288
    ds_read_b64_tr_b16 a[38:39], v216 offset:13312
    ds_read_b64_tr_b16 a[40:41], v215 offset:14336
    ds_read_b64_tr_b16 a[42:43], v215 offset:15360
    ds_read_b64_tr_b16 a[44:45], v216 offset:14336
    ds_read_b64_tr_b16 a[46:47], v216 offset:15360
    s_waitcnt vmcnt(0)
    v_mov_b32 v8, s4
    s_mov_b64 exec, 1
    buffer_store_dword v8, v9, s[40:43], s81 offen sc1
    s_mov_b64 exec, -1
    s_waitcnt lgkmcnt(15)
    s_add_u32 m0, s70, 0
    s_mov_b32 s73, 1261568
    buffer_load_dwordx4 v213, s[20:23], s73 offen lds
    s_add_u32 m0, s70, 1024
    s_mov_b32 s73, 1290240
    buffer_load_dwordx4 v213, s[20:23], s73 offen lds
    s_add_u32 m0, s70, 2048
    s_mov_b32 s73, 1318912
    buffer_load_dwordx4 v213, s[20:23], s73 offen lds
    s_add_u32 m0, s70, 3072
    s_mov_b32 s73, 1347584
    buffer_load_dwordx4 v213, s[20:23], s73 offen lds
    s_add_u32 m0, s70, 4096
    s_mov_b32 s73, 1376256
    buffer_load_dwordx4 v213, s[20:23], s73 offen lds
    s_add_u32 m0, s70, 5120
    s_mov_b32 s73, 1404928
    buffer_load_dwordx4 v213, s[20:23], s73 offen lds
    s_add_u32 m0, s70, 6144
    s_mov_b32 s73, 1433600
    buffer_load_dwordx4 v213, s[20:23], s73 offen lds
    s_add_u32 m0, s70, 7168
    s_mov_b32 s73, 1462272
    buffer_load_dwordx4 v213, s[20:23], s73 offen lds
    s_waitcnt lgkmcnt(12)
    s_add_u32 m0, s70, 8192
    s_mov_b32 s73, 1490944
    buffer_load_dwordx4 v213, s[20:23], s73 offen lds
    s_add_u32 m0, s70, 9216
    s_mov_b32 s73, 1519616
    buffer_load_dwordx4 v213, s[20:23], s73 offen lds
    s_waitcnt lgkmcnt(8)
    s_add_u32 m0, s70, 10240
    s_mov_b32 s73, 1548288
    buffer_load_dwordx4 v213, s[20:23], s73 offen lds
    s_add_u32 m0, s70, 11264
    s_mov_b32 s73, 1576960
    buffer_load_dwordx4 v213, s[20:23], s73 offen lds
    s_waitcnt lgkmcnt(4)
    s_add_u32 m0, s70, 12288
    s_mov_b32 s73, 1605632
    buffer_load_dwordx4 v213, s[20:23], s73 offen lds
    s_add_u32 m0, s70, 13312
    s_mov_b32 s73, 1634304
    buffer_load_dwordx4 v213, s[20:23], s73 offen lds
    s_waitcnt lgkmcnt(0)
    s_add_u32 m0, s70, 14336
    s_mov_b32 s73, 1662976
    buffer_load_dwordx4 v213, s[20:23], s73 offen lds
    s_add_u32 m0, s70, 15360
    s_mov_b32 s73, 1691648
    buffer_load_dwordx4 v213, s[20:23], s73 offen lds
    s_add_u32 m0, s70, 16384
    s_mov_b32 s73, 1720320
    buffer_load_dwordx4 v213, s[20:23], s73 offen lds
    s_add_u32 m0, s70, 17408
    s_mov_b32 s73, 1748992
    buffer_load_dwordx4 v213, s[20:23], s73 offen lds
    s_add_u32 m0, s70, 18432
    s_mov_b32 s73, 1777664
    buffer_load_dwordx4 v213, s[20:23], s73 offen lds
    s_add_u32 m0, s70, 19456
    s_mov_b32 s73, 1806336
    buffer_load_dwordx4 v213, s[20:23], s73 offen lds
    s_add_u32 m0, s70, 28672
    s_mov_b32 s73, 0
    buffer_load_dwordx4 v214, s[24:27], s73 offen lds
    s_add_u32 m0, s70, 29696
    s_mov_b32 s73, 32768
    buffer_load_dwordx4 v214, s[24:27], s73 offen lds
    s_add_u32 m0, s70, 30720
    s_mov_b32 s73, 65536
    buffer_load_dwordx4 v214, s[24:27], s73 offen lds
    s_add_u32 m0, s70, 31744
    s_mov_b32 s73, 98304
    buffer_load_dwordx4 v214, s[24:27], s73 offen lds
    s_add_u32 m0, s70, 32768
    s_mov_b32 s73, 131072
    buffer_load_dwordx4 v214, s[24:27], s73 offen lds
    s_add_u32 m0, s70, 33792
    s_mov_b32 s73, 163840
    buffer_load_dwordx4 v214, s[24:27], s73 offen lds
    s_add_u32 m0, s70, 34816
    s_mov_b32 s73, 196608
    buffer_load_dwordx4 v214, s[24:27], s73 offen lds
    s_add_u32 m0, s70, 35840
    s_mov_b32 s73, 229376
    buffer_load_dwordx4 v214, s[24:27], s73 offen lds
    v_lshrrev_b32 v220, 5, v1
    v_lshlrev_b32 v220, 3, v220
    s_lshl_b32 s68, s65, 7
    s_lshr_b32 s69, s3, 1
    s_lshl_b32 s69, s69, 6
    s_add_u32 s68, s68, s69
    buffer_load_dwordx2 v[222:223], v220, s[28:31], s68 offen offset:0
    buffer_load_dwordx2 v[224:225], v220, s[28:31], s68 offen offset:16
    buffer_load_dwordx2 v[226:227], v220, s[28:31], s68 offen offset:32
    buffer_load_dwordx2 v[228:229], v220, s[28:31], s68 offen offset:48
    s_lshl_b32 s68, s64, 1
    s_and_b32 s69, s3, 1
    s_add_u32 s71, s68, s69
    s_xor_b32 s72, s71, 1
    s_mul_i32 s68, s3, 32768
    s_add_u32 s68, s68, 0x200000
    s_mul_i32 s71, s71, 131072
    s_add_u32 s71, s71, s68
    s_mul_i32 s72, s72, 131072
    s_add_u32 s72, s72, s68
    s_waitcnt vmcnt(30)
    ds_read_b64_tr_b16 a[48:49], v215 offset:0
    ds_read_b64_tr_b16 a[50:51], v215 offset:1024
    ds_read_b64_tr_b16 a[52:53], v216 offset:0
    ds_read_b64_tr_b16 a[54:55], v216 offset:1024
    s_waitcnt vmcnt(28)
    ds_read_b64_tr_b16 a[56:57], v215 offset:2048
    ds_read_b64_tr_b16 a[58:59], v215 offset:3072
    ds_read_b64_tr_b16 a[60:61], v216 offset:2048
    ds_read_b64_tr_b16 a[62:63], v216 offset:3072
    s_waitcnt vmcnt(26)
    ds_read_b64_tr_b16 a[64:65], v215 offset:4096
    ds_read_b64_tr_b16 a[66:67], v215 offset:5120
    ds_read_b64_tr_b16 a[68:69], v216 offset:4096
    ds_read_b64_tr_b16 a[70:71], v216 offset:5120
    s_waitcnt vmcnt(24)
    ds_read_b64_tr_b16 a[72:73], v215 offset:6144
    ds_read_b64_tr_b16 a[74:75], v215 offset:7168
    ds_read_b64_tr_b16 a[76:77], v216 offset:6144
    ds_read_b64_tr_b16 a[78:79], v216 offset:7168
    s_waitcnt vmcnt(22)
    ds_read_b64_tr_b16 a[80:81], v215 offset:8192
    ds_read_b64_tr_b16 a[82:83], v215 offset:9216
    ds_read_b64_tr_b16 a[84:85], v216 offset:8192
    ds_read_b64_tr_b16 a[86:87], v216 offset:9216
    s_waitcnt vmcnt(20)
    ds_read_b64_tr_b16 a[88:89], v215 offset:10240
    ds_read_b64_tr_b16 a[90:91], v215 offset:11264
    ds_read_b64_tr_b16 a[92:93], v216 offset:10240
    ds_read_b64_tr_b16 a[94:95], v216 offset:11264
    s_waitcnt vmcnt(18)
    ds_read_b64_tr_b16 a[96:97], v215 offset:12288
    ds_read_b64_tr_b16 a[98:99], v215 offset:13312
    ds_read_b64_tr_b16 a[100:101], v216 offset:12288
    ds_read_b64_tr_b16 a[102:103], v216 offset:13312
    s_waitcnt vmcnt(16)
    ds_read_b64_tr_b16 a[104:105], v215 offset:14336
    ds_read_b64_tr_b16 a[106:107], v215 offset:15360
    ds_read_b64_tr_b16 a[108:109], v216 offset:14336
    ds_read_b64_tr_b16 a[110:111], v216 offset:15360
    s_waitcnt vmcnt(14)
    ds_read_b64_tr_b16 a[112:113], v215 offset:16384
    ds_read_b64_tr_b16 a[114:115], v215 offset:17408
    ds_read_b64_tr_b16 a[116:117], v216 offset:16384
    ds_read_b64_tr_b16 a[118:119], v216 offset:17408
    s_waitcnt vmcnt(12)
    ds_read_b64_tr_b16 a[120:121], v215 offset:18432
    ds_read_b64_tr_b16 a[122:123], v215 offset:19456
    ds_read_b64_tr_b16 a[124:125], v216 offset:18432
    ds_read_b64_tr_b16 a[126:127], v216 offset:19456
    s_waitcnt lgkmcnt(0)
    s_barrier
    s_waitcnt vmcnt(3)
    v_lshlrev_b32 v16, 16, v222
    v_and_b32 v17, 0xffff0000, v222
    v_lshlrev_b32 v18, 16, v223
    v_and_b32 v19, 0xffff0000, v223
    s_waitcnt vmcnt(2)
    v_lshlrev_b32 v20, 16, v224
    v_and_b32 v21, 0xffff0000, v224
    v_lshlrev_b32 v22, 16, v225
    v_and_b32 v23, 0xffff0000, v225
    s_waitcnt vmcnt(1)
    v_lshlrev_b32 v24, 16, v226
    v_and_b32 v25, 0xffff0000, v226
    v_lshlrev_b32 v26, 16, v227
    v_and_b32 v27, 0xffff0000, v227
    s_waitcnt vmcnt(0)
    v_lshlrev_b32 v28, 16, v228
    v_and_b32 v29, 0xffff0000, v228
    v_lshlrev_b32 v30, 16, v229
    v_and_b32 v31, 0xffff0000, v229
    buffer_load_dword v249, v11, s[40:43], s84 offen sc1
    s_sleep 3
    buffer_load_dword v250, v11, s[40:43], s84 offen sc1
    s_sleep 3
    s_nop 0
Lpoll_P_8:
    s_sub_u32 s6, s6, 1
    s_cbranch_scc1 L_end_P
    buffer_load_dword v251, v11, s[40:43], s84 offen sc1
    s_waitcnt vmcnt(2)
    v_cmp_ne_u32 vcc, s4, v249
    s_nop 1
    s_cbranch_vccz Lpd_P_9
    buffer_load_dword v249, v11, s[40:43], s84 offen sc1
    s_waitcnt vmcnt(2)
    v_cmp_ne_u32 vcc, s4, v250
    s_nop 1
    s_cbranch_vccz Lpd_P_9
    buffer_load_dword v250, v11, s[40:43], s84 offen sc1
    s_waitcnt vmcnt(2)
    v_cmp_ne_u32 vcc, s4, v251
    s_nop 1
    s_cbranch_vccnz Lpoll_P_8
    s_nop 1
Lpd_P_9:
    buffer_load_dwordx4 v[80:83], v5, s[40:43], s71 offen offset:0 sc1
    buffer_load_dwordx4 v[84:87], v5, s[40:43], s72 offen offset:0 sc1
    buffer_load_dwordx4 v[88:91], v5, s[40:43], s71 offen offset:1024 sc1
    buffer_load_dwordx4 v[92:95], v5, s[40:43], s72 offen offset:1024 sc1
    buffer_load_dwordx4 v[96:99], v5, s[40:43], s71 offen offset:2048 sc1
    buffer_load_dwordx4 v[100:103], v5, s[40:43], s72 offen offset:2048 sc1
    buffer_load_dwordx4 v[104:107], v5, s[40:43], s71 offen offset:3072 sc1
    buffer_load_dwordx4 v[108:111], v5, s[40:43], s72 offen offset:3072 sc1
    s_add_u32 s71, s71, 4096
    s_add_u32 s72, s72, 4096
    buffer_load_dwordx4 v[112:115], v5, s[40:43], s71 offen offset:0 sc1
    buffer_load_dwordx4 v[116:119], v5, s[40:43], s72 offen offset:0 sc1
    buffer_load_dwordx4 v[120:123], v5, s[40:43], s71 offen offset:1024 sc1
    buffer_load_dwordx4 v[124:127], v5, s[40:43], s72 offen offset:1024 sc1
    buffer_load_dwordx4 v[128:131], v5, s[40:43], s71 offen offset:2048 sc1
    buffer_load_dwordx4 v[132:135], v5, s[40:43], s72 offen offset:2048 sc1
    buffer_load_dwordx4 v[136:139], v5, s[40:43], s71 offen offset:3072 sc1
    buffer_load_dwordx4 v[140:143], v5, s[40:43], s72 offen offset:3072 sc1
    s_waitcnt vmcnt(15)
    v_mfma_f32_32x32x16_bf16 v[16:31], a[128:131], v[80:83], v[16:31]
    s_waitcnt vmcnt(14)
    v_mfma_f32_32x32x16_bf16 v[32:47], a[128:131], v[84:87], 0
    v_mfma_f32_32x32x16_bf16 v[48:63], a[132:135], v[80:83], 0
    v_mfma_f32_32x32x16_bf16 v[64:79], a[132:135], v[84:87], 0
    s_add_u32 s71, s71, 4096
    s_add_u32 s72, s72, 4096
    buffer_load_dwordx4 v[144:147], v5, s[40:43], s71 offen offset:0 sc1
    buffer_load_dwordx4 v[148:151], v5, s[40:43], s72 offen offset:0 sc1
    buffer_load_dwordx4 v[152:155], v5, s[40:43], s71 offen offset:1024 sc1
    buffer_load_dwordx4 v[156:159], v5, s[40:43], s72 offen offset:1024 sc1
    s_waitcnt vmcnt(17)
    v_mfma_f32_32x32x16_bf16 v[16:31], a[136:139], v[88:91], v[16:31]
    s_waitcnt vmcnt(16)
    v_mfma_f32_32x32x16_bf16 v[32:47], a[136:139], v[92:95], v[32:47]
    v_mfma_f32_32x32x16_bf16 v[48:63], a[140:143], v[88:91], v[48:63]
    v_mfma_f32_32x32x16_bf16 v[64:79], a[140:143], v[92:95], v[64:79]
    buffer_load_dwordx4 v[160:163], v5, s[40:43], s71 offen offset:2048 sc1
    buffer_load_dwordx4 v[164:167], v5, s[40:43], s72 offen offset:2048 sc1
    buffer_load_dwordx4 v[168:171], v5, s[40:43], s71 offen offset:3072 sc1
    buffer_load_dwordx4 v[172:175], v5, s[40:43], s72 offen offset:3072 sc1
    s_waitcnt vmcnt(19)
    v_mfma_f32_32x32x16_bf16 v[16:31], a[144:147], v[96:99], v[16:31]
    s_waitcnt vmcnt(18)
    v_mfma_f32_32x32x16_bf16 v[32:47], a[144:147], v[100:103], v[32:47]
    v_mfma_f32_32x32x16_bf16 v[48:63], a[148:151], v[96:99], v[48:63]
    v_mfma_f32_32x32x16_bf16 v[64:79], a[148:151], v[100:103], v[64:79]
    s_add_u32 s71, s71, 4096
    s_add_u32 s72, s72, 4096
    buffer_load_dwordx4 v[176:179], v5, s[40:43], s71 offen offset:0 sc1
    buffer_load_dwordx4 v[180:183], v5, s[40:43], s72 offen offset:0 sc1
    buffer_load_dwordx4 v[184:187], v5, s[40:43], s71 offen offset:1024 sc1
    buffer_load_dwordx4 v[188:191], v5, s[40:43], s72 offen offset:1024 sc1
    s_waitcnt vmcnt(21)
    v_mfma_f32_32x32x16_bf16 v[16:31], a[152:155], v[104:107], v[16:31]
    s_waitcnt vmcnt(20)
    v_mfma_f32_32x32x16_bf16 v[32:47], a[152:155], v[108:111], v[32:47]
    v_mfma_f32_32x32x16_bf16 v[48:63], a[156:159], v[104:107], v[48:63]
    v_mfma_f32_32x32x16_bf16 v[64:79], a[156:159], v[108:111], v[64:79]
    buffer_load_dwordx4 v[192:195], v5, s[40:43], s71 offen offset:2048 sc1
    buffer_load_dwordx4 v[196:199], v5, s[40:43], s72 offen offset:2048 sc1
    buffer_load_dwordx4 v[200:203], v5, s[40:43], s71 offen offset:3072 sc1
    buffer_load_dwordx4 v[204:207], v5, s[40:43], s72 offen offset:3072 sc1
    s_waitcnt vmcnt(23)
    v_mfma_f32_32x32x16_bf16 v[16:31], a[160:163], v[112:115], v[16:31]
    s_waitcnt vmcnt(22)
    v_mfma_f32_32x32x16_bf16 v[32:47], a[160:163], v[116:119], v[32:47]
    v_mfma_f32_32x32x16_bf16 v[48:63], a[164:167], v[112:115], v[48:63]
    v_mfma_f32_32x32x16_bf16 v[64:79], a[164:167], v[116:119], v[64:79]
    s_add_u32 s71, s71, 4096
    s_add_u32 s72, s72, 4096
    buffer_load_dwordx4 v[80:83], v5, s[40:43], s71 offen offset:0 sc1
    buffer_load_dwordx4 v[84:87], v5, s[40:43], s72 offen offset:0 sc1
    buffer_load_dwordx4 v[88:91], v5, s[40:43], s71 offen offset:1024 sc1
    buffer_load_dwordx4 v[92:95], v5, s[40:43], s72 offen offset:1024 sc1
    s_waitcnt vmcnt(25)
    v_mfma_f32_32x32x16_bf16 v[16:31], a[168:171], v[120:123], v[16:31]
    s_waitcnt vmcnt(24)
    v_mfma_f32_32x32x16_bf16 v[32:47], a[168:171], v[124:127], v[32:47]
    v_mfma_f32_32x32x16_bf16 v[48:63], a[172:175], v[120:123], v[48:63]
    v_mfma_f32_32x32x16_bf16 v[64:79], a[172:175], v[124:127], v[64:79]
    buffer_load_dwordx4 v[96:99], v5, s[40:43], s71 offen offset:2048 sc1
    buffer_load_dwordx4 v[100:103], v5, s[40:43], s72 offen offset:2048 sc1
    buffer_load_dwordx4 v[104:107], v5, s[40:43], s71 offen offset:3072 sc1
    buffer_load_dwordx4 v[108:111], v5, s[40:43], s72 offen offset:3072 sc1
    s_waitcnt vmcnt(27)
    v_mfma_f32_32x32x16_bf16 v[16:31], a[176:179], v[128:131], v[16:31]
    s_waitcnt vmcnt(26)
    v_mfma_f32_32x32x16_bf16 v[32:47], a[176:179], v[132:135], v[32:47]
    v_mfma_f32_32x32x16_bf16 v[48:63], a[180:183], v[128:131], v[48:63]
    v_mfma_f32_32x32x16_bf16 v[64:79], a[180:183], v[132:135], v[64:79]
    s_add_u32 s71, s71, 4096
    s_add_u32 s72, s72, 4096
    buffer_load_dwordx4 v[112:115], v5, s[40:43], s71 offen offset:0 sc1
    buffer_load_dwordx4 v[116:119], v5, s[40:43], s72 offen offset:0 sc1
    buffer_load_dwordx4 v[120:123], v5, s[40:43], s71 offen offset:1024 sc1
    buffer_load_dwordx4 v[124:127], v5, s[40:43], s72 offen offset:1024 sc1
    s_waitcnt vmcnt(29)
    v_mfma_f32_32x32x16_bf16 v[16:31], a[184:187], v[136:139], v[16:31]
    s_waitcnt vmcnt(28)
    v_mfma_f32_32x32x16_bf16 v[32:47], a[184:187], v[140:143], v[32:47]
    v_mfma_f32_32x32x16_bf16 v[48:63], a[188:191], v[136:139], v[48:63]
    v_mfma_f32_32x32x16_bf16 v[64:79], a[188:191], v[140:143], v[64:79]
    buffer_load_dwordx4 v[128:131], v5, s[40:43], s71 offen offset:2048 sc1
    buffer_load_dwordx4 v[132:135], v5, s[40:43], s72 offen offset:2048 sc1
    buffer_load_dwordx4 v[136:139], v5, s[40:43], s71 offen offset:3072 sc1
    buffer_load_dwordx4 v[140:143], v5, s[40:43], s72 offen offset:3072 sc1
    s_waitcnt vmcnt(31)
    v_mfma_f32_32x32x16_bf16 v[16:31], a[192:195], v[144:147], v[16:31]
    s_waitcnt vmcnt(30)
    v_mfma_f32_32x32x16_bf16 v[32:47], a[192:195], v[148:151], v[32:47]
    v_mfma_f32_32x32x16_bf16 v[48:63], a[196:199], v[144:147], v[48:63]
    v_mfma_f32_32x32x16_bf16 v[64:79], a[196:199], v[148:151], v[64:79]
    ds_read_b64_tr_b16 a[128:129], v217 offset:28672
    ds_read_b64_tr_b16 a[130:131], v217 offset:29696
    ds_read_b64_tr_b16 a[132:133], v218 offset:28672
    ds_read_b64_tr_b16 a[134:135], v218 offset:29696
    s_add_u32 s71, s71, 4096
    s_add_u32 s72, s72, 4096
    buffer_load_dwordx4 v[144:147], v5, s[40:43], s71 offen offset:0 sc1
    buffer_load_dwordx4 v[148:151], v5, s[40:43], s72 offen offset:0 sc1
    s_waitcnt vmcnt(31)
    v_mfma_f32_32x32x16_bf16 v[16:31], a[200:203], v[152:155], v[16:31]
    s_waitcnt vmcnt(30)
    v_mfma_f32_32x32x16_bf16 v[32:47], a[200:203], v[156:159], v[32:47]
    v_mfma_f32_32x32x16_bf16 v[48:63], a[204:207], v[152:155], v[48:63]
    v_mfma_f32_32x32x16_bf16 v[64:79], a[204:207], v[156:159], v[64:79]
    ds_read_b64_tr_b16 a[136:137], v217 offset:30720
    ds_read_b64_tr_b16 a[138:139], v217 offset:31744
    ds_read_b64_tr_b16 a[140:141], v218 offset:30720
    ds_read_b64_tr_b16 a[142:143], v218 offset:31744
    buffer_load_dwordx4 v[152:155], v5, s[40:43], s71 offen offset:1024 sc1
    buffer_load_dwordx4 v[156:159], v5, s[40:43], s72 offen offset:1024 sc1
    s_waitcnt vmcnt(31)
    v_mfma_f32_32x32x16_bf16 v[16:31], a[208:211], v[160:163], v[16:31]
    s_waitcnt vmcnt(30)
    v_mfma_f32_32x32x16_bf16 v[32:47], a[208:211], v[164:167], v[32:47]
    v_mfma_f32_32x32x16_bf16 v[48:63], a[212:215], v[160:163], v[48:63]
    v_mfma_f32_32x32x16_bf16 v[64:79], a[212:215], v[164:167], v[64:79]
    ds_read_b64_tr_b16 a[144:145], v217 offset:32768
    ds_read_b64_tr_b16 a[146:147], v217 offset:33792
    ds_read_b64_tr_b16 a[148:149], v218 offset:32768
    ds_read_b64_tr_b16 a[150:151], v218 offset:33792
    buffer_load_dwordx4 v[160:163], v5, s[40:43], s71 offen offset:2048 sc1
    buffer_load_dwordx4 v[164:167], v5, s[40:43], s72 offen offset:2048 sc1
    s_waitcnt vmcnt(31)
    v_mfma_f32_32x32x16_bf16 v[16:31], a[216:219], v[168:171], v[16:31]
    s_waitcnt vmcnt(30)
    v_mfma_f32_32x32x16_bf16 v[32:47], a[216:219], v[172:175], v[32:47]
    v_mfma_f32_32x32x16_bf16 v[48:63], a[220:223], v[168:171], v[48:63]
    v_mfma_f32_32x32x16_bf16 v[64:79], a[220:223], v[172:175], v[64:79]
    ds_read_b64_tr_b16 a[152:153], v217 offset:34816
    ds_read_b64_tr_b16 a[154:155], v217 offset:35840
    ds_read_b64_tr_b16 a[156:157], v218 offset:34816
    ds_read_b64_tr_b16 a[158:159], v218 offset:35840
    buffer_load_dwordx4 v[168:171], v5, s[40:43], s71 offen offset:3072 sc1
    buffer_load_dwordx4 v[172:175], v5, s[40:43], s72 offen offset:3072 sc1
    s_waitcnt vmcnt(31)
    v_mfma_f32_32x32x16_bf16 v[16:31], a[224:227], v[176:179], v[16:31]
    s_waitcnt vmcnt(30)
    v_mfma_f32_32x32x16_bf16 v[32:47], a[224:227], v[180:183], v[32:47]
    v_mfma_f32_32x32x16_bf16 v[48:63], a[228:231], v[176:179], v[48:63]
    v_mfma_f32_32x32x16_bf16 v[64:79], a[228:231], v[180:183], v[64:79]
    s_add_u32 s71, s71, 4096
    s_add_u32 s72, s72, 4096
    buffer_load_dwordx4 v[176:179], v5, s[40:43], s71 offen offset:0 sc1
    buffer_load_dwordx4 v[180:183], v5, s[40:43], s72 offen offset:0 sc1
    s_waitcnt vmcnt(31)
    v_mfma_f32_32x32x16_bf16 v[16:31], a[232:235], v[184:187], v[16:31]
    s_waitcnt vmcnt(30)
    v_mfma_f32_32x32x16_bf16 v[32:47], a[232:235], v[188:191], v[32:47]
    v_mfma_f32_32x32x16_bf16 v[48:63], a[236:239], v[184:187], v[48:63]
    v_mfma_f32_32x32x16_bf16 v[64:79], a[236:239], v[188:191], v[64:79]
    buffer_load_dwordx4 v[184:187], v5, s[40:43], s71 offen offset:1024 sc1
    buffer_load_dwordx4 v[188:191], v5, s[40:43], s72 offen offset:1024 sc1
    s_waitcnt vmcnt(31)
    v_mfma_f32_32x32x16_bf16 v[16:31], a[240:243], v[192:195], v[16:31]
    s_waitcnt vmcnt(30)
    v_mfma_f32_32x32x16_bf16 v[32:47], a[240:243], v[196:199], v[32:47]
    v_mfma_f32_32x32x16_bf16 v[48:63], a[244:247], v[192:195], v[48:63]
    v_mfma_f32_32x32x16_bf16 v[64:79], a[244:247], v[196:199], v[64:79]
    buffer_load_dwordx4 v[192:195], v5, s[40:43], s71 offen offset:2048 sc1
    buffer_load_dwordx4 v[196:199], v5, s[40:43], s72 offen offset:2048 sc1
    s_waitcnt vmcnt(31)
    v_mfma_f32_32x32x16_bf16 v[16:31], a[248:251], v[200:203], v[16:31]
    s_waitcnt vmcnt(30)
    v_mfma_f32_32x32x16_bf16 v[32:47], a[248:251], v[204:207], v[32:47]
    v_mfma_f32_32x32x16_bf16 v[48:63], a[252:255], v[200:203], v[48:63]
    v_mfma_f32_32x32x16_bf16 v[64:79], a[252:255], v[204:207], v[64:79]
    buffer_load_dwordx4 v[200:203], v5, s[40:43], s71 offen offset:3072 sc1
    buffer_load_dwordx4 v[204:207], v5, s[40:43], s72 offen offset:3072 sc1
    s_waitcnt vmcnt(31)
    v_mfma_f32_32x32x16_bf16 v[16:31], a[0:3], v[80:83], v[16:31]
    s_waitcnt vmcnt(30)
    v_mfma_f32_32x32x16_bf16 v[32:47], a[0:3], v[84:87], v[32:47]
    v_mfma_f32_32x32x16_bf16 v[48:63], a[4:7], v[80:83], v[48:63]
    v_mfma_f32_32x32x16_bf16 v[64:79], a[4:7], v[84:87], v[64:79]
    s_waitcnt vmcnt(29)
    v_mfma_f32_32x32x16_bf16 v[16:31], a[8:11], v[88:91], v[16:31]
    s_waitcnt vmcnt(28)
    v_mfma_f32_32x32x16_bf16 v[32:47], a[8:11], v[92:95], v[32:47]
    v_mfma_f32_32x32x16_bf16 v[48:63], a[12:15], v[88:91], v[48:63]
    v_mfma_f32_32x32x16_bf16 v[64:79], a[12:15], v[92:95], v[64:79]
    s_add_u32 m0, s70, 12288
    s_mov_b32 s73, 262144
    buffer_load_dwordx4 v214, s[24:27], s73 offen lds
    s_add_u32 m0, s70, 13312
    s_mov_b32 s73, 294912
    buffer_load_dwordx4 v214, s[24:27], s73 offen lds
    s_waitcnt vmcnt(29)
    v_mfma_f32_32x32x16_bf16 v[16:31], a[16:19], v[96:99], v[16:31]
    s_waitcnt vmcnt(28)
    v_mfma_f32_32x32x16_bf16 v[32:47], a[16:19], v[100:103], v[32:47]
    v_mfma_f32_32x32x16_bf16 v[48:63], a[20:23], v[96:99], v[48:63]
    v_mfma_f32_32x32x16_bf16 v[64:79], a[20:23], v[100:103], v[64:79]
    s_add_u32 m0, s70, 14336
    s_mov_b32 s73, 327680
    buffer_load_dwordx4 v214, s[24:27], s73 offen lds
    s_add_u32 m0, s70, 15360
    s_mov_b32 s73, 360448
    buffer_load_dwordx4 v214, s[24:27], s73 offen lds
    s_waitcnt vmcnt(29)
    v_mfma_f32_32x32x16_bf16 v[16:31], a[24:27], v[104:107], v[16:31]
    s_waitcnt vmcnt(28)
    v_mfma_f32_32x32x16_bf16 v[32:47], a[24:27], v[108:111], v[32:47]
    v_mfma_f32_32x32x16_bf16 v[48:63], a[28:31], v[104:107], v[48:63]
    v_mfma_f32_32x32x16_bf16 v[64:79], a[28:31], v[108:111], v[64:79]
    s_add_u32 m0, s70, 16384
    s_mov_b32 s73, 393216
    buffer_load_dwordx4 v214, s[24:27], s73 offen lds
    s_add_u32 m0, s70, 17408
    s_mov_b32 s73, 425984
    buffer_load_dwordx4 v214, s[24:27], s73 offen lds
    s_waitcnt vmcnt(29)
    v_mfma_f32_32x32x16_bf16 v[16:31], a[32:35], v[112:115], v[16:31]
    s_waitcnt vmcnt(28)
    v_mfma_f32_32x32x16_bf16 v[32:47], a[32:35], v[116:119], v[32:47]
    v_mfma_f32_32x32x16_bf16 v[48:63], a[36:39], v[112:115], v[48:63]
    v_mfma_f32_32x32x16_bf16 v[64:79], a[36:39], v[116:119], v[64:79]
    s_add_u32 m0, s70, 18432
    s_mov_b32 s73, 458752
    buffer_load_dwordx4 v214, s[24:27], s73 offen lds
    s_add_u32 m0, s70, 19456
    s_mov_b32 s73, 491520
    buffer_load_dwordx4 v214, s[24:27], s73 offen lds
    s_waitcnt vmcnt(29)
    v_mfma_f32_32x32x16_bf16 v[16:31], a[40:43], v[120:123], v[16:31]
    s_waitcnt vmcnt(28)
    v_mfma_f32_32x32x16_bf16 v[32:47], a[40:43], v[124:127], v[32:47]
    v_mfma_f32_32x32x16_bf16 v[48:63], a[44:47], v[120:123], v[48:63]
    v_mfma_f32_32x32x16_bf16 v[64:79], a[44:47], v[124:127], v[64:79]
    s_add_u32 m0, s70, 20480
    s_mov_b32 s73, 524288
    buffer_load_dwordx4 v214, s[24:27], s73 offen lds
    s_add_u32 m0, s70, 21504
    s_mov_b32 s73, 557056
    buffer_load_dwordx4 v214, s[24:27], s73 offen lds
    s_waitcnt vmcnt(29)
    v_mfma_f32_32x32x16_bf16 v[16:31], a[48:51], v[128:131], v[16:31]
    s_waitcnt vmcnt(28)
    v_mfma_f32_32x32x16_bf16 v[32:47], a[48:51], v[132:135], v[32:47]
    v_mfma_f32_32x32x16_bf16 v[48:63], a[52:55], v[128:131], v[48:63]
    v_mfma_f32_32x32x16_bf16 v[64:79], a[52:55], v[132:135], v[64:79]
    s_add_u32 m0, s70, 22528
    s_mov_b32 s73, 589824
    buffer_load_dwordx4 v214, s[24:27], s73 offen lds
    s_add_u32 m0, s70, 23552
    s_mov_b32 s73, 622592
    buffer_load_dwordx4 v214, s[24:27], s73 offen lds
    s_waitcnt vmcnt(29)
    v_mfma_f32_32x32x16_bf16 v[16:31], a[56:59], v[136:139], v[16:31]
    s_waitcnt vmcnt(28)
    v_mfma_f32_32x32x16_bf16 v[32:47], a[56:59], v[140:143], v[32:47]
    v_mfma_f32_32x32x16_bf16 v[48:63], a[60:63], v[136:139], v[48:63]
    v_mfma_f32_32x32x16_bf16 v[64:79], a[60:63], v[140:143], v[64:79]
    s_add_u32 m0, s70, 24576
    s_mov_b32 s73, 655360
    buffer_load_dwordx4 v214, s[24:27], s73 offen lds
    s_add_u32 m0, s70, 25600
    s_mov_b32 s73, 688128
    buffer_load_dwordx4 v214, s[24:27], s73 offen lds
    s_waitcnt vmcnt(29)
    v_mfma_f32_32x32x16_bf16 v[16:31], a[64:67], v[144:147], v[16:31]
    s_waitcnt vmcnt(28)
    v_mfma_f32_32x32x16_bf16 v[32:47], a[64:67], v[148:151], v[32:47]
    v_mfma_f32_32x32x16_bf16 v[48:63], a[68:71], v[144:147], v[48:63]
    v_mfma_f32_32x32x16_bf16 v[64:79], a[68:71], v[148:151], v[64:79]
    s_add_u32 m0, s70, 26624
    s_mov_b32 s73, 720896
    buffer_load_dwordx4 v214, s[24:27], s73 offen lds
    s_add_u32 m0, s70, 27648
    s_mov_b32 s73, 753664
    buffer_load_dwordx4 v214, s[24:27], s73 offen lds
    s_waitcnt vmcnt(29)
    v_mfma_f32_32x32x16_bf16 v[16:31], a[72:75], v[152:155], v[16:31]
    s_waitcnt vmcnt(28)
    v_mfma_f32_32x32x16_bf16 v[32:47], a[72:75], v[156:159], v[32:47]
    v_mfma_f32_32x32x16_bf16 v[48:63], a[76:79], v[152:155], v[48:63]
    v_mfma_f32_32x32x16_bf16 v[64:79], a[76:79], v[156:159], v[64:79]
    s_waitcnt lgkmcnt(12)
    s_add_u32 m0, s70, 28672
    s_mov_b32 s73, 786432
    buffer_load_dwordx4 v214, s[24:27], s73 offen lds
    s_add_u32 m0, s70, 29696
    s_mov_b32 s73, 819200
    buffer_load_dwordx4 v214, s[24:27], s73 offen lds
    s_waitcnt vmcnt(29)
    v_mfma_f32_32x32x16_bf16 v[16:31], a[80:83], v[160:163], v[16:31]
    s_waitcnt vmcnt(28)
    v_mfma_f32_32x32x16_bf16 v[32:47], a[80:83], v[164:167], v[32:47]
    v_mfma_f32_32x32x16_bf16 v[48:63], a[84:87], v[160:163], v[48:63]
    v_mfma_f32_32x32x16_bf16 v[64:79], a[84:87], v[164:167], v[64:79]
    s_waitcnt lgkmcnt(8)
    s_add_u32 m0, s70, 30720
    s_mov_b32 s73, 851968
    buffer_load_dwordx4 v214, s[24:27], s73 offen lds
    s_add_u32 m0, s70, 31744
    s_mov_b32 s73, 884736
    buffer_load_dwordx4 v214, s[24:27], s73 offen lds
    s_waitcnt vmcnt(29)
    v_mfma_f32_32x32x16_bf16 v[16:31], a[88:91], v[168:171], v[16:31]
    s_waitcnt vmcnt(28)
    v_mfma_f32_32x32x16_bf16 v[32:47], a[88:91], v[172:175], v[32:47]
    v_mfma_f32_32x32x16_bf16 v[48:63], a[92:95], v[168:171], v[48:63]
    v_mfma_f32_32x32x16_bf16 v[64:79], a[92:95], v[172:175], v[64:79]
    s_waitcnt lgkmcnt(4)
    s_add_u32 m0, s70, 32768
    s_mov_b32 s73, 917504
    buffer_load_dwordx4 v214, s[24:27], s73 offen lds
    s_add_u32 m0, s70, 33792
    s_mov_b32 s73, 950272
    buffer_load_dwordx4 v214, s[24:27], s73 offen lds
    s_waitcnt vmcnt(29)
    v_mfma_f32_32x32x16_bf16 v[16:31], a[96:99], v[176:179], v[16:31]
    s_waitcnt vmcnt(28)
    v_mfma_f32_32x32x16_bf16 v[32:47], a[96:99], v[180:183], v[32:47]
    v_mfma_f32_32x32x16_bf16 v[48:63], a[100:103], v[176:179], v[48:63]
    v_mfma_f32_32x32x16_bf16 v[64:79], a[100:103], v[180:183], v[64:79]
    s_waitcnt lgkmcnt(0)
    s_add_u32 m0, s70, 34816
    s_mov_b32 s73, 983040
    buffer_load_dwordx4 v214, s[24:27], s73 offen lds
    s_add_u32 m0, s70, 35840
    s_mov_b32 s73, 1015808
    buffer_load_dwordx4 v214, s[24:27], s73 offen lds
    s_waitcnt vmcnt(29)
    v_mfma_f32_32x32x16_bf16 v[16:31], a[104:107], v[184:187], v[16:31]
    s_waitcnt vmcnt(28)
    v_mfma_f32_32x32x16_bf16 v[32:47], a[104:107], v[188:191], v[32:47]
    v_mfma_f32_32x32x16_bf16 v[48:63], a[108:111], v[184:187], v[48:63]
    v_mfma_f32_32x32x16_bf16 v[64:79], a[108:111], v[188:191], v[64:79]
    s_waitcnt vmcnt(27)
    v_mfma_f32_32x32x16_bf16 v[16:31], a[112:115], v[192:195], v[16:31]
    s_waitcnt vmcnt(26)
    v_mfma_f32_32x32x16_bf16 v[32:47], a[112:115], v[196:199], v[32:47]
    v_mfma_f32_32x32x16_bf16 v[48:63], a[116:119], v[192:195], v[48:63]
    v_mfma_f32_32x32x16_bf16 v[64:79], a[116:119], v[196:199], v[64:79]
    s_waitcnt vmcnt(25)
    v_mfma_f32_32x32x16_bf16 v[16:31], a[120:123], v[200:203], v[16:31]
    s_waitcnt vmcnt(24)
    v_mfma_f32_32x32x16_bf16 v[32:47], a[120:123], v[204:207], v[32:47]
    v_mfma_f32_32x32x16_bf16 v[48:63], a[124:127], v[200:203], v[48:63]
    v_mfma_f32_32x32x16_bf16 v[64:79], a[124:127], v[204:207], v[64:79]
    s_xor_b32 s68, s3, 1
    s_mul_i32 s68, s68, 36864
    s_add_u32 s68, s68, 12288
    v_add_u32 v221, s68, v4
    s_xor_b32 s68, s3, 2
    s_mul_i32 s68, s68, 36864
    s_add_u32 s68, s68, 16384
    v_add_u32 v222, s68, v4
    s_xor_b32 s68, s3, 3
    s_mul_i32 s68, s68, 36864
    s_add_u32 s68, s68, 20480
    v_add_u32 v223, s68, v4
    ds_write_b128 v221, v[32:35] offset:0
    ds_write_b128 v221, v[36:39] offset:1024
    ds_write_b128 v221, v[40:43] offset:2048
    ds_write_b128 v221, v[44:47] offset:3072
    ds_write_b128 v222, v[48:51] offset:0
    ds_write_b128 v222, v[52:55] offset:1024
    ds_write_b128 v222, v[56:59] offset:2048
    ds_write_b128 v222, v[60:63] offset:3072
    ds_write_b128 v223, v[64:67] offset:0
    ds_write_b128 v223, v[68:71] offset:1024
    ds_write_b128 v223, v[72:75] offset:2048
    ds_write_b128 v223, v[76:79] offset:3072
    v_add_u32 v220, s70, v4
    s_lshl_b32 s68, s64, 1
    s_and_b32 s69, s3, 1
    s_add_u32 s68, s68, s69
    s_mul_i32 s68, s68, 112
    s_lshl_b32 s69, s65, 2
    s_add_u32 s68, s68, s69
    s_and_b32 s69, s3, 2
    s_add_u32 s68, s68, s69
    s_lshl_b32 s68, s68, 10
    s_add_u32 s68, s68, 0x3c0000
    s_waitcnt lgkmcnt(0)
    s_barrier
    ds_read_b128 v[32:35], v220 offset:0
    ds_read_b128 v[48:51], v220 offset:4096
    ds_read_b128 v[64:67], v220 offset:8192
    ds_read_b128 v[36:39], v220 offset:1024
    ds_read_b128 v[52:55], v220 offset:5120
    ds_read_b128 v[68:71], v220 offset:9216
    ds_read_b128 v[40:43], v220 offset:2048
    ds_read_b128 v[56:59], v220 offset:6144
    ds_read_b128 v[72:75], v220 offset:10240
    ds_read_b128 v[44:47], v220 offset:3072
    ds_read_b128 v[60:63], v220 offset:7168
    ds_read_b128 v[76:79], v220 offset:11264
    s_mov_b32 s88, 0xc0135761
    s_mov_b32 s90, 0xbdd2d3e8
    v_mov_b32 v224, s88
    v_mov_b32 v225, s88
    s_waitcnt lgkmcnt(10)
    v_pk_add_f32 v[32:33], v[32:33], v[48:49]
    s_waitcnt lgkmcnt(9)
    v_pk_add_f32 v[16:17], v[16:17], v[64:65]
    v_pk_add_f32 v[34:35], v[34:35], v[50:51]
    v_pk_add_f32 v[18:19], v[18:19], v[66:67]
    s_waitcnt lgkmcnt(7)
    v_pk_add_f32 v[36:37], v[36:37], v[52:53]
    s_waitcnt lgkmcnt(6)
    v_pk_add_f32 v[20:21], v[20:21], v[68:69]
    v_pk_add_f32 v[38:39], v[38:39], v[54:55]
    v_pk_add_f32 v[22:23], v[22:23], v[70:71]
    v_pk_add_f32 v[16:17], v[16:17], v[32:33]
    v_pk_add_f32 v[18:19], v[18:19], v[34:35]
    v_pk_add_f32 v[20:21], v[20:21], v[36:37]
    v_pk_add_f32 v[22:23], v[22:23], v[38:39]
    v_pk_mul_f32 v[80:81], v[16:17], v[16:17]
    v_pk_mul_f32 v[82:83], v[18:19], v[18:19]
    v_pk_mul_f32 v[84:85], v[20:21], v[20:21]
    v_pk_mul_f32 v[86:87], v[22:23], v[22:23]
    v_pk_fma_f32 v[80:81], v[80:81], s[90:91], v[224:225] op_sel_hi:[1,0,1]
    v_pk_fma_f32 v[82:83], v[82:83], s[90:91], v[224:225] op_sel_hi:[1,0,1]
    v_pk_fma_f32 v[84:85], v[84:85], s[90:91], v[224:225] op_sel_hi:[1,0,1]
    v_pk_fma_f32 v[86:87], v[86:87], s[90:91], v[224:225] op_sel_hi:[1,0,1]
    v_pk_mul_f32 v[80:81], v[80:81], v[16:17]
    v_pk_mul_f32 v[82:83], v[82:83], v[18:19]
    v_pk_mul_f32 v[84:85], v[84:85], v[20:21]
    v_pk_mul_f32 v[86:87], v[86:87], v[22:23]
    v_exp_f32 v80, v80
    v_exp_f32 v81, v81
    v_exp_f32 v82, v82
    v_exp_f32 v83, v83
    v_exp_f32 v84, v84
    v_exp_f32 v85, v85
    v_exp_f32 v86, v86
    v_exp_f32 v87, v87
    v_pk_add_f32 v[80:81], v[80:81], 1.0 op_sel_hi:[1,0]
    v_pk_add_f32 v[82:83], v[82:83], 1.0 op_sel_hi:[1,0]
    v_pk_add_f32 v[84:85], v[84:85], 1.0 op_sel_hi:[1,0]
    v_pk_add_f32 v[86:87], v[86:87], 1.0 op_sel_hi:[1,0]
    v_rcp_f32 v80, v80
    v_rcp_f32 v81, v81
    v_rcp_f32 v82, v82
    v_rcp_f32 v83, v83
    v_rcp_f32 v84, v84
    v_rcp_f32 v85, v85
    v_rcp_f32 v86, v86
    v_rcp_f32 v87, v87
    v_pk_mul_f32 v[80:81], v[80:81], v[16:17]
    v_pk_mul_f32 v[82:83], v[82:83], v[18:19]
    v_pk_mul_f32 v[84:85], v[84:85], v[20:21]
    v_pk_mul_f32 v[86:87], v[86:87], v[22:23]
    v_cvt_pk_bf16_f32 v96, v80, v81
    v_cvt_pk_bf16_f32 v97, v82, v83
    v_cvt_pk_bf16_f32 v98, v84, v85
    v_cvt_pk_bf16_f32 v99, v86, v87
    buffer_store_dwordx4 v[96:99], v5, s[40:43], s68 offen offset:0 sc1
    s_waitcnt lgkmcnt(4)
    v_pk_add_f32 v[40:41], v[40:41], v[56:57]
    s_waitcnt lgkmcnt(3)
    v_pk_add_f32 v[24:25], v[24:25], v[72:73]
    v_pk_add_f32 v[42:43], v[42:43], v[58:59]
    v_pk_add_f32 v[26:27], v[26:27], v[74:75]
    s_waitcnt lgkmcnt(1)
    v_pk_add_f32 v[44:45], v[44:45], v[60:61]
    s_waitcnt lgkmcnt(0)
    v_pk_add_f32 v[28:29], v[28:29], v[76:77]
    v_pk_add_f32 v[46:47], v[46:47], v[62:63]
    v_pk_add_f32 v[30:31], v[30:31], v[78:79]
    v_pk_add_f32 v[24:25], v[24:25], v[40:41]
    v_pk_add_f32 v[26:27], v[26:27], v[42:43]
    v_pk_add_f32 v[28:29], v[28:29], v[44:45]
    v_pk_add_f32 v[30:31], v[30:31], v[46:47]
    v_pk_mul_f32 v[88:89], v[24:25], v[24:25]
    v_pk_mul_f32 v[90:91], v[26:27], v[26:27]
    v_pk_mul_f32 v[92:93], v[28:29], v[28:29]
    v_pk_mul_f32 v[94:95], v[30:31], v[30:31]
    v_pk_fma_f32 v[88:89], v[88:89], s[90:91], v[224:225] op_sel_hi:[1,0,1]
    v_pk_fma_f32 v[90:91], v[90:91], s[90:91], v[224:225] op_sel_hi:[1,0,1]
    v_pk_fma_f32 v[92:93], v[92:93], s[90:91], v[224:225] op_sel_hi:[1,0,1]
    v_pk_fma_f32 v[94:95], v[94:95], s[90:91], v[224:225] op_sel_hi:[1,0,1]
    v_pk_mul_f32 v[88:89], v[88:89], v[24:25]
    v_pk_mul_f32 v[90:91], v[90:91], v[26:27]
    v_pk_mul_f32 v[92:93], v[92:93], v[28:29]
    v_pk_mul_f32 v[94:95], v[94:95], v[30:31]
    v_exp_f32 v88, v88
    v_exp_f32 v89, v89
    v_exp_f32 v90, v90
    v_exp_f32 v91, v91
    v_exp_f32 v92, v92
    v_exp_f32 v93, v93
    v_exp_f32 v94, v94
    v_exp_f32 v95, v95
    v_pk_add_f32 v[88:89], v[88:89], 1.0 op_sel_hi:[1,0]
    v_pk_add_f32 v[90:91], v[90:91], 1.0 op_sel_hi:[1,0]
    v_pk_add_f32 v[92:93], v[92:93], 1.0 op_sel_hi:[1,0]
    v_pk_add_f32 v[94:95], v[94:95], 1.0 op_sel_hi:[1,0]
    v_rcp_f32 v88, v88
    v_rcp_f32 v89, v89
    v_rcp_f32 v90, v90
    v_rcp_f32 v91, v91
    v_rcp_f32 v92, v92
    v_rcp_f32 v93, v93
    v_rcp_f32 v94, v94
    v_rcp_f32 v95, v95
    v_pk_mul_f32 v[88:89], v[88:89], v[24:25]
    v_pk_mul_f32 v[90:91], v[90:91], v[26:27]
    v_pk_mul_f32 v[92:93], v[92:93], v[28:29]
    v_pk_mul_f32 v[94:95], v[94:95], v[30:31]
    v_cvt_pk_bf16_f32 v100, v88, v89
    v_cvt_pk_bf16_f32 v101, v90, v91
    v_cvt_pk_bf16_f32 v102, v92, v93
    v_cvt_pk_bf16_f32 v103, v94, v95
    buffer_store_dwordx4 v[100:103], v5, s[40:43], s68 offen offset:1024 sc1
    v_mov_b32 v9, v5
    s_waitcnt vmcnt(24)
    ds_read_b64_tr_b16 a[160:161], v217 offset:12288
    ds_read_b64_tr_b16 a[162:163], v217 offset:13312
    ds_read_b64_tr_b16 a[164:165], v218 offset:12288
    ds_read_b64_tr_b16 a[166:167], v218 offset:13312
    s_waitcnt vmcnt(22)
    ds_read_b64_tr_b16 a[168:169], v217 offset:14336
    ds_read_b64_tr_b16 a[170:171], v217 offset:15360
    ds_read_b64_tr_b16 a[172:173], v218 offset:14336
    ds_read_b64_tr_b16 a[174:175], v218 offset:15360
    s_waitcnt vmcnt(20)
    ds_read_b64_tr_b16 a[176:177], v217 offset:16384
    ds_read_b64_tr_b16 a[178:179], v217 offset:17408
    ds_read_b64_tr_b16 a[180:181], v218 offset:16384
    ds_read_b64_tr_b16 a[182:183], v218 offset:17408
    s_waitcnt vmcnt(18)
    ds_read_b64_tr_b16 a[184:185], v217 offset:18432
    ds_read_b64_tr_b16 a[186:187], v217 offset:19456
    ds_read_b64_tr_b16 a[188:189], v218 offset:18432
    ds_read_b64_tr_b16 a[190:191], v218 offset:19456
    s_waitcnt vmcnt(16)
    ds_read_b64_tr_b16 a[192:193], v217 offset:20480
    ds_read_b64_tr_b16 a[194:195], v217 offset:21504
    ds_read_b64_tr_b16 a[196:197], v218 offset:20480
    ds_read_b64_tr_b16 a[198:199], v218 offset:21504
    s_waitcnt vmcnt(14)
    ds_read_b64_tr_b16 a[200:201], v217 offset:22528
    ds_read_b64_tr_b16 a[202:203], v217 offset:23552
    ds_read_b64_tr_b16 a[204:205], v218 offset:22528
    ds_read_b64_tr_b16 a[206:207], v218 offset:23552
    s_waitcnt vmcnt(12)
    ds_read_b64_tr_b16 a[208:209], v217 offset:24576
    ds_read_b64_tr_b16 a[210:211], v217 offset:25600
    ds_read_b64_tr_b16 a[212:213], v218 offset:24576
    ds_read_b64_tr_b16 a[214:215], v218 offset:25600
    s_waitcnt vmcnt(10)
    ds_read_b64_tr_b16 a[216:217], v217 offset:26624
    ds_read_b64_tr_b16 a[218:219], v217 offset:27648
    ds_read_b64_tr_b16 a[220:221], v218 offset:26624
    ds_read_b64_tr_b16 a[222:223], v218 offset:27648
    s_waitcnt vmcnt(8)
    ds_read_b64_tr_b16 a[224:225], v217 offset:28672
    ds_read_b64_tr_b16 a[226:227], v217 offset:29696
    ds_read_b64_tr_b16 a[228:229], v218 offset:28672
    ds_read_b64_tr_b16 a[230:231], v218 offset:29696
    s_waitcnt vmcnt(6)
    ds_read_b64_tr_b16 a[232:233], v217 offset:30720
    ds_read_b64_tr_b16 a[234:235], v217 offset:31744
    ds_read_b64_tr_b16 a[236:237], v218 offset:30720
    ds_read_b64_tr_b16 a[238:239], v218 offset:31744
    s_waitcnt vmcnt(4)
    ds_read_b64_tr_b16 a[240:241], v217 offset:32768
    ds_read_b64_tr_b16 a[242:243], v217 offset:33792
    ds_read_b64_tr_b16 a[244:245], v218 offset:32768
    ds_read_b64_tr_b16 a[246:247], v218 offset:33792
    s_waitcnt vmcnt(2)
    ds_read_b64_tr_b16 a[248:249], v217 offset:34816
    ds_read_b64_tr_b16 a[250:251], v217 offset:35840
    ds_read_b64_tr_b16 a[252:253], v218 offset:34816
    ds_read_b64_tr_b16 a[254:255], v218 offset:35840
    s_waitcnt vmcnt(0)
    v_mov_b32 v8, s4
    s_mov_b64 exec, 1
    buffer_store_dword v8, v9, s[40:43], s82 offen sc1
    s_mov_b64 exec, -1
    s_add_u32 m0, s70, 0
    s_mov_b32 s73, 1048576
    buffer_load_dwordx4 v214, s[24:27], s73 offen lds
    s_add_u32 m0, s70, 1024
    s_mov_b32 s73, 1081344
    buffer_load_dwordx4 v214, s[24:27], s73 offen lds
    s_add_u32 m0, s70, 2048
    s_mov_b32 s73, 1114112
    buffer_load_dwordx4 v214, s[24:27], s73 offen lds
    s_add_u32 m0, s70, 3072
    s_mov_b32 s73, 1146880
    buffer_load_dwordx4 v214, s[24:27], s73 offen lds
    s_add_u32 m0, s70, 4096
    s_mov_b32 s73, 1179648
    buffer_load_dwordx4 v214, s[24:27], s73 offen lds
    s_add_u32 m0, s70, 5120
    s_mov_b32 s73, 1212416
    buffer_load_dwordx4 v214, s[24:27], s73 offen lds
    s_add_u32 m0, s70, 6144
    s_mov_b32 s73, 1245184
    buffer_load_dwordx4 v214, s[24:27], s73 offen lds
    s_add_u32 m0, s70, 7168
    s_mov_b32 s73, 1277952
    buffer_load_dwordx4 v214, s[24:27], s73 offen lds
    s_add_u32 m0, s70, 8192
    s_mov_b32 s73, 1310720
    buffer_load_dwordx4 v214, s[24:27], s73 offen lds
    s_add_u32 m0, s70, 9216
    s_mov_b32 s73, 1343488
    buffer_load_dwordx4 v214, s[24:27], s73 offen lds
    s_add_u32 m0, s70, 10240
    s_mov_b32 s73, 1376256
    buffer_load_dwordx4 v214, s[24:27], s73 offen lds
    s_add_u32 m0, s70, 11264
    s_mov_b32 s73, 1409024
    buffer_load_dwordx4 v214, s[24:27], s73 offen lds
    s_waitcnt lgkmcnt(15)
    s_add_u32 m0, s70, 12288
    s_mov_b32 s73, 1441792
    buffer_load_dwordx4 v214, s[24:27], s73 offen lds
    s_add_u32 m0, s70, 13312
    s_mov_b32 s73, 1474560
    buffer_load_dwordx4 v214, s[24:27], s73 offen lds
    s_add_u32 m0, s70, 14336
    s_mov_b32 s73, 1507328
    buffer_load_dwordx4 v214, s[24:27], s73 offen lds
    s_add_u32 m0, s70, 15360
    s_mov_b32 s73, 1540096
    buffer_load_dwordx4 v214, s[24:27], s73 offen lds
    s_add_u32 m0, s70, 16384
    s_mov_b32 s73, 1572864
    buffer_load_dwordx4 v214, s[24:27], s73 offen lds
    s_add_u32 m0, s70, 17408
    s_mov_b32 s73, 1605632
    buffer_load_dwordx4 v214, s[24:27], s73 offen lds
    s_add_u32 m0, s70, 18432
    s_mov_b32 s73, 1638400
    buffer_load_dwordx4 v214, s[24:27], s73 offen lds
    s_add_u32 m0, s70, 19456
    s_mov_b32 s73, 1671168
    buffer_load_dwordx4 v214, s[24:27], s73 offen lds
    s_add_u32 m0, s70, 20480
    s_mov_b32 s73, 1703936
    buffer_load_dwordx4 v214, s[24:27], s73 offen lds
    s_add_u32 m0, s70, 21504
    s_mov_b32 s73, 1736704
    buffer_load_dwordx4 v214, s[24:27], s73 offen lds
    s_add_u32 m0, s70, 22528
    s_mov_b32 s73, 1769472
    buffer_load_dwordx4 v214, s[24:27], s73 offen lds
    s_add_u32 m0, s70, 23552
    s_mov_b32 s73, 1802240
    buffer_load_dwordx4 v214, s[24:27], s73 offen lds
    v_lshrrev_b32 v220, 5, v1
    v_lshlrev_b32 v220, 3, v220
    s_lshl_b32 s68, s67, 7
    s_lshr_b32 s69, s3, 1
    s_lshl_b32 s69, s69, 6
    s_add_u32 s68, s68, s69
    buffer_load_dwordx2 v[222:223], v220, s[32:35], s68 offen offset:0
    buffer_load_dwordx2 v[224:225], v220, s[32:35], s68 offen offset:16
    buffer_load_dwordx2 v[226:227], v220, s[32:35], s68 offen offset:32
    buffer_load_dwordx2 v[228:229], v220, s[32:35], s68 offen offset:48
    s_lshl_b32 s68, s66, 1
    s_and_b32 s69, s3, 1
    s_add_u32 s71, s68, s69
    s_xor_b32 s72, s71, 1
    s_mul_i32 s68, s3, 28672
    s_add_u32 s68, s68, 0x3c0000
    s_mul_i32 s71, s71, 114688
    s_add_u32 s71, s71, s68
    s_mul_i32 s72, s72, 114688
    s_add_u32 s72, s72, s68
    buffer_load_dword v249, v12, s[40:43], s85 offen sc1
    s_sleep 3
    buffer_load_dword v250, v12, s[40:43], s85 offen sc1
    s_sleep 3
    s_nop 0
Lpoll_P_10:
    s_sub_u32 s6, s6, 1
    s_cbranch_scc1 L_end_P
    buffer_load_dword v251, v12, s[40:43], s85 offen sc1
    s_waitcnt vmcnt(2)
    v_cmp_ne_u32 vcc, s4, v249
    s_nop 1
    s_cbranch_vccz Lpd_P_11
    buffer_load_dword v249, v12, s[40:43], s85 offen sc1
    s_waitcnt vmcnt(2)
    v_cmp_ne_u32 vcc, s4, v250
    s_nop 1
    s_cbranch_vccz Lpd_P_11
    buffer_load_dword v250, v12, s[40:43], s85 offen sc1
    s_waitcnt vmcnt(2)
    v_cmp_ne_u32 vcc, s4, v251
    s_nop 1
    s_cbranch_vccnz Lpoll_P_10
    s_nop 1
Lpd_P_11:
    buffer_load_dwordx4 v[80:83], v4, s[40:43], s71 offen offset:0 sc1
    buffer_load_dwordx4 v[84:87], v4, s[40:43], s72 offen offset:0 sc1
    buffer_load_dwordx4 v[88:91], v4, s[40:43], s71 offen offset:1024 sc1
    buffer_load_dwordx4 v[92:95], v4, s[40:43], s72 offen offset:1024 sc1
    buffer_load_dwordx4 v[96:99], v4, s[40:43], s71 offen offset:2048 sc1
    buffer_load_dwordx4 v[100:103], v4, s[40:43], s72 offen offset:2048 sc1
    buffer_load_dwordx4 v[104:107], v4, s[40:43], s71 offen offset:3072 sc1
    buffer_load_dwordx4 v[108:111], v4, s[40:43], s72 offen offset:3072 sc1
    s_add_u32 s71, s71, 4096
    s_add_u32 s72, s72, 4096
    buffer_load_dwordx4 v[112:115], v4, s[40:43], s71 offen offset:0 sc1
    buffer_load_dwordx4 v[116:119], v4, s[40:43], s72 offen offset:0 sc1
    buffer_load_dwordx4 v[120:123], v4, s[40:43], s71 offen offset:1024 sc1
    buffer_load_dwordx4 v[124:127], v4, s[40:43], s72 offen offset:1024 sc1
    v_lshlrev_b32 v16, 16, v222
    v_and_b32 v17, 0xffff0000, v222
    v_lshlrev_b32 v238, 16, v240
    v_and_b32 v239, 0xffff0000, v240
    v_pk_add_f32 v[16:17], v[16:17], v[238:239]
    v_lshlrev_b32 v18, 16, v223
    v_and_b32 v19, 0xffff0000, v223
    v_lshlrev_b32 v238, 16, v241
    v_and_b32 v239, 0xffff0000, v241
    v_pk_add_f32 v[18:19], v[18:19], v[238:239]
    v_lshlrev_b32 v20, 16, v224
    v_and_b32 v21, 0xffff0000, v224
    v_lshlrev_b32 v238, 16, v242
    v_and_b32 v239, 0xffff0000, v242
    v_pk_add_f32 v[20:21], v[20:21], v[238:239]
    v_lshlrev_b32 v22, 16, v225
    v_and_b32 v23, 0xffff0000, v225
    v_lshlrev_b32 v238, 16, v243
    v_and_b32 v239, 0xffff0000, v243
    v_pk_add_f32 v[22:23], v[22:23], v[238:239]
    v_lshlrev_b32 v24, 16, v226
    v_and_b32 v25, 0xffff0000, v226
    v_lshlrev_b32 v238, 16, v244
    v_and_b32 v239, 0xffff0000, v244
    v_pk_add_f32 v[24:25], v[24:25], v[238:239]
    v_lshlrev_b32 v26, 16, v227
    v_and_b32 v27, 0xffff0000, v227
    v_lshlrev_b32 v238, 16, v245
    v_and_b32 v239, 0xffff0000, v245
    v_pk_add_f32 v[26:27], v[26:27], v[238:239]
    v_lshlrev_b32 v28, 16, v228
    v_and_b32 v29, 0xffff0000, v228
    v_lshlrev_b32 v238, 16, v246
    v_and_b32 v239, 0xffff0000, v246
    v_pk_add_f32 v[28:29], v[28:29], v[238:239]
    v_lshlrev_b32 v30, 16, v229
    v_and_b32 v31, 0xffff0000, v229
    v_lshlrev_b32 v238, 16, v247
    v_and_b32 v239, 0xffff0000, v247
    v_pk_add_f32 v[30:31], v[30:31], v[238:239]
    buffer_load_dwordx4 v[128:131], v4, s[40:43], s71 offen offset:2048 sc1
    buffer_load_dwordx4 v[132:135], v4, s[40:43], s72 offen offset:2048 sc1
    buffer_load_dwordx4 v[136:139], v4, s[40:43], s71 offen offset:3072 sc1
    buffer_load_dwordx4 v[140:143], v4, s[40:43], s72 offen offset:3072 sc1
    s_waitcnt vmcnt(15)
    v_mfma_f32_32x32x16_bf16 v[16:31], a[128:131], v[80:83], v[16:31]
    s_waitcnt vmcnt(14)
    v_mfma_f32_32x32x16_bf16 v[32:47], a[128:131], v[84:87], 0
    v_mfma_f32_32x32x16_bf16 v[48:63], a[132:135], v[80:83], 0
    v_mfma_f32_32x32x16_bf16 v[64:79], a[132:135], v[84:87], 0
    ds_read_b64_tr_b16 a[0:1], v217 offset:0
    ds_read_b64_tr_b16 a[2:3], v217 offset:1024
    ds_read_b64_tr_b16 a[4:5], v218 offset:0
    ds_read_b64_tr_b16 a[6:7], v218 offset:1024
    s_add_u32 s71, s71, 4096
    s_add_u32 s72, s72, 4096
    buffer_load_dwordx4 v[144:147], v4, s[40:43], s71 offen offset:0 sc1
    buffer_load_dwordx4 v[148:151], v4, s[40:43], s72 offen offset:0 sc1
    buffer_load_dwordx4 v[152:155], v4, s[40:43], s71 offen offset:1024 sc1
    buffer_load_dwordx4 v[156:159], v4, s[40:43], s72 offen offset:1024 sc1
    s_waitcnt vmcnt(17)
    v_mfma_f32_32x32x16_bf16 v[16:31], a[136:139], v[88:91], v[16:31]
    s_waitcnt vmcnt(16)
    v_mfma_f32_32x32x16_bf16 v[32:47], a[136:139], v[92:95], v[32:47]
    v_mfma_f32_32x32x16_bf16 v[48:63], a[140:143], v[88:91], v[48:63]
    v_mfma_f32_32x32x16_bf16 v[64:79], a[140:143], v[92:95], v[64:79]
    ds_read_b64_tr_b16 a[8:9], v217 offset:2048
    ds_read_b64_tr_b16 a[10:11], v217 offset:3072
    ds_read_b64_tr_b16 a[12:13], v218 offset:2048
    ds_read_b64_tr_b16 a[14:15], v218 offset:3072
    buffer_load_dwordx4 v[160:163], v4, s[40:43], s71 offen offset:2048 sc1
    buffer_load_dwordx4 v[164:167], v4, s[40:43], s72 offen offset:2048 sc1
    buffer_load_dwordx4 v[168:171], v4, s[40:43], s71 offen offset:3072 sc1
    buffer_load_dwordx4 v[172:175], v4, s[40:43], s72 offen offset:3072 sc1
    s_waitcnt vmcnt(19)
    v_mfma_f32_32x32x16_bf16 v[16:31], a[144:147], v[96:99], v[16:31]
    s_waitcnt vmcnt(18)
    v_mfma_f32_32x32x16_bf16 v[32:47], a[144:147], v[100:103], v[32:47]
    v_mfma_f32_32x32x16_bf16 v[48:63], a[148:151], v[96:99], v[48:63]
    v_mfma_f32_32x32x16_bf16 v[64:79], a[148:151], v[100:103], v[64:79]
    ds_read_b64_tr_b16 a[16:17], v217 offset:4096
    ds_read_b64_tr_b16 a[18:19], v217 offset:5120
    ds_read_b64_tr_b16 a[20:21], v218 offset:4096
    ds_read_b64_tr_b16 a[22:23], v218 offset:5120
    s_add_u32 s71, s71, 4096
    s_add_u32 s72, s72, 4096
    buffer_load_dwordx4 v[176:179], v4, s[40:43], s71 offen offset:0 sc1
    buffer_load_dwordx4 v[180:183], v4, s[40:43], s72 offen offset:0 sc1
    buffer_load_dwordx4 v[184:187], v4, s[40:43], s71 offen offset:1024 sc1
    buffer_load_dwordx4 v[188:191], v4, s[40:43], s72 offen offset:1024 sc1
    s_waitcnt vmcnt(21)
    v_mfma_f32_32x32x16_bf16 v[16:31], a[152:155], v[104:107], v[16:31]
    s_waitcnt vmcnt(20)
    v_mfma_f32_32x32x16_bf16 v[32:47], a[152:155], v[108:111], v[32:47]
    v_mfma_f32_32x32x16_bf16 v[48:63], a[156:159], v[104:107], v[48:63]
    v_mfma_f32_32x32x16_bf16 v[64:79], a[156:159], v[108:111], v[64:79]
    ds_read_b64_tr_b16 a[24:25], v217 offset:6144
    ds_read_b64_tr_b16 a[26:27], v217 offset:7168
    ds_read_b64_tr_b16 a[28:29], v218 offset:6144
    ds_read_b64_tr_b16 a[30:31], v218 offset:7168
    buffer_load_dwordx4 v[192:195], v4, s[40:43], s71 offen offset:2048 sc1
    buffer_load_dwordx4 v[196:199], v4, s[40:43], s72 offen offset:2048 sc1
    buffer_load_dwordx4 v[200:203], v4, s[40:43], s71 offen offset:3072 sc1
    buffer_load_dwordx4 v[204:207], v4, s[40:43], s72 offen offset:3072 sc1
    s_waitcnt vmcnt(23)
    v_mfma_f32_32x32x16_bf16 v[16:31], a[160:163], v[112:115], v[16:31]
    s_waitcnt vmcnt(22)
    v_mfma_f32_32x32x16_bf16 v[32:47], a[160:163], v[116:119], v[32:47]
    v_mfma_f32_32x32x16_bf16 v[48:63], a[164:167], v[112:115], v[48:63]
    v_mfma_f32_32x32x16_bf16 v[64:79], a[164:167], v[116:119], v[64:79]
    ds_read_b64_tr_b16 a[32:33], v217 offset:8192
    ds_read_b64_tr_b16 a[34:35], v217 offset:9216
    ds_read_b64_tr_b16 a[36:37], v218 offset:8192
    ds_read_b64_tr_b16 a[38:39], v218 offset:9216
    s_add_u32 s71, s71, 4096
    s_add_u32 s72, s72, 4096
    buffer_load_dwordx4 v[80:83], v4, s[40:43], s71 offen offset:0 sc1
    buffer_load_dwordx4 v[84:87], v4, s[40:43], s72 offen offset:0 sc1
    buffer_load_dwordx4 v[88:91], v4, s[40:43], s71 offen offset:1024 sc1
    buffer_load_dwordx4 v[92:95], v4, s[40:43], s72 offen offset:1024 sc1
    s_waitcnt vmcnt(25)
    v_mfma_f32_32x32x16_bf16 v[16:31], a[168:171], v[120:123], v[16:31]
    s_waitcnt vmcnt(24)
    v_mfma_f32_32x32x16_bf16 v[32:47], a[168:171], v[124:127], v[32:47]
    v_mfma_f32_32x32x16_bf16 v[48:63], a[172:175], v[120:123], v[48:63]
    v_mfma_f32_32x32x16_bf16 v[64:79], a[172:175], v[124:127], v[64:79]
    ds_read_b64_tr_b16 a[40:41], v217 offset:10240
    ds_read_b64_tr_b16 a[42:43], v217 offset:11264
    ds_read_b64_tr_b16 a[44:45], v218 offset:10240
    ds_read_b64_tr_b16 a[46:47], v218 offset:11264
    buffer_load_dwordx4 v[96:99], v4, s[40:43], s71 offen offset:2048 sc1
    buffer_load_dwordx4 v[100:103], v4, s[40:43], s72 offen offset:2048 sc1
    buffer_load_dwordx4 v[104:107], v4, s[40:43], s71 offen offset:3072 sc1
    buffer_load_dwordx4 v[108:111], v4, s[40:43], s72 offen offset:3072 sc1
    s_waitcnt vmcnt(27)
    v_mfma_f32_32x32x16_bf16 v[16:31], a[176:179], v[128:131], v[16:31]
    s_waitcnt vmcnt(26)
    v_mfma_f32_32x32x16_bf16 v[32:47], a[176:179], v[132:135], v[32:47]
    v_mfma_f32_32x32x16_bf16 v[48:63], a[180:183], v[128:131], v[48:63]
    v_mfma_f32_32x32x16_bf16 v[64:79], a[180:183], v[132:135], v[64:79]
    ds_read_b64_tr_b16 a[48:49], v217 offset:12288
    ds_read_b64_tr_b16 a[50:51], v217 offset:13312
    ds_read_b64_tr_b16 a[52:53], v218 offset:12288
    ds_read_b64_tr_b16 a[54:55], v218 offset:13312
    s_add_u32 s71, s71, 4096
    s_add_u32 s72, s72, 4096
    buffer_load_dwordx4 v[112:115], v4, s[40:43], s71 offen offset:0 sc1
    buffer_load_dwordx4 v[116:119], v4, s[40:43], s72 offen offset:0 sc1
    buffer_load_dwordx4 v[120:123], v4, s[40:43], s71 offen offset:1024 sc1
    buffer_load_dwordx4 v[124:127], v4, s[40:43], s72 offen offset:1024 sc1
    s_waitcnt vmcnt(29)
    v_mfma_f32_32x32x16_bf16 v[16:31], a[184:187], v[136:139], v[16:31]
    s_waitcnt vmcnt(28)
    v_mfma_f32_32x32x16_bf16 v[32:47], a[184:187], v[140:143], v[32:47]
    v_mfma_f32_32x32x16_bf16 v[48:63], a[188:191], v[136:139], v[48:63]
    v_mfma_f32_32x32x16_bf16 v[64:79], a[188:191], v[140:143], v[64:79]
    ds_read_b64_tr_b16 a[56:57], v217 offset:14336
    ds_read_b64_tr_b16 a[58:59], v217 offset:15360
    ds_read_b64_tr_b16 a[60:61], v218 offset:14336
    ds_read_b64_tr_b16 a[62:63], v218 offset:15360
    buffer_load_dwordx4 v[128:131], v4, s[40:43], s71 offen offset:2048 sc1
    buffer_load_dwordx4 v[132:135], v4, s[40:43], s72 offen offset:2048 sc1
    buffer_load_dwordx4 v[136:139], v4, s[40:43], s71 offen offset:3072 sc1
    buffer_load_dwordx4 v[140:143], v4, s[40:43], s72 offen offset:3072 sc1
    s_waitcnt vmcnt(31)
    v_mfma_f32_32x32x16_bf16 v[16:31], a[192:195], v[144:147], v[16:31]
    s_waitcnt vmcnt(30)
    v_mfma_f32_32x32x16_bf16 v[32:47], a[192:195], v[148:151], v[32:47]
    v_mfma_f32_32x32x16_bf16 v[48:63], a[196:199], v[144:147], v[48:63]
    v_mfma_f32_32x32x16_bf16 v[64:79], a[196:199], v[148:151], v[64:79]
    ds_read_b64_tr_b16 a[64:65], v217 offset:16384
    ds_read_b64_tr_b16 a[66:67], v217 offset:17408
    ds_read_b64_tr_b16 a[68:69], v218 offset:16384
    ds_read_b64_tr_b16 a[70:71], v218 offset:17408
    s_add_u32 s71, s71, 4096
    s_add_u32 s72, s72, 4096
    buffer_load_dwordx4 v[144:147], v4, s[40:43], s71 offen offset:0 sc1
    buffer_load_dwordx4 v[148:151], v4, s[40:43], s72 offen offset:0 sc1
    s_waitcnt vmcnt(31)
    v_mfma_f32_32x32x16_bf16 v[16:31], a[200:203], v[152:155], v[16:31]
    s_waitcnt vmcnt(30)
    v_mfma_f32_32x32x16_bf16 v[32:47], a[200:203], v[156:159], v[32:47]
    v_mfma_f32_32x32x16_bf16 v[48:63], a[204:207], v[152:155], v[48:63]
    v_mfma_f32_32x32x16_bf16 v[64:79], a[204:207], v[156:159], v[64:79]
    ds_read_b64_tr_b16 a[72:73], v217 offset:18432
    ds_read_b64_tr_b16 a[74:75], v217 offset:19456
    ds_read_b64_tr_b16 a[76:77], v218 offset:18432
    ds_read_b64_tr_b16 a[78:79], v218 offset:19456
    buffer_load_dwordx4 v[152:155], v4, s[40:43], s71 offen offset:1024 sc1
    buffer_load_dwordx4 v[156:159], v4, s[40:43], s72 offen offset:1024 sc1
    s_waitcnt vmcnt(31)
    v_mfma_f32_32x32x16_bf16 v[16:31], a[208:211], v[160:163], v[16:31]
    s_waitcnt vmcnt(30)
    v_mfma_f32_32x32x16_bf16 v[32:47], a[208:211], v[164:167], v[32:47]
    v_mfma_f32_32x32x16_bf16 v[48:63], a[212:215], v[160:163], v[48:63]
    v_mfma_f32_32x32x16_bf16 v[64:79], a[212:215], v[164:167], v[64:79]
    ds_read_b64_tr_b16 a[80:81], v217 offset:20480
    ds_read_b64_tr_b16 a[82:83], v217 offset:21504
    ds_read_b64_tr_b16 a[84:85], v218 offset:20480
    ds_read_b64_tr_b16 a[86:87], v218 offset:21504
    buffer_load_dwordx4 v[160:163], v4, s[40:43], s71 offen offset:2048 sc1
    buffer_load_dwordx4 v[164:167], v4, s[40:43], s72 offen offset:2048 sc1
    s_waitcnt vmcnt(31)
    v_mfma_f32_32x32x16_bf16 v[16:31], a[216:219], v[168:171], v[16:31]
    s_waitcnt vmcnt(30)
    v_mfma_f32_32x32x16_bf16 v[32:47], a[216:219], v[172:175], v[32:47]
    v_mfma_f32_32x32x16_bf16 v[48:63], a[220:223], v[168:171], v[48:63]
    v_mfma_f32_32x32x16_bf16 v[64:79], a[220:223], v[172:175], v[64:79]
    ds_read_b64_tr_b16 a[88:89], v217 offset:22528
    ds_read_b64_tr_b16 a[90:91], v217 offset:23552
    ds_read_b64_tr_b16 a[92:93], v218 offset:22528
    ds_read_b64_tr_b16 a[94:95], v218 offset:23552
    buffer_load_dwordx4 v[168:171], v4, s[40:43], s71 offen offset:3072 sc1
    buffer_load_dwordx4 v[172:175], v4, s[40:43], s72 offen offset:3072 sc1
    s_waitcnt vmcnt(31) lgkmcnt(15)
    v_mfma_f32_32x32x16_bf16 v[16:31], a[224:227], v[176:179], v[16:31]
    s_waitcnt vmcnt(30)
    v_mfma_f32_32x32x16_bf16 v[32:47], a[224:227], v[180:183], v[32:47]
    v_mfma_f32_32x32x16_bf16 v[48:63], a[228:231], v[176:179], v[48:63]
    v_mfma_f32_32x32x16_bf16 v[64:79], a[228:231], v[180:183], v[64:79]
    s_waitcnt vmcnt(29)
    v_mfma_f32_32x32x16_bf16 v[16:31], a[232:235], v[184:187], v[16:31]
    s_waitcnt vmcnt(28)
    v_mfma_f32_32x32x16_bf16 v[32:47], a[232:235], v[188:191], v[32:47]
    v_mfma_f32_32x32x16_bf16 v[48:63], a[236:239], v[184:187], v[48:63]
    v_mfma_f32_32x32x16_bf16 v[64:79], a[236:239], v[188:191], v[64:79]
    s_waitcnt vmcnt(27)
    v_mfma_f32_32x32x16_bf16 v[16:31], a[240:243], v[192:195], v[16:31]
    s_waitcnt vmcnt(26)
    v_mfma_f32_32x32x16_bf16 v[32:47], a[240:243], v[196:199], v[32:47]
    v_mfma_f32_32x32x16_bf16 v[48:63], a[244:247], v[192:195], v[48:63]
    v_mfma_f32_32x32x16_bf16 v[64:79], a[244:247], v[196:199], v[64:79]
    s_waitcnt vmcnt(25)
    v_mfma_f32_32x32x16_bf16 v[16:31], a[248:251], v[200:203], v[16:31]
    s_waitcnt vmcnt(24)
    v_mfma_f32_32x32x16_bf16 v[32:47], a[248:251], v[204:207], v[32:47]
    v_mfma_f32_32x32x16_bf16 v[48:63], a[252:255], v[200:203], v[48:63]
    v_mfma_f32_32x32x16_bf16 v[64:79], a[252:255], v[204:207], v[64:79]
    s_waitcnt vmcnt(23)
    v_mfma_f32_32x32x16_bf16 v[16:31], a[0:3], v[80:83], v[16:31]
    s_waitcnt vmcnt(22)
    v_mfma_f32_32x32x16_bf16 v[32:47], a[0:3], v[84:87], v[32:47]
    v_mfma_f32_32x32x16_bf16 v[48:63], a[4:7], v[80:83], v[48:63]
    v_mfma_f32_32x32x16_bf16 v[64:79], a[4:7], v[84:87], v[64:79]
    s_waitcnt vmcnt(21)
    v_mfma_f32_32x32x16_bf16 v[16:31], a[8:11], v[88:91], v[16:31]
    s_waitcnt vmcnt(20)
    v_mfma_f32_32x32x16_bf16 v[32:47], a[8:11], v[92:95], v[32:47]
    v_mfma_f32_32x32x16_bf16 v[48:63], a[12:15], v[88:91], v[48:63]
    v_mfma_f32_32x32x16_bf16 v[64:79], a[12:15], v[92:95], v[64:79]
    v_lshrrev_b32 v220, 5, v1
    v_lshlrev_b32 v220, 10, v220
    v_and_b32 v221, 31, v1
    v_lshl_add_u32 v220, v221, 2, v220
    s_lshr_b32 s69, s3, 1
    s_lshl_b32 s68, s69, 13
    s_and_b32 s69, s3, 1
    s_lshl_b32 s69, s69, 7
    s_add_u32 s68, s68, s69
    v_add_u32 v220, s68, v220
    v_xor_b32 v221, 128, v220
    v_xor_b32 v222, 0x2000, v220
    v_xor_b32 v223, 0x2080, v220
    s_mul_i32 s68, s3, 36864
    s_add_u32 s68, s68, 12288
    v_add_u32 v220, s68, v220
    v_add_u32 v221, s68, v221
    v_add_u32 v222, s68, v222
    v_add_u32 v223, s68, v223
    s_lshl_b32 s68, s3, 12
    s_add_u32 s68, s68, 12288
    v_add_u32 v224, s68, v4
    v_add_u32 v226, 73728, v224
    v_mul_u32_u24 v225, 896, v3
    v_lshl_add_u32 v225, v2, 3, v225
    s_lshl_b32 s68, s67, 2
    s_add_u32 s68, s68, s3
    s_mul_i32 s68, s68, 14336
    s_lshl_b32 s69, s66, 7
    s_add_u32 s68, s68, s69
    s_add_u32 s69, s68, 7168
    s_waitcnt vmcnt(19)
    v_mfma_f32_32x32x16_bf16 v[16:31], a[16:19], v[96:99], v[16:31]
    s_waitcnt vmcnt(18)
    v_mfma_f32_32x32x16_bf16 v[32:47], a[16:19], v[100:103], v[32:47]
    v_mfma_f32_32x32x16_bf16 v[48:63], a[20:23], v[96:99], v[48:63]
    v_mfma_f32_32x32x16_bf16 v[64:79], a[20:23], v[100:103], v[64:79]
    s_waitcnt vmcnt(17)
    v_mfma_f32_32x32x16_bf16 v[16:31], a[24:27], v[104:107], v[16:31]
    s_waitcnt vmcnt(16)
    v_mfma_f32_32x32x16_bf16 v[32:47], a[24:27], v[108:111], v[32:47]
    v_mfma_f32_32x32x16_bf16 v[48:63], a[28:31], v[104:107], v[48:63]
    v_mfma_f32_32x32x16_bf16 v[64:79], a[28:31], v[108:111], v[64:79]
    s_waitcnt vmcnt(15)
    v_mfma_f32_32x32x16_bf16 v[16:31], a[32:35], v[112:115], v[16:31]
    s_waitcnt vmcnt(14)
    v_mfma_f32_32x32x16_bf16 v[32:47], a[32:35], v[116:119], v[32:47]
    v_mfma_f32_32x32x16_bf16 v[48:63], a[36:39], v[112:115], v[48:63]
    v_mfma_f32_32x32x16_bf16 v[64:79], a[36:39], v[116:119], v[64:79]
    s_waitcnt vmcnt(13)
    v_mfma_f32_32x32x16_bf16 v[16:31], a[40:43], v[120:123], v[16:31]
    s_waitcnt vmcnt(12)
    v_mfma_f32_32x32x16_bf16 v[32:47], a[40:43], v[124:127], v[32:47]
    v_mfma_f32_32x32x16_bf16 v[48:63], a[44:47], v[120:123], v[48:63]
    v_mfma_f32_32x32x16_bf16 v[64:79], a[44:47], v[124:127], v[64:79]
    s_waitcnt vmcnt(11)
    v_mfma_f32_32x32x16_bf16 v[16:31], a[48:51], v[128:131], v[16:31]
    s_waitcnt vmcnt(10)
    v_mfma_f32_32x32x16_bf16 v[32:47], a[48:51], v[132:135], v[32:47]
    v_mfma_f32_32x32x16_bf16 v[48:63], a[52:55], v[128:131], v[48:63]
    v_mfma_f32_32x32x16_bf16 v[64:79], a[52:55], v[132:135], v[64:79]
    s_waitcnt vmcnt(9)
    v_mfma_f32_32x32x16_bf16 v[16:31], a[56:59], v[136:139], v[16:31]
    s_waitcnt vmcnt(8)
    v_mfma_f32_32x32x16_bf16 v[32:47], a[56:59], v[140:143], v[32:47]
    v_mfma_f32_32x32x16_bf16 v[48:63], a[60:63], v[136:139], v[48:63]
    v_mfma_f32_32x32x16_bf16 v[64:79], a[60:63], v[140:143], v[64:79]
    s_waitcnt vmcnt(7) lgkmcnt(14)
    v_mfma_f32_32x32x16_bf16 v[16:31], a[64:67], v[144:147], v[16:31]
    s_waitcnt vmcnt(6)
    v_mfma_f32_32x32x16_bf16 v[32:47], a[64:67], v[148:151], v[32:47]
    s_waitcnt lgkmcnt(12)
    v_mfma_f32_32x32x16_bf16 v[48:63], a[68:71], v[144:147], v[48:63]
    v_mfma_f32_32x32x16_bf16 v[64:79], a[68:71], v[148:151], v[64:79]
    s_waitcnt vmcnt(5) lgkmcnt(10)
    v_mfma_f32_32x32x16_bf16 v[16:31], a[72:75], v[152:155], v[16:31]
    s_waitcnt vmcnt(4)
    v_mfma_f32_32x32x16_bf16 v[32:47], a[72:75], v[156:159], v[32:47]
    s_waitcnt lgkmcnt(8)
    v_mfma_f32_32x32x16_bf16 v[48:63], a[76:79], v[152:155], v[48:63]
    v_mfma_f32_32x32x16_bf16 v[64:79], a[76:79], v[156:159], v[64:79]
    s_waitcnt vmcnt(3) lgkmcnt(6)
    v_mfma_f32_32x32x16_bf16 v[16:31], a[80:83], v[160:163], v[16:31]
    s_waitcnt vmcnt(2)
    v_mfma_f32_32x32x16_bf16 v[32:47], a[80:83], v[164:167], v[32:47]
    s_waitcnt lgkmcnt(4)
    v_mfma_f32_32x32x16_bf16 v[48:63], a[84:87], v[160:163], v[48:63]
    v_mfma_f32_32x32x16_bf16 v[64:79], a[84:87], v[164:167], v[64:79]
    s_waitcnt vmcnt(1) lgkmcnt(2)
    v_mfma_f32_32x32x16_bf16 v[16:31], a[88:91], v[168:171], v[16:31]
    s_waitcnt vmcnt(0)
    v_mfma_f32_32x32x16_bf16 v[32:47], a[88:91], v[172:175], v[32:47]
    s_waitcnt lgkmcnt(0)
    v_mfma_f32_32x32x16_bf16 v[48:63], a[92:95], v[168:171], v[48:63]
    v_mfma_f32_32x32x16_bf16 v[64:79], a[92:95], v[172:175], v[64:79]
    s_nop 6
    ds_write2st64_b32 v220, v16, v17 offset0:0 offset1:1
    ds_write2st64_b32 v220, v18, v19 offset0:2 offset1:3
    ds_write2st64_b32 v220, v20, v21 offset0:8 offset1:9
    ds_write2st64_b32 v220, v22, v23 offset0:10 offset1:11
    ds_write2st64_b32 v220, v24, v25 offset0:16 offset1:17
    ds_write2st64_b32 v220, v26, v27 offset0:18 offset1:19
    ds_write2st64_b32 v220, v28, v29 offset0:24 offset1:25
    ds_write2st64_b32 v220, v30, v31 offset0:26 offset1:27
    ds_write2st64_b32 v221, v32, v33 offset0:0 offset1:1
    ds_write2st64_b32 v221, v34, v35 offset0:2 offset1:3
    ds_write2st64_b32 v221, v36, v37 offset0:8 offset1:9
    ds_write2st64_b32 v221, v38, v39 offset0:10 offset1:11
    ds_write2st64_b32 v221, v40, v41 offset0:16 offset1:17
    ds_write2st64_b32 v221, v42, v43 offset0:18 offset1:19
    ds_write2st64_b32 v221, v44, v45 offset0:24 offset1:25
    ds_write2st64_b32 v221, v46, v47 offset0:26 offset1:27
    ds_write2st64_b32 v222, v48, v49 offset0:0 offset1:1
    ds_write2st64_b32 v222, v50, v51 offset0:2 offset1:3
    ds_write2st64_b32 v222, v52, v53 offset0:8 offset1:9
    ds_write2st64_b32 v222, v54, v55 offset0:10 offset1:11
    ds_write2st64_b32 v222, v56, v57 offset0:16 offset1:17
    ds_write2st64_b32 v222, v58, v59 offset0:18 offset1:19
    ds_write2st64_b32 v222, v60, v61 offset0:24 offset1:25
    ds_write2st64_b32 v222, v62, v63 offset0:26 offset1:27
    ds_write2st64_b32 v223, v64, v65 offset0:0 offset1:1
    ds_write2st64_b32 v223, v66, v67 offset0:2 offset1:3
    ds_write2st64_b32 v223, v68, v69 offset0:8 offset1:9
    ds_write2st64_b32 v223, v70, v71 offset0:10 offset1:11
    ds_write2st64_b32 v223, v72, v73 offset0:16 offset1:17
    ds_write2st64_b32 v223, v74, v75 offset0:18 offset1:19
    ds_write2st64_b32 v223, v76, v77 offset0:24 offset1:25
    ds_write2st64_b32 v223, v78, v79 offset0:26 offset1:27
    s_waitcnt lgkmcnt(0)
    s_barrier
    ds_read_b128 v[16:19], v224 offset:0
    ds_read_b128 v[20:23], v224 offset:36864
    ds_read_b128 v[24:27], v226 offset:0
    ds_read_b128 v[28:31], v226 offset:36864
    ds_read_b128 v[32:35], v224 offset:1024
    ds_read_b128 v[36:39], v224 offset:37888
    ds_read_b128 v[40:43], v226 offset:1024
    ds_read_b128 v[44:47], v226 offset:37888
    ds_read_b128 v[48:51], v224 offset:2048
    ds_read_b128 v[52:55], v224 offset:38912
    ds_read_b128 v[56:59], v226 offset:2048
    ds_read_b128 v[60:63], v226 offset:38912
    ds_read_b128 v[64:67], v224 offset:3072
    ds_read_b128 v[68:71], v224 offset:39936
    ds_read_b128 v[72:75], v226 offset:3072
    ds_read_b128 v[76:79], v226 offset:39936
    s_waitcnt lgkmcnt(14)
    v_pk_add_f32 v[16:17], v[16:17], v[20:21]
    s_waitcnt lgkmcnt(12)
    v_pk_add_f32 v[24:25], v[24:25], v[28:29]
    v_pk_add_f32 v[18:19], v[18:19], v[22:23]
    v_pk_add_f32 v[26:27], v[26:27], v[30:31]
    v_pk_add_f32 v[16:17], v[16:17], v[24:25]
    v_pk_add_f32 v[18:19], v[18:19], v[26:27]
    v_cvt_pk_bf16_f32 v20, v16, v17
    v_cvt_pk_bf16_f32 v21, v18, v19
    buffer_store_dwordx2 v[20:21], v225, s[36:39], s68 offen offset:0
    s_waitcnt lgkmcnt(10)
    v_pk_add_f32 v[32:33], v[32:33], v[36:37]
    s_waitcnt lgkmcnt(8)
    v_pk_add_f32 v[40:41], v[40:41], v[44:45]
    v_pk_add_f32 v[34:35], v[34:35], v[38:39]
    v_pk_add_f32 v[42:43], v[42:43], v[46:47]
    v_pk_add_f32 v[32:33], v[32:33], v[40:41]
    v_pk_add_f32 v[34:35], v[34:35], v[42:43]
    v_cvt_pk_bf16_f32 v36, v32, v33
    v_cvt_pk_bf16_f32 v37, v34, v35
    buffer_store_dwordx2 v[36:37], v225, s[36:39], s68 offen offset:3584
    s_waitcnt lgkmcnt(6)
    v_pk_add_f32 v[48:49], v[48:49], v[52:53]
    s_waitcnt lgkmcnt(4)
    v_pk_add_f32 v[56:57], v[56:57], v[60:61]
    v_pk_add_f32 v[50:51], v[50:51], v[54:55]
    v_pk_add_f32 v[58:59], v[58:59], v[62:63]
    v_pk_add_f32 v[48:49], v[48:49], v[56:57]
    v_pk_add_f32 v[50:51], v[50:51], v[58:59]
    v_cvt_pk_bf16_f32 v52, v48, v49
    v_cvt_pk_bf16_f32 v53, v50, v51
    buffer_store_dwordx2 v[52:53], v225, s[36:39], s69 offen offset:0
    s_waitcnt lgkmcnt(2)
    v_pk_add_f32 v[64:65], v[64:65], v[68:69]
    s_waitcnt lgkmcnt(0)
    v_pk_add_f32 v[72:73], v[72:73], v[76:77]
    v_pk_add_f32 v[66:67], v[66:67], v[70:71]
    v_pk_add_f32 v[74:75], v[74:75], v[78:79]
    v_pk_add_f32 v[64:65], v[64:65], v[72:73]
    v_pk_add_f32 v[66:67], v[66:67], v[74:75]
    v_cvt_pk_bf16_f32 v68, v64, v65
    v_cvt_pk_bf16_f32 v69, v66, v67
    buffer_store_dwordx2 v[68:69], v225, s[36:39], s69 offen offset:3584
L_end_P:
    s_endpgm

.section .rodata,"a"
.p2align 6
.amdhsa_kernel sequential_preLN__sliding_local_dilated__mixer_token_mlp__prompt_kernel
  .amdhsa_next_free_vgpr 508
  .amdhsa_next_free_sgpr 102
  .amdhsa_accum_offset 252
  .amdhsa_group_segment_fixed_size 0
  .amdhsa_kernarg_size 88
  .amdhsa_user_sgpr_count 2
  .amdhsa_user_sgpr_kernarg_segment_ptr 1
  .amdhsa_system_sgpr_workgroup_id_x 1
.end_amdhsa_kernel
```

```asm
; @launch grid=(256,1,1) block=(256,1,1) lds=163840
.amdgcn_target "amdgcn-amd-amdhsa--gfx950"
.text
.globl sequential_preLN__sliding_local_dilated__mixer_token_mlp__prompt_kernel
.p2align 8
.type sequential_preLN__sliding_local_dilated__mixer_token_mlp__prompt_kernel,@function
sequential_preLN__sliding_local_dilated__mixer_token_mlp__prompt_kernel:
    s_cmp_ge_u32 s2, 256
    s_cbranch_scc1 L_end_P
    s_load_dwordx2 s[8:9], s[0:1], 0
    s_load_dwordx2 s[12:13], s[0:1], 8
    s_load_dwordx2 s[44:45], s[0:1], 72
    s_load_dwordx2 s[40:41], s[0:1], 80
    s_load_dwordx2 s[16:17], s[0:1], 16
    s_load_dwordx2 s[20:21], s[0:1], 32
    s_load_dwordx2 s[24:25], s[0:1], 48
    s_load_dwordx2 s[28:29], s[0:1], 40
    s_load_dwordx2 s[32:33], s[0:1], 56
    s_load_dwordx2 s[36:37], s[0:1], 64
    v_lshrrev_b32 v1, 6, v0
    s_nop 0
    v_readfirstlane_b32 s3, v1
    v_and_b32 v1, 63, v0
    v_and_b32 v2, 15, v0
    v_lshrrev_b32 v3, 4, v1
    v_lshlrev_b32 v4, 4, v1
    s_mov_b32 s10, 0x1c0000
    s_mov_b32 s11, 0x00020000
    s_mov_b32 s14, 0x126000
    s_mov_b32 s15, 0x00020000
    s_mov_b32 s46, 0x100
    s_mov_b32 s47, 0x00020000
    s_mov_b32 s42, 0x590000
    s_mov_b32 s43, 0x00020000
    s_mov_b32 s18, 0x62000
    s_mov_b32 s19, 0x00020000
    s_mov_b32 s22, 0x700000
    s_mov_b32 s23, 0x00020000
    s_mov_b32 s26, 0x700000
    s_mov_b32 s27, 0x00020000
    s_mov_b32 s30, 0xe00
    s_mov_b32 s31, 0x00020000
    s_mov_b32 s34, 0x1000
    s_mov_b32 s35, 0x00020000
    s_mov_b32 s38, 0x1c0000
    s_mov_b32 s39, 0x00020000
    s_mov_b32 s5, 0x3f803f80
    s_mov_b32 s6, 0x40000
    s_bfe_u32 s48, s2, 0x20001
    s_lshl_b32 s48, s48, 2
    s_lshr_b32 s53, s2, 6
    s_add_u32 s48, s48, s53
    s_bfe_u32 s49, s2, 0x30003
    s_and_b32 s53, s2, 1
    s_lshl_b32 s53, s53, 3
    s_add_u32 s49, s49, s53
    v_lshrrev_b32 v237, 2, v1
    v_mul_u32_u24 v123, 2688, v237
    v_lshrrev_b32 v237, 5, v1
    v_lshlrev_b32 v237, 1, v237
    v_and_b32 v238, 3, v1
    v_xor_b32 v237, v237, v238
    v_lshl_add_u32 v123, v237, 4, v123
    s_mul_i32 s53, s49, 56
    s_min_u32 s53, s53, 832
    s_mul_i32 s51, s3, 43008
    s_add_u32 s53, s53, s51
    v_add_u32 v123, s53, v123
    s_lshr_b32 s53, s3, 1
    s_mul_i32 s51, s53, 6144
    s_and_b32 s53, s3, 1
    s_lshl_b32 s53, s53, 10
    s_add_u32 s51, s51, s53
    v_lshrrev_b32 v237, 3, v1
    v_mul_u32_u24 v122, 896, v237
    v_and_b32 v237, 7, v1
    v_xor_b32 v237, v237, v3
    v_lshl_add_u32 v120, v237, 4, v122
    s_lshl_b32 s50, s48, 7
    s_lshl_b32 s53, s3, 5
    s_add_u32 s53, s53, s50
    s_mul_i32 s53, s53, 896
    v_xor_b32 v121, 64, v120
    v_add_u32 v120, s53, v120
    s_add_u32 s53, s53, 7168
    v_add_u32 v121, s53, v121
    s_lshl_b32 s53, s3, 1
    v_xor_b32 v237, s53, v237
    v_lshl_add_u32 v122, v237, 4, v122
    s_lshl_b32 s53, s3, 2
    s_add_u32 s53, s53, s50
    s_sub_u32 s53, s53, 16
    s_mul_i32 s53, s53, 896
    s_cmp_eq_u32 s48, 0
    s_cselect_b32 s53, 0x40000000, s53
    v_add_u32 v122, s53, v122
    s_lshl_b32 s52, s3, 12
    s_add_u32 s52, s52, 63488
    s_lshl_b32 s7, s3, 9
    s_cmp_eq_u32 s3, 0
    s_cselect_b32 s54, 0xffffff00, -1
    s_mov_b32 s55, 0
    s_memrealtime s[86:87]
    v_mov_b32 v7, 0
    s_waitcnt lgkmcnt(0)
    s_or_b32 s86, s86, 1
    v_mov_b32 v6, s86
    s_or_b32 s86, s2, s3
    s_cmp_eq_u32 s86, 0
    s_cselect_b64 exec, 1, 0
    buffer_store_dword v6, v7, s[44:47], 0 offen sc1
    s_mov_b64 exec, -1
    s_add_u32 m0, s51, 12288
    s_mov_b32 s73, 0
    buffer_load_dwordx4 v123, s[12:15], s73 offen lds
    s_add_u32 m0, s51, 14336
    s_mov_b32 s73, 896
    buffer_load_dwordx4 v123, s[12:15], s73 offen lds
    s_add_u32 m0, s51, 16384
    s_mov_b32 s73, 1792
    buffer_load_dwordx4 v123, s[12:15], s73 offen lds
    s_add_u32 m0, s52, 36864
    s_mov_b32 s73, 0
    buffer_load_dwordx4 v120, s[8:11], s73 offen lds
    s_add_u32 m0, s52, 37888
    s_mov_b32 s73, 0
    buffer_load_dwordx4 v121, s[8:11], s73 offen lds
    s_add_u32 m0, s52, 38912
    s_mov_b32 s73, 14336
    buffer_load_dwordx4 v120, s[8:11], s73 offen lds
    s_add_u32 m0, s52, 39936
    s_mov_b32 s73, 14336
    buffer_load_dwordx4 v121, s[8:11], s73 offen lds
    s_add_u32 m0, s7, 98304
    s_mov_b32 s73, 0
    s_mov_b64 exec, s[54:55]
    buffer_load_dwordx4 v122, s[8:11], s73 offen lds
    s_mov_b64 exec, -1
    s_add_u32 m0, s51, 24576
    s_mov_b32 s73, 172032
    buffer_load_dwordx4 v123, s[12:15], s73 offen lds
    s_add_u32 m0, s51, 26624
    s_mov_b32 s73, 172928
    buffer_load_dwordx4 v123, s[12:15], s73 offen lds
    s_add_u32 m0, s51, 28672
    s_mov_b32 s73, 173824
    buffer_load_dwordx4 v123, s[12:15], s73 offen lds
    s_add_u32 m0, s52, 18432
    s_mov_b32 s73, 128
    buffer_load_dwordx4 v120, s[8:11], s73 offen lds
    s_add_u32 m0, s52, 19456
    s_mov_b32 s73, 128
    buffer_load_dwordx4 v121, s[8:11], s73 offen lds
    s_add_u32 m0, s52, 20480
    s_mov_b32 s73, 14464
    buffer_load_dwordx4 v120, s[8:11], s73 offen lds
    s_add_u32 m0, s52, 21504
    s_mov_b32 s73, 14464
    buffer_load_dwordx4 v121, s[8:11], s73 offen lds
    s_add_u32 m0, s7, 79872
    s_mov_b32 s73, 128
    s_mov_b64 exec, s[54:55]
    buffer_load_dwordx4 v122, s[8:11], s73 offen lds
    s_mov_b64 exec, -1
    s_bfe_u32 s53, s2, 0x30003
    s_add_u32 s86, s53, 1
    s_lshr_b32 s86, s86, 1
    s_lshr_b32 s87, s2, 6
    s_mul_i32 s87, s87, 5
    s_add_u32 s86, s86, s87
    s_lshl_b32 s86, s86, 2
    s_add_u32 s53, s86, s3
    s_mov_b32 s86, 0x2a54
    s_bitcmp1_b32 s86, s49
    s_cselect_b32 s79, 0x40000000, 0
    s_mul_i32 s86, s53, 48
    v_add_u32 v237, s86, v1
    v_mul_u32_u24 v238, 43691, v237
    v_lshrrev_b32 v238, 19, v238
    v_mul_u32_u24 v239, 12, v238
    v_sub_u32 v239, v237, v239
    v_lshrrev_b32 v239, 2, v239
    v_mul_u32_u24 v239, 896, v239
    v_mul_u32_u24 v238, 2688, v238
    v_and_b32 v237, 3, v237
    v_lshlrev_b32 v237, 7, v237
    v_add3_u32 v237, v237, v238, v239
    v_add_u32 v237, s79, v237
    s_and_b32 s86, s2, 1
    s_mul_i32 s86, s86, 384
    s_add_u32 s86, s86, 344064
    s_mov_b32 exec_hi, 0xffff
    buffer_load_dword v232, v237, s[12:15], s86 offen
    v_lshlrev_b32 v237, 7, v1
    v_add_u32 v238, s79, v237
    s_mul_i32 s86, s53, 6016
    s_bfe_u32 s87, s2, 0x20001
    s_mul_i32 s87, s87, 458752
    s_add_u32 s86, s86, s87
    s_max_u32 s86, s86, 14336
    s_sub_u32 s86, s86, 14336
    s_mov_b32 exec_hi, 0x7fff
    buffer_load_dword v233, v238, s[8:11], s86 offen
    s_getpc_b64 s[86:87]
Lpc_P:
    s_mul_i32 s53, s53, 384
    v_add_u32 v237, s53, v237
    v_min_u32 v237, L_end_P-Lpc_P, v237
    s_mov_b64 exec, 7
    global_load_dword v236, v237, s[86:87]
    s_mov_b64 exec, -1
    v_mul_u32_u24 v237, 18432, v3
    v_lshl_add_u32 v237, v2, 3, v237
    v_mov_b32 v238, s5
    v_add_u32 v237, 61440, v237
    ds_write2_b32 v237, v238, v238 offset0:0 offset1:1
    s_lshr_b32 s68, s2, 3
    s_mul_i32 s69, s68, 37
    s_lshr_b32 s69, s69, 8
    s_mul_i32 s64, s69, 7
    s_sub_u32 s64, s68, s64
    s_mov_b32 s66, s64
    s_and_b32 s68, s2, 7
    s_lshl_b32 s67, s68, 2
    s_add_u32 s67, s67, s69
    s_cmp_ge_u32 s69, 4
    s_cselect_b32 s67, 99, s67
    s_mul_i32 s71, s68, 3
    s_add_u32 s71, s71, 4
    s_lshl_b32 s72, s68, 2
    s_cmp_lt_u32 s68, 4
    s_cselect_b32 s65, s72, s71
    s_cselect_b32 s71, 4, 3
    s_add_u32 s65, s65, s69
    s_cmp_ge_u32 s69, s71
    s_cselect_b32 s65, 99, s65
    v_lshrrev_b32 v219, 3, v1
    v_mul_u32_u24 v208, 896, v219
    v_and_b32 v219, 1, v3
    v_lshlrev_b32 v219, 2, v219
    v_and_b32 v220, 7, v1
    v_xor_b32 v219, v219, v220
    v_lshl_add_u32 v208, v219, 4, v208
    s_lshl_b32 s58, s66, 7
    s_mul_i32 s60, s3, 100352
    s_add_u32 s58, s58, s60
    v_add_u32 v208, s58, v208
    s_mul_i32 s59, s3, 14336
    s_add_u32 s59, s59, 106496
    v_lshrrev_b32 v219, 5, v1
    v_lshlrev_b32 v209, 9, v219
    v_bfe_u32 v219, v1, 2, 2
    v_lshl_add_u32 v209, v219, 7, v209
    v_lshrrev_b32 v219, 1, v219
    s_and_b32 s58, s3, 1
    v_xor_b32 v219, s58, v219
    v_lshl_add_u32 v209, v219, 6, v209
    v_and_b32 v219, 1, v3
    v_lshl_add_u32 v209, v219, 5, v209
    v_and_b32 v219, 3, v1
    v_lshl_add_u32 v209, v219, 3, v209
    v_add_u32 v209, 106496, v209
    s_mul_i32 s70, s3, 36864
    s_add_u32 s70, s70, 12288
    v_lshrrev_b32 v219, 3, v1
    v_mul_u32_u24 v213, 3584, v219
    v_and_b32 v219, 1, v3
    v_lshlrev_b32 v219, 2, v219
    v_and_b32 v220, 7, v1
    v_xor_b32 v219, v219, v220
    v_lshl_add_u32 v213, v219, 4, v213
    s_mul_i32 s68, s3, 1835008
    s_lshl_b32 s69, s65, 7
    s_add_u32 s68, s68, s69
    s_cmp_ge_u32 s65, 99
    s_cselect_b32 s68, 0x40000000, s68
    v_add_u32 v213, s68, v213
    s_cselect_b32 s68, 0x40000000, 0
    v_add_u32 v5, s68, v4
    v_lshrrev_b32 v219, 5, v1
    v_lshlrev_b32 v215, 9, v219
    v_bfe_u32 v219, v1, 2, 2
    v_lshl_add_u32 v215, v219, 7, v215
    v_lshrrev_b32 v219, 1, v219
    s_lshr_b32 s68, s3, 1
    v_xor_b32 v219, s68, v219
    v_lshl_add_u32 v215, v219, 6, v215
    v_and_b32 v219, 1, v3
    v_lshl_add_u32 v215, v219, 5, v215
    v_and_b32 v219, 3, v1
    v_lshl_add_u32 v215, v219, 3, v215
    v_add_u32 v215, s70, v215
    v_xor_b32 v216, 64, v215
    s_mul_i32 s70, s3, 36864
    s_add_u32 s70, s70, 12288
    v_lshrrev_b32 v219, 3, v1
    v_mul_u32_u24 v214, 4096, v219
    v_and_b32 v219, 1, v3
    v_lshlrev_b32 v219, 2, v219
    v_and_b32 v220, 7, v1
    v_xor_b32 v219, v219, v220
    v_lshl_add_u32 v214, v219, 4, v214
    s_mul_i32 s68, s3, 1835008
    s_lshl_b32 s69, s67, 7
    s_add_u32 s68, s68, s69
    s_cmp_ge_u32 s67, 99
    s_cselect_b32 s68, 0x40000000, s68
    v_add_u32 v214, s68, v214
    v_lshrrev_b32 v219, 5, v1
    v_lshlrev_b32 v217, 9, v219
    v_bfe_u32 v219, v1, 2, 2
    v_lshl_add_u32 v217, v219, 7, v217
    v_lshrrev_b32 v219, 1, v219
    s_lshr_b32 s68, s3, 1
    v_xor_b32 v219, s68, v219
    v_lshl_add_u32 v217, v219, 6, v217
    v_and_b32 v219, 1, v3
    v_lshl_add_u32 v217, v219, 5, v217
    v_and_b32 v219, 3, v1
    v_lshl_add_u32 v217, v219, 3, v217
    v_add_u32 v217, s70, v217
    v_xor_b32 v218, 64, v217
    s_and_b32 s68, s2, 7
    s_cmp_ge_u32 s68, 8
    s_cselect_b32 s94, 8, 0
    s_sub_u32 s68, s68, s94
    s_lshl_b32 s94, s68, 12
    s_add_u32 s68, s68, 1
    s_cmp_ge_u32 s68, 8
    s_cselect_b32 s95, 8, 0
    s_sub_u32 s68, s68, s95
    s_lshl_b32 s95, s68, 12
    s_add_u32 s68, s68, 1
    s_cmp_ge_u32 s68, 8
    s_cselect_b32 s96, 8, 0
    s_sub_u32 s68, s68, s96
    s_lshl_b32 s96, s68, 12
    s_add_u32 s68, s68, 1
    s_cmp_ge_u32 s68, 8
    s_cselect_b32 s97, 8, 0
    s_sub_u32 s68, s68, s97
    s_lshl_b32 s97, s68, 12
    s_add_u32 s68, s68, 1
    s_cmp_ge_u32 s68, 8
    s_cselect_b32 s98, 8, 0
    s_sub_u32 s68, s68, s98
    s_lshl_b32 s98, s68, 12
    s_add_u32 s68, s68, 1
    s_cmp_ge_u32 s68, 8
    s_cselect_b32 s99, 8, 0
    s_sub_u32 s68, s68, s99
    s_lshl_b32 s99, s68, 12
    s_add_u32 s68, s68, 1
    s_cmp_ge_u32 s68, 8
    s_cselect_b32 s100, 8, 0
    s_sub_u32 s68, s68, s100
    s_lshl_b32 s100, s68, 12
    s_add_u32 s68, s68, 1
    s_cmp_ge_u32 s68, 8
    s_cselect_b32 s101, 8, 0
    s_sub_u32 s68, s68, s101
    s_lshl_b32 s101, s68, 12
    s_lshl_b32 s80, s48, 2
    s_add_u32 s80, s80, s3
    s_lshl_b32 s80, s80, 4
    s_add_u32 s80, s80, s49
    s_lshl_b32 s80, s80, 2
    s_add_u32 s80, s80, 0x588000
    s_lshl_b32 s83, s67, 1
    s_lshr_b32 s79, s3, 1
    s_add_u32 s83, s83, s79
    s_lshl_b32 s83, s83, 6
    s_add_u32 s83, s83, 0x588000
    v_lshlrev_b32 v10, 2, v2
    s_lshl_b32 s84, s64, 9
    s_add_u32 s84, s84, 0x589000
    s_lshl_b32 s81, s67, 2
    s_add_u32 s81, s81, s3
    s_lshl_b32 s81, s81, 2
    s_add_u32 s81, s81, s84
    s_lshl_b32 s79, s3, 7
    s_add_u32 s84, s84, s79
    v_and_b32 v11, 31, v1
    v_lshlrev_b32 v11, 2, v11
    s_lshl_b32 s85, s64, 9
    s_add_u32 s85, s85, 0x58a000
    s_lshl_b32 s82, s65, 2
    s_add_u32 s82, s82, s3
    s_lshl_b32 s82, s82, 2
    s_add_u32 s82, s82, s85
    s_mul_i32 s79, s3, 112
    s_add_u32 s85, s85, s79
    v_min_u32 v12, 27, v1
    v_lshlrev_b32 v12, 2, v12
    v_mov_b32 v9, 0
    v_lshlrev_b32 v124, 9, v3
    v_bfe_u32 v237, v1, 2, 2
    v_lshl_add_u32 v124, v237, 6, v124
    v_and_b32 v237, 3, v1
    v_lshl_add_u32 v124, v237, 3, v124
    v_and_b32 v237, 1, v3
    v_lshlrev_b32 v237, 5, v237
    v_add_u32 v124, v124, v237
    v_add_u32 v124, 12288, v124
    v_xor_b32 v125, 32, v124
    s_and_b32 s53, s3, 1
    s_lshl_b32 s53, s53, 5
    v_xor_b32 v127, s53, v124
    s_lshr_b32 s53, s3, 1
    s_lshl_b32 s53, s53, 11
    s_add_u32 s53, s53, 2048
    v_add_u32 v126, s53, v127
    v_lshrrev_b32 v237, 1, v2
    v_xor_b32 v237, v237, v3
    v_lshlrev_b32 v237, 4, v237
    v_lshl_add_u32 v237, v2, 7, v237
    v_add_u32 v130, 61440, v237
    v_xor_b32 v131, 64, v130
    v_add_u32 v128, s52, v237
    v_xor_b32 v129, 64, v128
    v_lshlrev_b32 v237, 2, v3
    v_sub_u32 v237, v2, v237
    v_mov_b32 v239, 0xf149f2ca
    v_add_u32 v238, 16, v237
    v_and_b32 v238, 0xfffffff1, v238
    v_cmp_eq_u32 vcc, 0, v238
    s_nop 1
    v_cndmask_b32 v240, v239, 0, vcc
    v_add_u32 v238, 15, v237
    v_and_b32 v238, 0xfffffff1, v238
    v_cmp_eq_u32 vcc, 0, v238
    s_nop 1
    v_cndmask_b32 v241, v239, 0, vcc
    v_add_u32 v238, 14, v237
    v_and_b32 v238, 0xfffffff1, v238
    v_cmp_eq_u32 vcc, 0, v238
    s_nop 1
    v_cndmask_b32 v242, v239, 0, vcc
    v_add_u32 v238, 13, v237
    v_and_b32 v238, 0xfffffff1, v238
    v_cmp_eq_u32 vcc, 0, v238
    s_nop 1
    v_cndmask_b32 v243, v239, 0, vcc
    v_add_u32 v238, 0, v237
    v_and_b32 v238, 0xfffffff1, v238
    v_cmp_eq_u32 vcc, 0, v238
    s_nop 1
    v_cndmask_b32 v244, v239, 0, vcc
    v_add_u32 v238, -1, v237
    v_and_b32 v238, 0xfffffff1, v238
    v_cmp_eq_u32 vcc, 0, v238
    s_nop 1
    v_cndmask_b32 v245, v239, 0, vcc
    v_add_u32 v238, -2, v237
    v_and_b32 v238, 0xfffffff1, v238
    v_cmp_eq_u32 vcc, 0, v238
    s_nop 1
    v_cndmask_b32 v246, v239, 0, vcc
    v_add_u32 v238, -3, v237
    v_and_b32 v238, 0xfffffff1, v238
    v_cmp_eq_u32 vcc, 0, v238
    s_nop 1
    v_cndmask_b32 v247, v239, 0, vcc
    s_or_b32 s53, s48, s3
    s_cmp_eq_u32 s53, 0
    s_cselect_b64 vcc, -1, 0
    v_cndmask_b32 v248, v240, v239, vcc
    v_cndmask_b32 v249, v241, v239, vcc
    v_cndmask_b32 v250, v242, v239, vcc
    v_cndmask_b32 v251, v243, v239, vcc
    v_mov_b32 v40, s5
    v_mov_b32 v41, s5
    v_mov_b32 v42, s5
    v_mov_b32 v43, s5
    s_mov_b32 s88, 0x22222222
    s_mov_b32 s89, 0x22222222
    s_mov_b32 s90, 0x44444444
    s_mov_b32 s91, 0x44444444
    s_mov_b32 s92, 0x88888888
    s_mov_b32 s93, 0x88888888
    v_lshlrev_b32 v72, 4, v3
    s_lshl_b32 s53, s3, 6
    v_add_u32 v73, s53, v72
    s_and_b32 s53, s53, 64
    v_add_u32 v74, s53, v72
    s_mul_i32 s53, s3, 384
    v_lshl_add_u32 v75, v2, 2, s53
    v_add_u32 v76, s53, v72
    s_and_b32 s53, s3, 1
    s_lshl_b32 s53, s53, 3
    v_add_u32 v80, s53, v4
    v_lshrrev_b32 v81, 2, v2
    v_lshlrev_b32 v81, 8, v81
    v_lshl_add_u32 v81, v3, 6, v81
    v_and_b32 v82, 3, v2
    v_lshl_add_u32 v81, v82, 1, v81
    v_add_u32 v81, s53, v81
    v_add_u32 v81, 1024, v81
    s_cmp_lt_u32 s3, 2
    s_cselect_b64 vcc, -1, 0
    s_cselect_b32 s53, 2, 16
    v_cndmask_b32 v80, v81, v80, vcc
    v_add_u32 v81, s53, v80
    v_add_u32 v82, s53, v81
    v_add_u32 v83, s53, v82
    v_lshlrev_b32 v77, 2, v2
    s_lshl_b32 s53, s3, 11
    v_add_u32 v78, s53, v4
    s_lshl_b32 s62, s48, 3
    s_lshl_b32 s63, s3, 1
    s_add_u32 s62, s62, s63
    s_lshl_b32 s62, s62, 4
    s_add_u32 s62, s62, s49
    s_lshl_b32 s62, s62, 10
    s_add_u32 s63, s62, 16384
    s_waitcnt vmcnt(11)
    s_waitcnt lgkmcnt(0)
    s_barrier
    ds_read_b128 v[16:19], v128 offset:36864
    ds_read_b128 v[20:23], v128 offset:38912
    ds_read_b128 v[24:27], v130 offset:36864
    ds_read_b64_tr_b16 v[88:89], v124 offset:0
    ds_read_b64_tr_b16 v[90:91], v124 offset:256
    ds_read_b64_tr_b16 v[92:93], v125 offset:0
    ds_read_b64_tr_b16 v[94:95], v125 offset:256
    ds_read_b64_tr_b16 v[96:97], v124 offset:2048
    ds_read_b64_tr_b16 v[98:99], v124 offset:2304
    ds_read_b64_tr_b16 v[100:101], v125 offset:2048
    ds_read_b64_tr_b16 v[102:103], v125 offset:2304
    ds_read_b64_tr_b16 v[104:105], v124 offset:4096
    ds_read_b64_tr_b16 v[106:107], v124 offset:4352
    ds_read_b64_tr_b16 v[108:109], v125 offset:4096
    ds_read_b64_tr_b16 v[110:111], v125 offset:4352
    ds_read_b64_tr_b16 v[112:113], v126 offset:0
    ds_read_b64_tr_b16 v[114:115], v126 offset:256
    ds_read_b64_tr_b16 v[116:117], v127 offset:0
    ds_read_b64_tr_b16 v[118:119], v127 offset:256
    s_waitcnt lgkmcnt(8)
    v_mfma_f32_16x16x32_bf16 v[136:139], v[88:91], v[16:19], 0
    ds_read_b128 v[28:31], v129 offset:36864
    v_mfma_f32_16x16x32_bf16 v[160:163], v[88:91], v[20:23], 0
    ds_read_b128 v[32:35], v129 offset:38912
    v_mfma_f32_16x16x32_bf16 v[140:143], v[92:95], v[16:19], 0
    ds_read_b128 v[36:39], v131 offset:36864
    v_mfma_f32_16x16x32_bf16 v[164:167], v[92:95], v[20:23], 0
    ds_read_b64_tr_b16 v[88:89], v124 offset:6144
    v_mfma_f32_16x16x32_bf16 v[144:147], v[96:99], v[16:19], 0
    ds_read_b64_tr_b16 v[90:91], v124 offset:6400
    s_add_u32 m0, s51, 36864
    s_mov_b32 s73, 344064
    buffer_load_dwordx4 v123, s[12:15], s73 offen lds
    v_mfma_f32_16x16x32_bf16 v[168:171], v[96:99], v[20:23], 0
    ds_read_b64_tr_b16 v[92:93], v125 offset:6144
    v_mfma_f32_16x16x32_bf16 v[148:151], v[100:103], v[16:19], 0
    ds_read_b64_tr_b16 v[94:95], v125 offset:6400
    v_mfma_f32_16x16x32_bf16 v[172:175], v[100:103], v[20:23], 0
    ds_read_b64_tr_b16 v[96:97], v124 offset:8192
    s_waitcnt lgkmcnt(8)
    v_mfma_f32_16x16x32_bf16 v[152:155], v[16:19], v[104:107], 0
    ds_read_b64_tr_b16 v[98:99], v124 offset:8448
    v_mfma_f32_16x16x32_bf16 v[176:179], v[20:23], v[104:107], 0
    ds_read_b64_tr_b16 v[100:101], v125 offset:8192
    s_add_u32 m0, s51, 38912
    s_mov_b32 s73, 344960
    buffer_load_dwordx4 v123, s[12:15], s73 offen lds
    v_mfma_f32_16x16x32_bf16 v[156:159], v[16:19], v[108:111], 0
    ds_read_b64_tr_b16 v[102:103], v125 offset:8448
    v_mfma_f32_16x16x32_bf16 v[180:183], v[20:23], v[108:111], 0
    ds_read_b64_tr_b16 v[104:105], v124 offset:10240
    v_mfma_f32_16x16x32_bf16 v[184:187], v[112:115], v[24:27], 0
    ds_read_b64_tr_b16 v[106:107], v124 offset:10496
    v_mfma_f32_16x16x32_bf16 v[188:191], v[116:119], v[24:27], 0
    ds_read_b64_tr_b16 v[108:109], v125 offset:10240
    v_mfma_f32_16x16x32_bf16 v[48:51], v[16:19], v[16:19], 0
    ds_read_b64_tr_b16 v[110:111], v125 offset:10496
    s_add_u32 m0, s51, 40960
    s_mov_b32 s73, 345856
    buffer_load_dwordx4 v123, s[12:15], s73 offen lds
    v_mfma_f32_16x16x32_bf16 v[52:55], v[20:23], v[20:23], 0
    ds_read_b64_tr_b16 v[112:113], v126 offset:6144
    v_mfma_f32_16x16x32_bf16 v[56:59], v[24:27], v[24:27], 0
    ds_read_b64_tr_b16 v[114:115], v126 offset:6400
    v_mfma_f32_16x16x32_bf16 v[60:63], v[40:43], v[16:19], 0
    ds_read_b64_tr_b16 v[116:117], v127 offset:6144
    v_mfma_f32_16x16x32_bf16 v[64:67], v[40:43], v[20:23], 0
    ds_read_b64_tr_b16 v[118:119], v127 offset:6400
    v_mfma_f32_16x16x32_bf16 v[68:71], v[40:43], v[24:27], 0
    s_add_u32 m0, s52, 0
    s_mov_b32 s73, 256
    buffer_load_dwordx4 v120, s[8:11], s73 offen lds
    s_add_u32 m0, s52, 1024
    s_mov_b32 s73, 256
    buffer_load_dwordx4 v121, s[8:11], s73 offen lds
    s_add_u32 m0, s52, 2048
    s_mov_b32 s73, 14592
    buffer_load_dwordx4 v120, s[8:11], s73 offen lds
    s_add_u32 m0, s52, 3072
    s_mov_b32 s73, 14592
    buffer_load_dwordx4 v121, s[8:11], s73 offen lds
    s_add_u32 m0, s7, 61440
    s_mov_b32 s73, 256
    s_mov_b64 exec, s[54:55]
    buffer_load_dwordx4 v122, s[8:11], s73 offen lds
    s_mov_b64 exec, -1
    s_waitcnt vmcnt(11)
    s_barrier
    s_waitcnt lgkmcnt(8)
    v_mfma_f32_16x16x32_bf16 v[136:139], v[88:91], v[28:31], v[136:139]
    ds_read_b128 v[16:19], v128 offset:18432
    v_mfma_f32_16x16x32_bf16 v[160:163], v[88:91], v[32:35], v[160:163]
    ds_read_b128 v[20:23], v128 offset:20480
    v_mfma_f32_16x16x32_bf16 v[140:143], v[92:95], v[28:31], v[140:143]
    ds_read_b128 v[24:27], v130 offset:18432
    v_mfma_f32_16x16x32_bf16 v[164:167], v[92:95], v[32:35], v[164:167]
    ds_read_b64_tr_b16 v[88:89], v124 offset:12288
    v_mfma_f32_16x16x32_bf16 v[144:147], v[96:99], v[28:31], v[144:147]
    ds_read_b64_tr_b16 v[90:91], v124 offset:12544
    s_add_u32 m0, s51, 49152
    s_mov_b32 s73, 516096
    buffer_load_dwordx4 v123, s[12:15], s73 offen lds
    v_mfma_f32_16x16x32_bf16 v[168:171], v[96:99], v[32:35], v[168:171]
    ds_read_b64_tr_b16 v[92:93], v125 offset:12288
    v_mfma_f32_16x16x32_bf16 v[148:151], v[100:103], v[28:31], v[148:151]
    ds_read_b64_tr_b16 v[94:95], v125 offset:12544
    v_mfma_f32_16x16x32_bf16 v[172:175], v[100:103], v[32:35], v[172:175]
    ds_read_b64_tr_b16 v[96:97], v124 offset:14336
    s_waitcnt lgkmcnt(8)
    v_mfma_f32_16x16x32_bf16 v[152:155], v[28:31], v[104:107], v[152:155]
    ds_read_b64_tr_b16 v[98:99], v124 offset:14592
    v_mfma_f32_16x16x32_bf16 v[176:179], v[32:35], v[104:107], v[176:179]
    ds_read_b64_tr_b16 v[100:101], v125 offset:14336
    s_add_u32 m0, s51, 51200
    s_mov_b32 s73, 516992
    buffer_load_dwordx4 v123, s[12:15], s73 offen lds
    v_mfma_f32_16x16x32_bf16 v[156:159], v[28:31], v[108:111], v[156:159]
    ds_read_b64_tr_b16 v[102:103], v125 offset:14592
    v_mfma_f32_16x16x32_bf16 v[180:183], v[32:35], v[108:111], v[180:183]
    ds_read_b64_tr_b16 v[104:105], v124 offset:16384
    v_mfma_f32_16x16x32_bf16 v[184:187], v[112:115], v[36:39], v[184:187]
    ds_read_b64_tr_b16 v[106:107], v124 offset:16640
    v_mfma_f32_16x16x32_bf16 v[188:191], v[116:119], v[36:39], v[188:191]
    ds_read_b64_tr_b16 v[108:109], v125 offset:16384
    v_mfma_f32_16x16x32_bf16 v[48:51], v[28:31], v[28:31], v[48:51]
    ds_read_b64_tr_b16 v[110:111], v125 offset:16640
    s_add_u32 m0, s51, 53248
    s_mov_b32 s73, 517888
    buffer_load_dwordx4 v123, s[12:15], s73 offen lds
    v_mfma_f32_16x16x32_bf16 v[52:55], v[32:35], v[32:35], v[52:55]
    ds_read_b64_tr_b16 v[112:113], v126 offset:12288
    v_mfma_f32_16x16x32_bf16 v[56:59], v[36:39], v[36:39], v[56:59]
    ds_read_b64_tr_b16 v[114:115], v126 offset:12544
    v_mfma_f32_16x16x32_bf16 v[60:63], v[40:43], v[28:31], v[60:63]
    ds_read_b64_tr_b16 v[116:117], v127 offset:12288
    v_mfma_f32_16x16x32_bf16 v[64:67], v[40:43], v[32:35], v[64:67]
    ds_read_b64_tr_b16 v[118:119], v127 offset:12544
    v_mfma_f32_16x16x32_bf16 v[68:71], v[40:43], v[36:39], v[68:71]
    s_add_u32 m0, s52, 55296
    s_mov_b32 s73, 384
    buffer_load_dwordx4 v120, s[8:11], s73 offen lds
    s_waitcnt lgkmcnt(8)
    v_mfma_f32_16x16x32_bf16 v[136:139], v[88:91], v[16:19], v[136:139]
    ds_read_b128 v[28:31], v129 offset:18432
    v_mfma_f32_16x16x32_bf16 v[160:163], v[88:91], v[20:23], v[160:163]
    ds_read_b128 v[32:35], v129 offset:20480
    v_mfma_f32_16x16x32_bf16 v[140:143], v[92:95], v[16:19], v[140:143]
    ds_read_b128 v[36:39], v131 offset:18432
    v_mfma_f32_16x16x32_bf16 v[164:167], v[92:95], v[20:23], v[164:167]
    ds_read_b64_tr_b16 v[88:89], v124 offset:18432
    v_mfma_f32_16x16x32_bf16 v[144:147], v[96:99], v[16:19], v[144:147]
    ds_read_b64_tr_b16 v[90:91], v124 offset:18688
    s_add_u32 m0, s52, 56320
    s_mov_b32 s73, 384
    buffer_load_dwordx4 v121, s[8:11], s73 offen lds
    v_mfma_f32_16x16x32_bf16 v[168:171], v[96:99], v[20:23], v[168:171]
    ds_read_b64_tr_b16 v[92:93], v125 offset:18432
    v_mfma_f32_16x16x32_bf16 v[148:151], v[100:103], v[16:19], v[148:151]
    ds_read_b64_tr_b16 v[94:95], v125 offset:18688
    v_mfma_f32_16x16x32_bf16 v[172:175], v[100:103], v[20:23], v[172:175]
    ds_read_b64_tr_b16 v[96:97], v124 offset:20480
    s_waitcnt lgkmcnt(8)
    v_mfma_f32_16x16x32_bf16 v[152:155], v[16:19], v[104:107], v[152:155]
    ds_read_b64_tr_b16 v[98:99], v124 offset:20736
    v_mfma_f32_16x16x32_bf16 v[176:179], v[20:23], v[104:107], v[176:179]
    ds_read_b64_tr_b16 v[100:101], v125 offset:20480
    s_add_u32 m0, s52, 57344
    s_mov_b32 s73, 14720
    buffer_load_dwordx4 v120, s[8:11], s73 offen lds
    v_mfma_f32_16x16x32_bf16 v[156:159], v[16:19], v[108:111], v[156:159]
    ds_read_b64_tr_b16 v[102:103], v125 offset:20736
    v_mfma_f32_16x16x32_bf16 v[180:183], v[20:23], v[108:111], v[180:183]
    ds_read_b64_tr_b16 v[104:105], v124 offset:22528
    v_mfma_f32_16x16x32_bf16 v[184:187], v[112:115], v[24:27], v[184:187]
    ds_read_b64_tr_b16 v[106:107], v124 offset:22784
    v_mfma_f32_16x16x32_bf16 v[188:191], v[116:119], v[24:27], v[188:191]
    ds_read_b64_tr_b16 v[108:109], v125 offset:22528
    v_mfma_f32_16x16x32_bf16 v[48:51], v[16:19], v[16:19], v[48:51]
    ds_read_b64_tr_b16 v[110:111], v125 offset:22784
    s_add_u32 m0, s52, 58368
    s_mov_b32 s73, 14720
    buffer_load_dwordx4 v121, s[8:11], s73 offen lds
    v_mfma_f32_16x16x32_bf16 v[52:55], v[20:23], v[20:23], v[52:55]
    ds_read_b64_tr_b16 v[112:113], v126 offset:18432
    v_mfma_f32_16x16x32_bf16 v[56:59], v[24:27], v[24:27], v[56:59]
    ds_read_b64_tr_b16 v[114:115], v126 offset:18688
    v_mfma_f32_16x16x32_bf16 v[60:63], v[40:43], v[16:19], v[60:63]
    ds_read_b64_tr_b16 v[116:117], v127 offset:18432
    v_mfma_f32_16x16x32_bf16 v[64:67], v[40:43], v[20:23], v[64:67]
    ds_read_b64_tr_b16 v[118:119], v127 offset:18688
    v_mfma_f32_16x16x32_bf16 v[68:71], v[40:43], v[24:27], v[68:71]
    s_add_u32 m0, s7, 116736
    s_mov_b32 s73, 384
    s_mov_b64 exec, s[54:55]
    buffer_load_dwordx4 v122, s[8:11], s73 offen lds
    s_mov_b64 exec, -1
    s_waitcnt vmcnt(8)
    s_barrier
    s_waitcnt lgkmcnt(8)
    v_mfma_f32_16x16x32_bf16 v[136:139], v[88:91], v[28:31], v[136:139]
    ds_read_b128 v[16:19], v128 offset:0
    v_mfma_f32_16x16x32_bf16 v[160:163], v[88:91], v[32:35], v[160:163]
    ds_read_b128 v[20:23], v128 offset:2048
    v_mfma_f32_16x16x32_bf16 v[140:143], v[92:95], v[28:31], v[140:143]
    ds_read_b128 v[24:27], v130 offset:0
    v_mfma_f32_16x16x32_bf16 v[164:167], v[92:95], v[32:35], v[164:167]
    ds_read_b64_tr_b16 v[88:89], v124 offset:24576
    v_mfma_f32_16x16x32_bf16 v[144:147], v[96:99], v[28:31], v[144:147]
    ds_read_b64_tr_b16 v[90:91], v124 offset:24832
    s_add_u32 m0, s51, 12288
    s_mov_b32 s73, 688128
    buffer_load_dwordx4 v123, s[12:15], s73 offen lds
    v_mfma_f32_16x16x32_bf16 v[168:171], v[96:99], v[32:35], v[168:171]
    ds_read_b64_tr_b16 v[92:93], v125 offset:24576
    v_mfma_f32_16x16x32_bf16 v[148:151], v[100:103], v[28:31], v[148:151]
    ds_read_b64_tr_b16 v[94:95], v125 offset:24832
    v_mfma_f32_16x16x32_bf16 v[172:175], v[100:103], v[32:35], v[172:175]
    ds_read_b64_tr_b16 v[96:97], v124 offset:26624
    s_waitcnt lgkmcnt(8)
    v_mfma_f32_16x16x32_bf16 v[152:155], v[28:31], v[104:107], v[152:155]
    ds_read_b64_tr_b16 v[98:99], v124 offset:26880
    v_mfma_f32_16x16x32_bf16 v[176:179], v[32:35], v[104:107], v[176:179]
    ds_read_b64_tr_b16 v[100:101], v125 offset:26624
    s_add_u32 m0, s51, 14336
    s_mov_b32 s73, 689024
    buffer_load_dwordx4 v123, s[12:15], s73 offen lds
    v_mfma_f32_16x16x32_bf16 v[156:159], v[28:31], v[108:111], v[156:159]
    ds_read_b64_tr_b16 v[102:103], v125 offset:26880
    v_mfma_f32_16x16x32_bf16 v[180:183], v[32:35], v[108:111], v[180:183]
    ds_read_b64_tr_b16 v[104:105], v124 offset:28672
    v_mfma_f32_16x16x32_bf16 v[184:187], v[112:115], v[36:39], v[184:187]
    ds_read_b64_tr_b16 v[106:107], v124 offset:28928
    v_mfma_f32_16x16x32_bf16 v[188:191], v[116:119], v[36:39], v[188:191]
    ds_read_b64_tr_b16 v[108:109], v125 offset:28672
    v_mfma_f32_16x16x32_bf16 v[48:51], v[28:31], v[28:31], v[48:51]
    ds_read_b64_tr_b16 v[110:111], v125 offset:28928
    s_add_u32 m0, s51, 16384
    s_mov_b32 s73, 689920
    buffer_load_dwordx4 v123, s[12:15], s73 offen lds
    v_mfma_f32_16x16x32_bf16 v[52:55], v[32:35], v[32:35], v[52:55]
    ds_read_b64_tr_b16 v[112:113], v126 offset:24576
    v_mfma_f32_16x16x32_bf16 v[56:59], v[36:39], v[36:39], v[56:59]
    ds_read_b64_tr_b16 v[114:115], v126 offset:24832
    v_mfma_f32_16x16x32_bf16 v[60:63], v[40:43], v[28:31], v[60:63]
    ds_read_b64_tr_b16 v[116:117], v127 offset:24576
    v_mfma_f32_16x16x32_bf16 v[64:67], v[40:43], v[32:35], v[64:67]
    ds_read_b64_tr_b16 v[118:119], v127 offset:24832
    v_mfma_f32_16x16x32_bf16 v[68:71], v[40:43], v[36:39], v[68:71]
    s_add_u32 m0, s52, 36864
    s_mov_b32 s73, 512
    buffer_load_dwordx4 v120, s[8:11], s73 offen lds
    s_waitcnt lgkmcnt(8)
    v_mfma_f32_16x16x32_bf16 v[136:139], v[88:91], v[16:19], v[136:139]
    ds_read_b128 v[28:31], v129 offset:0
    v_mfma_f32_16x16x32_bf16 v[160:163], v[88:91], v[20:23], v[160:163]
    ds_read_b128 v[32:35], v129 offset:2048
    v_mfma_f32_16x16x32_bf16 v[140:143], v[92:95], v[16:19], v[140:143]
    ds_read_b128 v[36:39], v131 offset:0
    v_mfma_f32_16x16x32_bf16 v[164:167], v[92:95], v[20:23], v[164:167]
    ds_read_b64_tr_b16 v[88:89], v124 offset:30720
    v_mfma_f32_16x16x32_bf16 v[144:147], v[96:99], v[16:19], v[144:147]
    ds_read_b64_tr_b16 v[90:91], v124 offset:30976
    s_add_u32 m0, s52, 37888
    s_mov_b32 s73, 512
    buffer_load_dwordx4 v121, s[8:11], s73 offen lds
    v_mfma_f32_16x16x32_bf16 v[168:171], v[96:99], v[20:23], v[168:171]
    ds_read_b64_tr_b16 v[92:93], v125 offset:30720
    v_mfma_f32_16x16x32_bf16 v[148:151], v[100:103], v[16:19], v[148:151]
    ds_read_b64_tr_b16 v[94:95], v125 offset:30976
    v_mfma_f32_16x16x32_bf16 v[172:175], v[100:103], v[20:23], v[172:175]
    ds_read_b64_tr_b16 v[96:97], v124 offset:32768
    s_waitcnt lgkmcnt(8)
    v_mfma_f32_16x16x32_bf16 v[152:155], v[16:19], v[104:107], v[152:155]
    ds_read_b64_tr_b16 v[98:99], v124 offset:33024
    v_mfma_f32_16x16x32_bf16 v[176:179], v[20:23], v[104:107], v[176:179]
    ds_read_b64_tr_b16 v[100:101], v125 offset:32768
    s_add_u32 m0, s52, 38912
    s_mov_b32 s73, 14848
    buffer_load_dwordx4 v120, s[8:11], s73 offen lds
    v_mfma_f32_16x16x32_bf16 v[156:159], v[16:19], v[108:111], v[156:159]
    ds_read_b64_tr_b16 v[102:103], v125 offset:33024
    v_mfma_f32_16x16x32_bf16 v[180:183], v[20:23], v[108:111], v[180:183]
    ds_read_b64_tr_b16 v[104:105], v124 offset:34816
    v_mfma_f32_16x16x32_bf16 v[184:187], v[112:115], v[24:27], v[184:187]
    ds_read_b64_tr_b16 v[106:107], v124 offset:35072
    v_mfma_f32_16x16x32_bf16 v[188:191], v[116:119], v[24:27], v[188:191]
    ds_read_b64_tr_b16 v[108:109], v125 offset:34816
    v_mfma_f32_16x16x32_bf16 v[48:51], v[16:19], v[16:19], v[48:51]
    ds_read_b64_tr_b16 v[110:111], v125 offset:35072
    s_add_u32 m0, s52, 39936
    s_mov_b32 s73, 14848
    buffer_load_dwordx4 v121, s[8:11], s73 offen lds
    v_mfma_f32_16x16x32_bf16 v[52:55], v[20:23], v[20:23], v[52:55]
    ds_read_b64_tr_b16 v[112:113], v126 offset:30720
    v_mfma_f32_16x16x32_bf16 v[56:59], v[24:27], v[24:27], v[56:59]
    ds_read_b64_tr_b16 v[114:115], v126 offset:30976
    v_mfma_f32_16x16x32_bf16 v[60:63], v[40:43], v[16:19], v[60:63]
    ds_read_b64_tr_b16 v[116:117], v127 offset:30720
    v_mfma_f32_16x16x32_bf16 v[64:67], v[40:43], v[20:23], v[64:67]
    ds_read_b64_tr_b16 v[118:119], v127 offset:30976
    v_mfma_f32_16x16x32_bf16 v[68:71], v[40:43], v[24:27], v[68:71]
    s_add_u32 m0, s7, 98304
    s_mov_b32 s73, 512
    s_mov_b64 exec, s[54:55]
    buffer_load_dwordx4 v122, s[8:11], s73 offen lds
    s_mov_b64 exec, -1
    s_waitcnt vmcnt(8)
    s_barrier
    s_waitcnt lgkmcnt(8)
    v_mfma_f32_16x16x32_bf16 v[136:139], v[88:91], v[28:31], v[136:139]
    ds_read_b128 v[16:19], v128 offset:55296
    v_mfma_f32_16x16x32_bf16 v[160:163], v[88:91], v[32:35], v[160:163]
    ds_read_b128 v[20:23], v128 offset:57344
    v_mfma_f32_16x16x32_bf16 v[140:143], v[92:95], v[28:31], v[140:143]
    ds_read_b128 v[24:27], v130 offset:55296
    v_mfma_f32_16x16x32_bf16 v[164:167], v[92:95], v[32:35], v[164:167]
    ds_read_b64_tr_b16 v[88:89], v124 offset:36864
    v_mfma_f32_16x16x32_bf16 v[144:147], v[96:99], v[28:31], v[144:147]
    ds_read_b64_tr_b16 v[90:91], v124 offset:37120
    s_add_u32 m0, s51, 24576
    s_mov_b32 s73, 860160
    buffer_load_dwordx4 v123, s[12:15], s73 offen lds
    v_mfma_f32_16x16x32_bf16 v[168:171], v[96:99], v[32:35], v[168:171]
    ds_read_b64_tr_b16 v[92:93], v125 offset:36864
    v_mfma_f32_16x16x32_bf16 v[148:151], v[100:103], v[28:31], v[148:151]
    ds_read_b64_tr_b16 v[94:95], v125 offset:37120
    v_mfma_f32_16x16x32_bf16 v[172:175], v[100:103], v[32:35], v[172:175]
    ds_read_b64_tr_b16 v[96:97], v124 offset:38912
    s_waitcnt lgkmcnt(8)
    v_mfma_f32_16x16x32_bf16 v[152:155], v[28:31], v[104:107], v[152:155]
    ds_read_b64_tr_b16 v[98:99], v124 offset:39168
    v_mfma_f32_16x16x32_bf16 v[176:179], v[32:35], v[104:107], v[176:179]
    ds_read_b64_tr_b16 v[100:101], v125 offset:38912
    s_add_u32 m0, s51, 26624
    s_mov_b32 s73, 861056
    buffer_load_dwordx4 v123, s[12:15], s73 offen lds
    v_mfma_f32_16x16x32_bf16 v[156:159], v[28:31], v[108:111], v[156:159]
    ds_read_b64_tr_b16 v[102:103], v125 offset:39168
    v_mfma_f32_16x16x32_bf16 v[180:183], v[32:35], v[108:111], v[180:183]
    ds_read_b64_tr_b16 v[104:105], v124 offset:40960
    v_mfma_f32_16x16x32_bf16 v[184:187], v[112:115], v[36:39], v[184:187]
    ds_read_b64_tr_b16 v[106:107], v124 offset:41216
    v_mfma_f32_16x16x32_bf16 v[188:191], v[116:119], v[36:39], v[188:191]
    ds_read_b64_tr_b16 v[108:109], v125 offset:40960
    v_mfma_f32_16x16x32_bf16 v[48:51], v[28:31], v[28:31], v[48:51]
    ds_read_b64_tr_b16 v[110:111], v125 offset:41216
    s_add_u32 m0, s51, 28672
    s_mov_b32 s73, 861952
    buffer_load_dwordx4 v123, s[12:15], s73 offen lds
    v_mfma_f32_16x16x32_bf16 v[52:55], v[32:35], v[32:35], v[52:55]
    ds_read_b64_tr_b16 v[112:113], v126 offset:36864
    v_mfma_f32_16x16x32_bf16 v[56:59], v[36:39], v[36:39], v[56:59]
    ds_read_b64_tr_b16 v[114:115], v126 offset:37120
    v_mfma_f32_16x16x32_bf16 v[60:63], v[40:43], v[28:31], v[60:63]
    ds_read_b64_tr_b16 v[116:117], v127 offset:36864
    v_mfma_f32_16x16x32_bf16 v[64:67], v[40:43], v[32:35], v[64:67]
    ds_read_b64_tr_b16 v[118:119], v127 offset:37120
    v_mfma_f32_16x16x32_bf16 v[68:71], v[40:43], v[36:39], v[68:71]
    s_add_u32 m0, s52, 18432
    s_mov_b32 s73, 640
    buffer_load_dwordx4 v120, s[8:11], s73 offen lds
    s_waitcnt lgkmcnt(8)
    v_mfma_f32_16x16x32_bf16 v[136:139], v[88:91], v[16:19], v[136:139]
    ds_read_b128 v[28:31], v129 offset:55296
    v_mfma_f32_16x16x32_bf16 v[160:163], v[88:91], v[20:23], v[160:163]
    ds_read_b128 v[32:35], v129 offset:57344
    v_mfma_f32_16x16x32_bf16 v[140:143], v[92:95], v[16:19], v[140:143]
    ds_read_b128 v[36:39], v131 offset:55296
    v_mfma_f32_16x16x32_bf16 v[164:167], v[92:95], v[20:23], v[164:167]
    ds_read_b64_tr_b16 v[88:89], v124 offset:43008
    v_mfma_f32_16x16x32_bf16 v[144:147], v[96:99], v[16:19], v[144:147]
    ds_read_b64_tr_b16 v[90:91], v124 offset:43264
    s_add_u32 m0, s52, 19456
    s_mov_b32 s73, 640
    buffer_load_dwordx4 v121, s[8:11], s73 offen lds
    v_mfma_f32_16x16x32_bf16 v[168:171], v[96:99], v[20:23], v[168:171]
    ds_read_b64_tr_b16 v[92:93], v125 offset:43008
    v_mfma_f32_16x16x32_bf16 v[148:151], v[100:103], v[16:19], v[148:151]
    ds_read_b64_tr_b16 v[94:95], v125 offset:43264
    v_mfma_f32_16x16x32_bf16 v[172:175], v[100:103], v[20:23], v[172:175]
    ds_read_b64_tr_b16 v[96:97], v124 offset:45056
    s_waitcnt lgkmcnt(8)
    v_mfma_f32_16x16x32_bf16 v[152:155], v[16:19], v[104:107], v[152:155]
    ds_read_b64_tr_b16 v[98:99], v124 offset:45312
    v_mfma_f32_16x16x32_bf16 v[176:179], v[20:23], v[104:107], v[176:179]
    ds_read_b64_tr_b16 v[100:101], v125 offset:45056
    s_add_u32 m0, s52, 20480
    s_mov_b32 s73, 14976
    buffer_load_dwordx4 v120, s[8:11], s73 offen lds
    v_mfma_f32_16x16x32_bf16 v[156:159], v[16:19], v[108:111], v[156:159]
    ds_read_b64_tr_b16 v[102:103], v125 offset:45312
    v_mfma_f32_16x16x32_bf16 v[180:183], v[20:23], v[108:111], v[180:183]
    ds_read_b64_tr_b16 v[104:105], v124 offset:47104
    v_mfma_f32_16x16x32_bf16 v[184:187], v[112:115], v[24:27], v[184:187]
    ds_read_b64_tr_b16 v[106:107], v124 offset:47360
    v_mfma_f32_16x16x32_bf16 v[188:191], v[116:119], v[24:27], v[188:191]
    ds_read_b64_tr_b16 v[108:109], v125 offset:47104
    v_mfma_f32_16x16x32_bf16 v[48:51], v[16:19], v[16:19], v[48:51]
    ds_read_b64_tr_b16 v[110:111], v125 offset:47360
    s_add_u32 m0, s52, 21504
    s_mov_b32 s73, 14976
    buffer_load_dwordx4 v121, s[8:11], s73 offen lds
    v_mfma_f32_16x16x32_bf16 v[52:55], v[20:23], v[20:23], v[52:55]
    ds_read_b64_tr_b16 v[112:113], v126 offset:43008
    v_mfma_f32_16x16x32_bf16 v[56:59], v[24:27], v[24:27], v[56:59]
    ds_read_b64_tr_b16 v[114:115], v126 offset:43264
    v_mfma_f32_16x16x32_bf16 v[60:63], v[40:43], v[16:19], v[60:63]
    ds_read_b64_tr_b16 v[116:117], v127 offset:43008
    v_mfma_f32_16x16x32_bf16 v[64:67], v[40:43], v[20:23], v[64:67]
    ds_read_b64_tr_b16 v[118:119], v127 offset:43264
    v_mfma_f32_16x16x32_bf16 v[68:71], v[40:43], v[24:27], v[68:71]
    s_add_u32 m0, s7, 79872
    s_mov_b32 s73, 640
    s_mov_b64 exec, s[54:55]
    buffer_load_dwordx4 v122, s[8:11], s73 offen lds
    s_mov_b64 exec, -1
    s_waitcnt vmcnt(8)
    s_barrier
    s_waitcnt lgkmcnt(8)
    v_mfma_f32_16x16x32_bf16 v[136:139], v[88:91], v[28:31], v[136:139]
    ds_read_b128 v[16:19], v128 offset:36864
    v_mfma_f32_16x16x32_bf16 v[160:163], v[88:91], v[32:35], v[160:163]
    ds_read_b128 v[20:23], v128 offset:38912
    v_mfma_f32_16x16x32_bf16 v[140:143], v[92:95], v[28:31], v[140:143]
    ds_read_b128 v[24:27], v130 offset:36864
    v_mfma_f32_16x16x32_bf16 v[164:167], v[92:95], v[32:35], v[164:167]
    ds_read_b64_tr_b16 v[88:89], v124 offset:0
    v_mfma_f32_16x16x32_bf16 v[144:147], v[96:99], v[28:31], v[144:147]
    ds_read_b64_tr_b16 v[90:91], v124 offset:256
    s_add_u32 m0, s51, 36864
    s_mov_b32 s73, 1032192
    buffer_load_dwordx4 v123, s[12:15], s73 offen lds
    v_mfma_f32_16x16x32_bf16 v[168:171], v[96:99], v[32:35], v[168:171]
    ds_read_b64_tr_b16 v[92:93], v125 offset:0
    v_mfma_f32_16x16x32_bf16 v[148:151], v[100:103], v[28:31], v[148:151]
    ds_read_b64_tr_b16 v[94:95], v125 offset:256
    v_mfma_f32_16x16x32_bf16 v[172:175], v[100:103], v[32:35], v[172:175]
    ds_read_b64_tr_b16 v[96:97], v124 offset:2048
    s_waitcnt lgkmcnt(8)
    v_mfma_f32_16x16x32_bf16 v[152:155], v[28:31], v[104:107], v[152:155]
    ds_read_b64_tr_b16 v[98:99], v124 offset:2304
    v_mfma_f32_16x16x32_bf16 v[176:179], v[32:35], v[104:107], v[176:179]
    ds_read_b64_tr_b16 v[100:101], v125 offset:2048
    s_add_u32 m0, s51, 38912
    s_mov_b32 s73, 1033088
    buffer_load_dwordx4 v123, s[12:15], s73 offen lds
    v_mfma_f32_16x16x32_bf16 v[156:159], v[28:31], v[108:111], v[156:159]
    ds_read_b64_tr_b16 v[102:103], v125 offset:2304
    v_mfma_f32_16x16x32_bf16 v[180:183], v[32:35], v[108:111], v[180:183]
    ds_read_b64_tr_b16 v[104:105], v124 offset:4096
    v_mfma_f32_16x16x32_bf16 v[184:187], v[112:115], v[36:39], v[184:187]
    ds_read_b64_tr_b16 v[106:107], v124 offset:4352
    v_mfma_f32_16x16x32_bf16 v[188:191], v[116:119], v[36:39], v[188:191]
    ds_read_b64_tr_b16 v[108:109], v125 offset:4096
    v_mfma_f32_16x16x32_bf16 v[48:51], v[28:31], v[28:31], v[48:51]
    ds_read_b64_tr_b16 v[110:111], v125 offset:4352
    s_add_u32 m0, s51, 40960
    s_mov_b32 s73, 1033984
    buffer_load_dwordx4 v123, s[12:15], s73 offen lds
    v_mfma_f32_16x16x32_bf16 v[52:55], v[32:35], v[32:35], v[52:55]
    ds_read_b64_tr_b16 v[112:113], v126 offset:0
    v_mfma_f32_16x16x32_bf16 v[56:59], v[36:39], v[36:39], v[56:59]
    ds_read_b64_tr_b16 v[114:115], v126 offset:256
    v_mfma_f32_16x16x32_bf16 v[60:63], v[40:43], v[28:31], v[60:63]
    ds_read_b64_tr_b16 v[116:117], v127 offset:0
    v_mfma_f32_16x16x32_bf16 v[64:67], v[40:43], v[32:35], v[64:67]
    ds_read_b64_tr_b16 v[118:119], v127 offset:256
    v_mfma_f32_16x16x32_bf16 v[68:71], v[40:43], v[36:39], v[68:71]
    s_add_u32 m0, s52, 0
    s_mov_b32 s73, 768
    buffer_load_dwordx4 v120, s[8:11], s73 offen lds
    s_waitcnt lgkmcnt(8)
    v_mfma_f32_16x16x32_bf16 v[136:139], v[88:91], v[16:19], v[136:139]
    ds_read_b128 v[28:31], v129 offset:36864
    v_mfma_f32_16x16x32_bf16 v[160:163], v[88:91], v[20:23], v[160:163]
    ds_read_b128 v[32:35], v129 offset:38912
    v_mfma_f32_16x16x32_bf16 v[140:143], v[92:95], v[16:19], v[140:143]
    ds_read_b128 v[36:39], v131 offset:36864
    v_mfma_f32_16x16x32_bf16 v[164:167], v[92:95], v[20:23], v[164:167]
    ds_read_b64_tr_b16 v[88:89], v124 offset:6144
    v_mfma_f32_16x16x32_bf16 v[144:147], v[96:99], v[16:19], v[144:147]
    ds_read_b64_tr_b16 v[90:91], v124 offset:6400
    s_add_u32 m0, s52, 1024
    s_mov_b32 s73, 768
    buffer_load_dwordx4 v121, s[8:11], s73 offen lds
    v_mfma_f32_16x16x32_bf16 v[168:171], v[96:99], v[20:23], v[168:171]
    ds_read_b64_tr_b16 v[92:93], v125 offset:6144
    v_mfma_f32_16x16x32_bf16 v[148:151], v[100:103], v[16:19], v[148:151]
    ds_read_b64_tr_b16 v[94:95], v125 offset:6400
    v_mfma_f32_16x16x32_bf16 v[172:175], v[100:103], v[20:23], v[172:175]
    ds_read_b64_tr_b16 v[96:97], v124 offset:8192
    s_waitcnt lgkmcnt(8)
    v_mfma_f32_16x16x32_bf16 v[152:155], v[16:19], v[104:107], v[152:155]
    ds_read_b64_tr_b16 v[98:99], v124 offset:8448
    v_mfma_f32_16x16x32_bf16 v[176:179], v[20:23], v[104:107], v[176:179]
    ds_read_b64_tr_b16 v[100:101], v125 offset:8192
    s_add_u32 m0, s52, 2048
    s_mov_b32 s73, 15104
    buffer_load_dwordx4 v120, s[8:11], s73 offen lds
    v_mfma_f32_16x16x32_bf16 v[156:159], v[16:19], v[108:111], v[156:159]
    ds_read_b64_tr_b16 v[102:103], v125 offset:8448
    v_mfma_f32_16x16x32_bf16 v[180:183], v[20:23], v[108:111], v[180:183]
    ds_read_b64_tr_b16 v[104:105], v124 offset:10240
    v_mfma_f32_16x16x32_bf16 v[184:187], v[112:115], v[24:27], v[184:187]
    ds_read_b64_tr_b16 v[106:107], v124 offset:10496
    v_mfma_f32_16x16x32_bf16 v[188:191], v[116:119], v[24:27], v[188:191]
    ds_read_b64_tr_b16 v[108:109], v125 offset:10240
    v_mfma_f32_16x16x32_bf16 v[48:51], v[16:19], v[16:19], v[48:51]
    ds_read_b64_tr_b16 v[110:111], v125 offset:10496
    s_add_u32 m0, s52, 3072
    s_mov_b32 s73, 15104
    buffer_load_dwordx4 v121, s[8:11], s73 offen lds
    v_mfma_f32_16x16x32_bf16 v[52:55], v[20:23], v[20:23], v[52:55]
    ds_read_b64_tr_b16 v[112:113], v126 offset:6144
    v_mfma_f32_16x16x32_bf16 v[56:59], v[24:27], v[24:27], v[56:59]
    ds_read_b64_tr_b16 v[114:115], v126 offset:6400
    v_mfma_f32_16x16x32_bf16 v[60:63], v[40:43], v[16:19], v[60:63]
    ds_read_b64_tr_b16 v[116:117], v127 offset:6144
    v_mfma_f32_16x16x32_bf16 v[64:67], v[40:43], v[20:23], v[64:67]
    ds_read_b64_tr_b16 v[118:119], v127 offset:6400
    v_mfma_f32_16x16x32_bf16 v[68:71], v[40:43], v[24:27], v[68:71]
    s_add_u32 m0, s7, 61440
    s_mov_b32 s73, 768
    s_mov_b64 exec, s[54:55]
    buffer_load_dwordx4 v122, s[8:11], s73 offen lds
    s_mov_b64 exec, -1
    v_mov_b32 v7, 0
    buffer_load_dword v6, v7, s[44:47], 0 offen sc1
    s_lshr_b32 s68, s2, 3
    s_lshl_b32 s68, s68, 2
    s_add_u32 s68, s68, s3
    v_lshlrev_b32 v219, 7, v1
    s_mul_i32 s86, s68, 3200
    s_mov_b64 exec, 0x1ffffff
    buffer_load_dword v234, v219, s[16:19], s86 offen
    s_mov_b64 exec, -1
    v_lshrrev_b32 v219, 2, v1
    v_mul_u32_u24 v219, 3584, v219
    v_and_b32 v220, 3, v1
    v_lshl_add_u32 v219, v220, 7, v219
    s_mul_i32 s68, s68, 57344
    s_and_b32 s69, s2, 7
    s_mul_i32 s86, s69, 3
    s_add_u32 s86, s86, 4
    s_lshl_b32 s87, s69, 2
    s_min_u32 s86, s86, s87
    s_lshl_b32 s86, s86, 7
    s_add_u32 s86, s86, s68
    s_cmp_lt_u32 s69, 4
    s_cselect_b32 exec_lo, -1, 0x77777777
    s_cselect_b32 exec_hi, -1, 0x77777777
    buffer_load_dword v235, v219, s[20:23], s86 offen
    s_mov_b64 exec, -1
    s_waitcnt vmcnt(11)
    s_barrier
    s_waitcnt lgkmcnt(8)
    v_mfma_f32_16x16x32_bf16 v[136:139], v[88:91], v[28:31], v[136:139]
    ds_read_b128 v[16:19], v128 offset:18432
    v_mfma_f32_16x16x32_bf16 v[160:163], v[88:91], v[32:35], v[160:163]
    ds_read_b128 v[20:23], v128 offset:20480
    v_mfma_f32_16x16x32_bf16 v[140:143], v[92:95], v[28:31], v[140:143]
    ds_read_b128 v[24:27], v130 offset:18432
    v_mfma_f32_16x16x32_bf16 v[164:167], v[92:95], v[32:35], v[164:167]
    ds_read_b64_tr_b16 v[88:89], v124 offset:12288
    v_mfma_f32_16x16x32_bf16 v[144:147], v[96:99], v[28:31], v[144:147]
    ds_read_b64_tr_b16 v[90:91], v124 offset:12544
    v_mfma_f32_16x16x32_bf16 v[168:171], v[96:99], v[32:35], v[168:171]
    ds_read_b64_tr_b16 v[92:93], v125 offset:12288
    v_mfma_f32_16x16x32_bf16 v[148:151], v[100:103], v[28:31], v[148:151]
    ds_read_b64_tr_b16 v[94:95], v125 offset:12544
    v_mfma_f32_16x16x32_bf16 v[172:175], v[100:103], v[32:35], v[172:175]
    ds_read_b64_tr_b16 v[96:97], v124 offset:14336
    s_waitcnt lgkmcnt(8)
    v_mfma_f32_16x16x32_bf16 v[152:155], v[28:31], v[104:107], v[152:155]
    ds_read_b64_tr_b16 v[98:99], v124 offset:14592
    v_mfma_f32_16x16x32_bf16 v[176:179], v[32:35], v[104:107], v[176:179]
    ds_read_b64_tr_b16 v[100:101], v125 offset:14336
    v_mfma_f32_16x16x32_bf16 v[156:159], v[28:31], v[108:111], v[156:159]
    ds_read_b64_tr_b16 v[102:103], v125 offset:14592
    v_mfma_f32_16x16x32_bf16 v[180:183], v[32:35], v[108:111], v[180:183]
    ds_read_b64_tr_b16 v[104:105], v124 offset:16384
    v_mfma_f32_16x16x32_bf16 v[184:187], v[112:115], v[36:39], v[184:187]
    ds_read_b64_tr_b16 v[106:107], v124 offset:16640
    v_mfma_f32_16x16x32_bf16 v[188:191], v[116:119], v[36:39], v[188:191]
    ds_read_b64_tr_b16 v[108:109], v125 offset:16384
    v_mfma_f32_16x16x32_bf16 v[48:51], v[28:31], v[28:31], v[48:51]
    ds_read_b64_tr_b16 v[110:111], v125 offset:16640
    v_mfma_f32_16x16x32_bf16 v[52:55], v[32:35], v[32:35], v[52:55]
    ds_read_b64_tr_b16 v[112:113], v126 offset:12288
    v_mfma_f32_16x16x32_bf16 v[56:59], v[36:39], v[36:39], v[56:59]
    ds_read_b64_tr_b16 v[114:115], v126 offset:12544
    v_mfma_f32_16x16x32_bf16 v[60:63], v[40:43], v[28:31], v[60:63]
    ds_read_b64_tr_b16 v[116:117], v127 offset:12288
    v_mfma_f32_16x16x32_bf16 v[64:67], v[40:43], v[32:35], v[64:67]
    ds_read_b64_tr_b16 v[118:119], v127 offset:12544
    v_mfma_f32_16x16x32_bf16 v[68:71], v[40:43], v[36:39], v[68:71]
    s_waitcnt lgkmcnt(8)
    v_mfma_f32_16x16x32_bf16 v[136:139], v[88:91], v[16:19], v[136:139]
    ds_read_b128 v[28:31], v129 offset:18432
    v_mfma_f32_16x16x32_bf16 v[160:163], v[88:91], v[20:23], v[160:163]
    ds_read_b128 v[32:35], v129 offset:20480
    v_mfma_f32_16x16x32_bf16 v[140:143], v[92:95], v[16:19], v[140:143]
    ds_read_b128 v[36:39], v131 offset:18432
    v_mfma_f32_16x16x32_bf16 v[164:167], v[92:95], v[20:23], v[164:167]
    ds_read_b64_tr_b16 v[88:89], v124 offset:18432
    v_mfma_f32_16x16x32_bf16 v[144:147], v[96:99], v[16:19], v[144:147]
    ds_read_b64_tr_b16 v[90:91], v124 offset:18688
    v_mfma_f32_16x16x32_bf16 v[168:171], v[96:99], v[20:23], v[168:171]
    ds_read_b64_tr_b16 v[92:93], v125 offset:18432
    v_mfma_f32_16x16x32_bf16 v[148:151], v[100:103], v[16:19], v[148:151]
    ds_read_b64_tr_b16 v[94:95], v125 offset:18688
    v_mfma_f32_16x16x32_bf16 v[172:175], v[100:103], v[20:23], v[172:175]
    ds_read_b64_tr_b16 v[96:97], v124 offset:20480
    s_waitcnt lgkmcnt(8)
    v_mfma_f32_16x16x32_bf16 v[152:155], v[16:19], v[104:107], v[152:155]
    ds_read_b64_tr_b16 v[98:99], v124 offset:20736
    v_mfma_f32_16x16x32_bf16 v[176:179], v[20:23], v[104:107], v[176:179]
    ds_read_b64_tr_b16 v[100:101], v125 offset:20480
    v_mfma_f32_16x16x32_bf16 v[156:159], v[16:19], v[108:111], v[156:159]
    ds_read_b64_tr_b16 v[102:103], v125 offset:20736
    v_mfma_f32_16x16x32_bf16 v[180:183], v[20:23], v[108:111], v[180:183]
    ds_read_b64_tr_b16 v[104:105], v124 offset:22528
    v_mfma_f32_16x16x32_bf16 v[184:187], v[112:115], v[24:27], v[184:187]
    ds_read_b64_tr_b16 v[106:107], v124 offset:22784
    v_mfma_f32_16x16x32_bf16 v[188:191], v[116:119], v[24:27], v[188:191]
    ds_read_b64_tr_b16 v[108:109], v125 offset:22528
    v_mfma_f32_16x16x32_bf16 v[48:51], v[16:19], v[16:19], v[48:51]
    ds_read_b64_tr_b16 v[110:111], v125 offset:22784
    v_mfma_f32_16x16x32_bf16 v[52:55], v[20:23], v[20:23], v[52:55]
    ds_read_b64_tr_b16 v[112:113], v126 offset:18432
    v_mfma_f32_16x16x32_bf16 v[56:59], v[24:27], v[24:27], v[56:59]
    ds_read_b64_tr_b16 v[114:115], v126 offset:18688
    v_mfma_f32_16x16x32_bf16 v[60:63], v[40:43], v[16:19], v[60:63]
    ds_read_b64_tr_b16 v[116:117], v127 offset:18432
    v_mfma_f32_16x16x32_bf16 v[64:67], v[40:43], v[20:23], v[64:67]
    ds_read_b64_tr_b16 v[118:119], v127 offset:18688
    v_mfma_f32_16x16x32_bf16 v[68:71], v[40:43], v[24:27], v[68:71]
    s_waitcnt vmcnt(3)
    s_barrier
    s_waitcnt lgkmcnt(8)
    v_mfma_f32_16x16x32_bf16 v[136:139], v[88:91], v[28:31], v[136:139]
    ds_read_b128 v[16:19], v128 offset:0
    v_mfma_f32_16x16x32_bf16 v[160:163], v[88:91], v[32:35], v[160:163]
    ds_read_b128 v[20:23], v128 offset:2048
    v_mfma_f32_16x16x32_bf16 v[140:143], v[92:95], v[28:31], v[140:143]
    ds_read_b128 v[24:27], v130 offset:0
    v_mfma_f32_16x16x32_bf16 v[164:167], v[92:95], v[32:35], v[164:167]
    ds_read_b64_tr_b16 v[88:89], v124 offset:24576
    v_mfma_f32_16x16x32_bf16 v[144:147], v[96:99], v[28:31], v[144:147]
    ds_read_b64_tr_b16 v[90:91], v124 offset:24832
    v_mfma_f32_16x16x32_bf16 v[168:171], v[96:99], v[32:35], v[168:171]
    ds_read_b64_tr_b16 v[92:93], v125 offset:24576
    v_mfma_f32_16x16x32_bf16 v[148:151], v[100:103], v[28:31], v[148:151]
    ds_read_b64_tr_b16 v[94:95], v125 offset:24832
    v_mfma_f32_16x16x32_bf16 v[172:175], v[100:103], v[32:35], v[172:175]
    ds_read_b64_tr_b16 v[96:97], v124 offset:26624
    s_waitcnt lgkmcnt(8)
    v_mfma_f32_16x16x32_bf16 v[152:155], v[28:31], v[104:107], v[152:155]
    ds_read_b64_tr_b16 v[98:99], v124 offset:26880
    v_mfma_f32_16x16x32_bf16 v[176:179], v[32:35], v[104:107], v[176:179]
    ds_read_b64_tr_b16 v[100:101], v125 offset:26624
    v_mfma_f32_16x16x32_bf16 v[156:159], v[28:31], v[108:111], v[156:159]
    ds_read_b64_tr_b16 v[102:103], v125 offset:26880
    v_mfma_f32_16x16x32_bf16 v[180:183], v[32:35], v[108:111], v[180:183]
    ds_read_b64_tr_b16 v[104:105], v124 offset:28672
    v_mfma_f32_16x16x32_bf16 v[184:187], v[112:115], v[36:39], v[184:187]
    ds_read_b64_tr_b16 v[106:107], v124 offset:28928
    v_mfma_f32_16x16x32_bf16 v[188:191], v[116:119], v[36:39], v[188:191]
    ds_read_b64_tr_b16 v[108:109], v125 offset:28672
    v_mfma_f32_16x16x32_bf16 v[48:51], v[28:31], v[28:31], v[48:51]
    ds_read_b64_tr_b16 v[110:111], v125 offset:28928
    v_mfma_f32_16x16x32_bf16 v[52:55], v[32:35], v[32:35], v[52:55]
    ds_read_b64_tr_b16 v[112:113], v126 offset:24576
    v_mfma_f32_16x16x32_bf16 v[56:59], v[36:39], v[36:39], v[56:59]
    ds_read_b64_tr_b16 v[114:115], v126 offset:24832
    v_mfma_f32_16x16x32_bf16 v[60:63], v[40:43], v[28:31], v[60:63]
    ds_read_b64_tr_b16 v[116:117], v127 offset:24576
    v_mfma_f32_16x16x32_bf16 v[64:67], v[40:43], v[32:35], v[64:67]
    ds_read_b64_tr_b16 v[118:119], v127 offset:24832
    v_mfma_f32_16x16x32_bf16 v[68:71], v[40:43], v[36:39], v[68:71]
    s_waitcnt lgkmcnt(8)
    v_mfma_f32_16x16x32_bf16 v[136:139], v[88:91], v[16:19], v[136:139]
    ds_read_b128 v[28:31], v129 offset:0
    v_mfma_f32_16x16x32_bf16 v[160:163], v[88:91], v[20:23], v[160:163]
    ds_read_b128 v[32:35], v129 offset:2048
    v_mfma_f32_16x16x32_bf16 v[140:143], v[92:95], v[16:19], v[140:143]
    ds_read_b128 v[36:39], v131 offset:0
    v_mfma_f32_16x16x32_bf16 v[164:167], v[92:95], v[20:23], v[164:167]
    ds_read_b64_tr_b16 v[88:89], v124 offset:30720
    v_mfma_f32_16x16x32_bf16 v[144:147], v[96:99], v[16:19], v[144:147]
    ds_read_b64_tr_b16 v[90:91], v124 offset:30976
    v_mfma_f32_16x16x32_bf16 v[168:171], v[96:99], v[20:23], v[168:171]
    ds_read_b64_tr_b16 v[92:93], v125 offset:30720
    v_mfma_f32_16x16x32_bf16 v[148:151], v[100:103], v[16:19], v[148:151]
    ds_read_b64_tr_b16 v[94:95], v125 offset:30976
    v_mfma_f32_16x16x32_bf16 v[172:175], v[100:103], v[20:23], v[172:175]
    ds_read_b64_tr_b16 v[96:97], v124 offset:32768
    s_waitcnt lgkmcnt(8)
    v_mfma_f32_16x16x32_bf16 v[152:155], v[16:19], v[104:107], v[152:155]
    ds_read_b64_tr_b16 v[98:99], v124 offset:33024
    v_mfma_f32_16x16x32_bf16 v[176:179], v[20:23], v[104:107], v[176:179]
    ds_read_b64_tr_b16 v[100:101], v125 offset:32768
    v_mfma_f32_16x16x32_bf16 v[156:159], v[16:19], v[108:111], v[156:159]
    ds_read_b64_tr_b16 v[102:103], v125 offset:33024
    v_mfma_f32_16x16x32_bf16 v[180:183], v[20:23], v[108:111], v[180:183]
    ds_read_b64_tr_b16 v[104:105], v124 offset:34816
    v_mfma_f32_16x16x32_bf16 v[184:187], v[112:115], v[24:27], v[184:187]
    ds_read_b64_tr_b16 v[106:107], v124 offset:35072
    v_mfma_f32_16x16x32_bf16 v[188:191], v[116:119], v[24:27], v[188:191]
    ds_read_b64_tr_b16 v[108:109], v125 offset:34816
    v_mfma_f32_16x16x32_bf16 v[48:51], v[16:19], v[16:19], v[48:51]
    ds_read_b64_tr_b16 v[110:111], v125 offset:35072
    v_mfma_f32_16x16x32_bf16 v[52:55], v[20:23], v[20:23], v[52:55]
    ds_read_b64_tr_b16 v[112:113], v126 offset:30720
    v_mfma_f32_16x16x32_bf16 v[56:59], v[24:27], v[24:27], v[56:59]
    ds_read_b64_tr_b16 v[114:115], v126 offset:30976
    v_mfma_f32_16x16x32_bf16 v[60:63], v[40:43], v[16:19], v[60:63]
    ds_read_b64_tr_b16 v[116:117], v127 offset:30720
    v_mfma_f32_16x16x32_bf16 v[64:67], v[40:43], v[20:23], v[64:67]
    ds_read_b64_tr_b16 v[118:119], v127 offset:30976
    v_mfma_f32_16x16x32_bf16 v[68:71], v[40:43], v[24:27], v[68:71]
    s_waitcnt lgkmcnt(8)
    v_mfma_f32_16x16x32_bf16 v[136:139], v[88:91], v[28:31], v[136:139]
    v_mfma_f32_16x16x32_bf16 v[160:163], v[88:91], v[32:35], v[160:163]
    v_mfma_f32_16x16x32_bf16 v[140:143], v[92:95], v[28:31], v[140:143]
    v_mfma_f32_16x16x32_bf16 v[164:167], v[92:95], v[32:35], v[164:167]
    v_mfma_f32_16x16x32_bf16 v[144:147], v[96:99], v[28:31], v[144:147]
    v_mfma_f32_16x16x32_bf16 v[168:171], v[96:99], v[32:35], v[168:171]
    v_mfma_f32_16x16x32_bf16 v[148:151], v[100:103], v[28:31], v[148:151]
    v_mfma_f32_16x16x32_bf16 v[172:175], v[100:103], v[32:35], v[172:175]
    s_waitcnt lgkmcnt(6)
    v_mfma_f32_16x16x32_bf16 v[152:155], v[28:31], v[104:107], v[152:155]
    v_mfma_f32_16x16x32_bf16 v[176:179], v[32:35], v[104:107], v[176:179]
    s_waitcnt lgkmcnt(4)
    v_mfma_f32_16x16x32_bf16 v[156:159], v[28:31], v[108:111], v[156:159]
    v_mfma_f32_16x16x32_bf16 v[180:183], v[32:35], v[108:111], v[180:183]
    s_waitcnt lgkmcnt(2)
    v_mfma_f32_16x16x32_bf16 v[184:187], v[112:115], v[36:39], v[184:187]
    s_waitcnt lgkmcnt(0)
    v_mfma_f32_16x16x32_bf16 v[188:191], v[116:119], v[36:39], v[188:191]
    v_mfma_f32_16x16x32_bf16 v[48:51], v[28:31], v[28:31], v[48:51]
    v_mfma_f32_16x16x32_bf16 v[52:55], v[32:35], v[32:35], v[52:55]
    v_mfma_f32_16x16x32_bf16 v[56:59], v[36:39], v[36:39], v[56:59]
    v_mfma_f32_16x16x32_bf16 v[60:63], v[40:43], v[28:31], v[60:63]
    v_mfma_f32_16x16x32_bf16 v[64:67], v[40:43], v[32:35], v[64:67]
    v_mfma_f32_16x16x32_bf16 v[68:71], v[40:43], v[36:39], v[68:71]
    s_mov_b32 exec_lo, 0x00010001
    s_mov_b32 exec_hi, 0x00010001
    ds_write_b128 v73, v[184:187] offset:128
    ds_write_b128 v74, v[188:191] offset:0
    s_mov_b64 exec, -1
    v_cndmask_b32 v48, v48, v49, s[88:89]
    v_cndmask_b32 v52, v52, v53, s[88:89]
    v_cndmask_b32 v56, v56, v57, s[88:89]
    v_cndmask_b32 v48, v48, v50, s[90:91]
    v_cndmask_b32 v52, v52, v54, s[90:91]
    v_cndmask_b32 v56, v56, v58, s[90:91]
    v_cndmask_b32 v48, v48, v51, s[92:93]
    v_cndmask_b32 v52, v52, v55, s[92:93]
    v_cndmask_b32 v56, v56, v59, s[92:93]
    v_mul_f32 v25, 0x3b124925, v60
    v_mul_f32 v27, 0x3b124925, v64
    v_mul_f32 v29, 0x3b124925, v68
    v_mul_f32 v24, v25, v25
    v_mul_f32 v26, v27, v27
    v_mul_f32 v28, v29, v29
    v_mul_f32 v48, 0x3b124925, v48
    v_mul_f32 v52, 0x3b124925, v52
    v_mul_f32 v56, 0x3b124925, v56
    v_sub_f32 v24, v48, v24
    v_sub_f32 v26, v52, v26
    v_sub_f32 v28, v56, v28
    v_max_f32 v24, 0, v24
    v_max_f32 v26, 0, v26
    v_max_f32 v28, 0, v28
    v_add_f32 v24, 0x3727c5ac, v24
    v_add_f32 v26, 0x3727c5ac, v26
    v_add_f32 v28, 0x3727c5ac, v28
    v_rsq_f32 v24, v24
    v_rsq_f32 v26, v26
    v_rsq_f32 v28, v28
    s_mov_b32 exec_lo, 0x00f0000f
    s_mov_b32 exec_hi, 0xf0000f00
    ds_write2_b32 v75, v24, v25 offset0:128 offset1:144
    ds_write2_b32 v75, v26, v27 offset0:160 offset1:176
    ds_write2_b32 v75, v28, v29 offset0:192 offset1:208
    s_mov_b64 exec, -1
    v_mov_b32_dpp v16, v184 row_newbcast:0 row_mask:0xf bank_mask:0xf
    v_mov_b32_dpp v17, v185 row_newbcast:0 row_mask:0xf bank_mask:0xf
    v_mov_b32_dpp v18, v186 row_newbcast:0 row_mask:0xf bank_mask:0xf
    v_mov_b32_dpp v19, v187 row_newbcast:0 row_mask:0xf bank_mask:0xf
    v_pk_fma_f32 v[16:17], v[16:17], v[28:29], v[184:185] op_sel:[0,1,0] op_sel_hi:[1,1,1] neg_lo:[0,1,0] neg_hi:[0,1,0]
    v_pk_fma_f32 v[18:19], v[18:19], v[28:29], v[186:187] op_sel:[0,1,0] op_sel_hi:[1,1,1] neg_lo:[0,1,0] neg_hi:[0,1,0]
    s_cmp_eq_u32 s49, 15
    s_cselect_b32 s88, 0xffff0000, -1
    s_mov_b32 s89, -1
    s_mov_b32 s90, -1
    s_cselect_b32 s91, -1, 0xffff
    s_waitcnt lgkmcnt(0)
    s_barrier
    ds_read_b32 v26, v75 offset:640
    ds_read_b32 v28, v75 offset:768
    ds_read_b32 v24, v75 offset:512
    ds_read_b128 v[56:59], v72 offset:128
    ds_read_b128 v[60:63], v72 offset:192
    ds_read_b32 v64, v77 offset:256
    ds_read_b32 v65, v77 offset:320
    ds_read_b128 v[44:47], v76 offset:704
    ds_read_b128 v[40:43], v76 offset:640
    ds_read_b128 v[36:39], v76 offset:576
    ds_read_b128 v[32:35], v76 offset:512
    ds_read_b128 v[48:51], v72 offset:0
    ds_read_b128 v[52:55], v72 offset:64
    s_waitcnt lgkmcnt(9)
    v_pk_fma_f32 v[168:169], v[56:57], v[26:27], v[168:169] op_sel:[0,1,0] op_sel_hi:[1,1,1] neg_lo:[0,1,0] neg_hi:[0,1,0]
    v_pk_fma_f32 v[170:171], v[58:59], v[26:27], v[170:171] op_sel:[0,1,0] op_sel_hi:[1,1,1] neg_lo:[0,1,0] neg_hi:[0,1,0]
    v_pk_mul_f32 v[168:169], v[168:169], v[26:27] op_sel:[0,0] op_sel_hi:[1,0]
    v_pk_mul_f32 v[170:171], v[170:171], v[26:27] op_sel:[0,0] op_sel_hi:[1,0]
    v_cvt_pk_bf16_f32 v104, v168, v169
    v_cvt_pk_bf16_f32 v105, v170, v171
    s_waitcnt lgkmcnt(8)
    v_pk_fma_f32 v[172:173], v[60:61], v[26:27], v[172:173] op_sel:[0,1,0] op_sel_hi:[1,1,1] neg_lo:[0,1,0] neg_hi:[0,1,0]
    v_pk_fma_f32 v[174:175], v[62:63], v[26:27], v[174:175] op_sel:[0,1,0] op_sel_hi:[1,1,1] neg_lo:[0,1,0] neg_hi:[0,1,0]
    v_pk_mul_f32 v[172:173], v[172:173], v[26:27] op_sel:[0,0] op_sel_hi:[1,0]
    v_pk_mul_f32 v[174:175], v[174:175], v[26:27] op_sel:[0,0] op_sel_hi:[1,0]
    v_cvt_pk_bf16_f32 v106, v172, v173
    v_cvt_pk_bf16_f32 v107, v174, v175
    ds_write_b128 v78, v[104:107] offset:4096
    v_pk_mul_f32 v[16:17], v[16:17], v[28:29] op_sel_hi:[1,0]
    v_pk_mul_f32 v[18:19], v[18:19], v[28:29] op_sel_hi:[1,0]
    v_cvt_pk_bf16_f32 v16, v16, v17
    v_cvt_pk_bf16_f32 v18, v18, v19
    ds_write_b16 v80, v16 offset:2048
    ds_write_b16_d16_hi v81, v16 offset:2048
    ds_write_b16 v82, v18 offset:2048
    ds_write_b16_d16_hi v83, v18 offset:2048
    s_waitcnt lgkmcnt(10)
    v_pk_fma_f32 v[176:177], v[44:45], v[64:65], v[176:177] op_sel:[0,0,0] op_sel_hi:[1,0,1] neg_lo:[0,1,0] neg_hi:[0,1,0]
    v_pk_fma_f32 v[178:179], v[46:47], v[64:65], v[178:179] op_sel:[0,0,0] op_sel_hi:[1,0,1] neg_lo:[0,1,0] neg_hi:[0,1,0]
    s_waitcnt lgkmcnt(9)
    v_pk_mul_f32 v[176:177], v[176:177], v[40:41]
    v_pk_mul_f32 v[178:179], v[178:179], v[42:43]
    v_cvt_pk_bf16_f32 v112, v176, v177
    v_cvt_pk_bf16_f32 v113, v178, v179
    v_pk_fma_f32 v[180:181], v[44:45], v[64:65], v[180:181] op_sel:[0,1,0] op_sel_hi:[1,1,1] neg_lo:[0,1,0] neg_hi:[0,1,0]
    v_pk_fma_f32 v[182:183], v[46:47], v[64:65], v[182:183] op_sel:[0,1,0] op_sel_hi:[1,1,1] neg_lo:[0,1,0] neg_hi:[0,1,0]
    v_pk_mul_f32 v[180:181], v[180:181], v[40:41]
    v_pk_mul_f32 v[182:183], v[182:183], v[42:43]
    v_cvt_pk_bf16_f32 v118, v180, v181
    v_cvt_pk_bf16_f32 v119, v182, v183
    ds_write_b64 v78, v[112:113] offset:5120
    ds_write_b64 v78, v[118:119] offset:5128
    v_mul_f32 v68, 0x3e8b97f6, v24
    v_mul_f32 v70, 0x3e8b97f6, v26
    v_cndmask_b32 v69, 0, v68, s[90:91]
    v_cndmask_b32 v68, 0, v68, s[88:89]
    v_cndmask_b32 v71, 0, v70, s[90:91]
    v_cndmask_b32 v70, 0, v70, s[88:89]
    v_pk_fma_f32 v[144:145], v[56:57], v[24:25], v[144:145] op_sel:[0,1,0] op_sel_hi:[1,1,1] neg_lo:[0,1,0] neg_hi:[0,1,0]
    v_pk_fma_f32 v[146:147], v[58:59], v[24:25], v[146:147] op_sel:[0,1,0] op_sel_hi:[1,1,1] neg_lo:[0,1,0] neg_hi:[0,1,0]
    v_pk_mul_f32 v[144:145], v[144:145], v[24:25] op_sel:[0,0] op_sel_hi:[1,0]
    v_pk_mul_f32 v[146:147], v[146:147], v[24:25] op_sel:[0,0] op_sel_hi:[1,0]
    v_cvt_pk_bf16_f32 v100, v144, v145
    v_cvt_pk_bf16_f32 v101, v146, v147
    v_pk_fma_f32 v[148:149], v[60:61], v[24:25], v[148:149] op_sel:[0,1,0] op_sel_hi:[1,1,1] neg_lo:[0,1,0] neg_hi:[0,1,0]
    v_pk_fma_f32 v[150:151], v[62:63], v[24:25], v[150:151] op_sel:[0,1,0] op_sel_hi:[1,1,1] neg_lo:[0,1,0] neg_hi:[0,1,0]
    v_pk_mul_f32 v[148:149], v[148:149], v[24:25] op_sel:[0,0] op_sel_hi:[1,0]
    v_pk_mul_f32 v[150:151], v[150:151], v[24:25] op_sel:[0,0] op_sel_hi:[1,0]
    v_cvt_pk_bf16_f32 v102, v148, v149
    v_cvt_pk_bf16_f32 v103, v150, v151
    s_waitcnt lgkmcnt(0)
    s_barrier
    ds_read_b128 v[96:99], v78 offset:2048
    ds_read_b64 v[108:109], v78 offset:3072
    ds_read_b64 v[114:115], v78 offset:3080
    v_pk_fma_f32 v[160:161], v[48:49], v[26:27], v[160:161] op_sel:[0,1,0] op_sel_hi:[1,1,1] neg_lo:[0,1,0] neg_hi:[0,1,0]
    v_pk_fma_f32 v[162:163], v[50:51], v[26:27], v[162:163] op_sel:[0,1,0] op_sel_hi:[1,1,1] neg_lo:[0,1,0] neg_hi:[0,1,0]
    v_pk_mul_f32 v[160:161], v[160:161], v[70:71] op_sel:[0,0] op_sel_hi:[1,0]
    v_pk_mul_f32 v[162:163], v[162:163], v[70:71] op_sel:[0,0] op_sel_hi:[1,0]
    v_cvt_pk_bf16_f32 v92, v160, v161
    v_cvt_pk_bf16_f32 v93, v162, v163
    v_pk_fma_f32 v[164:165], v[52:53], v[26:27], v[164:165] op_sel:[0,1,0] op_sel_hi:[1,1,1] neg_lo:[0,1,0] neg_hi:[0,1,0]
    v_pk_fma_f32 v[166:167], v[54:55], v[26:27], v[166:167] op_sel:[0,1,0] op_sel_hi:[1,1,1] neg_lo:[0,1,0] neg_hi:[0,1,0]
    v_pk_mul_f32 v[164:165], v[164:165], v[70:71] op_sel:[0,1] op_sel_hi:[1,1]
    v_pk_mul_f32 v[166:167], v[166:167], v[70:71] op_sel:[0,1] op_sel_hi:[1,1]
    v_cvt_pk_bf16_f32 v94, v164, v165
    v_cvt_pk_bf16_f32 v95, v166, v167
    s_nop 1
    v_mfma_f32_16x16x32_bf16 v[128:131], v[100:103], v[92:95], v[240:243]
    v_mfma_f32_16x16x32_bf16 v[132:135], v[104:107], v[92:95], v[244:247]
    v_pk_fma_f32 v[136:137], v[48:49], v[24:25], v[136:137] op_sel:[0,1,0] op_sel_hi:[1,1,1] neg_lo:[0,1,0] neg_hi:[0,1,0]
    v_pk_fma_f32 v[138:139], v[50:51], v[24:25], v[138:139] op_sel:[0,1,0] op_sel_hi:[1,1,1] neg_lo:[0,1,0] neg_hi:[0,1,0]
    v_pk_mul_f32 v[136:137], v[136:137], v[68:69] op_sel:[0,0] op_sel_hi:[1,0]
    v_pk_mul_f32 v[138:139], v[138:139], v[68:69] op_sel:[0,0] op_sel_hi:[1,0]
    v_cvt_pk_bf16_f32 v88, v136, v137
    v_cvt_pk_bf16_f32 v89, v138, v139
    v_pk_fma_f32 v[140:141], v[52:53], v[24:25], v[140:141] op_sel:[0,1,0] op_sel_hi:[1,1,1] neg_lo:[0,1,0] neg_hi:[0,1,0]
    v_pk_fma_f32 v[142:143], v[54:55], v[24:25], v[142:143] op_sel:[0,1,0] op_sel_hi:[1,1,1] neg_lo:[0,1,0] neg_hi:[0,1,0]
    v_pk_mul_f32 v[140:141], v[140:141], v[68:69] op_sel:[0,1] op_sel_hi:[1,1]
    v_pk_mul_f32 v[142:143], v[142:143], v[68:69] op_sel:[0,1] op_sel_hi:[1,1]
    v_cvt_pk_bf16_f32 v90, v140, v141
    v_cvt_pk_bf16_f32 v91, v142, v143
    s_waitcnt lgkmcnt(2)
    s_nop 0
    v_mfma_f32_16x16x32_bf16 v[120:123], v[96:99], v[88:91], v[248:251]
    v_mfma_f32_16x16x32_bf16 v[124:127], v[100:103], v[88:91], v[244:247]
    v_pk_fma_f32 v[152:153], v[36:37], v[64:65], v[152:153] op_sel:[0,0,0] op_sel_hi:[1,0,1] neg_lo:[0,1,0] neg_hi:[0,1,0]
    v_pk_fma_f32 v[154:155], v[38:39], v[64:65], v[154:155] op_sel:[0,0,0] op_sel_hi:[1,0,1] neg_lo:[0,1,0] neg_hi:[0,1,0]
    v_pk_mul_f32 v[152:153], v[152:153], v[32:33]
    v_pk_mul_f32 v[154:155], v[154:155], v[34:35]
    v_cvt_pk_bf16_f32 v110, v152, v153
    v_cvt_pk_bf16_f32 v111, v154, v155
    v_pk_fma_f32 v[156:157], v[36:37], v[64:65], v[156:157] op_sel:[0,1,0] op_sel_hi:[1,1,1] neg_lo:[0,1,0] neg_hi:[0,1,0]
    v_pk_fma_f32 v[158:159], v[38:39], v[64:65], v[158:159] op_sel:[0,1,0] op_sel_hi:[1,1,1] neg_lo:[0,1,0] neg_hi:[0,1,0]
    v_pk_mul_f32 v[156:157], v[156:157], v[32:33]
    v_pk_mul_f32 v[158:159], v[158:159], v[34:35]
    v_cvt_pk_bf16_f32 v116, v156, v157
    v_cvt_pk_bf16_f32 v117, v158, v159
    v_max3_f32 v137, v128, v129, v130
    v_max3_f32 v139, v131, v132, v133
    v_max3_f32 v137, v137, v134, v135
    v_max_f32 v137, v137, v139
    v_max3_f32 v136, v120, v121, v122
    v_max3_f32 v138, v123, v124, v125
    v_max3_f32 v136, v136, v126, v127
    v_max_f32 v136, v136, v138
    v_mov_b32 v138, v136
    v_mov_b32 v139, v137
    s_nop 0
    v_permlane32_swap_b32 v136, v138
    v_permlane32_swap_b32 v137, v139
    v_max_f32 v136, v136, v138
    v_max_f32 v137, v137, v139
    v_mov_b32 v138, v136
    v_mov_b32 v139, v137
    s_nop 0
    v_permlane16_swap_b32 v136, v138
    v_permlane16_swap_b32 v137, v139
    v_max_f32 v136, v136, v138
    v_max_f32 v137, v137, v139
    v_pk_add_f32 v[128:129], v[128:129], v[136:137] op_sel:[0,1] op_sel_hi:[1,1] neg_lo:[0,1] neg_hi:[0,1]
    v_pk_add_f32 v[130:131], v[130:131], v[136:137] op_sel:[0,1] op_sel_hi:[1,1] neg_lo:[0,1] neg_hi:[0,1]
    v_pk_add_f32 v[132:133], v[132:133], v[136:137] op_sel:[0,1] op_sel_hi:[1,1] neg_lo:[0,1] neg_hi:[0,1]
    v_pk_add_f32 v[134:135], v[134:135], v[136:137] op_sel:[0,1] op_sel_hi:[1,1] neg_lo:[0,1] neg_hi:[0,1]
    v_exp_f32 v128, v128
    v_exp_f32 v129, v129
    v_exp_f32 v130, v130
    v_exp_f32 v131, v131
    v_exp_f32 v132, v132
    v_exp_f32 v133, v133
    v_exp_f32 v134, v134
    v_exp_f32 v135, v135
    v_cvt_pk_bf16_f32 v148, v128, v129
    v_cvt_pk_bf16_f32 v149, v130, v131
    v_cvt_pk_bf16_f32 v150, v132, v133
    v_cvt_pk_bf16_f32 v151, v134, v135
    s_nop 1
    v_mfma_f32_16x16x32_bf16 v[160:163], v[110:113], v[148:151], 0
    v_mfma_f32_16x16x32_bf16 v[164:167], v[116:119], v[148:151], 0
    v_pk_add_f32 v[120:121], v[120:121], v[136:137] op_sel:[0,0] op_sel_hi:[1,0] neg_lo:[0,1] neg_hi:[0,1]
    v_pk_add_f32 v[122:123], v[122:123], v[136:137] op_sel:[0,0] op_sel_hi:[1,0] neg_lo:[0,1] neg_hi:[0,1]
    v_pk_add_f32 v[124:125], v[124:125], v[136:137] op_sel:[0,0] op_sel_hi:[1,0] neg_lo:[0,1] neg_hi:[0,1]
    v_pk_add_f32 v[126:127], v[126:127], v[136:137] op_sel:[0,0] op_sel_hi:[1,0] neg_lo:[0,1] neg_hi:[0,1]
    v_exp_f32 v120, v120
    v_exp_f32 v121, v121
    v_exp_f32 v122, v122
    v_exp_f32 v123, v123
    v_exp_f32 v124, v124
    v_exp_f32 v125, v125
    v_exp_f32 v126, v126
    v_exp_f32 v127, v127
    v_cvt_pk_bf16_f32 v144, v120, v121
    v_cvt_pk_bf16_f32 v145, v122, v123
    v_cvt_pk_bf16_f32 v146, v124, v125
    v_cvt_pk_bf16_f32 v147, v126, v127
    s_waitcnt lgkmcnt(1)
    s_nop 0
    v_mfma_f32_16x16x32_bf16 v[152:155], v[108:111], v[144:147], 0
    s_waitcnt lgkmcnt(0)
    v_mfma_f32_16x16x32_bf16 v[156:159], v[114:117], v[144:147], 0
    v_pk_add_f32 v[120:121], v[120:121], v[122:123]
    v_pk_add_f32 v[124:125], v[124:125], v[126:127]
    v_pk_add_f32 v[128:129], v[128:129], v[130:131]
    v_pk_add_f32 v[132:133], v[132:133], v[134:135]
    v_pk_add_f32 v[120:121], v[120:121], v[124:125]
    v_pk_add_f32 v[128:129], v[128:129], v[132:133]
    v_add_f32 v140, v120, v121
    v_add_f32 v142, v128, v129
    v_mov_b32 v138, v140
    v_mov_b32 v139, v142
    s_nop 0
    v_permlane32_swap_b32 v140, v138
    v_permlane32_swap_b32 v142, v139
    v_add_f32 v140, v140, v138
    v_add_f32 v142, v142, v139
    v_mov_b32 v138, v140
    v_mov_b32 v139, v142
    s_nop 0
    v_permlane16_swap_b32 v140, v138
    v_permlane16_swap_b32 v142, v139
    v_add_f32 v140, v140, v138
    v_add_f32 v142, v142, v139
    v_rcp_f32 v140, v140
    v_rcp_f32 v142, v142
    v_cndmask_b32 v141, 0, v140, s[90:91]
    v_cndmask_b32 v140, 0, v140, s[88:89]
    v_cndmask_b32 v143, 0, v142, s[90:91]
    v_cndmask_b32 v142, 0, v142, s[88:89]
    v_pk_mul_f32 v[152:153], v[152:153], v[140:141] op_sel_hi:[1,0]
    v_pk_mul_f32 v[154:155], v[154:155], v[140:141] op_sel_hi:[1,0]
    v_pk_mul_f32 v[156:157], v[156:157], v[140:141] op_sel:[0,1] op_sel_hi:[1,1]
    v_pk_mul_f32 v[158:159], v[158:159], v[140:141] op_sel:[0,1] op_sel_hi:[1,1]
    v_cvt_pk_bf16_f32 v144, v152, v153
    v_cvt_pk_bf16_f32 v145, v154, v155
    v_cvt_pk_bf16_f32 v146, v156, v157
    v_cvt_pk_bf16_f32 v147, v158, v159
    buffer_store_dwordx4 v[144:147], v4, s[40:43], s62 offen sc1
    v_pk_mul_f32 v[160:161], v[160:161], v[142:143] op_sel_hi:[1,0]
    v_pk_mul_f32 v[162:163], v[162:163], v[142:143] op_sel_hi:[1,0]
    v_pk_mul_f32 v[164:165], v[164:165], v[142:143] op_sel:[0,1] op_sel_hi:[1,1]
    v_pk_mul_f32 v[166:167], v[166:167], v[142:143] op_sel:[0,1] op_sel_hi:[1,1]
    v_cvt_pk_bf16_f32 v148, v160, v161
    v_cvt_pk_bf16_f32 v149, v162, v163
    v_cvt_pk_bf16_f32 v150, v164, v165
    v_cvt_pk_bf16_f32 v151, v166, v167
    buffer_store_dwordx4 v[148:151], v4, s[40:43], s63 offen sc1
    s_add_u32 m0, s59, 0
    s_mov_b32 s73, 0
    buffer_load_dwordx4 v208, s[16:19], s73 offen lds
    s_add_u32 m0, s59, 1024
    s_mov_b32 s73, 7168
    buffer_load_dwordx4 v208, s[16:19], s73 offen lds
    s_add_u32 m0, s59, 2048
    s_mov_b32 s73, 14336
    buffer_load_dwordx4 v208, s[16:19], s73 offen lds
    s_add_u32 m0, s59, 3072
    s_mov_b32 s73, 21504
    buffer_load_dwordx4 v208, s[16:19], s73 offen lds
    s_add_u32 m0, s59, 4096
    s_mov_b32 s73, 28672
    buffer_load_dwordx4 v208, s[16:19], s73 offen lds
    s_add_u32 m0, s59, 5120
    s_mov_b32 s73, 35840
    buffer_load_dwordx4 v208, s[16:19], s73 offen lds
    s_add_u32 m0, s59, 6144
    s_mov_b32 s73, 43008
    buffer_load_dwordx4 v208, s[16:19], s73 offen lds
    s_add_u32 m0, s59, 7168
    s_mov_b32 s73, 50176
    buffer_load_dwordx4 v208, s[16:19], s73 offen lds
    s_add_u32 m0, s59, 8192
    s_mov_b32 s73, 57344
    buffer_load_dwordx4 v208, s[16:19], s73 offen lds
    s_add_u32 m0, s59, 9216
    s_mov_b32 s73, 64512
    buffer_load_dwordx4 v208, s[16:19], s73 offen lds
    s_add_u32 m0, s59, 10240
    s_mov_b32 s73, 71680
    buffer_load_dwordx4 v208, s[16:19], s73 offen lds
    s_add_u32 m0, s59, 11264
    s_mov_b32 s73, 78848
    buffer_load_dwordx4 v208, s[16:19], s73 offen lds
    s_add_u32 m0, s59, 12288
    s_mov_b32 s73, 86016
    buffer_load_dwordx4 v208, s[16:19], s73 offen lds
    s_add_u32 m0, s59, 13312
    s_mov_b32 s73, 93184
    buffer_load_dwordx4 v208, s[16:19], s73 offen lds
    s_waitcnt vmcnt(18)
    v_readfirstlane_b32 s4, v6
    s_nop 1
    s_cmp_lg_u32 s4, 0
    s_cbranch_scc1 Lepd_P_2
    s_nop 0
Lepg_P_1:
    s_sub_u32 s6, s6, 1
    s_cbranch_scc1 L_end_P
    buffer_load_dword v6, v7, s[44:47], 0 offen sc1
    s_waitcnt vmcnt(0)
    v_readfirstlane_b32 s4, v6
    s_nop 1
    s_cmp_eq_u32 s4, 0
    s_cbranch_scc1 Lepg_P_1
Lepd_P_2:
    s_waitcnt vmcnt(14)
    v_mov_b32 v8, s4
    s_mov_b64 exec, 1
    buffer_store_dword v8, v9, s[40:43], s80 offen sc1
    s_mov_b64 exec, -1
    s_cmp_lt_u32 s67, 99
    s_cbranch_scc1 Lnotag_P_3
    s_lshr_b32 s68, s2, 3
    s_sub_u32 s68, s68, 28
    s_lshl_b32 s68, s68, 2
    s_add_u32 s68, s68, s3
    s_lshl_b32 s68, s68, 16
    s_and_b32 s69, s2, 7
    s_lshl_b32 s69, s69, 9
    s_add_u32 s68, s68, s69
    v_lshrrev_b32 v16, 2, v1
    v_lshlrev_b32 v16, 12, v16
    v_and_b32 v17, 3, v1
    v_lshl_add_u32 v16, v17, 7, v16
    buffer_load_dword v18, v16, s[24:27], s68 offen
    s_add_u32 s68, s68, 0x100000
    s_waitcnt vmcnt(3)
    buffer_load_dword v19, v16, s[24:27], s68 offen
    s_add_u32 s68, s68, 0x100000
    s_waitcnt vmcnt(3)
    buffer_load_dword v20, v16, s[24:27], s68 offen
    s_add_u32 s68, s68, 0x100000
    s_waitcnt vmcnt(3)
    buffer_load_dword v21, v16, s[24:27], s68 offen
    s_add_u32 s68, s68, 0x100000
    s_waitcnt vmcnt(3)
    buffer_load_dword v22, v16, s[24:27], s68 offen
    s_add_u32 s68, s68, 0x100000
    s_waitcnt vmcnt(3)
    buffer_load_dword v23, v16, s[24:27], s68 offen
    s_add_u32 s68, s68, 0x100000
    s_waitcnt vmcnt(3)
    buffer_load_dword v24, v16, s[24:27], s68 offen
    s_add_u32 s68, s68, 0x100000
    s_waitcnt vmcnt(3)
    s_waitcnt vmcnt(0)
    s_branch L_end_P
Lnotag_P_3:
    v_lshrrev_b32 v221, 5, v1
    v_mul_u32_u24 v221, 3584, v221
    v_and_b32 v222, 31, v1
    v_lshl_add_u32 v221, v222, 1, v221
    s_lshl_b32 s58, s67, 1
    s_lshr_b32 s60, s3, 1
    s_add_u32 s58, s58, s60
    s_mul_i32 s58, s58, 28672
    s_lshl_b32 s60, s66, 7
    s_add_u32 s58, s58, s60
    s_and_b32 s60, s3, 1
    s_lshl_b32 s60, s60, 6
    s_add_u32 s58, s58, s60
    buffer_load_ushort v192, v221, s[8:11], s58 offen offset:0
    buffer_load_ushort v193, v221, s[8:11], s58 offen offset:896
    buffer_load_ushort v194, v221, s[8:11], s58 offen offset:1792
    buffer_load_ushort v195, v221, s[8:11], s58 offen offset:2688
    s_add_u32 s58, s58, 7168
    buffer_load_ushort v196, v221, s[8:11], s58 offen offset:0
    buffer_load_ushort v197, v221, s[8:11], s58 offen offset:896
    buffer_load_ushort v198, v221, s[8:11], s58 offen offset:1792
    buffer_load_ushort v199, v221, s[8:11], s58 offen offset:2688
    s_add_u32 s58, s58, 7168
    buffer_load_ushort v200, v221, s[8:11], s58 offen offset:0
    buffer_load_ushort v201, v221, s[8:11], s58 offen offset:896
    buffer_load_ushort v202, v221, s[8:11], s58 offen offset:1792
    buffer_load_ushort v203, v221, s[8:11], s58 offen offset:2688
    s_add_u32 s58, s58, 7168
    buffer_load_ushort v204, v221, s[8:11], s58 offen offset:0
    buffer_load_ushort v205, v221, s[8:11], s58 offen offset:896
    buffer_load_ushort v206, v221, s[8:11], s58 offen offset:1792
    buffer_load_ushort v207, v221, s[8:11], s58 offen offset:2688
    s_and_b32 s68, s2, 7
    s_cmp_ge_u32 s68, 7
    s_cselect_b32 s48, 7, 0
    s_sub_u32 s68, s68, s48
    s_lshl_b32 s48, s68, 12
    s_add_u32 s68, s68, 1
    s_cmp_ge_u32 s68, 7
    s_cselect_b32 s49, 7, 0
    s_sub_u32 s68, s68, s49
    s_lshl_b32 s49, s68, 12
    s_add_u32 s68, s68, 1
    s_cmp_ge_u32 s68, 7
    s_cselect_b32 s50, 7, 0
    s_sub_u32 s68, s68, s50
    s_lshl_b32 s50, s68, 12
    s_add_u32 s68, s68, 1
    s_cmp_ge_u32 s68, 7
    s_cselect_b32 s51, 7, 0
    s_sub_u32 s68, s68, s51
    s_lshl_b32 s51, s68, 12
    s_add_u32 s68, s68, 1
    s_cmp_ge_u32 s68, 7
    s_cselect_b32 s52, 7, 0
    s_sub_u32 s68, s68, s52
    s_lshl_b32 s52, s68, 12
    s_add_u32 s68, s68, 1
    s_cmp_ge_u32 s68, 7
    s_cselect_b32 s53, 7, 0
    s_sub_u32 s68, s68, s53
    s_lshl_b32 s53, s68, 12
    s_add_u32 s68, s68, 1
    s_cmp_ge_u32 s68, 7
    s_cselect_b32 s54, 7, 0
    s_sub_u32 s68, s68, s54
    s_lshl_b32 s54, s68, 12
    s_waitcnt vmcnt(17)
    s_barrier
    ds_read_b64_tr_b16 a[0:1], v209 offset:0
    ds_read_b64_tr_b16 a[2:3], v209 offset:2048
    ds_read_b64_tr_b16 a[4:5], v209 offset:1024
    ds_read_b64_tr_b16 a[6:7], v209 offset:3072
    ds_read_b64_tr_b16 a[8:9], v209 offset:3584
    ds_read_b64_tr_b16 a[10:11], v209 offset:5632
    ds_read_b64_tr_b16 a[12:13], v209 offset:4608
    ds_read_b64_tr_b16 a[14:15], v209 offset:6656
    ds_read_b64_tr_b16 a[16:17], v209 offset:7168
    ds_read_b64_tr_b16 a[18:19], v209 offset:9216
    ds_read_b64_tr_b16 a[20:21], v209 offset:8192
    ds_read_b64_tr_b16 a[22:23], v209 offset:10240
    ds_read_b64_tr_b16 a[24:25], v209 offset:10752
    ds_read_b64_tr_b16 a[26:27], v209 offset:12800
    ds_read_b64_tr_b16 a[28:29], v209 offset:11776
    ds_read_b64_tr_b16 a[30:31], v209 offset:13824
    ds_read_b64_tr_b16 a[32:33], v209 offset:14336
    ds_read_b64_tr_b16 a[34:35], v209 offset:16384
    ds_read_b64_tr_b16 a[36:37], v209 offset:15360
    ds_read_b64_tr_b16 a[38:39], v209 offset:17408
    ds_read_b64_tr_b16 a[40:41], v209 offset:17920
    ds_read_b64_tr_b16 a[42:43], v209 offset:19968
    ds_read_b64_tr_b16 a[44:45], v209 offset:18944
    ds_read_b64_tr_b16 a[46:47], v209 offset:20992
    ds_read_b64_tr_b16 a[48:49], v209 offset:21504
    ds_read_b64_tr_b16 a[50:51], v209 offset:23552
    ds_read_b64_tr_b16 a[52:53], v209 offset:22528
    ds_read_b64_tr_b16 a[54:55], v209 offset:24576
    ds_read_b64_tr_b16 a[56:57], v209 offset:25088
    ds_read_b64_tr_b16 a[58:59], v209 offset:27136
    ds_read_b64_tr_b16 a[60:61], v209 offset:26112
    ds_read_b64_tr_b16 a[62:63], v209 offset:28160
    ds_read_b64_tr_b16 a[64:65], v209 offset:28672
    ds_read_b64_tr_b16 a[66:67], v209 offset:30720
    ds_read_b64_tr_b16 a[68:69], v209 offset:29696
    ds_read_b64_tr_b16 a[70:71], v209 offset:31744
    ds_read_b64_tr_b16 a[72:73], v209 offset:32256
    ds_read_b64_tr_b16 a[74:75], v209 offset:34304
    ds_read_b64_tr_b16 a[76:77], v209 offset:33280
    ds_read_b64_tr_b16 a[78:79], v209 offset:35328
    ds_read_b64_tr_b16 a[80:81], v209 offset:35840
    ds_read_b64_tr_b16 a[82:83], v209 offset:37888
    ds_read_b64_tr_b16 a[84:85], v209 offset:36864
    ds_read_b64_tr_b16 a[86:87], v209 offset:38912
    ds_read_b64_tr_b16 a[88:89], v209 offset:39424
    ds_read_b64_tr_b16 a[90:91], v209 offset:41472
    ds_read_b64_tr_b16 a[92:93], v209 offset:40448
    ds_read_b64_tr_b16 a[94:95], v209 offset:42496
    ds_read_b64_tr_b16 a[96:97], v209 offset:43008
    ds_read_b64_tr_b16 a[98:99], v209 offset:45056
    ds_read_b64_tr_b16 a[100:101], v209 offset:44032
    ds_read_b64_tr_b16 a[102:103], v209 offset:46080
    ds_read_b64_tr_b16 a[104:105], v209 offset:46592
    ds_read_b64_tr_b16 a[106:107], v209 offset:48640
    ds_read_b64_tr_b16 a[108:109], v209 offset:47616
    ds_read_b64_tr_b16 a[110:111], v209 offset:49664
    ds_read_b64_tr_b16 a[112:113], v209 offset:50176
    ds_read_b64_tr_b16 a[114:115], v209 offset:52224
    ds_read_b64_tr_b16 a[116:117], v209 offset:51200
    ds_read_b64_tr_b16 a[118:119], v209 offset:53248
    ds_read_b64_tr_b16 a[120:121], v209 offset:53248
    ds_read_b64_tr_b16 a[122:123], v209 offset:55296
    ds_read_b64_tr_b16 a[124:125], v209 offset:54272
    ds_read_b64_tr_b16 a[126:127], v209 offset:56320
    s_waitcnt lgkmcnt(0)
    s_barrier
    s_add_u32 m0, s70, 16384
    s_mul_i32 s73, s94, 56
    s_add_u32 s73, s73, 0
    buffer_load_dwordx4 v213, s[20:23], s73 offen lds
    s_add_u32 m0, s70, 17408
    s_mul_i32 s73, s94, 56
    s_add_u32 s73, s73, 28672
    buffer_load_dwordx4 v213, s[20:23], s73 offen lds
    s_add_u32 m0, s70, 18432
    s_mul_i32 s73, s94, 56
    s_add_u32 s73, s73, 57344
    buffer_load_dwordx4 v213, s[20:23], s73 offen lds
    s_add_u32 m0, s70, 19456
    s_mul_i32 s73, s94, 56
    s_add_u32 s73, s73, 86016
    buffer_load_dwordx4 v213, s[20:23], s73 offen lds
    s_add_u32 m0, s70, 20480
    s_mul_i32 s73, s94, 56
    s_add_u32 s73, s73, 114688
    buffer_load_dwordx4 v213, s[20:23], s73 offen lds
    s_add_u32 m0, s70, 21504
    s_mul_i32 s73, s94, 56
    s_add_u32 s73, s73, 143360
    buffer_load_dwordx4 v213, s[20:23], s73 offen lds
    s_add_u32 m0, s70, 22528
    s_mul_i32 s73, s94, 56
    s_add_u32 s73, s73, 172032
    buffer_load_dwordx4 v213, s[20:23], s73 offen lds
    s_add_u32 m0, s70, 23552
    s_mul_i32 s73, s94, 56
    s_add_u32 s73, s73, 200704
    buffer_load_dwordx4 v213, s[20:23], s73 offen lds
    s_add_u32 m0, s70, 24576
    s_mul_i32 s73, s95, 56
    s_add_u32 s73, s73, 0
    buffer_load_dwordx4 v213, s[20:23], s73 offen lds
    s_add_u32 m0, s70, 25600
    s_mul_i32 s73, s95, 56
    s_add_u32 s73, s73, 28672
    buffer_load_dwordx4 v213, s[20:23], s73 offen lds
    s_add_u32 m0, s70, 26624
    s_mul_i32 s73, s95, 56
    s_add_u32 s73, s73, 57344
    buffer_load_dwordx4 v213, s[20:23], s73 offen lds
    s_add_u32 m0, s70, 27648
    s_mul_i32 s73, s95, 56
    s_add_u32 s73, s73, 86016
    buffer_load_dwordx4 v213, s[20:23], s73 offen lds
    s_add_u32 m0, s70, 28672
    s_mul_i32 s73, s95, 56
    s_add_u32 s73, s73, 114688
    buffer_load_dwordx4 v213, s[20:23], s73 offen lds
    s_add_u32 m0, s70, 29696
    s_mul_i32 s73, s95, 56
    s_add_u32 s73, s73, 143360
    buffer_load_dwordx4 v213, s[20:23], s73 offen lds
    s_add_u32 m0, s70, 30720
    s_mul_i32 s73, s95, 56
    s_add_u32 s73, s73, 172032
    buffer_load_dwordx4 v213, s[20:23], s73 offen lds
    s_add_u32 m0, s70, 31744
    s_mul_i32 s73, s95, 56
    s_add_u32 s73, s73, 200704
    buffer_load_dwordx4 v213, s[20:23], s73 offen lds
    s_add_u32 m0, s70, 32768
    s_mul_i32 s73, s96, 56
    s_add_u32 s73, s73, 0
    buffer_load_dwordx4 v213, s[20:23], s73 offen lds
    s_add_u32 m0, s70, 33792
    s_mul_i32 s73, s96, 56
    s_add_u32 s73, s73, 28672
    buffer_load_dwordx4 v213, s[20:23], s73 offen lds
    s_add_u32 m0, s70, 34816
    s_mul_i32 s73, s96, 56
    s_add_u32 s73, s73, 57344
    buffer_load_dwordx4 v213, s[20:23], s73 offen lds
    s_add_u32 m0, s70, 35840
    s_mul_i32 s73, s96, 56
    s_add_u32 s73, s73, 86016
    buffer_load_dwordx4 v213, s[20:23], s73 offen lds
    buffer_load_dword v249, v10, s[40:43], s83 offen sc1
    s_sleep 3
    buffer_load_dword v250, v10, s[40:43], s83 offen sc1
    s_sleep 3
    s_nop 0
Lpoll_P_4:
    s_sub_u32 s6, s6, 1
    s_cbranch_scc1 L_end_P
    buffer_load_dword v251, v10, s[40:43], s83 offen sc1
    s_waitcnt vmcnt(2)
    v_cmp_ne_u32 vcc, s4, v249
    s_nop 1
    s_cbranch_vccz Lpd_P_5
    buffer_load_dword v249, v10, s[40:43], s83 offen sc1
    s_waitcnt vmcnt(2)
    v_cmp_ne_u32 vcc, s4, v250
    s_nop 1
    s_cbranch_vccz Lpd_P_5
    buffer_load_dword v250, v10, s[40:43], s83 offen sc1
    s_waitcnt vmcnt(2)
    v_cmp_ne_u32 vcc, s4, v251
    s_nop 1
    s_cbranch_vccnz Lpoll_P_4
    s_nop 1
Lpd_P_5:
    s_lshl_b32 s58, s67, 16
    s_lshl_b32 s60, s3, 14
    s_add_u32 s58, s58, s60
    s_add_u32 m0, s70, 0
    s_nop 0
    buffer_load_dwordx4 v4, s[40:43], s58 offen offset:0 sc1 lds
    buffer_load_dwordx4 v4, s[40:43], s58 offen offset:1024 sc1 lds
    buffer_load_dwordx4 v4, s[40:43], s58 offen offset:2048 sc1 lds
    buffer_load_dwordx4 v4, s[40:43], s58 offen offset:3072 sc1 lds
    s_add_u32 m0, s70, 4096
    s_add_u32 s58, s58, 4096
    buffer_load_dwordx4 v4, s[40:43], s58 offen offset:0 sc1 lds
    buffer_load_dwordx4 v4, s[40:43], s58 offen offset:1024 sc1 lds
    buffer_load_dwordx4 v4, s[40:43], s58 offen offset:2048 sc1 lds
    buffer_load_dwordx4 v4, s[40:43], s58 offen offset:3072 sc1 lds
    s_add_u32 m0, s70, 8192
    s_add_u32 s58, s58, 4096
    buffer_load_dwordx4 v4, s[40:43], s58 offen offset:0 sc1 lds
    buffer_load_dwordx4 v4, s[40:43], s58 offen offset:1024 sc1 lds
    buffer_load_dwordx4 v4, s[40:43], s58 offen offset:2048 sc1 lds
    buffer_load_dwordx4 v4, s[40:43], s58 offen offset:3072 sc1 lds
    s_add_u32 m0, s70, 12288
    s_add_u32 s58, s58, 4096
    buffer_load_dwordx4 v4, s[40:43], s58 offen offset:0 sc1 lds
    buffer_load_dwordx4 v4, s[40:43], s58 offen offset:1024 sc1 lds
    buffer_load_dwordx4 v4, s[40:43], s58 offen offset:2048 sc1 lds
    buffer_load_dwordx4 v4, s[40:43], s58 offen offset:3072 sc1 lds
    v_and_b32 v64, 1, v3
    v_mul_u32_u24 v64, 36864, v64
    v_lshl_add_u32 v64, v2, 4, v64
    v_lshrrev_b32 v65, 5, v1
    v_lshl_add_u32 v64, v65, 8, v64
    s_lshr_b32 s60, s3, 1
    s_mul_i32 s60, s60, 73728
    s_add_u32 s60, s60, 12288
    v_add_u32 v64, s60, v64
    ds_read_b64_tr_b16 a[128:129], v215 offset:16384
    ds_read_b64_tr_b16 a[130:131], v215 offset:17408
    ds_read_b64_tr_b16 a[132:133], v216 offset:16384
    ds_read_b64_tr_b16 a[134:135], v216 offset:17408
    ds_read_b64_tr_b16 a[136:137], v215 offset:18432
    ds_read_b64_tr_b16 a[138:139], v215 offset:19456
    ds_read_b64_tr_b16 a[140:141], v216 offset:18432
    ds_read_b64_tr_b16 a[142:143], v216 offset:19456
    ds_read_b64_tr_b16 a[144:145], v215 offset:20480
    ds_read_b64_tr_b16 a[146:147], v215 offset:21504
    ds_read_b64_tr_b16 a[148:149], v216 offset:20480
    ds_read_b64_tr_b16 a[150:151], v216 offset:21504
    ds_read_b64_tr_b16 a[152:153], v215 offset:22528
    ds_read_b64_tr_b16 a[154:155], v215 offset:23552
    ds_read_b64_tr_b16 a[156:157], v216 offset:22528
    ds_read_b64_tr_b16 a[158:159], v216 offset:23552
    ds_read_b64_tr_b16 a[160:161], v215 offset:24576
    ds_read_b64_tr_b16 a[162:163], v215 offset:25600
    ds_read_b64_tr_b16 a[164:165], v216 offset:24576
    ds_read_b64_tr_b16 a[166:167], v216 offset:25600
    ds_read_b64_tr_b16 a[168:169], v215 offset:26624
    ds_read_b64_tr_b16 a[170:171], v215 offset:27648
    ds_read_b64_tr_b16 a[172:173], v216 offset:26624
    ds_read_b64_tr_b16 a[174:175], v216 offset:27648
    ds_read_b64_tr_b16 a[176:177], v215 offset:28672
    ds_read_b64_tr_b16 a[178:179], v215 offset:29696
    ds_read_b64_tr_b16 a[180:181], v216 offset:28672
    ds_read_b64_tr_b16 a[182:183], v216 offset:29696
    ds_read_b64_tr_b16 a[184:185], v215 offset:30720
    ds_read_b64_tr_b16 a[186:187], v215 offset:31744
    ds_read_b64_tr_b16 a[188:189], v216 offset:30720
    ds_read_b64_tr_b16 a[190:191], v216 offset:31744
    ds_read_b64_tr_b16 a[192:193], v215 offset:32768
    ds_read_b64_tr_b16 a[194:195], v215 offset:33792
    ds_read_b64_tr_b16 a[196:197], v216 offset:32768
    ds_read_b64_tr_b16 a[198:199], v216 offset:33792
    ds_read_b64_tr_b16 a[200:201], v215 offset:34816
    ds_read_b64_tr_b16 a[202:203], v215 offset:35840
    ds_read_b64_tr_b16 a[204:205], v216 offset:34816
    ds_read_b64_tr_b16 a[206:207], v216 offset:35840
    v_lshlrev_b32 v192, 16, v192
    v_lshlrev_b32 v193, 16, v193
    v_lshlrev_b32 v194, 16, v194
    v_lshlrev_b32 v195, 16, v195
    v_lshlrev_b32 v196, 16, v196
    v_lshlrev_b32 v197, 16, v197
    v_lshlrev_b32 v198, 16, v198
    v_lshlrev_b32 v199, 16, v199
    v_lshlrev_b32 v200, 16, v200
    v_lshlrev_b32 v201, 16, v201
    v_lshlrev_b32 v202, 16, v202
    v_lshlrev_b32 v203, 16, v203
    v_lshlrev_b32 v204, 16, v204
    v_lshlrev_b32 v205, 16, v205
    v_lshlrev_b32 v206, 16, v206
    v_lshlrev_b32 v207, 16, v207
    s_waitcnt vmcnt(8)
    s_barrier
    ds_read_b128 v[32:35], v64 offset:0
    ds_read_b128 v[36:39], v64 offset:512
    ds_read_b128 v[40:43], v64 offset:1024
    ds_read_b128 v[44:47], v64 offset:1536
    ds_read_b128 v[48:51], v64 offset:2048
    ds_read_b128 v[52:55], v64 offset:2560
    s_waitcnt lgkmcnt(5)
    v_mfma_f32_32x32x16_bf16 v[192:207], v[32:35], a[0:3], v[192:207]
    ds_read_b128 v[56:59], v64 offset:3072
    s_add_u32 m0, s70, 16384
    s_mul_i32 s73, s96, 56
    s_add_u32 s73, s73, 114688
    buffer_load_dwordx4 v213, s[20:23], s73 offen lds
    s_waitcnt lgkmcnt(5)
    v_mfma_f32_32x32x16_bf16 v[192:207], v[36:39], a[4:7], v[192:207]
    ds_read_b128 v[60:63], v64 offset:3584
    s_waitcnt lgkmcnt(5)
    v_mfma_f32_32x32x16_bf16 v[192:207], v[40:43], a[8:11], v[192:207]
    ds_read_b128 v[32:35], v64 offset:4096
    s_waitcnt lgkmcnt(5)
    v_mfma_f32_32x32x16_bf16 v[192:207], v[44:47], a[12:15], v[192:207]
    ds_read_b128 v[36:39], v64 offset:4608
    s_add_u32 m0, s70, 17408
    s_mul_i32 s73, s96, 56
    s_add_u32 s73, s73, 143360
    buffer_load_dwordx4 v213, s[20:23], s73 offen lds
    s_waitcnt lgkmcnt(5)
    v_mfma_f32_32x32x16_bf16 v[192:207], v[48:51], a[16:19], v[192:207]
    ds_read_b128 v[40:43], v64 offset:5120
    s_waitcnt lgkmcnt(5)
    v_mfma_f32_32x32x16_bf16 v[192:207], v[52:55], a[20:23], v[192:207]
    ds_read_b128 v[44:47], v64 offset:5632
    s_waitcnt lgkmcnt(5)
    v_mfma_f32_32x32x16_bf16 v[192:207], v[56:59], a[24:27], v[192:207]
    ds_read_b128 v[48:51], v64 offset:6144
    s_add_u32 m0, s70, 18432
    s_mul_i32 s73, s96, 56
    s_add_u32 s73, s73, 172032
    buffer_load_dwordx4 v213, s[20:23], s73 offen lds
    s_waitcnt lgkmcnt(5)
    v_mfma_f32_32x32x16_bf16 v[192:207], v[60:63], a[28:31], v[192:207]
    ds_read_b128 v[52:55], v64 offset:6656
    s_waitcnt lgkmcnt(5)
    v_mfma_f32_32x32x16_bf16 v[192:207], v[32:35], a[32:35], v[192:207]
    ds_read_b128 v[56:59], v64 offset:7168
    s_waitcnt lgkmcnt(5)
    v_mfma_f32_32x32x16_bf16 v[192:207], v[36:39], a[36:39], v[192:207]
    ds_read_b128 v[60:63], v64 offset:7680
    s_add_u32 m0, s70, 19456
    s_mul_i32 s73, s96, 56
    s_add_u32 s73, s73, 200704
    buffer_load_dwordx4 v213, s[20:23], s73 offen lds
    s_waitcnt lgkmcnt(5)
    v_mfma_f32_32x32x16_bf16 v[192:207], v[40:43], a[40:43], v[192:207]
    s_waitcnt lgkmcnt(4)
    v_mfma_f32_32x32x16_bf16 v[192:207], v[44:47], a[44:47], v[192:207]
    s_waitcnt vmcnt(4)
    s_barrier
    ds_read_b128 v[32:35], v64 offset:8192
    ds_read_b128 v[36:39], v64 offset:8704
    s_waitcnt lgkmcnt(5)
    v_mfma_f32_32x32x16_bf16 v[192:207], v[48:51], a[48:51], v[192:207]
    ds_read_b128 v[40:43], v64 offset:9216
    s_add_u32 m0, s70, 20480
    s_mul_i32 s73, s97, 56
    s_add_u32 s73, s73, 0
    buffer_load_dwordx4 v213, s[20:23], s73 offen lds
    s_waitcnt lgkmcnt(5)
    v_mfma_f32_32x32x16_bf16 v[192:207], v[52:55], a[52:55], v[192:207]
    ds_read_b128 v[44:47], v64 offset:9728
    s_waitcnt lgkmcnt(5)
    v_mfma_f32_32x32x16_bf16 v[192:207], v[56:59], a[56:59], v[192:207]
    ds_read_b128 v[48:51], v64 offset:10240
    s_waitcnt lgkmcnt(5)
    v_mfma_f32_32x32x16_bf16 v[192:207], v[60:63], a[60:63], v[192:207]
    ds_read_b128 v[52:55], v64 offset:10752
    s_add_u32 m0, s70, 21504
    s_mul_i32 s73, s97, 56
    s_add_u32 s73, s73, 28672
    buffer_load_dwordx4 v213, s[20:23], s73 offen lds
    s_waitcnt lgkmcnt(5)
    v_mfma_f32_32x32x16_bf16 v[192:207], v[32:35], a[64:67], v[192:207]
    ds_read_b128 v[56:59], v64 offset:11264
    s_waitcnt lgkmcnt(5)
    v_mfma_f32_32x32x16_bf16 v[192:207], v[36:39], a[68:71], v[192:207]
    ds_read_b128 v[60:63], v64 offset:11776
    s_waitcnt lgkmcnt(5)
    v_mfma_f32_32x32x16_bf16 v[192:207], v[40:43], a[72:75], v[192:207]
    ds_read_b128 v[32:35], v64 offset:12288
    s_add_u32 m0, s70, 22528
    s_mul_i32 s73, s97, 56
    s_add_u32 s73, s73, 57344
    buffer_load_dwordx4 v213, s[20:23], s73 offen lds
    s_waitcnt lgkmcnt(5)
    v_mfma_f32_32x32x16_bf16 v[192:207], v[44:47], a[76:79], v[192:207]
    ds_read_b128 v[36:39], v64 offset:12800
    s_waitcnt lgkmcnt(5)
    v_mfma_f32_32x32x16_bf16 v[192:207], v[48:51], a[80:83], v[192:207]
    ds_read_b128 v[40:43], v64 offset:13312
    s_waitcnt lgkmcnt(5)
    v_mfma_f32_32x32x16_bf16 v[192:207], v[52:55], a[84:87], v[192:207]
    ds_read_b128 v[44:47], v64 offset:13824
    s_add_u32 m0, s70, 23552
    s_mul_i32 s73, s97, 56
    s_add_u32 s73, s73, 86016
    buffer_load_dwordx4 v213, s[20:23], s73 offen lds
    s_waitcnt lgkmcnt(5)
    v_mfma_f32_32x32x16_bf16 v[192:207], v[56:59], a[88:91], v[192:207]
    ds_read_b128 v[48:51], v64 offset:14336
    s_waitcnt lgkmcnt(5)
    v_mfma_f32_32x32x16_bf16 v[192:207], v[60:63], a[92:95], v[192:207]
    ds_read_b128 v[52:55], v64 offset:14848
    s_waitcnt lgkmcnt(5)
    v_mfma_f32_32x32x16_bf16 v[192:207], v[32:35], a[96:99], v[192:207]
    ds_read_b128 v[56:59], v64 offset:15360
    s_waitcnt lgkmcnt(5)
    v_mfma_f32_32x32x16_bf16 v[192:207], v[36:39], a[100:103], v[192:207]
    ds_read_b128 v[60:63], v64 offset:15872
    s_waitcnt lgkmcnt(5)
    v_mfma_f32_32x32x16_bf16 v[192:207], v[40:43], a[104:107], v[192:207]
    s_waitcnt lgkmcnt(4)
    v_mfma_f32_32x32x16_bf16 v[192:207], v[44:47], a[108:111], v[192:207]
    s_waitcnt lgkmcnt(3)
    v_mfma_f32_32x32x16_bf16 v[192:207], v[48:51], a[112:115], v[192:207]
    s_waitcnt lgkmcnt(2)
    v_mfma_f32_32x32x16_bf16 v[192:207], v[52:55], a[116:119], v[192:207]
    s_waitcnt lgkmcnt(1)
    v_mfma_f32_32x32x16_bf16 v[192:207], v[56:59], a[120:123], v[192:207]
    s_waitcnt lgkmcnt(0)
    v_mfma_f32_32x32x16_bf16 v[192:207], v[60:63], a[124:127], v[192:207]
    s_nop 11
    v_pk_mul_f32 v[68:69], v[192:193], v[192:193]
    v_pk_mul_f32 v[70:71], v[194:195], v[194:195]
    v_pk_mul_f32 v[72:73], v[196:197], v[196:197]
    v_pk_mul_f32 v[74:75], v[198:199], v[198:199]
    v_pk_mul_f32 v[76:77], v[200:201], v[200:201]
    v_pk_mul_f32 v[78:79], v[202:203], v[202:203]
    v_pk_mul_f32 v[80:81], v[204:205], v[204:205]
    v_pk_mul_f32 v[82:83], v[206:207], v[206:207]
    v_add_f32_dpp v84, v192, v192 row_mirror row_mask:0xf bank_mask:0x3
    v_add_f32_dpp v85, v193, v193 row_mirror row_mask:0xf bank_mask:0x3
    v_add_f32_dpp v86, v196, v196 row_mirror row_mask:0xf bank_mask:0x3
    v_add_f32_dpp v87, v197, v197 row_mirror row_mask:0xf bank_mask:0x3
    v_add_f32_dpp v88, v200, v200 row_mirror row_mask:0xf bank_mask:0x3
    v_add_f32_dpp v89, v201, v201 row_mirror row_mask:0xf bank_mask:0x3
    v_add_f32_dpp v90, v204, v204 row_mirror row_mask:0xf bank_mask:0x3
    v_add_f32_dpp v91, v205, v205 row_mirror row_mask:0xf bank_mask:0x3
    v_add_f32_dpp v92, v68, v68 row_mirror row_mask:0xf bank_mask:0x3
    v_add_f32_dpp v93, v69, v69 row_mirror row_mask:0xf bank_mask:0x3
    v_add_f32_dpp v94, v72, v72 row_mirror row_mask:0xf bank_mask:0x3
    v_add_f32_dpp v95, v73, v73 row_mirror row_mask:0xf bank_mask:0x3
    v_add_f32_dpp v96, v76, v76 row_mirror row_mask:0xf bank_mask:0x3
    v_add_f32_dpp v97, v77, v77 row_mirror row_mask:0xf bank_mask:0x3
    v_add_f32_dpp v98, v80, v80 row_mirror row_mask:0xf bank_mask:0x3
    v_add_f32_dpp v99, v81, v81 row_mirror row_mask:0xf bank_mask:0x3
    v_add_f32_dpp v84, v194, v194 row_mirror row_mask:0xf bank_mask:0xc
    v_add_f32_dpp v85, v195, v195 row_mirror row_mask:0xf bank_mask:0xc
    v_add_f32_dpp v86, v198, v198 row_mirror row_mask:0xf bank_mask:0xc
    v_add_f32_dpp v87, v199, v199 row_mirror row_mask:0xf bank_mask:0xc
    v_add_f32_dpp v88, v202, v202 row_mirror row_mask:0xf bank_mask:0xc
    v_add_f32_dpp v89, v203, v203 row_mirror row_mask:0xf bank_mask:0xc
    v_add_f32_dpp v90, v206, v206 row_mirror row_mask:0xf bank_mask:0xc
    v_add_f32_dpp v91, v207, v207 row_mirror row_mask:0xf bank_mask:0xc
    v_add_f32_dpp v92, v70, v70 row_mirror row_mask:0xf bank_mask:0xc
    v_add_f32_dpp v93, v71, v71 row_mirror row_mask:0xf bank_mask:0xc
    v_add_f32_dpp v94, v74, v74 row_mirror row_mask:0xf bank_mask:0xc
    v_add_f32_dpp v95, v75, v75 row_mirror row_mask:0xf bank_mask:0xc
    v_add_f32_dpp v96, v78, v78 row_mirror row_mask:0xf bank_mask:0xc
    v_add_f32_dpp v97, v79, v79 row_mirror row_mask:0xf bank_mask:0xc
    v_add_f32_dpp v98, v82, v82 row_mirror row_mask:0xf bank_mask:0xc
    v_add_f32_dpp v99, v83, v83 row_mirror row_mask:0xf bank_mask:0xc
    v_add_f32_dpp v84, v84, v84 row_half_mirror row_mask:0xf bank_mask:0x5
    v_add_f32_dpp v86, v86, v86 row_half_mirror row_mask:0xf bank_mask:0x5
    v_add_f32_dpp v88, v88, v88 row_half_mirror row_mask:0xf bank_mask:0x5
    v_add_f32_dpp v90, v90, v90 row_half_mirror row_mask:0xf bank_mask:0x5
    v_add_f32_dpp v92, v92, v92 row_half_mirror row_mask:0xf bank_mask:0x5
    v_add_f32_dpp v94, v94, v94 row_half_mirror row_mask:0xf bank_mask:0x5
    v_add_f32_dpp v96, v96, v96 row_half_mirror row_mask:0xf bank_mask:0x5
    v_add_f32_dpp v98, v98, v98 row_half_mirror row_mask:0xf bank_mask:0x5
    v_add_f32_dpp v84, v85, v85 row_half_mirror row_mask:0xf bank_mask:0xa
    v_add_f32_dpp v86, v87, v87 row_half_mirror row_mask:0xf bank_mask:0xa
    v_add_f32_dpp v88, v89, v89 row_half_mirror row_mask:0xf bank_mask:0xa
    v_add_f32_dpp v90, v91, v91 row_half_mirror row_mask:0xf bank_mask:0xa
    v_add_f32_dpp v92, v93, v93 row_half_mirror row_mask:0xf bank_mask:0xa
    v_add_f32_dpp v94, v95, v95 row_half_mirror row_mask:0xf bank_mask:0xa
    v_add_f32_dpp v96, v97, v97 row_half_mirror row_mask:0xf bank_mask:0xa
    v_add_f32_dpp v98, v99, v99 row_half_mirror row_mask:0xf bank_mask:0xa
    v_add_f32_dpp v85, v84, v84 quad_perm:[1,0,3,2] row_mask:0xf bank_mask:0xf
    v_add_f32_dpp v87, v86, v86 quad_perm:[1,0,3,2] row_mask:0xf bank_mask:0xf
    v_add_f32_dpp v89, v88, v88 quad_perm:[1,0,3,2] row_mask:0xf bank_mask:0xf
    v_add_f32_dpp v91, v90, v90 quad_perm:[1,0,3,2] row_mask:0xf bank_mask:0xf
    v_add_f32_dpp v93, v92, v92 quad_perm:[1,0,3,2] row_mask:0xf bank_mask:0xf
    v_add_f32_dpp v95, v94, v94 quad_perm:[1,0,3,2] row_mask:0xf bank_mask:0xf
    v_add_f32_dpp v97, v96, v96 quad_perm:[1,0,3,2] row_mask:0xf bank_mask:0xf
    v_add_f32_dpp v99, v98, v98 quad_perm:[1,0,3,2] row_mask:0xf bank_mask:0xf
    v_add_f32_dpp v68, v85, v85 quad_perm:[2,3,0,1] row_mask:0xf bank_mask:0xf
    v_add_f32_dpp v69, v87, v87 quad_perm:[2,3,0,1] row_mask:0xf bank_mask:0xf
    v_add_f32_dpp v70, v89, v89 quad_perm:[2,3,0,1] row_mask:0xf bank_mask:0xf
    v_add_f32_dpp v71, v91, v91 quad_perm:[2,3,0,1] row_mask:0xf bank_mask:0xf
    v_add_f32_dpp v72, v93, v93 quad_perm:[2,3,0,1] row_mask:0xf bank_mask:0xf
    v_add_f32_dpp v73, v95, v95 quad_perm:[2,3,0,1] row_mask:0xf bank_mask:0xf
    v_add_f32_dpp v74, v97, v97 quad_perm:[2,3,0,1] row_mask:0xf bank_mask:0xf
    v_add_f32_dpp v75, v99, v99 quad_perm:[2,3,0,1] row_mask:0xf bank_mask:0xf
    v_permlane16_swap_b32 v68, v69
    v_permlane16_swap_b32 v70, v71
    v_permlane16_swap_b32 v72, v73
    v_permlane16_swap_b32 v74, v75
    v_add_f32 v84, v68, v69
    v_add_f32 v85, v72, v73
    v_add_f32 v86, v70, v71
    v_add_f32 v87, v74, v75
    v_and_b32 v65, 1, v3
    v_lshlrev_b32 v65, 6, v65
    v_lshrrev_b32 v66, 5, v1
    v_lshl_add_u32 v65, v66, 5, v65
    v_bfe_u32 v67, v1, 2, 2
    v_lshl_add_u32 v65, v67, 3, v65
    s_lshl_b32 s58, s3, 8
    v_add_u32 v65, s58, v65
    ds_write_b64 v65, v[84:85] offset:0
    ds_write_b64 v65, v[86:87] offset:128
    v_and_b32 v67, 31, v1
    v_lshlrev_b32 v65, 9, v66
    v_lshl_add_u32 v65, v67, 4, v65
    v_lshlrev_b32 v66, 8, v66
    v_lshl_add_u32 v66, v67, 3, v66
    s_and_b32 s58, s58, 512
    v_add_u32 v66, s58, v66
    s_lshl_b32 s58, s67, 1
    s_lshr_b32 s60, s3, 1
    s_add_u32 s58, s58, s60
    s_lshl_b32 s58, s58, 12
    s_add_u32 s58, s58, 0x548000
    s_lshl_b32 s60, s66, 9
    s_add_u32 s60, s60, s58
    s_waitcnt lgkmcnt(0)
    s_barrier
    ds_read_b64 v[84:85], v66 offset:0
    v_mov_b32 v89, s4
    v_mov_b32 v91, s4
    s_waitcnt lgkmcnt(0)
    v_mov_b32 v88, v84
    v_mov_b32 v90, v85
    s_nop 0
    v_permlane32_swap_b32 v88, v84
    v_permlane32_swap_b32 v90, v85
    v_add_f32 v88, v88, v84
    v_add_f32 v90, v90, v85
    s_bitcmp0_b32 s3, 0
    s_cselect_b32 exec_lo, -1, 0
    s_mov_b32 exec_hi, 0
    buffer_store_dwordx4 v[88:91], v65, s[40:43], s60 offen sc1
    s_mov_b64 exec, -1
    v_cvt_pk_bf16_f32 v240, v192, v193
    v_cvt_pk_bf16_f32 v241, v194, v195
    v_cvt_pk_bf16_f32 v242, v196, v197
    v_cvt_pk_bf16_f32 v243, v198, v199
    v_cvt_pk_bf16_f32 v244, v200, v201
    v_cvt_pk_bf16_f32 v245, v202, v203
    v_cvt_pk_bf16_f32 v246, v204, v205
    v_cvt_pk_bf16_f32 v247, v206, v207
    s_lshl_b32 s61, s66, 1
    s_and_b32 s60, s3, 1
    s_add_u32 s61, s61, s60
    s_lshl_b32 s61, s61, 7
    s_lshl_b32 s60, s67, 2
    s_add_u32 s61, s61, s60
    s_and_b32 s60, s3, 2
    s_add_u32 s61, s61, s60
    s_lshl_b32 s61, s61, 10
    s_add_u32 s61, s61, 0x200000
    v_lshlrev_b32 v66, 4, v67
    v_cmp_gt_u32 s[86:87], 32, v1
    s_add_u32 m0, s70, 0
    s_mul_i32 s73, s97, 56
    s_add_u32 s73, s73, 114688
    buffer_load_dwordx4 v213, s[20:23], s73 offen lds
    s_add_u32 m0, s70, 1024
    s_mul_i32 s73, s97, 56
    s_add_u32 s73, s73, 143360
    buffer_load_dwordx4 v213, s[20:23], s73 offen lds
    s_add_u32 m0, s70, 2048
    s_mul_i32 s73, s97, 56
    s_add_u32 s73, s73, 172032
    buffer_load_dwordx4 v213, s[20:23], s73 offen lds
    s_add_u32 m0, s70, 3072
    s_mul_i32 s73, s97, 56
    s_add_u32 s73, s73, 200704
    buffer_load_dwordx4 v213, s[20:23], s73 offen lds
    s_add_u32 m0, s70, 4096
    s_mul_i32 s73, s98, 56
    s_add_u32 s73, s73, 0
    buffer_load_dwordx4 v213, s[20:23], s73 offen lds
    s_add_u32 m0, s70, 5120
    s_mul_i32 s73, s98, 56
    s_add_u32 s73, s73, 28672
    buffer_load_dwordx4 v213, s[20:23], s73 offen lds
    s_add_u32 m0, s70, 6144
    s_mul_i32 s73, s98, 56
    s_add_u32 s73, s73, 57344
    buffer_load_dwordx4 v213, s[20:23], s73 offen lds
    s_add_u32 m0, s70, 7168
    s_mul_i32 s73, s98, 56
    s_add_u32 s73, s73, 86016
    buffer_load_dwordx4 v213, s[20:23], s73 offen lds
    s_add_u32 m0, s70, 8192
    s_mul_i32 s73, s98, 56
    s_add_u32 s73, s73, 114688
    buffer_load_dwordx4 v213, s[20:23], s73 offen lds
    s_add_u32 m0, s70, 9216
    s_mul_i32 s73, s98, 56
    s_add_u32 s73, s73, 143360
    buffer_load_dwordx4 v213, s[20:23], s73 offen lds
    s_add_u32 m0, s70, 10240
    s_mul_i32 s73, s98, 56
    s_add_u32 s73, s73, 172032
    buffer_load_dwordx4 v213, s[20:23], s73 offen lds
    s_add_u32 m0, s70, 11264
    s_mul_i32 s73, s98, 56
    s_add_u32 s73, s73, 200704
    buffer_load_dwordx4 v213, s[20:23], s73 offen lds
    s_add_u32 m0, s70, 12288
    s_mul_i32 s73, s99, 56
    s_add_u32 s73, s73, 0
    buffer_load_dwordx4 v213, s[20:23], s73 offen lds
    s_add_u32 m0, s70, 13312
    s_mul_i32 s73, s99, 56
    s_add_u32 s73, s73, 28672
    buffer_load_dwordx4 v213, s[20:23], s73 offen lds
    s_add_u32 m0, s70, 14336
    s_mul_i32 s73, s99, 56
    s_add_u32 s73, s73, 57344
    buffer_load_dwordx4 v213, s[20:23], s73 offen lds
    s_add_u32 m0, s70, 15360
    s_mul_i32 s73, s99, 56
    s_add_u32 s73, s73, 86016
    buffer_load_dwordx4 v213, s[20:23], s73 offen lds
    buffer_load_dwordx4 v[96:99], v65, s[40:43], s58 offen offset:0 sc1
    buffer_load_dwordx4 v[100:103], v65, s[40:43], s58 offen offset:1024 sc1
    buffer_load_dwordx4 v[104:107], v65, s[40:43], s58 offen offset:2048 sc1
    buffer_load_dwordx4 v[108:111], v66, s[40:43], s58 offen offset:3072 sc1
    s_sleep 5
    s_nop 0
Lst_P_6:
    s_sub_u32 s6, s6, 1
    s_cbranch_scc1 L_end_P
    buffer_load_dwordx4 v[112:115], v65, s[40:43], s58 offen offset:0 sc1
    buffer_load_dwordx4 v[116:119], v65, s[40:43], s58 offen offset:1024 sc1
    buffer_load_dwordx4 v[120:123], v65, s[40:43], s58 offen offset:2048 sc1
    buffer_load_dwordx4 v[124:127], v66, s[40:43], s58 offen offset:3072 sc1
    s_waitcnt vmcnt(4)
    v_xor_b32 v97, s4, v97
    v_xor_b32 v99, s4, v99
    v_xor_b32 v101, s4, v101
    v_xor_b32 v103, s4, v103
    v_xor_b32 v105, s4, v105
    v_xor_b32 v107, s4, v107
    v_xor_b32 v109, s4, v109
    v_xor_b32 v111, s4, v111
    v_cndmask_b32 v108, 0, v108, s[86:87]
    v_cndmask_b32 v110, 0, v110, s[86:87]
    v_or3_b32 v97, v97, v99, v101
    v_or3_b32 v103, v103, v105, v107
    v_or3_b32 v97, v97, v109, v111
    v_or_b32 v97, v97, v103
    v_cmp_ne_u32 vcc, 0, v97
    v_add_f32 v128, v96, v100
    v_add_f32 v129, v104, v108
    v_add_f32 v130, v98, v102
    v_add_f32 v131, v106, v110
    s_cbranch_vccz Lstd_P_7
    buffer_load_dwordx4 v[96:99], v65, s[40:43], s58 offen offset:0 sc1
    buffer_load_dwordx4 v[100:103], v65, s[40:43], s58 offen offset:1024 sc1
    buffer_load_dwordx4 v[104:107], v65, s[40:43], s58 offen offset:2048 sc1
    buffer_load_dwordx4 v[108:111], v66, s[40:43], s58 offen offset:3072 sc1
    s_waitcnt vmcnt(4)
    v_xor_b32 v113, s4, v113
    v_xor_b32 v115, s4, v115
    v_xor_b32 v117, s4, v117
    v_xor_b32 v119, s4, v119
    v_xor_b32 v121, s4, v121
    v_xor_b32 v123, s4, v123
    v_xor_b32 v125, s4, v125
    v_xor_b32 v127, s4, v127
    v_cndmask_b32 v124, 0, v124, s[86:87]
    v_cndmask_b32 v126, 0, v126, s[86:87]
    v_or3_b32 v113, v113, v115, v117
    v_or3_b32 v119, v119, v121, v123
    v_or3_b32 v113, v113, v125, v127
    v_or_b32 v113, v113, v119
    v_cmp_ne_u32 vcc, 0, v113
    v_add_f32 v128, v112, v116
    v_add_f32 v129, v120, v124
    v_add_f32 v130, v114, v118
    v_add_f32 v131, v122, v126
    s_cbranch_vccnz Lst_P_6
    s_nop 3
Lstd_P_7:
    v_add_f32 v128, v128, v129
    v_add_f32 v130, v130, v131
    v_mov_b32 v136, v128
    v_mov_b32 v138, v130
    s_nop 0
    v_permlane32_swap_b32 v128, v136
    v_permlane32_swap_b32 v130, v138
    v_add_f32 v128, v128, v136
    v_add_f32 v130, v130, v138
    v_mul_f32 v133, 0x3b124925, v128
    v_mul_f32 v130, 0x3b124925, v130
    v_fma_f32 v130, -v133, v133, v130
    v_max_f32 v130, 0, v130
    v_add_f32 v135, 0x3727c5ac, v130
    v_rsq_f32 v135, v135
    s_nop 0
    v_mul_f32 v130, v130, v135
    v_fmaak_f32 v130, v130, v135, 0x3727c5ac
    v_rsq_f32 v130, v130
    s_nop 0
    v_mul_f32 v135, v135, v130
    s_lshl_b32 s60, s3, 8
    v_lshl_add_u32 v66, v67, 2, s60
    ds_write_b32 v66, v133 offset:1024
    ds_write_b32 v66, v135 offset:1152
    v_lshrrev_b32 v66, 5, v1
    v_lshl_add_u32 v66, v66, 4, s60
    s_waitcnt lgkmcnt(0)
    ds_read_b128 v[140:143], v66 offset:1024
    ds_read_b128 v[156:159], v66 offset:1152
    ds_read_b128 v[144:147], v66 offset:1056
    ds_read_b128 v[160:163], v66 offset:1184
    ds_read_b128 v[148:151], v66 offset:1088
    ds_read_b128 v[164:167], v66 offset:1216
    ds_read_b128 v[152:155], v66 offset:1120
    ds_read_b128 v[168:171], v66 offset:1248
    s_waitcnt lgkmcnt(7)
    v_pk_add_f32 v[192:193], v[192:193], v[140:141] neg_lo:[0,1] neg_hi:[0,1]
    v_pk_add_f32 v[194:195], v[194:195], v[142:143] neg_lo:[0,1] neg_hi:[0,1]
    s_waitcnt lgkmcnt(5)
    v_pk_add_f32 v[196:197], v[196:197], v[144:145] neg_lo:[0,1] neg_hi:[0,1]
    v_pk_add_f32 v[198:199], v[198:199], v[146:147] neg_lo:[0,1] neg_hi:[0,1]
    v_pk_mul_f32 v[192:193], v[192:193], v[156:157]
    v_pk_mul_f32 v[194:195], v[194:195], v[158:159]
    s_waitcnt lgkmcnt(4)
    v_pk_mul_f32 v[196:197], v[196:197], v[160:161]
    v_pk_mul_f32 v[198:199], v[198:199], v[162:163]
    v_cvt_pk_bf16_f32 v84, v192, v193
    v_cvt_pk_bf16_f32 v85, v194, v195
    v_cvt_pk_bf16_f32 v86, v196, v197
    v_cvt_pk_bf16_f32 v87, v198, v199
    buffer_store_dwordx4 v[84:87], v4, s[40:43], s61 offen offset:0 sc1
    s_waitcnt lgkmcnt(3)
    v_pk_add_f32 v[200:201], v[200:201], v[148:149] neg_lo:[0,1] neg_hi:[0,1]
    v_pk_add_f32 v[202:203], v[202:203], v[150:151] neg_lo:[0,1] neg_hi:[0,1]
    s_waitcnt lgkmcnt(1)
    v_pk_add_f32 v[204:205], v[204:205], v[152:153] neg_lo:[0,1] neg_hi:[0,1]
    v_pk_add_f32 v[206:207], v[206:207], v[154:155] neg_lo:[0,1] neg_hi:[0,1]
    v_pk_mul_f32 v[200:201], v[200:201], v[164:165]
    v_pk_mul_f32 v[202:203], v[202:203], v[166:167]
    s_waitcnt lgkmcnt(0)
    v_pk_mul_f32 v[204:205], v[204:205], v[168:169]
    v_pk_mul_f32 v[206:207], v[206:207], v[170:171]
    v_cvt_pk_bf16_f32 v88, v200, v201
    v_cvt_pk_bf16_f32 v89, v202, v203
    v_cvt_pk_bf16_f32 v90, v204, v205
    v_cvt_pk_bf16_f32 v91, v206, v207
    buffer_store_dwordx4 v[88:91], v4, s[40:43], s61 offen offset:1024 sc1
    ds_read_b64_tr_b16 a[208:209], v215 offset:16384
    ds_read_b64_tr_b16 a[210:211], v215 offset:17408
    ds_read_b64_tr_b16 a[212:213], v216 offset:16384
    ds_read_b64_tr_b16 a[214:215], v216 offset:17408
    ds_read_b64_tr_b16 a[216:217], v215 offset:18432
    ds_read_b64_tr_b16 a[218:219], v215 offset:19456
    ds_read_b64_tr_b16 a[220:221], v216 offset:18432
    ds_read_b64_tr_b16 a[222:223], v216 offset:19456
    ds_read_b64_tr_b16 a[224:225], v215 offset:20480
    ds_read_b64_tr_b16 a[226:227], v215 offset:21504
    ds_read_b64_tr_b16 a[228:229], v216 offset:20480
    ds_read_b64_tr_b16 a[230:231], v216 offset:21504
    ds_read_b64_tr_b16 a[232:233], v215 offset:22528
    ds_read_b64_tr_b16 a[234:235], v215 offset:23552
    ds_read_b64_tr_b16 a[236:237], v216 offset:22528
    ds_read_b64_tr_b16 a[238:239], v216 offset:23552
    ds_read_b64_tr_b16 a[240:241], v215 offset:0
    ds_read_b64_tr_b16 a[242:243], v215 offset:1024
    ds_read_b64_tr_b16 a[244:245], v216 offset:0
    ds_read_b64_tr_b16 a[246:247], v216 offset:1024
    ds_read_b64_tr_b16 a[248:249], v215 offset:2048
    ds_read_b64_tr_b16 a[250:251], v215 offset:3072
    ds_read_b64_tr_b16 a[252:253], v216 offset:2048
    ds_read_b64_tr_b16 a[254:255], v216 offset:3072
    ds_read_b64_tr_b16 a[0:1], v215 offset:4096
    ds_read_b64_tr_b16 a[2:3], v215 offset:5120
    ds_read_b64_tr_b16 a[4:5], v216 offset:4096
    ds_read_b64_tr_b16 a[6:7], v216 offset:5120
    ds_read_b64_tr_b16 a[8:9], v215 offset:6144
    ds_read_b64_tr_b16 a[10:11], v215 offset:7168
    ds_read_b64_tr_b16 a[12:13], v216 offset:6144
    ds_read_b64_tr_b16 a[14:15], v216 offset:7168
    ds_read_b64_tr_b16 a[16:17], v215 offset:8192
    ds_read_b64_tr_b16 a[18:19], v215 offset:9216
    ds_read_b64_tr_b16 a[20:21], v216 offset:8192
    ds_read_b64_tr_b16 a[22:23], v216 offset:9216
    ds_read_b64_tr_b16 a[24:25], v215 offset:10240
    ds_read_b64_tr_b16 a[26:27], v215 offset:11264
    ds_read_b64_tr_b16 a[28:29], v216 offset:10240
    ds_read_b64_tr_b16 a[30:31], v216 offset:11264
    ds_read_b64_tr_b16 a[32:33], v215 offset:12288
    ds_read_b64_tr_b16 a[34:35], v215 offset:13312
    ds_read_b64_tr_b16 a[36:37], v216 offset:12288
    ds_read_b64_tr_b16 a[38:39], v216 offset:13312
    ds_read_b64_tr_b16 a[40:41], v215 offset:14336
    ds_read_b64_tr_b16 a[42:43], v215 offset:15360
    ds_read_b64_tr_b16 a[44:45], v216 offset:14336
    ds_read_b64_tr_b16 a[46:47], v216 offset:15360
    s_waitcnt vmcnt(0)
    v_mov_b32 v8, s4
    s_mov_b64 exec, 1
    buffer_store_dword v8, v9, s[40:43], s81 offen sc1
    s_mov_b64 exec, -1
    s_waitcnt lgkmcnt(4)
    s_add_u32 m0, s70, 12288
    s_mul_i32 s73, s99, 56
    s_add_u32 s73, s73, 114688
    buffer_load_dwordx4 v213, s[20:23], s73 offen lds
    s_add_u32 m0, s70, 13312
    s_mul_i32 s73, s99, 56
    s_add_u32 s73, s73, 143360
    buffer_load_dwordx4 v213, s[20:23], s73 offen lds
    s_waitcnt lgkmcnt(0)
    s_add_u32 m0, s70, 14336
    s_mul_i32 s73, s99, 56
    s_add_u32 s73, s73, 172032
    buffer_load_dwordx4 v213, s[20:23], s73 offen lds
    s_add_u32 m0, s70, 15360
    s_mul_i32 s73, s99, 56
    s_add_u32 s73, s73, 200704
    buffer_load_dwordx4 v213, s[20:23], s73 offen lds
    s_add_u32 m0, s70, 16384
    s_mul_i32 s73, s100, 56
    s_add_u32 s73, s73, 0
    buffer_load_dwordx4 v213, s[20:23], s73 offen lds
    s_add_u32 m0, s70, 17408
    s_mul_i32 s73, s100, 56
    s_add_u32 s73, s73, 28672
    buffer_load_dwordx4 v213, s[20:23], s73 offen lds
    s_add_u32 m0, s70, 18432
    s_mul_i32 s73, s100, 56
    s_add_u32 s73, s73, 57344
    buffer_load_dwordx4 v213, s[20:23], s73 offen lds
    s_add_u32 m0, s70, 19456
    s_mul_i32 s73, s100, 56
    s_add_u32 s73, s73, 86016
    buffer_load_dwordx4 v213, s[20:23], s73 offen lds
    s_add_u32 m0, s70, 20480
    s_mul_i32 s73, s100, 56
    s_add_u32 s73, s73, 114688
    buffer_load_dwordx4 v213, s[20:23], s73 offen lds
    s_add_u32 m0, s70, 21504
    s_mul_i32 s73, s100, 56
    s_add_u32 s73, s73, 143360
    buffer_load_dwordx4 v213, s[20:23], s73 offen lds
    s_add_u32 m0, s70, 22528
    s_mul_i32 s73, s100, 56
    s_add_u32 s73, s73, 172032
    buffer_load_dwordx4 v213, s[20:23], s73 offen lds
    s_add_u32 m0, s70, 23552
    s_mul_i32 s73, s100, 56
    s_add_u32 s73, s73, 200704
    buffer_load_dwordx4 v213, s[20:23], s73 offen lds
    s_add_u32 m0, s70, 24576
    s_mul_i32 s73, s101, 56
    s_add_u32 s73, s73, 0
    buffer_load_dwordx4 v213, s[20:23], s73 offen lds
    s_add_u32 m0, s70, 25600
    s_mul_i32 s73, s101, 56
    s_add_u32 s73, s73, 28672
    buffer_load_dwordx4 v213, s[20:23], s73 offen lds
    s_add_u32 m0, s70, 26624
    s_mul_i32 s73, s101, 56
    s_add_u32 s73, s73, 57344
    buffer_load_dwordx4 v213, s[20:23], s73 offen lds
    s_add_u32 m0, s70, 27648
    s_mul_i32 s73, s101, 56
    s_add_u32 s73, s73, 86016
    buffer_load_dwordx4 v213, s[20:23], s73 offen lds
    s_add_u32 m0, s70, 28672
    s_mul_i32 s73, s101, 56
    s_add_u32 s73, s73, 114688
    buffer_load_dwordx4 v213, s[20:23], s73 offen lds
    s_add_u32 m0, s70, 29696
    s_mul_i32 s73, s101, 56
    s_add_u32 s73, s73, 143360
    buffer_load_dwordx4 v213, s[20:23], s73 offen lds
    s_add_u32 m0, s70, 30720
    s_mul_i32 s73, s101, 56
    s_add_u32 s73, s73, 172032
    buffer_load_dwordx4 v213, s[20:23], s73 offen lds
    s_add_u32 m0, s70, 31744
    s_mul_i32 s73, s101, 56
    s_add_u32 s73, s73, 200704
    buffer_load_dwordx4 v213, s[20:23], s73 offen lds
    s_add_u32 m0, s70, 32768
    s_mul_i32 s73, s48, 64
    s_add_u32 s73, s73, 0
    buffer_load_dwordx4 v214, s[24:27], s73 offen lds
    s_add_u32 m0, s70, 33792
    s_mul_i32 s73, s48, 64
    s_add_u32 s73, s73, 32768
    buffer_load_dwordx4 v214, s[24:27], s73 offen lds
    s_add_u32 m0, s70, 34816
    s_mul_i32 s73, s48, 64
    s_add_u32 s73, s73, 65536
    buffer_load_dwordx4 v214, s[24:27], s73 offen lds
    s_add_u32 m0, s70, 35840
    s_mul_i32 s73, s48, 64
    s_add_u32 s73, s73, 98304
    buffer_load_dwordx4 v214, s[24:27], s73 offen lds
    v_lshrrev_b32 v220, 5, v1
    v_lshlrev_b32 v220, 3, v220
    s_lshl_b32 s68, s65, 7
    s_lshr_b32 s69, s3, 1
    s_lshl_b32 s69, s69, 6
    s_add_u32 s68, s68, s69
    buffer_load_dwordx2 v[222:223], v220, s[28:31], s68 offen offset:0
    buffer_load_dwordx2 v[224:225], v220, s[28:31], s68 offen offset:16
    buffer_load_dwordx2 v[226:227], v220, s[28:31], s68 offen offset:32
    buffer_load_dwordx2 v[228:229], v220, s[28:31], s68 offen offset:48
    s_lshl_b32 s68, s64, 1
    s_and_b32 s69, s3, 1
    s_add_u32 s71, s68, s69
    s_xor_b32 s72, s71, 1
    s_mul_i32 s68, s3, 32768
    s_add_u32 s68, s68, 0x200000
    s_mul_i32 s71, s71, 131072
    s_add_u32 s71, s71, s68
    s_mul_i32 s72, s72, 131072
    s_add_u32 s72, s72, s68
    buffer_load_dword v249, v11, s[40:43], s84 offen sc1
    s_sleep 3
    buffer_load_dword v250, v11, s[40:43], s84 offen sc1
    s_sleep 3
    s_nop 0
Lpoll_P_8:
    s_sub_u32 s6, s6, 1
    s_cbranch_scc1 L_end_P
    buffer_load_dword v251, v11, s[40:43], s84 offen sc1
    s_waitcnt vmcnt(2)
    v_cmp_ne_u32 vcc, s4, v249
    s_nop 1
    s_cbranch_vccz Lpd_P_9
    buffer_load_dword v249, v11, s[40:43], s84 offen sc1
    s_waitcnt vmcnt(2)
    v_cmp_ne_u32 vcc, s4, v250
    s_nop 1
    s_cbranch_vccz Lpd_P_9
    buffer_load_dword v250, v11, s[40:43], s84 offen sc1
    s_waitcnt vmcnt(2)
    v_cmp_ne_u32 vcc, s4, v251
    s_nop 1
    s_cbranch_vccnz Lpoll_P_8
    s_nop 1
Lpd_P_9:
    s_add_u32 s56, s71, s94
    s_add_u32 s57, s72, s94
    buffer_load_dwordx4 v[80:83], v5, s[40:43], s56 offen offset:0 sc1
    buffer_load_dwordx4 v[84:87], v5, s[40:43], s57 offen offset:0 sc1
    buffer_load_dwordx4 v[88:91], v5, s[40:43], s56 offen offset:1024 sc1
    buffer_load_dwordx4 v[92:95], v5, s[40:43], s57 offen offset:1024 sc1
    buffer_load_dwordx4 v[96:99], v5, s[40:43], s56 offen offset:2048 sc1
    buffer_load_dwordx4 v[100:103], v5, s[40:43], s57 offen offset:2048 sc1
    buffer_load_dwordx4 v[104:107], v5, s[40:43], s56 offen offset:3072 sc1
    buffer_load_dwordx4 v[108:111], v5, s[40:43], s57 offen offset:3072 sc1
    s_add_u32 s56, s71, s95
    s_add_u32 s57, s72, s95
    buffer_load_dwordx4 v[112:115], v5, s[40:43], s56 offen offset:0 sc1
    buffer_load_dwordx4 v[116:119], v5, s[40:43], s57 offen offset:0 sc1
    buffer_load_dwordx4 v[120:123], v5, s[40:43], s56 offen offset:1024 sc1
    buffer_load_dwordx4 v[124:127], v5, s[40:43], s57 offen offset:1024 sc1
    v_lshlrev_b32 v16, 16, v222
    v_and_b32 v17, 0xffff0000, v222
    v_lshlrev_b32 v18, 16, v223
    v_and_b32 v19, 0xffff0000, v223
    v_lshlrev_b32 v20, 16, v224
    v_and_b32 v21, 0xffff0000, v224
    v_lshlrev_b32 v22, 16, v225
    v_and_b32 v23, 0xffff0000, v225
    v_lshlrev_b32 v24, 16, v226
    v_and_b32 v25, 0xffff0000, v226
    v_lshlrev_b32 v26, 16, v227
    v_and_b32 v27, 0xffff0000, v227
    v_lshlrev_b32 v28, 16, v228
    v_and_b32 v29, 0xffff0000, v228
    v_lshlrev_b32 v30, 16, v229
    v_and_b32 v31, 0xffff0000, v229
    ds_read_b64_tr_b16 a[48:49], v215 offset:12288
    ds_read_b64_tr_b16 a[50:51], v215 offset:13312
    ds_read_b64_tr_b16 a[52:53], v216 offset:12288
    ds_read_b64_tr_b16 a[54:55], v216 offset:13312
    ds_read_b64_tr_b16 a[56:57], v215 offset:14336
    ds_read_b64_tr_b16 a[58:59], v215 offset:15360
    ds_read_b64_tr_b16 a[60:61], v216 offset:14336
    ds_read_b64_tr_b16 a[62:63], v216 offset:15360
    ds_read_b64_tr_b16 a[64:65], v215 offset:16384
    ds_read_b64_tr_b16 a[66:67], v215 offset:17408
    ds_read_b64_tr_b16 a[68:69], v216 offset:16384
    ds_read_b64_tr_b16 a[70:71], v216 offset:17408
    ds_read_b64_tr_b16 a[72:73], v215 offset:18432
    ds_read_b64_tr_b16 a[74:75], v215 offset:19456
    ds_read_b64_tr_b16 a[76:77], v216 offset:18432
    ds_read_b64_tr_b16 a[78:79], v216 offset:19456
    ds_read_b64_tr_b16 a[80:81], v215 offset:20480
    ds_read_b64_tr_b16 a[82:83], v215 offset:21504
    ds_read_b64_tr_b16 a[84:85], v216 offset:20480
    ds_read_b64_tr_b16 a[86:87], v216 offset:21504
    ds_read_b64_tr_b16 a[88:89], v215 offset:22528
    ds_read_b64_tr_b16 a[90:91], v215 offset:23552
    ds_read_b64_tr_b16 a[92:93], v216 offset:22528
    ds_read_b64_tr_b16 a[94:95], v216 offset:23552
    ds_read_b64_tr_b16 a[96:97], v215 offset:24576
    ds_read_b64_tr_b16 a[98:99], v215 offset:25600
    ds_read_b64_tr_b16 a[100:101], v216 offset:24576
    ds_read_b64_tr_b16 a[102:103], v216 offset:25600
    ds_read_b64_tr_b16 a[104:105], v215 offset:26624
    ds_read_b64_tr_b16 a[106:107], v215 offset:27648
    ds_read_b64_tr_b16 a[108:109], v216 offset:26624
    ds_read_b64_tr_b16 a[110:111], v216 offset:27648
    ds_read_b64_tr_b16 a[112:113], v215 offset:28672
    ds_read_b64_tr_b16 a[114:115], v215 offset:29696
    ds_read_b64_tr_b16 a[116:117], v216 offset:28672
    ds_read_b64_tr_b16 a[118:119], v216 offset:29696
    ds_read_b64_tr_b16 a[120:121], v215 offset:30720
    ds_read_b64_tr_b16 a[122:123], v215 offset:31744
    ds_read_b64_tr_b16 a[124:125], v216 offset:30720
    ds_read_b64_tr_b16 a[126:127], v216 offset:31744
    buffer_load_dwordx4 v[128:131], v5, s[40:43], s56 offen offset:2048 sc1
    buffer_load_dwordx4 v[132:135], v5, s[40:43], s57 offen offset:2048 sc1
    buffer_load_dwordx4 v[136:139], v5, s[40:43], s56 offen offset:3072 sc1
    buffer_load_dwordx4 v[140:143], v5, s[40:43], s57 offen offset:3072 sc1
    s_waitcnt vmcnt(15)
    v_mfma_f32_32x32x16_bf16 v[16:31], a[128:131], v[80:83], v[16:31]
    s_waitcnt vmcnt(14)
    v_mfma_f32_32x32x16_bf16 v[32:47], a[128:131], v[84:87], 0
    v_mfma_f32_32x32x16_bf16 v[48:63], a[132:135], v[80:83], 0
    v_mfma_f32_32x32x16_bf16 v[64:79], a[132:135], v[84:87], 0
    s_add_u32 s56, s71, s96
    s_add_u32 s57, s72, s96
    buffer_load_dwordx4 v[144:147], v5, s[40:43], s56 offen offset:0 sc1
    buffer_load_dwordx4 v[148:151], v5, s[40:43], s57 offen offset:0 sc1
    buffer_load_dwordx4 v[152:155], v5, s[40:43], s56 offen offset:1024 sc1
    buffer_load_dwordx4 v[156:159], v5, s[40:43], s57 offen offset:1024 sc1
    s_waitcnt vmcnt(17)
    v_mfma_f32_32x32x16_bf16 v[16:31], a[136:139], v[88:91], v[16:31]
    s_waitcnt vmcnt(16)
    v_mfma_f32_32x32x16_bf16 v[32:47], a[136:139], v[92:95], v[32:47]
    v_mfma_f32_32x32x16_bf16 v[48:63], a[140:143], v[88:91], v[48:63]
    v_mfma_f32_32x32x16_bf16 v[64:79], a[140:143], v[92:95], v[64:79]
    buffer_load_dwordx4 v[160:163], v5, s[40:43], s56 offen offset:2048 sc1
    buffer_load_dwordx4 v[164:167], v5, s[40:43], s57 offen offset:2048 sc1
    buffer_load_dwordx4 v[168:171], v5, s[40:43], s56 offen offset:3072 sc1
    buffer_load_dwordx4 v[172:175], v5, s[40:43], s57 offen offset:3072 sc1
    s_waitcnt vmcnt(19)
    v_mfma_f32_32x32x16_bf16 v[16:31], a[144:147], v[96:99], v[16:31]
    s_waitcnt vmcnt(18)
    v_mfma_f32_32x32x16_bf16 v[32:47], a[144:147], v[100:103], v[32:47]
    v_mfma_f32_32x32x16_bf16 v[48:63], a[148:151], v[96:99], v[48:63]
    v_mfma_f32_32x32x16_bf16 v[64:79], a[148:151], v[100:103], v[64:79]
    s_add_u32 s56, s71, s97
    s_add_u32 s57, s72, s97
    buffer_load_dwordx4 v[176:179], v5, s[40:43], s56 offen offset:0 sc1
    buffer_load_dwordx4 v[180:183], v5, s[40:43], s57 offen offset:0 sc1
    buffer_load_dwordx4 v[184:187], v5, s[40:43], s56 offen offset:1024 sc1
    buffer_load_dwordx4 v[188:191], v5, s[40:43], s57 offen offset:1024 sc1
    s_waitcnt vmcnt(21)
    v_mfma_f32_32x32x16_bf16 v[16:31], a[152:155], v[104:107], v[16:31]
    s_waitcnt vmcnt(20)
    v_mfma_f32_32x32x16_bf16 v[32:47], a[152:155], v[108:111], v[32:47]
    v_mfma_f32_32x32x16_bf16 v[48:63], a[156:159], v[104:107], v[48:63]
    v_mfma_f32_32x32x16_bf16 v[64:79], a[156:159], v[108:111], v[64:79]
    buffer_load_dwordx4 v[192:195], v5, s[40:43], s56 offen offset:2048 sc1
    buffer_load_dwordx4 v[196:199], v5, s[40:43], s57 offen offset:2048 sc1
    buffer_load_dwordx4 v[200:203], v5, s[40:43], s56 offen offset:3072 sc1
    buffer_load_dwordx4 v[204:207], v5, s[40:43], s57 offen offset:3072 sc1
    s_waitcnt vmcnt(23)
    v_mfma_f32_32x32x16_bf16 v[16:31], a[160:163], v[112:115], v[16:31]
    s_waitcnt vmcnt(22)
    v_mfma_f32_32x32x16_bf16 v[32:47], a[160:163], v[116:119], v[32:47]
    v_mfma_f32_32x32x16_bf16 v[48:63], a[164:167], v[112:115], v[48:63]
    v_mfma_f32_32x32x16_bf16 v[64:79], a[164:167], v[116:119], v[64:79]
    s_add_u32 s56, s71, s98
    s_add_u32 s57, s72, s98
    buffer_load_dwordx4 v[80:83], v5, s[40:43], s56 offen offset:0 sc1
    buffer_load_dwordx4 v[84:87], v5, s[40:43], s57 offen offset:0 sc1
    buffer_load_dwordx4 v[88:91], v5, s[40:43], s56 offen offset:1024 sc1
    buffer_load_dwordx4 v[92:95], v5, s[40:43], s57 offen offset:1024 sc1
    s_waitcnt vmcnt(25)
    v_mfma_f32_32x32x16_bf16 v[16:31], a[168:171], v[120:123], v[16:31]
    s_waitcnt vmcnt(24)
    v_mfma_f32_32x32x16_bf16 v[32:47], a[168:171], v[124:127], v[32:47]
    v_mfma_f32_32x32x16_bf16 v[48:63], a[172:175], v[120:123], v[48:63]
    v_mfma_f32_32x32x16_bf16 v[64:79], a[172:175], v[124:127], v[64:79]
    buffer_load_dwordx4 v[96:99], v5, s[40:43], s56 offen offset:2048 sc1
    buffer_load_dwordx4 v[100:103], v5, s[40:43], s57 offen offset:2048 sc1
    buffer_load_dwordx4 v[104:107], v5, s[40:43], s56 offen offset:3072 sc1
    buffer_load_dwordx4 v[108:111], v5, s[40:43], s57 offen offset:3072 sc1
    s_waitcnt vmcnt(27)
    v_mfma_f32_32x32x16_bf16 v[16:31], a[176:179], v[128:131], v[16:31]
    s_waitcnt vmcnt(26)
    v_mfma_f32_32x32x16_bf16 v[32:47], a[176:179], v[132:135], v[32:47]
    v_mfma_f32_32x32x16_bf16 v[48:63], a[180:183], v[128:131], v[48:63]
    v_mfma_f32_32x32x16_bf16 v[64:79], a[180:183], v[132:135], v[64:79]
    s_add_u32 s56, s71, s99
    s_add_u32 s57, s72, s99
    buffer_load_dwordx4 v[112:115], v5, s[40:43], s56 offen offset:0 sc1
    buffer_load_dwordx4 v[116:119], v5, s[40:43], s57 offen offset:0 sc1
    buffer_load_dwordx4 v[120:123], v5, s[40:43], s56 offen offset:1024 sc1
    buffer_load_dwordx4 v[124:127], v5, s[40:43], s57 offen offset:1024 sc1
    s_waitcnt vmcnt(29)
    v_mfma_f32_32x32x16_bf16 v[16:31], a[184:187], v[136:139], v[16:31]
    s_waitcnt vmcnt(28)
    v_mfma_f32_32x32x16_bf16 v[32:47], a[184:187], v[140:143], v[32:47]
    v_mfma_f32_32x32x16_bf16 v[48:63], a[188:191], v[136:139], v[48:63]
    v_mfma_f32_32x32x16_bf16 v[64:79], a[188:191], v[140:143], v[64:79]
    buffer_load_dwordx4 v[128:131], v5, s[40:43], s56 offen offset:2048 sc1
    buffer_load_dwordx4 v[132:135], v5, s[40:43], s57 offen offset:2048 sc1
    buffer_load_dwordx4 v[136:139], v5, s[40:43], s56 offen offset:3072 sc1
    buffer_load_dwordx4 v[140:143], v5, s[40:43], s57 offen offset:3072 sc1
    s_waitcnt vmcnt(31)
    v_mfma_f32_32x32x16_bf16 v[16:31], a[192:195], v[144:147], v[16:31]
    s_waitcnt vmcnt(30)
    v_mfma_f32_32x32x16_bf16 v[32:47], a[192:195], v[148:151], v[32:47]
    v_mfma_f32_32x32x16_bf16 v[48:63], a[196:199], v[144:147], v[48:63]
    v_mfma_f32_32x32x16_bf16 v[64:79], a[196:199], v[148:151], v[64:79]
    ds_read_b64_tr_b16 a[128:129], v217 offset:32768
    ds_read_b64_tr_b16 a[130:131], v217 offset:33792
    ds_read_b64_tr_b16 a[132:133], v218 offset:32768
    ds_read_b64_tr_b16 a[134:135], v218 offset:33792
    s_add_u32 s56, s71, s100
    s_add_u32 s57, s72, s100
    buffer_load_dwordx4 v[144:147], v5, s[40:43], s56 offen offset:0 sc1
    buffer_load_dwordx4 v[148:151], v5, s[40:43], s57 offen offset:0 sc1
    s_waitcnt vmcnt(31)
    v_mfma_f32_32x32x16_bf16 v[16:31], a[200:203], v[152:155], v[16:31]
    s_waitcnt vmcnt(30)
    v_mfma_f32_32x32x16_bf16 v[32:47], a[200:203], v[156:159], v[32:47]
    v_mfma_f32_32x32x16_bf16 v[48:63], a[204:207], v[152:155], v[48:63]
    v_mfma_f32_32x32x16_bf16 v[64:79], a[204:207], v[156:159], v[64:79]
    ds_read_b64_tr_b16 a[136:137], v217 offset:34816
    ds_read_b64_tr_b16 a[138:139], v217 offset:35840
    ds_read_b64_tr_b16 a[140:141], v218 offset:34816
    ds_read_b64_tr_b16 a[142:143], v218 offset:35840
    buffer_load_dwordx4 v[152:155], v5, s[40:43], s56 offen offset:1024 sc1
    buffer_load_dwordx4 v[156:159], v5, s[40:43], s57 offen offset:1024 sc1
    s_waitcnt vmcnt(31)
    v_mfma_f32_32x32x16_bf16 v[16:31], a[208:211], v[160:163], v[16:31]
    s_waitcnt vmcnt(30)
    v_mfma_f32_32x32x16_bf16 v[32:47], a[208:211], v[164:167], v[32:47]
    v_mfma_f32_32x32x16_bf16 v[48:63], a[212:215], v[160:163], v[48:63]
    v_mfma_f32_32x32x16_bf16 v[64:79], a[212:215], v[164:167], v[64:79]
    buffer_load_dwordx4 v[160:163], v5, s[40:43], s56 offen offset:2048 sc1
    buffer_load_dwordx4 v[164:167], v5, s[40:43], s57 offen offset:2048 sc1
    s_waitcnt vmcnt(31)
    v_mfma_f32_32x32x16_bf16 v[16:31], a[216:219], v[168:171], v[16:31]
    s_waitcnt vmcnt(30)
    v_mfma_f32_32x32x16_bf16 v[32:47], a[216:219], v[172:175], v[32:47]
    v_mfma_f32_32x32x16_bf16 v[48:63], a[220:223], v[168:171], v[48:63]
    v_mfma_f32_32x32x16_bf16 v[64:79], a[220:223], v[172:175], v[64:79]
    buffer_load_dwordx4 v[168:171], v5, s[40:43], s56 offen offset:3072 sc1
    buffer_load_dwordx4 v[172:175], v5, s[40:43], s57 offen offset:3072 sc1
    s_waitcnt vmcnt(31)
    v_mfma_f32_32x32x16_bf16 v[16:31], a[224:227], v[176:179], v[16:31]
    s_waitcnt vmcnt(30)
    v_mfma_f32_32x32x16_bf16 v[32:47], a[224:227], v[180:183], v[32:47]
    v_mfma_f32_32x32x16_bf16 v[48:63], a[228:231], v[176:179], v[48:63]
    v_mfma_f32_32x32x16_bf16 v[64:79], a[228:231], v[180:183], v[64:79]
    s_add_u32 s56, s71, s101
    s_add_u32 s57, s72, s101
    buffer_load_dwordx4 v[176:179], v5, s[40:43], s56 offen offset:0 sc1
    buffer_load_dwordx4 v[180:183], v5, s[40:43], s57 offen offset:0 sc1
    s_waitcnt vmcnt(31)
    v_mfma_f32_32x32x16_bf16 v[16:31], a[232:235], v[184:187], v[16:31]
    s_waitcnt vmcnt(30)
    v_mfma_f32_32x32x16_bf16 v[32:47], a[232:235], v[188:191], v[32:47]
    v_mfma_f32_32x32x16_bf16 v[48:63], a[236:239], v[184:187], v[48:63]
    v_mfma_f32_32x32x16_bf16 v[64:79], a[236:239], v[188:191], v[64:79]
    buffer_load_dwordx4 v[184:187], v5, s[40:43], s56 offen offset:1024 sc1
    buffer_load_dwordx4 v[188:191], v5, s[40:43], s57 offen offset:1024 sc1
    s_waitcnt vmcnt(31)
    v_mfma_f32_32x32x16_bf16 v[16:31], a[240:243], v[192:195], v[16:31]
    s_waitcnt vmcnt(30)
    v_mfma_f32_32x32x16_bf16 v[32:47], a[240:243], v[196:199], v[32:47]
    v_mfma_f32_32x32x16_bf16 v[48:63], a[244:247], v[192:195], v[48:63]
    v_mfma_f32_32x32x16_bf16 v[64:79], a[244:247], v[196:199], v[64:79]
    buffer_load_dwordx4 v[192:195], v5, s[40:43], s56 offen offset:2048 sc1
    buffer_load_dwordx4 v[196:199], v5, s[40:43], s57 offen offset:2048 sc1
    s_waitcnt vmcnt(31)
    v_mfma_f32_32x32x16_bf16 v[16:31], a[248:251], v[200:203], v[16:31]
    s_waitcnt vmcnt(30)
    v_mfma_f32_32x32x16_bf16 v[32:47], a[248:251], v[204:207], v[32:47]
    v_mfma_f32_32x32x16_bf16 v[48:63], a[252:255], v[200:203], v[48:63]
    v_mfma_f32_32x32x16_bf16 v[64:79], a[252:255], v[204:207], v[64:79]
    buffer_load_dwordx4 v[200:203], v5, s[40:43], s56 offen offset:3072 sc1
    buffer_load_dwordx4 v[204:207], v5, s[40:43], s57 offen offset:3072 sc1
    s_waitcnt vmcnt(31)
    v_mfma_f32_32x32x16_bf16 v[16:31], a[0:3], v[80:83], v[16:31]
    s_waitcnt vmcnt(30)
    v_mfma_f32_32x32x16_bf16 v[32:47], a[0:3], v[84:87], v[32:47]
    v_mfma_f32_32x32x16_bf16 v[48:63], a[4:7], v[80:83], v[48:63]
    v_mfma_f32_32x32x16_bf16 v[64:79], a[4:7], v[84:87], v[64:79]
    s_barrier
    s_waitcnt vmcnt(29)
    v_mfma_f32_32x32x16_bf16 v[16:31], a[8:11], v[88:91], v[16:31]
    s_waitcnt vmcnt(28)
    v_mfma_f32_32x32x16_bf16 v[32:47], a[8:11], v[92:95], v[32:47]
    v_mfma_f32_32x32x16_bf16 v[48:63], a[12:15], v[88:91], v[48:63]
    v_mfma_f32_32x32x16_bf16 v[64:79], a[12:15], v[92:95], v[64:79]
    s_waitcnt lgkmcnt(15)
    s_add_u32 m0, s70, 12288
    s_mul_i32 s73, s48, 64
    s_add_u32 s73, s73, 131072
    buffer_load_dwordx4 v214, s[24:27], s73 offen lds
    s_add_u32 m0, s70, 13312
    s_mul_i32 s73, s48, 64
    s_add_u32 s73, s73, 163840
    buffer_load_dwordx4 v214, s[24:27], s73 offen lds
    s_waitcnt vmcnt(29)
    v_mfma_f32_32x32x16_bf16 v[16:31], a[16:19], v[96:99], v[16:31]
    s_waitcnt vmcnt(28)
    v_mfma_f32_32x32x16_bf16 v[32:47], a[16:19], v[100:103], v[32:47]
    v_mfma_f32_32x32x16_bf16 v[48:63], a[20:23], v[96:99], v[48:63]
    v_mfma_f32_32x32x16_bf16 v[64:79], a[20:23], v[100:103], v[64:79]
    s_add_u32 m0, s70, 14336
    s_mul_i32 s73, s48, 64
    s_add_u32 s73, s73, 196608
    buffer_load_dwordx4 v214, s[24:27], s73 offen lds
    s_add_u32 m0, s70, 15360
    s_mul_i32 s73, s48, 64
    s_add_u32 s73, s73, 229376
    buffer_load_dwordx4 v214, s[24:27], s73 offen lds
    s_waitcnt vmcnt(29)
    v_mfma_f32_32x32x16_bf16 v[16:31], a[24:27], v[104:107], v[16:31]
    s_waitcnt vmcnt(28)
    v_mfma_f32_32x32x16_bf16 v[32:47], a[24:27], v[108:111], v[32:47]
    v_mfma_f32_32x32x16_bf16 v[48:63], a[28:31], v[104:107], v[48:63]
    v_mfma_f32_32x32x16_bf16 v[64:79], a[28:31], v[108:111], v[64:79]
    s_add_u32 m0, s70, 16384
    s_mul_i32 s73, s49, 64
    s_add_u32 s73, s73, 0
    buffer_load_dwordx4 v214, s[24:27], s73 offen lds
    s_add_u32 m0, s70, 17408
    s_mul_i32 s73, s49, 64
    s_add_u32 s73, s73, 32768
    buffer_load_dwordx4 v214, s[24:27], s73 offen lds
    s_waitcnt vmcnt(29)
    v_mfma_f32_32x32x16_bf16 v[16:31], a[32:35], v[112:115], v[16:31]
    s_waitcnt vmcnt(28)
    v_mfma_f32_32x32x16_bf16 v[32:47], a[32:35], v[116:119], v[32:47]
    v_mfma_f32_32x32x16_bf16 v[48:63], a[36:39], v[112:115], v[48:63]
    v_mfma_f32_32x32x16_bf16 v[64:79], a[36:39], v[116:119], v[64:79]
    s_add_u32 m0, s70, 18432
    s_mul_i32 s73, s49, 64
    s_add_u32 s73, s73, 65536
    buffer_load_dwordx4 v214, s[24:27], s73 offen lds
    s_add_u32 m0, s70, 19456
    s_mul_i32 s73, s49, 64
    s_add_u32 s73, s73, 98304
    buffer_load_dwordx4 v214, s[24:27], s73 offen lds
    s_waitcnt vmcnt(29)
    v_mfma_f32_32x32x16_bf16 v[16:31], a[40:43], v[120:123], v[16:31]
    s_waitcnt vmcnt(28)
    v_mfma_f32_32x32x16_bf16 v[32:47], a[40:43], v[124:127], v[32:47]
    v_mfma_f32_32x32x16_bf16 v[48:63], a[44:47], v[120:123], v[48:63]
    v_mfma_f32_32x32x16_bf16 v[64:79], a[44:47], v[124:127], v[64:79]
    s_add_u32 m0, s70, 20480
    s_mul_i32 s73, s49, 64
    s_add_u32 s73, s73, 131072
    buffer_load_dwordx4 v214, s[24:27], s73 offen lds
    s_add_u32 m0, s70, 21504
    s_mul_i32 s73, s49, 64
    s_add_u32 s73, s73, 163840
    buffer_load_dwordx4 v214, s[24:27], s73 offen lds
    s_waitcnt vmcnt(29)
    v_mfma_f32_32x32x16_bf16 v[16:31], a[48:51], v[128:131], v[16:31]
    s_waitcnt vmcnt(28)
    v_mfma_f32_32x32x16_bf16 v[32:47], a[48:51], v[132:135], v[32:47]
    v_mfma_f32_32x32x16_bf16 v[48:63], a[52:55], v[128:131], v[48:63]
    v_mfma_f32_32x32x16_bf16 v[64:79], a[52:55], v[132:135], v[64:79]
    s_add_u32 m0, s70, 22528
    s_mul_i32 s73, s49, 64
    s_add_u32 s73, s73, 196608
    buffer_load_dwordx4 v214, s[24:27], s73 offen lds
    s_add_u32 m0, s70, 23552
    s_mul_i32 s73, s49, 64
    s_add_u32 s73, s73, 229376
    buffer_load_dwordx4 v214, s[24:27], s73 offen lds
    s_waitcnt vmcnt(29)
    v_mfma_f32_32x32x16_bf16 v[16:31], a[56:59], v[136:139], v[16:31]
    s_waitcnt vmcnt(28)
    v_mfma_f32_32x32x16_bf16 v[32:47], a[56:59], v[140:143], v[32:47]
    v_mfma_f32_32x32x16_bf16 v[48:63], a[60:63], v[136:139], v[48:63]
    v_mfma_f32_32x32x16_bf16 v[64:79], a[60:63], v[140:143], v[64:79]
    s_add_u32 m0, s70, 24576
    s_mul_i32 s73, s50, 64
    s_add_u32 s73, s73, 0
    buffer_load_dwordx4 v214, s[24:27], s73 offen lds
    s_add_u32 m0, s70, 25600
    s_mul_i32 s73, s50, 64
    s_add_u32 s73, s73, 32768
    buffer_load_dwordx4 v214, s[24:27], s73 offen lds
    s_waitcnt vmcnt(29)
    v_mfma_f32_32x32x16_bf16 v[16:31], a[64:67], v[144:147], v[16:31]
    s_waitcnt vmcnt(28)
    v_mfma_f32_32x32x16_bf16 v[32:47], a[64:67], v[148:151], v[32:47]
    v_mfma_f32_32x32x16_bf16 v[48:63], a[68:71], v[144:147], v[48:63]
    v_mfma_f32_32x32x16_bf16 v[64:79], a[68:71], v[148:151], v[64:79]
    s_add_u32 m0, s70, 26624
    s_mul_i32 s73, s50, 64
    s_add_u32 s73, s73, 65536
    buffer_load_dwordx4 v214, s[24:27], s73 offen lds
    s_add_u32 m0, s70, 27648
    s_mul_i32 s73, s50, 64
    s_add_u32 s73, s73, 98304
    buffer_load_dwordx4 v214, s[24:27], s73 offen lds
    s_waitcnt vmcnt(29)
    v_mfma_f32_32x32x16_bf16 v[16:31], a[72:75], v[152:155], v[16:31]
    s_waitcnt vmcnt(28)
    v_mfma_f32_32x32x16_bf16 v[32:47], a[72:75], v[156:159], v[32:47]
    v_mfma_f32_32x32x16_bf16 v[48:63], a[76:79], v[152:155], v[48:63]
    v_mfma_f32_32x32x16_bf16 v[64:79], a[76:79], v[156:159], v[64:79]
    s_waitcnt lgkmcnt(12)
    s_add_u32 m0, s70, 28672
    s_mul_i32 s73, s50, 64
    s_add_u32 s73, s73, 131072
    buffer_load_dwordx4 v214, s[24:27], s73 offen lds
    s_add_u32 m0, s70, 29696
    s_mul_i32 s73, s50, 64
    s_add_u32 s73, s73, 163840
    buffer_load_dwordx4 v214, s[24:27], s73 offen lds
    s_waitcnt vmcnt(29)
    v_mfma_f32_32x32x16_bf16 v[16:31], a[80:83], v[160:163], v[16:31]
    s_waitcnt vmcnt(28)
    v_mfma_f32_32x32x16_bf16 v[32:47], a[80:83], v[164:167], v[32:47]
    v_mfma_f32_32x32x16_bf16 v[48:63], a[84:87], v[160:163], v[48:63]
    v_mfma_f32_32x32x16_bf16 v[64:79], a[84:87], v[164:167], v[64:79]
    s_waitcnt lgkmcnt(8)
    s_add_u32 m0, s70, 30720
    s_mul_i32 s73, s50, 64
    s_add_u32 s73, s73, 196608
    buffer_load_dwordx4 v214, s[24:27], s73 offen lds
    s_add_u32 m0, s70, 31744
    s_mul_i32 s73, s50, 64
    s_add_u32 s73, s73, 229376
    buffer_load_dwordx4 v214, s[24:27], s73 offen lds
    s_waitcnt vmcnt(29)
    v_mfma_f32_32x32x16_bf16 v[16:31], a[88:91], v[168:171], v[16:31]
    s_waitcnt vmcnt(28)
    v_mfma_f32_32x32x16_bf16 v[32:47], a[88:91], v[172:175], v[32:47]
    v_mfma_f32_32x32x16_bf16 v[48:63], a[92:95], v[168:171], v[48:63]
    v_mfma_f32_32x32x16_bf16 v[64:79], a[92:95], v[172:175], v[64:79]
    s_waitcnt lgkmcnt(4)
    s_add_u32 m0, s70, 32768
    s_mul_i32 s73, s51, 64
    s_add_u32 s73, s73, 0
    buffer_load_dwordx4 v214, s[24:27], s73 offen lds
    s_add_u32 m0, s70, 33792
    s_mul_i32 s73, s51, 64
    s_add_u32 s73, s73, 32768
    buffer_load_dwordx4 v214, s[24:27], s73 offen lds
    s_waitcnt vmcnt(29)
    v_mfma_f32_32x32x16_bf16 v[16:31], a[96:99], v[176:179], v[16:31]
    s_waitcnt vmcnt(28)
    v_mfma_f32_32x32x16_bf16 v[32:47], a[96:99], v[180:183], v[32:47]
    v_mfma_f32_32x32x16_bf16 v[48:63], a[100:103], v[176:179], v[48:63]
    v_mfma_f32_32x32x16_bf16 v[64:79], a[100:103], v[180:183], v[64:79]
    s_waitcnt lgkmcnt(0)
    s_add_u32 m0, s70, 34816
    s_mul_i32 s73, s51, 64
    s_add_u32 s73, s73, 65536
    buffer_load_dwordx4 v214, s[24:27], s73 offen lds
    s_add_u32 m0, s70, 35840
    s_mul_i32 s73, s51, 64
    s_add_u32 s73, s73, 98304
    buffer_load_dwordx4 v214, s[24:27], s73 offen lds
    s_waitcnt vmcnt(29)
    v_mfma_f32_32x32x16_bf16 v[16:31], a[104:107], v[184:187], v[16:31]
    s_waitcnt vmcnt(28)
    v_mfma_f32_32x32x16_bf16 v[32:47], a[104:107], v[188:191], v[32:47]
    v_mfma_f32_32x32x16_bf16 v[48:63], a[108:111], v[184:187], v[48:63]
    v_mfma_f32_32x32x16_bf16 v[64:79], a[108:111], v[188:191], v[64:79]
    s_waitcnt vmcnt(27)
    v_mfma_f32_32x32x16_bf16 v[16:31], a[112:115], v[192:195], v[16:31]
    s_waitcnt vmcnt(26)
    v_mfma_f32_32x32x16_bf16 v[32:47], a[112:115], v[196:199], v[32:47]
    v_mfma_f32_32x32x16_bf16 v[48:63], a[116:119], v[192:195], v[48:63]
    v_mfma_f32_32x32x16_bf16 v[64:79], a[116:119], v[196:199], v[64:79]
    s_waitcnt vmcnt(25)
    v_mfma_f32_32x32x16_bf16 v[16:31], a[120:123], v[200:203], v[16:31]
    s_waitcnt vmcnt(24)
    v_mfma_f32_32x32x16_bf16 v[32:47], a[120:123], v[204:207], v[32:47]
    v_mfma_f32_32x32x16_bf16 v[48:63], a[124:127], v[200:203], v[48:63]
    v_mfma_f32_32x32x16_bf16 v[64:79], a[124:127], v[204:207], v[64:79]
    s_xor_b32 s68, s3, 1
    s_mul_i32 s68, s68, 36864
    s_add_u32 s68, s68, 12288
    v_add_u32 v221, s68, v4
    s_xor_b32 s68, s3, 2
    s_mul_i32 s68, s68, 36864
    s_add_u32 s68, s68, 16384
    v_add_u32 v222, s68, v4
    s_xor_b32 s68, s3, 3
    s_mul_i32 s68, s68, 36864
    s_add_u32 s68, s68, 20480
    v_add_u32 v223, s68, v4
    ds_write_b128 v221, v[32:35] offset:0
    ds_write_b128 v221, v[36:39] offset:1024
    ds_write_b128 v221, v[40:43] offset:2048
    ds_write_b128 v221, v[44:47] offset:3072
    ds_write_b128 v222, v[48:51] offset:0
    ds_write_b128 v222, v[52:55] offset:1024
    ds_write_b128 v222, v[56:59] offset:2048
    ds_write_b128 v222, v[60:63] offset:3072
    ds_write_b128 v223, v[64:67] offset:0
    ds_write_b128 v223, v[68:71] offset:1024
    ds_write_b128 v223, v[72:75] offset:2048
    ds_write_b128 v223, v[76:79] offset:3072
    v_add_u32 v220, s70, v4
    s_lshl_b32 s68, s64, 1
    s_and_b32 s69, s3, 1
    s_add_u32 s68, s68, s69
    s_mul_i32 s68, s68, 112
    s_lshl_b32 s69, s65, 2
    s_add_u32 s68, s68, s69
    s_and_b32 s69, s3, 2
    s_add_u32 s68, s68, s69
    s_lshl_b32 s68, s68, 10
    s_add_u32 s68, s68, 0x3c0000
    s_waitcnt lgkmcnt(0)
    s_barrier
    ds_read_b128 v[32:35], v220 offset:0
    ds_read_b128 v[48:51], v220 offset:4096
    ds_read_b128 v[64:67], v220 offset:8192
    ds_read_b128 v[36:39], v220 offset:1024
    ds_read_b128 v[52:55], v220 offset:5120
    ds_read_b128 v[68:71], v220 offset:9216
    ds_read_b128 v[40:43], v220 offset:2048
    ds_read_b128 v[56:59], v220 offset:6144
    ds_read_b128 v[72:75], v220 offset:10240
    ds_read_b128 v[44:47], v220 offset:3072
    ds_read_b128 v[60:63], v220 offset:7168
    ds_read_b128 v[76:79], v220 offset:11264
    s_mov_b32 s88, 0xc0135761
    s_mov_b32 s90, 0xbdd2d3e8
    v_mov_b32 v224, s88
    v_mov_b32 v225, s88
    s_waitcnt lgkmcnt(10)
    v_pk_add_f32 v[32:33], v[32:33], v[48:49]
    s_waitcnt lgkmcnt(9)
    v_pk_add_f32 v[16:17], v[16:17], v[64:65]
    v_pk_add_f32 v[34:35], v[34:35], v[50:51]
    v_pk_add_f32 v[18:19], v[18:19], v[66:67]
    s_waitcnt lgkmcnt(7)
    v_pk_add_f32 v[36:37], v[36:37], v[52:53]
    s_waitcnt lgkmcnt(6)
    v_pk_add_f32 v[20:21], v[20:21], v[68:69]
    v_pk_add_f32 v[38:39], v[38:39], v[54:55]
    v_pk_add_f32 v[22:23], v[22:23], v[70:71]
    v_pk_add_f32 v[16:17], v[16:17], v[32:33]
    v_pk_add_f32 v[18:19], v[18:19], v[34:35]
    v_pk_add_f32 v[20:21], v[20:21], v[36:37]
    v_pk_add_f32 v[22:23], v[22:23], v[38:39]
    v_pk_mul_f32 v[80:81], v[16:17], v[16:17]
    v_pk_mul_f32 v[82:83], v[18:19], v[18:19]
    v_pk_mul_f32 v[84:85], v[20:21], v[20:21]
    v_pk_mul_f32 v[86:87], v[22:23], v[22:23]
    v_pk_fma_f32 v[80:81], v[80:81], s[90:91], v[224:225] op_sel_hi:[1,0,1]
    v_pk_fma_f32 v[82:83], v[82:83], s[90:91], v[224:225] op_sel_hi:[1,0,1]
    v_pk_fma_f32 v[84:85], v[84:85], s[90:91], v[224:225] op_sel_hi:[1,0,1]
    v_pk_fma_f32 v[86:87], v[86:87], s[90:91], v[224:225] op_sel_hi:[1,0,1]
    v_pk_mul_f32 v[80:81], v[80:81], v[16:17]
    v_pk_mul_f32 v[82:83], v[82:83], v[18:19]
    v_pk_mul_f32 v[84:85], v[84:85], v[20:21]
    v_pk_mul_f32 v[86:87], v[86:87], v[22:23]
    v_exp_f32 v80, v80
    v_exp_f32 v81, v81
    v_exp_f32 v82, v82
    v_exp_f32 v83, v83
    v_exp_f32 v84, v84
    v_exp_f32 v85, v85
    v_exp_f32 v86, v86
    v_exp_f32 v87, v87
    v_pk_add_f32 v[80:81], v[80:81], 1.0 op_sel_hi:[1,0]
    v_pk_add_f32 v[82:83], v[82:83], 1.0 op_sel_hi:[1,0]
    v_pk_add_f32 v[84:85], v[84:85], 1.0 op_sel_hi:[1,0]
    v_pk_add_f32 v[86:87], v[86:87], 1.0 op_sel_hi:[1,0]
    v_rcp_f32 v80, v80
    v_rcp_f32 v81, v81
    v_rcp_f32 v82, v82
    v_rcp_f32 v83, v83
    v_rcp_f32 v84, v84
    v_rcp_f32 v85, v85
    v_rcp_f32 v86, v86
    v_rcp_f32 v87, v87
    v_pk_mul_f32 v[80:81], v[80:81], v[16:17]
    v_pk_mul_f32 v[82:83], v[82:83], v[18:19]
    v_pk_mul_f32 v[84:85], v[84:85], v[20:21]
    v_pk_mul_f32 v[86:87], v[86:87], v[22:23]
    v_cvt_pk_bf16_f32 v96, v80, v81
    v_cvt_pk_bf16_f32 v97, v82, v83
    v_cvt_pk_bf16_f32 v98, v84, v85
    v_cvt_pk_bf16_f32 v99, v86, v87
    buffer_store_dwordx4 v[96:99], v5, s[40:43], s68 offen offset:0 sc1
    s_waitcnt lgkmcnt(4)
    v_pk_add_f32 v[40:41], v[40:41], v[56:57]
    s_waitcnt lgkmcnt(3)
    v_pk_add_f32 v[24:25], v[24:25], v[72:73]
    v_pk_add_f32 v[42:43], v[42:43], v[58:59]
    v_pk_add_f32 v[26:27], v[26:27], v[74:75]
    s_waitcnt lgkmcnt(1)
    v_pk_add_f32 v[44:45], v[44:45], v[60:61]
    s_waitcnt lgkmcnt(0)
    v_pk_add_f32 v[28:29], v[28:29], v[76:77]
    v_pk_add_f32 v[46:47], v[46:47], v[62:63]
    v_pk_add_f32 v[30:31], v[30:31], v[78:79]
    v_pk_add_f32 v[24:25], v[24:25], v[40:41]
    v_pk_add_f32 v[26:27], v[26:27], v[42:43]
    v_pk_add_f32 v[28:29], v[28:29], v[44:45]
    v_pk_add_f32 v[30:31], v[30:31], v[46:47]
    v_pk_mul_f32 v[88:89], v[24:25], v[24:25]
    v_pk_mul_f32 v[90:91], v[26:27], v[26:27]
    v_pk_mul_f32 v[92:93], v[28:29], v[28:29]
    v_pk_mul_f32 v[94:95], v[30:31], v[30:31]
    v_pk_fma_f32 v[88:89], v[88:89], s[90:91], v[224:225] op_sel_hi:[1,0,1]
    v_pk_fma_f32 v[90:91], v[90:91], s[90:91], v[224:225] op_sel_hi:[1,0,1]
    v_pk_fma_f32 v[92:93], v[92:93], s[90:91], v[224:225] op_sel_hi:[1,0,1]
    v_pk_fma_f32 v[94:95], v[94:95], s[90:91], v[224:225] op_sel_hi:[1,0,1]
    v_pk_mul_f32 v[88:89], v[88:89], v[24:25]
    v_pk_mul_f32 v[90:91], v[90:91], v[26:27]
    v_pk_mul_f32 v[92:93], v[92:93], v[28:29]
    v_pk_mul_f32 v[94:95], v[94:95], v[30:31]
    v_exp_f32 v88, v88
    v_exp_f32 v89, v89
    v_exp_f32 v90, v90
    v_exp_f32 v91, v91
    v_exp_f32 v92, v92
    v_exp_f32 v93, v93
    v_exp_f32 v94, v94
    v_exp_f32 v95, v95
    v_pk_add_f32 v[88:89], v[88:89], 1.0 op_sel_hi:[1,0]
    v_pk_add_f32 v[90:91], v[90:91], 1.0 op_sel_hi:[1,0]
    v_pk_add_f32 v[92:93], v[92:93], 1.0 op_sel_hi:[1,0]
    v_pk_add_f32 v[94:95], v[94:95], 1.0 op_sel_hi:[1,0]
    v_rcp_f32 v88, v88
    v_rcp_f32 v89, v89
    v_rcp_f32 v90, v90
    v_rcp_f32 v91, v91
    v_rcp_f32 v92, v92
    v_rcp_f32 v93, v93
    v_rcp_f32 v94, v94
    v_rcp_f32 v95, v95
    v_pk_mul_f32 v[88:89], v[88:89], v[24:25]
    v_pk_mul_f32 v[90:91], v[90:91], v[26:27]
    v_pk_mul_f32 v[92:93], v[92:93], v[28:29]
    v_pk_mul_f32 v[94:95], v[94:95], v[30:31]
    v_cvt_pk_bf16_f32 v100, v88, v89
    v_cvt_pk_bf16_f32 v101, v90, v91
    v_cvt_pk_bf16_f32 v102, v92, v93
    v_cvt_pk_bf16_f32 v103, v94, v95
    buffer_store_dwordx4 v[100:103], v5, s[40:43], s68 offen offset:1024 sc1
    v_mov_b32 v9, v5
    s_waitcnt vmcnt(24)
    ds_read_b64_tr_b16 a[144:145], v217 offset:12288
    ds_read_b64_tr_b16 a[146:147], v217 offset:13312
    ds_read_b64_tr_b16 a[148:149], v218 offset:12288
    ds_read_b64_tr_b16 a[150:151], v218 offset:13312
    s_waitcnt vmcnt(22)
    ds_read_b64_tr_b16 a[152:153], v217 offset:14336
    ds_read_b64_tr_b16 a[154:155], v217 offset:15360
    ds_read_b64_tr_b16 a[156:157], v218 offset:14336
    ds_read_b64_tr_b16 a[158:159], v218 offset:15360
    s_waitcnt vmcnt(20)
    ds_read_b64_tr_b16 a[160:161], v217 offset:16384
    ds_read_b64_tr_b16 a[162:163], v217 offset:17408
    ds_read_b64_tr_b16 a[164:165], v218 offset:16384
    ds_read_b64_tr_b16 a[166:167], v218 offset:17408
    s_waitcnt vmcnt(18)
    ds_read_b64_tr_b16 a[168:169], v217 offset:18432
    ds_read_b64_tr_b16 a[170:171], v217 offset:19456
    ds_read_b64_tr_b16 a[172:173], v218 offset:18432
    ds_read_b64_tr_b16 a[174:175], v218 offset:19456
    s_waitcnt vmcnt(16)
    ds_read_b64_tr_b16 a[176:177], v217 offset:20480
    ds_read_b64_tr_b16 a[178:179], v217 offset:21504
    ds_read_b64_tr_b16 a[180:181], v218 offset:20480
    ds_read_b64_tr_b16 a[182:183], v218 offset:21504
    s_waitcnt vmcnt(14)
    ds_read_b64_tr_b16 a[184:185], v217 offset:22528
    ds_read_b64_tr_b16 a[186:187], v217 offset:23552
    ds_read_b64_tr_b16 a[188:189], v218 offset:22528
    ds_read_b64_tr_b16 a[190:191], v218 offset:23552
    s_waitcnt vmcnt(12)
    ds_read_b64_tr_b16 a[192:193], v217 offset:24576
    ds_read_b64_tr_b16 a[194:195], v217 offset:25600
    ds_read_b64_tr_b16 a[196:197], v218 offset:24576
    ds_read_b64_tr_b16 a[198:199], v218 offset:25600
    s_waitcnt vmcnt(10)
    ds_read_b64_tr_b16 a[200:201], v217 offset:26624
    ds_read_b64_tr_b16 a[202:203], v217 offset:27648
    ds_read_b64_tr_b16 a[204:205], v218 offset:26624
    ds_read_b64_tr_b16 a[206:207], v218 offset:27648
    s_waitcnt vmcnt(8)
    ds_read_b64_tr_b16 a[208:209], v217 offset:28672
    ds_read_b64_tr_b16 a[210:211], v217 offset:29696
    ds_read_b64_tr_b16 a[212:213], v218 offset:28672
    ds_read_b64_tr_b16 a[214:215], v218 offset:29696
    s_waitcnt vmcnt(6)
    ds_read_b64_tr_b16 a[216:217], v217 offset:30720
    ds_read_b64_tr_b16 a[218:219], v217 offset:31744
    ds_read_b64_tr_b16 a[220:221], v218 offset:30720
    ds_read_b64_tr_b16 a[222:223], v218 offset:31744
    s_waitcnt vmcnt(4)
    ds_read_b64_tr_b16 a[224:225], v217 offset:32768
    ds_read_b64_tr_b16 a[226:227], v217 offset:33792
    ds_read_b64_tr_b16 a[228:229], v218 offset:32768
    ds_read_b64_tr_b16 a[230:231], v218 offset:33792
    s_waitcnt vmcnt(2)
    ds_read_b64_tr_b16 a[232:233], v217 offset:34816
    ds_read_b64_tr_b16 a[234:235], v217 offset:35840
    ds_read_b64_tr_b16 a[236:237], v218 offset:34816
    ds_read_b64_tr_b16 a[238:239], v218 offset:35840
    s_waitcnt vmcnt(0)
    v_mov_b32 v8, s4
    s_mov_b64 exec, 1
    buffer_store_dword v8, v9, s[40:43], s82 offen sc1
    s_mov_b64 exec, -1
    s_add_u32 m0, s70, 0
    s_mul_i32 s73, s51, 64
    s_add_u32 s73, s73, 131072
    buffer_load_dwordx4 v214, s[24:27], s73 offen lds
    s_add_u32 m0, s70, 1024
    s_mul_i32 s73, s51, 64
    s_add_u32 s73, s73, 163840
    buffer_load_dwordx4 v214, s[24:27], s73 offen lds
    s_add_u32 m0, s70, 2048
    s_mul_i32 s73, s51, 64
    s_add_u32 s73, s73, 196608
    buffer_load_dwordx4 v214, s[24:27], s73 offen lds
    s_add_u32 m0, s70, 3072
    s_mul_i32 s73, s51, 64
    s_add_u32 s73, s73, 229376
    buffer_load_dwordx4 v214, s[24:27], s73 offen lds
    s_add_u32 m0, s70, 4096
    s_mul_i32 s73, s52, 64
    s_add_u32 s73, s73, 0
    buffer_load_dwordx4 v214, s[24:27], s73 offen lds
    s_add_u32 m0, s70, 5120
    s_mul_i32 s73, s52, 64
    s_add_u32 s73, s73, 32768
    buffer_load_dwordx4 v214, s[24:27], s73 offen lds
    s_add_u32 m0, s70, 6144
    s_mul_i32 s73, s52, 64
    s_add_u32 s73, s73, 65536
    buffer_load_dwordx4 v214, s[24:27], s73 offen lds
    s_add_u32 m0, s70, 7168
    s_mul_i32 s73, s52, 64
    s_add_u32 s73, s73, 98304
    buffer_load_dwordx4 v214, s[24:27], s73 offen lds
    s_add_u32 m0, s70, 8192
    s_mul_i32 s73, s52, 64
    s_add_u32 s73, s73, 131072
    buffer_load_dwordx4 v214, s[24:27], s73 offen lds
    s_add_u32 m0, s70, 9216
    s_mul_i32 s73, s52, 64
    s_add_u32 s73, s73, 163840
    buffer_load_dwordx4 v214, s[24:27], s73 offen lds
    s_add_u32 m0, s70, 10240
    s_mul_i32 s73, s52, 64
    s_add_u32 s73, s73, 196608
    buffer_load_dwordx4 v214, s[24:27], s73 offen lds
    s_add_u32 m0, s70, 11264
    s_mul_i32 s73, s52, 64
    s_add_u32 s73, s73, 229376
    buffer_load_dwordx4 v214, s[24:27], s73 offen lds
    s_waitcnt lgkmcnt(15)
    s_add_u32 m0, s70, 12288
    s_mul_i32 s73, s53, 64
    s_add_u32 s73, s73, 0
    buffer_load_dwordx4 v214, s[24:27], s73 offen lds
    s_add_u32 m0, s70, 13312
    s_mul_i32 s73, s53, 64
    s_add_u32 s73, s73, 32768
    buffer_load_dwordx4 v214, s[24:27], s73 offen lds
    s_add_u32 m0, s70, 14336
    s_mul_i32 s73, s53, 64
    s_add_u32 s73, s73, 65536
    buffer_load_dwordx4 v214, s[24:27], s73 offen lds
    s_add_u32 m0, s70, 15360
    s_mul_i32 s73, s53, 64
    s_add_u32 s73, s73, 98304
    buffer_load_dwordx4 v214, s[24:27], s73 offen lds
    s_add_u32 m0, s70, 16384
    s_mul_i32 s73, s53, 64
    s_add_u32 s73, s73, 131072
    buffer_load_dwordx4 v214, s[24:27], s73 offen lds
    s_add_u32 m0, s70, 17408
    s_mul_i32 s73, s53, 64
    s_add_u32 s73, s73, 163840
    buffer_load_dwordx4 v214, s[24:27], s73 offen lds
    s_add_u32 m0, s70, 18432
    s_mul_i32 s73, s53, 64
    s_add_u32 s73, s73, 196608
    buffer_load_dwordx4 v214, s[24:27], s73 offen lds
    s_add_u32 m0, s70, 19456
    s_mul_i32 s73, s53, 64
    s_add_u32 s73, s73, 229376
    buffer_load_dwordx4 v214, s[24:27], s73 offen lds
    s_add_u32 m0, s70, 20480
    s_mul_i32 s73, s54, 64
    s_add_u32 s73, s73, 0
    buffer_load_dwordx4 v214, s[24:27], s73 offen lds
    s_add_u32 m0, s70, 21504
    s_mul_i32 s73, s54, 64
    s_add_u32 s73, s73, 32768
    buffer_load_dwordx4 v214, s[24:27], s73 offen lds
    s_add_u32 m0, s70, 22528
    s_mul_i32 s73, s54, 64
    s_add_u32 s73, s73, 65536
    buffer_load_dwordx4 v214, s[24:27], s73 offen lds
    s_add_u32 m0, s70, 23552
    s_mul_i32 s73, s54, 64
    s_add_u32 s73, s73, 98304
    buffer_load_dwordx4 v214, s[24:27], s73 offen lds
    s_add_u32 m0, s70, 24576
    s_mul_i32 s73, s54, 64
    s_add_u32 s73, s73, 131072
    buffer_load_dwordx4 v214, s[24:27], s73 offen lds
    s_add_u32 m0, s70, 25600
    s_mul_i32 s73, s54, 64
    s_add_u32 s73, s73, 163840
    buffer_load_dwordx4 v214, s[24:27], s73 offen lds
    s_add_u32 m0, s70, 26624
    s_mul_i32 s73, s54, 64
    s_add_u32 s73, s73, 196608
    buffer_load_dwordx4 v214, s[24:27], s73 offen lds
    s_add_u32 m0, s70, 27648
    s_mul_i32 s73, s54, 64
    s_add_u32 s73, s73, 229376
    buffer_load_dwordx4 v214, s[24:27], s73 offen lds
    v_lshrrev_b32 v220, 5, v1
    v_lshlrev_b32 v220, 3, v220
    s_lshl_b32 s68, s67, 7
    s_lshr_b32 s69, s3, 1
    s_lshl_b32 s69, s69, 6
    s_add_u32 s68, s68, s69
    buffer_load_dwordx2 v[222:223], v220, s[32:35], s68 offen offset:0
    buffer_load_dwordx2 v[224:225], v220, s[32:35], s68 offen offset:16
    buffer_load_dwordx2 v[226:227], v220, s[32:35], s68 offen offset:32
    buffer_load_dwordx2 v[228:229], v220, s[32:35], s68 offen offset:48
    s_lshl_b32 s68, s66, 1
    s_and_b32 s69, s3, 1
    s_add_u32 s71, s68, s69
    s_xor_b32 s72, s71, 1
    s_mul_i32 s68, s3, 28672
    s_add_u32 s68, s68, 0x3c0000
    s_mul_i32 s71, s71, 114688
    s_add_u32 s71, s71, s68
    s_mul_i32 s72, s72, 114688
    s_add_u32 s72, s72, s68
    buffer_load_dword v249, v12, s[40:43], s85 offen sc1
    s_sleep 3
    buffer_load_dword v250, v12, s[40:43], s85 offen sc1
    s_sleep 3
    s_nop 0
Lpoll_P_10:
    s_sub_u32 s6, s6, 1
    s_cbranch_scc1 L_end_P
    buffer_load_dword v251, v12, s[40:43], s85 offen sc1
    s_waitcnt vmcnt(2)
    v_cmp_ne_u32 vcc, s4, v249
    s_nop 1
    s_cbranch_vccz Lpd_P_11
    buffer_load_dword v249, v12, s[40:43], s85 offen sc1
    s_waitcnt vmcnt(2)
    v_cmp_ne_u32 vcc, s4, v250
    s_nop 1
    s_cbranch_vccz Lpd_P_11
    buffer_load_dword v250, v12, s[40:43], s85 offen sc1
    s_waitcnt vmcnt(2)
    v_cmp_ne_u32 vcc, s4, v251
    s_nop 1
    s_cbranch_vccnz Lpoll_P_10
    s_nop 1
Lpd_P_11:
    s_add_u32 s56, s71, s48
    s_add_u32 s57, s72, s48
    buffer_load_dwordx4 v[80:83], v4, s[40:43], s56 offen offset:0 sc1
    buffer_load_dwordx4 v[84:87], v4, s[40:43], s57 offen offset:0 sc1
    buffer_load_dwordx4 v[88:91], v4, s[40:43], s56 offen offset:1024 sc1
    buffer_load_dwordx4 v[92:95], v4, s[40:43], s57 offen offset:1024 sc1
    buffer_load_dwordx4 v[96:99], v4, s[40:43], s56 offen offset:2048 sc1
    buffer_load_dwordx4 v[100:103], v4, s[40:43], s57 offen offset:2048 sc1
    buffer_load_dwordx4 v[104:107], v4, s[40:43], s56 offen offset:3072 sc1
    buffer_load_dwordx4 v[108:111], v4, s[40:43], s57 offen offset:3072 sc1
    s_add_u32 s56, s71, s49
    s_add_u32 s57, s72, s49
    buffer_load_dwordx4 v[112:115], v4, s[40:43], s56 offen offset:0 sc1
    buffer_load_dwordx4 v[116:119], v4, s[40:43], s57 offen offset:0 sc1
    buffer_load_dwordx4 v[120:123], v4, s[40:43], s56 offen offset:1024 sc1
    buffer_load_dwordx4 v[124:127], v4, s[40:43], s57 offen offset:1024 sc1
    v_lshlrev_b32 v16, 16, v222
    v_and_b32 v17, 0xffff0000, v222
    v_lshlrev_b32 v238, 16, v240
    v_and_b32 v239, 0xffff0000, v240
    v_pk_add_f32 v[16:17], v[16:17], v[238:239]
    v_lshlrev_b32 v18, 16, v223
    v_and_b32 v19, 0xffff0000, v223
    v_lshlrev_b32 v238, 16, v241
    v_and_b32 v239, 0xffff0000, v241
    v_pk_add_f32 v[18:19], v[18:19], v[238:239]
    v_lshlrev_b32 v20, 16, v224
    v_and_b32 v21, 0xffff0000, v224
    v_lshlrev_b32 v238, 16, v242
    v_and_b32 v239, 0xffff0000, v242
    v_pk_add_f32 v[20:21], v[20:21], v[238:239]
    v_lshlrev_b32 v22, 16, v225
    v_and_b32 v23, 0xffff0000, v225
    v_lshlrev_b32 v238, 16, v243
    v_and_b32 v239, 0xffff0000, v243
    v_pk_add_f32 v[22:23], v[22:23], v[238:239]
    v_lshlrev_b32 v24, 16, v226
    v_and_b32 v25, 0xffff0000, v226
    v_lshlrev_b32 v238, 16, v244
    v_and_b32 v239, 0xffff0000, v244
    v_pk_add_f32 v[24:25], v[24:25], v[238:239]
    v_lshlrev_b32 v26, 16, v227
    v_and_b32 v27, 0xffff0000, v227
    v_lshlrev_b32 v238, 16, v245
    v_and_b32 v239, 0xffff0000, v245
    v_pk_add_f32 v[26:27], v[26:27], v[238:239]
    v_lshlrev_b32 v28, 16, v228
    v_and_b32 v29, 0xffff0000, v228
    v_lshlrev_b32 v238, 16, v246
    v_and_b32 v239, 0xffff0000, v246
    v_pk_add_f32 v[28:29], v[28:29], v[238:239]
    v_lshlrev_b32 v30, 16, v229
    v_and_b32 v31, 0xffff0000, v229
    v_lshlrev_b32 v238, 16, v247
    v_and_b32 v239, 0xffff0000, v247
    v_pk_add_f32 v[30:31], v[30:31], v[238:239]
    buffer_load_dwordx4 v[128:131], v4, s[40:43], s56 offen offset:2048 sc1
    buffer_load_dwordx4 v[132:135], v4, s[40:43], s57 offen offset:2048 sc1
    buffer_load_dwordx4 v[136:139], v4, s[40:43], s56 offen offset:3072 sc1
    buffer_load_dwordx4 v[140:143], v4, s[40:43], s57 offen offset:3072 sc1
    s_waitcnt vmcnt(15)
    v_mfma_f32_32x32x16_bf16 v[16:31], a[128:131], v[80:83], v[16:31]
    s_waitcnt vmcnt(14)
    v_mfma_f32_32x32x16_bf16 v[32:47], a[128:131], v[84:87], 0
    v_mfma_f32_32x32x16_bf16 v[48:63], a[132:135], v[80:83], 0
    v_mfma_f32_32x32x16_bf16 v[64:79], a[132:135], v[84:87], 0
    ds_read_b64_tr_b16 a[240:241], v217 offset:0
    ds_read_b64_tr_b16 a[242:243], v217 offset:1024
    ds_read_b64_tr_b16 a[244:245], v218 offset:0
    ds_read_b64_tr_b16 a[246:247], v218 offset:1024
    s_add_u32 s56, s71, s50
    s_add_u32 s57, s72, s50
    buffer_load_dwordx4 v[144:147], v4, s[40:43], s56 offen offset:0 sc1
    buffer_load_dwordx4 v[148:151], v4, s[40:43], s57 offen offset:0 sc1
    buffer_load_dwordx4 v[152:155], v4, s[40:43], s56 offen offset:1024 sc1
    buffer_load_dwordx4 v[156:159], v4, s[40:43], s57 offen offset:1024 sc1
    s_waitcnt vmcnt(17)
    v_mfma_f32_32x32x16_bf16 v[16:31], a[136:139], v[88:91], v[16:31]
    s_waitcnt vmcnt(16)
    v_mfma_f32_32x32x16_bf16 v[32:47], a[136:139], v[92:95], v[32:47]
    v_mfma_f32_32x32x16_bf16 v[48:63], a[140:143], v[88:91], v[48:63]
    v_mfma_f32_32x32x16_bf16 v[64:79], a[140:143], v[92:95], v[64:79]
    ds_read_b64_tr_b16 a[248:249], v217 offset:2048
    ds_read_b64_tr_b16 a[250:251], v217 offset:3072
    ds_read_b64_tr_b16 a[252:253], v218 offset:2048
    ds_read_b64_tr_b16 a[254:255], v218 offset:3072
    buffer_load_dwordx4 v[160:163], v4, s[40:43], s56 offen offset:2048 sc1
    buffer_load_dwordx4 v[164:167], v4, s[40:43], s57 offen offset:2048 sc1
    buffer_load_dwordx4 v[168:171], v4, s[40:43], s56 offen offset:3072 sc1
    buffer_load_dwordx4 v[172:175], v4, s[40:43], s57 offen offset:3072 sc1
    s_waitcnt vmcnt(19)
    v_mfma_f32_32x32x16_bf16 v[16:31], a[144:147], v[96:99], v[16:31]
    s_waitcnt vmcnt(18)
    v_mfma_f32_32x32x16_bf16 v[32:47], a[144:147], v[100:103], v[32:47]
    v_mfma_f32_32x32x16_bf16 v[48:63], a[148:151], v[96:99], v[48:63]
    v_mfma_f32_32x32x16_bf16 v[64:79], a[148:151], v[100:103], v[64:79]
    ds_read_b64_tr_b16 a[0:1], v217 offset:4096
    ds_read_b64_tr_b16 a[2:3], v217 offset:5120
    ds_read_b64_tr_b16 a[4:5], v218 offset:4096
    ds_read_b64_tr_b16 a[6:7], v218 offset:5120
    s_add_u32 s56, s71, s51
    s_add_u32 s57, s72, s51
    buffer_load_dwordx4 v[176:179], v4, s[40:43], s56 offen offset:0 sc1
    buffer_load_dwordx4 v[180:183], v4, s[40:43], s57 offen offset:0 sc1
    buffer_load_dwordx4 v[184:187], v4, s[40:43], s56 offen offset:1024 sc1
    buffer_load_dwordx4 v[188:191], v4, s[40:43], s57 offen offset:1024 sc1
    s_waitcnt vmcnt(21)
    v_mfma_f32_32x32x16_bf16 v[16:31], a[152:155], v[104:107], v[16:31]
    s_waitcnt vmcnt(20)
    v_mfma_f32_32x32x16_bf16 v[32:47], a[152:155], v[108:111], v[32:47]
    v_mfma_f32_32x32x16_bf16 v[48:63], a[156:159], v[104:107], v[48:63]
    v_mfma_f32_32x32x16_bf16 v[64:79], a[156:159], v[108:111], v[64:79]
    ds_read_b64_tr_b16 a[8:9], v217 offset:6144
    ds_read_b64_tr_b16 a[10:11], v217 offset:7168
    ds_read_b64_tr_b16 a[12:13], v218 offset:6144
    ds_read_b64_tr_b16 a[14:15], v218 offset:7168
    buffer_load_dwordx4 v[192:195], v4, s[40:43], s56 offen offset:2048 sc1
    buffer_load_dwordx4 v[196:199], v4, s[40:43], s57 offen offset:2048 sc1
    buffer_load_dwordx4 v[200:203], v4, s[40:43], s56 offen offset:3072 sc1
    buffer_load_dwordx4 v[204:207], v4, s[40:43], s57 offen offset:3072 sc1
    s_waitcnt vmcnt(23)
    v_mfma_f32_32x32x16_bf16 v[16:31], a[160:163], v[112:115], v[16:31]
    s_waitcnt vmcnt(22)
    v_mfma_f32_32x32x16_bf16 v[32:47], a[160:163], v[116:119], v[32:47]
    v_mfma_f32_32x32x16_bf16 v[48:63], a[164:167], v[112:115], v[48:63]
    v_mfma_f32_32x32x16_bf16 v[64:79], a[164:167], v[116:119], v[64:79]
    ds_read_b64_tr_b16 a[16:17], v217 offset:8192
    ds_read_b64_tr_b16 a[18:19], v217 offset:9216
    ds_read_b64_tr_b16 a[20:21], v218 offset:8192
    ds_read_b64_tr_b16 a[22:23], v218 offset:9216
    s_add_u32 s56, s71, s52
    s_add_u32 s57, s72, s52
    buffer_load_dwordx4 v[80:83], v4, s[40:43], s56 offen offset:0 sc1
    buffer_load_dwordx4 v[84:87], v4, s[40:43], s57 offen offset:0 sc1
    buffer_load_dwordx4 v[88:91], v4, s[40:43], s56 offen offset:1024 sc1
    buffer_load_dwordx4 v[92:95], v4, s[40:43], s57 offen offset:1024 sc1
    s_waitcnt vmcnt(25)
    v_mfma_f32_32x32x16_bf16 v[16:31], a[168:171], v[120:123], v[16:31]
    s_waitcnt vmcnt(24)
    v_mfma_f32_32x32x16_bf16 v[32:47], a[168:171], v[124:127], v[32:47]
    v_mfma_f32_32x32x16_bf16 v[48:63], a[172:175], v[120:123], v[48:63]
    v_mfma_f32_32x32x16_bf16 v[64:79], a[172:175], v[124:127], v[64:79]
    ds_read_b64_tr_b16 a[24:25], v217 offset:10240
    ds_read_b64_tr_b16 a[26:27], v217 offset:11264
    ds_read_b64_tr_b16 a[28:29], v218 offset:10240
    ds_read_b64_tr_b16 a[30:31], v218 offset:11264
    buffer_load_dwordx4 v[96:99], v4, s[40:43], s56 offen offset:2048 sc1
    buffer_load_dwordx4 v[100:103], v4, s[40:43], s57 offen offset:2048 sc1
    buffer_load_dwordx4 v[104:107], v4, s[40:43], s56 offen offset:3072 sc1
    buffer_load_dwordx4 v[108:111], v4, s[40:43], s57 offen offset:3072 sc1
    s_waitcnt vmcnt(27)
    v_mfma_f32_32x32x16_bf16 v[16:31], a[176:179], v[128:131], v[16:31]
    s_waitcnt vmcnt(26)
    v_mfma_f32_32x32x16_bf16 v[32:47], a[176:179], v[132:135], v[32:47]
    v_mfma_f32_32x32x16_bf16 v[48:63], a[180:183], v[128:131], v[48:63]
    v_mfma_f32_32x32x16_bf16 v[64:79], a[180:183], v[132:135], v[64:79]
    ds_read_b64_tr_b16 a[32:33], v217 offset:12288
    ds_read_b64_tr_b16 a[34:35], v217 offset:13312
    ds_read_b64_tr_b16 a[36:37], v218 offset:12288
    ds_read_b64_tr_b16 a[38:39], v218 offset:13312
    s_add_u32 s56, s71, s53
    s_add_u32 s57, s72, s53
    buffer_load_dwordx4 v[112:115], v4, s[40:43], s56 offen offset:0 sc1
    buffer_load_dwordx4 v[116:119], v4, s[40:43], s57 offen offset:0 sc1
    buffer_load_dwordx4 v[120:123], v4, s[40:43], s56 offen offset:1024 sc1
    buffer_load_dwordx4 v[124:127], v4, s[40:43], s57 offen offset:1024 sc1
    s_waitcnt vmcnt(29)
    v_mfma_f32_32x32x16_bf16 v[16:31], a[184:187], v[136:139], v[16:31]
    s_waitcnt vmcnt(28)
    v_mfma_f32_32x32x16_bf16 v[32:47], a[184:187], v[140:143], v[32:47]
    v_mfma_f32_32x32x16_bf16 v[48:63], a[188:191], v[136:139], v[48:63]
    v_mfma_f32_32x32x16_bf16 v[64:79], a[188:191], v[140:143], v[64:79]
    ds_read_b64_tr_b16 a[40:41], v217 offset:14336
    ds_read_b64_tr_b16 a[42:43], v217 offset:15360
    ds_read_b64_tr_b16 a[44:45], v218 offset:14336
    ds_read_b64_tr_b16 a[46:47], v218 offset:15360
    buffer_load_dwordx4 v[128:131], v4, s[40:43], s56 offen offset:2048 sc1
    buffer_load_dwordx4 v[132:135], v4, s[40:43], s57 offen offset:2048 sc1
    buffer_load_dwordx4 v[136:139], v4, s[40:43], s56 offen offset:3072 sc1
    buffer_load_dwordx4 v[140:143], v4, s[40:43], s57 offen offset:3072 sc1
    s_waitcnt vmcnt(31)
    v_mfma_f32_32x32x16_bf16 v[16:31], a[192:195], v[144:147], v[16:31]
    s_waitcnt vmcnt(30)
    v_mfma_f32_32x32x16_bf16 v[32:47], a[192:195], v[148:151], v[32:47]
    v_mfma_f32_32x32x16_bf16 v[48:63], a[196:199], v[144:147], v[48:63]
    v_mfma_f32_32x32x16_bf16 v[64:79], a[196:199], v[148:151], v[64:79]
    ds_read_b64_tr_b16 a[48:49], v217 offset:16384
    ds_read_b64_tr_b16 a[50:51], v217 offset:17408
    ds_read_b64_tr_b16 a[52:53], v218 offset:16384
    ds_read_b64_tr_b16 a[54:55], v218 offset:17408
    s_add_u32 s56, s71, s54
    s_add_u32 s57, s72, s54
    buffer_load_dwordx4 v[144:147], v4, s[40:43], s56 offen offset:0 sc1
    buffer_load_dwordx4 v[148:151], v4, s[40:43], s57 offen offset:0 sc1
    s_waitcnt vmcnt(31)
    v_mfma_f32_32x32x16_bf16 v[16:31], a[200:203], v[152:155], v[16:31]
    s_waitcnt vmcnt(30)
    v_mfma_f32_32x32x16_bf16 v[32:47], a[200:203], v[156:159], v[32:47]
    v_mfma_f32_32x32x16_bf16 v[48:63], a[204:207], v[152:155], v[48:63]
    v_mfma_f32_32x32x16_bf16 v[64:79], a[204:207], v[156:159], v[64:79]
    ds_read_b64_tr_b16 a[56:57], v217 offset:18432
    ds_read_b64_tr_b16 a[58:59], v217 offset:19456
    ds_read_b64_tr_b16 a[60:61], v218 offset:18432
    ds_read_b64_tr_b16 a[62:63], v218 offset:19456
    buffer_load_dwordx4 v[152:155], v4, s[40:43], s56 offen offset:1024 sc1
    buffer_load_dwordx4 v[156:159], v4, s[40:43], s57 offen offset:1024 sc1
    s_waitcnt vmcnt(31) lgkmcnt(15)
    v_mfma_f32_32x32x16_bf16 v[16:31], a[208:211], v[160:163], v[16:31]
    s_waitcnt vmcnt(30)
    v_mfma_f32_32x32x16_bf16 v[32:47], a[208:211], v[164:167], v[32:47]
    v_mfma_f32_32x32x16_bf16 v[48:63], a[212:215], v[160:163], v[48:63]
    v_mfma_f32_32x32x16_bf16 v[64:79], a[212:215], v[164:167], v[64:79]
    ds_read_b64_tr_b16 a[64:65], v217 offset:20480
    ds_read_b64_tr_b16 a[66:67], v217 offset:21504
    ds_read_b64_tr_b16 a[68:69], v218 offset:20480
    ds_read_b64_tr_b16 a[70:71], v218 offset:21504
    buffer_load_dwordx4 v[160:163], v4, s[40:43], s56 offen offset:2048 sc1
    buffer_load_dwordx4 v[164:167], v4, s[40:43], s57 offen offset:2048 sc1
    s_waitcnt vmcnt(31)
    v_mfma_f32_32x32x16_bf16 v[16:31], a[216:219], v[168:171], v[16:31]
    s_waitcnt vmcnt(30)
    v_mfma_f32_32x32x16_bf16 v[32:47], a[216:219], v[172:175], v[32:47]
    v_mfma_f32_32x32x16_bf16 v[48:63], a[220:223], v[168:171], v[48:63]
    v_mfma_f32_32x32x16_bf16 v[64:79], a[220:223], v[172:175], v[64:79]
    ds_read_b64_tr_b16 a[72:73], v217 offset:22528
    ds_read_b64_tr_b16 a[74:75], v217 offset:23552
    ds_read_b64_tr_b16 a[76:77], v218 offset:22528
    ds_read_b64_tr_b16 a[78:79], v218 offset:23552
    buffer_load_dwordx4 v[168:171], v4, s[40:43], s56 offen offset:3072 sc1
    buffer_load_dwordx4 v[172:175], v4, s[40:43], s57 offen offset:3072 sc1
    s_waitcnt vmcnt(31)
    v_mfma_f32_32x32x16_bf16 v[16:31], a[224:227], v[176:179], v[16:31]
    s_waitcnt vmcnt(30)
    v_mfma_f32_32x32x16_bf16 v[32:47], a[224:227], v[180:183], v[32:47]
    v_mfma_f32_32x32x16_bf16 v[48:63], a[228:231], v[176:179], v[48:63]
    v_mfma_f32_32x32x16_bf16 v[64:79], a[228:231], v[180:183], v[64:79]
    ds_read_b64_tr_b16 a[80:81], v217 offset:24576
    ds_read_b64_tr_b16 a[82:83], v217 offset:25600
    ds_read_b64_tr_b16 a[84:85], v218 offset:24576
    ds_read_b64_tr_b16 a[86:87], v218 offset:25600
    s_waitcnt vmcnt(29)
    v_mfma_f32_32x32x16_bf16 v[16:31], a[232:235], v[184:187], v[16:31]
    s_waitcnt vmcnt(28)
    v_mfma_f32_32x32x16_bf16 v[32:47], a[232:235], v[188:191], v[32:47]
    v_mfma_f32_32x32x16_bf16 v[48:63], a[236:239], v[184:187], v[48:63]
    v_mfma_f32_32x32x16_bf16 v[64:79], a[236:239], v[188:191], v[64:79]
    ds_read_b64_tr_b16 a[88:89], v217 offset:26624
    ds_read_b64_tr_b16 a[90:91], v217 offset:27648
    ds_read_b64_tr_b16 a[92:93], v218 offset:26624
    ds_read_b64_tr_b16 a[94:95], v218 offset:27648
    s_waitcnt vmcnt(27)
    v_mfma_f32_32x32x16_bf16 v[16:31], a[240:243], v[192:195], v[16:31]
    s_waitcnt vmcnt(26)
    v_mfma_f32_32x32x16_bf16 v[32:47], a[240:243], v[196:199], v[32:47]
    v_mfma_f32_32x32x16_bf16 v[48:63], a[244:247], v[192:195], v[48:63]
    v_mfma_f32_32x32x16_bf16 v[64:79], a[244:247], v[196:199], v[64:79]
    s_waitcnt vmcnt(25)
    v_mfma_f32_32x32x16_bf16 v[16:31], a[248:251], v[200:203], v[16:31]
    s_waitcnt vmcnt(24)
    v_mfma_f32_32x32x16_bf16 v[32:47], a[248:251], v[204:207], v[32:47]
    v_mfma_f32_32x32x16_bf16 v[48:63], a[252:255], v[200:203], v[48:63]
    v_mfma_f32_32x32x16_bf16 v[64:79], a[252:255], v[204:207], v[64:79]
    s_waitcnt vmcnt(23)
    v_mfma_f32_32x32x16_bf16 v[16:31], a[0:3], v[80:83], v[16:31]
    s_waitcnt vmcnt(22)
    v_mfma_f32_32x32x16_bf16 v[32:47], a[0:3], v[84:87], v[32:47]
    v_mfma_f32_32x32x16_bf16 v[48:63], a[4:7], v[80:83], v[48:63]
    v_mfma_f32_32x32x16_bf16 v[64:79], a[4:7], v[84:87], v[64:79]
    s_waitcnt vmcnt(21)
    v_mfma_f32_32x32x16_bf16 v[16:31], a[8:11], v[88:91], v[16:31]
    s_waitcnt vmcnt(20)
    v_mfma_f32_32x32x16_bf16 v[32:47], a[8:11], v[92:95], v[32:47]
    v_mfma_f32_32x32x16_bf16 v[48:63], a[12:15], v[88:91], v[48:63]
    v_mfma_f32_32x32x16_bf16 v[64:79], a[12:15], v[92:95], v[64:79]
    v_lshrrev_b32 v220, 5, v1
    v_lshlrev_b32 v220, 10, v220
    v_and_b32 v221, 31, v1
    v_lshl_add_u32 v220, v221, 2, v220
    s_lshr_b32 s69, s3, 1
    s_lshl_b32 s68, s69, 13
    s_and_b32 s69, s3, 1
    s_lshl_b32 s69, s69, 7
    s_add_u32 s68, s68, s69
    v_add_u32 v220, s68, v220
    v_xor_b32 v221, 128, v220
    v_xor_b32 v222, 0x2000, v220
    v_xor_b32 v223, 0x2080, v220
    s_mul_i32 s68, s3, 36864
    s_add_u32 s68, s68, 12288
    v_add_u32 v220, s68, v220
    v_add_u32 v221, s68, v221
    v_add_u32 v222, s68, v222
    v_add_u32 v223, s68, v223
    s_lshl_b32 s68, s3, 12
    s_add_u32 s68, s68, 12288
    v_add_u32 v224, s68, v4
    v_add_u32 v226, 73728, v224
    v_mul_u32_u24 v225, 896, v3
    v_lshl_add_u32 v225, v2, 3, v225
    s_lshl_b32 s68, s67, 2
    s_add_u32 s68, s68, s3
    s_mul_i32 s68, s68, 14336
    s_lshl_b32 s69, s66, 7
    s_add_u32 s68, s68, s69
    s_add_u32 s69, s68, 7168
    s_waitcnt vmcnt(19)
    v_mfma_f32_32x32x16_bf16 v[16:31], a[16:19], v[96:99], v[16:31]
    s_waitcnt vmcnt(18)
    v_mfma_f32_32x32x16_bf16 v[32:47], a[16:19], v[100:103], v[32:47]
    v_mfma_f32_32x32x16_bf16 v[48:63], a[20:23], v[96:99], v[48:63]
    v_mfma_f32_32x32x16_bf16 v[64:79], a[20:23], v[100:103], v[64:79]
    s_waitcnt vmcnt(17)
    v_mfma_f32_32x32x16_bf16 v[16:31], a[24:27], v[104:107], v[16:31]
    s_waitcnt vmcnt(16)
    v_mfma_f32_32x32x16_bf16 v[32:47], a[24:27], v[108:111], v[32:47]
    v_mfma_f32_32x32x16_bf16 v[48:63], a[28:31], v[104:107], v[48:63]
    v_mfma_f32_32x32x16_bf16 v[64:79], a[28:31], v[108:111], v[64:79]
    s_waitcnt vmcnt(15) lgkmcnt(15)
    v_mfma_f32_32x32x16_bf16 v[16:31], a[32:35], v[112:115], v[16:31]
    s_waitcnt vmcnt(14)
    v_mfma_f32_32x32x16_bf16 v[32:47], a[32:35], v[116:119], v[32:47]
    v_mfma_f32_32x32x16_bf16 v[48:63], a[36:39], v[112:115], v[48:63]
    v_mfma_f32_32x32x16_bf16 v[64:79], a[36:39], v[116:119], v[64:79]
    s_waitcnt vmcnt(13)
    v_mfma_f32_32x32x16_bf16 v[16:31], a[40:43], v[120:123], v[16:31]
    s_waitcnt vmcnt(12)
    v_mfma_f32_32x32x16_bf16 v[32:47], a[40:43], v[124:127], v[32:47]
    v_mfma_f32_32x32x16_bf16 v[48:63], a[44:47], v[120:123], v[48:63]
    v_mfma_f32_32x32x16_bf16 v[64:79], a[44:47], v[124:127], v[64:79]
    s_waitcnt vmcnt(11)
    v_mfma_f32_32x32x16_bf16 v[16:31], a[48:51], v[128:131], v[16:31]
    s_waitcnt vmcnt(10)
    v_mfma_f32_32x32x16_bf16 v[32:47], a[48:51], v[132:135], v[32:47]
    v_mfma_f32_32x32x16_bf16 v[48:63], a[52:55], v[128:131], v[48:63]
    v_mfma_f32_32x32x16_bf16 v[64:79], a[52:55], v[132:135], v[64:79]
    s_waitcnt vmcnt(9)
    v_mfma_f32_32x32x16_bf16 v[16:31], a[56:59], v[136:139], v[16:31]
    s_waitcnt vmcnt(8)
    v_mfma_f32_32x32x16_bf16 v[32:47], a[56:59], v[140:143], v[32:47]
    v_mfma_f32_32x32x16_bf16 v[48:63], a[60:63], v[136:139], v[48:63]
    v_mfma_f32_32x32x16_bf16 v[64:79], a[60:63], v[140:143], v[64:79]
    s_waitcnt vmcnt(7) lgkmcnt(14)
    v_mfma_f32_32x32x16_bf16 v[16:31], a[64:67], v[144:147], v[16:31]
    s_waitcnt vmcnt(6)
    v_mfma_f32_32x32x16_bf16 v[32:47], a[64:67], v[148:151], v[32:47]
    s_waitcnt lgkmcnt(12)
    v_mfma_f32_32x32x16_bf16 v[48:63], a[68:71], v[144:147], v[48:63]
    v_mfma_f32_32x32x16_bf16 v[64:79], a[68:71], v[148:151], v[64:79]
    s_waitcnt vmcnt(5) lgkmcnt(10)
    v_mfma_f32_32x32x16_bf16 v[16:31], a[72:75], v[152:155], v[16:31]
    s_waitcnt vmcnt(4)
    v_mfma_f32_32x32x16_bf16 v[32:47], a[72:75], v[156:159], v[32:47]
    s_waitcnt lgkmcnt(8)
    v_mfma_f32_32x32x16_bf16 v[48:63], a[76:79], v[152:155], v[48:63]
    v_mfma_f32_32x32x16_bf16 v[64:79], a[76:79], v[156:159], v[64:79]
    s_waitcnt vmcnt(3) lgkmcnt(6)
    v_mfma_f32_32x32x16_bf16 v[16:31], a[80:83], v[160:163], v[16:31]
    s_waitcnt vmcnt(2)
    v_mfma_f32_32x32x16_bf16 v[32:47], a[80:83], v[164:167], v[32:47]
    s_waitcnt lgkmcnt(4)
    v_mfma_f32_32x32x16_bf16 v[48:63], a[84:87], v[160:163], v[48:63]
    v_mfma_f32_32x32x16_bf16 v[64:79], a[84:87], v[164:167], v[64:79]
    s_waitcnt vmcnt(1) lgkmcnt(2)
    v_mfma_f32_32x32x16_bf16 v[16:31], a[88:91], v[168:171], v[16:31]
    s_waitcnt vmcnt(0)
    v_mfma_f32_32x32x16_bf16 v[32:47], a[88:91], v[172:175], v[32:47]
    s_waitcnt lgkmcnt(0)
    v_mfma_f32_32x32x16_bf16 v[48:63], a[92:95], v[168:171], v[48:63]
    v_mfma_f32_32x32x16_bf16 v[64:79], a[92:95], v[172:175], v[64:79]
    s_nop 6
    ds_write2st64_b32 v220, v16, v17 offset0:0 offset1:1
    ds_write2st64_b32 v220, v18, v19 offset0:2 offset1:3
    ds_write2st64_b32 v220, v20, v21 offset0:8 offset1:9
    ds_write2st64_b32 v220, v22, v23 offset0:10 offset1:11
    ds_write2st64_b32 v220, v24, v25 offset0:16 offset1:17
    ds_write2st64_b32 v220, v26, v27 offset0:18 offset1:19
    ds_write2st64_b32 v220, v28, v29 offset0:24 offset1:25
    ds_write2st64_b32 v220, v30, v31 offset0:26 offset1:27
    ds_write2st64_b32 v221, v32, v33 offset0:0 offset1:1
    ds_write2st64_b32 v221, v34, v35 offset0:2 offset1:3
    ds_write2st64_b32 v221, v36, v37 offset0:8 offset1:9
    ds_write2st64_b32 v221, v38, v39 offset0:10 offset1:11
    ds_write2st64_b32 v221, v40, v41 offset0:16 offset1:17
    ds_write2st64_b32 v221, v42, v43 offset0:18 offset1:19
    ds_write2st64_b32 v221, v44, v45 offset0:24 offset1:25
    ds_write2st64_b32 v221, v46, v47 offset0:26 offset1:27
    ds_write2st64_b32 v222, v48, v49 offset0:0 offset1:1
    ds_write2st64_b32 v222, v50, v51 offset0:2 offset1:3
    ds_write2st64_b32 v222, v52, v53 offset0:8 offset1:9
    ds_write2st64_b32 v222, v54, v55 offset0:10 offset1:11
    ds_write2st64_b32 v222, v56, v57 offset0:16 offset1:17
    ds_write2st64_b32 v222, v58, v59 offset0:18 offset1:19
    ds_write2st64_b32 v222, v60, v61 offset0:24 offset1:25
    ds_write2st64_b32 v222, v62, v63 offset0:26 offset1:27
    ds_write2st64_b32 v223, v64, v65 offset0:0 offset1:1
    ds_write2st64_b32 v223, v66, v67 offset0:2 offset1:3
    ds_write2st64_b32 v223, v68, v69 offset0:8 offset1:9
    ds_write2st64_b32 v223, v70, v71 offset0:10 offset1:11
    ds_write2st64_b32 v223, v72, v73 offset0:16 offset1:17
    ds_write2st64_b32 v223, v74, v75 offset0:18 offset1:19
    ds_write2st64_b32 v223, v76, v77 offset0:24 offset1:25
    ds_write2st64_b32 v223, v78, v79 offset0:26 offset1:27
    s_waitcnt lgkmcnt(0)
    s_barrier
    ds_read_b128 v[16:19], v224 offset:0
    ds_read_b128 v[20:23], v224 offset:36864
    ds_read_b128 v[24:27], v226 offset:0
    ds_read_b128 v[28:31], v226 offset:36864
    ds_read_b128 v[32:35], v224 offset:1024
    ds_read_b128 v[36:39], v224 offset:37888
    ds_read_b128 v[40:43], v226 offset:1024
    ds_read_b128 v[44:47], v226 offset:37888
    ds_read_b128 v[48:51], v224 offset:2048
    ds_read_b128 v[52:55], v224 offset:38912
    ds_read_b128 v[56:59], v226 offset:2048
    ds_read_b128 v[60:63], v226 offset:38912
    ds_read_b128 v[64:67], v224 offset:3072
    ds_read_b128 v[68:71], v224 offset:39936
    ds_read_b128 v[72:75], v226 offset:3072
    ds_read_b128 v[76:79], v226 offset:39936
    s_waitcnt lgkmcnt(14)
    v_pk_add_f32 v[16:17], v[16:17], v[20:21]
    s_waitcnt lgkmcnt(12)
    v_pk_add_f32 v[24:25], v[24:25], v[28:29]
    v_pk_add_f32 v[18:19], v[18:19], v[22:23]
    v_pk_add_f32 v[26:27], v[26:27], v[30:31]
    v_pk_add_f32 v[16:17], v[16:17], v[24:25]
    v_pk_add_f32 v[18:19], v[18:19], v[26:27]
    v_cvt_pk_bf16_f32 v20, v16, v17
    v_cvt_pk_bf16_f32 v21, v18, v19
    buffer_store_dwordx2 v[20:21], v225, s[36:39], s68 offen offset:0
    s_waitcnt lgkmcnt(10)
    v_pk_add_f32 v[32:33], v[32:33], v[36:37]
    s_waitcnt lgkmcnt(8)
    v_pk_add_f32 v[40:41], v[40:41], v[44:45]
    v_pk_add_f32 v[34:35], v[34:35], v[38:39]
    v_pk_add_f32 v[42:43], v[42:43], v[46:47]
    v_pk_add_f32 v[32:33], v[32:33], v[40:41]
    v_pk_add_f32 v[34:35], v[34:35], v[42:43]
    v_cvt_pk_bf16_f32 v36, v32, v33
    v_cvt_pk_bf16_f32 v37, v34, v35
    buffer_store_dwordx2 v[36:37], v225, s[36:39], s68 offen offset:3584
    s_waitcnt lgkmcnt(6)
    v_pk_add_f32 v[48:49], v[48:49], v[52:53]
    s_waitcnt lgkmcnt(4)
    v_pk_add_f32 v[56:57], v[56:57], v[60:61]
    v_pk_add_f32 v[50:51], v[50:51], v[54:55]
    v_pk_add_f32 v[58:59], v[58:59], v[62:63]
    v_pk_add_f32 v[48:49], v[48:49], v[56:57]
    v_pk_add_f32 v[50:51], v[50:51], v[58:59]
    v_cvt_pk_bf16_f32 v52, v48, v49
    v_cvt_pk_bf16_f32 v53, v50, v51
    buffer_store_dwordx2 v[52:53], v225, s[36:39], s69 offen offset:0
    s_waitcnt lgkmcnt(2)
    v_pk_add_f32 v[64:65], v[64:65], v[68:69]
    s_waitcnt lgkmcnt(0)
    v_pk_add_f32 v[72:73], v[72:73], v[76:77]
    v_pk_add_f32 v[66:67], v[66:67], v[70:71]
    v_pk_add_f32 v[74:75], v[74:75], v[78:79]
    v_pk_add_f32 v[64:65], v[64:65], v[72:73]
    v_pk_add_f32 v[66:67], v[66:67], v[74:75]
    v_cvt_pk_bf16_f32 v68, v64, v65
    v_cvt_pk_bf16_f32 v69, v66, v67
    buffer_store_dwordx2 v[68:69], v225, s[36:39], s69 offen offset:3584
L_end_P:
    s_endpgm

.section .rodata,"a"
.p2align 6
.amdhsa_kernel sequential_preLN__sliding_local_dilated__mixer_token_mlp__prompt_kernel
  .amdhsa_next_free_vgpr 508
  .amdhsa_next_free_sgpr 102
  .amdhsa_accum_offset 252
  .amdhsa_group_segment_fixed_size 0
  .amdhsa_kernarg_size 88
  .amdhsa_user_sgpr_count 2
  .amdhsa_user_sgpr_kernarg_segment_ptr 1
  .amdhsa_system_sgpr_workgroup_id_x 1
.end_amdhsa_kernel
```

```asm
; @launch grid=(256,1,1) block=(256,1,1) lds=163840
.amdgcn_target "amdgcn-amd-amdhsa--gfx950"
.text
.globl sequential_preLN__sliding_local_dilated__mixer_token_mlp__prompt_kernel
.p2align 8
.type sequential_preLN__sliding_local_dilated__mixer_token_mlp__prompt_kernel,@function
sequential_preLN__sliding_local_dilated__mixer_token_mlp__prompt_kernel:
    s_cmp_ge_u32 s2, 256
    s_cbranch_scc1 L_end_P
    s_load_dwordx2 s[8:9], s[0:1], 0
    s_load_dwordx2 s[12:13], s[0:1], 8
    s_load_dwordx2 s[44:45], s[0:1], 72
    s_load_dwordx2 s[40:41], s[0:1], 80
    s_load_dwordx2 s[16:17], s[0:1], 16
    s_load_dwordx2 s[20:21], s[0:1], 32
    s_load_dwordx2 s[24:25], s[0:1], 48
    s_load_dwordx2 s[28:29], s[0:1], 40
    s_load_dwordx2 s[32:33], s[0:1], 56
    s_load_dwordx2 s[36:37], s[0:1], 64
    v_lshrrev_b32 v1, 6, v0
    s_nop 0
    v_readfirstlane_b32 s3, v1
    v_and_b32 v1, 63, v0
    v_and_b32 v2, 15, v0
    v_lshrrev_b32 v3, 4, v1
    v_lshlrev_b32 v4, 4, v1
    s_mov_b32 s10, 0x1c0000
    s_mov_b32 s11, 0x00020000
    s_mov_b32 s14, 0x126000
    s_mov_b32 s15, 0x00020000
    s_mov_b32 s46, 0x100
    s_mov_b32 s47, 0x00020000
    s_mov_b32 s42, 0x5c0000
    s_mov_b32 s43, 0x00020000
    s_mov_b32 s18, 0x62000
    s_mov_b32 s19, 0x00020000
    s_mov_b32 s22, 0x700000
    s_mov_b32 s23, 0x00020000
    s_mov_b32 s26, 0x700000
    s_mov_b32 s27, 0x00020000
    s_mov_b32 s30, 0xe00
    s_mov_b32 s31, 0x00020000
    s_mov_b32 s34, 0x1000
    s_mov_b32 s35, 0x00020000
    s_mov_b32 s38, 0x1c0000
    s_mov_b32 s39, 0x00020000
    s_mov_b32 s5, 0x3f803f80
    s_mov_b32 s6, 0x40000
    s_bfe_u32 s48, s2, 0x20001
    s_lshl_b32 s48, s48, 2
    s_lshr_b32 s53, s2, 6
    s_add_u32 s48, s48, s53
    s_bfe_u32 s49, s2, 0x30003
    s_and_b32 s53, s2, 1
    s_lshl_b32 s53, s53, 3
    s_add_u32 s49, s49, s53
    v_lshrrev_b32 v237, 2, v1
    v_mul_u32_u24 v123, 2688, v237
    v_lshrrev_b32 v237, 5, v1
    v_lshlrev_b32 v237, 1, v237
    v_and_b32 v238, 3, v1
    v_xor_b32 v237, v237, v238
    v_lshl_add_u32 v123, v237, 4, v123
    s_mul_i32 s53, s49, 56
    s_min_u32 s53, s53, 832
    s_mul_i32 s51, s3, 43008
    s_add_u32 s53, s53, s51
    v_add_u32 v123, s53, v123
    s_lshr_b32 s53, s3, 1
    s_mul_i32 s51, s53, 6144
    s_and_b32 s53, s3, 1
    s_lshl_b32 s53, s53, 10
    s_add_u32 s51, s51, s53
    v_lshrrev_b32 v237, 3, v1
    v_mul_u32_u24 v122, 896, v237
    v_and_b32 v237, 7, v1
    v_xor_b32 v237, v237, v3
    v_lshl_add_u32 v120, v237, 4, v122
    s_lshl_b32 s50, s48, 7
    s_lshl_b32 s53, s3, 5
    s_add_u32 s53, s53, s50
    s_mul_i32 s53, s53, 896
    v_xor_b32 v121, 64, v120
    v_add_u32 v120, s53, v120
    s_add_u32 s53, s53, 7168
    v_add_u32 v121, s53, v121
    s_lshl_b32 s53, s3, 1
    v_xor_b32 v237, s53, v237
    v_lshl_add_u32 v122, v237, 4, v122
    s_lshl_b32 s53, s3, 2
    s_add_u32 s53, s53, s50
    s_sub_u32 s53, s53, 16
    s_mul_i32 s53, s53, 896
    s_cmp_eq_u32 s48, 0
    s_cselect_b32 s53, 0x40000000, s53
    v_add_u32 v122, s53, v122
    s_lshl_b32 s52, s3, 12
    s_add_u32 s52, s52, 63488
    s_lshl_b32 s7, s3, 9
    s_cmp_eq_u32 s3, 0
    s_cselect_b32 s54, 0xffffff00, -1
    s_mov_b32 s55, 0
    s_memrealtime s[86:87]
    v_mov_b32 v7, 0
    s_waitcnt lgkmcnt(0)
    s_or_b32 s86, s86, 1
    v_mov_b32 v6, s86
    s_or_b32 s86, s2, s3
    s_cmp_eq_u32 s86, 0
    s_cselect_b64 exec, 1, 0
    buffer_store_dword v6, v7, s[44:47], 0 offen sc1
    s_mov_b64 exec, -1
    s_add_u32 m0, s51, 12288
    s_mov_b32 s73, 0
    buffer_load_dwordx4 v123, s[12:15], s73 offen lds
    s_add_u32 m0, s51, 14336
    s_mov_b32 s73, 896
    buffer_load_dwordx4 v123, s[12:15], s73 offen lds
    s_add_u32 m0, s51, 16384
    s_mov_b32 s73, 1792
    buffer_load_dwordx4 v123, s[12:15], s73 offen lds
    s_add_u32 m0, s52, 36864
    s_mov_b32 s73, 0
    buffer_load_dwordx4 v120, s[8:11], s73 offen lds
    s_add_u32 m0, s52, 37888
    s_mov_b32 s73, 0
    buffer_load_dwordx4 v121, s[8:11], s73 offen lds
    s_add_u32 m0, s52, 38912
    s_mov_b32 s73, 14336
    buffer_load_dwordx4 v120, s[8:11], s73 offen lds
    s_add_u32 m0, s52, 39936
    s_mov_b32 s73, 14336
    buffer_load_dwordx4 v121, s[8:11], s73 offen lds
    s_add_u32 m0, s7, 98304
    s_mov_b32 s73, 0
    s_mov_b64 exec, s[54:55]
    buffer_load_dwordx4 v122, s[8:11], s73 offen lds
    s_mov_b64 exec, -1
    s_add_u32 m0, s51, 24576
    s_mov_b32 s73, 172032
    buffer_load_dwordx4 v123, s[12:15], s73 offen lds
    s_add_u32 m0, s51, 26624
    s_mov_b32 s73, 172928
    buffer_load_dwordx4 v123, s[12:15], s73 offen lds
    s_add_u32 m0, s51, 28672
    s_mov_b32 s73, 173824
    buffer_load_dwordx4 v123, s[12:15], s73 offen lds
    s_add_u32 m0, s52, 18432
    s_mov_b32 s73, 128
    buffer_load_dwordx4 v120, s[8:11], s73 offen lds
    s_add_u32 m0, s52, 19456
    s_mov_b32 s73, 128
    buffer_load_dwordx4 v121, s[8:11], s73 offen lds
    s_add_u32 m0, s52, 20480
    s_mov_b32 s73, 14464
    buffer_load_dwordx4 v120, s[8:11], s73 offen lds
    s_add_u32 m0, s52, 21504
    s_mov_b32 s73, 14464
    buffer_load_dwordx4 v121, s[8:11], s73 offen lds
    s_add_u32 m0, s7, 79872
    s_mov_b32 s73, 128
    s_mov_b64 exec, s[54:55]
    buffer_load_dwordx4 v122, s[8:11], s73 offen lds
    s_mov_b64 exec, -1
    s_bfe_u32 s53, s2, 0x30003
    s_add_u32 s86, s53, 1
    s_lshr_b32 s86, s86, 1
    s_lshr_b32 s87, s2, 6
    s_mul_i32 s87, s87, 5
    s_add_u32 s86, s86, s87
    s_lshl_b32 s86, s86, 2
    s_add_u32 s53, s86, s3
    s_mov_b32 s86, 0x2a54
    s_bitcmp1_b32 s86, s49
    s_cselect_b32 s79, 0x40000000, 0
    s_mul_i32 s86, s53, 48
    v_add_u32 v237, s86, v1
    v_mul_u32_u24 v238, 43691, v237
    v_lshrrev_b32 v238, 19, v238
    v_mul_u32_u24 v239, 12, v238
    v_sub_u32 v239, v237, v239
    v_lshrrev_b32 v239, 2, v239
    v_mul_u32_u24 v239, 896, v239
    v_mul_u32_u24 v238, 2688, v238
    v_and_b32 v237, 3, v237
    v_lshlrev_b32 v237, 7, v237
    v_add3_u32 v237, v237, v238, v239
    v_add_u32 v237, s79, v237
    s_and_b32 s86, s2, 1
    s_mul_i32 s86, s86, 384
    s_add_u32 s86, s86, 344064
    s_mov_b32 exec_hi, 0xffff
    buffer_load_dword v232, v237, s[12:15], s86 offen
    v_lshlrev_b32 v237, 7, v1
    v_add_u32 v238, s79, v237
    s_mul_i32 s86, s53, 6016
    s_bfe_u32 s87, s2, 0x20001
    s_mul_i32 s87, s87, 458752
    s_add_u32 s86, s86, s87
    s_max_u32 s86, s86, 14336
    s_sub_u32 s86, s86, 14336
    s_mov_b32 exec_hi, 0x7fff
    buffer_load_dword v233, v238, s[8:11], s86 offen
    s_getpc_b64 s[86:87]
Lpc_P:
    s_mul_i32 s53, s53, 384
    v_add_u32 v237, s53, v237
    v_min_u32 v237, L_end_P-Lpc_P, v237
    s_mov_b64 exec, 7
    global_load_dword v236, v237, s[86:87]
    s_mov_b64 exec, -1
    v_mul_u32_u24 v237, 18432, v3
    v_lshl_add_u32 v237, v2, 3, v237
    v_mov_b32 v238, s5
    v_add_u32 v237, 61440, v237
    ds_write2_b32 v237, v238, v238 offset0:0 offset1:1
    s_lshr_b32 s68, s2, 3
    s_mul_i32 s69, s68, 37
    s_lshr_b32 s69, s69, 8
    s_mul_i32 s64, s69, 7
    s_sub_u32 s64, s68, s64
    s_mov_b32 s66, s64
    s_and_b32 s68, s2, 7
    s_lshl_b32 s67, s68, 2
    s_add_u32 s67, s67, s69
    s_cmp_ge_u32 s69, 4
    s_cselect_b32 s67, 99, s67
    s_mul_i32 s71, s68, 3
    s_add_u32 s71, s71, 4
    s_lshl_b32 s72, s68, 2
    s_cmp_lt_u32 s68, 4
    s_cselect_b32 s65, s72, s71
    s_cselect_b32 s71, 4, 3
    s_add_u32 s65, s65, s69
    s_cmp_ge_u32 s69, s71
    s_cselect_b32 s65, 99, s65
    v_lshrrev_b32 v219, 3, v1
    v_mul_u32_u24 v208, 896, v219
    v_and_b32 v219, 1, v3
    v_lshlrev_b32 v219, 2, v219
    v_and_b32 v220, 7, v1
    v_xor_b32 v219, v219, v220
    v_lshl_add_u32 v208, v219, 4, v208
    s_lshl_b32 s58, s66, 7
    s_mul_i32 s60, s3, 100352
    s_add_u32 s58, s58, s60
    v_add_u32 v208, s58, v208
    s_mul_i32 s59, s3, 14336
    s_add_u32 s59, s59, 106496
    v_lshrrev_b32 v219, 5, v1
    v_lshlrev_b32 v209, 9, v219
    v_bfe_u32 v219, v1, 2, 2
    v_lshl_add_u32 v209, v219, 7, v209
    v_lshrrev_b32 v219, 1, v219
    s_and_b32 s58, s3, 1
    v_xor_b32 v219, s58, v219
    v_lshl_add_u32 v209, v219, 6, v209
    v_and_b32 v219, 1, v3
    v_lshl_add_u32 v209, v219, 5, v209
    v_and_b32 v219, 3, v1
    v_lshl_add_u32 v209, v219, 3, v209
    v_add_u32 v209, 106496, v209
    s_mul_i32 s70, s3, 36864
    s_add_u32 s70, s70, 12288
    v_lshrrev_b32 v219, 3, v1
    v_mul_u32_u24 v213, 3584, v219
    v_and_b32 v219, 1, v3
    v_lshlrev_b32 v219, 2, v219
    v_and_b32 v220, 7, v1
    v_xor_b32 v219, v219, v220
    v_lshl_add_u32 v213, v219, 4, v213
    s_mul_i32 s68, s3, 1835008
    s_lshl_b32 s69, s65, 7
    s_add_u32 s68, s68, s69
    s_cmp_ge_u32 s65, 99
    s_cselect_b32 s68, 0x40000000, s68
    v_add_u32 v213, s68, v213
    s_cselect_b32 s68, 0x40000000, 0
    v_add_u32 v5, s68, v4
    v_lshrrev_b32 v219, 5, v1
    v_lshlrev_b32 v215, 9, v219
    v_bfe_u32 v219, v1, 2, 2
    v_lshl_add_u32 v215, v219, 7, v215
    v_lshrrev_b32 v219, 1, v219
    s_lshr_b32 s68, s3, 1
    v_xor_b32 v219, s68, v219
    v_lshl_add_u32 v215, v219, 6, v215
    v_and_b32 v219, 1, v3
    v_lshl_add_u32 v215, v219, 5, v215
    v_and_b32 v219, 3, v1
    v_lshl_add_u32 v215, v219, 3, v215
    v_add_u32 v215, s70, v215
    v_xor_b32 v216, 64, v215
    s_mul_i32 s70, s3, 36864
    s_add_u32 s70, s70, 12288
    v_lshrrev_b32 v219, 3, v1
    v_mul_u32_u24 v214, 4096, v219
    v_and_b32 v219, 1, v3
    v_lshlrev_b32 v219, 2, v219
    v_and_b32 v220, 7, v1
    v_xor_b32 v219, v219, v220
    v_lshl_add_u32 v214, v219, 4, v214
    s_mul_i32 s68, s3, 1835008
    s_lshl_b32 s69, s67, 7
    s_add_u32 s68, s68, s69
    s_cmp_ge_u32 s67, 99
    s_cselect_b32 s68, 0x40000000, s68
    v_add_u32 v214, s68, v214
    v_lshrrev_b32 v219, 5, v1
    v_lshlrev_b32 v217, 9, v219
    v_bfe_u32 v219, v1, 2, 2
    v_lshl_add_u32 v217, v219, 7, v217
    v_lshrrev_b32 v219, 1, v219
    s_lshr_b32 s68, s3, 1
    v_xor_b32 v219, s68, v219
    v_lshl_add_u32 v217, v219, 6, v217
    v_and_b32 v219, 1, v3
    v_lshl_add_u32 v217, v219, 5, v217
    v_and_b32 v219, 3, v1
    v_lshl_add_u32 v217, v219, 3, v217
    v_add_u32 v217, s70, v217
    v_xor_b32 v218, 64, v217
    s_and_b32 s68, s2, 7
    s_cmp_ge_u32 s68, 8
    s_cselect_b32 s94, 8, 0
    s_sub_u32 s68, s68, s94
    s_lshl_b32 s94, s68, 12
    s_add_u32 s68, s68, 1
    s_cmp_ge_u32 s68, 8
    s_cselect_b32 s95, 8, 0
    s_sub_u32 s68, s68, s95
    s_lshl_b32 s95, s68, 12
    s_add_u32 s68, s68, 1
    s_cmp_ge_u32 s68, 8
    s_cselect_b32 s96, 8, 0
    s_sub_u32 s68, s68, s96
    s_lshl_b32 s96, s68, 12
    s_add_u32 s68, s68, 1
    s_cmp_ge_u32 s68, 8
    s_cselect_b32 s97, 8, 0
    s_sub_u32 s68, s68, s97
    s_lshl_b32 s97, s68, 12
    s_add_u32 s68, s68, 1
    s_cmp_ge_u32 s68, 8
    s_cselect_b32 s98, 8, 0
    s_sub_u32 s68, s68, s98
    s_lshl_b32 s98, s68, 12
    s_add_u32 s68, s68, 1
    s_cmp_ge_u32 s68, 8
    s_cselect_b32 s99, 8, 0
    s_sub_u32 s68, s68, s99
    s_lshl_b32 s99, s68, 12
    s_add_u32 s68, s68, 1
    s_cmp_ge_u32 s68, 8
    s_cselect_b32 s100, 8, 0
    s_sub_u32 s68, s68, s100
    s_lshl_b32 s100, s68, 12
    s_add_u32 s68, s68, 1
    s_cmp_ge_u32 s68, 8
    s_cselect_b32 s101, 8, 0
    s_sub_u32 s68, s68, s101
    s_lshl_b32 s101, s68, 12
    s_lshl_b32 s80, s48, 2
    s_add_u32 s80, s80, s3
    s_lshl_b32 s80, s80, 11
    s_lshr_b32 s79, s49, 2
    s_lshl_b32 s79, s79, 7
    s_add_u32 s80, s80, s79
    s_and_b32 s79, s49, 3
    s_lshl_b32 s79, s79, 2
    s_add_u32 s80, s80, s79
    s_add_u32 s80, s80, 0x588000
    s_lshl_b32 s83, s67, 1
    s_lshr_b32 s79, s3, 1
    s_add_u32 s83, s83, s79
    s_lshl_b32 s83, s83, 11
    s_add_u32 s83, s83, 0x588000
    v_lshrrev_b32 v10, 2, v2
    v_lshlrev_b32 v10, 7, v10
    v_and_b32 v219, 3, v2
    v_lshl_add_u32 v10, v219, 2, v10
    s_lshl_b32 s84, s64, 12
    s_add_u32 s85, s84, 0x5b0000
    s_add_u32 s84, s84, 0x5a8000
    s_lshl_b32 s81, s67, 5
    s_add_u32 s81, s81, s3
    s_lshl_b32 s81, s81, 2
    s_add_u32 s81, s81, s84
    s_lshl_b32 s79, s3, 10
    s_add_u32 s84, s84, s79
    v_bfe_u32 v11, v1, 2, 3
    v_min_u32 v12, 6, v11
    v_and_b32 v219, 3, v1
    v_lshlrev_b32 v219, 2, v219
    v_lshl_add_u32 v11, v11, 7, v219
    v_lshl_add_u32 v12, v12, 7, v219
    s_lshl_b32 s82, s65, 5
    s_add_u32 s82, s82, s3
    s_lshl_b32 s82, s82, 2
    s_add_u32 s82, s82, s85
    s_mul_i32 s79, s3, 896
    s_add_u32 s85, s85, s79
    v_mov_b32 v9, 0
    v_lshlrev_b32 v124, 9, v3
    v_bfe_u32 v237, v1, 2, 2
    v_lshl_add_u32 v124, v237, 6, v124
    v_and_b32 v237, 3, v1
    v_lshl_add_u32 v124, v237, 3, v124
    v_and_b32 v237, 1, v3
    v_lshlrev_b32 v237, 5, v237
    v_add_u32 v124, v124, v237
    v_add_u32 v124, 12288, v124
    v_xor_b32 v125, 32, v124
    s_and_b32 s53, s3, 1
    s_lshl_b32 s53, s53, 5
    v_xor_b32 v127, s53, v124
    s_lshr_b32 s53, s3, 1
    s_lshl_b32 s53, s53, 11
    s_add_u32 s53, s53, 2048
    v_add_u32 v126, s53, v127
    v_lshrrev_b32 v237, 1, v2
    v_xor_b32 v237, v237, v3
    v_lshlrev_b32 v237, 4, v237
    v_lshl_add_u32 v237, v2, 7, v237
    v_add_u32 v130, 61440, v237
    v_xor_b32 v131, 64, v130
    v_add_u32 v128, s52, v237
    v_xor_b32 v129, 64, v128
    v_lshlrev_b32 v237, 2, v3
    v_sub_u32 v237, v2, v237
    v_mov_b32 v239, 0xf149f2ca
    v_add_u32 v238, 16, v237
    v_and_b32 v238, 0xfffffff1, v238
    v_cmp_eq_u32 vcc, 0, v238
    s_nop 1
    v_cndmask_b32 v240, v239, 0, vcc
    v_add_u32 v238, 15, v237
    v_and_b32 v238, 0xfffffff1, v238
    v_cmp_eq_u32 vcc, 0, v238
    s_nop 1
    v_cndmask_b32 v241, v239, 0, vcc
    v_add_u32 v238, 14, v237
    v_and_b32 v238, 0xfffffff1, v238
    v_cmp_eq_u32 vcc, 0, v238
    s_nop 1
    v_cndmask_b32 v242, v239, 0, vcc
    v_add_u32 v238, 13, v237
    v_and_b32 v238, 0xfffffff1, v238
    v_cmp_eq_u32 vcc, 0, v238
    s_nop 1
    v_cndmask_b32 v243, v239, 0, vcc
    v_add_u32 v238, 0, v237
    v_and_b32 v238, 0xfffffff1, v238
    v_cmp_eq_u32 vcc, 0, v238
    s_nop 1
    v_cndmask_b32 v244, v239, 0, vcc
    v_add_u32 v238, -1, v237
    v_and_b32 v238, 0xfffffff1, v238
    v_cmp_eq_u32 vcc, 0, v238
    s_nop 1
    v_cndmask_b32 v245, v239, 0, vcc
    v_add_u32 v238, -2, v237
    v_and_b32 v238, 0xfffffff1, v238
    v_cmp_eq_u32 vcc, 0, v238
    s_nop 1
    v_cndmask_b32 v246, v239, 0, vcc
    v_add_u32 v238, -3, v237
    v_and_b32 v238, 0xfffffff1, v238
    v_cmp_eq_u32 vcc, 0, v238
    s_nop 1
    v_cndmask_b32 v247, v239, 0, vcc
    s_or_b32 s53, s48, s3
    s_cmp_eq_u32 s53, 0
    s_cselect_b64 vcc, -1, 0
    v_cndmask_b32 v248, v240, v239, vcc
    v_cndmask_b32 v249, v241, v239, vcc
    v_cndmask_b32 v250, v242, v239, vcc
    v_cndmask_b32 v251, v243, v239, vcc
    v_mov_b32 v40, s5
    v_mov_b32 v41, s5
    v_mov_b32 v42, s5
    v_mov_b32 v43, s5
    s_mov_b32 s88, 0x22222222
    s_mov_b32 s89, 0x22222222
    s_mov_b32 s90, 0x44444444
    s_mov_b32 s91, 0x44444444
    s_mov_b32 s92, 0x88888888
    s_mov_b32 s93, 0x88888888
    v_lshlrev_b32 v72, 4, v3
    s_lshl_b32 s53, s3, 6
    v_add_u32 v73, s53, v72
    s_and_b32 s53, s53, 64
    v_add_u32 v74, s53, v72
    s_mul_i32 s53, s3, 384
    v_lshl_add_u32 v75, v2, 2, s53
    v_add_u32 v76, s53, v72
    s_and_b32 s53, s3, 1
    s_lshl_b32 s53, s53, 3
    v_add_u32 v80, s53, v4
    v_lshrrev_b32 v81, 2, v2
    v_lshlrev_b32 v81, 8, v81
    v_lshl_add_u32 v81, v3, 6, v81
    v_and_b32 v82, 3, v2
    v_lshl_add_u32 v81, v82, 1, v81
    v_add_u32 v81, s53, v81
    v_add_u32 v81, 1024, v81
    s_cmp_lt_u32 s3, 2
    s_cselect_b64 vcc, -1, 0
    s_cselect_b32 s53, 2, 16
    v_cndmask_b32 v80, v81, v80, vcc
    v_add_u32 v81, s53, v80
    v_add_u32 v82, s53, v81
    v_add_u32 v83, s53, v82
    v_lshlrev_b32 v77, 2, v2
    s_lshl_b32 s53, s3, 11
    v_add_u32 v78, s53, v4
    s_lshl_b32 s62, s48, 3
    s_lshl_b32 s63, s3, 1
    s_add_u32 s62, s62, s63
    s_lshl_b32 s62, s62, 4
    s_add_u32 s62, s62, s49
    s_lshl_b32 s62, s62, 10
    s_add_u32 s63, s62, 16384
    s_waitcnt vmcnt(11)
    s_waitcnt lgkmcnt(0)
    s_barrier
    ds_read_b128 v[16:19], v128 offset:36864
    ds_read_b128 v[20:23], v128 offset:38912
    ds_read_b128 v[24:27], v130 offset:36864
    ds_read_b64_tr_b16 v[88:89], v124 offset:0
    ds_read_b64_tr_b16 v[90:91], v124 offset:256
    ds_read_b64_tr_b16 v[92:93], v125 offset:0
    ds_read_b64_tr_b16 v[94:95], v125 offset:256
    ds_read_b64_tr_b16 v[96:97], v124 offset:2048
    ds_read_b64_tr_b16 v[98:99], v124 offset:2304
    ds_read_b64_tr_b16 v[100:101], v125 offset:2048
    ds_read_b64_tr_b16 v[102:103], v125 offset:2304
    ds_read_b64_tr_b16 v[104:105], v124 offset:4096
    ds_read_b64_tr_b16 v[106:107], v124 offset:4352
    ds_read_b64_tr_b16 v[108:109], v125 offset:4096
    ds_read_b64_tr_b16 v[110:111], v125 offset:4352
    ds_read_b64_tr_b16 v[112:113], v126 offset:0
    ds_read_b64_tr_b16 v[114:115], v126 offset:256
    ds_read_b64_tr_b16 v[116:117], v127 offset:0
    ds_read_b64_tr_b16 v[118:119], v127 offset:256
    s_waitcnt lgkmcnt(8)
    v_mfma_f32_16x16x32_bf16 v[136:139], v[88:91], v[16:19], 0
    ds_read_b128 v[28:31], v129 offset:36864
    v_mfma_f32_16x16x32_bf16 v[160:163], v[88:91], v[20:23], 0
    ds_read_b128 v[32:35], v129 offset:38912
    v_mfma_f32_16x16x32_bf16 v[140:143], v[92:95], v[16:19], 0
    ds_read_b128 v[36:39], v131 offset:36864
    v_mfma_f32_16x16x32_bf16 v[164:167], v[92:95], v[20:23], 0
    ds_read_b64_tr_b16 v[88:89], v124 offset:6144
    v_mfma_f32_16x16x32_bf16 v[144:147], v[96:99], v[16:19], 0
    ds_read_b64_tr_b16 v[90:91], v124 offset:6400
    s_add_u32 m0, s51, 36864
    s_mov_b32 s73, 344064
    buffer_load_dwordx4 v123, s[12:15], s73 offen lds
    v_mfma_f32_16x16x32_bf16 v[168:171], v[96:99], v[20:23], 0
    ds_read_b64_tr_b16 v[92:93], v125 offset:6144
    v_mfma_f32_16x16x32_bf16 v[148:151], v[100:103], v[16:19], 0
    ds_read_b64_tr_b16 v[94:95], v125 offset:6400
    v_mfma_f32_16x16x32_bf16 v[172:175], v[100:103], v[20:23], 0
    ds_read_b64_tr_b16 v[96:97], v124 offset:8192
    s_waitcnt lgkmcnt(8)
    v_mfma_f32_16x16x32_bf16 v[152:155], v[16:19], v[104:107], 0
    ds_read_b64_tr_b16 v[98:99], v124 offset:8448
    v_mfma_f32_16x16x32_bf16 v[176:179], v[20:23], v[104:107], 0
    ds_read_b64_tr_b16 v[100:101], v125 offset:8192
    s_add_u32 m0, s51, 38912
    s_mov_b32 s73, 344960
    buffer_load_dwordx4 v123, s[12:15], s73 offen lds
    v_mfma_f32_16x16x32_bf16 v[156:159], v[16:19], v[108:111], 0
    ds_read_b64_tr_b16 v[102:103], v125 offset:8448
    v_mfma_f32_16x16x32_bf16 v[180:183], v[20:23], v[108:111], 0
    ds_read_b64_tr_b16 v[104:105], v124 offset:10240
    v_mfma_f32_16x16x32_bf16 v[184:187], v[112:115], v[24:27], 0
    ds_read_b64_tr_b16 v[106:107], v124 offset:10496
    v_mfma_f32_16x16x32_bf16 v[188:191], v[116:119], v[24:27], 0
    ds_read_b64_tr_b16 v[108:109], v125 offset:10240
    v_mfma_f32_16x16x32_bf16 v[48:51], v[16:19], v[16:19], 0
    ds_read_b64_tr_b16 v[110:111], v125 offset:10496
    s_add_u32 m0, s51, 40960
    s_mov_b32 s73, 345856
    buffer_load_dwordx4 v123, s[12:15], s73 offen lds
    v_mfma_f32_16x16x32_bf16 v[52:55], v[20:23], v[20:23], 0
    ds_read_b64_tr_b16 v[112:113], v126 offset:6144
    v_mfma_f32_16x16x32_bf16 v[56:59], v[24:27], v[24:27], 0
    ds_read_b64_tr_b16 v[114:115], v126 offset:6400
    v_mfma_f32_16x16x32_bf16 v[60:63], v[40:43], v[16:19], 0
    ds_read_b64_tr_b16 v[116:117], v127 offset:6144
    v_mfma_f32_16x16x32_bf16 v[64:67], v[40:43], v[20:23], 0
    ds_read_b64_tr_b16 v[118:119], v127 offset:6400
    v_mfma_f32_16x16x32_bf16 v[68:71], v[40:43], v[24:27], 0
    s_add_u32 m0, s52, 0
    s_mov_b32 s73, 256
    buffer_load_dwordx4 v120, s[8:11], s73 offen lds
    s_add_u32 m0, s52, 1024
    s_mov_b32 s73, 256
    buffer_load_dwordx4 v121, s[8:11], s73 offen lds
    s_add_u32 m0, s52, 2048
    s_mov_b32 s73, 14592
    buffer_load_dwordx4 v120, s[8:11], s73 offen lds
    s_add_u32 m0, s52, 3072
    s_mov_b32 s73, 14592
    buffer_load_dwordx4 v121, s[8:11], s73 offen lds
    s_add_u32 m0, s7, 61440
    s_mov_b32 s73, 256
    s_mov_b64 exec, s[54:55]
    buffer_load_dwordx4 v122, s[8:11], s73 offen lds
    s_mov_b64 exec, -1
    s_waitcnt vmcnt(11)
    s_barrier
    s_waitcnt lgkmcnt(8)
    v_mfma_f32_16x16x32_bf16 v[136:139], v[88:91], v[28:31], v[136:139]
    ds_read_b128 v[16:19], v128 offset:18432
    v_mfma_f32_16x16x32_bf16 v[160:163], v[88:91], v[32:35], v[160:163]
    ds_read_b128 v[20:23], v128 offset:20480
    v_mfma_f32_16x16x32_bf16 v[140:143], v[92:95], v[28:31], v[140:143]
    ds_read_b128 v[24:27], v130 offset:18432
    v_mfma_f32_16x16x32_bf16 v[164:167], v[92:95], v[32:35], v[164:167]
    ds_read_b64_tr_b16 v[88:89], v124 offset:12288
    v_mfma_f32_16x16x32_bf16 v[144:147], v[96:99], v[28:31], v[144:147]
    ds_read_b64_tr_b16 v[90:91], v124 offset:12544
    s_add_u32 m0, s51, 49152
    s_mov_b32 s73, 516096
    buffer_load_dwordx4 v123, s[12:15], s73 offen lds
    v_mfma_f32_16x16x32_bf16 v[168:171], v[96:99], v[32:35], v[168:171]
    ds_read_b64_tr_b16 v[92:93], v125 offset:12288
    v_mfma_f32_16x16x32_bf16 v[148:151], v[100:103], v[28:31], v[148:151]
    ds_read_b64_tr_b16 v[94:95], v125 offset:12544
    v_mfma_f32_16x16x32_bf16 v[172:175], v[100:103], v[32:35], v[172:175]
    ds_read_b64_tr_b16 v[96:97], v124 offset:14336
    s_waitcnt lgkmcnt(8)
    v_mfma_f32_16x16x32_bf16 v[152:155], v[28:31], v[104:107], v[152:155]
    ds_read_b64_tr_b16 v[98:99], v124 offset:14592
    v_mfma_f32_16x16x32_bf16 v[176:179], v[32:35], v[104:107], v[176:179]
    ds_read_b64_tr_b16 v[100:101], v125 offset:14336
    s_add_u32 m0, s51, 51200
    s_mov_b32 s73, 516992
    buffer_load_dwordx4 v123, s[12:15], s73 offen lds
    v_mfma_f32_16x16x32_bf16 v[156:159], v[28:31], v[108:111], v[156:159]
    ds_read_b64_tr_b16 v[102:103], v125 offset:14592
    v_mfma_f32_16x16x32_bf16 v[180:183], v[32:35], v[108:111], v[180:183]
    ds_read_b64_tr_b16 v[104:105], v124 offset:16384
    v_mfma_f32_16x16x32_bf16 v[184:187], v[112:115], v[36:39], v[184:187]
    ds_read_b64_tr_b16 v[106:107], v124 offset:16640
    v_mfma_f32_16x16x32_bf16 v[188:191], v[116:119], v[36:39], v[188:191]
    ds_read_b64_tr_b16 v[108:109], v125 offset:16384
    v_mfma_f32_16x16x32_bf16 v[48:51], v[28:31], v[28:31], v[48:51]
    ds_read_b64_tr_b16 v[110:111], v125 offset:16640
    s_add_u32 m0, s51, 53248
    s_mov_b32 s73, 517888
    buffer_load_dwordx4 v123, s[12:15], s73 offen lds
    v_mfma_f32_16x16x32_bf16 v[52:55], v[32:35], v[32:35], v[52:55]
    ds_read_b64_tr_b16 v[112:113], v126 offset:12288
    v_mfma_f32_16x16x32_bf16 v[56:59], v[36:39], v[36:39], v[56:59]
    ds_read_b64_tr_b16 v[114:115], v126 offset:12544
    v_mfma_f32_16x16x32_bf16 v[60:63], v[40:43], v[28:31], v[60:63]
    ds_read_b64_tr_b16 v[116:117], v127 offset:12288
    v_mfma_f32_16x16x32_bf16 v[64:67], v[40:43], v[32:35], v[64:67]
    ds_read_b64_tr_b16 v[118:119], v127 offset:12544
    v_mfma_f32_16x16x32_bf16 v[68:71], v[40:43], v[36:39], v[68:71]
    s_add_u32 m0, s52, 55296
    s_mov_b32 s73, 384
    buffer_load_dwordx4 v120, s[8:11], s73 offen lds
    s_waitcnt lgkmcnt(8)
    v_mfma_f32_16x16x32_bf16 v[136:139], v[88:91], v[16:19], v[136:139]
    ds_read_b128 v[28:31], v129 offset:18432
    v_mfma_f32_16x16x32_bf16 v[160:163], v[88:91], v[20:23], v[160:163]
    ds_read_b128 v[32:35], v129 offset:20480
    v_mfma_f32_16x16x32_bf16 v[140:143], v[92:95], v[16:19], v[140:143]
    ds_read_b128 v[36:39], v131 offset:18432
    v_mfma_f32_16x16x32_bf16 v[164:167], v[92:95], v[20:23], v[164:167]
    ds_read_b64_tr_b16 v[88:89], v124 offset:18432
    v_mfma_f32_16x16x32_bf16 v[144:147], v[96:99], v[16:19], v[144:147]
    ds_read_b64_tr_b16 v[90:91], v124 offset:18688
    s_add_u32 m0, s52, 56320
    s_mov_b32 s73, 384
    buffer_load_dwordx4 v121, s[8:11], s73 offen lds
    v_mfma_f32_16x16x32_bf16 v[168:171], v[96:99], v[20:23], v[168:171]
    ds_read_b64_tr_b16 v[92:93], v125 offset:18432
    v_mfma_f32_16x16x32_bf16 v[148:151], v[100:103], v[16:19], v[148:151]
    ds_read_b64_tr_b16 v[94:95], v125 offset:18688
    v_mfma_f32_16x16x32_bf16 v[172:175], v[100:103], v[20:23], v[172:175]
    ds_read_b64_tr_b16 v[96:97], v124 offset:20480
    s_waitcnt lgkmcnt(8)
    v_mfma_f32_16x16x32_bf16 v[152:155], v[16:19], v[104:107], v[152:155]
    ds_read_b64_tr_b16 v[98:99], v124 offset:20736
    v_mfma_f32_16x16x32_bf16 v[176:179], v[20:23], v[104:107], v[176:179]
    ds_read_b64_tr_b16 v[100:101], v125 offset:20480
    s_add_u32 m0, s52, 57344
    s_mov_b32 s73, 14720
    buffer_load_dwordx4 v120, s[8:11], s73 offen lds
    v_mfma_f32_16x16x32_bf16 v[156:159], v[16:19], v[108:111], v[156:159]
    ds_read_b64_tr_b16 v[102:103], v125 offset:20736
    v_mfma_f32_16x16x32_bf16 v[180:183], v[20:23], v[108:111], v[180:183]
    ds_read_b64_tr_b16 v[104:105], v124 offset:22528
    v_mfma_f32_16x16x32_bf16 v[184:187], v[112:115], v[24:27], v[184:187]
    ds_read_b64_tr_b16 v[106:107], v124 offset:22784
    v_mfma_f32_16x16x32_bf16 v[188:191], v[116:119], v[24:27], v[188:191]
    ds_read_b64_tr_b16 v[108:109], v125 offset:22528
    v_mfma_f32_16x16x32_bf16 v[48:51], v[16:19], v[16:19], v[48:51]
    ds_read_b64_tr_b16 v[110:111], v125 offset:22784
    s_add_u32 m0, s52, 58368
    s_mov_b32 s73, 14720
    buffer_load_dwordx4 v121, s[8:11], s73 offen lds
    v_mfma_f32_16x16x32_bf16 v[52:55], v[20:23], v[20:23], v[52:55]
    ds_read_b64_tr_b16 v[112:113], v126 offset:18432
    v_mfma_f32_16x16x32_bf16 v[56:59], v[24:27], v[24:27], v[56:59]
    ds_read_b64_tr_b16 v[114:115], v126 offset:18688
    v_mfma_f32_16x16x32_bf16 v[60:63], v[40:43], v[16:19], v[60:63]
    ds_read_b64_tr_b16 v[116:117], v127 offset:18432
    v_mfma_f32_16x16x32_bf16 v[64:67], v[40:43], v[20:23], v[64:67]
    ds_read_b64_tr_b16 v[118:119], v127 offset:18688
    v_mfma_f32_16x16x32_bf16 v[68:71], v[40:43], v[24:27], v[68:71]
    s_add_u32 m0, s7, 116736
    s_mov_b32 s73, 384
    s_mov_b64 exec, s[54:55]
    buffer_load_dwordx4 v122, s[8:11], s73 offen lds
    s_mov_b64 exec, -1
    s_waitcnt vmcnt(8)
    s_barrier
    s_waitcnt lgkmcnt(8)
    v_mfma_f32_16x16x32_bf16 v[136:139], v[88:91], v[28:31], v[136:139]
    ds_read_b128 v[16:19], v128 offset:0
    v_mfma_f32_16x16x32_bf16 v[160:163], v[88:91], v[32:35], v[160:163]
    ds_read_b128 v[20:23], v128 offset:2048
    v_mfma_f32_16x16x32_bf16 v[140:143], v[92:95], v[28:31], v[140:143]
    ds_read_b128 v[24:27], v130 offset:0
    v_mfma_f32_16x16x32_bf16 v[164:167], v[92:95], v[32:35], v[164:167]
    ds_read_b64_tr_b16 v[88:89], v124 offset:24576
    v_mfma_f32_16x16x32_bf16 v[144:147], v[96:99], v[28:31], v[144:147]
    ds_read_b64_tr_b16 v[90:91], v124 offset:24832
    s_add_u32 m0, s51, 12288
    s_mov_b32 s73, 688128
    buffer_load_dwordx4 v123, s[12:15], s73 offen lds
    v_mfma_f32_16x16x32_bf16 v[168:171], v[96:99], v[32:35], v[168:171]
    ds_read_b64_tr_b16 v[92:93], v125 offset:24576
    v_mfma_f32_16x16x32_bf16 v[148:151], v[100:103], v[28:31], v[148:151]
    ds_read_b64_tr_b16 v[94:95], v125 offset:24832
    v_mfma_f32_16x16x32_bf16 v[172:175], v[100:103], v[32:35], v[172:175]
    ds_read_b64_tr_b16 v[96:97], v124 offset:26624
    s_waitcnt lgkmcnt(8)
    v_mfma_f32_16x16x32_bf16 v[152:155], v[28:31], v[104:107], v[152:155]
    ds_read_b64_tr_b16 v[98:99], v124 offset:26880
    v_mfma_f32_16x16x32_bf16 v[176:179], v[32:35], v[104:107], v[176:179]
    ds_read_b64_tr_b16 v[100:101], v125 offset:26624
    s_add_u32 m0, s51, 14336
    s_mov_b32 s73, 689024
    buffer_load_dwordx4 v123, s[12:15], s73 offen lds
    v_mfma_f32_16x16x32_bf16 v[156:159], v[28:31], v[108:111], v[156:159]
    ds_read_b64_tr_b16 v[102:103], v125 offset:26880
    v_mfma_f32_16x16x32_bf16 v[180:183], v[32:35], v[108:111], v[180:183]
    ds_read_b64_tr_b16 v[104:105], v124 offset:28672
    v_mfma_f32_16x16x32_bf16 v[184:187], v[112:115], v[36:39], v[184:187]
    ds_read_b64_tr_b16 v[106:107], v124 offset:28928
    v_mfma_f32_16x16x32_bf16 v[188:191], v[116:119], v[36:39], v[188:191]
    ds_read_b64_tr_b16 v[108:109], v125 offset:28672
    v_mfma_f32_16x16x32_bf16 v[48:51], v[28:31], v[28:31], v[48:51]
    ds_read_b64_tr_b16 v[110:111], v125 offset:28928
    s_add_u32 m0, s51, 16384
    s_mov_b32 s73, 689920
    buffer_load_dwordx4 v123, s[12:15], s73 offen lds
    v_mfma_f32_16x16x32_bf16 v[52:55], v[32:35], v[32:35], v[52:55]
    ds_read_b64_tr_b16 v[112:113], v126 offset:24576
    v_mfma_f32_16x16x32_bf16 v[56:59], v[36:39], v[36:39], v[56:59]
    ds_read_b64_tr_b16 v[114:115], v126 offset:24832
    v_mfma_f32_16x16x32_bf16 v[60:63], v[40:43], v[28:31], v[60:63]
    ds_read_b64_tr_b16 v[116:117], v127 offset:24576
    v_mfma_f32_16x16x32_bf16 v[64:67], v[40:43], v[32:35], v[64:67]
    ds_read_b64_tr_b16 v[118:119], v127 offset:24832
    v_mfma_f32_16x16x32_bf16 v[68:71], v[40:43], v[36:39], v[68:71]
    s_add_u32 m0, s52, 36864
    s_mov_b32 s73, 512
    buffer_load_dwordx4 v120, s[8:11], s73 offen lds
    s_waitcnt lgkmcnt(8)
    v_mfma_f32_16x16x32_bf16 v[136:139], v[88:91], v[16:19], v[136:139]
    ds_read_b128 v[28:31], v129 offset:0
    v_mfma_f32_16x16x32_bf16 v[160:163], v[88:91], v[20:23], v[160:163]
    ds_read_b128 v[32:35], v129 offset:2048
    v_mfma_f32_16x16x32_bf16 v[140:143], v[92:95], v[16:19], v[140:143]
    ds_read_b128 v[36:39], v131 offset:0
    v_mfma_f32_16x16x32_bf16 v[164:167], v[92:95], v[20:23], v[164:167]
    ds_read_b64_tr_b16 v[88:89], v124 offset:30720
    v_mfma_f32_16x16x32_bf16 v[144:147], v[96:99], v[16:19], v[144:147]
    ds_read_b64_tr_b16 v[90:91], v124 offset:30976
    s_add_u32 m0, s52, 37888
    s_mov_b32 s73, 512
    buffer_load_dwordx4 v121, s[8:11], s73 offen lds
    v_mfma_f32_16x16x32_bf16 v[168:171], v[96:99], v[20:23], v[168:171]
    ds_read_b64_tr_b16 v[92:93], v125 offset:30720
    v_mfma_f32_16x16x32_bf16 v[148:151], v[100:103], v[16:19], v[148:151]
    ds_read_b64_tr_b16 v[94:95], v125 offset:30976
    v_mfma_f32_16x16x32_bf16 v[172:175], v[100:103], v[20:23], v[172:175]
    ds_read_b64_tr_b16 v[96:97], v124 offset:32768
    s_waitcnt lgkmcnt(8)
    v_mfma_f32_16x16x32_bf16 v[152:155], v[16:19], v[104:107], v[152:155]
    ds_read_b64_tr_b16 v[98:99], v124 offset:33024
    v_mfma_f32_16x16x32_bf16 v[176:179], v[20:23], v[104:107], v[176:179]
    ds_read_b64_tr_b16 v[100:101], v125 offset:32768
    s_add_u32 m0, s52, 38912
    s_mov_b32 s73, 14848
    buffer_load_dwordx4 v120, s[8:11], s73 offen lds
    v_mfma_f32_16x16x32_bf16 v[156:159], v[16:19], v[108:111], v[156:159]
    ds_read_b64_tr_b16 v[102:103], v125 offset:33024
    v_mfma_f32_16x16x32_bf16 v[180:183], v[20:23], v[108:111], v[180:183]
    ds_read_b64_tr_b16 v[104:105], v124 offset:34816
    v_mfma_f32_16x16x32_bf16 v[184:187], v[112:115], v[24:27], v[184:187]
    ds_read_b64_tr_b16 v[106:107], v124 offset:35072
    v_mfma_f32_16x16x32_bf16 v[188:191], v[116:119], v[24:27], v[188:191]
    ds_read_b64_tr_b16 v[108:109], v125 offset:34816
    v_mfma_f32_16x16x32_bf16 v[48:51], v[16:19], v[16:19], v[48:51]
    ds_read_b64_tr_b16 v[110:111], v125 offset:35072
    s_add_u32 m0, s52, 39936
    s_mov_b32 s73, 14848
    buffer_load_dwordx4 v121, s[8:11], s73 offen lds
    v_mfma_f32_16x16x32_bf16 v[52:55], v[20:23], v[20:23], v[52:55]
    ds_read_b64_tr_b16 v[112:113], v126 offset:30720
    v_mfma_f32_16x16x32_bf16 v[56:59], v[24:27], v[24:27], v[56:59]
    ds_read_b64_tr_b16 v[114:115], v126 offset:30976
    v_mfma_f32_16x16x32_bf16 v[60:63], v[40:43], v[16:19], v[60:63]
    ds_read_b64_tr_b16 v[116:117], v127 offset:30720
    v_mfma_f32_16x16x32_bf16 v[64:67], v[40:43], v[20:23], v[64:67]
    ds_read_b64_tr_b16 v[118:119], v127 offset:30976
    v_mfma_f32_16x16x32_bf16 v[68:71], v[40:43], v[24:27], v[68:71]
    s_add_u32 m0, s7, 98304
    s_mov_b32 s73, 512
    s_mov_b64 exec, s[54:55]
    buffer_load_dwordx4 v122, s[8:11], s73 offen lds
    s_mov_b64 exec, -1
    s_waitcnt vmcnt(8)
    s_barrier
    s_waitcnt lgkmcnt(8)
    v_mfma_f32_16x16x32_bf16 v[136:139], v[88:91], v[28:31], v[136:139]
    ds_read_b128 v[16:19], v128 offset:55296
    v_mfma_f32_16x16x32_bf16 v[160:163], v[88:91], v[32:35], v[160:163]
    ds_read_b128 v[20:23], v128 offset:57344
    v_mfma_f32_16x16x32_bf16 v[140:143], v[92:95], v[28:31], v[140:143]
    ds_read_b128 v[24:27], v130 offset:55296
    v_mfma_f32_16x16x32_bf16 v[164:167], v[92:95], v[32:35], v[164:167]
    ds_read_b64_tr_b16 v[88:89], v124 offset:36864
    v_mfma_f32_16x16x32_bf16 v[144:147], v[96:99], v[28:31], v[144:147]
    ds_read_b64_tr_b16 v[90:91], v124 offset:37120
    s_add_u32 m0, s51, 24576
    s_mov_b32 s73, 860160
    buffer_load_dwordx4 v123, s[12:15], s73 offen lds
    v_mfma_f32_16x16x32_bf16 v[168:171], v[96:99], v[32:35], v[168:171]
    ds_read_b64_tr_b16 v[92:93], v125 offset:36864
    v_mfma_f32_16x16x32_bf16 v[148:151], v[100:103], v[28:31], v[148:151]
    ds_read_b64_tr_b16 v[94:95], v125 offset:37120
    v_mfma_f32_16x16x32_bf16 v[172:175], v[100:103], v[32:35], v[172:175]
    ds_read_b64_tr_b16 v[96:97], v124 offset:38912
    s_waitcnt lgkmcnt(8)
    v_mfma_f32_16x16x32_bf16 v[152:155], v[28:31], v[104:107], v[152:155]
    ds_read_b64_tr_b16 v[98:99], v124 offset:39168
    v_mfma_f32_16x16x32_bf16 v[176:179], v[32:35], v[104:107], v[176:179]
    ds_read_b64_tr_b16 v[100:101], v125 offset:38912
    s_add_u32 m0, s51, 26624
    s_mov_b32 s73, 861056
    buffer_load_dwordx4 v123, s[12:15], s73 offen lds
    v_mfma_f32_16x16x32_bf16 v[156:159], v[28:31], v[108:111], v[156:159]
    ds_read_b64_tr_b16 v[102:103], v125 offset:39168
    v_mfma_f32_16x16x32_bf16 v[180:183], v[32:35], v[108:111], v[180:183]
    ds_read_b64_tr_b16 v[104:105], v124 offset:40960
    v_mfma_f32_16x16x32_bf16 v[184:187], v[112:115], v[36:39], v[184:187]
    ds_read_b64_tr_b16 v[106:107], v124 offset:41216
    v_mfma_f32_16x16x32_bf16 v[188:191], v[116:119], v[36:39], v[188:191]
    ds_read_b64_tr_b16 v[108:109], v125 offset:40960
    v_mfma_f32_16x16x32_bf16 v[48:51], v[28:31], v[28:31], v[48:51]
    ds_read_b64_tr_b16 v[110:111], v125 offset:41216
    s_add_u32 m0, s51, 28672
    s_mov_b32 s73, 861952
    buffer_load_dwordx4 v123, s[12:15], s73 offen lds
    v_mfma_f32_16x16x32_bf16 v[52:55], v[32:35], v[32:35], v[52:55]
    ds_read_b64_tr_b16 v[112:113], v126 offset:36864
    v_mfma_f32_16x16x32_bf16 v[56:59], v[36:39], v[36:39], v[56:59]
    ds_read_b64_tr_b16 v[114:115], v126 offset:37120
    v_mfma_f32_16x16x32_bf16 v[60:63], v[40:43], v[28:31], v[60:63]
    ds_read_b64_tr_b16 v[116:117], v127 offset:36864
    v_mfma_f32_16x16x32_bf16 v[64:67], v[40:43], v[32:35], v[64:67]
    ds_read_b64_tr_b16 v[118:119], v127 offset:37120
    v_mfma_f32_16x16x32_bf16 v[68:71], v[40:43], v[36:39], v[68:71]
    s_add_u32 m0, s52, 18432
    s_mov_b32 s73, 640
    buffer_load_dwordx4 v120, s[8:11], s73 offen lds
    s_waitcnt lgkmcnt(8)
    v_mfma_f32_16x16x32_bf16 v[136:139], v[88:91], v[16:19], v[136:139]
    ds_read_b128 v[28:31], v129 offset:55296
    v_mfma_f32_16x16x32_bf16 v[160:163], v[88:91], v[20:23], v[160:163]
    ds_read_b128 v[32:35], v129 offset:57344
    v_mfma_f32_16x16x32_bf16 v[140:143], v[92:95], v[16:19], v[140:143]
    ds_read_b128 v[36:39], v131 offset:55296
    v_mfma_f32_16x16x32_bf16 v[164:167], v[92:95], v[20:23], v[164:167]
    ds_read_b64_tr_b16 v[88:89], v124 offset:43008
    v_mfma_f32_16x16x32_bf16 v[144:147], v[96:99], v[16:19], v[144:147]
    ds_read_b64_tr_b16 v[90:91], v124 offset:43264
    s_add_u32 m0, s52, 19456
    s_mov_b32 s73, 640
    buffer_load_dwordx4 v121, s[8:11], s73 offen lds
    v_mfma_f32_16x16x32_bf16 v[168:171], v[96:99], v[20:23], v[168:171]
    ds_read_b64_tr_b16 v[92:93], v125 offset:43008
    v_mfma_f32_16x16x32_bf16 v[148:151], v[100:103], v[16:19], v[148:151]
    ds_read_b64_tr_b16 v[94:95], v125 offset:43264
    v_mfma_f32_16x16x32_bf16 v[172:175], v[100:103], v[20:23], v[172:175]
    ds_read_b64_tr_b16 v[96:97], v124 offset:45056
    s_waitcnt lgkmcnt(8)
    v_mfma_f32_16x16x32_bf16 v[152:155], v[16:19], v[104:107], v[152:155]
    ds_read_b64_tr_b16 v[98:99], v124 offset:45312
    v_mfma_f32_16x16x32_bf16 v[176:179], v[20:23], v[104:107], v[176:179]
    ds_read_b64_tr_b16 v[100:101], v125 offset:45056
    s_add_u32 m0, s52, 20480
    s_mov_b32 s73, 14976
    buffer_load_dwordx4 v120, s[8:11], s73 offen lds
    v_mfma_f32_16x16x32_bf16 v[156:159], v[16:19], v[108:111], v[156:159]
    ds_read_b64_tr_b16 v[102:103], v125 offset:45312
    v_mfma_f32_16x16x32_bf16 v[180:183], v[20:23], v[108:111], v[180:183]
    ds_read_b64_tr_b16 v[104:105], v124 offset:47104
    v_mfma_f32_16x16x32_bf16 v[184:187], v[112:115], v[24:27], v[184:187]
    ds_read_b64_tr_b16 v[106:107], v124 offset:47360
    v_mfma_f32_16x16x32_bf16 v[188:191], v[116:119], v[24:27], v[188:191]
    ds_read_b64_tr_b16 v[108:109], v125 offset:47104
    v_mfma_f32_16x16x32_bf16 v[48:51], v[16:19], v[16:19], v[48:51]
    ds_read_b64_tr_b16 v[110:111], v125 offset:47360
    s_add_u32 m0, s52, 21504
    s_mov_b32 s73, 14976
    buffer_load_dwordx4 v121, s[8:11], s73 offen lds
    v_mfma_f32_16x16x32_bf16 v[52:55], v[20:23], v[20:23], v[52:55]
    ds_read_b64_tr_b16 v[112:113], v126 offset:43008
    v_mfma_f32_16x16x32_bf16 v[56:59], v[24:27], v[24:27], v[56:59]
    ds_read_b64_tr_b16 v[114:115], v126 offset:43264
    v_mfma_f32_16x16x32_bf16 v[60:63], v[40:43], v[16:19], v[60:63]
    ds_read_b64_tr_b16 v[116:117], v127 offset:43008
    v_mfma_f32_16x16x32_bf16 v[64:67], v[40:43], v[20:23], v[64:67]
    ds_read_b64_tr_b16 v[118:119], v127 offset:43264
    v_mfma_f32_16x16x32_bf16 v[68:71], v[40:43], v[24:27], v[68:71]
    s_add_u32 m0, s7, 79872
    s_mov_b32 s73, 640
    s_mov_b64 exec, s[54:55]
    buffer_load_dwordx4 v122, s[8:11], s73 offen lds
    s_mov_b64 exec, -1
    s_waitcnt vmcnt(8)
    s_barrier
    s_waitcnt lgkmcnt(8)
    v_mfma_f32_16x16x32_bf16 v[136:139], v[88:91], v[28:31], v[136:139]
    ds_read_b128 v[16:19], v128 offset:36864
    v_mfma_f32_16x16x32_bf16 v[160:163], v[88:91], v[32:35], v[160:163]
    ds_read_b128 v[20:23], v128 offset:38912
    v_mfma_f32_16x16x32_bf16 v[140:143], v[92:95], v[28:31], v[140:143]
    ds_read_b128 v[24:27], v130 offset:36864
    v_mfma_f32_16x16x32_bf16 v[164:167], v[92:95], v[32:35], v[164:167]
    ds_read_b64_tr_b16 v[88:89], v124 offset:0
    v_mfma_f32_16x16x32_bf16 v[144:147], v[96:99], v[28:31], v[144:147]
    ds_read_b64_tr_b16 v[90:91], v124 offset:256
    s_add_u32 m0, s51, 36864
    s_mov_b32 s73, 1032192
    buffer_load_dwordx4 v123, s[12:15], s73 offen lds
    v_mfma_f32_16x16x32_bf16 v[168:171], v[96:99], v[32:35], v[168:171]
    ds_read_b64_tr_b16 v[92:93], v125 offset:0
    v_mfma_f32_16x16x32_bf16 v[148:151], v[100:103], v[28:31], v[148:151]
    ds_read_b64_tr_b16 v[94:95], v125 offset:256
    v_mfma_f32_16x16x32_bf16 v[172:175], v[100:103], v[32:35], v[172:175]
    ds_read_b64_tr_b16 v[96:97], v124 offset:2048
    s_waitcnt lgkmcnt(8)
    v_mfma_f32_16x16x32_bf16 v[152:155], v[28:31], v[104:107], v[152:155]
    ds_read_b64_tr_b16 v[98:99], v124 offset:2304
    v_mfma_f32_16x16x32_bf16 v[176:179], v[32:35], v[104:107], v[176:179]
    ds_read_b64_tr_b16 v[100:101], v125 offset:2048
    s_add_u32 m0, s51, 38912
    s_mov_b32 s73, 1033088
    buffer_load_dwordx4 v123, s[12:15], s73 offen lds
    v_mfma_f32_16x16x32_bf16 v[156:159], v[28:31], v[108:111], v[156:159]
    ds_read_b64_tr_b16 v[102:103], v125 offset:2304
    v_mfma_f32_16x16x32_bf16 v[180:183], v[32:35], v[108:111], v[180:183]
    ds_read_b64_tr_b16 v[104:105], v124 offset:4096
    v_mfma_f32_16x16x32_bf16 v[184:187], v[112:115], v[36:39], v[184:187]
    ds_read_b64_tr_b16 v[106:107], v124 offset:4352
    v_mfma_f32_16x16x32_bf16 v[188:191], v[116:119], v[36:39], v[188:191]
    ds_read_b64_tr_b16 v[108:109], v125 offset:4096
    v_mfma_f32_16x16x32_bf16 v[48:51], v[28:31], v[28:31], v[48:51]
    ds_read_b64_tr_b16 v[110:111], v125 offset:4352
    s_add_u32 m0, s51, 40960
    s_mov_b32 s73, 1033984
    buffer_load_dwordx4 v123, s[12:15], s73 offen lds
    v_mfma_f32_16x16x32_bf16 v[52:55], v[32:35], v[32:35], v[52:55]
    ds_read_b64_tr_b16 v[112:113], v126 offset:0
    v_mfma_f32_16x16x32_bf16 v[56:59], v[36:39], v[36:39], v[56:59]
    ds_read_b64_tr_b16 v[114:115], v126 offset:256
    v_mfma_f32_16x16x32_bf16 v[60:63], v[40:43], v[28:31], v[60:63]
    ds_read_b64_tr_b16 v[116:117], v127 offset:0
    v_mfma_f32_16x16x32_bf16 v[64:67], v[40:43], v[32:35], v[64:67]
    ds_read_b64_tr_b16 v[118:119], v127 offset:256
    v_mfma_f32_16x16x32_bf16 v[68:71], v[40:43], v[36:39], v[68:71]
    s_add_u32 m0, s52, 0
    s_mov_b32 s73, 768
    buffer_load_dwordx4 v120, s[8:11], s73 offen lds
    s_waitcnt lgkmcnt(8)
    v_mfma_f32_16x16x32_bf16 v[136:139], v[88:91], v[16:19], v[136:139]
    ds_read_b128 v[28:31], v129 offset:36864
    v_mfma_f32_16x16x32_bf16 v[160:163], v[88:91], v[20:23], v[160:163]
    ds_read_b128 v[32:35], v129 offset:38912
    v_mfma_f32_16x16x32_bf16 v[140:143], v[92:95], v[16:19], v[140:143]
    ds_read_b128 v[36:39], v131 offset:36864
    v_mfma_f32_16x16x32_bf16 v[164:167], v[92:95], v[20:23], v[164:167]
    ds_read_b64_tr_b16 v[88:89], v124 offset:6144
    v_mfma_f32_16x16x32_bf16 v[144:147], v[96:99], v[16:19], v[144:147]
    ds_read_b64_tr_b16 v[90:91], v124 offset:6400
    s_add_u32 m0, s52, 1024
    s_mov_b32 s73, 768
    buffer_load_dwordx4 v121, s[8:11], s73 offen lds
    v_mfma_f32_16x16x32_bf16 v[168:171], v[96:99], v[20:23], v[168:171]
    ds_read_b64_tr_b16 v[92:93], v125 offset:6144
    v_mfma_f32_16x16x32_bf16 v[148:151], v[100:103], v[16:19], v[148:151]
    ds_read_b64_tr_b16 v[94:95], v125 offset:6400
    v_mfma_f32_16x16x32_bf16 v[172:175], v[100:103], v[20:23], v[172:175]
    ds_read_b64_tr_b16 v[96:97], v124 offset:8192
    s_waitcnt lgkmcnt(8)
    v_mfma_f32_16x16x32_bf16 v[152:155], v[16:19], v[104:107], v[152:155]
    ds_read_b64_tr_b16 v[98:99], v124 offset:8448
    v_mfma_f32_16x16x32_bf16 v[176:179], v[20:23], v[104:107], v[176:179]
    ds_read_b64_tr_b16 v[100:101], v125 offset:8192
    s_add_u32 m0, s52, 2048
    s_mov_b32 s73, 15104
    buffer_load_dwordx4 v120, s[8:11], s73 offen lds
    v_mfma_f32_16x16x32_bf16 v[156:159], v[16:19], v[108:111], v[156:159]
    ds_read_b64_tr_b16 v[102:103], v125 offset:8448
    v_mfma_f32_16x16x32_bf16 v[180:183], v[20:23], v[108:111], v[180:183]
    ds_read_b64_tr_b16 v[104:105], v124 offset:10240
    v_mfma_f32_16x16x32_bf16 v[184:187], v[112:115], v[24:27], v[184:187]
    ds_read_b64_tr_b16 v[106:107], v124 offset:10496
    v_mfma_f32_16x16x32_bf16 v[188:191], v[116:119], v[24:27], v[188:191]
    ds_read_b64_tr_b16 v[108:109], v125 offset:10240
    v_mfma_f32_16x16x32_bf16 v[48:51], v[16:19], v[16:19], v[48:51]
    ds_read_b64_tr_b16 v[110:111], v125 offset:10496
    s_add_u32 m0, s52, 3072
    s_mov_b32 s73, 15104
    buffer_load_dwordx4 v121, s[8:11], s73 offen lds
    v_mfma_f32_16x16x32_bf16 v[52:55], v[20:23], v[20:23], v[52:55]
    ds_read_b64_tr_b16 v[112:113], v126 offset:6144
    v_mfma_f32_16x16x32_bf16 v[56:59], v[24:27], v[24:27], v[56:59]
    ds_read_b64_tr_b16 v[114:115], v126 offset:6400
    v_mfma_f32_16x16x32_bf16 v[60:63], v[40:43], v[16:19], v[60:63]
    ds_read_b64_tr_b16 v[116:117], v127 offset:6144
    v_mfma_f32_16x16x32_bf16 v[64:67], v[40:43], v[20:23], v[64:67]
    ds_read_b64_tr_b16 v[118:119], v127 offset:6400
    v_mfma_f32_16x16x32_bf16 v[68:71], v[40:43], v[24:27], v[68:71]
    s_add_u32 m0, s7, 61440
    s_mov_b32 s73, 768
    s_mov_b64 exec, s[54:55]
    buffer_load_dwordx4 v122, s[8:11], s73 offen lds
    s_mov_b64 exec, -1
    v_mov_b32 v7, 0
    buffer_load_dword v6, v7, s[44:47], 0 offen sc1
    s_lshr_b32 s68, s2, 3
    s_lshl_b32 s68, s68, 2
    s_add_u32 s68, s68, s3
    v_lshlrev_b32 v219, 7, v1
    s_mul_i32 s86, s68, 3200
    s_mov_b64 exec, 0x1ffffff
    buffer_load_dword v234, v219, s[16:19], s86 offen
    s_mov_b64 exec, -1
    v_lshrrev_b32 v219, 2, v1
    v_mul_u32_u24 v219, 3584, v219
    v_and_b32 v220, 3, v1
    v_lshl_add_u32 v219, v220, 7, v219
    s_mul_i32 s68, s68, 57344
    s_and_b32 s69, s2, 7
    s_mul_i32 s86, s69, 3
    s_add_u32 s86, s86, 4
    s_lshl_b32 s87, s69, 2
    s_min_u32 s86, s86, s87
    s_lshl_b32 s86, s86, 7
    s_add_u32 s86, s86, s68
    s_cmp_lt_u32 s69, 4
    s_cselect_b32 exec_lo, -1, 0x77777777
    s_cselect_b32 exec_hi, -1, 0x77777777
    buffer_load_dword v235, v219, s[20:23], s86 offen
    s_mov_b64 exec, -1
    s_waitcnt vmcnt(11)
    s_barrier
    s_waitcnt lgkmcnt(8)
    v_mfma_f32_16x16x32_bf16 v[136:139], v[88:91], v[28:31], v[136:139]
    ds_read_b128 v[16:19], v128 offset:18432
    v_mfma_f32_16x16x32_bf16 v[160:163], v[88:91], v[32:35], v[160:163]
    ds_read_b128 v[20:23], v128 offset:20480
    v_mfma_f32_16x16x32_bf16 v[140:143], v[92:95], v[28:31], v[140:143]
    ds_read_b128 v[24:27], v130 offset:18432
    v_mfma_f32_16x16x32_bf16 v[164:167], v[92:95], v[32:35], v[164:167]
    ds_read_b64_tr_b16 v[88:89], v124 offset:12288
    v_mfma_f32_16x16x32_bf16 v[144:147], v[96:99], v[28:31], v[144:147]
    ds_read_b64_tr_b16 v[90:91], v124 offset:12544
    v_mfma_f32_16x16x32_bf16 v[168:171], v[96:99], v[32:35], v[168:171]
    ds_read_b64_tr_b16 v[92:93], v125 offset:12288
    v_mfma_f32_16x16x32_bf16 v[148:151], v[100:103], v[28:31], v[148:151]
    ds_read_b64_tr_b16 v[94:95], v125 offset:12544
    v_mfma_f32_16x16x32_bf16 v[172:175], v[100:103], v[32:35], v[172:175]
    ds_read_b64_tr_b16 v[96:97], v124 offset:14336
    s_waitcnt lgkmcnt(8)
    v_mfma_f32_16x16x32_bf16 v[152:155], v[28:31], v[104:107], v[152:155]
    ds_read_b64_tr_b16 v[98:99], v124 offset:14592
    v_mfma_f32_16x16x32_bf16 v[176:179], v[32:35], v[104:107], v[176:179]
    ds_read_b64_tr_b16 v[100:101], v125 offset:14336
    v_mfma_f32_16x16x32_bf16 v[156:159], v[28:31], v[108:111], v[156:159]
    ds_read_b64_tr_b16 v[102:103], v125 offset:14592
    v_mfma_f32_16x16x32_bf16 v[180:183], v[32:35], v[108:111], v[180:183]
    ds_read_b64_tr_b16 v[104:105], v124 offset:16384
    v_mfma_f32_16x16x32_bf16 v[184:187], v[112:115], v[36:39], v[184:187]
    ds_read_b64_tr_b16 v[106:107], v124 offset:16640
    v_mfma_f32_16x16x32_bf16 v[188:191], v[116:119], v[36:39], v[188:191]
    ds_read_b64_tr_b16 v[108:109], v125 offset:16384
    v_mfma_f32_16x16x32_bf16 v[48:51], v[28:31], v[28:31], v[48:51]
    ds_read_b64_tr_b16 v[110:111], v125 offset:16640
    v_mfma_f32_16x16x32_bf16 v[52:55], v[32:35], v[32:35], v[52:55]
    ds_read_b64_tr_b16 v[112:113], v126 offset:12288
    v_mfma_f32_16x16x32_bf16 v[56:59], v[36:39], v[36:39], v[56:59]
    ds_read_b64_tr_b16 v[114:115], v126 offset:12544
    v_mfma_f32_16x16x32_bf16 v[60:63], v[40:43], v[28:31], v[60:63]
    ds_read_b64_tr_b16 v[116:117], v127 offset:12288
    v_mfma_f32_16x16x32_bf16 v[64:67], v[40:43], v[32:35], v[64:67]
    ds_read_b64_tr_b16 v[118:119], v127 offset:12544
    v_mfma_f32_16x16x32_bf16 v[68:71], v[40:43], v[36:39], v[68:71]
    s_waitcnt lgkmcnt(8)
    v_mfma_f32_16x16x32_bf16 v[136:139], v[88:91], v[16:19], v[136:139]
    ds_read_b128 v[28:31], v129 offset:18432
    v_mfma_f32_16x16x32_bf16 v[160:163], v[88:91], v[20:23], v[160:163]
    ds_read_b128 v[32:35], v129 offset:20480
    v_mfma_f32_16x16x32_bf16 v[140:143], v[92:95], v[16:19], v[140:143]
    ds_read_b128 v[36:39], v131 offset:18432
    v_mfma_f32_16x16x32_bf16 v[164:167], v[92:95], v[20:23], v[164:167]
    ds_read_b64_tr_b16 v[88:89], v124 offset:18432
    v_mfma_f32_16x16x32_bf16 v[144:147], v[96:99], v[16:19], v[144:147]
    ds_read_b64_tr_b16 v[90:91], v124 offset:18688
    v_mfma_f32_16x16x32_bf16 v[168:171], v[96:99], v[20:23], v[168:171]
    ds_read_b64_tr_b16 v[92:93], v125 offset:18432
    v_mfma_f32_16x16x32_bf16 v[148:151], v[100:103], v[16:19], v[148:151]
    ds_read_b64_tr_b16 v[94:95], v125 offset:18688
    v_mfma_f32_16x16x32_bf16 v[172:175], v[100:103], v[20:23], v[172:175]
    ds_read_b64_tr_b16 v[96:97], v124 offset:20480
    s_waitcnt lgkmcnt(8)
    v_mfma_f32_16x16x32_bf16 v[152:155], v[16:19], v[104:107], v[152:155]
    ds_read_b64_tr_b16 v[98:99], v124 offset:20736
    v_mfma_f32_16x16x32_bf16 v[176:179], v[20:23], v[104:107], v[176:179]
    ds_read_b64_tr_b16 v[100:101], v125 offset:20480
    v_mfma_f32_16x16x32_bf16 v[156:159], v[16:19], v[108:111], v[156:159]
    ds_read_b64_tr_b16 v[102:103], v125 offset:20736
    v_mfma_f32_16x16x32_bf16 v[180:183], v[20:23], v[108:111], v[180:183]
    ds_read_b64_tr_b16 v[104:105], v124 offset:22528
    v_mfma_f32_16x16x32_bf16 v[184:187], v[112:115], v[24:27], v[184:187]
    ds_read_b64_tr_b16 v[106:107], v124 offset:22784
    v_mfma_f32_16x16x32_bf16 v[188:191], v[116:119], v[24:27], v[188:191]
    ds_read_b64_tr_b16 v[108:109], v125 offset:22528
    v_mfma_f32_16x16x32_bf16 v[48:51], v[16:19], v[16:19], v[48:51]
    ds_read_b64_tr_b16 v[110:111], v125 offset:22784
    v_mfma_f32_16x16x32_bf16 v[52:55], v[20:23], v[20:23], v[52:55]
    ds_read_b64_tr_b16 v[112:113], v126 offset:18432
    v_mfma_f32_16x16x32_bf16 v[56:59], v[24:27], v[24:27], v[56:59]
    ds_read_b64_tr_b16 v[114:115], v126 offset:18688
    v_mfma_f32_16x16x32_bf16 v[60:63], v[40:43], v[16:19], v[60:63]
    ds_read_b64_tr_b16 v[116:117], v127 offset:18432
    v_mfma_f32_16x16x32_bf16 v[64:67], v[40:43], v[20:23], v[64:67]
    ds_read_b64_tr_b16 v[118:119], v127 offset:18688
    v_mfma_f32_16x16x32_bf16 v[68:71], v[40:43], v[24:27], v[68:71]
    s_waitcnt vmcnt(3)
    s_barrier
    s_waitcnt lgkmcnt(8)
    v_mfma_f32_16x16x32_bf16 v[136:139], v[88:91], v[28:31], v[136:139]
    ds_read_b128 v[16:19], v128 offset:0
    v_mfma_f32_16x16x32_bf16 v[160:163], v[88:91], v[32:35], v[160:163]
    ds_read_b128 v[20:23], v128 offset:2048
    v_mfma_f32_16x16x32_bf16 v[140:143], v[92:95], v[28:31], v[140:143]
    ds_read_b128 v[24:27], v130 offset:0
    v_mfma_f32_16x16x32_bf16 v[164:167], v[92:95], v[32:35], v[164:167]
    ds_read_b64_tr_b16 v[88:89], v124 offset:24576
    v_mfma_f32_16x16x32_bf16 v[144:147], v[96:99], v[28:31], v[144:147]
    ds_read_b64_tr_b16 v[90:91], v124 offset:24832
    v_mfma_f32_16x16x32_bf16 v[168:171], v[96:99], v[32:35], v[168:171]
    ds_read_b64_tr_b16 v[92:93], v125 offset:24576
    v_mfma_f32_16x16x32_bf16 v[148:151], v[100:103], v[28:31], v[148:151]
    ds_read_b64_tr_b16 v[94:95], v125 offset:24832
    v_mfma_f32_16x16x32_bf16 v[172:175], v[100:103], v[32:35], v[172:175]
    ds_read_b64_tr_b16 v[96:97], v124 offset:26624
    s_waitcnt lgkmcnt(8)
    v_mfma_f32_16x16x32_bf16 v[152:155], v[28:31], v[104:107], v[152:155]
    ds_read_b64_tr_b16 v[98:99], v124 offset:26880
    v_mfma_f32_16x16x32_bf16 v[176:179], v[32:35], v[104:107], v[176:179]
    ds_read_b64_tr_b16 v[100:101], v125 offset:26624
    v_mfma_f32_16x16x32_bf16 v[156:159], v[28:31], v[108:111], v[156:159]
    ds_read_b64_tr_b16 v[102:103], v125 offset:26880
    v_mfma_f32_16x16x32_bf16 v[180:183], v[32:35], v[108:111], v[180:183]
    ds_read_b64_tr_b16 v[104:105], v124 offset:28672
    v_mfma_f32_16x16x32_bf16 v[184:187], v[112:115], v[36:39], v[184:187]
    ds_read_b64_tr_b16 v[106:107], v124 offset:28928
    v_mfma_f32_16x16x32_bf16 v[188:191], v[116:119], v[36:39], v[188:191]
    ds_read_b64_tr_b16 v[108:109], v125 offset:28672
    v_mfma_f32_16x16x32_bf16 v[48:51], v[28:31], v[28:31], v[48:51]
    ds_read_b64_tr_b16 v[110:111], v125 offset:28928
    v_mfma_f32_16x16x32_bf16 v[52:55], v[32:35], v[32:35], v[52:55]
    ds_read_b64_tr_b16 v[112:113], v126 offset:24576
    v_mfma_f32_16x16x32_bf16 v[56:59], v[36:39], v[36:39], v[56:59]
    ds_read_b64_tr_b16 v[114:115], v126 offset:24832
    v_mfma_f32_16x16x32_bf16 v[60:63], v[40:43], v[28:31], v[60:63]
    ds_read_b64_tr_b16 v[116:117], v127 offset:24576
    v_mfma_f32_16x16x32_bf16 v[64:67], v[40:43], v[32:35], v[64:67]
    ds_read_b64_tr_b16 v[118:119], v127 offset:24832
    v_mfma_f32_16x16x32_bf16 v[68:71], v[40:43], v[36:39], v[68:71]
    s_waitcnt lgkmcnt(8)
    v_mfma_f32_16x16x32_bf16 v[136:139], v[88:91], v[16:19], v[136:139]
    ds_read_b128 v[28:31], v129 offset:0
    v_mfma_f32_16x16x32_bf16 v[160:163], v[88:91], v[20:23], v[160:163]
    ds_read_b128 v[32:35], v129 offset:2048
    v_mfma_f32_16x16x32_bf16 v[140:143], v[92:95], v[16:19], v[140:143]
    ds_read_b128 v[36:39], v131 offset:0
    v_mfma_f32_16x16x32_bf16 v[164:167], v[92:95], v[20:23], v[164:167]
    ds_read_b64_tr_b16 v[88:89], v124 offset:30720
    v_mfma_f32_16x16x32_bf16 v[144:147], v[96:99], v[16:19], v[144:147]
    ds_read_b64_tr_b16 v[90:91], v124 offset:30976
    v_mfma_f32_16x16x32_bf16 v[168:171], v[96:99], v[20:23], v[168:171]
    ds_read_b64_tr_b16 v[92:93], v125 offset:30720
    v_mfma_f32_16x16x32_bf16 v[148:151], v[100:103], v[16:19], v[148:151]
    ds_read_b64_tr_b16 v[94:95], v125 offset:30976
    v_mfma_f32_16x16x32_bf16 v[172:175], v[100:103], v[20:23], v[172:175]
    ds_read_b64_tr_b16 v[96:97], v124 offset:32768
    s_waitcnt lgkmcnt(8)
    v_mfma_f32_16x16x32_bf16 v[152:155], v[16:19], v[104:107], v[152:155]
    ds_read_b64_tr_b16 v[98:99], v124 offset:33024
    v_mfma_f32_16x16x32_bf16 v[176:179], v[20:23], v[104:107], v[176:179]
    ds_read_b64_tr_b16 v[100:101], v125 offset:32768
    v_mfma_f32_16x16x32_bf16 v[156:159], v[16:19], v[108:111], v[156:159]
    ds_read_b64_tr_b16 v[102:103], v125 offset:33024
    v_mfma_f32_16x16x32_bf16 v[180:183], v[20:23], v[108:111], v[180:183]
    ds_read_b64_tr_b16 v[104:105], v124 offset:34816
    v_mfma_f32_16x16x32_bf16 v[184:187], v[112:115], v[24:27], v[184:187]
    ds_read_b64_tr_b16 v[106:107], v124 offset:35072
    v_mfma_f32_16x16x32_bf16 v[188:191], v[116:119], v[24:27], v[188:191]
    ds_read_b64_tr_b16 v[108:109], v125 offset:34816
    v_mfma_f32_16x16x32_bf16 v[48:51], v[16:19], v[16:19], v[48:51]
    ds_read_b64_tr_b16 v[110:111], v125 offset:35072
    v_mfma_f32_16x16x32_bf16 v[52:55], v[20:23], v[20:23], v[52:55]
    ds_read_b64_tr_b16 v[112:113], v126 offset:30720
    v_mfma_f32_16x16x32_bf16 v[56:59], v[24:27], v[24:27], v[56:59]
    ds_read_b64_tr_b16 v[114:115], v126 offset:30976
    v_mfma_f32_16x16x32_bf16 v[60:63], v[40:43], v[16:19], v[60:63]
    ds_read_b64_tr_b16 v[116:117], v127 offset:30720
    v_mfma_f32_16x16x32_bf16 v[64:67], v[40:43], v[20:23], v[64:67]
    ds_read_b64_tr_b16 v[118:119], v127 offset:30976
    v_mfma_f32_16x16x32_bf16 v[68:71], v[40:43], v[24:27], v[68:71]
    s_waitcnt lgkmcnt(8)
    v_mfma_f32_16x16x32_bf16 v[136:139], v[88:91], v[28:31], v[136:139]
    v_mfma_f32_16x16x32_bf16 v[160:163], v[88:91], v[32:35], v[160:163]
    v_mfma_f32_16x16x32_bf16 v[140:143], v[92:95], v[28:31], v[140:143]
    v_mfma_f32_16x16x32_bf16 v[164:167], v[92:95], v[32:35], v[164:167]
    v_mfma_f32_16x16x32_bf16 v[144:147], v[96:99], v[28:31], v[144:147]
    v_mfma_f32_16x16x32_bf16 v[168:171], v[96:99], v[32:35], v[168:171]
    v_mfma_f32_16x16x32_bf16 v[148:151], v[100:103], v[28:31], v[148:151]
    v_mfma_f32_16x16x32_bf16 v[172:175], v[100:103], v[32:35], v[172:175]
    s_waitcnt lgkmcnt(6)
    v_mfma_f32_16x16x32_bf16 v[152:155], v[28:31], v[104:107], v[152:155]
    v_mfma_f32_16x16x32_bf16 v[176:179], v[32:35], v[104:107], v[176:179]
    s_waitcnt lgkmcnt(4)
    v_mfma_f32_16x16x32_bf16 v[156:159], v[28:31], v[108:111], v[156:159]
    v_mfma_f32_16x16x32_bf16 v[180:183], v[32:35], v[108:111], v[180:183]
    s_waitcnt lgkmcnt(2)
    v_mfma_f32_16x16x32_bf16 v[184:187], v[112:115], v[36:39], v[184:187]
    s_waitcnt lgkmcnt(0)
    v_mfma_f32_16x16x32_bf16 v[188:191], v[116:119], v[36:39], v[188:191]
    v_mfma_f32_16x16x32_bf16 v[48:51], v[28:31], v[28:31], v[48:51]
    v_mfma_f32_16x16x32_bf16 v[52:55], v[32:35], v[32:35], v[52:55]
    v_mfma_f32_16x16x32_bf16 v[56:59], v[36:39], v[36:39], v[56:59]
    v_mfma_f32_16x16x32_bf16 v[60:63], v[40:43], v[28:31], v[60:63]
    v_mfma_f32_16x16x32_bf16 v[64:67], v[40:43], v[32:35], v[64:67]
    v_mfma_f32_16x16x32_bf16 v[68:71], v[40:43], v[36:39], v[68:71]
    s_mov_b32 exec_lo, 0x00010001
    s_mov_b32 exec_hi, 0x00010001
    ds_write_b128 v73, v[184:187] offset:128
    ds_write_b128 v74, v[188:191] offset:0
    s_mov_b64 exec, -1
    v_cndmask_b32 v48, v48, v49, s[88:89]
    v_cndmask_b32 v52, v52, v53, s[88:89]
    v_cndmask_b32 v56, v56, v57, s[88:89]
    v_cndmask_b32 v48, v48, v50, s[90:91]
    v_cndmask_b32 v52, v52, v54, s[90:91]
    v_cndmask_b32 v56, v56, v58, s[90:91]
    v_cndmask_b32 v48, v48, v51, s[92:93]
    v_cndmask_b32 v52, v52, v55, s[92:93]
    v_cndmask_b32 v56, v56, v59, s[92:93]
    v_mul_f32 v25, 0x3b124925, v60
    v_mul_f32 v27, 0x3b124925, v64
    v_mul_f32 v29, 0x3b124925, v68
    v_mul_f32 v24, v25, v25
    v_mul_f32 v26, v27, v27
    v_mul_f32 v28, v29, v29
    v_mul_f32 v48, 0x3b124925, v48
    v_mul_f32 v52, 0x3b124925, v52
    v_mul_f32 v56, 0x3b124925, v56
    v_sub_f32 v24, v48, v24
    v_sub_f32 v26, v52, v26
    v_sub_f32 v28, v56, v28
    v_max_f32 v24, 0, v24
    v_max_f32 v26, 0, v26
    v_max_f32 v28, 0, v28
    v_add_f32 v24, 0x3727c5ac, v24
    v_add_f32 v26, 0x3727c5ac, v26
    v_add_f32 v28, 0x3727c5ac, v28
    v_rsq_f32 v24, v24
    v_rsq_f32 v26, v26
    v_rsq_f32 v28, v28
    s_mov_b32 exec_lo, 0x00f0000f
    s_mov_b32 exec_hi, 0xf0000f00
    ds_write2_b32 v75, v24, v25 offset0:128 offset1:144
    ds_write2_b32 v75, v26, v27 offset0:160 offset1:176
    ds_write2_b32 v75, v28, v29 offset0:192 offset1:208
    s_mov_b64 exec, -1
    v_mov_b32_dpp v16, v184 row_newbcast:0 row_mask:0xf bank_mask:0xf
    v_mov_b32_dpp v17, v185 row_newbcast:0 row_mask:0xf bank_mask:0xf
    v_mov_b32_dpp v18, v186 row_newbcast:0 row_mask:0xf bank_mask:0xf
    v_mov_b32_dpp v19, v187 row_newbcast:0 row_mask:0xf bank_mask:0xf
    v_pk_fma_f32 v[16:17], v[16:17], v[28:29], v[184:185] op_sel:[0,1,0] op_sel_hi:[1,1,1] neg_lo:[0,1,0] neg_hi:[0,1,0]
    v_pk_fma_f32 v[18:19], v[18:19], v[28:29], v[186:187] op_sel:[0,1,0] op_sel_hi:[1,1,1] neg_lo:[0,1,0] neg_hi:[0,1,0]
    s_cmp_eq_u32 s49, 15
    s_cselect_b32 s88, 0xffff0000, -1
    s_mov_b32 s89, -1
    s_mov_b32 s90, -1
    s_cselect_b32 s91, -1, 0xffff
    s_waitcnt lgkmcnt(0)
    s_barrier
    ds_read_b32 v26, v75 offset:640
    ds_read_b32 v28, v75 offset:768
    ds_read_b32 v24, v75 offset:512
    ds_read_b128 v[56:59], v72 offset:128
    ds_read_b128 v[60:63], v72 offset:192
    ds_read_b32 v64, v77 offset:256
    ds_read_b32 v65, v77 offset:320
    ds_read_b128 v[44:47], v76 offset:704
    ds_read_b128 v[40:43], v76 offset:640
    ds_read_b128 v[36:39], v76 offset:576
    ds_read_b128 v[32:35], v76 offset:512
    ds_read_b128 v[48:51], v72 offset:0
    ds_read_b128 v[52:55], v72 offset:64
    s_waitcnt lgkmcnt(9)
    v_pk_fma_f32 v[168:169], v[56:57], v[26:27], v[168:169] op_sel:[0,1,0] op_sel_hi:[1,1,1] neg_lo:[0,1,0] neg_hi:[0,1,0]
    v_pk_fma_f32 v[170:171], v[58:59], v[26:27], v[170:171] op_sel:[0,1,0] op_sel_hi:[1,1,1] neg_lo:[0,1,0] neg_hi:[0,1,0]
    v_pk_mul_f32 v[168:169], v[168:169], v[26:27] op_sel:[0,0] op_sel_hi:[1,0]
    v_pk_mul_f32 v[170:171], v[170:171], v[26:27] op_sel:[0,0] op_sel_hi:[1,0]
    v_cvt_pk_bf16_f32 v104, v168, v169
    v_cvt_pk_bf16_f32 v105, v170, v171
    s_waitcnt lgkmcnt(8)
    v_pk_fma_f32 v[172:173], v[60:61], v[26:27], v[172:173] op_sel:[0,1,0] op_sel_hi:[1,1,1] neg_lo:[0,1,0] neg_hi:[0,1,0]
    v_pk_fma_f32 v[174:175], v[62:63], v[26:27], v[174:175] op_sel:[0,1,0] op_sel_hi:[1,1,1] neg_lo:[0,1,0] neg_hi:[0,1,0]
    v_pk_mul_f32 v[172:173], v[172:173], v[26:27] op_sel:[0,0] op_sel_hi:[1,0]
    v_pk_mul_f32 v[174:175], v[174:175], v[26:27] op_sel:[0,0] op_sel_hi:[1,0]
    v_cvt_pk_bf16_f32 v106, v172, v173
    v_cvt_pk_bf16_f32 v107, v174, v175
    ds_write_b128 v78, v[104:107] offset:4096
    v_pk_mul_f32 v[16:17], v[16:17], v[28:29] op_sel_hi:[1,0]
    v_pk_mul_f32 v[18:19], v[18:19], v[28:29] op_sel_hi:[1,0]
    v_cvt_pk_bf16_f32 v16, v16, v17
    v_cvt_pk_bf16_f32 v18, v18, v19
    ds_write_b16 v80, v16 offset:2048
    ds_write_b16_d16_hi v81, v16 offset:2048
    ds_write_b16 v82, v18 offset:2048
    ds_write_b16_d16_hi v83, v18 offset:2048
    s_waitcnt lgkmcnt(10)
    v_pk_fma_f32 v[176:177], v[44:45], v[64:65], v[176:177] op_sel:[0,0,0] op_sel_hi:[1,0,1] neg_lo:[0,1,0] neg_hi:[0,1,0]
    v_pk_fma_f32 v[178:179], v[46:47], v[64:65], v[178:179] op_sel:[0,0,0] op_sel_hi:[1,0,1] neg_lo:[0,1,0] neg_hi:[0,1,0]
    s_waitcnt lgkmcnt(9)
    v_pk_mul_f32 v[176:177], v[176:177], v[40:41]
    v_pk_mul_f32 v[178:179], v[178:179], v[42:43]
    v_cvt_pk_bf16_f32 v112, v176, v177
    v_cvt_pk_bf16_f32 v113, v178, v179
    v_pk_fma_f32 v[180:181], v[44:45], v[64:65], v[180:181] op_sel:[0,1,0] op_sel_hi:[1,1,1] neg_lo:[0,1,0] neg_hi:[0,1,0]
    v_pk_fma_f32 v[182:183], v[46:47], v[64:65], v[182:183] op_sel:[0,1,0] op_sel_hi:[1,1,1] neg_lo:[0,1,0] neg_hi:[0,1,0]
    v_pk_mul_f32 v[180:181], v[180:181], v[40:41]
    v_pk_mul_f32 v[182:183], v[182:183], v[42:43]
    v_cvt_pk_bf16_f32 v118, v180, v181
    v_cvt_pk_bf16_f32 v119, v182, v183
    ds_write_b64 v78, v[112:113] offset:5120
    ds_write_b64 v78, v[118:119] offset:5128
    v_mul_f32 v68, 0x3e8b97f6, v24
    v_mul_f32 v70, 0x3e8b97f6, v26
    v_cndmask_b32 v69, 0, v68, s[90:91]
    v_cndmask_b32 v68, 0, v68, s[88:89]
    v_cndmask_b32 v71, 0, v70, s[90:91]
    v_cndmask_b32 v70, 0, v70, s[88:89]
    v_pk_fma_f32 v[144:145], v[56:57], v[24:25], v[144:145] op_sel:[0,1,0] op_sel_hi:[1,1,1] neg_lo:[0,1,0] neg_hi:[0,1,0]
    v_pk_fma_f32 v[146:147], v[58:59], v[24:25], v[146:147] op_sel:[0,1,0] op_sel_hi:[1,1,1] neg_lo:[0,1,0] neg_hi:[0,1,0]
    v_pk_mul_f32 v[144:145], v[144:145], v[24:25] op_sel:[0,0] op_sel_hi:[1,0]
    v_pk_mul_f32 v[146:147], v[146:147], v[24:25] op_sel:[0,0] op_sel_hi:[1,0]
    v_cvt_pk_bf16_f32 v100, v144, v145
    v_cvt_pk_bf16_f32 v101, v146, v147
    v_pk_fma_f32 v[148:149], v[60:61], v[24:25], v[148:149] op_sel:[0,1,0] op_sel_hi:[1,1,1] neg_lo:[0,1,0] neg_hi:[0,1,0]
    v_pk_fma_f32 v[150:151], v[62:63], v[24:25], v[150:151] op_sel:[0,1,0] op_sel_hi:[1,1,1] neg_lo:[0,1,0] neg_hi:[0,1,0]
    v_pk_mul_f32 v[148:149], v[148:149], v[24:25] op_sel:[0,0] op_sel_hi:[1,0]
    v_pk_mul_f32 v[150:151], v[150:151], v[24:25] op_sel:[0,0] op_sel_hi:[1,0]
    v_cvt_pk_bf16_f32 v102, v148, v149
    v_cvt_pk_bf16_f32 v103, v150, v151
    s_waitcnt lgkmcnt(0)
    s_barrier
    ds_read_b128 v[96:99], v78 offset:2048
    ds_read_b64 v[108:109], v78 offset:3072
    ds_read_b64 v[114:115], v78 offset:3080
    v_pk_fma_f32 v[160:161], v[48:49], v[26:27], v[160:161] op_sel:[0,1,0] op_sel_hi:[1,1,1] neg_lo:[0,1,0] neg_hi:[0,1,0]
    v_pk_fma_f32 v[162:163], v[50:51], v[26:27], v[162:163] op_sel:[0,1,0] op_sel_hi:[1,1,1] neg_lo:[0,1,0] neg_hi:[0,1,0]
    v_pk_mul_f32 v[160:161], v[160:161], v[70:71] op_sel:[0,0] op_sel_hi:[1,0]
    v_pk_mul_f32 v[162:163], v[162:163], v[70:71] op_sel:[0,0] op_sel_hi:[1,0]
    v_cvt_pk_bf16_f32 v92, v160, v161
    v_cvt_pk_bf16_f32 v93, v162, v163
    v_pk_fma_f32 v[164:165], v[52:53], v[26:27], v[164:165] op_sel:[0,1,0] op_sel_hi:[1,1,1] neg_lo:[0,1,0] neg_hi:[0,1,0]
    v_pk_fma_f32 v[166:167], v[54:55], v[26:27], v[166:167] op_sel:[0,1,0] op_sel_hi:[1,1,1] neg_lo:[0,1,0] neg_hi:[0,1,0]
    v_pk_mul_f32 v[164:165], v[164:165], v[70:71] op_sel:[0,1] op_sel_hi:[1,1]
    v_pk_mul_f32 v[166:167], v[166:167], v[70:71] op_sel:[0,1] op_sel_hi:[1,1]
    v_cvt_pk_bf16_f32 v94, v164, v165
    v_cvt_pk_bf16_f32 v95, v166, v167
    s_nop 1
    v_mfma_f32_16x16x32_bf16 v[128:131], v[100:103], v[92:95], v[240:243]
    v_mfma_f32_16x16x32_bf16 v[132:135], v[104:107], v[92:95], v[244:247]
    v_pk_fma_f32 v[136:137], v[48:49], v[24:25], v[136:137] op_sel:[0,1,0] op_sel_hi:[1,1,1] neg_lo:[0,1,0] neg_hi:[0,1,0]
    v_pk_fma_f32 v[138:139], v[50:51], v[24:25], v[138:139] op_sel:[0,1,0] op_sel_hi:[1,1,1] neg_lo:[0,1,0] neg_hi:[0,1,0]
    v_pk_mul_f32 v[136:137], v[136:137], v[68:69] op_sel:[0,0] op_sel_hi:[1,0]
    v_pk_mul_f32 v[138:139], v[138:139], v[68:69] op_sel:[0,0] op_sel_hi:[1,0]
    v_cvt_pk_bf16_f32 v88, v136, v137
    v_cvt_pk_bf16_f32 v89, v138, v139
    v_pk_fma_f32 v[140:141], v[52:53], v[24:25], v[140:141] op_sel:[0,1,0] op_sel_hi:[1,1,1] neg_lo:[0,1,0] neg_hi:[0,1,0]
    v_pk_fma_f32 v[142:143], v[54:55], v[24:25], v[142:143] op_sel:[0,1,0] op_sel_hi:[1,1,1] neg_lo:[0,1,0] neg_hi:[0,1,0]
    v_pk_mul_f32 v[140:141], v[140:141], v[68:69] op_sel:[0,1] op_sel_hi:[1,1]
    v_pk_mul_f32 v[142:143], v[142:143], v[68:69] op_sel:[0,1] op_sel_hi:[1,1]
    v_cvt_pk_bf16_f32 v90, v140, v141
    v_cvt_pk_bf16_f32 v91, v142, v143
    s_waitcnt lgkmcnt(2)
    s_nop 0
    v_mfma_f32_16x16x32_bf16 v[120:123], v[96:99], v[88:91], v[248:251]
    v_mfma_f32_16x16x32_bf16 v[124:127], v[100:103], v[88:91], v[244:247]
    v_pk_fma_f32 v[152:153], v[36:37], v[64:65], v[152:153] op_sel:[0,0,0] op_sel_hi:[1,0,1] neg_lo:[0,1,0] neg_hi:[0,1,0]
    v_pk_fma_f32 v[154:155], v[38:39], v[64:65], v[154:155] op_sel:[0,0,0] op_sel_hi:[1,0,1] neg_lo:[0,1,0] neg_hi:[0,1,0]
    v_pk_mul_f32 v[152:153], v[152:153], v[32:33]
    v_pk_mul_f32 v[154:155], v[154:155], v[34:35]
    v_cvt_pk_bf16_f32 v110, v152, v153
    v_cvt_pk_bf16_f32 v111, v154, v155
    v_pk_fma_f32 v[156:157], v[36:37], v[64:65], v[156:157] op_sel:[0,1,0] op_sel_hi:[1,1,1] neg_lo:[0,1,0] neg_hi:[0,1,0]
    v_pk_fma_f32 v[158:159], v[38:39], v[64:65], v[158:159] op_sel:[0,1,0] op_sel_hi:[1,1,1] neg_lo:[0,1,0] neg_hi:[0,1,0]
    v_pk_mul_f32 v[156:157], v[156:157], v[32:33]
    v_pk_mul_f32 v[158:159], v[158:159], v[34:35]
    v_cvt_pk_bf16_f32 v116, v156, v157
    v_cvt_pk_bf16_f32 v117, v158, v159
    v_max3_f32 v137, v128, v129, v130
    v_max3_f32 v139, v131, v132, v133
    v_max3_f32 v137, v137, v134, v135
    v_max_f32 v137, v137, v139
    v_max3_f32 v136, v120, v121, v122
    v_max3_f32 v138, v123, v124, v125
    v_max3_f32 v136, v136, v126, v127
    v_max_f32 v136, v136, v138
    v_mov_b32 v138, v136
    v_mov_b32 v139, v137
    s_nop 0
    v_permlane32_swap_b32 v136, v138
    v_permlane32_swap_b32 v137, v139
    v_max_f32 v136, v136, v138
    v_max_f32 v137, v137, v139
    v_mov_b32 v138, v136
    v_mov_b32 v139, v137
    s_nop 0
    v_permlane16_swap_b32 v136, v138
    v_permlane16_swap_b32 v137, v139
    v_max_f32 v136, v136, v138
    v_max_f32 v137, v137, v139
    v_pk_add_f32 v[128:129], v[128:129], v[136:137] op_sel:[0,1] op_sel_hi:[1,1] neg_lo:[0,1] neg_hi:[0,1]
    v_pk_add_f32 v[130:131], v[130:131], v[136:137] op_sel:[0,1] op_sel_hi:[1,1] neg_lo:[0,1] neg_hi:[0,1]
    v_pk_add_f32 v[132:133], v[132:133], v[136:137] op_sel:[0,1] op_sel_hi:[1,1] neg_lo:[0,1] neg_hi:[0,1]
    v_pk_add_f32 v[134:135], v[134:135], v[136:137] op_sel:[0,1] op_sel_hi:[1,1] neg_lo:[0,1] neg_hi:[0,1]
    v_exp_f32 v128, v128
    v_exp_f32 v129, v129
    v_exp_f32 v130, v130
    v_exp_f32 v131, v131
    v_exp_f32 v132, v132
    v_exp_f32 v133, v133
    v_exp_f32 v134, v134
    v_exp_f32 v135, v135
    v_cvt_pk_bf16_f32 v148, v128, v129
    v_cvt_pk_bf16_f32 v149, v130, v131
    v_cvt_pk_bf16_f32 v150, v132, v133
    v_cvt_pk_bf16_f32 v151, v134, v135
    s_nop 1
    v_mfma_f32_16x16x32_bf16 v[160:163], v[110:113], v[148:151], 0
    v_mfma_f32_16x16x32_bf16 v[164:167], v[116:119], v[148:151], 0
    v_pk_add_f32 v[120:121], v[120:121], v[136:137] op_sel:[0,0] op_sel_hi:[1,0] neg_lo:[0,1] neg_hi:[0,1]
    v_pk_add_f32 v[122:123], v[122:123], v[136:137] op_sel:[0,0] op_sel_hi:[1,0] neg_lo:[0,1] neg_hi:[0,1]
    v_pk_add_f32 v[124:125], v[124:125], v[136:137] op_sel:[0,0] op_sel_hi:[1,0] neg_lo:[0,1] neg_hi:[0,1]
    v_pk_add_f32 v[126:127], v[126:127], v[136:137] op_sel:[0,0] op_sel_hi:[1,0] neg_lo:[0,1] neg_hi:[0,1]
    v_exp_f32 v120, v120
    v_exp_f32 v121, v121
    v_exp_f32 v122, v122
    v_exp_f32 v123, v123
    v_exp_f32 v124, v124
    v_exp_f32 v125, v125
    v_exp_f32 v126, v126
    v_exp_f32 v127, v127
    v_cvt_pk_bf16_f32 v144, v120, v121
    v_cvt_pk_bf16_f32 v145, v122, v123
    v_cvt_pk_bf16_f32 v146, v124, v125
    v_cvt_pk_bf16_f32 v147, v126, v127
    s_waitcnt lgkmcnt(1)
    s_nop 0
    v_mfma_f32_16x16x32_bf16 v[152:155], v[108:111], v[144:147], 0
    s_waitcnt lgkmcnt(0)
    v_mfma_f32_16x16x32_bf16 v[156:159], v[114:117], v[144:147], 0
    v_pk_add_f32 v[120:121], v[120:121], v[122:123]
    v_pk_add_f32 v[124:125], v[124:125], v[126:127]
    v_pk_add_f32 v[128:129], v[128:129], v[130:131]
    v_pk_add_f32 v[132:133], v[132:133], v[134:135]
    v_pk_add_f32 v[120:121], v[120:121], v[124:125]
    v_pk_add_f32 v[128:129], v[128:129], v[132:133]
    v_add_f32 v140, v120, v121
    v_add_f32 v142, v128, v129
    v_mov_b32 v138, v140
    v_mov_b32 v139, v142
    s_nop 0
    v_permlane32_swap_b32 v140, v138
    v_permlane32_swap_b32 v142, v139
    v_add_f32 v140, v140, v138
    v_add_f32 v142, v142, v139
    v_mov_b32 v138, v140
    v_mov_b32 v139, v142
    s_nop 0
    v_permlane16_swap_b32 v140, v138
    v_permlane16_swap_b32 v142, v139
    v_add_f32 v140, v140, v138
    v_add_f32 v142, v142, v139
    v_rcp_f32 v140, v140
    v_rcp_f32 v142, v142
    v_cndmask_b32 v141, 0, v140, s[90:91]
    v_cndmask_b32 v140, 0, v140, s[88:89]
    v_cndmask_b32 v143, 0, v142, s[90:91]
    v_cndmask_b32 v142, 0, v142, s[88:89]
    v_pk_mul_f32 v[152:153], v[152:153], v[140:141] op_sel_hi:[1,0]
    v_pk_mul_f32 v[154:155], v[154:155], v[140:141] op_sel_hi:[1,0]
    v_pk_mul_f32 v[156:157], v[156:157], v[140:141] op_sel:[0,1] op_sel_hi:[1,1]
    v_pk_mul_f32 v[158:159], v[158:159], v[140:141] op_sel:[0,1] op_sel_hi:[1,1]
    v_cvt_pk_bf16_f32 v144, v152, v153
    v_cvt_pk_bf16_f32 v145, v154, v155
    v_cvt_pk_bf16_f32 v146, v156, v157
    v_cvt_pk_bf16_f32 v147, v158, v159
    buffer_store_dwordx4 v[144:147], v4, s[40:43], s62 offen sc1
    v_pk_mul_f32 v[160:161], v[160:161], v[142:143] op_sel_hi:[1,0]
    v_pk_mul_f32 v[162:163], v[162:163], v[142:143] op_sel_hi:[1,0]
    v_pk_mul_f32 v[164:165], v[164:165], v[142:143] op_sel:[0,1] op_sel_hi:[1,1]
    v_pk_mul_f32 v[166:167], v[166:167], v[142:143] op_sel:[0,1] op_sel_hi:[1,1]
    v_cvt_pk_bf16_f32 v148, v160, v161
    v_cvt_pk_bf16_f32 v149, v162, v163
    v_cvt_pk_bf16_f32 v150, v164, v165
    v_cvt_pk_bf16_f32 v151, v166, v167
    buffer_store_dwordx4 v[148:151], v4, s[40:43], s63 offen sc1
    s_add_u32 m0, s59, 0
    s_mov_b32 s73, 0
    buffer_load_dwordx4 v208, s[16:19], s73 offen lds
    s_add_u32 m0, s59, 1024
    s_mov_b32 s73, 7168
    buffer_load_dwordx4 v208, s[16:19], s73 offen lds
    s_add_u32 m0, s59, 2048
    s_mov_b32 s73, 14336
    buffer_load_dwordx4 v208, s[16:19], s73 offen lds
    s_add_u32 m0, s59, 3072
    s_mov_b32 s73, 21504
    buffer_load_dwordx4 v208, s[16:19], s73 offen lds
    s_add_u32 m0, s59, 4096
    s_mov_b32 s73, 28672
    buffer_load_dwordx4 v208, s[16:19], s73 offen lds
    s_add_u32 m0, s59, 5120
    s_mov_b32 s73, 35840
    buffer_load_dwordx4 v208, s[16:19], s73 offen lds
    s_add_u32 m0, s59, 6144
    s_mov_b32 s73, 43008
    buffer_load_dwordx4 v208, s[16:19], s73 offen lds
    s_add_u32 m0, s59, 7168
    s_mov_b32 s73, 50176
    buffer_load_dwordx4 v208, s[16:19], s73 offen lds
    s_add_u32 m0, s59, 8192
    s_mov_b32 s73, 57344
    buffer_load_dwordx4 v208, s[16:19], s73 offen lds
    s_add_u32 m0, s59, 9216
    s_mov_b32 s73, 64512
    buffer_load_dwordx4 v208, s[16:19], s73 offen lds
    s_add_u32 m0, s59, 10240
    s_mov_b32 s73, 71680
    buffer_load_dwordx4 v208, s[16:19], s73 offen lds
    s_add_u32 m0, s59, 11264
    s_mov_b32 s73, 78848
    buffer_load_dwordx4 v208, s[16:19], s73 offen lds
    s_add_u32 m0, s59, 12288
    s_mov_b32 s73, 86016
    buffer_load_dwordx4 v208, s[16:19], s73 offen lds
    s_add_u32 m0, s59, 13312
    s_mov_b32 s73, 93184
    buffer_load_dwordx4 v208, s[16:19], s73 offen lds
    s_waitcnt vmcnt(18)
    v_readfirstlane_b32 s4, v6
    s_nop 1
    s_cmp_lg_u32 s4, 0
    s_cbranch_scc1 Lepd_P_2
    s_nop 0
Lepg_P_1:
    s_sub_u32 s6, s6, 1
    s_cbranch_scc1 L_end_P
    buffer_load_dword v6, v7, s[44:47], 0 offen sc1
    s_waitcnt vmcnt(0)
    v_readfirstlane_b32 s4, v6
    s_nop 1
    s_cmp_eq_u32 s4, 0
    s_cbranch_scc1 Lepg_P_1
Lepd_P_2:
    s_waitcnt vmcnt(14)
    v_mov_b32 v8, s4
    s_mov_b64 exec, 1
    buffer_store_dword v8, v9, s[40:43], s80 offen sc1
    s_mov_b64 exec, -1
    s_cmp_lt_u32 s67, 99
    s_cbranch_scc1 Lnotag_P_3
    s_lshr_b32 s68, s2, 3
    s_sub_u32 s68, s68, 28
    s_lshl_b32 s68, s68, 2
    s_add_u32 s68, s68, s3
    s_lshl_b32 s68, s68, 16
    s_and_b32 s69, s2, 7
    s_lshl_b32 s69, s69, 9
    s_add_u32 s68, s68, s69
    v_lshrrev_b32 v16, 2, v1
    v_lshlrev_b32 v16, 12, v16
    v_and_b32 v17, 3, v1
    v_lshl_add_u32 v16, v17, 7, v16
    buffer_load_dword v18, v16, s[24:27], s68 offen
    s_add_u32 s68, s68, 0x100000
    s_waitcnt vmcnt(3)
    buffer_load_dword v19, v16, s[24:27], s68 offen
    s_add_u32 s68, s68, 0x100000
    s_waitcnt vmcnt(3)
    buffer_load_dword v20, v16, s[24:27], s68 offen
    s_add_u32 s68, s68, 0x100000
    s_waitcnt vmcnt(3)
    buffer_load_dword v21, v16, s[24:27], s68 offen
    s_add_u32 s68, s68, 0x100000
    s_waitcnt vmcnt(3)
    buffer_load_dword v22, v16, s[24:27], s68 offen
    s_add_u32 s68, s68, 0x100000
    s_waitcnt vmcnt(3)
    buffer_load_dword v23, v16, s[24:27], s68 offen
    s_add_u32 s68, s68, 0x100000
    s_waitcnt vmcnt(3)
    buffer_load_dword v24, v16, s[24:27], s68 offen
    s_add_u32 s68, s68, 0x100000
    s_waitcnt vmcnt(3)
    s_waitcnt vmcnt(0)
    s_branch L_end_P
Lnotag_P_3:
    v_lshrrev_b32 v221, 5, v1
    v_mul_u32_u24 v221, 3584, v221
    v_and_b32 v222, 31, v1
    v_lshl_add_u32 v221, v222, 1, v221
    s_lshl_b32 s58, s67, 1
    s_lshr_b32 s60, s3, 1
    s_add_u32 s58, s58, s60
    s_mul_i32 s58, s58, 28672
    s_lshl_b32 s60, s66, 7
    s_add_u32 s58, s58, s60
    s_and_b32 s60, s3, 1
    s_lshl_b32 s60, s60, 6
    s_add_u32 s58, s58, s60
    buffer_load_ushort v192, v221, s[8:11], s58 offen offset:0
    buffer_load_ushort v193, v221, s[8:11], s58 offen offset:896
    buffer_load_ushort v194, v221, s[8:11], s58 offen offset:1792
    buffer_load_ushort v195, v221, s[8:11], s58 offen offset:2688
    s_add_u32 s58, s58, 7168
    buffer_load_ushort v196, v221, s[8:11], s58 offen offset:0
    buffer_load_ushort v197, v221, s[8:11], s58 offen offset:896
    buffer_load_ushort v198, v221, s[8:11], s58 offen offset:1792
    buffer_load_ushort v199, v221, s[8:11], s58 offen offset:2688
    s_add_u32 s58, s58, 7168
    buffer_load_ushort v200, v221, s[8:11], s58 offen offset:0
    buffer_load_ushort v201, v221, s[8:11], s58 offen offset:896
    buffer_load_ushort v202, v221, s[8:11], s58 offen offset:1792
    buffer_load_ushort v203, v221, s[8:11], s58 offen offset:2688
    s_add_u32 s58, s58, 7168
    buffer_load_ushort v204, v221, s[8:11], s58 offen offset:0
    buffer_load_ushort v205, v221, s[8:11], s58 offen offset:896
    buffer_load_ushort v206, v221, s[8:11], s58 offen offset:1792
    buffer_load_ushort v207, v221, s[8:11], s58 offen offset:2688
    s_and_b32 s68, s2, 7
    s_cmp_ge_u32 s68, 7
    s_cselect_b32 s48, 7, 0
    s_sub_u32 s68, s68, s48
    s_lshl_b32 s48, s68, 12
    s_add_u32 s68, s68, 1
    s_cmp_ge_u32 s68, 7
    s_cselect_b32 s49, 7, 0
    s_sub_u32 s68, s68, s49
    s_lshl_b32 s49, s68, 12
    s_add_u32 s68, s68, 1
    s_cmp_ge_u32 s68, 7
    s_cselect_b32 s50, 7, 0
    s_sub_u32 s68, s68, s50
    s_lshl_b32 s50, s68, 12
    s_add_u32 s68, s68, 1
    s_cmp_ge_u32 s68, 7
    s_cselect_b32 s51, 7, 0
    s_sub_u32 s68, s68, s51
    s_lshl_b32 s51, s68, 12
    s_add_u32 s68, s68, 1
    s_cmp_ge_u32 s68, 7
    s_cselect_b32 s52, 7, 0
    s_sub_u32 s68, s68, s52
    s_lshl_b32 s52, s68, 12
    s_add_u32 s68, s68, 1
    s_cmp_ge_u32 s68, 7
    s_cselect_b32 s53, 7, 0
    s_sub_u32 s68, s68, s53
    s_lshl_b32 s53, s68, 12
    s_add_u32 s68, s68, 1
    s_cmp_ge_u32 s68, 7
    s_cselect_b32 s54, 7, 0
    s_sub_u32 s68, s68, s54
    s_lshl_b32 s54, s68, 12
    s_waitcnt vmcnt(17)
    s_barrier
    ds_read_b64_tr_b16 a[0:1], v209 offset:0
    ds_read_b64_tr_b16 a[2:3], v209 offset:2048
    ds_read_b64_tr_b16 a[4:5], v209 offset:1024
    ds_read_b64_tr_b16 a[6:7], v209 offset:3072
    ds_read_b64_tr_b16 a[8:9], v209 offset:3584
    ds_read_b64_tr_b16 a[10:11], v209 offset:5632
    ds_read_b64_tr_b16 a[12:13], v209 offset:4608
    ds_read_b64_tr_b16 a[14:15], v209 offset:6656
    ds_read_b64_tr_b16 a[16:17], v209 offset:7168
    ds_read_b64_tr_b16 a[18:19], v209 offset:9216
    ds_read_b64_tr_b16 a[20:21], v209 offset:8192
    ds_read_b64_tr_b16 a[22:23], v209 offset:10240
    ds_read_b64_tr_b16 a[24:25], v209 offset:10752
    ds_read_b64_tr_b16 a[26:27], v209 offset:12800
    ds_read_b64_tr_b16 a[28:29], v209 offset:11776
    ds_read_b64_tr_b16 a[30:31], v209 offset:13824
    ds_read_b64_tr_b16 a[32:33], v209 offset:14336
    ds_read_b64_tr_b16 a[34:35], v209 offset:16384
    ds_read_b64_tr_b16 a[36:37], v209 offset:15360
    ds_read_b64_tr_b16 a[38:39], v209 offset:17408
    ds_read_b64_tr_b16 a[40:41], v209 offset:17920
    ds_read_b64_tr_b16 a[42:43], v209 offset:19968
    ds_read_b64_tr_b16 a[44:45], v209 offset:18944
    ds_read_b64_tr_b16 a[46:47], v209 offset:20992
    ds_read_b64_tr_b16 a[48:49], v209 offset:21504
    ds_read_b64_tr_b16 a[50:51], v209 offset:23552
    ds_read_b64_tr_b16 a[52:53], v209 offset:22528
    ds_read_b64_tr_b16 a[54:55], v209 offset:24576
    ds_read_b64_tr_b16 a[56:57], v209 offset:25088
    ds_read_b64_tr_b16 a[58:59], v209 offset:27136
    ds_read_b64_tr_b16 a[60:61], v209 offset:26112
    ds_read_b64_tr_b16 a[62:63], v209 offset:28160
    ds_read_b64_tr_b16 a[64:65], v209 offset:28672
    ds_read_b64_tr_b16 a[66:67], v209 offset:30720
    ds_read_b64_tr_b16 a[68:69], v209 offset:29696
    ds_read_b64_tr_b16 a[70:71], v209 offset:31744
    ds_read_b64_tr_b16 a[72:73], v209 offset:32256
    ds_read_b64_tr_b16 a[74:75], v209 offset:34304
    ds_read_b64_tr_b16 a[76:77], v209 offset:33280
    ds_read_b64_tr_b16 a[78:79], v209 offset:35328
    ds_read_b64_tr_b16 a[80:81], v209 offset:35840
    ds_read_b64_tr_b16 a[82:83], v209 offset:37888
    ds_read_b64_tr_b16 a[84:85], v209 offset:36864
    ds_read_b64_tr_b16 a[86:87], v209 offset:38912
    ds_read_b64_tr_b16 a[88:89], v209 offset:39424
    ds_read_b64_tr_b16 a[90:91], v209 offset:41472
    ds_read_b64_tr_b16 a[92:93], v209 offset:40448
    ds_read_b64_tr_b16 a[94:95], v209 offset:42496
    ds_read_b64_tr_b16 a[96:97], v209 offset:43008
    ds_read_b64_tr_b16 a[98:99], v209 offset:45056
    ds_read_b64_tr_b16 a[100:101], v209 offset:44032
    ds_read_b64_tr_b16 a[102:103], v209 offset:46080
    ds_read_b64_tr_b16 a[104:105], v209 offset:46592
    ds_read_b64_tr_b16 a[106:107], v209 offset:48640
    ds_read_b64_tr_b16 a[108:109], v209 offset:47616
    ds_read_b64_tr_b16 a[110:111], v209 offset:49664
    ds_read_b64_tr_b16 a[112:113], v209 offset:50176
    ds_read_b64_tr_b16 a[114:115], v209 offset:52224
    ds_read_b64_tr_b16 a[116:117], v209 offset:51200
    ds_read_b64_tr_b16 a[118:119], v209 offset:53248
    ds_read_b64_tr_b16 a[120:121], v209 offset:53248
    ds_read_b64_tr_b16 a[122:123], v209 offset:55296
    ds_read_b64_tr_b16 a[124:125], v209 offset:54272
    ds_read_b64_tr_b16 a[126:127], v209 offset:56320
    s_waitcnt lgkmcnt(0)
    s_barrier
    s_add_u32 m0, s70, 16384
    s_mul_i32 s73, s94, 56
    s_add_u32 s73, s73, 0
    buffer_load_dwordx4 v213, s[20:23], s73 offen lds
    s_add_u32 m0, s70, 17408
    s_mul_i32 s73, s94, 56
    s_add_u32 s73, s73, 28672
    buffer_load_dwordx4 v213, s[20:23], s73 offen lds
    s_add_u32 m0, s70, 18432
    s_mul_i32 s73, s94, 56
    s_add_u32 s73, s73, 57344
    buffer_load_dwordx4 v213, s[20:23], s73 offen lds
    s_add_u32 m0, s70, 19456
    s_mul_i32 s73, s94, 56
    s_add_u32 s73, s73, 86016
    buffer_load_dwordx4 v213, s[20:23], s73 offen lds
    s_add_u32 m0, s70, 20480
    s_mul_i32 s73, s94, 56
    s_add_u32 s73, s73, 114688
    buffer_load_dwordx4 v213, s[20:23], s73 offen lds
    s_add_u32 m0, s70, 21504
    s_mul_i32 s73, s94, 56
    s_add_u32 s73, s73, 143360
    buffer_load_dwordx4 v213, s[20:23], s73 offen lds
    s_add_u32 m0, s70, 22528
    s_mul_i32 s73, s94, 56
    s_add_u32 s73, s73, 172032
    buffer_load_dwordx4 v213, s[20:23], s73 offen lds
    s_add_u32 m0, s70, 23552
    s_mul_i32 s73, s94, 56
    s_add_u32 s73, s73, 200704
    buffer_load_dwordx4 v213, s[20:23], s73 offen lds
    s_add_u32 m0, s70, 24576
    s_mul_i32 s73, s95, 56
    s_add_u32 s73, s73, 0
    buffer_load_dwordx4 v213, s[20:23], s73 offen lds
    s_add_u32 m0, s70, 25600
    s_mul_i32 s73, s95, 56
    s_add_u32 s73, s73, 28672
    buffer_load_dwordx4 v213, s[20:23], s73 offen lds
    s_add_u32 m0, s70, 26624
    s_mul_i32 s73, s95, 56
    s_add_u32 s73, s73, 57344
    buffer_load_dwordx4 v213, s[20:23], s73 offen lds
    s_add_u32 m0, s70, 27648
    s_mul_i32 s73, s95, 56
    s_add_u32 s73, s73, 86016
    buffer_load_dwordx4 v213, s[20:23], s73 offen lds
    s_add_u32 m0, s70, 28672
    s_mul_i32 s73, s95, 56
    s_add_u32 s73, s73, 114688
    buffer_load_dwordx4 v213, s[20:23], s73 offen lds
    s_add_u32 m0, s70, 29696
    s_mul_i32 s73, s95, 56
    s_add_u32 s73, s73, 143360
    buffer_load_dwordx4 v213, s[20:23], s73 offen lds
    s_add_u32 m0, s70, 30720
    s_mul_i32 s73, s95, 56
    s_add_u32 s73, s73, 172032
    buffer_load_dwordx4 v213, s[20:23], s73 offen lds
    s_add_u32 m0, s70, 31744
    s_mul_i32 s73, s95, 56
    s_add_u32 s73, s73, 200704
    buffer_load_dwordx4 v213, s[20:23], s73 offen lds
    s_add_u32 m0, s70, 32768
    s_mul_i32 s73, s96, 56
    s_add_u32 s73, s73, 0
    buffer_load_dwordx4 v213, s[20:23], s73 offen lds
    s_add_u32 m0, s70, 33792
    s_mul_i32 s73, s96, 56
    s_add_u32 s73, s73, 28672
    buffer_load_dwordx4 v213, s[20:23], s73 offen lds
    s_add_u32 m0, s70, 34816
    s_mul_i32 s73, s96, 56
    s_add_u32 s73, s73, 57344
    buffer_load_dwordx4 v213, s[20:23], s73 offen lds
    s_add_u32 m0, s70, 35840
    s_mul_i32 s73, s96, 56
    s_add_u32 s73, s73, 86016
    buffer_load_dwordx4 v213, s[20:23], s73 offen lds
    buffer_load_dword v249, v10, s[40:43], s83 offen sc1
    s_sleep 3
    buffer_load_dword v250, v10, s[40:43], s83 offen sc1
    s_sleep 3
    s_nop 0
Lpoll_P_4:
    s_sub_u32 s6, s6, 1
    s_cbranch_scc1 L_end_P
    buffer_load_dword v251, v10, s[40:43], s83 offen sc1
    s_waitcnt vmcnt(2)
    v_cmp_ne_u32 vcc, s4, v249
    s_nop 1
    s_cbranch_vccz Lpd_P_5
    buffer_load_dword v249, v10, s[40:43], s83 offen sc1
    s_waitcnt vmcnt(2)
    v_cmp_ne_u32 vcc, s4, v250
    s_nop 1
    s_cbranch_vccz Lpd_P_5
    buffer_load_dword v250, v10, s[40:43], s83 offen sc1
    s_waitcnt vmcnt(2)
    v_cmp_ne_u32 vcc, s4, v251
    s_nop 1
    s_cbranch_vccnz Lpoll_P_4
    s_nop 1
Lpd_P_5:
    s_lshl_b32 s58, s67, 16
    s_lshl_b32 s60, s3, 14
    s_add_u32 s58, s58, s60
    s_add_u32 m0, s70, 0
    s_nop 0
    buffer_load_dwordx4 v4, s[40:43], s58 offen offset:0 sc1 lds
    buffer_load_dwordx4 v4, s[40:43], s58 offen offset:1024 sc1 lds
    buffer_load_dwordx4 v4, s[40:43], s58 offen offset:2048 sc1 lds
    buffer_load_dwordx4 v4, s[40:43], s58 offen offset:3072 sc1 lds
    s_add_u32 m0, s70, 4096
    s_add_u32 s58, s58, 4096
    buffer_load_dwordx4 v4, s[40:43], s58 offen offset:0 sc1 lds
    buffer_load_dwordx4 v4, s[40:43], s58 offen offset:1024 sc1 lds
    buffer_load_dwordx4 v4, s[40:43], s58 offen offset:2048 sc1 lds
    buffer_load_dwordx4 v4, s[40:43], s58 offen offset:3072 sc1 lds
    s_add_u32 m0, s70, 8192
    s_add_u32 s58, s58, 4096
    buffer_load_dwordx4 v4, s[40:43], s58 offen offset:0 sc1 lds
    buffer_load_dwordx4 v4, s[40:43], s58 offen offset:1024 sc1 lds
    buffer_load_dwordx4 v4, s[40:43], s58 offen offset:2048 sc1 lds
    buffer_load_dwordx4 v4, s[40:43], s58 offen offset:3072 sc1 lds
    s_add_u32 m0, s70, 12288
    s_add_u32 s58, s58, 4096
    buffer_load_dwordx4 v4, s[40:43], s58 offen offset:0 sc1 lds
    buffer_load_dwordx4 v4, s[40:43], s58 offen offset:1024 sc1 lds
    buffer_load_dwordx4 v4, s[40:43], s58 offen offset:2048 sc1 lds
    buffer_load_dwordx4 v4, s[40:43], s58 offen offset:3072 sc1 lds
    v_and_b32 v64, 1, v3
    v_mul_u32_u24 v64, 36864, v64
    v_lshl_add_u32 v64, v2, 4, v64
    v_lshrrev_b32 v65, 5, v1
    v_lshl_add_u32 v64, v65, 8, v64
    s_lshr_b32 s60, s3, 1
    s_mul_i32 s60, s60, 73728
    s_add_u32 s60, s60, 12288
    v_add_u32 v64, s60, v64
    ds_read_b64_tr_b16 a[128:129], v215 offset:16384
    ds_read_b64_tr_b16 a[130:131], v215 offset:17408
    ds_read_b64_tr_b16 a[132:133], v216 offset:16384
    ds_read_b64_tr_b16 a[134:135], v216 offset:17408
    ds_read_b64_tr_b16 a[136:137], v215 offset:18432
    ds_read_b64_tr_b16 a[138:139], v215 offset:19456
    ds_read_b64_tr_b16 a[140:141], v216 offset:18432
    ds_read_b64_tr_b16 a[142:143], v216 offset:19456
    ds_read_b64_tr_b16 a[144:145], v215 offset:20480
    ds_read_b64_tr_b16 a[146:147], v215 offset:21504
    ds_read_b64_tr_b16 a[148:149], v216 offset:20480
    ds_read_b64_tr_b16 a[150:151], v216 offset:21504
    ds_read_b64_tr_b16 a[152:153], v215 offset:22528
    ds_read_b64_tr_b16 a[154:155], v215 offset:23552
    ds_read_b64_tr_b16 a[156:157], v216 offset:22528
    ds_read_b64_tr_b16 a[158:159], v216 offset:23552
    ds_read_b64_tr_b16 a[160:161], v215 offset:24576
    ds_read_b64_tr_b16 a[162:163], v215 offset:25600
    ds_read_b64_tr_b16 a[164:165], v216 offset:24576
    ds_read_b64_tr_b16 a[166:167], v216 offset:25600
    ds_read_b64_tr_b16 a[168:169], v215 offset:26624
    ds_read_b64_tr_b16 a[170:171], v215 offset:27648
    ds_read_b64_tr_b16 a[172:173], v216 offset:26624
    ds_read_b64_tr_b16 a[174:175], v216 offset:27648
    ds_read_b64_tr_b16 a[176:177], v215 offset:28672
    ds_read_b64_tr_b16 a[178:179], v215 offset:29696
    ds_read_b64_tr_b16 a[180:181], v216 offset:28672
    ds_read_b64_tr_b16 a[182:183], v216 offset:29696
    ds_read_b64_tr_b16 a[184:185], v215 offset:30720
    ds_read_b64_tr_b16 a[186:187], v215 offset:31744
    ds_read_b64_tr_b16 a[188:189], v216 offset:30720
    ds_read_b64_tr_b16 a[190:191], v216 offset:31744
    ds_read_b64_tr_b16 a[192:193], v215 offset:32768
    ds_read_b64_tr_b16 a[194:195], v215 offset:33792
    ds_read_b64_tr_b16 a[196:197], v216 offset:32768
    ds_read_b64_tr_b16 a[198:199], v216 offset:33792
    ds_read_b64_tr_b16 a[200:201], v215 offset:34816
    ds_read_b64_tr_b16 a[202:203], v215 offset:35840
    ds_read_b64_tr_b16 a[204:205], v216 offset:34816
    ds_read_b64_tr_b16 a[206:207], v216 offset:35840
    v_lshlrev_b32 v192, 16, v192
    v_lshlrev_b32 v193, 16, v193
    v_lshlrev_b32 v194, 16, v194
    v_lshlrev_b32 v195, 16, v195
    v_lshlrev_b32 v196, 16, v196
    v_lshlrev_b32 v197, 16, v197
    v_lshlrev_b32 v198, 16, v198
    v_lshlrev_b32 v199, 16, v199
    v_lshlrev_b32 v200, 16, v200
    v_lshlrev_b32 v201, 16, v201
    v_lshlrev_b32 v202, 16, v202
    v_lshlrev_b32 v203, 16, v203
    v_lshlrev_b32 v204, 16, v204
    v_lshlrev_b32 v205, 16, v205
    v_lshlrev_b32 v206, 16, v206
    v_lshlrev_b32 v207, 16, v207
    s_waitcnt vmcnt(8)
    s_barrier
    ds_read_b128 v[32:35], v64 offset:0
    ds_read_b128 v[36:39], v64 offset:512
    ds_read_b128 v[40:43], v64 offset:1024
    ds_read_b128 v[44:47], v64 offset:1536
    ds_read_b128 v[48:51], v64 offset:2048
    ds_read_b128 v[52:55], v64 offset:2560
    s_waitcnt lgkmcnt(5)
    v_mfma_f32_32x32x16_bf16 v[192:207], v[32:35], a[0:3], v[192:207]
    ds_read_b128 v[56:59], v64 offset:3072
    s_add_u32 m0, s70, 16384
    s_mul_i32 s73, s96, 56
    s_add_u32 s73, s73, 114688
    buffer_load_dwordx4 v213, s[20:23], s73 offen lds
    s_waitcnt lgkmcnt(5)
    v_mfma_f32_32x32x16_bf16 v[192:207], v[36:39], a[4:7], v[192:207]
    ds_read_b128 v[60:63], v64 offset:3584
    s_waitcnt lgkmcnt(5)
    v_mfma_f32_32x32x16_bf16 v[192:207], v[40:43], a[8:11], v[192:207]
    ds_read_b128 v[32:35], v64 offset:4096
    s_waitcnt lgkmcnt(5)
    v_mfma_f32_32x32x16_bf16 v[192:207], v[44:47], a[12:15], v[192:207]
    ds_read_b128 v[36:39], v64 offset:4608
    s_add_u32 m0, s70, 17408
    s_mul_i32 s73, s96, 56
    s_add_u32 s73, s73, 143360
    buffer_load_dwordx4 v213, s[20:23], s73 offen lds
    s_waitcnt lgkmcnt(5)
    v_mfma_f32_32x32x16_bf16 v[192:207], v[48:51], a[16:19], v[192:207]
    ds_read_b128 v[40:43], v64 offset:5120
    s_waitcnt lgkmcnt(5)
    v_mfma_f32_32x32x16_bf16 v[192:207], v[52:55], a[20:23], v[192:207]
    ds_read_b128 v[44:47], v64 offset:5632
    s_waitcnt lgkmcnt(5)
    v_mfma_f32_32x32x16_bf16 v[192:207], v[56:59], a[24:27], v[192:207]
    ds_read_b128 v[48:51], v64 offset:6144
    s_add_u32 m0, s70, 18432
    s_mul_i32 s73, s96, 56
    s_add_u32 s73, s73, 172032
    buffer_load_dwordx4 v213, s[20:23], s73 offen lds
    s_waitcnt lgkmcnt(5)
    v_mfma_f32_32x32x16_bf16 v[192:207], v[60:63], a[28:31], v[192:207]
    ds_read_b128 v[52:55], v64 offset:6656
    s_waitcnt lgkmcnt(5)
    v_mfma_f32_32x32x16_bf16 v[192:207], v[32:35], a[32:35], v[192:207]
    ds_read_b128 v[56:59], v64 offset:7168
    s_waitcnt lgkmcnt(5)
    v_mfma_f32_32x32x16_bf16 v[192:207], v[36:39], a[36:39], v[192:207]
    ds_read_b128 v[60:63], v64 offset:7680
    s_add_u32 m0, s70, 19456
    s_mul_i32 s73, s96, 56
    s_add_u32 s73, s73, 200704
    buffer_load_dwordx4 v213, s[20:23], s73 offen lds
    s_waitcnt lgkmcnt(5)
    v_mfma_f32_32x32x16_bf16 v[192:207], v[40:43], a[40:43], v[192:207]
    s_waitcnt lgkmcnt(4)
    v_mfma_f32_32x32x16_bf16 v[192:207], v[44:47], a[44:47], v[192:207]
    s_waitcnt vmcnt(4)
    s_barrier
    ds_read_b128 v[32:35], v64 offset:8192
    ds_read_b128 v[36:39], v64 offset:8704
    s_waitcnt lgkmcnt(5)
    v_mfma_f32_32x32x16_bf16 v[192:207], v[48:51], a[48:51], v[192:207]
    ds_read_b128 v[40:43], v64 offset:9216
    s_add_u32 m0, s70, 20480
    s_mul_i32 s73, s97, 56
    s_add_u32 s73, s73, 0
    buffer_load_dwordx4 v213, s[20:23], s73 offen lds
    s_waitcnt lgkmcnt(5)
    v_mfma_f32_32x32x16_bf16 v[192:207], v[52:55], a[52:55], v[192:207]
    ds_read_b128 v[44:47], v64 offset:9728
    s_waitcnt lgkmcnt(5)
    v_mfma_f32_32x32x16_bf16 v[192:207], v[56:59], a[56:59], v[192:207]
    ds_read_b128 v[48:51], v64 offset:10240
    s_waitcnt lgkmcnt(5)
    v_mfma_f32_32x32x16_bf16 v[192:207], v[60:63], a[60:63], v[192:207]
    ds_read_b128 v[52:55], v64 offset:10752
    s_add_u32 m0, s70, 21504
    s_mul_i32 s73, s97, 56
    s_add_u32 s73, s73, 28672
    buffer_load_dwordx4 v213, s[20:23], s73 offen lds
    s_waitcnt lgkmcnt(5)
    v_mfma_f32_32x32x16_bf16 v[192:207], v[32:35], a[64:67], v[192:207]
    ds_read_b128 v[56:59], v64 offset:11264
    s_waitcnt lgkmcnt(5)
    v_mfma_f32_32x32x16_bf16 v[192:207], v[36:39], a[68:71], v[192:207]
    ds_read_b128 v[60:63], v64 offset:11776
    s_waitcnt lgkmcnt(5)
    v_mfma_f32_32x32x16_bf16 v[192:207], v[40:43], a[72:75], v[192:207]
    ds_read_b128 v[32:35], v64 offset:12288
    s_add_u32 m0, s70, 22528
    s_mul_i32 s73, s97, 56
    s_add_u32 s73, s73, 57344
    buffer_load_dwordx4 v213, s[20:23], s73 offen lds
    s_waitcnt lgkmcnt(5)
    v_mfma_f32_32x32x16_bf16 v[192:207], v[44:47], a[76:79], v[192:207]
    ds_read_b128 v[36:39], v64 offset:12800
    s_waitcnt lgkmcnt(5)
    v_mfma_f32_32x32x16_bf16 v[192:207], v[48:51], a[80:83], v[192:207]
    ds_read_b128 v[40:43], v64 offset:13312
    s_waitcnt lgkmcnt(5)
    v_mfma_f32_32x32x16_bf16 v[192:207], v[52:55], a[84:87], v[192:207]
    ds_read_b128 v[44:47], v64 offset:13824
    s_add_u32 m0, s70, 23552
    s_mul_i32 s73, s97, 56
    s_add_u32 s73, s73, 86016
    buffer_load_dwordx4 v213, s[20:23], s73 offen lds
    s_waitcnt lgkmcnt(5)
    v_mfma_f32_32x32x16_bf16 v[192:207], v[56:59], a[88:91], v[192:207]
    ds_read_b128 v[48:51], v64 offset:14336
    s_waitcnt lgkmcnt(5)
    v_mfma_f32_32x32x16_bf16 v[192:207], v[60:63], a[92:95], v[192:207]
    ds_read_b128 v[52:55], v64 offset:14848
    s_waitcnt lgkmcnt(5)
    v_mfma_f32_32x32x16_bf16 v[192:207], v[32:35], a[96:99], v[192:207]
    ds_read_b128 v[56:59], v64 offset:15360
    s_add_u32 m0, s70, 24576
    s_mul_i32 s73, s97, 56
    s_add_u32 s73, s73, 114688
    buffer_load_dwordx4 v213, s[20:23], s73 offen lds
    s_waitcnt lgkmcnt(5)
    v_mfma_f32_32x32x16_bf16 v[192:207], v[36:39], a[100:103], v[192:207]
    ds_read_b128 v[60:63], v64 offset:15872
    s_waitcnt lgkmcnt(5)
    v_mfma_f32_32x32x16_bf16 v[192:207], v[40:43], a[104:107], v[192:207]
    s_waitcnt lgkmcnt(4)
    v_mfma_f32_32x32x16_bf16 v[192:207], v[44:47], a[108:111], v[192:207]
    s_add_u32 m0, s70, 25600
    s_mul_i32 s73, s97, 56
    s_add_u32 s73, s73, 143360
    buffer_load_dwordx4 v213, s[20:23], s73 offen lds
    s_waitcnt lgkmcnt(3)
    v_mfma_f32_32x32x16_bf16 v[192:207], v[48:51], a[112:115], v[192:207]
    s_waitcnt lgkmcnt(2)
    v_mfma_f32_32x32x16_bf16 v[192:207], v[52:55], a[116:119], v[192:207]
    s_waitcnt lgkmcnt(1)
    v_mfma_f32_32x32x16_bf16 v[192:207], v[56:59], a[120:123], v[192:207]
    s_add_u32 m0, s70, 26624
    s_mul_i32 s73, s97, 56
    s_add_u32 s73, s73, 172032
    buffer_load_dwordx4 v213, s[20:23], s73 offen lds
    s_waitcnt lgkmcnt(0)
    v_mfma_f32_32x32x16_bf16 v[192:207], v[60:63], a[124:127], v[192:207]
    s_nop 11
    v_pk_mul_f32 v[68:69], v[192:193], v[192:193]
    v_pk_mul_f32 v[70:71], v[194:195], v[194:195]
    v_pk_mul_f32 v[72:73], v[196:197], v[196:197]
    v_pk_mul_f32 v[74:75], v[198:199], v[198:199]
    v_pk_mul_f32 v[76:77], v[200:201], v[200:201]
    v_pk_mul_f32 v[78:79], v[202:203], v[202:203]
    v_pk_mul_f32 v[80:81], v[204:205], v[204:205]
    v_pk_mul_f32 v[82:83], v[206:207], v[206:207]
    s_add_u32 m0, s70, 27648
    s_mul_i32 s73, s97, 56
    s_add_u32 s73, s73, 200704
    buffer_load_dwordx4 v213, s[20:23], s73 offen lds
    v_add_f32_dpp v84, v192, v192 row_mirror row_mask:0xf bank_mask:0x3
    v_add_f32_dpp v85, v193, v193 row_mirror row_mask:0xf bank_mask:0x3
    v_add_f32_dpp v86, v196, v196 row_mirror row_mask:0xf bank_mask:0x3
    v_add_f32_dpp v87, v197, v197 row_mirror row_mask:0xf bank_mask:0x3
    v_add_f32_dpp v88, v200, v200 row_mirror row_mask:0xf bank_mask:0x3
    v_add_f32_dpp v89, v201, v201 row_mirror row_mask:0xf bank_mask:0x3
    v_add_f32_dpp v90, v204, v204 row_mirror row_mask:0xf bank_mask:0x3
    v_add_f32_dpp v91, v205, v205 row_mirror row_mask:0xf bank_mask:0x3
    s_add_u32 m0, s70, 28672
    s_mul_i32 s73, s98, 56
    s_add_u32 s73, s73, 0
    buffer_load_dwordx4 v213, s[20:23], s73 offen lds
    v_add_f32_dpp v92, v68, v68 row_mirror row_mask:0xf bank_mask:0x3
    v_add_f32_dpp v93, v69, v69 row_mirror row_mask:0xf bank_mask:0x3
    v_add_f32_dpp v94, v72, v72 row_mirror row_mask:0xf bank_mask:0x3
    v_add_f32_dpp v95, v73, v73 row_mirror row_mask:0xf bank_mask:0x3
    v_add_f32_dpp v96, v76, v76 row_mirror row_mask:0xf bank_mask:0x3
    v_add_f32_dpp v97, v77, v77 row_mirror row_mask:0xf bank_mask:0x3
    v_add_f32_dpp v98, v80, v80 row_mirror row_mask:0xf bank_mask:0x3
    v_add_f32_dpp v99, v81, v81 row_mirror row_mask:0xf bank_mask:0x3
    s_add_u32 m0, s70, 29696
    s_mul_i32 s73, s98, 56
    s_add_u32 s73, s73, 28672
    buffer_load_dwordx4 v213, s[20:23], s73 offen lds
    v_add_f32_dpp v84, v194, v194 row_mirror row_mask:0xf bank_mask:0xc
    v_add_f32_dpp v85, v195, v195 row_mirror row_mask:0xf bank_mask:0xc
    v_add_f32_dpp v86, v198, v198 row_mirror row_mask:0xf bank_mask:0xc
    v_add_f32_dpp v87, v199, v199 row_mirror row_mask:0xf bank_mask:0xc
    v_add_f32_dpp v88, v202, v202 row_mirror row_mask:0xf bank_mask:0xc
    v_add_f32_dpp v89, v203, v203 row_mirror row_mask:0xf bank_mask:0xc
    v_add_f32_dpp v90, v206, v206 row_mirror row_mask:0xf bank_mask:0xc
    v_add_f32_dpp v91, v207, v207 row_mirror row_mask:0xf bank_mask:0xc
    s_add_u32 m0, s70, 30720
    s_mul_i32 s73, s98, 56
    s_add_u32 s73, s73, 57344
    buffer_load_dwordx4 v213, s[20:23], s73 offen lds
    v_add_f32_dpp v92, v70, v70 row_mirror row_mask:0xf bank_mask:0xc
    v_add_f32_dpp v93, v71, v71 row_mirror row_mask:0xf bank_mask:0xc
    v_add_f32_dpp v94, v74, v74 row_mirror row_mask:0xf bank_mask:0xc
    v_add_f32_dpp v95, v75, v75 row_mirror row_mask:0xf bank_mask:0xc
    v_add_f32_dpp v96, v78, v78 row_mirror row_mask:0xf bank_mask:0xc
    v_add_f32_dpp v97, v79, v79 row_mirror row_mask:0xf bank_mask:0xc
    v_add_f32_dpp v98, v82, v82 row_mirror row_mask:0xf bank_mask:0xc
    v_add_f32_dpp v99, v83, v83 row_mirror row_mask:0xf bank_mask:0xc
    s_add_u32 m0, s70, 31744
    s_mul_i32 s73, s98, 56
    s_add_u32 s73, s73, 86016
    buffer_load_dwordx4 v213, s[20:23], s73 offen lds
    v_add_f32_dpp v84, v84, v84 row_half_mirror row_mask:0xf bank_mask:0x5
    v_add_f32_dpp v86, v86, v86 row_half_mirror row_mask:0xf bank_mask:0x5
    v_add_f32_dpp v88, v88, v88 row_half_mirror row_mask:0xf bank_mask:0x5
    v_add_f32_dpp v90, v90, v90 row_half_mirror row_mask:0xf bank_mask:0x5
    v_add_f32_dpp v92, v92, v92 row_half_mirror row_mask:0xf bank_mask:0x5
    v_add_f32_dpp v94, v94, v94 row_half_mirror row_mask:0xf bank_mask:0x5
    v_add_f32_dpp v96, v96, v96 row_half_mirror row_mask:0xf bank_mask:0x5
    v_add_f32_dpp v98, v98, v98 row_half_mirror row_mask:0xf bank_mask:0x5
    v_add_f32_dpp v84, v85, v85 row_half_mirror row_mask:0xf bank_mask:0xa
    v_add_f32_dpp v86, v87, v87 row_half_mirror row_mask:0xf bank_mask:0xa
    v_add_f32_dpp v88, v89, v89 row_half_mirror row_mask:0xf bank_mask:0xa
    v_add_f32_dpp v90, v91, v91 row_half_mirror row_mask:0xf bank_mask:0xa
    v_add_f32_dpp v92, v93, v93 row_half_mirror row_mask:0xf bank_mask:0xa
    v_add_f32_dpp v94, v95, v95 row_half_mirror row_mask:0xf bank_mask:0xa
    v_add_f32_dpp v96, v97, v97 row_half_mirror row_mask:0xf bank_mask:0xa
    v_add_f32_dpp v98, v99, v99 row_half_mirror row_mask:0xf bank_mask:0xa
    v_add_f32_dpp v85, v84, v84 quad_perm:[1,0,3,2] row_mask:0xf bank_mask:0xf
    v_add_f32_dpp v87, v86, v86 quad_perm:[1,0,3,2] row_mask:0xf bank_mask:0xf
    v_add_f32_dpp v89, v88, v88 quad_perm:[1,0,3,2] row_mask:0xf bank_mask:0xf
    v_add_f32_dpp v91, v90, v90 quad_perm:[1,0,3,2] row_mask:0xf bank_mask:0xf
    v_add_f32_dpp v93, v92, v92 quad_perm:[1,0,3,2] row_mask:0xf bank_mask:0xf
    v_add_f32_dpp v95, v94, v94 quad_perm:[1,0,3,2] row_mask:0xf bank_mask:0xf
    v_add_f32_dpp v97, v96, v96 quad_perm:[1,0,3,2] row_mask:0xf bank_mask:0xf
    v_add_f32_dpp v99, v98, v98 quad_perm:[1,0,3,2] row_mask:0xf bank_mask:0xf
    v_add_f32_dpp v68, v85, v85 quad_perm:[2,3,0,1] row_mask:0xf bank_mask:0xf
    v_add_f32_dpp v69, v87, v87 quad_perm:[2,3,0,1] row_mask:0xf bank_mask:0xf
    v_add_f32_dpp v70, v89, v89 quad_perm:[2,3,0,1] row_mask:0xf bank_mask:0xf
    v_add_f32_dpp v71, v91, v91 quad_perm:[2,3,0,1] row_mask:0xf bank_mask:0xf
    v_add_f32_dpp v72, v93, v93 quad_perm:[2,3,0,1] row_mask:0xf bank_mask:0xf
    v_add_f32_dpp v73, v95, v95 quad_perm:[2,3,0,1] row_mask:0xf bank_mask:0xf
    v_add_f32_dpp v74, v97, v97 quad_perm:[2,3,0,1] row_mask:0xf bank_mask:0xf
    v_add_f32_dpp v75, v99, v99 quad_perm:[2,3,0,1] row_mask:0xf bank_mask:0xf
    v_permlane16_swap_b32 v68, v69
    v_permlane16_swap_b32 v70, v71
    v_permlane16_swap_b32 v72, v73
    v_permlane16_swap_b32 v74, v75
    v_add_f32 v84, v68, v69
    v_add_f32 v85, v72, v73
    v_add_f32 v86, v70, v71
    v_add_f32 v87, v74, v75
    v_and_b32 v65, 1, v3
    v_lshlrev_b32 v65, 6, v65
    v_lshrrev_b32 v66, 5, v1
    v_lshl_add_u32 v65, v66, 5, v65
    v_bfe_u32 v67, v1, 2, 2
    v_lshl_add_u32 v65, v67, 3, v65
    s_lshl_b32 s58, s3, 8
    v_add_u32 v65, s58, v65
    ds_write_b64 v65, v[84:85] offset:0
    ds_write_b64 v65, v[86:87] offset:128
    v_and_b32 v67, 31, v1
    v_lshlrev_b32 v65, 9, v66
    v_lshl_add_u32 v65, v67, 4, v65
    v_lshlrev_b32 v66, 8, v66
    v_lshl_add_u32 v66, v67, 3, v66
    s_and_b32 s58, s58, 512
    v_add_u32 v66, s58, v66
    s_lshl_b32 s58, s67, 1
    s_lshr_b32 s60, s3, 1
    s_add_u32 s58, s58, s60
    s_lshl_b32 s58, s58, 12
    s_add_u32 s58, s58, 0x548000
    s_lshl_b32 s60, s66, 9
    s_add_u32 s60, s60, s58
    s_waitcnt lgkmcnt(0)
    s_barrier
    ds_read_b64 v[84:85], v66 offset:0
    v_mov_b32 v89, s4
    v_mov_b32 v91, s4
    s_waitcnt lgkmcnt(0)
    v_mov_b32 v88, v84
    v_mov_b32 v90, v85
    s_nop 0
    v_permlane32_swap_b32 v88, v84
    v_permlane32_swap_b32 v90, v85
    v_add_f32 v88, v88, v84
    v_add_f32 v90, v90, v85
    s_bitcmp0_b32 s3, 0
    s_cselect_b32 exec_lo, -1, 0
    s_mov_b32 exec_hi, 0
    buffer_store_dwordx4 v[88:91], v65, s[40:43], s60 offen sc1
    s_mov_b64 exec, -1
    v_cvt_pk_bf16_f32 v240, v192, v193
    v_cvt_pk_bf16_f32 v241, v194, v195
    v_cvt_pk_bf16_f32 v242, v196, v197
    v_cvt_pk_bf16_f32 v243, v198, v199
    v_cvt_pk_bf16_f32 v244, v200, v201
    v_cvt_pk_bf16_f32 v245, v202, v203
    v_cvt_pk_bf16_f32 v246, v204, v205
    v_cvt_pk_bf16_f32 v247, v206, v207
    s_lshl_b32 s61, s66, 1
    s_and_b32 s60, s3, 1
    s_add_u32 s61, s61, s60
    s_lshl_b32 s61, s61, 7
    s_lshl_b32 s60, s67, 2
    s_add_u32 s61, s61, s60
    s_and_b32 s60, s3, 2
    s_add_u32 s61, s61, s60
    s_lshl_b32 s61, s61, 10
    s_add_u32 s61, s61, 0x200000
    v_lshlrev_b32 v66, 4, v67
    v_cmp_gt_u32 s[86:87], 32, v1
    s_add_u32 m0, s70, 0
    s_mul_i32 s73, s98, 56
    s_add_u32 s73, s73, 114688
    buffer_load_dwordx4 v213, s[20:23], s73 offen lds
    s_add_u32 m0, s70, 1024
    s_mul_i32 s73, s98, 56
    s_add_u32 s73, s73, 143360
    buffer_load_dwordx4 v213, s[20:23], s73 offen lds
    s_add_u32 m0, s70, 2048
    s_mul_i32 s73, s98, 56
    s_add_u32 s73, s73, 172032
    buffer_load_dwordx4 v213, s[20:23], s73 offen lds
    s_add_u32 m0, s70, 3072
    s_mul_i32 s73, s98, 56
    s_add_u32 s73, s73, 200704
    buffer_load_dwordx4 v213, s[20:23], s73 offen lds
    s_add_u32 m0, s70, 4096
    s_mul_i32 s73, s99, 56
    s_add_u32 s73, s73, 0
    buffer_load_dwordx4 v213, s[20:23], s73 offen lds
    s_add_u32 m0, s70, 5120
    s_mul_i32 s73, s99, 56
    s_add_u32 s73, s73, 28672
    buffer_load_dwordx4 v213, s[20:23], s73 offen lds
    s_add_u32 m0, s70, 6144
    s_mul_i32 s73, s99, 56
    s_add_u32 s73, s73, 57344
    buffer_load_dwordx4 v213, s[20:23], s73 offen lds
    s_add_u32 m0, s70, 7168
    s_mul_i32 s73, s99, 56
    s_add_u32 s73, s73, 86016
    buffer_load_dwordx4 v213, s[20:23], s73 offen lds
    s_add_u32 m0, s70, 8192
    s_mul_i32 s73, s99, 56
    s_add_u32 s73, s73, 114688
    buffer_load_dwordx4 v213, s[20:23], s73 offen lds
    s_add_u32 m0, s70, 9216
    s_mul_i32 s73, s99, 56
    s_add_u32 s73, s73, 143360
    buffer_load_dwordx4 v213, s[20:23], s73 offen lds
    s_add_u32 m0, s70, 10240
    s_mul_i32 s73, s99, 56
    s_add_u32 s73, s73, 172032
    buffer_load_dwordx4 v213, s[20:23], s73 offen lds
    s_add_u32 m0, s70, 11264
    s_mul_i32 s73, s99, 56
    s_add_u32 s73, s73, 200704
    buffer_load_dwordx4 v213, s[20:23], s73 offen lds
    s_add_u32 m0, s70, 12288
    s_mul_i32 s73, s100, 56
    s_add_u32 s73, s73, 0
    buffer_load_dwordx4 v213, s[20:23], s73 offen lds
    s_add_u32 m0, s70, 13312
    s_mul_i32 s73, s100, 56
    s_add_u32 s73, s73, 28672
    buffer_load_dwordx4 v213, s[20:23], s73 offen lds
    s_add_u32 m0, s70, 14336
    s_mul_i32 s73, s100, 56
    s_add_u32 s73, s73, 57344
    buffer_load_dwordx4 v213, s[20:23], s73 offen lds
    s_add_u32 m0, s70, 15360
    s_mul_i32 s73, s100, 56
    s_add_u32 s73, s73, 86016
    buffer_load_dwordx4 v213, s[20:23], s73 offen lds
    buffer_load_dwordx4 v[96:99], v65, s[40:43], s58 offen offset:0 sc1
    buffer_load_dwordx4 v[100:103], v65, s[40:43], s58 offen offset:1024 sc1
    buffer_load_dwordx4 v[104:107], v65, s[40:43], s58 offen offset:2048 sc1
    buffer_load_dwordx4 v[108:111], v66, s[40:43], s58 offen offset:3072 sc1
    s_sleep 5
    s_nop 0
Lst_P_6:
    s_sub_u32 s6, s6, 1
    s_cbranch_scc1 L_end_P
    buffer_load_dwordx4 v[112:115], v65, s[40:43], s58 offen offset:0 sc1
    buffer_load_dwordx4 v[116:119], v65, s[40:43], s58 offen offset:1024 sc1
    buffer_load_dwordx4 v[120:123], v65, s[40:43], s58 offen offset:2048 sc1
    buffer_load_dwordx4 v[124:127], v66, s[40:43], s58 offen offset:3072 sc1
    s_waitcnt vmcnt(4)
    v_xor_b32 v97, s4, v97
    v_xor_b32 v99, s4, v99
    v_xor_b32 v101, s4, v101
    v_xor_b32 v103, s4, v103
    v_xor_b32 v105, s4, v105
    v_xor_b32 v107, s4, v107
    v_xor_b32 v109, s4, v109
    v_xor_b32 v111, s4, v111
    v_cndmask_b32 v108, 0, v108, s[86:87]
    v_cndmask_b32 v110, 0, v110, s[86:87]
    v_or3_b32 v97, v97, v99, v101
    v_or3_b32 v103, v103, v105, v107
    v_or3_b32 v97, v97, v109, v111
    v_or_b32 v97, v97, v103
    v_cmp_ne_u32 vcc, 0, v97
    v_add_f32 v128, v96, v100
    v_add_f32 v129, v104, v108
    v_add_f32 v130, v98, v102
    v_add_f32 v131, v106, v110
    s_cbranch_vccz Lstd_P_7
    buffer_load_dwordx4 v[96:99], v65, s[40:43], s58 offen offset:0 sc1
    buffer_load_dwordx4 v[100:103], v65, s[40:43], s58 offen offset:1024 sc1
    buffer_load_dwordx4 v[104:107], v65, s[40:43], s58 offen offset:2048 sc1
    buffer_load_dwordx4 v[108:111], v66, s[40:43], s58 offen offset:3072 sc1
    s_waitcnt vmcnt(4)
    v_xor_b32 v113, s4, v113
    v_xor_b32 v115, s4, v115
    v_xor_b32 v117, s4, v117
    v_xor_b32 v119, s4, v119
    v_xor_b32 v121, s4, v121
    v_xor_b32 v123, s4, v123
    v_xor_b32 v125, s4, v125
    v_xor_b32 v127, s4, v127
    v_cndmask_b32 v124, 0, v124, s[86:87]
    v_cndmask_b32 v126, 0, v126, s[86:87]
    v_or3_b32 v113, v113, v115, v117
    v_or3_b32 v119, v119, v121, v123
    v_or3_b32 v113, v113, v125, v127
    v_or_b32 v113, v113, v119
    v_cmp_ne_u32 vcc, 0, v113
    v_add_f32 v128, v112, v116
    v_add_f32 v129, v120, v124
    v_add_f32 v130, v114, v118
    v_add_f32 v131, v122, v126
    s_cbranch_vccnz Lst_P_6
    s_nop 3
Lstd_P_7:
    v_add_f32 v128, v128, v129
    v_add_f32 v130, v130, v131
    v_mov_b32 v136, v128
    v_mov_b32 v138, v130
    s_nop 0
    v_permlane32_swap_b32 v128, v136
    v_permlane32_swap_b32 v130, v138
    v_add_f32 v128, v128, v136
    v_add_f32 v130, v130, v138
    v_mul_f32 v133, 0x3b124925, v128
    v_mul_f32 v130, 0x3b124925, v130
    v_fma_f32 v130, -v133, v133, v130
    v_max_f32 v130, 0, v130
    v_add_f32 v135, 0x3727c5ac, v130
    v_rsq_f32 v135, v135
    s_nop 0
    v_mul_f32 v130, v130, v135
    v_fmaak_f32 v130, v130, v135, 0x3727c5ac
    v_rsq_f32 v130, v130
    s_nop 0
    v_mul_f32 v135, v135, v130
    s_lshl_b32 s60, s3, 8
    v_lshl_add_u32 v66, v67, 2, s60
    ds_write_b32 v66, v133 offset:1024
    ds_write_b32 v66, v135 offset:1152
    v_lshrrev_b32 v66, 5, v1
    v_lshl_add_u32 v66, v66, 4, s60
    s_waitcnt lgkmcnt(0)
    ds_read_b128 v[140:143], v66 offset:1024
    ds_read_b128 v[156:159], v66 offset:1152
    ds_read_b128 v[144:147], v66 offset:1056
    ds_read_b128 v[160:163], v66 offset:1184
    ds_read_b128 v[148:151], v66 offset:1088
    ds_read_b128 v[164:167], v66 offset:1216
    ds_read_b128 v[152:155], v66 offset:1120
    ds_read_b128 v[168:171], v66 offset:1248
    s_waitcnt lgkmcnt(7)
    v_pk_add_f32 v[192:193], v[192:193], v[140:141] neg_lo:[0,1] neg_hi:[0,1]
    v_pk_add_f32 v[194:195], v[194:195], v[142:143] neg_lo:[0,1] neg_hi:[0,1]
    s_waitcnt lgkmcnt(5)
    v_pk_add_f32 v[196:197], v[196:197], v[144:145] neg_lo:[0,1] neg_hi:[0,1]
    v_pk_add_f32 v[198:199], v[198:199], v[146:147] neg_lo:[0,1] neg_hi:[0,1]
    v_pk_mul_f32 v[192:193], v[192:193], v[156:157]
    v_pk_mul_f32 v[194:195], v[194:195], v[158:159]
    s_waitcnt lgkmcnt(4)
    v_pk_mul_f32 v[196:197], v[196:197], v[160:161]
    v_pk_mul_f32 v[198:199], v[198:199], v[162:163]
    v_cvt_pk_bf16_f32 v84, v192, v193
    v_cvt_pk_bf16_f32 v85, v194, v195
    v_cvt_pk_bf16_f32 v86, v196, v197
    v_cvt_pk_bf16_f32 v87, v198, v199
    buffer_store_dwordx4 v[84:87], v4, s[40:43], s61 offen offset:0 sc1
    s_waitcnt lgkmcnt(3)
    v_pk_add_f32 v[200:201], v[200:201], v[148:149] neg_lo:[0,1] neg_hi:[0,1]
    v_pk_add_f32 v[202:203], v[202:203], v[150:151] neg_lo:[0,1] neg_hi:[0,1]
    s_waitcnt lgkmcnt(1)
    v_pk_add_f32 v[204:205], v[204:205], v[152:153] neg_lo:[0,1] neg_hi:[0,1]
    v_pk_add_f32 v[206:207], v[206:207], v[154:155] neg_lo:[0,1] neg_hi:[0,1]
    v_pk_mul_f32 v[200:201], v[200:201], v[164:165]
    v_pk_mul_f32 v[202:203], v[202:203], v[166:167]
    s_waitcnt lgkmcnt(0)
    v_pk_mul_f32 v[204:205], v[204:205], v[168:169]
    v_pk_mul_f32 v[206:207], v[206:207], v[170:171]
    v_cvt_pk_bf16_f32 v88, v200, v201
    v_cvt_pk_bf16_f32 v89, v202, v203
    v_cvt_pk_bf16_f32 v90, v204, v205
    v_cvt_pk_bf16_f32 v91, v206, v207
    buffer_store_dwordx4 v[88:91], v4, s[40:43], s61 offen offset:1024 sc1
    ds_read_b64_tr_b16 a[208:209], v215 offset:16384
    ds_read_b64_tr_b16 a[210:211], v215 offset:17408
    ds_read_b64_tr_b16 a[212:213], v216 offset:16384
    ds_read_b64_tr_b16 a[214:215], v216 offset:17408
    ds_read_b64_tr_b16 a[216:217], v215 offset:18432
    ds_read_b64_tr_b16 a[218:219], v215 offset:19456
    ds_read_b64_tr_b16 a[220:221], v216 offset:18432
    ds_read_b64_tr_b16 a[222:223], v216 offset:19456
    ds_read_b64_tr_b16 a[224:225], v215 offset:20480
    ds_read_b64_tr_b16 a[226:227], v215 offset:21504
    ds_read_b64_tr_b16 a[228:229], v216 offset:20480
    ds_read_b64_tr_b16 a[230:231], v216 offset:21504
    ds_read_b64_tr_b16 a[232:233], v215 offset:22528
    ds_read_b64_tr_b16 a[234:235], v215 offset:23552
    ds_read_b64_tr_b16 a[236:237], v216 offset:22528
    ds_read_b64_tr_b16 a[238:239], v216 offset:23552
    ds_read_b64_tr_b16 a[240:241], v215 offset:24576
    ds_read_b64_tr_b16 a[242:243], v215 offset:25600
    ds_read_b64_tr_b16 a[244:245], v216 offset:24576
    ds_read_b64_tr_b16 a[246:247], v216 offset:25600
    ds_read_b64_tr_b16 a[248:249], v215 offset:26624
    ds_read_b64_tr_b16 a[250:251], v215 offset:27648
    ds_read_b64_tr_b16 a[252:253], v216 offset:26624
    ds_read_b64_tr_b16 a[254:255], v216 offset:27648
    ds_read_b64_tr_b16 a[0:1], v215 offset:28672
    ds_read_b64_tr_b16 a[2:3], v215 offset:29696
    ds_read_b64_tr_b16 a[4:5], v216 offset:28672
    ds_read_b64_tr_b16 a[6:7], v216 offset:29696
    ds_read_b64_tr_b16 a[8:9], v215 offset:30720
    ds_read_b64_tr_b16 a[10:11], v215 offset:31744
    ds_read_b64_tr_b16 a[12:13], v216 offset:30720
    ds_read_b64_tr_b16 a[14:15], v216 offset:31744
    ds_read_b64_tr_b16 a[16:17], v215 offset:0
    ds_read_b64_tr_b16 a[18:19], v215 offset:1024
    ds_read_b64_tr_b16 a[20:21], v216 offset:0
    ds_read_b64_tr_b16 a[22:23], v216 offset:1024
    ds_read_b64_tr_b16 a[24:25], v215 offset:2048
    ds_read_b64_tr_b16 a[26:27], v215 offset:3072
    ds_read_b64_tr_b16 a[28:29], v216 offset:2048
    ds_read_b64_tr_b16 a[30:31], v216 offset:3072
    ds_read_b64_tr_b16 a[32:33], v215 offset:4096
    ds_read_b64_tr_b16 a[34:35], v215 offset:5120
    ds_read_b64_tr_b16 a[36:37], v216 offset:4096
    ds_read_b64_tr_b16 a[38:39], v216 offset:5120
    ds_read_b64_tr_b16 a[40:41], v215 offset:6144
    ds_read_b64_tr_b16 a[42:43], v215 offset:7168
    ds_read_b64_tr_b16 a[44:45], v216 offset:6144
    ds_read_b64_tr_b16 a[46:47], v216 offset:7168
    ds_read_b64_tr_b16 a[48:49], v215 offset:8192
    ds_read_b64_tr_b16 a[50:51], v215 offset:9216
    ds_read_b64_tr_b16 a[52:53], v216 offset:8192
    ds_read_b64_tr_b16 a[54:55], v216 offset:9216
    ds_read_b64_tr_b16 a[56:57], v215 offset:10240
    ds_read_b64_tr_b16 a[58:59], v215 offset:11264
    ds_read_b64_tr_b16 a[60:61], v216 offset:10240
    ds_read_b64_tr_b16 a[62:63], v216 offset:11264
    ds_read_b64_tr_b16 a[64:65], v215 offset:12288
    ds_read_b64_tr_b16 a[66:67], v215 offset:13312
    ds_read_b64_tr_b16 a[68:69], v216 offset:12288
    ds_read_b64_tr_b16 a[70:71], v216 offset:13312
    ds_read_b64_tr_b16 a[72:73], v215 offset:14336
    ds_read_b64_tr_b16 a[74:75], v215 offset:15360
    ds_read_b64_tr_b16 a[76:77], v216 offset:14336
    ds_read_b64_tr_b16 a[78:79], v216 offset:15360
    s_waitcnt vmcnt(0)
    v_mov_b32 v8, s4
    s_mov_b64 exec, 1
    buffer_store_dword v8, v9, s[40:43], s81 offen sc1
    s_mov_b64 exec, -1
    s_waitcnt lgkmcnt(4)
    s_add_u32 m0, s70, 12288
    s_mul_i32 s73, s100, 56
    s_add_u32 s73, s73, 114688
    buffer_load_dwordx4 v213, s[20:23], s73 offen lds
    s_add_u32 m0, s70, 13312
    s_mul_i32 s73, s100, 56
    s_add_u32 s73, s73, 143360
    buffer_load_dwordx4 v213, s[20:23], s73 offen lds
    s_waitcnt lgkmcnt(0)
    s_add_u32 m0, s70, 14336
    s_mul_i32 s73, s100, 56
    s_add_u32 s73, s73, 172032
    buffer_load_dwordx4 v213, s[20:23], s73 offen lds
    s_add_u32 m0, s70, 15360
    s_mul_i32 s73, s100, 56
    s_add_u32 s73, s73, 200704
    buffer_load_dwordx4 v213, s[20:23], s73 offen lds
    s_add_u32 m0, s70, 16384
    s_mul_i32 s73, s101, 56
    s_add_u32 s73, s73, 0
    buffer_load_dwordx4 v213, s[20:23], s73 offen lds
    s_add_u32 m0, s70, 17408
    s_mul_i32 s73, s101, 56
    s_add_u32 s73, s73, 28672
    buffer_load_dwordx4 v213, s[20:23], s73 offen lds
    s_add_u32 m0, s70, 18432
    s_mul_i32 s73, s101, 56
    s_add_u32 s73, s73, 57344
    buffer_load_dwordx4 v213, s[20:23], s73 offen lds
    s_add_u32 m0, s70, 19456
    s_mul_i32 s73, s101, 56
    s_add_u32 s73, s73, 86016
    buffer_load_dwordx4 v213, s[20:23], s73 offen lds
    s_add_u32 m0, s70, 20480
    s_mul_i32 s73, s101, 56
    s_add_u32 s73, s73, 114688
    buffer_load_dwordx4 v213, s[20:23], s73 offen lds
    s_add_u32 m0, s70, 21504
    s_mul_i32 s73, s101, 56
    s_add_u32 s73, s73, 143360
    buffer_load_dwordx4 v213, s[20:23], s73 offen lds
    s_add_u32 m0, s70, 22528
    s_mul_i32 s73, s101, 56
    s_add_u32 s73, s73, 172032
    buffer_load_dwordx4 v213, s[20:23], s73 offen lds
    s_add_u32 m0, s70, 23552
    s_mul_i32 s73, s101, 56
    s_add_u32 s73, s73, 200704
    buffer_load_dwordx4 v213, s[20:23], s73 offen lds
    s_add_u32 m0, s70, 24576
    s_mul_i32 s73, s48, 64
    s_add_u32 s73, s73, 0
    buffer_load_dwordx4 v214, s[24:27], s73 offen lds
    s_add_u32 m0, s70, 25600
    s_mul_i32 s73, s48, 64
    s_add_u32 s73, s73, 32768
    buffer_load_dwordx4 v214, s[24:27], s73 offen lds
    s_add_u32 m0, s70, 26624
    s_mul_i32 s73, s48, 64
    s_add_u32 s73, s73, 65536
    buffer_load_dwordx4 v214, s[24:27], s73 offen lds
    s_add_u32 m0, s70, 27648
    s_mul_i32 s73, s48, 64
    s_add_u32 s73, s73, 98304
    buffer_load_dwordx4 v214, s[24:27], s73 offen lds
    s_add_u32 m0, s70, 28672
    s_mul_i32 s73, s48, 64
    s_add_u32 s73, s73, 131072
    buffer_load_dwordx4 v214, s[24:27], s73 offen lds
    s_add_u32 m0, s70, 29696
    s_mul_i32 s73, s48, 64
    s_add_u32 s73, s73, 163840
    buffer_load_dwordx4 v214, s[24:27], s73 offen lds
    s_add_u32 m0, s70, 30720
    s_mul_i32 s73, s48, 64
    s_add_u32 s73, s73, 196608
    buffer_load_dwordx4 v214, s[24:27], s73 offen lds
    s_add_u32 m0, s70, 31744
    s_mul_i32 s73, s48, 64
    s_add_u32 s73, s73, 229376
    buffer_load_dwordx4 v214, s[24:27], s73 offen lds
    s_add_u32 m0, s70, 32768
    s_mul_i32 s73, s49, 64
    s_add_u32 s73, s73, 0
    buffer_load_dwordx4 v214, s[24:27], s73 offen lds
    s_add_u32 m0, s70, 33792
    s_mul_i32 s73, s49, 64
    s_add_u32 s73, s73, 32768
    buffer_load_dwordx4 v214, s[24:27], s73 offen lds
    s_add_u32 m0, s70, 34816
    s_mul_i32 s73, s49, 64
    s_add_u32 s73, s73, 65536
    buffer_load_dwordx4 v214, s[24:27], s73 offen lds
    s_add_u32 m0, s70, 35840
    s_mul_i32 s73, s49, 64
    s_add_u32 s73, s73, 98304
    buffer_load_dwordx4 v214, s[24:27], s73 offen lds
    v_lshrrev_b32 v220, 5, v1
    v_lshlrev_b32 v220, 3, v220
    s_lshl_b32 s68, s65, 7
    s_lshr_b32 s69, s3, 1
    s_lshl_b32 s69, s69, 6
    s_add_u32 s68, s68, s69
    buffer_load_dwordx2 v[222:223], v220, s[28:31], s68 offen offset:0
    buffer_load_dwordx2 v[224:225], v220, s[28:31], s68 offen offset:16
    buffer_load_dwordx2 v[226:227], v220, s[28:31], s68 offen offset:32
    buffer_load_dwordx2 v[228:229], v220, s[28:31], s68 offen offset:48
    s_lshl_b32 s68, s64, 1
    s_and_b32 s69, s3, 1
    s_add_u32 s71, s68, s69
    s_xor_b32 s72, s71, 1
    s_mul_i32 s68, s3, 32768
    s_add_u32 s68, s68, 0x200000
    s_mul_i32 s71, s71, 131072
    s_add_u32 s71, s71, s68
    s_mul_i32 s72, s72, 131072
    s_add_u32 s72, s72, s68
    buffer_load_dword v249, v11, s[40:43], s84 offen sc1
    s_sleep 3
    buffer_load_dword v250, v11, s[40:43], s84 offen sc1
    s_sleep 3
    s_nop 0
Lpoll_P_8:
    s_sub_u32 s6, s6, 1
    s_cbranch_scc1 L_end_P
    buffer_load_dword v251, v11, s[40:43], s84 offen sc1
    s_waitcnt vmcnt(2)
    v_cmp_ne_u32 vcc, s4, v249
    s_nop 1
    s_cbranch_vccz Lpd_P_9
    buffer_load_dword v249, v11, s[40:43], s84 offen sc1
    s_waitcnt vmcnt(2)
    v_cmp_ne_u32 vcc, s4, v250
    s_nop 1
    s_cbranch_vccz Lpd_P_9
    buffer_load_dword v250, v11, s[40:43], s84 offen sc1
    s_waitcnt vmcnt(2)
    v_cmp_ne_u32 vcc, s4, v251
    s_nop 1
    s_cbranch_vccnz Lpoll_P_8
    s_nop 1
Lpd_P_9:
    s_add_u32 s56, s71, s94
    s_add_u32 s57, s72, s94
    buffer_load_dwordx4 v[80:83], v5, s[40:43], s56 offen offset:0 sc1
    buffer_load_dwordx4 v[84:87], v5, s[40:43], s57 offen offset:0 sc1
    buffer_load_dwordx4 v[88:91], v5, s[40:43], s56 offen offset:1024 sc1
    buffer_load_dwordx4 v[92:95], v5, s[40:43], s57 offen offset:1024 sc1
    buffer_load_dwordx4 v[96:99], v5, s[40:43], s56 offen offset:2048 sc1
    buffer_load_dwordx4 v[100:103], v5, s[40:43], s57 offen offset:2048 sc1
    buffer_load_dwordx4 v[104:107], v5, s[40:43], s56 offen offset:3072 sc1
    buffer_load_dwordx4 v[108:111], v5, s[40:43], s57 offen offset:3072 sc1
    s_add_u32 s56, s71, s95
    s_add_u32 s57, s72, s95
    buffer_load_dwordx4 v[112:115], v5, s[40:43], s56 offen offset:0 sc1
    buffer_load_dwordx4 v[116:119], v5, s[40:43], s57 offen offset:0 sc1
    buffer_load_dwordx4 v[120:123], v5, s[40:43], s56 offen offset:1024 sc1
    buffer_load_dwordx4 v[124:127], v5, s[40:43], s57 offen offset:1024 sc1
    v_lshlrev_b32 v16, 16, v222
    v_and_b32 v17, 0xffff0000, v222
    v_lshlrev_b32 v18, 16, v223
    v_and_b32 v19, 0xffff0000, v223
    v_lshlrev_b32 v20, 16, v224
    v_and_b32 v21, 0xffff0000, v224
    v_lshlrev_b32 v22, 16, v225
    v_and_b32 v23, 0xffff0000, v225
    v_lshlrev_b32 v24, 16, v226
    v_and_b32 v25, 0xffff0000, v226
    v_lshlrev_b32 v26, 16, v227
    v_and_b32 v27, 0xffff0000, v227
    v_lshlrev_b32 v28, 16, v228
    v_and_b32 v29, 0xffff0000, v228
    v_lshlrev_b32 v30, 16, v229
    v_and_b32 v31, 0xffff0000, v229
    ds_read_b64_tr_b16 a[80:81], v215 offset:12288
    ds_read_b64_tr_b16 a[82:83], v215 offset:13312
    ds_read_b64_tr_b16 a[84:85], v216 offset:12288
    ds_read_b64_tr_b16 a[86:87], v216 offset:13312
    ds_read_b64_tr_b16 a[88:89], v215 offset:14336
    ds_read_b64_tr_b16 a[90:91], v215 offset:15360
    ds_read_b64_tr_b16 a[92:93], v216 offset:14336
    ds_read_b64_tr_b16 a[94:95], v216 offset:15360
    ds_read_b64_tr_b16 a[96:97], v215 offset:16384
    ds_read_b64_tr_b16 a[98:99], v215 offset:17408
    ds_read_b64_tr_b16 a[100:101], v216 offset:16384
    ds_read_b64_tr_b16 a[102:103], v216 offset:17408
    ds_read_b64_tr_b16 a[104:105], v215 offset:18432
    ds_read_b64_tr_b16 a[106:107], v215 offset:19456
    ds_read_b64_tr_b16 a[108:109], v216 offset:18432
    ds_read_b64_tr_b16 a[110:111], v216 offset:19456
    ds_read_b64_tr_b16 a[112:113], v215 offset:20480
    ds_read_b64_tr_b16 a[114:115], v215 offset:21504
    ds_read_b64_tr_b16 a[116:117], v216 offset:20480
    ds_read_b64_tr_b16 a[118:119], v216 offset:21504
    ds_read_b64_tr_b16 a[120:121], v215 offset:22528
    ds_read_b64_tr_b16 a[122:123], v215 offset:23552
    ds_read_b64_tr_b16 a[124:125], v216 offset:22528
    ds_read_b64_tr_b16 a[126:127], v216 offset:23552
    buffer_load_dwordx4 v[128:131], v5, s[40:43], s56 offen offset:2048 sc1
    buffer_load_dwordx4 v[132:135], v5, s[40:43], s57 offen offset:2048 sc1
    buffer_load_dwordx4 v[136:139], v5, s[40:43], s56 offen offset:3072 sc1
    buffer_load_dwordx4 v[140:143], v5, s[40:43], s57 offen offset:3072 sc1
    s_waitcnt vmcnt(15)
    v_mfma_f32_32x32x16_bf16 v[16:31], a[128:131], v[80:83], v[16:31]
    s_waitcnt vmcnt(14)
    v_mfma_f32_32x32x16_bf16 v[32:47], a[128:131], v[84:87], 0
    v_mfma_f32_32x32x16_bf16 v[48:63], a[132:135], v[80:83], 0
    v_mfma_f32_32x32x16_bf16 v[64:79], a[132:135], v[84:87], 0
    s_add_u32 s56, s71, s96
    s_add_u32 s57, s72, s96
    buffer_load_dwordx4 v[144:147], v5, s[40:43], s56 offen offset:0 sc1
    buffer_load_dwordx4 v[148:151], v5, s[40:43], s57 offen offset:0 sc1
    buffer_load_dwordx4 v[152:155], v5, s[40:43], s56 offen offset:1024 sc1
    buffer_load_dwordx4 v[156:159], v5, s[40:43], s57 offen offset:1024 sc1
    s_waitcnt vmcnt(17)
    v_mfma_f32_32x32x16_bf16 v[16:31], a[136:139], v[88:91], v[16:31]
    s_waitcnt vmcnt(16)
    v_mfma_f32_32x32x16_bf16 v[32:47], a[136:139], v[92:95], v[32:47]
    v_mfma_f32_32x32x16_bf16 v[48:63], a[140:143], v[88:91], v[48:63]
    v_mfma_f32_32x32x16_bf16 v[64:79], a[140:143], v[92:95], v[64:79]
    buffer_load_dwordx4 v[160:163], v5, s[40:43], s56 offen offset:2048 sc1
    buffer_load_dwordx4 v[164:167], v5, s[40:43], s57 offen offset:2048 sc1
    buffer_load_dwordx4 v[168:171], v5, s[40:43], s56 offen offset:3072 sc1
    buffer_load_dwordx4 v[172:175], v5, s[40:43], s57 offen offset:3072 sc1
    s_waitcnt vmcnt(19)
    v_mfma_f32_32x32x16_bf16 v[16:31], a[144:147], v[96:99], v[16:31]
    s_waitcnt vmcnt(18)
    v_mfma_f32_32x32x16_bf16 v[32:47], a[144:147], v[100:103], v[32:47]
    v_mfma_f32_32x32x16_bf16 v[48:63], a[148:151], v[96:99], v[48:63]
    v_mfma_f32_32x32x16_bf16 v[64:79], a[148:151], v[100:103], v[64:79]
    s_add_u32 s56, s71, s97
    s_add_u32 s57, s72, s97
    buffer_load_dwordx4 v[176:179], v5, s[40:43], s56 offen offset:0 sc1
    buffer_load_dwordx4 v[180:183], v5, s[40:43], s57 offen offset:0 sc1
    buffer_load_dwordx4 v[184:187], v5, s[40:43], s56 offen offset:1024 sc1
    buffer_load_dwordx4 v[188:191], v5, s[40:43], s57 offen offset:1024 sc1
    s_waitcnt vmcnt(21)
    v_mfma_f32_32x32x16_bf16 v[16:31], a[152:155], v[104:107], v[16:31]
    s_waitcnt vmcnt(20)
    v_mfma_f32_32x32x16_bf16 v[32:47], a[152:155], v[108:111], v[32:47]
    v_mfma_f32_32x32x16_bf16 v[48:63], a[156:159], v[104:107], v[48:63]
    v_mfma_f32_32x32x16_bf16 v[64:79], a[156:159], v[108:111], v[64:79]
    buffer_load_dwordx4 v[192:195], v5, s[40:43], s56 offen offset:2048 sc1
    buffer_load_dwordx4 v[196:199], v5, s[40:43], s57 offen offset:2048 sc1
    buffer_load_dwordx4 v[200:203], v5, s[40:43], s56 offen offset:3072 sc1
    buffer_load_dwordx4 v[204:207], v5, s[40:43], s57 offen offset:3072 sc1
    s_waitcnt vmcnt(23)
    v_mfma_f32_32x32x16_bf16 v[16:31], a[160:163], v[112:115], v[16:31]
    s_waitcnt vmcnt(22)
    v_mfma_f32_32x32x16_bf16 v[32:47], a[160:163], v[116:119], v[32:47]
    v_mfma_f32_32x32x16_bf16 v[48:63], a[164:167], v[112:115], v[48:63]
    v_mfma_f32_32x32x16_bf16 v[64:79], a[164:167], v[116:119], v[64:79]
    s_add_u32 s56, s71, s98
    s_add_u32 s57, s72, s98
    buffer_load_dwordx4 v[80:83], v5, s[40:43], s56 offen offset:0 sc1
    buffer_load_dwordx4 v[84:87], v5, s[40:43], s57 offen offset:0 sc1
    buffer_load_dwordx4 v[88:91], v5, s[40:43], s56 offen offset:1024 sc1
    buffer_load_dwordx4 v[92:95], v5, s[40:43], s57 offen offset:1024 sc1
    s_waitcnt vmcnt(25)
    v_mfma_f32_32x32x16_bf16 v[16:31], a[168:171], v[120:123], v[16:31]
    s_waitcnt vmcnt(24)
    v_mfma_f32_32x32x16_bf16 v[32:47], a[168:171], v[124:127], v[32:47]
    v_mfma_f32_32x32x16_bf16 v[48:63], a[172:175], v[120:123], v[48:63]
    v_mfma_f32_32x32x16_bf16 v[64:79], a[172:175], v[124:127], v[64:79]
    buffer_load_dwordx4 v[96:99], v5, s[40:43], s56 offen offset:2048 sc1
    buffer_load_dwordx4 v[100:103], v5, s[40:43], s57 offen offset:2048 sc1
    buffer_load_dwordx4 v[104:107], v5, s[40:43], s56 offen offset:3072 sc1
    buffer_load_dwordx4 v[108:111], v5, s[40:43], s57 offen offset:3072 sc1
    s_waitcnt vmcnt(27)
    v_mfma_f32_32x32x16_bf16 v[16:31], a[176:179], v[128:131], v[16:31]
    s_waitcnt vmcnt(26)
    v_mfma_f32_32x32x16_bf16 v[32:47], a[176:179], v[132:135], v[32:47]
    v_mfma_f32_32x32x16_bf16 v[48:63], a[180:183], v[128:131], v[48:63]
    v_mfma_f32_32x32x16_bf16 v[64:79], a[180:183], v[132:135], v[64:79]
    s_add_u32 s56, s71, s99
    s_add_u32 s57, s72, s99
    buffer_load_dwordx4 v[112:115], v5, s[40:43], s56 offen offset:0 sc1
    buffer_load_dwordx4 v[116:119], v5, s[40:43], s57 offen offset:0 sc1
    buffer_load_dwordx4 v[120:123], v5, s[40:43], s56 offen offset:1024 sc1
    buffer_load_dwordx4 v[124:127], v5, s[40:43], s57 offen offset:1024 sc1
    s_waitcnt vmcnt(29)
    v_mfma_f32_32x32x16_bf16 v[16:31], a[184:187], v[136:139], v[16:31]
    s_waitcnt vmcnt(28)
    v_mfma_f32_32x32x16_bf16 v[32:47], a[184:187], v[140:143], v[32:47]
    v_mfma_f32_32x32x16_bf16 v[48:63], a[188:191], v[136:139], v[48:63]
    v_mfma_f32_32x32x16_bf16 v[64:79], a[188:191], v[140:143], v[64:79]
    buffer_load_dwordx4 v[128:131], v5, s[40:43], s56 offen offset:2048 sc1
    buffer_load_dwordx4 v[132:135], v5, s[40:43], s57 offen offset:2048 sc1
    buffer_load_dwordx4 v[136:139], v5, s[40:43], s56 offen offset:3072 sc1
    buffer_load_dwordx4 v[140:143], v5, s[40:43], s57 offen offset:3072 sc1
    s_waitcnt vmcnt(31)
    v_mfma_f32_32x32x16_bf16 v[16:31], a[192:195], v[144:147], v[16:31]
    s_waitcnt vmcnt(30)
    v_mfma_f32_32x32x16_bf16 v[32:47], a[192:195], v[148:151], v[32:47]
    v_mfma_f32_32x32x16_bf16 v[48:63], a[196:199], v[144:147], v[48:63]
    v_mfma_f32_32x32x16_bf16 v[64:79], a[196:199], v[148:151], v[64:79]
    ds_read_b64_tr_b16 a[128:129], v217 offset:24576
    ds_read_b64_tr_b16 a[130:131], v217 offset:25600
    ds_read_b64_tr_b16 a[132:133], v218 offset:24576
    ds_read_b64_tr_b16 a[134:135], v218 offset:25600
    s_add_u32 s56, s71, s100
    s_add_u32 s57, s72, s100
    buffer_load_dwordx4 v[144:147], v5, s[40:43], s56 offen offset:0 sc1
    buffer_load_dwordx4 v[148:151], v5, s[40:43], s57 offen offset:0 sc1
    s_waitcnt vmcnt(31)
    v_mfma_f32_32x32x16_bf16 v[16:31], a[200:203], v[152:155], v[16:31]
    s_waitcnt vmcnt(30)
    v_mfma_f32_32x32x16_bf16 v[32:47], a[200:203], v[156:159], v[32:47]
    v_mfma_f32_32x32x16_bf16 v[48:63], a[204:207], v[152:155], v[48:63]
    v_mfma_f32_32x32x16_bf16 v[64:79], a[204:207], v[156:159], v[64:79]
    ds_read_b64_tr_b16 a[136:137], v217 offset:26624
    ds_read_b64_tr_b16 a[138:139], v217 offset:27648
    ds_read_b64_tr_b16 a[140:141], v218 offset:26624
    ds_read_b64_tr_b16 a[142:143], v218 offset:27648
    buffer_load_dwordx4 v[152:155], v5, s[40:43], s56 offen offset:1024 sc1
    buffer_load_dwordx4 v[156:159], v5, s[40:43], s57 offen offset:1024 sc1
    s_waitcnt vmcnt(31)
    v_mfma_f32_32x32x16_bf16 v[16:31], a[208:211], v[160:163], v[16:31]
    s_waitcnt vmcnt(30)
    v_mfma_f32_32x32x16_bf16 v[32:47], a[208:211], v[164:167], v[32:47]
    v_mfma_f32_32x32x16_bf16 v[48:63], a[212:215], v[160:163], v[48:63]
    v_mfma_f32_32x32x16_bf16 v[64:79], a[212:215], v[164:167], v[64:79]
    ds_read_b64_tr_b16 a[144:145], v217 offset:28672
    ds_read_b64_tr_b16 a[146:147], v217 offset:29696
    ds_read_b64_tr_b16 a[148:149], v218 offset:28672
    ds_read_b64_tr_b16 a[150:151], v218 offset:29696
    buffer_load_dwordx4 v[160:163], v5, s[40:43], s56 offen offset:2048 sc1
    buffer_load_dwordx4 v[164:167], v5, s[40:43], s57 offen offset:2048 sc1
    s_waitcnt vmcnt(31)
    v_mfma_f32_32x32x16_bf16 v[16:31], a[216:219], v[168:171], v[16:31]
    s_waitcnt vmcnt(30)
    v_mfma_f32_32x32x16_bf16 v[32:47], a[216:219], v[172:175], v[32:47]
    v_mfma_f32_32x32x16_bf16 v[48:63], a[220:223], v[168:171], v[48:63]
    v_mfma_f32_32x32x16_bf16 v[64:79], a[220:223], v[172:175], v[64:79]
    ds_read_b64_tr_b16 a[152:153], v217 offset:30720
    ds_read_b64_tr_b16 a[154:155], v217 offset:31744
    ds_read_b64_tr_b16 a[156:157], v218 offset:30720
    ds_read_b64_tr_b16 a[158:159], v218 offset:31744
    buffer_load_dwordx4 v[168:171], v5, s[40:43], s56 offen offset:3072 sc1
    buffer_load_dwordx4 v[172:175], v5, s[40:43], s57 offen offset:3072 sc1
    s_waitcnt vmcnt(31)
    v_mfma_f32_32x32x16_bf16 v[16:31], a[224:227], v[176:179], v[16:31]
    s_waitcnt vmcnt(30)
    v_mfma_f32_32x32x16_bf16 v[32:47], a[224:227], v[180:183], v[32:47]
    v_mfma_f32_32x32x16_bf16 v[48:63], a[228:231], v[176:179], v[48:63]
    v_mfma_f32_32x32x16_bf16 v[64:79], a[228:231], v[180:183], v[64:79]
    ds_read_b64_tr_b16 a[160:161], v217 offset:32768
    ds_read_b64_tr_b16 a[162:163], v217 offset:33792
    ds_read_b64_tr_b16 a[164:165], v218 offset:32768
    ds_read_b64_tr_b16 a[166:167], v218 offset:33792
    s_add_u32 s56, s71, s101
    s_add_u32 s57, s72, s101
    buffer_load_dwordx4 v[176:179], v5, s[40:43], s56 offen offset:0 sc1
    buffer_load_dwordx4 v[180:183], v5, s[40:43], s57 offen offset:0 sc1
    s_waitcnt vmcnt(31)
    v_mfma_f32_32x32x16_bf16 v[16:31], a[232:235], v[184:187], v[16:31]
    s_waitcnt vmcnt(30)
    v_mfma_f32_32x32x16_bf16 v[32:47], a[232:235], v[188:191], v[32:47]
    v_mfma_f32_32x32x16_bf16 v[48:63], a[236:239], v[184:187], v[48:63]
    v_mfma_f32_32x32x16_bf16 v[64:79], a[236:239], v[188:191], v[64:79]
    ds_read_b64_tr_b16 a[168:169], v217 offset:34816
    ds_read_b64_tr_b16 a[170:171], v217 offset:35840
    ds_read_b64_tr_b16 a[172:173], v218 offset:34816
    ds_read_b64_tr_b16 a[174:175], v218 offset:35840
    buffer_load_dwordx4 v[184:187], v5, s[40:43], s56 offen offset:1024 sc1
    buffer_load_dwordx4 v[188:191], v5, s[40:43], s57 offen offset:1024 sc1
    s_waitcnt vmcnt(31)
    v_mfma_f32_32x32x16_bf16 v[16:31], a[240:243], v[192:195], v[16:31]
    s_waitcnt vmcnt(30)
    v_mfma_f32_32x32x16_bf16 v[32:47], a[240:243], v[196:199], v[32:47]
    v_mfma_f32_32x32x16_bf16 v[48:63], a[244:247], v[192:195], v[48:63]
    v_mfma_f32_32x32x16_bf16 v[64:79], a[244:247], v[196:199], v[64:79]
    s_xor_b32 s68, s3, 1
    s_mul_i32 s68, s68, 36864
    s_add_u32 s68, s68, 12288
    v_add_u32 v221, s68, v4
    s_xor_b32 s68, s3, 2
    s_mul_i32 s68, s68, 36864
    s_add_u32 s68, s68, 16384
    v_add_u32 v222, s68, v4
    s_xor_b32 s68, s3, 3
    s_mul_i32 s68, s68, 36864
    s_add_u32 s68, s68, 20480
    v_add_u32 v223, s68, v4
    v_add_u32 v220, s70, v4
    s_lshl_b32 s68, s64, 1
    s_and_b32 s69, s3, 1
    s_add_u32 s68, s68, s69
    s_mul_i32 s68, s68, 112
    s_lshl_b32 s69, s65, 2
    s_add_u32 s68, s68, s69
    s_and_b32 s69, s3, 2
    s_add_u32 s68, s68, s69
    s_lshl_b32 s68, s68, 10
    s_add_u32 s68, s68, 0x3c0000
    s_mov_b32 s88, 0xc0135761
    s_mov_b32 s90, 0xbdd2d3e8
    v_mov_b32 v224, s88
    v_mov_b32 v225, s88
    buffer_load_dwordx4 v[192:195], v5, s[40:43], s56 offen offset:2048 sc1
    buffer_load_dwordx4 v[196:199], v5, s[40:43], s57 offen offset:2048 sc1
    s_waitcnt vmcnt(31)
    v_mfma_f32_32x32x16_bf16 v[16:31], a[248:251], v[200:203], v[16:31]
    s_waitcnt vmcnt(30)
    v_mfma_f32_32x32x16_bf16 v[32:47], a[248:251], v[204:207], v[32:47]
    v_mfma_f32_32x32x16_bf16 v[48:63], a[252:255], v[200:203], v[48:63]
    v_mfma_f32_32x32x16_bf16 v[64:79], a[252:255], v[204:207], v[64:79]
    buffer_load_dwordx4 v[200:203], v5, s[40:43], s56 offen offset:3072 sc1
    buffer_load_dwordx4 v[204:207], v5, s[40:43], s57 offen offset:3072 sc1
    s_waitcnt vmcnt(31)
    v_mfma_f32_32x32x16_bf16 v[16:31], a[0:3], v[80:83], v[16:31]
    s_waitcnt vmcnt(30)
    v_mfma_f32_32x32x16_bf16 v[32:47], a[0:3], v[84:87], v[32:47]
    v_mfma_f32_32x32x16_bf16 v[48:63], a[4:7], v[80:83], v[48:63]
    v_mfma_f32_32x32x16_bf16 v[64:79], a[4:7], v[84:87], v[64:79]
    s_barrier
    s_waitcnt lgkmcnt(15)
    s_add_u32 m0, s70, 12288
    s_mul_i32 s73, s49, 64
    s_add_u32 s73, s73, 131072
    buffer_load_dwordx4 v214, s[24:27], s73 offen lds
    s_add_u32 m0, s70, 13312
    s_mul_i32 s73, s49, 64
    s_add_u32 s73, s73, 163840
    buffer_load_dwordx4 v214, s[24:27], s73 offen lds
    s_waitcnt vmcnt(31)
    v_mfma_f32_32x32x16_bf16 v[16:31], a[8:11], v[88:91], v[16:31]
    s_waitcnt vmcnt(30)
    v_mfma_f32_32x32x16_bf16 v[32:47], a[8:11], v[92:95], v[32:47]
    v_mfma_f32_32x32x16_bf16 v[48:63], a[12:15], v[88:91], v[48:63]
    v_mfma_f32_32x32x16_bf16 v[64:79], a[12:15], v[92:95], v[64:79]
    s_add_u32 m0, s70, 14336
    s_mul_i32 s73, s49, 64
    s_add_u32 s73, s73, 196608
    buffer_load_dwordx4 v214, s[24:27], s73 offen lds
    s_add_u32 m0, s70, 15360
    s_mul_i32 s73, s49, 64
    s_add_u32 s73, s73, 229376
    buffer_load_dwordx4 v214, s[24:27], s73 offen lds
    s_waitcnt vmcnt(31)
    v_mfma_f32_32x32x16_bf16 v[16:31], a[16:19], v[96:99], v[16:31]
    s_waitcnt vmcnt(30)
    v_mfma_f32_32x32x16_bf16 v[32:47], a[16:19], v[100:103], v[32:47]
    v_mfma_f32_32x32x16_bf16 v[48:63], a[20:23], v[96:99], v[48:63]
    v_mfma_f32_32x32x16_bf16 v[64:79], a[20:23], v[100:103], v[64:79]
    s_add_u32 m0, s70, 16384
    s_mul_i32 s73, s50, 64
    s_add_u32 s73, s73, 0
    buffer_load_dwordx4 v214, s[24:27], s73 offen lds
    s_add_u32 m0, s70, 17408
    s_mul_i32 s73, s50, 64
    s_add_u32 s73, s73, 32768
    buffer_load_dwordx4 v214, s[24:27], s73 offen lds
    s_waitcnt vmcnt(31)
    v_mfma_f32_32x32x16_bf16 v[16:31], a[24:27], v[104:107], v[16:31]
    s_waitcnt vmcnt(30)
    v_mfma_f32_32x32x16_bf16 v[32:47], a[24:27], v[108:111], v[32:47]
    v_mfma_f32_32x32x16_bf16 v[48:63], a[28:31], v[104:107], v[48:63]
    v_mfma_f32_32x32x16_bf16 v[64:79], a[28:31], v[108:111], v[64:79]
    s_add_u32 m0, s70, 18432
    s_mul_i32 s73, s50, 64
    s_add_u32 s73, s73, 65536
    buffer_load_dwordx4 v214, s[24:27], s73 offen lds
    s_add_u32 m0, s70, 19456
    s_mul_i32 s73, s50, 64
    s_add_u32 s73, s73, 98304
    buffer_load_dwordx4 v214, s[24:27], s73 offen lds
    s_waitcnt vmcnt(31)
    v_mfma_f32_32x32x16_bf16 v[16:31], a[32:35], v[112:115], v[16:31]
    s_waitcnt vmcnt(30)
    v_mfma_f32_32x32x16_bf16 v[32:47], a[32:35], v[116:119], v[32:47]
    v_mfma_f32_32x32x16_bf16 v[48:63], a[36:39], v[112:115], v[48:63]
    v_mfma_f32_32x32x16_bf16 v[64:79], a[36:39], v[116:119], v[64:79]
    s_add_u32 m0, s70, 20480
    s_mul_i32 s73, s50, 64
    s_add_u32 s73, s73, 131072
    buffer_load_dwordx4 v214, s[24:27], s73 offen lds
    s_add_u32 m0, s70, 21504
    s_mul_i32 s73, s50, 64
    s_add_u32 s73, s73, 163840
    buffer_load_dwordx4 v214, s[24:27], s73 offen lds
    s_waitcnt vmcnt(31)
    v_mfma_f32_32x32x16_bf16 v[16:31], a[40:43], v[120:123], v[16:31]
    s_waitcnt vmcnt(30)
    v_mfma_f32_32x32x16_bf16 v[32:47], a[40:43], v[124:127], v[32:47]
    v_mfma_f32_32x32x16_bf16 v[48:63], a[44:47], v[120:123], v[48:63]
    v_mfma_f32_32x32x16_bf16 v[64:79], a[44:47], v[124:127], v[64:79]
    s_add_u32 m0, s70, 22528
    s_mul_i32 s73, s50, 64
    s_add_u32 s73, s73, 196608
    buffer_load_dwordx4 v214, s[24:27], s73 offen lds
    s_add_u32 m0, s70, 23552
    s_mul_i32 s73, s50, 64
    s_add_u32 s73, s73, 229376
    buffer_load_dwordx4 v214, s[24:27], s73 offen lds
    s_waitcnt vmcnt(31)
    v_mfma_f32_32x32x16_bf16 v[16:31], a[48:51], v[128:131], v[16:31]
    s_waitcnt vmcnt(30)
    v_mfma_f32_32x32x16_bf16 v[32:47], a[48:51], v[132:135], v[32:47]
    v_mfma_f32_32x32x16_bf16 v[48:63], a[52:55], v[128:131], v[48:63]
    v_mfma_f32_32x32x16_bf16 v[64:79], a[52:55], v[132:135], v[64:79]
    s_add_u32 m0, s70, 24576
    s_mul_i32 s73, s51, 64
    s_add_u32 s73, s73, 0
    buffer_load_dwordx4 v214, s[24:27], s73 offen lds
    s_add_u32 m0, s70, 25600
    s_mul_i32 s73, s51, 64
    s_add_u32 s73, s73, 32768
    buffer_load_dwordx4 v214, s[24:27], s73 offen lds
    s_waitcnt vmcnt(31)
    v_mfma_f32_32x32x16_bf16 v[16:31], a[56:59], v[136:139], v[16:31]
    s_waitcnt vmcnt(30)
    v_mfma_f32_32x32x16_bf16 v[32:47], a[56:59], v[140:143], v[32:47]
    v_mfma_f32_32x32x16_bf16 v[48:63], a[60:63], v[136:139], v[48:63]
    v_mfma_f32_32x32x16_bf16 v[64:79], a[60:63], v[140:143], v[64:79]
    s_add_u32 m0, s70, 26624
    s_mul_i32 s73, s51, 64
    s_add_u32 s73, s73, 65536
    buffer_load_dwordx4 v214, s[24:27], s73 offen lds
    s_add_u32 m0, s70, 27648
    s_mul_i32 s73, s51, 64
    s_add_u32 s73, s73, 98304
    buffer_load_dwordx4 v214, s[24:27], s73 offen lds
    s_waitcnt vmcnt(31)
    v_mfma_f32_32x32x16_bf16 v[16:31], a[64:67], v[144:147], v[16:31]
    s_waitcnt vmcnt(30)
    v_mfma_f32_32x32x16_bf16 v[32:47], a[64:67], v[148:151], v[32:47]
    v_mfma_f32_32x32x16_bf16 v[48:63], a[68:71], v[144:147], v[48:63]
    v_mfma_f32_32x32x16_bf16 v[64:79], a[68:71], v[148:151], v[64:79]
    s_waitcnt lgkmcnt(12)
    s_add_u32 m0, s70, 28672
    s_mul_i32 s73, s51, 64
    s_add_u32 s73, s73, 131072
    buffer_load_dwordx4 v214, s[24:27], s73 offen lds
    s_add_u32 m0, s70, 29696
    s_mul_i32 s73, s51, 64
    s_add_u32 s73, s73, 163840
    buffer_load_dwordx4 v214, s[24:27], s73 offen lds
    s_waitcnt vmcnt(31)
    v_mfma_f32_32x32x16_bf16 v[16:31], a[72:75], v[152:155], v[16:31]
    s_waitcnt vmcnt(30)
    v_mfma_f32_32x32x16_bf16 v[32:47], a[72:75], v[156:159], v[32:47]
    v_mfma_f32_32x32x16_bf16 v[48:63], a[76:79], v[152:155], v[48:63]
    v_mfma_f32_32x32x16_bf16 v[64:79], a[76:79], v[156:159], v[64:79]
    s_waitcnt lgkmcnt(8)
    s_add_u32 m0, s70, 30720
    s_mul_i32 s73, s51, 64
    s_add_u32 s73, s73, 196608
    buffer_load_dwordx4 v214, s[24:27], s73 offen lds
    s_add_u32 m0, s70, 31744
    s_mul_i32 s73, s51, 64
    s_add_u32 s73, s73, 229376
    buffer_load_dwordx4 v214, s[24:27], s73 offen lds
    s_waitcnt vmcnt(31)
    v_mfma_f32_32x32x16_bf16 v[16:31], a[80:83], v[160:163], v[16:31]
    s_waitcnt vmcnt(30)
    v_mfma_f32_32x32x16_bf16 v[32:47], a[80:83], v[164:167], v[32:47]
    v_mfma_f32_32x32x16_bf16 v[48:63], a[84:87], v[160:163], v[48:63]
    v_mfma_f32_32x32x16_bf16 v[64:79], a[84:87], v[164:167], v[64:79]
    s_waitcnt lgkmcnt(4)
    s_add_u32 m0, s70, 32768
    s_mul_i32 s73, s52, 64
    s_add_u32 s73, s73, 0
    buffer_load_dwordx4 v214, s[24:27], s73 offen lds
    s_add_u32 m0, s70, 33792
    s_mul_i32 s73, s52, 64
    s_add_u32 s73, s73, 32768
    buffer_load_dwordx4 v214, s[24:27], s73 offen lds
    s_waitcnt vmcnt(31)
    v_mfma_f32_32x32x16_bf16 v[16:31], a[88:91], v[168:171], v[16:31]
    s_waitcnt vmcnt(30)
    v_mfma_f32_32x32x16_bf16 v[32:47], a[88:91], v[172:175], v[32:47]
    v_mfma_f32_32x32x16_bf16 v[48:63], a[92:95], v[168:171], v[48:63]
    v_mfma_f32_32x32x16_bf16 v[64:79], a[92:95], v[172:175], v[64:79]
    s_waitcnt lgkmcnt(0)
    s_add_u32 m0, s70, 34816
    s_mul_i32 s73, s52, 64
    s_add_u32 s73, s73, 65536
    buffer_load_dwordx4 v214, s[24:27], s73 offen lds
    s_add_u32 m0, s70, 35840
    s_mul_i32 s73, s52, 64
    s_add_u32 s73, s73, 98304
    buffer_load_dwordx4 v214, s[24:27], s73 offen lds
    s_waitcnt vmcnt(30)
    v_mfma_f32_32x32x16_bf16 v[64:79], a[100:103], v[180:183], v[64:79]
    s_waitcnt vmcnt(28)
    v_mfma_f32_32x32x16_bf16 v[64:79], a[108:111], v[188:191], v[64:79]
    s_waitcnt vmcnt(26)
    v_mfma_f32_32x32x16_bf16 v[64:79], a[116:119], v[196:199], v[64:79]
    s_waitcnt vmcnt(24)
    v_mfma_f32_32x32x16_bf16 v[64:79], a[124:127], v[204:207], v[64:79]
    v_mfma_f32_32x32x16_bf16 v[48:63], a[100:103], v[176:179], v[48:63]
    v_mfma_f32_32x32x16_bf16 v[48:63], a[108:111], v[184:187], v[48:63]
    s_nop 9
    ds_write_b128 v223, v[64:67] offset:0
    ds_write_b128 v223, v[68:71] offset:1024
    v_mfma_f32_32x32x16_bf16 v[48:63], a[116:119], v[192:195], v[48:63]
    ds_write_b128 v223, v[72:75] offset:2048
    v_mfma_f32_32x32x16_bf16 v[48:63], a[124:127], v[200:203], v[48:63]
    ds_write_b128 v223, v[76:79] offset:3072
    v_mfma_f32_32x32x16_bf16 v[32:47], a[96:99], v[180:183], v[32:47]
    v_mfma_f32_32x32x16_bf16 v[32:47], a[104:107], v[188:191], v[32:47]
    s_nop 8
    ds_write_b128 v222, v[48:51] offset:0
    ds_write_b128 v222, v[52:55] offset:1024
    v_mfma_f32_32x32x16_bf16 v[32:47], a[112:115], v[196:199], v[32:47]
    ds_write_b128 v222, v[56:59] offset:2048
    v_mfma_f32_32x32x16_bf16 v[32:47], a[120:123], v[204:207], v[32:47]
    ds_write_b128 v222, v[60:63] offset:3072
    v_mfma_f32_32x32x16_bf16 v[16:31], a[96:99], v[176:179], v[16:31]
    v_mfma_f32_32x32x16_bf16 v[16:31], a[104:107], v[184:187], v[16:31]
    s_nop 8
    ds_write_b128 v221, v[32:35] offset:0
    ds_write_b128 v221, v[36:39] offset:1024
    v_mfma_f32_32x32x16_bf16 v[16:31], a[112:115], v[192:195], v[16:31]
    ds_write_b128 v221, v[40:43] offset:2048
    v_mfma_f32_32x32x16_bf16 v[16:31], a[120:123], v[200:203], v[16:31]
    ds_write_b128 v221, v[44:47] offset:3072
    s_waitcnt lgkmcnt(0)
    s_barrier
    ds_read_b128 v[32:35], v220 offset:0
    ds_read_b128 v[48:51], v220 offset:4096
    ds_read_b128 v[64:67], v220 offset:8192
    ds_read_b128 v[36:39], v220 offset:1024
    ds_read_b128 v[52:55], v220 offset:5120
    ds_read_b128 v[68:71], v220 offset:9216
    ds_read_b128 v[40:43], v220 offset:2048
    ds_read_b128 v[56:59], v220 offset:6144
    ds_read_b128 v[72:75], v220 offset:10240
    ds_read_b128 v[44:47], v220 offset:3072
    ds_read_b128 v[60:63], v220 offset:7168
    ds_read_b128 v[76:79], v220 offset:11264
    s_waitcnt lgkmcnt(10)
    v_pk_add_f32 v[32:33], v[32:33], v[48:49]
    s_waitcnt lgkmcnt(9)
    v_pk_add_f32 v[16:17], v[16:17], v[64:65]
    v_pk_add_f32 v[34:35], v[34:35], v[50:51]
    v_pk_add_f32 v[18:19], v[18:19], v[66:67]
    s_waitcnt lgkmcnt(7)
    v_pk_add_f32 v[36:37], v[36:37], v[52:53]
    s_waitcnt lgkmcnt(6)
    v_pk_add_f32 v[20:21], v[20:21], v[68:69]
    v_pk_add_f32 v[38:39], v[38:39], v[54:55]
    v_pk_add_f32 v[22:23], v[22:23], v[70:71]
    v_pk_add_f32 v[16:17], v[16:17], v[32:33]
    v_pk_add_f32 v[18:19], v[18:19], v[34:35]
    v_pk_add_f32 v[20:21], v[20:21], v[36:37]
    v_pk_add_f32 v[22:23], v[22:23], v[38:39]
    v_pk_mul_f32 v[80:81], v[16:17], v[16:17]
    v_pk_mul_f32 v[82:83], v[18:19], v[18:19]
    v_pk_mul_f32 v[84:85], v[20:21], v[20:21]
    v_pk_mul_f32 v[86:87], v[22:23], v[22:23]
    v_pk_fma_f32 v[80:81], v[80:81], s[90:91], v[224:225] op_sel_hi:[1,0,1]
    v_pk_fma_f32 v[82:83], v[82:83], s[90:91], v[224:225] op_sel_hi:[1,0,1]
    v_pk_fma_f32 v[84:85], v[84:85], s[90:91], v[224:225] op_sel_hi:[1,0,1]
    v_pk_fma_f32 v[86:87], v[86:87], s[90:91], v[224:225] op_sel_hi:[1,0,1]
    v_pk_mul_f32 v[80:81], v[80:81], v[16:17]
    v_pk_mul_f32 v[82:83], v[82:83], v[18:19]
    v_pk_mul_f32 v[84:85], v[84:85], v[20:21]
    v_pk_mul_f32 v[86:87], v[86:87], v[22:23]
    v_exp_f32 v80, v80
    v_exp_f32 v81, v81
    v_exp_f32 v82, v82
    v_exp_f32 v83, v83
    v_exp_f32 v84, v84
    v_exp_f32 v85, v85
    v_exp_f32 v86, v86
    v_exp_f32 v87, v87
    v_pk_add_f32 v[80:81], v[80:81], 1.0 op_sel_hi:[1,0]
    v_pk_add_f32 v[82:83], v[82:83], 1.0 op_sel_hi:[1,0]
    v_pk_add_f32 v[84:85], v[84:85], 1.0 op_sel_hi:[1,0]
    v_pk_add_f32 v[86:87], v[86:87], 1.0 op_sel_hi:[1,0]
    v_rcp_f32 v80, v80
    v_rcp_f32 v81, v81
    v_rcp_f32 v82, v82
    v_rcp_f32 v83, v83
    v_rcp_f32 v84, v84
    v_rcp_f32 v85, v85
    v_rcp_f32 v86, v86
    v_rcp_f32 v87, v87
    v_pk_mul_f32 v[80:81], v[80:81], v[16:17]
    v_pk_mul_f32 v[82:83], v[82:83], v[18:19]
    v_pk_mul_f32 v[84:85], v[84:85], v[20:21]
    v_pk_mul_f32 v[86:87], v[86:87], v[22:23]
    v_cvt_pk_bf16_f32 v96, v80, v81
    v_cvt_pk_bf16_f32 v97, v82, v83
    v_cvt_pk_bf16_f32 v98, v84, v85
    v_cvt_pk_bf16_f32 v99, v86, v87
    buffer_store_dwordx4 v[96:99], v5, s[40:43], s68 offen offset:0 sc1
    s_waitcnt lgkmcnt(4)
    v_pk_add_f32 v[40:41], v[40:41], v[56:57]
    s_waitcnt lgkmcnt(3)
    v_pk_add_f32 v[24:25], v[24:25], v[72:73]
    v_pk_add_f32 v[42:43], v[42:43], v[58:59]
    v_pk_add_f32 v[26:27], v[26:27], v[74:75]
    s_waitcnt lgkmcnt(1)
    v_pk_add_f32 v[44:45], v[44:45], v[60:61]
    s_waitcnt lgkmcnt(0)
    v_pk_add_f32 v[28:29], v[28:29], v[76:77]
    v_pk_add_f32 v[46:47], v[46:47], v[62:63]
    v_pk_add_f32 v[30:31], v[30:31], v[78:79]
    v_pk_add_f32 v[24:25], v[24:25], v[40:41]
    v_pk_add_f32 v[26:27], v[26:27], v[42:43]
    v_pk_add_f32 v[28:29], v[28:29], v[44:45]
    v_pk_add_f32 v[30:31], v[30:31], v[46:47]
    v_pk_mul_f32 v[88:89], v[24:25], v[24:25]
    v_pk_mul_f32 v[90:91], v[26:27], v[26:27]
    v_pk_mul_f32 v[92:93], v[28:29], v[28:29]
    v_pk_mul_f32 v[94:95], v[30:31], v[30:31]
    v_pk_fma_f32 v[88:89], v[88:89], s[90:91], v[224:225] op_sel_hi:[1,0,1]
    v_pk_fma_f32 v[90:91], v[90:91], s[90:91], v[224:225] op_sel_hi:[1,0,1]
    v_pk_fma_f32 v[92:93], v[92:93], s[90:91], v[224:225] op_sel_hi:[1,0,1]
    v_pk_fma_f32 v[94:95], v[94:95], s[90:91], v[224:225] op_sel_hi:[1,0,1]
    v_pk_mul_f32 v[88:89], v[88:89], v[24:25]
    v_pk_mul_f32 v[90:91], v[90:91], v[26:27]
    v_pk_mul_f32 v[92:93], v[92:93], v[28:29]
    v_pk_mul_f32 v[94:95], v[94:95], v[30:31]
    v_exp_f32 v88, v88
    v_exp_f32 v89, v89
    v_exp_f32 v90, v90
    v_exp_f32 v91, v91
    v_exp_f32 v92, v92
    v_exp_f32 v93, v93
    v_exp_f32 v94, v94
    v_exp_f32 v95, v95
    v_pk_add_f32 v[88:89], v[88:89], 1.0 op_sel_hi:[1,0]
    v_pk_add_f32 v[90:91], v[90:91], 1.0 op_sel_hi:[1,0]
    v_pk_add_f32 v[92:93], v[92:93], 1.0 op_sel_hi:[1,0]
    v_pk_add_f32 v[94:95], v[94:95], 1.0 op_sel_hi:[1,0]
    v_rcp_f32 v88, v88
    v_rcp_f32 v89, v89
    v_rcp_f32 v90, v90
    v_rcp_f32 v91, v91
    v_rcp_f32 v92, v92
    v_rcp_f32 v93, v93
    v_rcp_f32 v94, v94
    v_rcp_f32 v95, v95
    v_pk_mul_f32 v[88:89], v[88:89], v[24:25]
    v_pk_mul_f32 v[90:91], v[90:91], v[26:27]
    v_pk_mul_f32 v[92:93], v[92:93], v[28:29]
    v_pk_mul_f32 v[94:95], v[94:95], v[30:31]
    v_cvt_pk_bf16_f32 v100, v88, v89
    v_cvt_pk_bf16_f32 v101, v90, v91
    v_cvt_pk_bf16_f32 v102, v92, v93
    v_cvt_pk_bf16_f32 v103, v94, v95
    buffer_store_dwordx4 v[100:103], v5, s[40:43], s68 offen offset:1024 sc1
    v_mov_b32 v9, v5
    s_waitcnt vmcnt(24)
    ds_read_b64_tr_b16 a[176:177], v217 offset:12288
    ds_read_b64_tr_b16 a[178:179], v217 offset:13312
    ds_read_b64_tr_b16 a[180:181], v218 offset:12288
    ds_read_b64_tr_b16 a[182:183], v218 offset:13312
    s_waitcnt vmcnt(22)
    ds_read_b64_tr_b16 a[184:185], v217 offset:14336
    ds_read_b64_tr_b16 a[186:187], v217 offset:15360
    ds_read_b64_tr_b16 a[188:189], v218 offset:14336
    ds_read_b64_tr_b16 a[190:191], v218 offset:15360
    s_waitcnt vmcnt(20)
    ds_read_b64_tr_b16 a[192:193], v217 offset:16384
    ds_read_b64_tr_b16 a[194:195], v217 offset:17408
    ds_read_b64_tr_b16 a[196:197], v218 offset:16384
    ds_read_b64_tr_b16 a[198:199], v218 offset:17408
    s_waitcnt vmcnt(18)
    ds_read_b64_tr_b16 a[200:201], v217 offset:18432
    ds_read_b64_tr_b16 a[202:203], v217 offset:19456
    ds_read_b64_tr_b16 a[204:205], v218 offset:18432
    ds_read_b64_tr_b16 a[206:207], v218 offset:19456
    s_waitcnt vmcnt(16)
    ds_read_b64_tr_b16 a[208:209], v217 offset:20480
    ds_read_b64_tr_b16 a[210:211], v217 offset:21504
    ds_read_b64_tr_b16 a[212:213], v218 offset:20480
    ds_read_b64_tr_b16 a[214:215], v218 offset:21504
    s_waitcnt vmcnt(14)
    ds_read_b64_tr_b16 a[216:217], v217 offset:22528
    ds_read_b64_tr_b16 a[218:219], v217 offset:23552
    ds_read_b64_tr_b16 a[220:221], v218 offset:22528
    ds_read_b64_tr_b16 a[222:223], v218 offset:23552
    s_waitcnt vmcnt(12)
    ds_read_b64_tr_b16 a[224:225], v217 offset:24576
    ds_read_b64_tr_b16 a[226:227], v217 offset:25600
    ds_read_b64_tr_b16 a[228:229], v218 offset:24576
    ds_read_b64_tr_b16 a[230:231], v218 offset:25600
    s_waitcnt vmcnt(10)
    ds_read_b64_tr_b16 a[232:233], v217 offset:26624
    ds_read_b64_tr_b16 a[234:235], v217 offset:27648
    ds_read_b64_tr_b16 a[236:237], v218 offset:26624
    ds_read_b64_tr_b16 a[238:239], v218 offset:27648
    s_waitcnt vmcnt(8)
    ds_read_b64_tr_b16 a[240:241], v217 offset:28672
    ds_read_b64_tr_b16 a[242:243], v217 offset:29696
    ds_read_b64_tr_b16 a[244:245], v218 offset:28672
    ds_read_b64_tr_b16 a[246:247], v218 offset:29696
    s_waitcnt vmcnt(6)
    ds_read_b64_tr_b16 a[248:249], v217 offset:30720
    ds_read_b64_tr_b16 a[250:251], v217 offset:31744
    ds_read_b64_tr_b16 a[252:253], v218 offset:30720
    ds_read_b64_tr_b16 a[254:255], v218 offset:31744
    s_waitcnt vmcnt(4)
    ds_read_b64_tr_b16 a[0:1], v217 offset:32768
    ds_read_b64_tr_b16 a[2:3], v217 offset:33792
    ds_read_b64_tr_b16 a[4:5], v218 offset:32768
    ds_read_b64_tr_b16 a[6:7], v218 offset:33792
    s_waitcnt vmcnt(2)
    ds_read_b64_tr_b16 a[8:9], v217 offset:34816
    ds_read_b64_tr_b16 a[10:11], v217 offset:35840
    ds_read_b64_tr_b16 a[12:13], v218 offset:34816
    ds_read_b64_tr_b16 a[14:15], v218 offset:35840
    s_waitcnt vmcnt(0)
    v_mov_b32 v8, s4
    s_mov_b64 exec, 1
    buffer_store_dword v8, v9, s[40:43], s82 offen sc1
    s_mov_b64 exec, -1
    s_add_u32 m0, s70, 0
    s_mul_i32 s73, s52, 64
    s_add_u32 s73, s73, 131072
    buffer_load_dwordx4 v214, s[24:27], s73 offen lds
    s_add_u32 m0, s70, 1024
    s_mul_i32 s73, s52, 64
    s_add_u32 s73, s73, 163840
    buffer_load_dwordx4 v214, s[24:27], s73 offen lds
    s_add_u32 m0, s70, 2048
    s_mul_i32 s73, s52, 64
    s_add_u32 s73, s73, 196608
    buffer_load_dwordx4 v214, s[24:27], s73 offen lds
    s_add_u32 m0, s70, 3072
    s_mul_i32 s73, s52, 64
    s_add_u32 s73, s73, 229376
    buffer_load_dwordx4 v214, s[24:27], s73 offen lds
    s_add_u32 m0, s70, 4096
    s_mul_i32 s73, s53, 64
    s_add_u32 s73, s73, 0
    buffer_load_dwordx4 v214, s[24:27], s73 offen lds
    s_add_u32 m0, s70, 5120
    s_mul_i32 s73, s53, 64
    s_add_u32 s73, s73, 32768
    buffer_load_dwordx4 v214, s[24:27], s73 offen lds
    s_add_u32 m0, s70, 6144
    s_mul_i32 s73, s53, 64
    s_add_u32 s73, s73, 65536
    buffer_load_dwordx4 v214, s[24:27], s73 offen lds
    s_add_u32 m0, s70, 7168
    s_mul_i32 s73, s53, 64
    s_add_u32 s73, s73, 98304
    buffer_load_dwordx4 v214, s[24:27], s73 offen lds
    s_add_u32 m0, s70, 8192
    s_mul_i32 s73, s53, 64
    s_add_u32 s73, s73, 131072
    buffer_load_dwordx4 v214, s[24:27], s73 offen lds
    s_add_u32 m0, s70, 9216
    s_mul_i32 s73, s53, 64
    s_add_u32 s73, s73, 163840
    buffer_load_dwordx4 v214, s[24:27], s73 offen lds
    s_add_u32 m0, s70, 10240
    s_mul_i32 s73, s53, 64
    s_add_u32 s73, s73, 196608
    buffer_load_dwordx4 v214, s[24:27], s73 offen lds
    s_add_u32 m0, s70, 11264
    s_mul_i32 s73, s53, 64
    s_add_u32 s73, s73, 229376
    buffer_load_dwordx4 v214, s[24:27], s73 offen lds
    s_waitcnt lgkmcnt(15)
    s_add_u32 m0, s70, 12288
    s_mul_i32 s73, s54, 64
    s_add_u32 s73, s73, 0
    buffer_load_dwordx4 v214, s[24:27], s73 offen lds
    s_add_u32 m0, s70, 13312
    s_mul_i32 s73, s54, 64
    s_add_u32 s73, s73, 32768
    buffer_load_dwordx4 v214, s[24:27], s73 offen lds
    s_add_u32 m0, s70, 14336
    s_mul_i32 s73, s54, 64
    s_add_u32 s73, s73, 65536
    buffer_load_dwordx4 v214, s[24:27], s73 offen lds
    s_add_u32 m0, s70, 15360
    s_mul_i32 s73, s54, 64
    s_add_u32 s73, s73, 98304
    buffer_load_dwordx4 v214, s[24:27], s73 offen lds
    s_add_u32 m0, s70, 16384
    s_mul_i32 s73, s54, 64
    s_add_u32 s73, s73, 131072
    buffer_load_dwordx4 v214, s[24:27], s73 offen lds
    s_add_u32 m0, s70, 17408
    s_mul_i32 s73, s54, 64
    s_add_u32 s73, s73, 163840
    buffer_load_dwordx4 v214, s[24:27], s73 offen lds
    s_add_u32 m0, s70, 18432
    s_mul_i32 s73, s54, 64
    s_add_u32 s73, s73, 196608
    buffer_load_dwordx4 v214, s[24:27], s73 offen lds
    s_add_u32 m0, s70, 19456
    s_mul_i32 s73, s54, 64
    s_add_u32 s73, s73, 229376
    buffer_load_dwordx4 v214, s[24:27], s73 offen lds
    v_lshrrev_b32 v220, 5, v1
    v_lshlrev_b32 v220, 3, v220
    s_lshl_b32 s68, s67, 7
    s_lshr_b32 s69, s3, 1
    s_lshl_b32 s69, s69, 6
    s_add_u32 s68, s68, s69
    buffer_load_dwordx2 v[222:223], v220, s[32:35], s68 offen offset:0
    buffer_load_dwordx2 v[224:225], v220, s[32:35], s68 offen offset:16
    buffer_load_dwordx2 v[226:227], v220, s[32:35], s68 offen offset:32
    buffer_load_dwordx2 v[228:229], v220, s[32:35], s68 offen offset:48
    s_lshl_b32 s68, s66, 1
    s_and_b32 s69, s3, 1
    s_add_u32 s71, s68, s69
    s_xor_b32 s72, s71, 1
    s_mul_i32 s68, s3, 28672
    s_add_u32 s68, s68, 0x3c0000
    s_mul_i32 s71, s71, 114688
    s_add_u32 s71, s71, s68
    s_mul_i32 s72, s72, 114688
    s_add_u32 s72, s72, s68
    buffer_load_dword v249, v12, s[40:43], s85 offen sc1
    s_sleep 3
    buffer_load_dword v250, v12, s[40:43], s85 offen sc1
    s_sleep 3
    s_nop 0
Lpoll_P_10:
    s_sub_u32 s6, s6, 1
    s_cbranch_scc1 L_end_P
    buffer_load_dword v251, v12, s[40:43], s85 offen sc1
    s_waitcnt vmcnt(2)
    v_cmp_ne_u32 vcc, s4, v249
    s_nop 1
    s_cbranch_vccz Lpd_P_11
    buffer_load_dword v249, v12, s[40:43], s85 offen sc1
    s_waitcnt vmcnt(2)
    v_cmp_ne_u32 vcc, s4, v250
    s_nop 1
    s_cbranch_vccz Lpd_P_11
    buffer_load_dword v250, v12, s[40:43], s85 offen sc1
    s_waitcnt vmcnt(2)
    v_cmp_ne_u32 vcc, s4, v251
    s_nop 1
    s_cbranch_vccnz Lpoll_P_10
    s_nop 1
Lpd_P_11:
    s_add_u32 s56, s71, s48
    s_add_u32 s57, s72, s48
    buffer_load_dwordx4 v[80:83], v4, s[40:43], s56 offen offset:0 sc1
    buffer_load_dwordx4 v[84:87], v4, s[40:43], s57 offen offset:0 sc1
    buffer_load_dwordx4 v[88:91], v4, s[40:43], s56 offen offset:1024 sc1
    buffer_load_dwordx4 v[92:95], v4, s[40:43], s57 offen offset:1024 sc1
    buffer_load_dwordx4 v[96:99], v4, s[40:43], s56 offen offset:2048 sc1
    buffer_load_dwordx4 v[100:103], v4, s[40:43], s57 offen offset:2048 sc1
    buffer_load_dwordx4 v[104:107], v4, s[40:43], s56 offen offset:3072 sc1
    buffer_load_dwordx4 v[108:111], v4, s[40:43], s57 offen offset:3072 sc1
    s_add_u32 s56, s71, s49
    s_add_u32 s57, s72, s49
    buffer_load_dwordx4 v[112:115], v4, s[40:43], s56 offen offset:0 sc1
    buffer_load_dwordx4 v[116:119], v4, s[40:43], s57 offen offset:0 sc1
    buffer_load_dwordx4 v[120:123], v4, s[40:43], s56 offen offset:1024 sc1
    buffer_load_dwordx4 v[124:127], v4, s[40:43], s57 offen offset:1024 sc1
    v_lshlrev_b32 v16, 16, v222
    v_and_b32 v17, 0xffff0000, v222
    v_lshlrev_b32 v238, 16, v240
    v_and_b32 v239, 0xffff0000, v240
    v_pk_add_f32 v[16:17], v[16:17], v[238:239]
    v_lshlrev_b32 v18, 16, v223
    v_and_b32 v19, 0xffff0000, v223
    v_lshlrev_b32 v238, 16, v241
    v_and_b32 v239, 0xffff0000, v241
    v_pk_add_f32 v[18:19], v[18:19], v[238:239]
    v_lshlrev_b32 v20, 16, v224
    v_and_b32 v21, 0xffff0000, v224
    v_lshlrev_b32 v238, 16, v242
    v_and_b32 v239, 0xffff0000, v242
    v_pk_add_f32 v[20:21], v[20:21], v[238:239]
    v_lshlrev_b32 v22, 16, v225
    v_and_b32 v23, 0xffff0000, v225
    v_lshlrev_b32 v238, 16, v243
    v_and_b32 v239, 0xffff0000, v243
    v_pk_add_f32 v[22:23], v[22:23], v[238:239]
    v_lshlrev_b32 v24, 16, v226
    v_and_b32 v25, 0xffff0000, v226
    v_lshlrev_b32 v238, 16, v244
    v_and_b32 v239, 0xffff0000, v244
    v_pk_add_f32 v[24:25], v[24:25], v[238:239]
    v_lshlrev_b32 v26, 16, v227
    v_and_b32 v27, 0xffff0000, v227
    v_lshlrev_b32 v238, 16, v245
    v_and_b32 v239, 0xffff0000, v245
    v_pk_add_f32 v[26:27], v[26:27], v[238:239]
    v_lshlrev_b32 v28, 16, v228
    v_and_b32 v29, 0xffff0000, v228
    v_lshlrev_b32 v238, 16, v246
    v_and_b32 v239, 0xffff0000, v246
    v_pk_add_f32 v[28:29], v[28:29], v[238:239]
    v_lshlrev_b32 v30, 16, v229
    v_and_b32 v31, 0xffff0000, v229
    v_lshlrev_b32 v238, 16, v247
    v_and_b32 v239, 0xffff0000, v247
    v_pk_add_f32 v[30:31], v[30:31], v[238:239]
    buffer_load_dwordx4 v[128:131], v4, s[40:43], s56 offen offset:2048 sc1
    buffer_load_dwordx4 v[132:135], v4, s[40:43], s57 offen offset:2048 sc1
    buffer_load_dwordx4 v[136:139], v4, s[40:43], s56 offen offset:3072 sc1
    buffer_load_dwordx4 v[140:143], v4, s[40:43], s57 offen offset:3072 sc1
    s_waitcnt vmcnt(15)
    v_mfma_f32_32x32x16_bf16 v[16:31], a[128:131], v[80:83], v[16:31]
    s_waitcnt vmcnt(14)
    v_mfma_f32_32x32x16_bf16 v[32:47], a[128:131], v[84:87], 0
    v_mfma_f32_32x32x16_bf16 v[48:63], a[132:135], v[80:83], 0
    v_mfma_f32_32x32x16_bf16 v[64:79], a[132:135], v[84:87], 0
    ds_read_b64_tr_b16 a[16:17], v217 offset:0
    ds_read_b64_tr_b16 a[18:19], v217 offset:1024
    ds_read_b64_tr_b16 a[20:21], v218 offset:0
    ds_read_b64_tr_b16 a[22:23], v218 offset:1024
    s_add_u32 s56, s71, s50
    s_add_u32 s57, s72, s50
    buffer_load_dwordx4 v[144:147], v4, s[40:43], s56 offen offset:0 sc1
    buffer_load_dwordx4 v[148:151], v4, s[40:43], s57 offen offset:0 sc1
    buffer_load_dwordx4 v[152:155], v4, s[40:43], s56 offen offset:1024 sc1
    buffer_load_dwordx4 v[156:159], v4, s[40:43], s57 offen offset:1024 sc1
    s_waitcnt vmcnt(17)
    v_mfma_f32_32x32x16_bf16 v[16:31], a[136:139], v[88:91], v[16:31]
    s_waitcnt vmcnt(16)
    v_mfma_f32_32x32x16_bf16 v[32:47], a[136:139], v[92:95], v[32:47]
    v_mfma_f32_32x32x16_bf16 v[48:63], a[140:143], v[88:91], v[48:63]
    v_mfma_f32_32x32x16_bf16 v[64:79], a[140:143], v[92:95], v[64:79]
    ds_read_b64_tr_b16 a[24:25], v217 offset:2048
    ds_read_b64_tr_b16 a[26:27], v217 offset:3072
    ds_read_b64_tr_b16 a[28:29], v218 offset:2048
    ds_read_b64_tr_b16 a[30:31], v218 offset:3072
    buffer_load_dwordx4 v[160:163], v4, s[40:43], s56 offen offset:2048 sc1
    buffer_load_dwordx4 v[164:167], v4, s[40:43], s57 offen offset:2048 sc1
    buffer_load_dwordx4 v[168:171], v4, s[40:43], s56 offen offset:3072 sc1
    buffer_load_dwordx4 v[172:175], v4, s[40:43], s57 offen offset:3072 sc1
    s_waitcnt vmcnt(19)
    v_mfma_f32_32x32x16_bf16 v[16:31], a[144:147], v[96:99], v[16:31]
    s_waitcnt vmcnt(18)
    v_mfma_f32_32x32x16_bf16 v[32:47], a[144:147], v[100:103], v[32:47]
    v_mfma_f32_32x32x16_bf16 v[48:63], a[148:151], v[96:99], v[48:63]
    v_mfma_f32_32x32x16_bf16 v[64:79], a[148:151], v[100:103], v[64:79]
    ds_read_b64_tr_b16 a[32:33], v217 offset:4096
    ds_read_b64_tr_b16 a[34:35], v217 offset:5120
    ds_read_b64_tr_b16 a[36:37], v218 offset:4096
    ds_read_b64_tr_b16 a[38:39], v218 offset:5120
    s_add_u32 s56, s71, s51
    s_add_u32 s57, s72, s51
    buffer_load_dwordx4 v[176:179], v4, s[40:43], s56 offen offset:0 sc1
    buffer_load_dwordx4 v[180:183], v4, s[40:43], s57 offen offset:0 sc1
    buffer_load_dwordx4 v[184:187], v4, s[40:43], s56 offen offset:1024 sc1
    buffer_load_dwordx4 v[188:191], v4, s[40:43], s57 offen offset:1024 sc1
    s_waitcnt vmcnt(21)
    v_mfma_f32_32x32x16_bf16 v[16:31], a[152:155], v[104:107], v[16:31]
    s_waitcnt vmcnt(20)
    v_mfma_f32_32x32x16_bf16 v[32:47], a[152:155], v[108:111], v[32:47]
    v_mfma_f32_32x32x16_bf16 v[48:63], a[156:159], v[104:107], v[48:63]
    v_mfma_f32_32x32x16_bf16 v[64:79], a[156:159], v[108:111], v[64:79]
    ds_read_b64_tr_b16 a[40:41], v217 offset:6144
    ds_read_b64_tr_b16 a[42:43], v217 offset:7168
    ds_read_b64_tr_b16 a[44:45], v218 offset:6144
    ds_read_b64_tr_b16 a[46:47], v218 offset:7168
    buffer_load_dwordx4 v[192:195], v4, s[40:43], s56 offen offset:2048 sc1
    buffer_load_dwordx4 v[196:199], v4, s[40:43], s57 offen offset:2048 sc1
    buffer_load_dwordx4 v[200:203], v4, s[40:43], s56 offen offset:3072 sc1
    buffer_load_dwordx4 v[204:207], v4, s[40:43], s57 offen offset:3072 sc1
    s_waitcnt vmcnt(23)
    v_mfma_f32_32x32x16_bf16 v[16:31], a[160:163], v[112:115], v[16:31]
    s_waitcnt vmcnt(22)
    v_mfma_f32_32x32x16_bf16 v[32:47], a[160:163], v[116:119], v[32:47]
    v_mfma_f32_32x32x16_bf16 v[48:63], a[164:167], v[112:115], v[48:63]
    v_mfma_f32_32x32x16_bf16 v[64:79], a[164:167], v[116:119], v[64:79]
    ds_read_b64_tr_b16 a[48:49], v217 offset:8192
    ds_read_b64_tr_b16 a[50:51], v217 offset:9216
    ds_read_b64_tr_b16 a[52:53], v218 offset:8192
    ds_read_b64_tr_b16 a[54:55], v218 offset:9216
    s_add_u32 s56, s71, s52
    s_add_u32 s57, s72, s52
    buffer_load_dwordx4 v[80:83], v4, s[40:43], s56 offen offset:0 sc1
    buffer_load_dwordx4 v[84:87], v4, s[40:43], s57 offen offset:0 sc1
    buffer_load_dwordx4 v[88:91], v4, s[40:43], s56 offen offset:1024 sc1
    buffer_load_dwordx4 v[92:95], v4, s[40:43], s57 offen offset:1024 sc1
    s_waitcnt vmcnt(25)
    v_mfma_f32_32x32x16_bf16 v[16:31], a[168:171], v[120:123], v[16:31]
    s_waitcnt vmcnt(24)
    v_mfma_f32_32x32x16_bf16 v[32:47], a[168:171], v[124:127], v[32:47]
    v_mfma_f32_32x32x16_bf16 v[48:63], a[172:175], v[120:123], v[48:63]
    v_mfma_f32_32x32x16_bf16 v[64:79], a[172:175], v[124:127], v[64:79]
    ds_read_b64_tr_b16 a[56:57], v217 offset:10240
    ds_read_b64_tr_b16 a[58:59], v217 offset:11264
    ds_read_b64_tr_b16 a[60:61], v218 offset:10240
    ds_read_b64_tr_b16 a[62:63], v218 offset:11264
    buffer_load_dwordx4 v[96:99], v4, s[40:43], s56 offen offset:2048 sc1
    buffer_load_dwordx4 v[100:103], v4, s[40:43], s57 offen offset:2048 sc1
    buffer_load_dwordx4 v[104:107], v4, s[40:43], s56 offen offset:3072 sc1
    buffer_load_dwordx4 v[108:111], v4, s[40:43], s57 offen offset:3072 sc1
    s_waitcnt vmcnt(27)
    v_mfma_f32_32x32x16_bf16 v[16:31], a[176:179], v[128:131], v[16:31]
    s_waitcnt vmcnt(26)
    v_mfma_f32_32x32x16_bf16 v[32:47], a[176:179], v[132:135], v[32:47]
    v_mfma_f32_32x32x16_bf16 v[48:63], a[180:183], v[128:131], v[48:63]
    v_mfma_f32_32x32x16_bf16 v[64:79], a[180:183], v[132:135], v[64:79]
    ds_read_b64_tr_b16 a[64:65], v217 offset:12288
    ds_read_b64_tr_b16 a[66:67], v217 offset:13312
    ds_read_b64_tr_b16 a[68:69], v218 offset:12288
    ds_read_b64_tr_b16 a[70:71], v218 offset:13312
    s_add_u32 s56, s71, s53
    s_add_u32 s57, s72, s53
    buffer_load_dwordx4 v[112:115], v4, s[40:43], s56 offen offset:0 sc1
    buffer_load_dwordx4 v[116:119], v4, s[40:43], s57 offen offset:0 sc1
    buffer_load_dwordx4 v[120:123], v4, s[40:43], s56 offen offset:1024 sc1
    buffer_load_dwordx4 v[124:127], v4, s[40:43], s57 offen offset:1024 sc1
    s_waitcnt vmcnt(29)
    v_mfma_f32_32x32x16_bf16 v[16:31], a[184:187], v[136:139], v[16:31]
    s_waitcnt vmcnt(28)
    v_mfma_f32_32x32x16_bf16 v[32:47], a[184:187], v[140:143], v[32:47]
    v_mfma_f32_32x32x16_bf16 v[48:63], a[188:191], v[136:139], v[48:63]
    v_mfma_f32_32x32x16_bf16 v[64:79], a[188:191], v[140:143], v[64:79]
    ds_read_b64_tr_b16 a[72:73], v217 offset:14336
    ds_read_b64_tr_b16 a[74:75], v217 offset:15360
    ds_read_b64_tr_b16 a[76:77], v218 offset:14336
    ds_read_b64_tr_b16 a[78:79], v218 offset:15360
    buffer_load_dwordx4 v[128:131], v4, s[40:43], s56 offen offset:2048 sc1
    buffer_load_dwordx4 v[132:135], v4, s[40:43], s57 offen offset:2048 sc1
    buffer_load_dwordx4 v[136:139], v4, s[40:43], s56 offen offset:3072 sc1
    buffer_load_dwordx4 v[140:143], v4, s[40:43], s57 offen offset:3072 sc1
    s_waitcnt vmcnt(31)
    v_mfma_f32_32x32x16_bf16 v[16:31], a[192:195], v[144:147], v[16:31]
    s_waitcnt vmcnt(30)
    v_mfma_f32_32x32x16_bf16 v[32:47], a[192:195], v[148:151], v[32:47]
    v_mfma_f32_32x32x16_bf16 v[48:63], a[196:199], v[144:147], v[48:63]
    v_mfma_f32_32x32x16_bf16 v[64:79], a[196:199], v[148:151], v[64:79]
    ds_read_b64_tr_b16 a[80:81], v217 offset:16384
    ds_read_b64_tr_b16 a[82:83], v217 offset:17408
    ds_read_b64_tr_b16 a[84:85], v218 offset:16384
    ds_read_b64_tr_b16 a[86:87], v218 offset:17408
    s_add_u32 s56, s71, s54
    s_add_u32 s57, s72, s54
    buffer_load_dwordx4 v[144:147], v4, s[40:43], s56 offen offset:0 sc1
    buffer_load_dwordx4 v[148:151], v4, s[40:43], s57 offen offset:0 sc1
    s_waitcnt vmcnt(31)
    v_mfma_f32_32x32x16_bf16 v[16:31], a[200:203], v[152:155], v[16:31]
    s_waitcnt vmcnt(30)
    v_mfma_f32_32x32x16_bf16 v[32:47], a[200:203], v[156:159], v[32:47]
    v_mfma_f32_32x32x16_bf16 v[48:63], a[204:207], v[152:155], v[48:63]
    v_mfma_f32_32x32x16_bf16 v[64:79], a[204:207], v[156:159], v[64:79]
    ds_read_b64_tr_b16 a[88:89], v217 offset:18432
    ds_read_b64_tr_b16 a[90:91], v217 offset:19456
    ds_read_b64_tr_b16 a[92:93], v218 offset:18432
    ds_read_b64_tr_b16 a[94:95], v218 offset:19456
    buffer_load_dwordx4 v[152:155], v4, s[40:43], s56 offen offset:1024 sc1
    buffer_load_dwordx4 v[156:159], v4, s[40:43], s57 offen offset:1024 sc1
    s_waitcnt vmcnt(31)
    v_mfma_f32_32x32x16_bf16 v[16:31], a[208:211], v[160:163], v[16:31]
    s_waitcnt vmcnt(30)
    v_mfma_f32_32x32x16_bf16 v[32:47], a[208:211], v[164:167], v[32:47]
    v_mfma_f32_32x32x16_bf16 v[48:63], a[212:215], v[160:163], v[48:63]
    v_mfma_f32_32x32x16_bf16 v[64:79], a[212:215], v[164:167], v[64:79]
    buffer_load_dwordx4 v[160:163], v4, s[40:43], s56 offen offset:2048 sc1
    buffer_load_dwordx4 v[164:167], v4, s[40:43], s57 offen offset:2048 sc1
    s_waitcnt vmcnt(31)
    v_mfma_f32_32x32x16_bf16 v[16:31], a[216:219], v[168:171], v[16:31]
    s_waitcnt vmcnt(30)
    v_mfma_f32_32x32x16_bf16 v[32:47], a[216:219], v[172:175], v[32:47]
    v_mfma_f32_32x32x16_bf16 v[48:63], a[220:223], v[168:171], v[48:63]
    v_mfma_f32_32x32x16_bf16 v[64:79], a[220:223], v[172:175], v[64:79]
    buffer_load_dwordx4 v[168:171], v4, s[40:43], s56 offen offset:3072 sc1
    buffer_load_dwordx4 v[172:175], v4, s[40:43], s57 offen offset:3072 sc1
    s_waitcnt vmcnt(31)
    v_mfma_f32_32x32x16_bf16 v[16:31], a[224:227], v[176:179], v[16:31]
    s_waitcnt vmcnt(30)
    v_mfma_f32_32x32x16_bf16 v[32:47], a[224:227], v[180:183], v[32:47]
    v_mfma_f32_32x32x16_bf16 v[48:63], a[228:231], v[176:179], v[48:63]
    v_mfma_f32_32x32x16_bf16 v[64:79], a[228:231], v[180:183], v[64:79]
    s_waitcnt vmcnt(29)
    v_mfma_f32_32x32x16_bf16 v[16:31], a[232:235], v[184:187], v[16:31]
    s_waitcnt vmcnt(28)
    v_mfma_f32_32x32x16_bf16 v[32:47], a[232:235], v[188:191], v[32:47]
    v_mfma_f32_32x32x16_bf16 v[48:63], a[236:239], v[184:187], v[48:63]
    v_mfma_f32_32x32x16_bf16 v[64:79], a[236:239], v[188:191], v[64:79]
    s_waitcnt vmcnt(27) lgkmcnt(15)
    v_mfma_f32_32x32x16_bf16 v[16:31], a[240:243], v[192:195], v[16:31]
    s_waitcnt vmcnt(26)
    v_mfma_f32_32x32x16_bf16 v[32:47], a[240:243], v[196:199], v[32:47]
    v_mfma_f32_32x32x16_bf16 v[48:63], a[244:247], v[192:195], v[48:63]
    v_mfma_f32_32x32x16_bf16 v[64:79], a[244:247], v[196:199], v[64:79]
    s_waitcnt vmcnt(25)
    v_mfma_f32_32x32x16_bf16 v[16:31], a[248:251], v[200:203], v[16:31]
    s_waitcnt vmcnt(24)
    v_mfma_f32_32x32x16_bf16 v[32:47], a[248:251], v[204:207], v[32:47]
    v_mfma_f32_32x32x16_bf16 v[48:63], a[252:255], v[200:203], v[48:63]
    v_mfma_f32_32x32x16_bf16 v[64:79], a[252:255], v[204:207], v[64:79]
    s_waitcnt vmcnt(23)
    v_mfma_f32_32x32x16_bf16 v[16:31], a[0:3], v[80:83], v[16:31]
    s_waitcnt vmcnt(22)
    v_mfma_f32_32x32x16_bf16 v[32:47], a[0:3], v[84:87], v[32:47]
    v_mfma_f32_32x32x16_bf16 v[48:63], a[4:7], v[80:83], v[48:63]
    v_mfma_f32_32x32x16_bf16 v[64:79], a[4:7], v[84:87], v[64:79]
    s_waitcnt vmcnt(21)
    v_mfma_f32_32x32x16_bf16 v[16:31], a[8:11], v[88:91], v[16:31]
    s_waitcnt vmcnt(20)
    v_mfma_f32_32x32x16_bf16 v[32:47], a[8:11], v[92:95], v[32:47]
    v_mfma_f32_32x32x16_bf16 v[48:63], a[12:15], v[88:91], v[48:63]
    v_mfma_f32_32x32x16_bf16 v[64:79], a[12:15], v[92:95], v[64:79]
    v_lshrrev_b32 v220, 5, v1
    v_lshlrev_b32 v220, 10, v220
    v_and_b32 v221, 31, v1
    v_lshl_add_u32 v220, v221, 2, v220
    s_lshr_b32 s69, s3, 1
    s_lshl_b32 s68, s69, 13
    s_and_b32 s69, s3, 1
    s_lshl_b32 s69, s69, 7
    s_add_u32 s68, s68, s69
    v_add_u32 v220, s68, v220
    v_xor_b32 v221, 128, v220
    v_xor_b32 v222, 0x2000, v220
    v_xor_b32 v223, 0x2080, v220
    s_mul_i32 s68, s3, 36864
    s_add_u32 s68, s68, 12288
    v_add_u32 v220, s68, v220
    v_add_u32 v221, s68, v221
    v_add_u32 v222, s68, v222
    v_add_u32 v223, s68, v223
    s_lshl_b32 s68, s3, 12
    s_add_u32 s68, s68, 12288
    v_add_u32 v224, s68, v4
    v_add_u32 v226, 73728, v224
    v_mul_u32_u24 v225, 896, v3
    v_lshl_add_u32 v225, v2, 3, v225
    s_lshl_b32 s68, s67, 2
    s_add_u32 s68, s68, s3
    s_mul_i32 s68, s68, 14336
    s_lshl_b32 s69, s66, 7
    s_add_u32 s68, s68, s69
    s_add_u32 s69, s68, 7168
    s_waitcnt vmcnt(19)
    v_mfma_f32_32x32x16_bf16 v[16:31], a[16:19], v[96:99], v[16:31]
    s_waitcnt vmcnt(18)
    v_mfma_f32_32x32x16_bf16 v[32:47], a[16:19], v[100:103], v[32:47]
    v_mfma_f32_32x32x16_bf16 v[48:63], a[20:23], v[96:99], v[48:63]
    v_mfma_f32_32x32x16_bf16 v[64:79], a[20:23], v[100:103], v[64:79]
    s_waitcnt vmcnt(17)
    v_mfma_f32_32x32x16_bf16 v[16:31], a[24:27], v[104:107], v[16:31]
    s_waitcnt vmcnt(16)
    v_mfma_f32_32x32x16_bf16 v[32:47], a[24:27], v[108:111], v[32:47]
    v_mfma_f32_32x32x16_bf16 v[48:63], a[28:31], v[104:107], v[48:63]
    v_mfma_f32_32x32x16_bf16 v[64:79], a[28:31], v[108:111], v[64:79]
    s_waitcnt vmcnt(15)
    v_mfma_f32_32x32x16_bf16 v[16:31], a[32:35], v[112:115], v[16:31]
    s_waitcnt vmcnt(14)
    v_mfma_f32_32x32x16_bf16 v[32:47], a[32:35], v[116:119], v[32:47]
    v_mfma_f32_32x32x16_bf16 v[48:63], a[36:39], v[112:115], v[48:63]
    v_mfma_f32_32x32x16_bf16 v[64:79], a[36:39], v[116:119], v[64:79]
    s_waitcnt vmcnt(13)
    v_mfma_f32_32x32x16_bf16 v[16:31], a[40:43], v[120:123], v[16:31]
    s_waitcnt vmcnt(12)
    v_mfma_f32_32x32x16_bf16 v[32:47], a[40:43], v[124:127], v[32:47]
    v_mfma_f32_32x32x16_bf16 v[48:63], a[44:47], v[120:123], v[48:63]
    v_mfma_f32_32x32x16_bf16 v[64:79], a[44:47], v[124:127], v[64:79]
    s_waitcnt vmcnt(11)
    v_mfma_f32_32x32x16_bf16 v[16:31], a[48:51], v[128:131], v[16:31]
    s_waitcnt vmcnt(10)
    v_mfma_f32_32x32x16_bf16 v[32:47], a[48:51], v[132:135], v[32:47]
    v_mfma_f32_32x32x16_bf16 v[48:63], a[52:55], v[128:131], v[48:63]
    v_mfma_f32_32x32x16_bf16 v[64:79], a[52:55], v[132:135], v[64:79]
    s_waitcnt vmcnt(9)
    v_mfma_f32_32x32x16_bf16 v[16:31], a[56:59], v[136:139], v[16:31]
    s_waitcnt vmcnt(8)
    v_mfma_f32_32x32x16_bf16 v[32:47], a[56:59], v[140:143], v[32:47]
    v_mfma_f32_32x32x16_bf16 v[48:63], a[60:63], v[136:139], v[48:63]
    v_mfma_f32_32x32x16_bf16 v[64:79], a[60:63], v[140:143], v[64:79]
    s_waitcnt vmcnt(6) lgkmcnt(12)
    v_mfma_f32_32x32x16_bf16 v[64:79], a[68:71], v[148:151], v[64:79]
    s_waitcnt vmcnt(4) lgkmcnt(8)
    v_mfma_f32_32x32x16_bf16 v[64:79], a[76:79], v[156:159], v[64:79]
    s_waitcnt vmcnt(2) lgkmcnt(4)
    v_mfma_f32_32x32x16_bf16 v[64:79], a[84:87], v[164:167], v[64:79]
    s_waitcnt vmcnt(0) lgkmcnt(0)
    v_mfma_f32_32x32x16_bf16 v[64:79], a[92:95], v[172:175], v[64:79]
    v_mfma_f32_32x32x16_bf16 v[48:63], a[68:71], v[144:147], v[48:63]
    v_mfma_f32_32x32x16_bf16 v[48:63], a[76:79], v[152:155], v[48:63]
    s_nop 9
    ds_write2st64_b32 v223, v64, v65 offset0:0 offset1:1
    ds_write2st64_b32 v223, v66, v67 offset0:2 offset1:3
    ds_write2st64_b32 v223, v68, v69 offset0:8 offset1:9
    v_mfma_f32_32x32x16_bf16 v[48:63], a[84:87], v[160:163], v[48:63]
    ds_write2st64_b32 v223, v70, v71 offset0:10 offset1:11
    ds_write2st64_b32 v223, v72, v73 offset0:16 offset1:17
    ds_write2st64_b32 v223, v74, v75 offset0:18 offset1:19
    v_mfma_f32_32x32x16_bf16 v[48:63], a[92:95], v[168:171], v[48:63]
    ds_write2st64_b32 v223, v76, v77 offset0:24 offset1:25
    ds_write2st64_b32 v223, v78, v79 offset0:26 offset1:27
    v_mfma_f32_32x32x16_bf16 v[32:47], a[64:67], v[148:151], v[32:47]
    v_mfma_f32_32x32x16_bf16 v[32:47], a[72:75], v[156:159], v[32:47]
    s_nop 7
    ds_write2st64_b32 v222, v48, v49 offset0:0 offset1:1
    ds_write2st64_b32 v222, v50, v51 offset0:2 offset1:3
    ds_write2st64_b32 v222, v52, v53 offset0:8 offset1:9
    v_mfma_f32_32x32x16_bf16 v[32:47], a[80:83], v[164:167], v[32:47]
    ds_write2st64_b32 v222, v54, v55 offset0:10 offset1:11
    ds_write2st64_b32 v222, v56, v57 offset0:16 offset1:17
    ds_write2st64_b32 v222, v58, v59 offset0:18 offset1:19
    v_mfma_f32_32x32x16_bf16 v[32:47], a[88:91], v[172:175], v[32:47]
    ds_write2st64_b32 v222, v60, v61 offset0:24 offset1:25
    ds_write2st64_b32 v222, v62, v63 offset0:26 offset1:27
    v_mfma_f32_32x32x16_bf16 v[16:31], a[64:67], v[144:147], v[16:31]
    v_mfma_f32_32x32x16_bf16 v[16:31], a[72:75], v[152:155], v[16:31]
    s_nop 7
    ds_write2st64_b32 v221, v32, v33 offset0:0 offset1:1
    ds_write2st64_b32 v221, v34, v35 offset0:2 offset1:3
    ds_write2st64_b32 v221, v36, v37 offset0:8 offset1:9
    v_mfma_f32_32x32x16_bf16 v[16:31], a[80:83], v[160:163], v[16:31]
    ds_write2st64_b32 v221, v38, v39 offset0:10 offset1:11
    ds_write2st64_b32 v221, v40, v41 offset0:16 offset1:17
    ds_write2st64_b32 v221, v42, v43 offset0:18 offset1:19
    v_mfma_f32_32x32x16_bf16 v[16:31], a[88:91], v[168:171], v[16:31]
    ds_write2st64_b32 v221, v44, v45 offset0:24 offset1:25
    ds_write2st64_b32 v221, v46, v47 offset0:26 offset1:27
    s_nop 9
    ds_write2st64_b32 v220, v16, v17 offset0:0 offset1:1
    ds_write2st64_b32 v220, v18, v19 offset0:2 offset1:3
    ds_write2st64_b32 v220, v20, v21 offset0:8 offset1:9
    ds_write2st64_b32 v220, v22, v23 offset0:10 offset1:11
    ds_write2st64_b32 v220, v24, v25 offset0:16 offset1:17
    ds_write2st64_b32 v220, v26, v27 offset0:18 offset1:19
    ds_write2st64_b32 v220, v28, v29 offset0:24 offset1:25
    ds_write2st64_b32 v220, v30, v31 offset0:26 offset1:27
    s_waitcnt lgkmcnt(0)
    s_barrier
    ds_read_b128 v[16:19], v224 offset:0
    ds_read_b128 v[20:23], v224 offset:36864
    ds_read_b128 v[24:27], v226 offset:0
    ds_read_b128 v[28:31], v226 offset:36864
    ds_read_b128 v[32:35], v224 offset:1024
    ds_read_b128 v[36:39], v224 offset:37888
    ds_read_b128 v[40:43], v226 offset:1024
    ds_read_b128 v[44:47], v226 offset:37888
    ds_read_b128 v[48:51], v224 offset:2048
    ds_read_b128 v[52:55], v224 offset:38912
    ds_read_b128 v[56:59], v226 offset:2048
    ds_read_b128 v[60:63], v226 offset:38912
    ds_read_b128 v[64:67], v224 offset:3072
    ds_read_b128 v[68:71], v224 offset:39936
    ds_read_b128 v[72:75], v226 offset:3072
    ds_read_b128 v[76:79], v226 offset:39936
    s_waitcnt lgkmcnt(14)
    v_pk_add_f32 v[16:17], v[16:17], v[20:21]
    s_waitcnt lgkmcnt(12)
    v_pk_add_f32 v[24:25], v[24:25], v[28:29]
    v_pk_add_f32 v[18:19], v[18:19], v[22:23]
    v_pk_add_f32 v[26:27], v[26:27], v[30:31]
    v_pk_add_f32 v[16:17], v[16:17], v[24:25]
    v_pk_add_f32 v[18:19], v[18:19], v[26:27]
    v_cvt_pk_bf16_f32 v20, v16, v17
    v_cvt_pk_bf16_f32 v21, v18, v19
    buffer_store_dwordx2 v[20:21], v225, s[36:39], s68 offen offset:0
    s_waitcnt lgkmcnt(10)
    v_pk_add_f32 v[32:33], v[32:33], v[36:37]
    s_waitcnt lgkmcnt(8)
    v_pk_add_f32 v[40:41], v[40:41], v[44:45]
    v_pk_add_f32 v[34:35], v[34:35], v[38:39]
    v_pk_add_f32 v[42:43], v[42:43], v[46:47]
    v_pk_add_f32 v[32:33], v[32:33], v[40:41]
    v_pk_add_f32 v[34:35], v[34:35], v[42:43]
    v_cvt_pk_bf16_f32 v36, v32, v33
    v_cvt_pk_bf16_f32 v37, v34, v35
    buffer_store_dwordx2 v[36:37], v225, s[36:39], s68 offen offset:3584
    s_waitcnt lgkmcnt(6)
    v_pk_add_f32 v[48:49], v[48:49], v[52:53]
    s_waitcnt lgkmcnt(4)
    v_pk_add_f32 v[56:57], v[56:57], v[60:61]
    v_pk_add_f32 v[50:51], v[50:51], v[54:55]
    v_pk_add_f32 v[58:59], v[58:59], v[62:63]
    v_pk_add_f32 v[48:49], v[48:49], v[56:57]
    v_pk_add_f32 v[50:51], v[50:51], v[58:59]
    v_cvt_pk_bf16_f32 v52, v48, v49
    v_cvt_pk_bf16_f32 v53, v50, v51
    buffer_store_dwordx2 v[52:53], v225, s[36:39], s69 offen offset:0
    s_waitcnt lgkmcnt(2)
    v_pk_add_f32 v[64:65], v[64:65], v[68:69]
    s_waitcnt lgkmcnt(0)
    v_pk_add_f32 v[72:73], v[72:73], v[76:77]
    v_pk_add_f32 v[66:67], v[66:67], v[70:71]
    v_pk_add_f32 v[74:75], v[74:75], v[78:79]
    v_pk_add_f32 v[64:65], v[64:65], v[72:73]
    v_pk_add_f32 v[66:67], v[66:67], v[74:75]
    v_cvt_pk_bf16_f32 v68, v64, v65
    v_cvt_pk_bf16_f32 v69, v66, v67
    buffer_store_dwordx2 v[68:69], v225, s[36:39], s69 offen offset:3584
L_end_P:
    s_endpgm

.section .rodata,"a"
.p2align 6
.amdhsa_kernel sequential_preLN__sliding_local_dilated__mixer_token_mlp__prompt_kernel
  .amdhsa_next_free_vgpr 508
  .amdhsa_next_free_sgpr 102
  .amdhsa_accum_offset 252
  .amdhsa_group_segment_fixed_size 0
  .amdhsa_kernarg_size 88
  .amdhsa_user_sgpr_count 2
  .amdhsa_user_sgpr_kernarg_segment_ptr 1
  .amdhsa_system_sgpr_workgroup_id_x 1
.end_amdhsa_kernel
```

```asm
; @launch grid=(256,1,1) block=(256,1,1) lds=163840
.amdgcn_target "amdgcn-amd-amdhsa--gfx950"
.text
.globl sequential_preLN__sliding_local_dilated__mixer_token_mlp__prompt_kernel
.p2align 8
.type sequential_preLN__sliding_local_dilated__mixer_token_mlp__prompt_kernel,@function
sequential_preLN__sliding_local_dilated__mixer_token_mlp__prompt_kernel:
    s_cmp_ge_u32 s2, 256
    s_cbranch_scc1 L_end_P
    s_load_dwordx2 s[8:9], s[0:1], 0
    s_load_dwordx2 s[12:13], s[0:1], 8
    s_load_dwordx2 s[44:45], s[0:1], 72
    s_load_dwordx2 s[40:41], s[0:1], 80
    s_load_dwordx2 s[16:17], s[0:1], 16
    s_load_dwordx2 s[20:21], s[0:1], 32
    s_load_dwordx2 s[24:25], s[0:1], 48
    s_load_dwordx2 s[28:29], s[0:1], 40
    s_load_dwordx2 s[32:33], s[0:1], 56
    s_load_dwordx2 s[36:37], s[0:1], 64
    v_lshrrev_b32 v1, 6, v0
    s_nop 0
    v_readfirstlane_b32 s3, v1
    v_and_b32 v1, 63, v0
    v_and_b32 v2, 15, v0
    v_lshrrev_b32 v3, 4, v1
    v_lshlrev_b32 v4, 4, v1
    s_mov_b32 s10, 0x1c0000
    s_mov_b32 s11, 0x00020000
    s_mov_b32 s14, 0x126000
    s_mov_b32 s15, 0x00020000
    s_mov_b32 s46, 0x100
    s_mov_b32 s47, 0x00020000
    s_mov_b32 s42, 0x5c0000
    s_mov_b32 s43, 0x00020000
    s_mov_b32 s18, 0x62000
    s_mov_b32 s19, 0x00020000
    s_mov_b32 s22, 0x700000
    s_mov_b32 s23, 0x00020000
    s_mov_b32 s26, 0x700000
    s_mov_b32 s27, 0x00020000
    s_mov_b32 s30, 0xe00
    s_mov_b32 s31, 0x00020000
    s_mov_b32 s34, 0x1000
    s_mov_b32 s35, 0x00020000
    s_mov_b32 s38, 0x1c0000
    s_mov_b32 s39, 0x00020000
    s_mov_b32 s5, 0x3f803f80
    s_mov_b32 s6, 0x40000
    s_bfe_u32 s48, s2, 0x20001
    s_lshl_b32 s48, s48, 2
    s_lshr_b32 s53, s2, 6
    s_add_u32 s48, s48, s53
    s_bfe_u32 s49, s2, 0x30003
    s_and_b32 s53, s2, 1
    s_lshl_b32 s53, s53, 3
    s_add_u32 s49, s49, s53
    v_lshrrev_b32 v237, 2, v1
    v_mul_u32_u24 v123, 2688, v237
    v_lshrrev_b32 v237, 5, v1
    v_lshlrev_b32 v237, 1, v237
    v_and_b32 v238, 3, v1
    v_xor_b32 v237, v237, v238
    v_lshl_add_u32 v123, v237, 4, v123
    s_mul_i32 s53, s49, 56
    s_min_u32 s53, s53, 832
    s_mul_i32 s51, s3, 43008
    s_add_u32 s53, s53, s51
    v_add_u32 v123, s53, v123
    s_lshr_b32 s53, s3, 1
    s_mul_i32 s51, s53, 6144
    s_and_b32 s53, s3, 1
    s_lshl_b32 s53, s53, 10
    s_add_u32 s51, s51, s53
    v_lshrrev_b32 v237, 3, v1
    v_mul_u32_u24 v122, 896, v237
    v_and_b32 v237, 7, v1
    v_xor_b32 v237, v237, v3
    v_lshl_add_u32 v120, v237, 4, v122
    s_lshl_b32 s50, s48, 7
    s_lshl_b32 s53, s3, 5
    s_add_u32 s53, s53, s50
    s_mul_i32 s53, s53, 896
    v_xor_b32 v121, 64, v120
    v_add_u32 v120, s53, v120
    s_add_u32 s53, s53, 7168
    v_add_u32 v121, s53, v121
    s_lshl_b32 s53, s3, 1
    v_xor_b32 v237, s53, v237
    v_lshl_add_u32 v122, v237, 4, v122
    s_lshl_b32 s53, s3, 2
    s_add_u32 s53, s53, s50
    s_sub_u32 s53, s53, 16
    s_mul_i32 s53, s53, 896
    s_cmp_eq_u32 s48, 0
    s_cselect_b32 s53, 0x40000000, s53
    v_add_u32 v122, s53, v122
    s_lshl_b32 s52, s3, 12
    s_add_u32 s52, s52, 63488
    s_lshl_b32 s7, s3, 9
    s_cmp_eq_u32 s3, 0
    s_cselect_b32 s54, 0xffffff00, -1
    s_mov_b32 s55, 0
    s_memrealtime s[86:87]
    v_mov_b32 v7, 0
    s_waitcnt lgkmcnt(0)
    s_or_b32 s86, s86, 1
    v_mov_b32 v6, s86
    s_or_b32 s86, s2, s3
    s_cmp_eq_u32 s86, 0
    s_cselect_b64 exec, 1, 0
    buffer_store_dword v6, v7, s[44:47], 0 offen sc1
    s_mov_b64 exec, -1
    s_add_u32 m0, s51, 12288
    s_mov_b32 s73, 0
    buffer_load_dwordx4 v123, s[12:15], s73 offen lds
    s_add_u32 m0, s51, 14336
    s_mov_b32 s73, 896
    buffer_load_dwordx4 v123, s[12:15], s73 offen lds
    s_add_u32 m0, s51, 16384
    s_mov_b32 s73, 1792
    buffer_load_dwordx4 v123, s[12:15], s73 offen lds
    s_add_u32 m0, s52, 36864
    s_mov_b32 s73, 0
    buffer_load_dwordx4 v120, s[8:11], s73 offen lds
    s_add_u32 m0, s52, 37888
    s_mov_b32 s73, 0
    buffer_load_dwordx4 v121, s[8:11], s73 offen lds
    s_add_u32 m0, s52, 38912
    s_mov_b32 s73, 14336
    buffer_load_dwordx4 v120, s[8:11], s73 offen lds
    s_add_u32 m0, s52, 39936
    s_mov_b32 s73, 14336
    buffer_load_dwordx4 v121, s[8:11], s73 offen lds
    s_add_u32 m0, s7, 98304
    s_mov_b32 s73, 0
    s_mov_b64 exec, s[54:55]
    buffer_load_dwordx4 v122, s[8:11], s73 offen lds
    s_mov_b64 exec, -1
    s_bfe_u32 s53, s2, 0x30003
    s_add_u32 s86, s53, 1
    s_lshr_b32 s86, s86, 1
    s_lshr_b32 s87, s2, 6
    s_mul_i32 s87, s87, 5
    s_add_u32 s86, s86, s87
    s_lshl_b32 s86, s86, 2
    s_add_u32 s53, s86, s3
    s_mov_b32 s86, 0x2a54
    s_bitcmp1_b32 s86, s49
    s_cselect_b32 s79, 0x40000000, 0
    s_mul_i32 s86, s53, 48
    v_add_u32 v237, s86, v1
    v_mul_u32_u24 v238, 43691, v237
    v_lshrrev_b32 v238, 19, v238
    v_mul_u32_u24 v239, 12, v238
    v_sub_u32 v239, v237, v239
    v_lshrrev_b32 v239, 2, v239
    v_mul_u32_u24 v239, 896, v239
    v_mul_u32_u24 v238, 2688, v238
    v_and_b32 v237, 3, v237
    v_lshlrev_b32 v237, 7, v237
    v_add3_u32 v237, v237, v238, v239
    v_add_u32 v237, s79, v237
    s_and_b32 s86, s2, 1
    s_mul_i32 s86, s86, 384
    s_add_u32 s86, s86, 344064
    s_mov_b32 exec_hi, 0xffff
    buffer_load_dword v232, v237, s[12:15], s86 offen
    v_lshlrev_b32 v237, 7, v1
    v_add_u32 v238, s79, v237
    s_mul_i32 s86, s53, 6016
    s_bfe_u32 s87, s2, 0x20001
    s_mul_i32 s87, s87, 458752
    s_add_u32 s86, s86, s87
    s_max_u32 s86, s86, 14336
    s_sub_u32 s86, s86, 14336
    s_mov_b32 exec_hi, 0x7fff
    buffer_load_dword v233, v238, s[8:11], s86 offen
    s_getpc_b64 s[86:87]
Lpc_P:
    s_mul_i32 s53, s53, 384
    v_add_u32 v237, s53, v237
    v_min_u32 v237, L_end_P-Lpc_P, v237
    s_mov_b64 exec, 7
    global_load_dword v236, v237, s[86:87]
    s_mov_b64 exec, -1
    v_mul_u32_u24 v237, 18432, v3
    v_lshl_add_u32 v237, v2, 3, v237
    v_mov_b32 v238, s5
    v_add_u32 v237, 61440, v237
    ds_write2_b32 v237, v238, v238 offset0:0 offset1:1
    s_lshr_b32 s68, s2, 3
    s_mul_i32 s69, s68, 37
    s_lshr_b32 s69, s69, 8
    s_mul_i32 s64, s69, 7
    s_sub_u32 s64, s68, s64
    s_mov_b32 s66, s64
    s_and_b32 s68, s2, 7
    s_lshl_b32 s67, s68, 2
    s_add_u32 s67, s67, s69
    s_cmp_ge_u32 s69, 4
    s_cselect_b32 s67, 99, s67
    s_mul_i32 s71, s68, 3
    s_add_u32 s71, s71, 4
    s_lshl_b32 s72, s68, 2
    s_cmp_lt_u32 s68, 4
    s_cselect_b32 s65, s72, s71
    s_cselect_b32 s71, 4, 3
    s_add_u32 s65, s65, s69
    s_cmp_ge_u32 s69, s71
    s_cselect_b32 s65, 99, s65
    v_lshrrev_b32 v219, 3, v1
    v_mul_u32_u24 v208, 896, v219
    v_and_b32 v219, 1, v3
    v_lshlrev_b32 v219, 2, v219
    v_and_b32 v220, 7, v1
    v_xor_b32 v219, v219, v220
    v_lshl_add_u32 v208, v219, 4, v208
    s_lshl_b32 s58, s66, 7
    s_mul_i32 s60, s3, 100352
    s_add_u32 s58, s58, s60
    v_add_u32 v208, s58, v208
    s_mul_i32 s59, s3, 14336
    s_add_u32 s59, s59, 106496
    v_lshrrev_b32 v219, 5, v1
    v_lshlrev_b32 v209, 9, v219
    v_bfe_u32 v219, v1, 2, 2
    v_lshl_add_u32 v209, v219, 7, v209
    v_lshrrev_b32 v219, 1, v219
    s_and_b32 s58, s3, 1
    v_xor_b32 v219, s58, v219
    v_lshl_add_u32 v209, v219, 6, v209
    v_and_b32 v219, 1, v3
    v_lshl_add_u32 v209, v219, 5, v209
    v_and_b32 v219, 3, v1
    v_lshl_add_u32 v209, v219, 3, v209
    v_add_u32 v209, 106496, v209
    s_mul_i32 s70, s3, 36864
    s_add_u32 s70, s70, 12288
    v_lshrrev_b32 v219, 3, v1
    v_mul_u32_u24 v213, 3584, v219
    v_and_b32 v219, 1, v3
    v_lshlrev_b32 v219, 2, v219
    v_and_b32 v220, 7, v1
    v_xor_b32 v219, v219, v220
    v_lshl_add_u32 v213, v219, 4, v213
    s_mul_i32 s68, s3, 1835008
    s_lshl_b32 s69, s65, 7
    s_add_u32 s68, s68, s69
    s_cmp_ge_u32 s65, 99
    s_cselect_b32 s68, 0x40000000, s68
    v_add_u32 v213, s68, v213
    s_cselect_b32 s68, 0x40000000, 0
    v_add_u32 v5, s68, v4
    v_lshrrev_b32 v219, 5, v1
    v_lshlrev_b32 v215, 9, v219
    v_bfe_u32 v219, v1, 2, 2
    v_lshl_add_u32 v215, v219, 7, v215
    v_lshrrev_b32 v219, 1, v219
    s_lshr_b32 s68, s3, 1
    v_xor_b32 v219, s68, v219
    v_lshl_add_u32 v215, v219, 6, v215
    v_and_b32 v219, 1, v3
    v_lshl_add_u32 v215, v219, 5, v215
    v_and_b32 v219, 3, v1
    v_lshl_add_u32 v215, v219, 3, v215
    v_add_u32 v215, s70, v215
    v_xor_b32 v216, 64, v215
    s_mul_i32 s70, s3, 36864
    s_add_u32 s70, s70, 12288
    v_lshrrev_b32 v219, 3, v1
    v_mul_u32_u24 v214, 4096, v219
    v_and_b32 v219, 1, v3
    v_lshlrev_b32 v219, 2, v219
    v_and_b32 v220, 7, v1
    v_xor_b32 v219, v219, v220
    v_lshl_add_u32 v214, v219, 4, v214
    s_mul_i32 s68, s3, 1835008
    s_lshl_b32 s69, s67, 7
    s_add_u32 s68, s68, s69
    s_cmp_ge_u32 s67, 99
    s_cselect_b32 s68, 0x40000000, s68
    v_add_u32 v214, s68, v214
    v_lshrrev_b32 v219, 5, v1
    v_lshlrev_b32 v217, 9, v219
    v_bfe_u32 v219, v1, 2, 2
    v_lshl_add_u32 v217, v219, 7, v217
    v_lshrrev_b32 v219, 1, v219
    s_lshr_b32 s68, s3, 1
    v_xor_b32 v219, s68, v219
    v_lshl_add_u32 v217, v219, 6, v217
    v_and_b32 v219, 1, v3
    v_lshl_add_u32 v217, v219, 5, v217
    v_and_b32 v219, 3, v1
    v_lshl_add_u32 v217, v219, 3, v217
    v_add_u32 v217, s70, v217
    v_xor_b32 v218, 64, v217
    s_and_b32 s68, s2, 7
    s_cmp_ge_u32 s68, 8
    s_cselect_b32 s94, 8, 0
    s_sub_u32 s68, s68, s94
    s_lshl_b32 s94, s68, 12
    s_add_u32 s68, s68, 1
    s_cmp_ge_u32 s68, 8
    s_cselect_b32 s95, 8, 0
    s_sub_u32 s68, s68, s95
    s_lshl_b32 s95, s68, 12
    s_add_u32 s68, s68, 1
    s_cmp_ge_u32 s68, 8
    s_cselect_b32 s96, 8, 0
    s_sub_u32 s68, s68, s96
    s_lshl_b32 s96, s68, 12
    s_add_u32 s68, s68, 1
    s_cmp_ge_u32 s68, 8
    s_cselect_b32 s97, 8, 0
    s_sub_u32 s68, s68, s97
    s_lshl_b32 s97, s68, 12
    s_add_u32 s68, s68, 1
    s_cmp_ge_u32 s68, 8
    s_cselect_b32 s98, 8, 0
    s_sub_u32 s68, s68, s98
    s_lshl_b32 s98, s68, 12
    s_add_u32 s68, s68, 1
    s_cmp_ge_u32 s68, 8
    s_cselect_b32 s99, 8, 0
    s_sub_u32 s68, s68, s99
    s_lshl_b32 s99, s68, 12
    s_add_u32 s68, s68, 1
    s_cmp_ge_u32 s68, 8
    s_cselect_b32 s100, 8, 0
    s_sub_u32 s68, s68, s100
    s_lshl_b32 s100, s68, 12
    s_add_u32 s68, s68, 1
    s_cmp_ge_u32 s68, 8
    s_cselect_b32 s101, 8, 0
    s_sub_u32 s68, s68, s101
    s_lshl_b32 s101, s68, 12
    s_lshl_b32 s80, s48, 2
    s_add_u32 s80, s80, s3
    s_lshl_b32 s80, s80, 11
    s_lshr_b32 s79, s49, 2
    s_lshl_b32 s79, s79, 7
    s_add_u32 s80, s80, s79
    s_and_b32 s79, s49, 3
    s_lshl_b32 s79, s79, 2
    s_add_u32 s80, s80, s79
    s_add_u32 s80, s80, 0x588000
    s_lshl_b32 s83, s67, 1
    s_lshr_b32 s79, s3, 1
    s_add_u32 s83, s83, s79
    s_lshl_b32 s83, s83, 11
    s_add_u32 s83, s83, 0x588000
    v_lshrrev_b32 v10, 2, v2
    v_lshlrev_b32 v10, 7, v10
    v_and_b32 v219, 3, v2
    v_lshl_add_u32 v10, v219, 2, v10
    s_lshl_b32 s84, s64, 12
    s_add_u32 s85, s84, 0x5b0000
    s_add_u32 s84, s84, 0x5a8000
    s_lshl_b32 s81, s67, 5
    s_add_u32 s81, s81, s3
    s_lshl_b32 s81, s81, 2
    s_add_u32 s81, s81, s84
    s_lshl_b32 s79, s3, 10
    s_add_u32 s84, s84, s79
    v_bfe_u32 v11, v1, 2, 3
    v_min_u32 v12, 6, v11
    v_and_b32 v219, 3, v1
    v_lshlrev_b32 v219, 2, v219
    v_lshl_add_u32 v11, v11, 7, v219
    v_lshl_add_u32 v12, v12, 7, v219
    s_lshl_b32 s82, s65, 5
    s_add_u32 s82, s82, s3
    s_lshl_b32 s82, s82, 2
    s_add_u32 s82, s82, s85
    s_mul_i32 s79, s3, 896
    s_add_u32 s85, s85, s79
    v_mov_b32 v9, 0
    v_lshlrev_b32 v124, 9, v3
    v_bfe_u32 v237, v1, 2, 2
    v_lshl_add_u32 v124, v237, 6, v124
    v_and_b32 v237, 3, v1
    v_lshl_add_u32 v124, v237, 3, v124
    v_and_b32 v237, 1, v3
    v_lshlrev_b32 v237, 5, v237
    v_add_u32 v124, v124, v237
    v_add_u32 v124, 12288, v124
    v_xor_b32 v125, 32, v124
    s_and_b32 s53, s3, 1
    s_lshl_b32 s53, s53, 5
    v_xor_b32 v127, s53, v124
    s_lshr_b32 s53, s3, 1
    s_lshl_b32 s53, s53, 11
    s_add_u32 s53, s53, 2048
    v_add_u32 v126, s53, v127
    v_lshrrev_b32 v237, 1, v2
    v_xor_b32 v237, v237, v3
    v_lshlrev_b32 v237, 4, v237
    v_lshl_add_u32 v237, v2, 7, v237
    v_add_u32 v130, 61440, v237
    v_xor_b32 v131, 64, v130
    v_add_u32 v128, s52, v237
    v_xor_b32 v129, 64, v128
    v_lshlrev_b32 v237, 2, v3
    v_sub_u32 v237, v2, v237
    v_mov_b32 v239, 0xf149f2ca
    v_add_u32 v238, 16, v237
    v_and_b32 v238, 0xfffffff1, v238
    v_cmp_eq_u32 vcc, 0, v238
    s_nop 1
    v_cndmask_b32 v240, v239, 0, vcc
    v_add_u32 v238, 15, v237
    v_and_b32 v238, 0xfffffff1, v238
    v_cmp_eq_u32 vcc, 0, v238
    s_nop 1
    v_cndmask_b32 v241, v239, 0, vcc
    v_add_u32 v238, 14, v237
    v_and_b32 v238, 0xfffffff1, v238
    v_cmp_eq_u32 vcc, 0, v238
    s_nop 1
    v_cndmask_b32 v242, v239, 0, vcc
    v_add_u32 v238, 13, v237
    v_and_b32 v238, 0xfffffff1, v238
    v_cmp_eq_u32 vcc, 0, v238
    s_nop 1
    v_cndmask_b32 v243, v239, 0, vcc
    v_add_u32 v238, 0, v237
    v_and_b32 v238, 0xfffffff1, v238
    v_cmp_eq_u32 vcc, 0, v238
    s_nop 1
    v_cndmask_b32 v244, v239, 0, vcc
    v_add_u32 v238, -1, v237
    v_and_b32 v238, 0xfffffff1, v238
    v_cmp_eq_u32 vcc, 0, v238
    s_nop 1
    v_cndmask_b32 v245, v239, 0, vcc
    v_add_u32 v238, -2, v237
    v_and_b32 v238, 0xfffffff1, v238
    v_cmp_eq_u32 vcc, 0, v238
    s_nop 1
    v_cndmask_b32 v246, v239, 0, vcc
    v_add_u32 v238, -3, v237
    v_and_b32 v238, 0xfffffff1, v238
    v_cmp_eq_u32 vcc, 0, v238
    s_nop 1
    v_cndmask_b32 v247, v239, 0, vcc
    s_or_b32 s53, s48, s3
    s_cmp_eq_u32 s53, 0
    s_cselect_b64 vcc, -1, 0
    v_cndmask_b32 v248, v240, v239, vcc
    v_cndmask_b32 v249, v241, v239, vcc
    v_cndmask_b32 v250, v242, v239, vcc
    v_cndmask_b32 v251, v243, v239, vcc
    v_mov_b32 v40, s5
    v_mov_b32 v41, s5
    v_mov_b32 v42, s5
    v_mov_b32 v43, s5
    s_mov_b32 s88, 0x22222222
    s_mov_b32 s89, 0x22222222
    s_mov_b32 s90, 0x44444444
    s_mov_b32 s91, 0x44444444
    s_mov_b32 s92, 0x88888888
    s_mov_b32 s93, 0x88888888
    v_lshlrev_b32 v72, 4, v3
    s_lshl_b32 s53, s3, 6
    v_add_u32 v73, s53, v72
    s_and_b32 s53, s53, 64
    v_add_u32 v74, s53, v72
    s_mul_i32 s53, s3, 384
    v_lshl_add_u32 v75, v2, 2, s53
    v_add_u32 v76, s53, v72
    s_and_b32 s53, s3, 1
    s_lshl_b32 s53, s53, 3
    v_add_u32 v80, s53, v4
    v_lshrrev_b32 v81, 2, v2
    v_lshlrev_b32 v81, 8, v81
    v_lshl_add_u32 v81, v3, 6, v81
    v_and_b32 v82, 3, v2
    v_lshl_add_u32 v81, v82, 1, v81
    v_add_u32 v81, s53, v81
    v_add_u32 v81, 1024, v81
    s_cmp_lt_u32 s3, 2
    s_cselect_b64 vcc, -1, 0
    s_cselect_b32 s53, 2, 16
    v_cndmask_b32 v80, v81, v80, vcc
    v_add_u32 v81, s53, v80
    v_add_u32 v82, s53, v81
    v_add_u32 v83, s53, v82
    v_lshlrev_b32 v77, 2, v2
    s_lshl_b32 s53, s3, 11
    v_add_u32 v78, s53, v4
    s_lshl_b32 s62, s48, 3
    s_lshl_b32 s63, s3, 1
    s_add_u32 s62, s62, s63
    s_lshl_b32 s62, s62, 4
    s_add_u32 s62, s62, s49
    s_lshl_b32 s62, s62, 10
    s_add_u32 s63, s62, 16384
    s_add_u32 m0, s51, 24576
    s_mov_b32 s73, 172032
    buffer_load_dwordx4 v123, s[12:15], s73 offen lds
    s_add_u32 m0, s51, 26624
    s_mov_b32 s73, 172928
    buffer_load_dwordx4 v123, s[12:15], s73 offen lds
    s_add_u32 m0, s51, 28672
    s_mov_b32 s73, 173824
    buffer_load_dwordx4 v123, s[12:15], s73 offen lds
    s_add_u32 m0, s52, 18432
    s_mov_b32 s73, 128
    buffer_load_dwordx4 v120, s[8:11], s73 offen lds
    s_add_u32 m0, s52, 19456
    s_mov_b32 s73, 128
    buffer_load_dwordx4 v121, s[8:11], s73 offen lds
    s_add_u32 m0, s52, 20480
    s_mov_b32 s73, 14464
    buffer_load_dwordx4 v120, s[8:11], s73 offen lds
    s_add_u32 m0, s52, 21504
    s_mov_b32 s73, 14464
    buffer_load_dwordx4 v121, s[8:11], s73 offen lds
    s_add_u32 m0, s7, 79872
    s_mov_b32 s73, 128
    s_mov_b64 exec, s[54:55]
    buffer_load_dwordx4 v122, s[8:11], s73 offen lds
    s_mov_b64 exec, -1
    s_waitcnt vmcnt(11)
    s_waitcnt lgkmcnt(0)
    s_barrier
    ds_read_b128 v[16:19], v128 offset:36864
    ds_read_b128 v[20:23], v128 offset:38912
    ds_read_b128 v[24:27], v130 offset:36864
    ds_read_b64_tr_b16 v[88:89], v124 offset:0
    ds_read_b64_tr_b16 v[90:91], v124 offset:256
    ds_read_b64_tr_b16 v[92:93], v125 offset:0
    ds_read_b64_tr_b16 v[94:95], v125 offset:256
    ds_read_b64_tr_b16 v[96:97], v124 offset:2048
    ds_read_b64_tr_b16 v[98:99], v124 offset:2304
    ds_read_b64_tr_b16 v[100:101], v125 offset:2048
    ds_read_b64_tr_b16 v[102:103], v125 offset:2304
    ds_read_b64_tr_b16 v[104:105], v124 offset:4096
    ds_read_b64_tr_b16 v[106:107], v124 offset:4352
    ds_read_b64_tr_b16 v[108:109], v125 offset:4096
    ds_read_b64_tr_b16 v[110:111], v125 offset:4352
    ds_read_b64_tr_b16 v[112:113], v126 offset:0
    ds_read_b64_tr_b16 v[114:115], v126 offset:256
    ds_read_b64_tr_b16 v[116:117], v127 offset:0
    ds_read_b64_tr_b16 v[118:119], v127 offset:256
    s_waitcnt lgkmcnt(8)
    v_mfma_f32_16x16x32_bf16 v[136:139], v[88:91], v[16:19], 0
    ds_read_b128 v[28:31], v129 offset:36864
    v_mfma_f32_16x16x32_bf16 v[160:163], v[88:91], v[20:23], 0
    ds_read_b128 v[32:35], v129 offset:38912
    v_mfma_f32_16x16x32_bf16 v[140:143], v[92:95], v[16:19], 0
    ds_read_b128 v[36:39], v131 offset:36864
    v_mfma_f32_16x16x32_bf16 v[164:167], v[92:95], v[20:23], 0
    ds_read_b64_tr_b16 v[88:89], v124 offset:6144
    v_mfma_f32_16x16x32_bf16 v[144:147], v[96:99], v[16:19], 0
    ds_read_b64_tr_b16 v[90:91], v124 offset:6400
    s_add_u32 m0, s51, 36864
    s_mov_b32 s73, 344064
    buffer_load_dwordx4 v123, s[12:15], s73 offen lds
    v_mfma_f32_16x16x32_bf16 v[168:171], v[96:99], v[20:23], 0
    ds_read_b64_tr_b16 v[92:93], v125 offset:6144
    v_mfma_f32_16x16x32_bf16 v[148:151], v[100:103], v[16:19], 0
    ds_read_b64_tr_b16 v[94:95], v125 offset:6400
    v_mfma_f32_16x16x32_bf16 v[172:175], v[100:103], v[20:23], 0
    ds_read_b64_tr_b16 v[96:97], v124 offset:8192
    s_waitcnt lgkmcnt(8)
    v_mfma_f32_16x16x32_bf16 v[152:155], v[16:19], v[104:107], 0
    ds_read_b64_tr_b16 v[98:99], v124 offset:8448
    v_mfma_f32_16x16x32_bf16 v[176:179], v[20:23], v[104:107], 0
    ds_read_b64_tr_b16 v[100:101], v125 offset:8192
    s_add_u32 m0, s51, 38912
    s_mov_b32 s73, 344960
    buffer_load_dwordx4 v123, s[12:15], s73 offen lds
    v_mfma_f32_16x16x32_bf16 v[156:159], v[16:19], v[108:111], 0
    ds_read_b64_tr_b16 v[102:103], v125 offset:8448
    v_mfma_f32_16x16x32_bf16 v[180:183], v[20:23], v[108:111], 0
    ds_read_b64_tr_b16 v[104:105], v124 offset:10240
    v_mfma_f32_16x16x32_bf16 v[184:187], v[112:115], v[24:27], 0
    ds_read_b64_tr_b16 v[106:107], v124 offset:10496
    v_mfma_f32_16x16x32_bf16 v[188:191], v[116:119], v[24:27], 0
    ds_read_b64_tr_b16 v[108:109], v125 offset:10240
    v_mfma_f32_16x16x32_bf16 v[48:51], v[16:19], v[16:19], 0
    ds_read_b64_tr_b16 v[110:111], v125 offset:10496
    s_add_u32 m0, s51, 40960
    s_mov_b32 s73, 345856
    buffer_load_dwordx4 v123, s[12:15], s73 offen lds
    v_mfma_f32_16x16x32_bf16 v[52:55], v[20:23], v[20:23], 0
    ds_read_b64_tr_b16 v[112:113], v126 offset:6144
    v_mfma_f32_16x16x32_bf16 v[56:59], v[24:27], v[24:27], 0
    ds_read_b64_tr_b16 v[114:115], v126 offset:6400
    v_mfma_f32_16x16x32_bf16 v[60:63], v[40:43], v[16:19], 0
    ds_read_b64_tr_b16 v[116:117], v127 offset:6144
    v_mfma_f32_16x16x32_bf16 v[64:67], v[40:43], v[20:23], 0
    ds_read_b64_tr_b16 v[118:119], v127 offset:6400
    v_mfma_f32_16x16x32_bf16 v[68:71], v[40:43], v[24:27], 0
    s_add_u32 m0, s52, 0
    s_mov_b32 s73, 256
    buffer_load_dwordx4 v120, s[8:11], s73 offen lds
    s_add_u32 m0, s52, 1024
    s_mov_b32 s73, 256
    buffer_load_dwordx4 v121, s[8:11], s73 offen lds
    s_add_u32 m0, s52, 2048
    s_mov_b32 s73, 14592
    buffer_load_dwordx4 v120, s[8:11], s73 offen lds
    s_add_u32 m0, s52, 3072
    s_mov_b32 s73, 14592
    buffer_load_dwordx4 v121, s[8:11], s73 offen lds
    s_add_u32 m0, s7, 61440
    s_mov_b32 s73, 256
    s_mov_b64 exec, s[54:55]
    buffer_load_dwordx4 v122, s[8:11], s73 offen lds
    s_mov_b64 exec, -1
    s_waitcnt vmcnt(8)
    s_barrier
    s_waitcnt lgkmcnt(8)
    v_mfma_f32_16x16x32_bf16 v[136:139], v[88:91], v[28:31], v[136:139]
    ds_read_b128 v[16:19], v128 offset:18432
    v_mfma_f32_16x16x32_bf16 v[160:163], v[88:91], v[32:35], v[160:163]
    ds_read_b128 v[20:23], v128 offset:20480
    v_mfma_f32_16x16x32_bf16 v[140:143], v[92:95], v[28:31], v[140:143]
    ds_read_b128 v[24:27], v130 offset:18432
    v_mfma_f32_16x16x32_bf16 v[164:167], v[92:95], v[32:35], v[164:167]
    ds_read_b64_tr_b16 v[88:89], v124 offset:12288
    v_mfma_f32_16x16x32_bf16 v[144:147], v[96:99], v[28:31], v[144:147]
    ds_read_b64_tr_b16 v[90:91], v124 offset:12544
    s_add_u32 m0, s51, 49152
    s_mov_b32 s73, 516096
    buffer_load_dwordx4 v123, s[12:15], s73 offen lds
    v_mfma_f32_16x16x32_bf16 v[168:171], v[96:99], v[32:35], v[168:171]
    ds_read_b64_tr_b16 v[92:93], v125 offset:12288
    v_mfma_f32_16x16x32_bf16 v[148:151], v[100:103], v[28:31], v[148:151]
    ds_read_b64_tr_b16 v[94:95], v125 offset:12544
    v_mfma_f32_16x16x32_bf16 v[172:175], v[100:103], v[32:35], v[172:175]
    ds_read_b64_tr_b16 v[96:97], v124 offset:14336
    s_waitcnt lgkmcnt(8)
    v_mfma_f32_16x16x32_bf16 v[152:155], v[28:31], v[104:107], v[152:155]
    ds_read_b64_tr_b16 v[98:99], v124 offset:14592
    v_mfma_f32_16x16x32_bf16 v[176:179], v[32:35], v[104:107], v[176:179]
    ds_read_b64_tr_b16 v[100:101], v125 offset:14336
    s_add_u32 m0, s51, 51200
    s_mov_b32 s73, 516992
    buffer_load_dwordx4 v123, s[12:15], s73 offen lds
    v_mfma_f32_16x16x32_bf16 v[156:159], v[28:31], v[108:111], v[156:159]
    ds_read_b64_tr_b16 v[102:103], v125 offset:14592
    v_mfma_f32_16x16x32_bf16 v[180:183], v[32:35], v[108:111], v[180:183]
    ds_read_b64_tr_b16 v[104:105], v124 offset:16384
    v_mfma_f32_16x16x32_bf16 v[184:187], v[112:115], v[36:39], v[184:187]
    ds_read_b64_tr_b16 v[106:107], v124 offset:16640
    v_mfma_f32_16x16x32_bf16 v[188:191], v[116:119], v[36:39], v[188:191]
    ds_read_b64_tr_b16 v[108:109], v125 offset:16384
    v_mfma_f32_16x16x32_bf16 v[48:51], v[28:31], v[28:31], v[48:51]
    ds_read_b64_tr_b16 v[110:111], v125 offset:16640
    s_add_u32 m0, s51, 53248
    s_mov_b32 s73, 517888
    buffer_load_dwordx4 v123, s[12:15], s73 offen lds
    v_mfma_f32_16x16x32_bf16 v[52:55], v[32:35], v[32:35], v[52:55]
    ds_read_b64_tr_b16 v[112:113], v126 offset:12288
    v_mfma_f32_16x16x32_bf16 v[56:59], v[36:39], v[36:39], v[56:59]
    ds_read_b64_tr_b16 v[114:115], v126 offset:12544
    v_mfma_f32_16x16x32_bf16 v[60:63], v[40:43], v[28:31], v[60:63]
    ds_read_b64_tr_b16 v[116:117], v127 offset:12288
    v_mfma_f32_16x16x32_bf16 v[64:67], v[40:43], v[32:35], v[64:67]
    ds_read_b64_tr_b16 v[118:119], v127 offset:12544
    v_mfma_f32_16x16x32_bf16 v[68:71], v[40:43], v[36:39], v[68:71]
    s_add_u32 m0, s52, 55296
    s_mov_b32 s73, 384
    buffer_load_dwordx4 v120, s[8:11], s73 offen lds
    s_waitcnt lgkmcnt(8)
    v_mfma_f32_16x16x32_bf16 v[136:139], v[88:91], v[16:19], v[136:139]
    ds_read_b128 v[28:31], v129 offset:18432
    v_mfma_f32_16x16x32_bf16 v[160:163], v[88:91], v[20:23], v[160:163]
    ds_read_b128 v[32:35], v129 offset:20480
    v_mfma_f32_16x16x32_bf16 v[140:143], v[92:95], v[16:19], v[140:143]
    ds_read_b128 v[36:39], v131 offset:18432
    v_mfma_f32_16x16x32_bf16 v[164:167], v[92:95], v[20:23], v[164:167]
    ds_read_b64_tr_b16 v[88:89], v124 offset:18432
    v_mfma_f32_16x16x32_bf16 v[144:147], v[96:99], v[16:19], v[144:147]
    ds_read_b64_tr_b16 v[90:91], v124 offset:18688
    s_add_u32 m0, s52, 56320
    s_mov_b32 s73, 384
    buffer_load_dwordx4 v121, s[8:11], s73 offen lds
    v_mfma_f32_16x16x32_bf16 v[168:171], v[96:99], v[20:23], v[168:171]
    ds_read_b64_tr_b16 v[92:93], v125 offset:18432
    v_mfma_f32_16x16x32_bf16 v[148:151], v[100:103], v[16:19], v[148:151]
    ds_read_b64_tr_b16 v[94:95], v125 offset:18688
    v_mfma_f32_16x16x32_bf16 v[172:175], v[100:103], v[20:23], v[172:175]
    ds_read_b64_tr_b16 v[96:97], v124 offset:20480
    s_waitcnt lgkmcnt(8)
    v_mfma_f32_16x16x32_bf16 v[152:155], v[16:19], v[104:107], v[152:155]
    ds_read_b64_tr_b16 v[98:99], v124 offset:20736
    v_mfma_f32_16x16x32_bf16 v[176:179], v[20:23], v[104:107], v[176:179]
    ds_read_b64_tr_b16 v[100:101], v125 offset:20480
    s_add_u32 m0, s52, 57344
    s_mov_b32 s73, 14720
    buffer_load_dwordx4 v120, s[8:11], s73 offen lds
    v_mfma_f32_16x16x32_bf16 v[156:159], v[16:19], v[108:111], v[156:159]
    ds_read_b64_tr_b16 v[102:103], v125 offset:20736
    v_mfma_f32_16x16x32_bf16 v[180:183], v[20:23], v[108:111], v[180:183]
    ds_read_b64_tr_b16 v[104:105], v124 offset:22528
    v_mfma_f32_16x16x32_bf16 v[184:187], v[112:115], v[24:27], v[184:187]
    ds_read_b64_tr_b16 v[106:107], v124 offset:22784
    v_mfma_f32_16x16x32_bf16 v[188:191], v[116:119], v[24:27], v[188:191]
    ds_read_b64_tr_b16 v[108:109], v125 offset:22528
    v_mfma_f32_16x16x32_bf16 v[48:51], v[16:19], v[16:19], v[48:51]
    ds_read_b64_tr_b16 v[110:111], v125 offset:22784
    s_add_u32 m0, s52, 58368
    s_mov_b32 s73, 14720
    buffer_load_dwordx4 v121, s[8:11], s73 offen lds
    v_mfma_f32_16x16x32_bf16 v[52:55], v[20:23], v[20:23], v[52:55]
    ds_read_b64_tr_b16 v[112:113], v126 offset:18432
    v_mfma_f32_16x16x32_bf16 v[56:59], v[24:27], v[24:27], v[56:59]
    ds_read_b64_tr_b16 v[114:115], v126 offset:18688
    v_mfma_f32_16x16x32_bf16 v[60:63], v[40:43], v[16:19], v[60:63]
    ds_read_b64_tr_b16 v[116:117], v127 offset:18432
    v_mfma_f32_16x16x32_bf16 v[64:67], v[40:43], v[20:23], v[64:67]
    ds_read_b64_tr_b16 v[118:119], v127 offset:18688
    v_mfma_f32_16x16x32_bf16 v[68:71], v[40:43], v[24:27], v[68:71]
    s_add_u32 m0, s7, 116736
    s_mov_b32 s73, 384
    s_mov_b64 exec, s[54:55]
    buffer_load_dwordx4 v122, s[8:11], s73 offen lds
    s_mov_b64 exec, -1
    s_waitcnt vmcnt(8)
    s_barrier
    s_waitcnt lgkmcnt(8)
    v_mfma_f32_16x16x32_bf16 v[136:139], v[88:91], v[28:31], v[136:139]
    ds_read_b128 v[16:19], v128 offset:0
    v_mfma_f32_16x16x32_bf16 v[160:163], v[88:91], v[32:35], v[160:163]
    ds_read_b128 v[20:23], v128 offset:2048
    v_mfma_f32_16x16x32_bf16 v[140:143], v[92:95], v[28:31], v[140:143]
    ds_read_b128 v[24:27], v130 offset:0
    v_mfma_f32_16x16x32_bf16 v[164:167], v[92:95], v[32:35], v[164:167]
    ds_read_b64_tr_b16 v[88:89], v124 offset:24576
    v_mfma_f32_16x16x32_bf16 v[144:147], v[96:99], v[28:31], v[144:147]
    ds_read_b64_tr_b16 v[90:91], v124 offset:24832
    s_add_u32 m0, s51, 12288
    s_mov_b32 s73, 688128
    buffer_load_dwordx4 v123, s[12:15], s73 offen lds
    v_mfma_f32_16x16x32_bf16 v[168:171], v[96:99], v[32:35], v[168:171]
    ds_read_b64_tr_b16 v[92:93], v125 offset:24576
    v_mfma_f32_16x16x32_bf16 v[148:151], v[100:103], v[28:31], v[148:151]
    ds_read_b64_tr_b16 v[94:95], v125 offset:24832
    v_mfma_f32_16x16x32_bf16 v[172:175], v[100:103], v[32:35], v[172:175]
    ds_read_b64_tr_b16 v[96:97], v124 offset:26624
    s_waitcnt lgkmcnt(8)
    v_mfma_f32_16x16x32_bf16 v[152:155], v[28:31], v[104:107], v[152:155]
    ds_read_b64_tr_b16 v[98:99], v124 offset:26880
    v_mfma_f32_16x16x32_bf16 v[176:179], v[32:35], v[104:107], v[176:179]
    ds_read_b64_tr_b16 v[100:101], v125 offset:26624
    s_add_u32 m0, s51, 14336
    s_mov_b32 s73, 689024
    buffer_load_dwordx4 v123, s[12:15], s73 offen lds
    v_mfma_f32_16x16x32_bf16 v[156:159], v[28:31], v[108:111], v[156:159]
    ds_read_b64_tr_b16 v[102:103], v125 offset:26880
    v_mfma_f32_16x16x32_bf16 v[180:183], v[32:35], v[108:111], v[180:183]
    ds_read_b64_tr_b16 v[104:105], v124 offset:28672
    v_mfma_f32_16x16x32_bf16 v[184:187], v[112:115], v[36:39], v[184:187]
    ds_read_b64_tr_b16 v[106:107], v124 offset:28928
    v_mfma_f32_16x16x32_bf16 v[188:191], v[116:119], v[36:39], v[188:191]
    ds_read_b64_tr_b16 v[108:109], v125 offset:28672
    v_mfma_f32_16x16x32_bf16 v[48:51], v[28:31], v[28:31], v[48:51]
    ds_read_b64_tr_b16 v[110:111], v125 offset:28928
    s_add_u32 m0, s51, 16384
    s_mov_b32 s73, 689920
    buffer_load_dwordx4 v123, s[12:15], s73 offen lds
    v_mfma_f32_16x16x32_bf16 v[52:55], v[32:35], v[32:35], v[52:55]
    ds_read_b64_tr_b16 v[112:113], v126 offset:24576
    v_mfma_f32_16x16x32_bf16 v[56:59], v[36:39], v[36:39], v[56:59]
    ds_read_b64_tr_b16 v[114:115], v126 offset:24832
    v_mfma_f32_16x16x32_bf16 v[60:63], v[40:43], v[28:31], v[60:63]
    ds_read_b64_tr_b16 v[116:117], v127 offset:24576
    v_mfma_f32_16x16x32_bf16 v[64:67], v[40:43], v[32:35], v[64:67]
    ds_read_b64_tr_b16 v[118:119], v127 offset:24832
    v_mfma_f32_16x16x32_bf16 v[68:71], v[40:43], v[36:39], v[68:71]
    s_add_u32 m0, s52, 36864
    s_mov_b32 s73, 512
    buffer_load_dwordx4 v120, s[8:11], s73 offen lds
    s_waitcnt lgkmcnt(8)
    v_mfma_f32_16x16x32_bf16 v[136:139], v[88:91], v[16:19], v[136:139]
    ds_read_b128 v[28:31], v129 offset:0
    v_mfma_f32_16x16x32_bf16 v[160:163], v[88:91], v[20:23], v[160:163]
    ds_read_b128 v[32:35], v129 offset:2048
    v_mfma_f32_16x16x32_bf16 v[140:143], v[92:95], v[16:19], v[140:143]
    ds_read_b128 v[36:39], v131 offset:0
    v_mfma_f32_16x16x32_bf16 v[164:167], v[92:95], v[20:23], v[164:167]
    ds_read_b64_tr_b16 v[88:89], v124 offset:30720
    v_mfma_f32_16x16x32_bf16 v[144:147], v[96:99], v[16:19], v[144:147]
    ds_read_b64_tr_b16 v[90:91], v124 offset:30976
    s_add_u32 m0, s52, 37888
    s_mov_b32 s73, 512
    buffer_load_dwordx4 v121, s[8:11], s73 offen lds
    v_mfma_f32_16x16x32_bf16 v[168:171], v[96:99], v[20:23], v[168:171]
    ds_read_b64_tr_b16 v[92:93], v125 offset:30720
    v_mfma_f32_16x16x32_bf16 v[148:151], v[100:103], v[16:19], v[148:151]
    ds_read_b64_tr_b16 v[94:95], v125 offset:30976
    v_mfma_f32_16x16x32_bf16 v[172:175], v[100:103], v[20:23], v[172:175]
    ds_read_b64_tr_b16 v[96:97], v124 offset:32768
    s_waitcnt lgkmcnt(8)
    v_mfma_f32_16x16x32_bf16 v[152:155], v[16:19], v[104:107], v[152:155]
    ds_read_b64_tr_b16 v[98:99], v124 offset:33024
    v_mfma_f32_16x16x32_bf16 v[176:179], v[20:23], v[104:107], v[176:179]
    ds_read_b64_tr_b16 v[100:101], v125 offset:32768
    s_add_u32 m0, s52, 38912
    s_mov_b32 s73, 14848
    buffer_load_dwordx4 v120, s[8:11], s73 offen lds
    v_mfma_f32_16x16x32_bf16 v[156:159], v[16:19], v[108:111], v[156:159]
    ds_read_b64_tr_b16 v[102:103], v125 offset:33024
    v_mfma_f32_16x16x32_bf16 v[180:183], v[20:23], v[108:111], v[180:183]
    ds_read_b64_tr_b16 v[104:105], v124 offset:34816
    v_mfma_f32_16x16x32_bf16 v[184:187], v[112:115], v[24:27], v[184:187]
    ds_read_b64_tr_b16 v[106:107], v124 offset:35072
    v_mfma_f32_16x16x32_bf16 v[188:191], v[116:119], v[24:27], v[188:191]
    ds_read_b64_tr_b16 v[108:109], v125 offset:34816
    v_mfma_f32_16x16x32_bf16 v[48:51], v[16:19], v[16:19], v[48:51]
    ds_read_b64_tr_b16 v[110:111], v125 offset:35072
    s_add_u32 m0, s52, 39936
    s_mov_b32 s73, 14848
    buffer_load_dwordx4 v121, s[8:11], s73 offen lds
    v_mfma_f32_16x16x32_bf16 v[52:55], v[20:23], v[20:23], v[52:55]
    ds_read_b64_tr_b16 v[112:113], v126 offset:30720
    v_mfma_f32_16x16x32_bf16 v[56:59], v[24:27], v[24:27], v[56:59]
    ds_read_b64_tr_b16 v[114:115], v126 offset:30976
    v_mfma_f32_16x16x32_bf16 v[60:63], v[40:43], v[16:19], v[60:63]
    ds_read_b64_tr_b16 v[116:117], v127 offset:30720
    v_mfma_f32_16x16x32_bf16 v[64:67], v[40:43], v[20:23], v[64:67]
    ds_read_b64_tr_b16 v[118:119], v127 offset:30976
    v_mfma_f32_16x16x32_bf16 v[68:71], v[40:43], v[24:27], v[68:71]
    s_add_u32 m0, s7, 98304
    s_mov_b32 s73, 512
    s_mov_b64 exec, s[54:55]
    buffer_load_dwordx4 v122, s[8:11], s73 offen lds
    s_mov_b64 exec, -1
    s_waitcnt vmcnt(8)
    s_barrier
    s_waitcnt lgkmcnt(8)
    v_mfma_f32_16x16x32_bf16 v[136:139], v[88:91], v[28:31], v[136:139]
    ds_read_b128 v[16:19], v128 offset:55296
    v_mfma_f32_16x16x32_bf16 v[160:163], v[88:91], v[32:35], v[160:163]
    ds_read_b128 v[20:23], v128 offset:57344
    v_mfma_f32_16x16x32_bf16 v[140:143], v[92:95], v[28:31], v[140:143]
    ds_read_b128 v[24:27], v130 offset:55296
    v_mfma_f32_16x16x32_bf16 v[164:167], v[92:95], v[32:35], v[164:167]
    ds_read_b64_tr_b16 v[88:89], v124 offset:36864
    v_mfma_f32_16x16x32_bf16 v[144:147], v[96:99], v[28:31], v[144:147]
    ds_read_b64_tr_b16 v[90:91], v124 offset:37120
    s_add_u32 m0, s51, 24576
    s_mov_b32 s73, 860160
    buffer_load_dwordx4 v123, s[12:15], s73 offen lds
    v_mfma_f32_16x16x32_bf16 v[168:171], v[96:99], v[32:35], v[168:171]
    ds_read_b64_tr_b16 v[92:93], v125 offset:36864
    v_mfma_f32_16x16x32_bf16 v[148:151], v[100:103], v[28:31], v[148:151]
    ds_read_b64_tr_b16 v[94:95], v125 offset:37120
    v_mfma_f32_16x16x32_bf16 v[172:175], v[100:103], v[32:35], v[172:175]
    ds_read_b64_tr_b16 v[96:97], v124 offset:38912
    s_waitcnt lgkmcnt(8)
    v_mfma_f32_16x16x32_bf16 v[152:155], v[28:31], v[104:107], v[152:155]
    ds_read_b64_tr_b16 v[98:99], v124 offset:39168
    v_mfma_f32_16x16x32_bf16 v[176:179], v[32:35], v[104:107], v[176:179]
    ds_read_b64_tr_b16 v[100:101], v125 offset:38912
    s_add_u32 m0, s51, 26624
    s_mov_b32 s73, 861056
    buffer_load_dwordx4 v123, s[12:15], s73 offen lds
    v_mfma_f32_16x16x32_bf16 v[156:159], v[28:31], v[108:111], v[156:159]
    ds_read_b64_tr_b16 v[102:103], v125 offset:39168
    v_mfma_f32_16x16x32_bf16 v[180:183], v[32:35], v[108:111], v[180:183]
    ds_read_b64_tr_b16 v[104:105], v124 offset:40960
    v_mfma_f32_16x16x32_bf16 v[184:187], v[112:115], v[36:39], v[184:187]
    ds_read_b64_tr_b16 v[106:107], v124 offset:41216
    v_mfma_f32_16x16x32_bf16 v[188:191], v[116:119], v[36:39], v[188:191]
    ds_read_b64_tr_b16 v[108:109], v125 offset:40960
    v_mfma_f32_16x16x32_bf16 v[48:51], v[28:31], v[28:31], v[48:51]
    ds_read_b64_tr_b16 v[110:111], v125 offset:41216
    s_add_u32 m0, s51, 28672
    s_mov_b32 s73, 861952
    buffer_load_dwordx4 v123, s[12:15], s73 offen lds
    v_mfma_f32_16x16x32_bf16 v[52:55], v[32:35], v[32:35], v[52:55]
    ds_read_b64_tr_b16 v[112:113], v126 offset:36864
    v_mfma_f32_16x16x32_bf16 v[56:59], v[36:39], v[36:39], v[56:59]
    ds_read_b64_tr_b16 v[114:115], v126 offset:37120
    v_mfma_f32_16x16x32_bf16 v[60:63], v[40:43], v[28:31], v[60:63]
    ds_read_b64_tr_b16 v[116:117], v127 offset:36864
    v_mfma_f32_16x16x32_bf16 v[64:67], v[40:43], v[32:35], v[64:67]
    ds_read_b64_tr_b16 v[118:119], v127 offset:37120
    v_mfma_f32_16x16x32_bf16 v[68:71], v[40:43], v[36:39], v[68:71]
    s_add_u32 m0, s52, 18432
    s_mov_b32 s73, 640
    buffer_load_dwordx4 v120, s[8:11], s73 offen lds
    s_waitcnt lgkmcnt(8)
    v_mfma_f32_16x16x32_bf16 v[136:139], v[88:91], v[16:19], v[136:139]
    ds_read_b128 v[28:31], v129 offset:55296
    v_mfma_f32_16x16x32_bf16 v[160:163], v[88:91], v[20:23], v[160:163]
    ds_read_b128 v[32:35], v129 offset:57344
    v_mfma_f32_16x16x32_bf16 v[140:143], v[92:95], v[16:19], v[140:143]
    ds_read_b128 v[36:39], v131 offset:55296
    v_mfma_f32_16x16x32_bf16 v[164:167], v[92:95], v[20:23], v[164:167]
    ds_read_b64_tr_b16 v[88:89], v124 offset:43008
    v_mfma_f32_16x16x32_bf16 v[144:147], v[96:99], v[16:19], v[144:147]
    ds_read_b64_tr_b16 v[90:91], v124 offset:43264
    s_add_u32 m0, s52, 19456
    s_mov_b32 s73, 640
    buffer_load_dwordx4 v121, s[8:11], s73 offen lds
    v_mfma_f32_16x16x32_bf16 v[168:171], v[96:99], v[20:23], v[168:171]
    ds_read_b64_tr_b16 v[92:93], v125 offset:43008
    v_mfma_f32_16x16x32_bf16 v[148:151], v[100:103], v[16:19], v[148:151]
    ds_read_b64_tr_b16 v[94:95], v125 offset:43264
    v_mfma_f32_16x16x32_bf16 v[172:175], v[100:103], v[20:23], v[172:175]
    ds_read_b64_tr_b16 v[96:97], v124 offset:45056
    s_waitcnt lgkmcnt(8)
    v_mfma_f32_16x16x32_bf16 v[152:155], v[16:19], v[104:107], v[152:155]
    ds_read_b64_tr_b16 v[98:99], v124 offset:45312
    v_mfma_f32_16x16x32_bf16 v[176:179], v[20:23], v[104:107], v[176:179]
    ds_read_b64_tr_b16 v[100:101], v125 offset:45056
    s_add_u32 m0, s52, 20480
    s_mov_b32 s73, 14976
    buffer_load_dwordx4 v120, s[8:11], s73 offen lds
    v_mfma_f32_16x16x32_bf16 v[156:159], v[16:19], v[108:111], v[156:159]
    ds_read_b64_tr_b16 v[102:103], v125 offset:45312
    v_mfma_f32_16x16x32_bf16 v[180:183], v[20:23], v[108:111], v[180:183]
    ds_read_b64_tr_b16 v[104:105], v124 offset:47104
    v_mfma_f32_16x16x32_bf16 v[184:187], v[112:115], v[24:27], v[184:187]
    ds_read_b64_tr_b16 v[106:107], v124 offset:47360
    v_mfma_f32_16x16x32_bf16 v[188:191], v[116:119], v[24:27], v[188:191]
    ds_read_b64_tr_b16 v[108:109], v125 offset:47104
    v_mfma_f32_16x16x32_bf16 v[48:51], v[16:19], v[16:19], v[48:51]
    ds_read_b64_tr_b16 v[110:111], v125 offset:47360
    s_add_u32 m0, s52, 21504
    s_mov_b32 s73, 14976
    buffer_load_dwordx4 v121, s[8:11], s73 offen lds
    v_mfma_f32_16x16x32_bf16 v[52:55], v[20:23], v[20:23], v[52:55]
    ds_read_b64_tr_b16 v[112:113], v126 offset:43008
    v_mfma_f32_16x16x32_bf16 v[56:59], v[24:27], v[24:27], v[56:59]
    ds_read_b64_tr_b16 v[114:115], v126 offset:43264
    v_mfma_f32_16x16x32_bf16 v[60:63], v[40:43], v[16:19], v[60:63]
    ds_read_b64_tr_b16 v[116:117], v127 offset:43008
    v_mfma_f32_16x16x32_bf16 v[64:67], v[40:43], v[20:23], v[64:67]
    ds_read_b64_tr_b16 v[118:119], v127 offset:43264
    v_mfma_f32_16x16x32_bf16 v[68:71], v[40:43], v[24:27], v[68:71]
    s_add_u32 m0, s7, 79872
    s_mov_b32 s73, 640
    s_mov_b64 exec, s[54:55]
    buffer_load_dwordx4 v122, s[8:11], s73 offen lds
    s_mov_b64 exec, -1
    s_waitcnt vmcnt(8)
    s_barrier
    s_waitcnt lgkmcnt(8)
    v_mfma_f32_16x16x32_bf16 v[136:139], v[88:91], v[28:31], v[136:139]
    ds_read_b128 v[16:19], v128 offset:36864
    v_mfma_f32_16x16x32_bf16 v[160:163], v[88:91], v[32:35], v[160:163]
    ds_read_b128 v[20:23], v128 offset:38912
    v_mfma_f32_16x16x32_bf16 v[140:143], v[92:95], v[28:31], v[140:143]
    ds_read_b128 v[24:27], v130 offset:36864
    v_mfma_f32_16x16x32_bf16 v[164:167], v[92:95], v[32:35], v[164:167]
    ds_read_b64_tr_b16 v[88:89], v124 offset:0
    v_mfma_f32_16x16x32_bf16 v[144:147], v[96:99], v[28:31], v[144:147]
    ds_read_b64_tr_b16 v[90:91], v124 offset:256
    s_add_u32 m0, s51, 36864
    s_mov_b32 s73, 1032192
    buffer_load_dwordx4 v123, s[12:15], s73 offen lds
    v_mfma_f32_16x16x32_bf16 v[168:171], v[96:99], v[32:35], v[168:171]
    ds_read_b64_tr_b16 v[92:93], v125 offset:0
    v_mfma_f32_16x16x32_bf16 v[148:151], v[100:103], v[28:31], v[148:151]
    ds_read_b64_tr_b16 v[94:95], v125 offset:256
    v_mfma_f32_16x16x32_bf16 v[172:175], v[100:103], v[32:35], v[172:175]
    ds_read_b64_tr_b16 v[96:97], v124 offset:2048
    s_waitcnt lgkmcnt(8)
    v_mfma_f32_16x16x32_bf16 v[152:155], v[28:31], v[104:107], v[152:155]
    ds_read_b64_tr_b16 v[98:99], v124 offset:2304
    v_mfma_f32_16x16x32_bf16 v[176:179], v[32:35], v[104:107], v[176:179]
    ds_read_b64_tr_b16 v[100:101], v125 offset:2048
    s_add_u32 m0, s51, 38912
    s_mov_b32 s73, 1033088
    buffer_load_dwordx4 v123, s[12:15], s73 offen lds
    v_mfma_f32_16x16x32_bf16 v[156:159], v[28:31], v[108:111], v[156:159]
    ds_read_b64_tr_b16 v[102:103], v125 offset:2304
    v_mfma_f32_16x16x32_bf16 v[180:183], v[32:35], v[108:111], v[180:183]
    ds_read_b64_tr_b16 v[104:105], v124 offset:4096
    v_mfma_f32_16x16x32_bf16 v[184:187], v[112:115], v[36:39], v[184:187]
    ds_read_b64_tr_b16 v[106:107], v124 offset:4352
    v_mfma_f32_16x16x32_bf16 v[188:191], v[116:119], v[36:39], v[188:191]
    ds_read_b64_tr_b16 v[108:109], v125 offset:4096
    v_mfma_f32_16x16x32_bf16 v[48:51], v[28:31], v[28:31], v[48:51]
    ds_read_b64_tr_b16 v[110:111], v125 offset:4352
    s_add_u32 m0, s51, 40960
    s_mov_b32 s73, 1033984
    buffer_load_dwordx4 v123, s[12:15], s73 offen lds
    v_mfma_f32_16x16x32_bf16 v[52:55], v[32:35], v[32:35], v[52:55]
    ds_read_b64_tr_b16 v[112:113], v126 offset:0
    v_mfma_f32_16x16x32_bf16 v[56:59], v[36:39], v[36:39], v[56:59]
    ds_read_b64_tr_b16 v[114:115], v126 offset:256
    v_mfma_f32_16x16x32_bf16 v[60:63], v[40:43], v[28:31], v[60:63]
    ds_read_b64_tr_b16 v[116:117], v127 offset:0
    v_mfma_f32_16x16x32_bf16 v[64:67], v[40:43], v[32:35], v[64:67]
    ds_read_b64_tr_b16 v[118:119], v127 offset:256
    v_mfma_f32_16x16x32_bf16 v[68:71], v[40:43], v[36:39], v[68:71]
    s_add_u32 m0, s52, 0
    s_mov_b32 s73, 768
    buffer_load_dwordx4 v120, s[8:11], s73 offen lds
    s_waitcnt lgkmcnt(8)
    v_mfma_f32_16x16x32_bf16 v[136:139], v[88:91], v[16:19], v[136:139]
    ds_read_b128 v[28:31], v129 offset:36864
    v_mfma_f32_16x16x32_bf16 v[160:163], v[88:91], v[20:23], v[160:163]
    ds_read_b128 v[32:35], v129 offset:38912
    v_mfma_f32_16x16x32_bf16 v[140:143], v[92:95], v[16:19], v[140:143]
    ds_read_b128 v[36:39], v131 offset:36864
    v_mfma_f32_16x16x32_bf16 v[164:167], v[92:95], v[20:23], v[164:167]
    ds_read_b64_tr_b16 v[88:89], v124 offset:6144
    v_mfma_f32_16x16x32_bf16 v[144:147], v[96:99], v[16:19], v[144:147]
    ds_read_b64_tr_b16 v[90:91], v124 offset:6400
    s_add_u32 m0, s52, 1024
    s_mov_b32 s73, 768
    buffer_load_dwordx4 v121, s[8:11], s73 offen lds
    v_mfma_f32_16x16x32_bf16 v[168:171], v[96:99], v[20:23], v[168:171]
    ds_read_b64_tr_b16 v[92:93], v125 offset:6144
    v_mfma_f32_16x16x32_bf16 v[148:151], v[100:103], v[16:19], v[148:151]
    ds_read_b64_tr_b16 v[94:95], v125 offset:6400
    v_mfma_f32_16x16x32_bf16 v[172:175], v[100:103], v[20:23], v[172:175]
    ds_read_b64_tr_b16 v[96:97], v124 offset:8192
    s_waitcnt lgkmcnt(8)
    v_mfma_f32_16x16x32_bf16 v[152:155], v[16:19], v[104:107], v[152:155]
    ds_read_b64_tr_b16 v[98:99], v124 offset:8448
    v_mfma_f32_16x16x32_bf16 v[176:179], v[20:23], v[104:107], v[176:179]
    ds_read_b64_tr_b16 v[100:101], v125 offset:8192
    s_add_u32 m0, s52, 2048
    s_mov_b32 s73, 15104
    buffer_load_dwordx4 v120, s[8:11], s73 offen lds
    v_mfma_f32_16x16x32_bf16 v[156:159], v[16:19], v[108:111], v[156:159]
    ds_read_b64_tr_b16 v[102:103], v125 offset:8448
    v_mfma_f32_16x16x32_bf16 v[180:183], v[20:23], v[108:111], v[180:183]
    ds_read_b64_tr_b16 v[104:105], v124 offset:10240
    v_mfma_f32_16x16x32_bf16 v[184:187], v[112:115], v[24:27], v[184:187]
    ds_read_b64_tr_b16 v[106:107], v124 offset:10496
    v_mfma_f32_16x16x32_bf16 v[188:191], v[116:119], v[24:27], v[188:191]
    ds_read_b64_tr_b16 v[108:109], v125 offset:10240
    v_mfma_f32_16x16x32_bf16 v[48:51], v[16:19], v[16:19], v[48:51]
    ds_read_b64_tr_b16 v[110:111], v125 offset:10496
    s_add_u32 m0, s52, 3072
    s_mov_b32 s73, 15104
    buffer_load_dwordx4 v121, s[8:11], s73 offen lds
    v_mfma_f32_16x16x32_bf16 v[52:55], v[20:23], v[20:23], v[52:55]
    ds_read_b64_tr_b16 v[112:113], v126 offset:6144
    v_mfma_f32_16x16x32_bf16 v[56:59], v[24:27], v[24:27], v[56:59]
    ds_read_b64_tr_b16 v[114:115], v126 offset:6400
    v_mfma_f32_16x16x32_bf16 v[60:63], v[40:43], v[16:19], v[60:63]
    ds_read_b64_tr_b16 v[116:117], v127 offset:6144
    v_mfma_f32_16x16x32_bf16 v[64:67], v[40:43], v[20:23], v[64:67]
    ds_read_b64_tr_b16 v[118:119], v127 offset:6400
    v_mfma_f32_16x16x32_bf16 v[68:71], v[40:43], v[24:27], v[68:71]
    s_add_u32 m0, s7, 61440
    s_mov_b32 s73, 768
    s_mov_b64 exec, s[54:55]
    buffer_load_dwordx4 v122, s[8:11], s73 offen lds
    s_mov_b64 exec, -1
    v_mov_b32 v7, 0
    buffer_load_dword v6, v7, s[44:47], 0 offen sc1
    s_lshr_b32 s68, s2, 3
    s_lshl_b32 s68, s68, 2
    s_add_u32 s68, s68, s3
    v_lshlrev_b32 v219, 7, v1
    s_mul_i32 s86, s68, 3200
    s_mov_b64 exec, 0x1ffffff
    buffer_load_dword v234, v219, s[16:19], s86 offen
    s_mov_b64 exec, -1
    v_lshrrev_b32 v219, 2, v1
    v_mul_u32_u24 v219, 3584, v219
    v_and_b32 v220, 3, v1
    v_lshl_add_u32 v219, v220, 7, v219
    s_mul_i32 s68, s68, 57344
    s_and_b32 s69, s2, 7
    s_mul_i32 s86, s69, 3
    s_add_u32 s86, s86, 4
    s_lshl_b32 s87, s69, 2
    s_min_u32 s86, s86, s87
    s_lshl_b32 s86, s86, 7
    s_add_u32 s86, s86, s68
    s_cmp_lt_u32 s69, 4
    s_cselect_b32 exec_lo, -1, 0x77777777
    s_cselect_b32 exec_hi, -1, 0x77777777
    buffer_load_dword v235, v219, s[20:23], s86 offen
    s_mov_b64 exec, -1
    s_waitcnt vmcnt(11)
    s_barrier
    s_waitcnt lgkmcnt(8)
    v_mfma_f32_16x16x32_bf16 v[136:139], v[88:91], v[28:31], v[136:139]
    ds_read_b128 v[16:19], v128 offset:18432
    v_mfma_f32_16x16x32_bf16 v[160:163], v[88:91], v[32:35], v[160:163]
    ds_read_b128 v[20:23], v128 offset:20480
    v_mfma_f32_16x16x32_bf16 v[140:143], v[92:95], v[28:31], v[140:143]
    ds_read_b128 v[24:27], v130 offset:18432
    v_mfma_f32_16x16x32_bf16 v[164:167], v[92:95], v[32:35], v[164:167]
    ds_read_b64_tr_b16 v[88:89], v124 offset:12288
    v_mfma_f32_16x16x32_bf16 v[144:147], v[96:99], v[28:31], v[144:147]
    ds_read_b64_tr_b16 v[90:91], v124 offset:12544
    v_mfma_f32_16x16x32_bf16 v[168:171], v[96:99], v[32:35], v[168:171]
    ds_read_b64_tr_b16 v[92:93], v125 offset:12288
    v_mfma_f32_16x16x32_bf16 v[148:151], v[100:103], v[28:31], v[148:151]
    ds_read_b64_tr_b16 v[94:95], v125 offset:12544
    v_mfma_f32_16x16x32_bf16 v[172:175], v[100:103], v[32:35], v[172:175]
    ds_read_b64_tr_b16 v[96:97], v124 offset:14336
    s_waitcnt lgkmcnt(8)
    v_mfma_f32_16x16x32_bf16 v[152:155], v[28:31], v[104:107], v[152:155]
    ds_read_b64_tr_b16 v[98:99], v124 offset:14592
    v_mfma_f32_16x16x32_bf16 v[176:179], v[32:35], v[104:107], v[176:179]
    ds_read_b64_tr_b16 v[100:101], v125 offset:14336
    v_mfma_f32_16x16x32_bf16 v[156:159], v[28:31], v[108:111], v[156:159]
    ds_read_b64_tr_b16 v[102:103], v125 offset:14592
    v_mfma_f32_16x16x32_bf16 v[180:183], v[32:35], v[108:111], v[180:183]
    ds_read_b64_tr_b16 v[104:105], v124 offset:16384
    v_mfma_f32_16x16x32_bf16 v[184:187], v[112:115], v[36:39], v[184:187]
    ds_read_b64_tr_b16 v[106:107], v124 offset:16640
    v_mfma_f32_16x16x32_bf16 v[188:191], v[116:119], v[36:39], v[188:191]
    ds_read_b64_tr_b16 v[108:109], v125 offset:16384
    v_mfma_f32_16x16x32_bf16 v[48:51], v[28:31], v[28:31], v[48:51]
    ds_read_b64_tr_b16 v[110:111], v125 offset:16640
    v_mfma_f32_16x16x32_bf16 v[52:55], v[32:35], v[32:35], v[52:55]
    ds_read_b64_tr_b16 v[112:113], v126 offset:12288
    v_mfma_f32_16x16x32_bf16 v[56:59], v[36:39], v[36:39], v[56:59]
    ds_read_b64_tr_b16 v[114:115], v126 offset:12544
    v_mfma_f32_16x16x32_bf16 v[60:63], v[40:43], v[28:31], v[60:63]
    ds_read_b64_tr_b16 v[116:117], v127 offset:12288
    v_mfma_f32_16x16x32_bf16 v[64:67], v[40:43], v[32:35], v[64:67]
    ds_read_b64_tr_b16 v[118:119], v127 offset:12544
    v_mfma_f32_16x16x32_bf16 v[68:71], v[40:43], v[36:39], v[68:71]
    s_waitcnt lgkmcnt(8)
    v_mfma_f32_16x16x32_bf16 v[136:139], v[88:91], v[16:19], v[136:139]
    ds_read_b128 v[28:31], v129 offset:18432
    v_mfma_f32_16x16x32_bf16 v[160:163], v[88:91], v[20:23], v[160:163]
    ds_read_b128 v[32:35], v129 offset:20480
    v_mfma_f32_16x16x32_bf16 v[140:143], v[92:95], v[16:19], v[140:143]
    ds_read_b128 v[36:39], v131 offset:18432
    v_mfma_f32_16x16x32_bf16 v[164:167], v[92:95], v[20:23], v[164:167]
    ds_read_b64_tr_b16 v[88:89], v124 offset:18432
    v_mfma_f32_16x16x32_bf16 v[144:147], v[96:99], v[16:19], v[144:147]
    ds_read_b64_tr_b16 v[90:91], v124 offset:18688
    v_mfma_f32_16x16x32_bf16 v[168:171], v[96:99], v[20:23], v[168:171]
    ds_read_b64_tr_b16 v[92:93], v125 offset:18432
    v_mfma_f32_16x16x32_bf16 v[148:151], v[100:103], v[16:19], v[148:151]
    ds_read_b64_tr_b16 v[94:95], v125 offset:18688
    v_mfma_f32_16x16x32_bf16 v[172:175], v[100:103], v[20:23], v[172:175]
    ds_read_b64_tr_b16 v[96:97], v124 offset:20480
    s_waitcnt lgkmcnt(8)
    v_mfma_f32_16x16x32_bf16 v[152:155], v[16:19], v[104:107], v[152:155]
    ds_read_b64_tr_b16 v[98:99], v124 offset:20736
    v_mfma_f32_16x16x32_bf16 v[176:179], v[20:23], v[104:107], v[176:179]
    ds_read_b64_tr_b16 v[100:101], v125 offset:20480
    v_mfma_f32_16x16x32_bf16 v[156:159], v[16:19], v[108:111], v[156:159]
    ds_read_b64_tr_b16 v[102:103], v125 offset:20736
    v_mfma_f32_16x16x32_bf16 v[180:183], v[20:23], v[108:111], v[180:183]
    ds_read_b64_tr_b16 v[104:105], v124 offset:22528
    v_mfma_f32_16x16x32_bf16 v[184:187], v[112:115], v[24:27], v[184:187]
    ds_read_b64_tr_b16 v[106:107], v124 offset:22784
    v_mfma_f32_16x16x32_bf16 v[188:191], v[116:119], v[24:27], v[188:191]
    ds_read_b64_tr_b16 v[108:109], v125 offset:22528
    v_mfma_f32_16x16x32_bf16 v[48:51], v[16:19], v[16:19], v[48:51]
    ds_read_b64_tr_b16 v[110:111], v125 offset:22784
    v_mfma_f32_16x16x32_bf16 v[52:55], v[20:23], v[20:23], v[52:55]
    ds_read_b64_tr_b16 v[112:113], v126 offset:18432
    v_mfma_f32_16x16x32_bf16 v[56:59], v[24:27], v[24:27], v[56:59]
    ds_read_b64_tr_b16 v[114:115], v126 offset:18688
    v_mfma_f32_16x16x32_bf16 v[60:63], v[40:43], v[16:19], v[60:63]
    ds_read_b64_tr_b16 v[116:117], v127 offset:18432
    v_mfma_f32_16x16x32_bf16 v[64:67], v[40:43], v[20:23], v[64:67]
    ds_read_b64_tr_b16 v[118:119], v127 offset:18688
    v_mfma_f32_16x16x32_bf16 v[68:71], v[40:43], v[24:27], v[68:71]
    s_waitcnt vmcnt(3)
    s_barrier
    s_waitcnt lgkmcnt(8)
    v_mfma_f32_16x16x32_bf16 v[136:139], v[88:91], v[28:31], v[136:139]
    ds_read_b128 v[16:19], v128 offset:0
    v_mfma_f32_16x16x32_bf16 v[160:163], v[88:91], v[32:35], v[160:163]
    ds_read_b128 v[20:23], v128 offset:2048
    v_mfma_f32_16x16x32_bf16 v[140:143], v[92:95], v[28:31], v[140:143]
    ds_read_b128 v[24:27], v130 offset:0
    v_mfma_f32_16x16x32_bf16 v[164:167], v[92:95], v[32:35], v[164:167]
    ds_read_b64_tr_b16 v[88:89], v124 offset:24576
    v_mfma_f32_16x16x32_bf16 v[144:147], v[96:99], v[28:31], v[144:147]
    ds_read_b64_tr_b16 v[90:91], v124 offset:24832
    v_mfma_f32_16x16x32_bf16 v[168:171], v[96:99], v[32:35], v[168:171]
    ds_read_b64_tr_b16 v[92:93], v125 offset:24576
    v_mfma_f32_16x16x32_bf16 v[148:151], v[100:103], v[28:31], v[148:151]
    ds_read_b64_tr_b16 v[94:95], v125 offset:24832
    v_mfma_f32_16x16x32_bf16 v[172:175], v[100:103], v[32:35], v[172:175]
    ds_read_b64_tr_b16 v[96:97], v124 offset:26624
    s_waitcnt lgkmcnt(8)
    v_mfma_f32_16x16x32_bf16 v[152:155], v[28:31], v[104:107], v[152:155]
    ds_read_b64_tr_b16 v[98:99], v124 offset:26880
    v_mfma_f32_16x16x32_bf16 v[176:179], v[32:35], v[104:107], v[176:179]
    ds_read_b64_tr_b16 v[100:101], v125 offset:26624
    v_mfma_f32_16x16x32_bf16 v[156:159], v[28:31], v[108:111], v[156:159]
    ds_read_b64_tr_b16 v[102:103], v125 offset:26880
    v_mfma_f32_16x16x32_bf16 v[180:183], v[32:35], v[108:111], v[180:183]
    ds_read_b64_tr_b16 v[104:105], v124 offset:28672
    v_mfma_f32_16x16x32_bf16 v[184:187], v[112:115], v[36:39], v[184:187]
    ds_read_b64_tr_b16 v[106:107], v124 offset:28928
    v_mfma_f32_16x16x32_bf16 v[188:191], v[116:119], v[36:39], v[188:191]
    ds_read_b64_tr_b16 v[108:109], v125 offset:28672
    v_mfma_f32_16x16x32_bf16 v[48:51], v[28:31], v[28:31], v[48:51]
    ds_read_b64_tr_b16 v[110:111], v125 offset:28928
    v_mfma_f32_16x16x32_bf16 v[52:55], v[32:35], v[32:35], v[52:55]
    ds_read_b64_tr_b16 v[112:113], v126 offset:24576
    v_mfma_f32_16x16x32_bf16 v[56:59], v[36:39], v[36:39], v[56:59]
    ds_read_b64_tr_b16 v[114:115], v126 offset:24832
    v_mfma_f32_16x16x32_bf16 v[60:63], v[40:43], v[28:31], v[60:63]
    ds_read_b64_tr_b16 v[116:117], v127 offset:24576
    v_mfma_f32_16x16x32_bf16 v[64:67], v[40:43], v[32:35], v[64:67]
    ds_read_b64_tr_b16 v[118:119], v127 offset:24832
    v_mfma_f32_16x16x32_bf16 v[68:71], v[40:43], v[36:39], v[68:71]
    s_waitcnt lgkmcnt(8)
    v_mfma_f32_16x16x32_bf16 v[136:139], v[88:91], v[16:19], v[136:139]
    ds_read_b128 v[28:31], v129 offset:0
    v_mfma_f32_16x16x32_bf16 v[160:163], v[88:91], v[20:23], v[160:163]
    ds_read_b128 v[32:35], v129 offset:2048
    v_mfma_f32_16x16x32_bf16 v[140:143], v[92:95], v[16:19], v[140:143]
    ds_read_b128 v[36:39], v131 offset:0
    v_mfma_f32_16x16x32_bf16 v[164:167], v[92:95], v[20:23], v[164:167]
    ds_read_b64_tr_b16 v[88:89], v124 offset:30720
    v_mfma_f32_16x16x32_bf16 v[144:147], v[96:99], v[16:19], v[144:147]
    ds_read_b64_tr_b16 v[90:91], v124 offset:30976
    v_mfma_f32_16x16x32_bf16 v[168:171], v[96:99], v[20:23], v[168:171]
    ds_read_b64_tr_b16 v[92:93], v125 offset:30720
    v_mfma_f32_16x16x32_bf16 v[148:151], v[100:103], v[16:19], v[148:151]
    ds_read_b64_tr_b16 v[94:95], v125 offset:30976
    v_mfma_f32_16x16x32_bf16 v[172:175], v[100:103], v[20:23], v[172:175]
    ds_read_b64_tr_b16 v[96:97], v124 offset:32768
    s_waitcnt lgkmcnt(8)
    v_mfma_f32_16x16x32_bf16 v[152:155], v[16:19], v[104:107], v[152:155]
    ds_read_b64_tr_b16 v[98:99], v124 offset:33024
    v_mfma_f32_16x16x32_bf16 v[176:179], v[20:23], v[104:107], v[176:179]
    ds_read_b64_tr_b16 v[100:101], v125 offset:32768
    v_mfma_f32_16x16x32_bf16 v[156:159], v[16:19], v[108:111], v[156:159]
    ds_read_b64_tr_b16 v[102:103], v125 offset:33024
    v_mfma_f32_16x16x32_bf16 v[180:183], v[20:23], v[108:111], v[180:183]
    ds_read_b64_tr_b16 v[104:105], v124 offset:34816
    v_mfma_f32_16x16x32_bf16 v[184:187], v[112:115], v[24:27], v[184:187]
    ds_read_b64_tr_b16 v[106:107], v124 offset:35072
    v_mfma_f32_16x16x32_bf16 v[188:191], v[116:119], v[24:27], v[188:191]
    ds_read_b64_tr_b16 v[108:109], v125 offset:34816
    v_mfma_f32_16x16x32_bf16 v[48:51], v[16:19], v[16:19], v[48:51]
    ds_read_b64_tr_b16 v[110:111], v125 offset:35072
    v_mfma_f32_16x16x32_bf16 v[52:55], v[20:23], v[20:23], v[52:55]
    ds_read_b64_tr_b16 v[112:113], v126 offset:30720
    v_mfma_f32_16x16x32_bf16 v[56:59], v[24:27], v[24:27], v[56:59]
    ds_read_b64_tr_b16 v[114:115], v126 offset:30976
    v_mfma_f32_16x16x32_bf16 v[60:63], v[40:43], v[16:19], v[60:63]
    ds_read_b64_tr_b16 v[116:117], v127 offset:30720
    v_mfma_f32_16x16x32_bf16 v[64:67], v[40:43], v[20:23], v[64:67]
    ds_read_b64_tr_b16 v[118:119], v127 offset:30976
    v_mfma_f32_16x16x32_bf16 v[68:71], v[40:43], v[24:27], v[68:71]
    s_waitcnt lgkmcnt(8)
    v_mfma_f32_16x16x32_bf16 v[136:139], v[88:91], v[28:31], v[136:139]
    v_mfma_f32_16x16x32_bf16 v[160:163], v[88:91], v[32:35], v[160:163]
    v_mfma_f32_16x16x32_bf16 v[140:143], v[92:95], v[28:31], v[140:143]
    v_mfma_f32_16x16x32_bf16 v[164:167], v[92:95], v[32:35], v[164:167]
    v_mfma_f32_16x16x32_bf16 v[144:147], v[96:99], v[28:31], v[144:147]
    v_mfma_f32_16x16x32_bf16 v[168:171], v[96:99], v[32:35], v[168:171]
    v_mfma_f32_16x16x32_bf16 v[148:151], v[100:103], v[28:31], v[148:151]
    v_mfma_f32_16x16x32_bf16 v[172:175], v[100:103], v[32:35], v[172:175]
    s_waitcnt lgkmcnt(6)
    v_mfma_f32_16x16x32_bf16 v[152:155], v[28:31], v[104:107], v[152:155]
    v_mfma_f32_16x16x32_bf16 v[176:179], v[32:35], v[104:107], v[176:179]
    s_waitcnt lgkmcnt(4)
    v_mfma_f32_16x16x32_bf16 v[156:159], v[28:31], v[108:111], v[156:159]
    v_mfma_f32_16x16x32_bf16 v[180:183], v[32:35], v[108:111], v[180:183]
    s_waitcnt lgkmcnt(2)
    v_mfma_f32_16x16x32_bf16 v[184:187], v[112:115], v[36:39], v[184:187]
    s_waitcnt lgkmcnt(0)
    v_mfma_f32_16x16x32_bf16 v[188:191], v[116:119], v[36:39], v[188:191]
    v_mfma_f32_16x16x32_bf16 v[48:51], v[28:31], v[28:31], v[48:51]
    v_mfma_f32_16x16x32_bf16 v[52:55], v[32:35], v[32:35], v[52:55]
    v_mfma_f32_16x16x32_bf16 v[56:59], v[36:39], v[36:39], v[56:59]
    v_mfma_f32_16x16x32_bf16 v[60:63], v[40:43], v[28:31], v[60:63]
    v_mfma_f32_16x16x32_bf16 v[64:67], v[40:43], v[32:35], v[64:67]
    v_mfma_f32_16x16x32_bf16 v[68:71], v[40:43], v[36:39], v[68:71]
    s_mov_b32 exec_lo, 0x00010001
    s_mov_b32 exec_hi, 0x00010001
    ds_write_b128 v73, v[184:187] offset:128
    ds_write_b128 v74, v[188:191] offset:0
    s_mov_b64 exec, -1
    v_cndmask_b32 v48, v48, v49, s[88:89]
    v_cndmask_b32 v52, v52, v53, s[88:89]
    v_cndmask_b32 v56, v56, v57, s[88:89]
    v_cndmask_b32 v48, v48, v50, s[90:91]
    v_cndmask_b32 v52, v52, v54, s[90:91]
    v_cndmask_b32 v56, v56, v58, s[90:91]
    v_cndmask_b32 v48, v48, v51, s[92:93]
    v_cndmask_b32 v52, v52, v55, s[92:93]
    v_cndmask_b32 v56, v56, v59, s[92:93]
    v_mul_f32 v25, 0x3b124925, v60
    v_mul_f32 v27, 0x3b124925, v64
    v_mul_f32 v29, 0x3b124925, v68
    v_mul_f32 v24, v25, v25
    v_mul_f32 v26, v27, v27
    v_mul_f32 v28, v29, v29
    v_mul_f32 v48, 0x3b124925, v48
    v_mul_f32 v52, 0x3b124925, v52
    v_mul_f32 v56, 0x3b124925, v56
    v_sub_f32 v24, v48, v24
    v_sub_f32 v26, v52, v26
    v_sub_f32 v28, v56, v28
    v_max_f32 v24, 0, v24
    v_max_f32 v26, 0, v26
    v_max_f32 v28, 0, v28
    v_add_f32 v24, 0x3727c5ac, v24
    v_add_f32 v26, 0x3727c5ac, v26
    v_add_f32 v28, 0x3727c5ac, v28
    v_rsq_f32 v24, v24
    v_rsq_f32 v26, v26
    v_rsq_f32 v28, v28
    s_mov_b32 exec_lo, 0x00f0000f
    s_mov_b32 exec_hi, 0xf0000f00
    ds_write2_b32 v75, v24, v25 offset0:128 offset1:144
    ds_write2_b32 v75, v26, v27 offset0:160 offset1:176
    ds_write2_b32 v75, v28, v29 offset0:192 offset1:208
    s_mov_b64 exec, -1
    v_mov_b32_dpp v16, v184 row_newbcast:0 row_mask:0xf bank_mask:0xf
    v_mov_b32_dpp v17, v185 row_newbcast:0 row_mask:0xf bank_mask:0xf
    v_mov_b32_dpp v18, v186 row_newbcast:0 row_mask:0xf bank_mask:0xf
    v_mov_b32_dpp v19, v187 row_newbcast:0 row_mask:0xf bank_mask:0xf
    v_pk_fma_f32 v[16:17], v[16:17], v[28:29], v[184:185] op_sel:[0,1,0] op_sel_hi:[1,1,1] neg_lo:[0,1,0] neg_hi:[0,1,0]
    v_pk_fma_f32 v[18:19], v[18:19], v[28:29], v[186:187] op_sel:[0,1,0] op_sel_hi:[1,1,1] neg_lo:[0,1,0] neg_hi:[0,1,0]
    s_cmp_eq_u32 s49, 15
    s_cselect_b32 s88, 0xffff0000, -1
    s_mov_b32 s89, -1
    s_mov_b32 s90, -1
    s_cselect_b32 s91, -1, 0xffff
    s_waitcnt lgkmcnt(0)
    s_barrier
    ds_read_b32 v26, v75 offset:640
    ds_read_b32 v28, v75 offset:768
    ds_read_b32 v24, v75 offset:512
    ds_read_b128 v[56:59], v72 offset:128
    ds_read_b128 v[60:63], v72 offset:192
    ds_read_b32 v64, v77 offset:256
    ds_read_b32 v65, v77 offset:320
    ds_read_b128 v[44:47], v76 offset:704
    ds_read_b128 v[40:43], v76 offset:640
    ds_read_b128 v[36:39], v76 offset:576
    ds_read_b128 v[32:35], v76 offset:512
    ds_read_b128 v[48:51], v72 offset:0
    ds_read_b128 v[52:55], v72 offset:64
    s_waitcnt lgkmcnt(9)
    v_pk_fma_f32 v[168:169], v[56:57], v[26:27], v[168:169] op_sel:[0,1,0] op_sel_hi:[1,1,1] neg_lo:[0,1,0] neg_hi:[0,1,0]
    v_pk_fma_f32 v[170:171], v[58:59], v[26:27], v[170:171] op_sel:[0,1,0] op_sel_hi:[1,1,1] neg_lo:[0,1,0] neg_hi:[0,1,0]
    v_pk_mul_f32 v[168:169], v[168:169], v[26:27] op_sel:[0,0] op_sel_hi:[1,0]
    v_pk_mul_f32 v[170:171], v[170:171], v[26:27] op_sel:[0,0] op_sel_hi:[1,0]
    v_cvt_pk_bf16_f32 v104, v168, v169
    v_cvt_pk_bf16_f32 v105, v170, v171
    s_waitcnt lgkmcnt(8)
    v_pk_fma_f32 v[172:173], v[60:61], v[26:27], v[172:173] op_sel:[0,1,0] op_sel_hi:[1,1,1] neg_lo:[0,1,0] neg_hi:[0,1,0]
    v_pk_fma_f32 v[174:175], v[62:63], v[26:27], v[174:175] op_sel:[0,1,0] op_sel_hi:[1,1,1] neg_lo:[0,1,0] neg_hi:[0,1,0]
    v_pk_mul_f32 v[172:173], v[172:173], v[26:27] op_sel:[0,0] op_sel_hi:[1,0]
    v_pk_mul_f32 v[174:175], v[174:175], v[26:27] op_sel:[0,0] op_sel_hi:[1,0]
    v_cvt_pk_bf16_f32 v106, v172, v173
    v_cvt_pk_bf16_f32 v107, v174, v175
    ds_write_b128 v78, v[104:107] offset:4096
    v_pk_mul_f32 v[16:17], v[16:17], v[28:29] op_sel_hi:[1,0]
    v_pk_mul_f32 v[18:19], v[18:19], v[28:29] op_sel_hi:[1,0]
    v_cvt_pk_bf16_f32 v16, v16, v17
    v_cvt_pk_bf16_f32 v18, v18, v19
    ds_write_b16 v80, v16 offset:2048
    ds_write_b16_d16_hi v81, v16 offset:2048
    ds_write_b16 v82, v18 offset:2048
    ds_write_b16_d16_hi v83, v18 offset:2048
    s_waitcnt lgkmcnt(10)
    v_pk_fma_f32 v[176:177], v[44:45], v[64:65], v[176:177] op_sel:[0,0,0] op_sel_hi:[1,0,1] neg_lo:[0,1,0] neg_hi:[0,1,0]
    v_pk_fma_f32 v[178:179], v[46:47], v[64:65], v[178:179] op_sel:[0,0,0] op_sel_hi:[1,0,1] neg_lo:[0,1,0] neg_hi:[0,1,0]
    s_waitcnt lgkmcnt(9)
    v_pk_mul_f32 v[176:177], v[176:177], v[40:41]
    v_pk_mul_f32 v[178:179], v[178:179], v[42:43]
    v_cvt_pk_bf16_f32 v112, v176, v177
    v_cvt_pk_bf16_f32 v113, v178, v179
    v_pk_fma_f32 v[180:181], v[44:45], v[64:65], v[180:181] op_sel:[0,1,0] op_sel_hi:[1,1,1] neg_lo:[0,1,0] neg_hi:[0,1,0]
    v_pk_fma_f32 v[182:183], v[46:47], v[64:65], v[182:183] op_sel:[0,1,0] op_sel_hi:[1,1,1] neg_lo:[0,1,0] neg_hi:[0,1,0]
    v_pk_mul_f32 v[180:181], v[180:181], v[40:41]
    v_pk_mul_f32 v[182:183], v[182:183], v[42:43]
    v_cvt_pk_bf16_f32 v118, v180, v181
    v_cvt_pk_bf16_f32 v119, v182, v183
    ds_write_b64 v78, v[112:113] offset:5120
    ds_write_b64 v78, v[118:119] offset:5128
    v_mul_f32 v68, 0x3e8b97f6, v24
    v_mul_f32 v70, 0x3e8b97f6, v26
    v_cndmask_b32 v69, 0, v68, s[90:91]
    v_cndmask_b32 v68, 0, v68, s[88:89]
    v_cndmask_b32 v71, 0, v70, s[90:91]
    v_cndmask_b32 v70, 0, v70, s[88:89]
    v_pk_fma_f32 v[144:145], v[56:57], v[24:25], v[144:145] op_sel:[0,1,0] op_sel_hi:[1,1,1] neg_lo:[0,1,0] neg_hi:[0,1,0]
    v_pk_fma_f32 v[146:147], v[58:59], v[24:25], v[146:147] op_sel:[0,1,0] op_sel_hi:[1,1,1] neg_lo:[0,1,0] neg_hi:[0,1,0]
    v_pk_mul_f32 v[144:145], v[144:145], v[24:25] op_sel:[0,0] op_sel_hi:[1,0]
    v_pk_mul_f32 v[146:147], v[146:147], v[24:25] op_sel:[0,0] op_sel_hi:[1,0]
    v_cvt_pk_bf16_f32 v100, v144, v145
    v_cvt_pk_bf16_f32 v101, v146, v147
    v_pk_fma_f32 v[148:149], v[60:61], v[24:25], v[148:149] op_sel:[0,1,0] op_sel_hi:[1,1,1] neg_lo:[0,1,0] neg_hi:[0,1,0]
    v_pk_fma_f32 v[150:151], v[62:63], v[24:25], v[150:151] op_sel:[0,1,0] op_sel_hi:[1,1,1] neg_lo:[0,1,0] neg_hi:[0,1,0]
    v_pk_mul_f32 v[148:149], v[148:149], v[24:25] op_sel:[0,0] op_sel_hi:[1,0]
    v_pk_mul_f32 v[150:151], v[150:151], v[24:25] op_sel:[0,0] op_sel_hi:[1,0]
    v_cvt_pk_bf16_f32 v102, v148, v149
    v_cvt_pk_bf16_f32 v103, v150, v151
    s_waitcnt lgkmcnt(0)
    s_barrier
    ds_read_b128 v[96:99], v78 offset:2048
    ds_read_b64 v[108:109], v78 offset:3072
    ds_read_b64 v[114:115], v78 offset:3080
    v_pk_fma_f32 v[160:161], v[48:49], v[26:27], v[160:161] op_sel:[0,1,0] op_sel_hi:[1,1,1] neg_lo:[0,1,0] neg_hi:[0,1,0]
    v_pk_fma_f32 v[162:163], v[50:51], v[26:27], v[162:163] op_sel:[0,1,0] op_sel_hi:[1,1,1] neg_lo:[0,1,0] neg_hi:[0,1,0]
    v_pk_mul_f32 v[160:161], v[160:161], v[70:71] op_sel:[0,0] op_sel_hi:[1,0]
    v_pk_mul_f32 v[162:163], v[162:163], v[70:71] op_sel:[0,0] op_sel_hi:[1,0]
    v_cvt_pk_bf16_f32 v92, v160, v161
    v_cvt_pk_bf16_f32 v93, v162, v163
    v_pk_fma_f32 v[164:165], v[52:53], v[26:27], v[164:165] op_sel:[0,1,0] op_sel_hi:[1,1,1] neg_lo:[0,1,0] neg_hi:[0,1,0]
    v_pk_fma_f32 v[166:167], v[54:55], v[26:27], v[166:167] op_sel:[0,1,0] op_sel_hi:[1,1,1] neg_lo:[0,1,0] neg_hi:[0,1,0]
    v_pk_mul_f32 v[164:165], v[164:165], v[70:71] op_sel:[0,1] op_sel_hi:[1,1]
    v_pk_mul_f32 v[166:167], v[166:167], v[70:71] op_sel:[0,1] op_sel_hi:[1,1]
    v_cvt_pk_bf16_f32 v94, v164, v165
    v_cvt_pk_bf16_f32 v95, v166, v167
    s_nop 1
    v_mfma_f32_16x16x32_bf16 v[128:131], v[100:103], v[92:95], v[240:243]
    v_mfma_f32_16x16x32_bf16 v[132:135], v[104:107], v[92:95], v[244:247]
    v_pk_fma_f32 v[136:137], v[48:49], v[24:25], v[136:137] op_sel:[0,1,0] op_sel_hi:[1,1,1] neg_lo:[0,1,0] neg_hi:[0,1,0]
    v_pk_fma_f32 v[138:139], v[50:51], v[24:25], v[138:139] op_sel:[0,1,0] op_sel_hi:[1,1,1] neg_lo:[0,1,0] neg_hi:[0,1,0]
    v_pk_mul_f32 v[136:137], v[136:137], v[68:69] op_sel:[0,0] op_sel_hi:[1,0]
    v_pk_mul_f32 v[138:139], v[138:139], v[68:69] op_sel:[0,0] op_sel_hi:[1,0]
    v_cvt_pk_bf16_f32 v88, v136, v137
    v_cvt_pk_bf16_f32 v89, v138, v139
    v_pk_fma_f32 v[140:141], v[52:53], v[24:25], v[140:141] op_sel:[0,1,0] op_sel_hi:[1,1,1] neg_lo:[0,1,0] neg_hi:[0,1,0]
    v_pk_fma_f32 v[142:143], v[54:55], v[24:25], v[142:143] op_sel:[0,1,0] op_sel_hi:[1,1,1] neg_lo:[0,1,0] neg_hi:[0,1,0]
    v_pk_mul_f32 v[140:141], v[140:141], v[68:69] op_sel:[0,1] op_sel_hi:[1,1]
    v_pk_mul_f32 v[142:143], v[142:143], v[68:69] op_sel:[0,1] op_sel_hi:[1,1]
    v_cvt_pk_bf16_f32 v90, v140, v141
    v_cvt_pk_bf16_f32 v91, v142, v143
    s_waitcnt lgkmcnt(2)
    s_nop 0
    v_mfma_f32_16x16x32_bf16 v[120:123], v[96:99], v[88:91], v[248:251]
    v_mfma_f32_16x16x32_bf16 v[124:127], v[100:103], v[88:91], v[244:247]
    v_pk_fma_f32 v[152:153], v[36:37], v[64:65], v[152:153] op_sel:[0,0,0] op_sel_hi:[1,0,1] neg_lo:[0,1,0] neg_hi:[0,1,0]
    v_pk_fma_f32 v[154:155], v[38:39], v[64:65], v[154:155] op_sel:[0,0,0] op_sel_hi:[1,0,1] neg_lo:[0,1,0] neg_hi:[0,1,0]
    v_pk_mul_f32 v[152:153], v[152:153], v[32:33]
    v_pk_mul_f32 v[154:155], v[154:155], v[34:35]
    v_cvt_pk_bf16_f32 v110, v152, v153
    v_cvt_pk_bf16_f32 v111, v154, v155
    v_pk_fma_f32 v[156:157], v[36:37], v[64:65], v[156:157] op_sel:[0,1,0] op_sel_hi:[1,1,1] neg_lo:[0,1,0] neg_hi:[0,1,0]
    v_pk_fma_f32 v[158:159], v[38:39], v[64:65], v[158:159] op_sel:[0,1,0] op_sel_hi:[1,1,1] neg_lo:[0,1,0] neg_hi:[0,1,0]
    v_pk_mul_f32 v[156:157], v[156:157], v[32:33]
    v_pk_mul_f32 v[158:159], v[158:159], v[34:35]
    v_cvt_pk_bf16_f32 v116, v156, v157
    v_cvt_pk_bf16_f32 v117, v158, v159
    v_max3_f32 v137, v128, v129, v130
    v_max3_f32 v139, v131, v132, v133
    v_max3_f32 v137, v137, v134, v135
    v_max_f32 v137, v137, v139
    v_max3_f32 v136, v120, v121, v122
    v_max3_f32 v138, v123, v124, v125
    v_max3_f32 v136, v136, v126, v127
    v_max_f32 v136, v136, v138
    v_mov_b32 v138, v136
    v_mov_b32 v139, v137
    s_nop 0
    v_permlane32_swap_b32 v136, v138
    v_permlane32_swap_b32 v137, v139
    v_max_f32 v136, v136, v138
    v_max_f32 v137, v137, v139
    v_mov_b32 v138, v136
    v_mov_b32 v139, v137
    s_nop 0
    v_permlane16_swap_b32 v136, v138
    v_permlane16_swap_b32 v137, v139
    v_max_f32 v136, v136, v138
    v_max_f32 v137, v137, v139
    v_pk_add_f32 v[128:129], v[128:129], v[136:137] op_sel:[0,1] op_sel_hi:[1,1] neg_lo:[0,1] neg_hi:[0,1]
    v_pk_add_f32 v[130:131], v[130:131], v[136:137] op_sel:[0,1] op_sel_hi:[1,1] neg_lo:[0,1] neg_hi:[0,1]
    v_pk_add_f32 v[132:133], v[132:133], v[136:137] op_sel:[0,1] op_sel_hi:[1,1] neg_lo:[0,1] neg_hi:[0,1]
    v_pk_add_f32 v[134:135], v[134:135], v[136:137] op_sel:[0,1] op_sel_hi:[1,1] neg_lo:[0,1] neg_hi:[0,1]
    v_exp_f32 v128, v128
    v_exp_f32 v129, v129
    v_exp_f32 v130, v130
    v_exp_f32 v131, v131
    v_exp_f32 v132, v132
    v_exp_f32 v133, v133
    v_exp_f32 v134, v134
    v_exp_f32 v135, v135
    v_cvt_pk_bf16_f32 v148, v128, v129
    v_cvt_pk_bf16_f32 v149, v130, v131
    v_cvt_pk_bf16_f32 v150, v132, v133
    v_cvt_pk_bf16_f32 v151, v134, v135
    s_nop 1
    v_mfma_f32_16x16x32_bf16 v[160:163], v[110:113], v[148:151], 0
    v_mfma_f32_16x16x32_bf16 v[164:167], v[116:119], v[148:151], 0
    v_pk_add_f32 v[120:121], v[120:121], v[136:137] op_sel:[0,0] op_sel_hi:[1,0] neg_lo:[0,1] neg_hi:[0,1]
    v_pk_add_f32 v[122:123], v[122:123], v[136:137] op_sel:[0,0] op_sel_hi:[1,0] neg_lo:[0,1] neg_hi:[0,1]
    v_pk_add_f32 v[124:125], v[124:125], v[136:137] op_sel:[0,0] op_sel_hi:[1,0] neg_lo:[0,1] neg_hi:[0,1]
    v_pk_add_f32 v[126:127], v[126:127], v[136:137] op_sel:[0,0] op_sel_hi:[1,0] neg_lo:[0,1] neg_hi:[0,1]
    v_exp_f32 v120, v120
    v_exp_f32 v121, v121
    v_exp_f32 v122, v122
    v_exp_f32 v123, v123
    v_exp_f32 v124, v124
    v_exp_f32 v125, v125
    v_exp_f32 v126, v126
    v_exp_f32 v127, v127
    v_cvt_pk_bf16_f32 v144, v120, v121
    v_cvt_pk_bf16_f32 v145, v122, v123
    v_cvt_pk_bf16_f32 v146, v124, v125
    v_cvt_pk_bf16_f32 v147, v126, v127
    s_waitcnt lgkmcnt(1)
    s_nop 0
    v_mfma_f32_16x16x32_bf16 v[152:155], v[108:111], v[144:147], 0
    s_waitcnt lgkmcnt(0)
    v_mfma_f32_16x16x32_bf16 v[156:159], v[114:117], v[144:147], 0
    v_pk_add_f32 v[120:121], v[120:121], v[122:123]
    v_pk_add_f32 v[124:125], v[124:125], v[126:127]
    v_pk_add_f32 v[128:129], v[128:129], v[130:131]
    v_pk_add_f32 v[132:133], v[132:133], v[134:135]
    v_pk_add_f32 v[120:121], v[120:121], v[124:125]
    v_pk_add_f32 v[128:129], v[128:129], v[132:133]
    v_add_f32 v140, v120, v121
    v_add_f32 v142, v128, v129
    v_mov_b32 v138, v140
    v_mov_b32 v139, v142
    s_nop 0
    v_permlane32_swap_b32 v140, v138
    v_permlane32_swap_b32 v142, v139
    v_add_f32 v140, v140, v138
    v_add_f32 v142, v142, v139
    v_mov_b32 v138, v140
    v_mov_b32 v139, v142
    s_nop 0
    v_permlane16_swap_b32 v140, v138
    v_permlane16_swap_b32 v142, v139
    v_add_f32 v140, v140, v138
    v_add_f32 v142, v142, v139
    v_rcp_f32 v140, v140
    v_rcp_f32 v142, v142
    v_cndmask_b32 v141, 0, v140, s[90:91]
    v_cndmask_b32 v140, 0, v140, s[88:89]
    v_cndmask_b32 v143, 0, v142, s[90:91]
    v_cndmask_b32 v142, 0, v142, s[88:89]
    v_pk_mul_f32 v[152:153], v[152:153], v[140:141] op_sel_hi:[1,0]
    v_pk_mul_f32 v[154:155], v[154:155], v[140:141] op_sel_hi:[1,0]
    v_pk_mul_f32 v[156:157], v[156:157], v[140:141] op_sel:[0,1] op_sel_hi:[1,1]
    v_pk_mul_f32 v[158:159], v[158:159], v[140:141] op_sel:[0,1] op_sel_hi:[1,1]
    v_cvt_pk_bf16_f32 v144, v152, v153
    v_cvt_pk_bf16_f32 v145, v154, v155
    v_cvt_pk_bf16_f32 v146, v156, v157
    v_cvt_pk_bf16_f32 v147, v158, v159
    buffer_store_dwordx4 v[144:147], v4, s[40:43], s62 offen sc1
    v_pk_mul_f32 v[160:161], v[160:161], v[142:143] op_sel_hi:[1,0]
    v_pk_mul_f32 v[162:163], v[162:163], v[142:143] op_sel_hi:[1,0]
    v_pk_mul_f32 v[164:165], v[164:165], v[142:143] op_sel:[0,1] op_sel_hi:[1,1]
    v_pk_mul_f32 v[166:167], v[166:167], v[142:143] op_sel:[0,1] op_sel_hi:[1,1]
    v_cvt_pk_bf16_f32 v148, v160, v161
    v_cvt_pk_bf16_f32 v149, v162, v163
    v_cvt_pk_bf16_f32 v150, v164, v165
    v_cvt_pk_bf16_f32 v151, v166, v167
    buffer_store_dwordx4 v[148:151], v4, s[40:43], s63 offen sc1
    s_add_u32 m0, s59, 0
    s_mov_b32 s73, 0
    buffer_load_dwordx4 v208, s[16:19], s73 offen lds
    s_add_u32 m0, s59, 1024
    s_mov_b32 s73, 7168
    buffer_load_dwordx4 v208, s[16:19], s73 offen lds
    s_add_u32 m0, s59, 2048
    s_mov_b32 s73, 14336
    buffer_load_dwordx4 v208, s[16:19], s73 offen lds
    s_add_u32 m0, s59, 3072
    s_mov_b32 s73, 21504
    buffer_load_dwordx4 v208, s[16:19], s73 offen lds
    s_add_u32 m0, s59, 4096
    s_mov_b32 s73, 28672
    buffer_load_dwordx4 v208, s[16:19], s73 offen lds
    s_add_u32 m0, s59, 5120
    s_mov_b32 s73, 35840
    buffer_load_dwordx4 v208, s[16:19], s73 offen lds
    s_add_u32 m0, s59, 6144
    s_mov_b32 s73, 43008
    buffer_load_dwordx4 v208, s[16:19], s73 offen lds
    s_add_u32 m0, s59, 7168
    s_mov_b32 s73, 50176
    buffer_load_dwordx4 v208, s[16:19], s73 offen lds
    s_add_u32 m0, s59, 8192
    s_mov_b32 s73, 57344
    buffer_load_dwordx4 v208, s[16:19], s73 offen lds
    s_add_u32 m0, s59, 9216
    s_mov_b32 s73, 64512
    buffer_load_dwordx4 v208, s[16:19], s73 offen lds
    s_add_u32 m0, s59, 10240
    s_mov_b32 s73, 71680
    buffer_load_dwordx4 v208, s[16:19], s73 offen lds
    s_add_u32 m0, s59, 11264
    s_mov_b32 s73, 78848
    buffer_load_dwordx4 v208, s[16:19], s73 offen lds
    s_add_u32 m0, s59, 12288
    s_mov_b32 s73, 86016
    buffer_load_dwordx4 v208, s[16:19], s73 offen lds
    s_add_u32 m0, s59, 13312
    s_mov_b32 s73, 93184
    buffer_load_dwordx4 v208, s[16:19], s73 offen lds
    s_waitcnt vmcnt(18)
    v_readfirstlane_b32 s4, v6
    s_nop 1
    s_cmp_lg_u32 s4, 0
    s_cbranch_scc1 Lepd_P_2
    s_nop 0
Lepg_P_1:
    s_sub_u32 s6, s6, 1
    s_cbranch_scc1 L_end_P
    buffer_load_dword v6, v7, s[44:47], 0 offen sc1
    s_waitcnt vmcnt(0)
    v_readfirstlane_b32 s4, v6
    s_nop 1
    s_cmp_eq_u32 s4, 0
    s_cbranch_scc1 Lepg_P_1
Lepd_P_2:
    s_waitcnt vmcnt(14)
    v_mov_b32 v8, s4
    s_mov_b64 exec, 1
    buffer_store_dword v8, v9, s[40:43], s80 offen sc1
    s_mov_b64 exec, -1
    s_cmp_lt_u32 s67, 99
    s_cbranch_scc1 Lnotag_P_3
    s_lshr_b32 s68, s2, 3
    s_sub_u32 s68, s68, 28
    s_lshl_b32 s68, s68, 2
    s_add_u32 s68, s68, s3
    s_lshl_b32 s68, s68, 16
    s_and_b32 s69, s2, 7
    s_lshl_b32 s69, s69, 9
    s_add_u32 s68, s68, s69
    v_lshrrev_b32 v16, 2, v1
    v_lshlrev_b32 v16, 12, v16
    v_and_b32 v17, 3, v1
    v_lshl_add_u32 v16, v17, 7, v16
    buffer_load_dword v18, v16, s[24:27], s68 offen
    s_add_u32 s68, s68, 0x100000
    s_waitcnt vmcnt(3)
    buffer_load_dword v19, v16, s[24:27], s68 offen
    s_add_u32 s68, s68, 0x100000
    s_waitcnt vmcnt(3)
    buffer_load_dword v20, v16, s[24:27], s68 offen
    s_add_u32 s68, s68, 0x100000
    s_waitcnt vmcnt(3)
    buffer_load_dword v21, v16, s[24:27], s68 offen
    s_add_u32 s68, s68, 0x100000
    s_waitcnt vmcnt(3)
    buffer_load_dword v22, v16, s[24:27], s68 offen
    s_add_u32 s68, s68, 0x100000
    s_waitcnt vmcnt(3)
    buffer_load_dword v23, v16, s[24:27], s68 offen
    s_add_u32 s68, s68, 0x100000
    s_waitcnt vmcnt(3)
    buffer_load_dword v24, v16, s[24:27], s68 offen
    s_add_u32 s68, s68, 0x100000
    s_waitcnt vmcnt(3)
    s_waitcnt vmcnt(0)
    s_branch L_end_P
Lnotag_P_3:
    v_lshrrev_b32 v221, 5, v1
    v_mul_u32_u24 v221, 3584, v221
    v_and_b32 v222, 31, v1
    v_lshl_add_u32 v221, v222, 1, v221
    s_lshl_b32 s58, s67, 1
    s_lshr_b32 s60, s3, 1
    s_add_u32 s58, s58, s60
    s_mul_i32 s58, s58, 28672
    s_lshl_b32 s60, s66, 7
    s_add_u32 s58, s58, s60
    s_and_b32 s60, s3, 1
    s_lshl_b32 s60, s60, 6
    s_add_u32 s58, s58, s60
    buffer_load_ushort v192, v221, s[8:11], s58 offen offset:0
    buffer_load_ushort v193, v221, s[8:11], s58 offen offset:896
    buffer_load_ushort v194, v221, s[8:11], s58 offen offset:1792
    buffer_load_ushort v195, v221, s[8:11], s58 offen offset:2688
    s_add_u32 s58, s58, 7168
    buffer_load_ushort v196, v221, s[8:11], s58 offen offset:0
    buffer_load_ushort v197, v221, s[8:11], s58 offen offset:896
    buffer_load_ushort v198, v221, s[8:11], s58 offen offset:1792
    buffer_load_ushort v199, v221, s[8:11], s58 offen offset:2688
    s_add_u32 s58, s58, 7168
    buffer_load_ushort v200, v221, s[8:11], s58 offen offset:0
    buffer_load_ushort v201, v221, s[8:11], s58 offen offset:896
    buffer_load_ushort v202, v221, s[8:11], s58 offen offset:1792
    buffer_load_ushort v203, v221, s[8:11], s58 offen offset:2688
    s_add_u32 s58, s58, 7168
    buffer_load_ushort v204, v221, s[8:11], s58 offen offset:0
    buffer_load_ushort v205, v221, s[8:11], s58 offen offset:896
    buffer_load_ushort v206, v221, s[8:11], s58 offen offset:1792
    buffer_load_ushort v207, v221, s[8:11], s58 offen offset:2688
    s_and_b32 s68, s2, 7
    s_cmp_ge_u32 s68, 7
    s_cselect_b32 s48, 7, 0
    s_sub_u32 s68, s68, s48
    s_lshl_b32 s48, s68, 12
    s_add_u32 s68, s68, 1
    s_cmp_ge_u32 s68, 7
    s_cselect_b32 s49, 7, 0
    s_sub_u32 s68, s68, s49
    s_lshl_b32 s49, s68, 12
    s_add_u32 s68, s68, 1
    s_cmp_ge_u32 s68, 7
    s_cselect_b32 s50, 7, 0
    s_sub_u32 s68, s68, s50
    s_lshl_b32 s50, s68, 12
    s_add_u32 s68, s68, 1
    s_cmp_ge_u32 s68, 7
    s_cselect_b32 s51, 7, 0
    s_sub_u32 s68, s68, s51
    s_lshl_b32 s51, s68, 12
    s_add_u32 s68, s68, 1
    s_cmp_ge_u32 s68, 7
    s_cselect_b32 s52, 7, 0
    s_sub_u32 s68, s68, s52
    s_lshl_b32 s52, s68, 12
    s_add_u32 s68, s68, 1
    s_cmp_ge_u32 s68, 7
    s_cselect_b32 s53, 7, 0
    s_sub_u32 s68, s68, s53
    s_lshl_b32 s53, s68, 12
    s_add_u32 s68, s68, 1
    s_cmp_ge_u32 s68, 7
    s_cselect_b32 s54, 7, 0
    s_sub_u32 s68, s68, s54
    s_lshl_b32 s54, s68, 12
    s_waitcnt vmcnt(17)
    s_barrier
    ds_read_b64_tr_b16 a[0:1], v209 offset:0
    ds_read_b64_tr_b16 a[2:3], v209 offset:2048
    ds_read_b64_tr_b16 a[4:5], v209 offset:1024
    ds_read_b64_tr_b16 a[6:7], v209 offset:3072
    ds_read_b64_tr_b16 a[8:9], v209 offset:3584
    ds_read_b64_tr_b16 a[10:11], v209 offset:5632
    ds_read_b64_tr_b16 a[12:13], v209 offset:4608
    ds_read_b64_tr_b16 a[14:15], v209 offset:6656
    ds_read_b64_tr_b16 a[16:17], v209 offset:7168
    ds_read_b64_tr_b16 a[18:19], v209 offset:9216
    ds_read_b64_tr_b16 a[20:21], v209 offset:8192
    ds_read_b64_tr_b16 a[22:23], v209 offset:10240
    ds_read_b64_tr_b16 a[24:25], v209 offset:10752
    ds_read_b64_tr_b16 a[26:27], v209 offset:12800
    ds_read_b64_tr_b16 a[28:29], v209 offset:11776
    ds_read_b64_tr_b16 a[30:31], v209 offset:13824
    ds_read_b64_tr_b16 a[32:33], v209 offset:14336
    ds_read_b64_tr_b16 a[34:35], v209 offset:16384
    ds_read_b64_tr_b16 a[36:37], v209 offset:15360
    ds_read_b64_tr_b16 a[38:39], v209 offset:17408
    ds_read_b64_tr_b16 a[40:41], v209 offset:17920
    ds_read_b64_tr_b16 a[42:43], v209 offset:19968
    ds_read_b64_tr_b16 a[44:45], v209 offset:18944
    ds_read_b64_tr_b16 a[46:47], v209 offset:20992
    ds_read_b64_tr_b16 a[48:49], v209 offset:21504
    ds_read_b64_tr_b16 a[50:51], v209 offset:23552
    ds_read_b64_tr_b16 a[52:53], v209 offset:22528
    ds_read_b64_tr_b16 a[54:55], v209 offset:24576
    ds_read_b64_tr_b16 a[56:57], v209 offset:25088
    ds_read_b64_tr_b16 a[58:59], v209 offset:27136
    ds_read_b64_tr_b16 a[60:61], v209 offset:26112
    ds_read_b64_tr_b16 a[62:63], v209 offset:28160
    ds_read_b64_tr_b16 a[64:65], v209 offset:28672
    ds_read_b64_tr_b16 a[66:67], v209 offset:30720
    ds_read_b64_tr_b16 a[68:69], v209 offset:29696
    ds_read_b64_tr_b16 a[70:71], v209 offset:31744
    ds_read_b64_tr_b16 a[72:73], v209 offset:32256
    ds_read_b64_tr_b16 a[74:75], v209 offset:34304
    ds_read_b64_tr_b16 a[76:77], v209 offset:33280
    ds_read_b64_tr_b16 a[78:79], v209 offset:35328
    ds_read_b64_tr_b16 a[80:81], v209 offset:35840
    ds_read_b64_tr_b16 a[82:83], v209 offset:37888
    ds_read_b64_tr_b16 a[84:85], v209 offset:36864
    ds_read_b64_tr_b16 a[86:87], v209 offset:38912
    ds_read_b64_tr_b16 a[88:89], v209 offset:39424
    ds_read_b64_tr_b16 a[90:91], v209 offset:41472
    ds_read_b64_tr_b16 a[92:93], v209 offset:40448
    ds_read_b64_tr_b16 a[94:95], v209 offset:42496
    ds_read_b64_tr_b16 a[96:97], v209 offset:43008
    ds_read_b64_tr_b16 a[98:99], v209 offset:45056
    ds_read_b64_tr_b16 a[100:101], v209 offset:44032
    ds_read_b64_tr_b16 a[102:103], v209 offset:46080
    ds_read_b64_tr_b16 a[104:105], v209 offset:46592
    ds_read_b64_tr_b16 a[106:107], v209 offset:48640
    ds_read_b64_tr_b16 a[108:109], v209 offset:47616
    ds_read_b64_tr_b16 a[110:111], v209 offset:49664
    ds_read_b64_tr_b16 a[112:113], v209 offset:50176
    ds_read_b64_tr_b16 a[114:115], v209 offset:52224
    ds_read_b64_tr_b16 a[116:117], v209 offset:51200
    ds_read_b64_tr_b16 a[118:119], v209 offset:53248
    ds_read_b64_tr_b16 a[120:121], v209 offset:53248
    ds_read_b64_tr_b16 a[122:123], v209 offset:55296
    ds_read_b64_tr_b16 a[124:125], v209 offset:54272
    ds_read_b64_tr_b16 a[126:127], v209 offset:56320
    s_waitcnt lgkmcnt(0)
    s_barrier
    s_add_u32 m0, s70, 16384
    s_mul_i32 s73, s94, 56
    s_add_u32 s73, s73, 0
    buffer_load_dwordx4 v213, s[20:23], s73 offen lds
    s_add_u32 m0, s70, 17408
    s_mul_i32 s73, s94, 56
    s_add_u32 s73, s73, 28672
    buffer_load_dwordx4 v213, s[20:23], s73 offen lds
    s_add_u32 m0, s70, 18432
    s_mul_i32 s73, s94, 56
    s_add_u32 s73, s73, 57344
    buffer_load_dwordx4 v213, s[20:23], s73 offen lds
    s_add_u32 m0, s70, 19456
    s_mul_i32 s73, s94, 56
    s_add_u32 s73, s73, 86016
    buffer_load_dwordx4 v213, s[20:23], s73 offen lds
    s_add_u32 m0, s70, 20480
    s_mul_i32 s73, s94, 56
    s_add_u32 s73, s73, 114688
    buffer_load_dwordx4 v213, s[20:23], s73 offen lds
    s_add_u32 m0, s70, 21504
    s_mul_i32 s73, s94, 56
    s_add_u32 s73, s73, 143360
    buffer_load_dwordx4 v213, s[20:23], s73 offen lds
    s_add_u32 m0, s70, 22528
    s_mul_i32 s73, s94, 56
    s_add_u32 s73, s73, 172032
    buffer_load_dwordx4 v213, s[20:23], s73 offen lds
    s_add_u32 m0, s70, 23552
    s_mul_i32 s73, s94, 56
    s_add_u32 s73, s73, 200704
    buffer_load_dwordx4 v213, s[20:23], s73 offen lds
    s_add_u32 m0, s70, 24576
    s_mul_i32 s73, s95, 56
    s_add_u32 s73, s73, 0
    buffer_load_dwordx4 v213, s[20:23], s73 offen lds
    s_add_u32 m0, s70, 25600
    s_mul_i32 s73, s95, 56
    s_add_u32 s73, s73, 28672
    buffer_load_dwordx4 v213, s[20:23], s73 offen lds
    s_add_u32 m0, s70, 26624
    s_mul_i32 s73, s95, 56
    s_add_u32 s73, s73, 57344
    buffer_load_dwordx4 v213, s[20:23], s73 offen lds
    s_add_u32 m0, s70, 27648
    s_mul_i32 s73, s95, 56
    s_add_u32 s73, s73, 86016
    buffer_load_dwordx4 v213, s[20:23], s73 offen lds
    s_add_u32 m0, s70, 28672
    s_mul_i32 s73, s95, 56
    s_add_u32 s73, s73, 114688
    buffer_load_dwordx4 v213, s[20:23], s73 offen lds
    s_add_u32 m0, s70, 29696
    s_mul_i32 s73, s95, 56
    s_add_u32 s73, s73, 143360
    buffer_load_dwordx4 v213, s[20:23], s73 offen lds
    s_add_u32 m0, s70, 30720
    s_mul_i32 s73, s95, 56
    s_add_u32 s73, s73, 172032
    buffer_load_dwordx4 v213, s[20:23], s73 offen lds
    s_add_u32 m0, s70, 31744
    s_mul_i32 s73, s95, 56
    s_add_u32 s73, s73, 200704
    buffer_load_dwordx4 v213, s[20:23], s73 offen lds
    s_add_u32 m0, s70, 32768
    s_mul_i32 s73, s96, 56
    s_add_u32 s73, s73, 0
    buffer_load_dwordx4 v213, s[20:23], s73 offen lds
    s_add_u32 m0, s70, 33792
    s_mul_i32 s73, s96, 56
    s_add_u32 s73, s73, 28672
    buffer_load_dwordx4 v213, s[20:23], s73 offen lds
    s_add_u32 m0, s70, 34816
    s_mul_i32 s73, s96, 56
    s_add_u32 s73, s73, 57344
    buffer_load_dwordx4 v213, s[20:23], s73 offen lds
    s_add_u32 m0, s70, 35840
    s_mul_i32 s73, s96, 56
    s_add_u32 s73, s73, 86016
    buffer_load_dwordx4 v213, s[20:23], s73 offen lds
    buffer_load_dword v249, v10, s[40:43], s83 offen sc1
    s_sleep 3
    buffer_load_dword v250, v10, s[40:43], s83 offen sc1
    s_sleep 3
    s_nop 0
Lpoll_P_4:
    s_sub_u32 s6, s6, 1
    s_cbranch_scc1 L_end_P
    buffer_load_dword v251, v10, s[40:43], s83 offen sc1
    s_waitcnt vmcnt(2)
    v_cmp_ne_u32 vcc, s4, v249
    s_nop 1
    s_cbranch_vccz Lpd_P_5
    buffer_load_dword v249, v10, s[40:43], s83 offen sc1
    s_waitcnt vmcnt(2)
    v_cmp_ne_u32 vcc, s4, v250
    s_nop 1
    s_cbranch_vccz Lpd_P_5
    buffer_load_dword v250, v10, s[40:43], s83 offen sc1
    s_waitcnt vmcnt(2)
    v_cmp_ne_u32 vcc, s4, v251
    s_nop 1
    s_cbranch_vccnz Lpoll_P_4
    s_nop 1
Lpd_P_5:
    s_lshl_b32 s58, s67, 16
    s_lshl_b32 s60, s3, 14
    s_add_u32 s58, s58, s60
    s_add_u32 m0, s70, 0
    s_nop 0
    buffer_load_dwordx4 v4, s[40:43], s58 offen offset:0 sc1 lds
    buffer_load_dwordx4 v4, s[40:43], s58 offen offset:1024 sc1 lds
    buffer_load_dwordx4 v4, s[40:43], s58 offen offset:2048 sc1 lds
    buffer_load_dwordx4 v4, s[40:43], s58 offen offset:3072 sc1 lds
    s_add_u32 m0, s70, 4096
    s_add_u32 s58, s58, 4096
    buffer_load_dwordx4 v4, s[40:43], s58 offen offset:0 sc1 lds
    buffer_load_dwordx4 v4, s[40:43], s58 offen offset:1024 sc1 lds
    buffer_load_dwordx4 v4, s[40:43], s58 offen offset:2048 sc1 lds
    buffer_load_dwordx4 v4, s[40:43], s58 offen offset:3072 sc1 lds
    s_add_u32 m0, s70, 8192
    s_add_u32 s58, s58, 4096
    buffer_load_dwordx4 v4, s[40:43], s58 offen offset:0 sc1 lds
    buffer_load_dwordx4 v4, s[40:43], s58 offen offset:1024 sc1 lds
    buffer_load_dwordx4 v4, s[40:43], s58 offen offset:2048 sc1 lds
    buffer_load_dwordx4 v4, s[40:43], s58 offen offset:3072 sc1 lds
    s_add_u32 m0, s70, 12288
    s_add_u32 s58, s58, 4096
    buffer_load_dwordx4 v4, s[40:43], s58 offen offset:0 sc1 lds
    buffer_load_dwordx4 v4, s[40:43], s58 offen offset:1024 sc1 lds
    buffer_load_dwordx4 v4, s[40:43], s58 offen offset:2048 sc1 lds
    buffer_load_dwordx4 v4, s[40:43], s58 offen offset:3072 sc1 lds
    v_and_b32 v64, 1, v3
    v_mul_u32_u24 v64, 36864, v64
    v_lshl_add_u32 v64, v2, 4, v64
    v_lshrrev_b32 v65, 5, v1
    v_lshl_add_u32 v64, v65, 8, v64
    s_lshr_b32 s60, s3, 1
    s_mul_i32 s60, s60, 73728
    s_add_u32 s60, s60, 12288
    v_add_u32 v64, s60, v64
    ds_read_b64_tr_b16 a[128:129], v215 offset:16384
    ds_read_b64_tr_b16 a[130:131], v215 offset:17408
    ds_read_b64_tr_b16 a[132:133], v216 offset:16384
    ds_read_b64_tr_b16 a[134:135], v216 offset:17408
    ds_read_b64_tr_b16 a[136:137], v215 offset:18432
    ds_read_b64_tr_b16 a[138:139], v215 offset:19456
    ds_read_b64_tr_b16 a[140:141], v216 offset:18432
    ds_read_b64_tr_b16 a[142:143], v216 offset:19456
    ds_read_b64_tr_b16 a[144:145], v215 offset:20480
    ds_read_b64_tr_b16 a[146:147], v215 offset:21504
    ds_read_b64_tr_b16 a[148:149], v216 offset:20480
    ds_read_b64_tr_b16 a[150:151], v216 offset:21504
    ds_read_b64_tr_b16 a[152:153], v215 offset:22528
    ds_read_b64_tr_b16 a[154:155], v215 offset:23552
    ds_read_b64_tr_b16 a[156:157], v216 offset:22528
    ds_read_b64_tr_b16 a[158:159], v216 offset:23552
    ds_read_b64_tr_b16 a[160:161], v215 offset:24576
    ds_read_b64_tr_b16 a[162:163], v215 offset:25600
    ds_read_b64_tr_b16 a[164:165], v216 offset:24576
    ds_read_b64_tr_b16 a[166:167], v216 offset:25600
    ds_read_b64_tr_b16 a[168:169], v215 offset:26624
    ds_read_b64_tr_b16 a[170:171], v215 offset:27648
    ds_read_b64_tr_b16 a[172:173], v216 offset:26624
    ds_read_b64_tr_b16 a[174:175], v216 offset:27648
    ds_read_b64_tr_b16 a[176:177], v215 offset:28672
    ds_read_b64_tr_b16 a[178:179], v215 offset:29696
    ds_read_b64_tr_b16 a[180:181], v216 offset:28672
    ds_read_b64_tr_b16 a[182:183], v216 offset:29696
    ds_read_b64_tr_b16 a[184:185], v215 offset:30720
    ds_read_b64_tr_b16 a[186:187], v215 offset:31744
    ds_read_b64_tr_b16 a[188:189], v216 offset:30720
    ds_read_b64_tr_b16 a[190:191], v216 offset:31744
    ds_read_b64_tr_b16 a[192:193], v215 offset:32768
    ds_read_b64_tr_b16 a[194:195], v215 offset:33792
    ds_read_b64_tr_b16 a[196:197], v216 offset:32768
    ds_read_b64_tr_b16 a[198:199], v216 offset:33792
    ds_read_b64_tr_b16 a[200:201], v215 offset:34816
    ds_read_b64_tr_b16 a[202:203], v215 offset:35840
    ds_read_b64_tr_b16 a[204:205], v216 offset:34816
    ds_read_b64_tr_b16 a[206:207], v216 offset:35840
    v_lshlrev_b32 v192, 16, v192
    v_lshlrev_b32 v193, 16, v193
    v_lshlrev_b32 v194, 16, v194
    v_lshlrev_b32 v195, 16, v195
    v_lshlrev_b32 v196, 16, v196
    v_lshlrev_b32 v197, 16, v197
    v_lshlrev_b32 v198, 16, v198
    v_lshlrev_b32 v199, 16, v199
    v_lshlrev_b32 v200, 16, v200
    v_lshlrev_b32 v201, 16, v201
    v_lshlrev_b32 v202, 16, v202
    v_lshlrev_b32 v203, 16, v203
    v_lshlrev_b32 v204, 16, v204
    v_lshlrev_b32 v205, 16, v205
    v_lshlrev_b32 v206, 16, v206
    v_lshlrev_b32 v207, 16, v207
    s_waitcnt vmcnt(8)
    s_barrier
    ds_read_b128 v[32:35], v64 offset:0
    ds_read_b128 v[36:39], v64 offset:512
    ds_read_b128 v[40:43], v64 offset:1024
    ds_read_b128 v[44:47], v64 offset:1536
    ds_read_b128 v[48:51], v64 offset:2048
    ds_read_b128 v[52:55], v64 offset:2560
    s_waitcnt lgkmcnt(5)
    v_mfma_f32_32x32x16_bf16 v[192:207], v[32:35], a[0:3], v[192:207]
    ds_read_b128 v[56:59], v64 offset:3072
    s_add_u32 m0, s70, 16384
    s_mul_i32 s73, s96, 56
    s_add_u32 s73, s73, 114688
    buffer_load_dwordx4 v213, s[20:23], s73 offen lds
    s_waitcnt lgkmcnt(5)
    v_mfma_f32_32x32x16_bf16 v[192:207], v[36:39], a[4:7], v[192:207]
    ds_read_b128 v[60:63], v64 offset:3584
    s_waitcnt lgkmcnt(5)
    v_mfma_f32_32x32x16_bf16 v[192:207], v[40:43], a[8:11], v[192:207]
    ds_read_b128 v[32:35], v64 offset:4096
    s_waitcnt lgkmcnt(5)
    v_mfma_f32_32x32x16_bf16 v[192:207], v[44:47], a[12:15], v[192:207]
    ds_read_b128 v[36:39], v64 offset:4608
    s_add_u32 m0, s70, 17408
    s_mul_i32 s73, s96, 56
    s_add_u32 s73, s73, 143360
    buffer_load_dwordx4 v213, s[20:23], s73 offen lds
    s_waitcnt lgkmcnt(5)
    v_mfma_f32_32x32x16_bf16 v[192:207], v[48:51], a[16:19], v[192:207]
    ds_read_b128 v[40:43], v64 offset:5120
    s_waitcnt lgkmcnt(5)
    v_mfma_f32_32x32x16_bf16 v[192:207], v[52:55], a[20:23], v[192:207]
    ds_read_b128 v[44:47], v64 offset:5632
    s_waitcnt lgkmcnt(5)
    v_mfma_f32_32x32x16_bf16 v[192:207], v[56:59], a[24:27], v[192:207]
    ds_read_b128 v[48:51], v64 offset:6144
    s_add_u32 m0, s70, 18432
    s_mul_i32 s73, s96, 56
    s_add_u32 s73, s73, 172032
    buffer_load_dwordx4 v213, s[20:23], s73 offen lds
    s_waitcnt lgkmcnt(5)
    v_mfma_f32_32x32x16_bf16 v[192:207], v[60:63], a[28:31], v[192:207]
    ds_read_b128 v[52:55], v64 offset:6656
    s_waitcnt lgkmcnt(5)
    v_mfma_f32_32x32x16_bf16 v[192:207], v[32:35], a[32:35], v[192:207]
    ds_read_b128 v[56:59], v64 offset:7168
    s_waitcnt lgkmcnt(5)
    v_mfma_f32_32x32x16_bf16 v[192:207], v[36:39], a[36:39], v[192:207]
    ds_read_b128 v[60:63], v64 offset:7680
    s_add_u32 m0, s70, 19456
    s_mul_i32 s73, s96, 56
    s_add_u32 s73, s73, 200704
    buffer_load_dwordx4 v213, s[20:23], s73 offen lds
    s_waitcnt lgkmcnt(5)
    v_mfma_f32_32x32x16_bf16 v[192:207], v[40:43], a[40:43], v[192:207]
    s_waitcnt lgkmcnt(4)
    v_mfma_f32_32x32x16_bf16 v[192:207], v[44:47], a[44:47], v[192:207]
    s_waitcnt vmcnt(4)
    s_barrier
    ds_read_b128 v[32:35], v64 offset:8192
    ds_read_b128 v[36:39], v64 offset:8704
    s_waitcnt lgkmcnt(5)
    v_mfma_f32_32x32x16_bf16 v[192:207], v[48:51], a[48:51], v[192:207]
    ds_read_b128 v[40:43], v64 offset:9216
    s_add_u32 m0, s70, 20480
    s_mul_i32 s73, s97, 56
    s_add_u32 s73, s73, 0
    buffer_load_dwordx4 v213, s[20:23], s73 offen lds
    s_waitcnt lgkmcnt(5)
    v_mfma_f32_32x32x16_bf16 v[192:207], v[52:55], a[52:55], v[192:207]
    ds_read_b128 v[44:47], v64 offset:9728
    s_waitcnt lgkmcnt(5)
    v_mfma_f32_32x32x16_bf16 v[192:207], v[56:59], a[56:59], v[192:207]
    ds_read_b128 v[48:51], v64 offset:10240
    s_waitcnt lgkmcnt(5)
    v_mfma_f32_32x32x16_bf16 v[192:207], v[60:63], a[60:63], v[192:207]
    ds_read_b128 v[52:55], v64 offset:10752
    s_add_u32 m0, s70, 21504
    s_mul_i32 s73, s97, 56
    s_add_u32 s73, s73, 28672
    buffer_load_dwordx4 v213, s[20:23], s73 offen lds
    s_waitcnt lgkmcnt(5)
    v_mfma_f32_32x32x16_bf16 v[192:207], v[32:35], a[64:67], v[192:207]
    ds_read_b128 v[56:59], v64 offset:11264
    s_waitcnt lgkmcnt(5)
    v_mfma_f32_32x32x16_bf16 v[192:207], v[36:39], a[68:71], v[192:207]
    ds_read_b128 v[60:63], v64 offset:11776
    s_waitcnt lgkmcnt(5)
    v_mfma_f32_32x32x16_bf16 v[192:207], v[40:43], a[72:75], v[192:207]
    ds_read_b128 v[32:35], v64 offset:12288
    s_add_u32 m0, s70, 22528
    s_mul_i32 s73, s97, 56
    s_add_u32 s73, s73, 57344
    buffer_load_dwordx4 v213, s[20:23], s73 offen lds
    s_waitcnt lgkmcnt(5)
    v_mfma_f32_32x32x16_bf16 v[192:207], v[44:47], a[76:79], v[192:207]
    ds_read_b128 v[36:39], v64 offset:12800
    s_waitcnt lgkmcnt(5)
    v_mfma_f32_32x32x16_bf16 v[192:207], v[48:51], a[80:83], v[192:207]
    ds_read_b128 v[40:43], v64 offset:13312
    s_waitcnt lgkmcnt(5)
    v_mfma_f32_32x32x16_bf16 v[192:207], v[52:55], a[84:87], v[192:207]
    ds_read_b128 v[44:47], v64 offset:13824
    s_add_u32 m0, s70, 23552
    s_mul_i32 s73, s97, 56
    s_add_u32 s73, s73, 86016
    buffer_load_dwordx4 v213, s[20:23], s73 offen lds
    s_waitcnt lgkmcnt(5)
    v_mfma_f32_32x32x16_bf16 v[192:207], v[56:59], a[88:91], v[192:207]
    ds_read_b128 v[48:51], v64 offset:14336
    s_waitcnt lgkmcnt(5)
    v_mfma_f32_32x32x16_bf16 v[192:207], v[60:63], a[92:95], v[192:207]
    ds_read_b128 v[52:55], v64 offset:14848
    s_waitcnt lgkmcnt(5)
    v_mfma_f32_32x32x16_bf16 v[192:207], v[32:35], a[96:99], v[192:207]
    ds_read_b128 v[56:59], v64 offset:15360
    s_add_u32 m0, s70, 24576
    s_mul_i32 s73, s97, 56
    s_add_u32 s73, s73, 114688
    buffer_load_dwordx4 v213, s[20:23], s73 offen lds
    s_waitcnt lgkmcnt(5)
    v_mfma_f32_32x32x16_bf16 v[192:207], v[36:39], a[100:103], v[192:207]
    ds_read_b128 v[60:63], v64 offset:15872
    s_waitcnt lgkmcnt(5)
    v_mfma_f32_32x32x16_bf16 v[192:207], v[40:43], a[104:107], v[192:207]
    s_waitcnt lgkmcnt(4)
    v_mfma_f32_32x32x16_bf16 v[192:207], v[44:47], a[108:111], v[192:207]
    s_add_u32 m0, s70, 25600
    s_mul_i32 s73, s97, 56
    s_add_u32 s73, s73, 143360
    buffer_load_dwordx4 v213, s[20:23], s73 offen lds
    s_waitcnt lgkmcnt(3)
    v_mfma_f32_32x32x16_bf16 v[192:207], v[48:51], a[112:115], v[192:207]
    s_waitcnt lgkmcnt(2)
    v_mfma_f32_32x32x16_bf16 v[192:207], v[52:55], a[116:119], v[192:207]
    s_waitcnt lgkmcnt(1)
    v_mfma_f32_32x32x16_bf16 v[192:207], v[56:59], a[120:123], v[192:207]
    s_add_u32 m0, s70, 26624
    s_mul_i32 s73, s97, 56
    s_add_u32 s73, s73, 172032
    buffer_load_dwordx4 v213, s[20:23], s73 offen lds
    s_waitcnt lgkmcnt(0)
    v_mfma_f32_32x32x16_bf16 v[192:207], v[60:63], a[124:127], v[192:207]
    s_nop 11
    v_pk_mul_f32 v[68:69], v[192:193], v[192:193]
    v_pk_mul_f32 v[70:71], v[194:195], v[194:195]
    v_pk_mul_f32 v[72:73], v[196:197], v[196:197]
    v_pk_mul_f32 v[74:75], v[198:199], v[198:199]
    v_pk_mul_f32 v[76:77], v[200:201], v[200:201]
    v_pk_mul_f32 v[78:79], v[202:203], v[202:203]
    v_pk_mul_f32 v[80:81], v[204:205], v[204:205]
    v_pk_mul_f32 v[82:83], v[206:207], v[206:207]
    s_add_u32 m0, s70, 27648
    s_mul_i32 s73, s97, 56
    s_add_u32 s73, s73, 200704
    buffer_load_dwordx4 v213, s[20:23], s73 offen lds
    v_add_f32_dpp v84, v192, v192 row_mirror row_mask:0xf bank_mask:0x3
    v_add_f32_dpp v85, v193, v193 row_mirror row_mask:0xf bank_mask:0x3
    v_add_f32_dpp v86, v196, v196 row_mirror row_mask:0xf bank_mask:0x3
    v_add_f32_dpp v87, v197, v197 row_mirror row_mask:0xf bank_mask:0x3
    v_add_f32_dpp v88, v200, v200 row_mirror row_mask:0xf bank_mask:0x3
    v_add_f32_dpp v89, v201, v201 row_mirror row_mask:0xf bank_mask:0x3
    v_add_f32_dpp v90, v204, v204 row_mirror row_mask:0xf bank_mask:0x3
    v_add_f32_dpp v91, v205, v205 row_mirror row_mask:0xf bank_mask:0x3
    s_add_u32 m0, s70, 28672
    s_mul_i32 s73, s98, 56
    s_add_u32 s73, s73, 0
    buffer_load_dwordx4 v213, s[20:23], s73 offen lds
    v_add_f32_dpp v92, v68, v68 row_mirror row_mask:0xf bank_mask:0x3
    v_add_f32_dpp v93, v69, v69 row_mirror row_mask:0xf bank_mask:0x3
    v_add_f32_dpp v94, v72, v72 row_mirror row_mask:0xf bank_mask:0x3
    v_add_f32_dpp v95, v73, v73 row_mirror row_mask:0xf bank_mask:0x3
    v_add_f32_dpp v96, v76, v76 row_mirror row_mask:0xf bank_mask:0x3
    v_add_f32_dpp v97, v77, v77 row_mirror row_mask:0xf bank_mask:0x3
    v_add_f32_dpp v98, v80, v80 row_mirror row_mask:0xf bank_mask:0x3
    v_add_f32_dpp v99, v81, v81 row_mirror row_mask:0xf bank_mask:0x3
    s_add_u32 m0, s70, 29696
    s_mul_i32 s73, s98, 56
    s_add_u32 s73, s73, 28672
    buffer_load_dwordx4 v213, s[20:23], s73 offen lds
    v_add_f32_dpp v84, v194, v194 row_mirror row_mask:0xf bank_mask:0xc
    v_add_f32_dpp v85, v195, v195 row_mirror row_mask:0xf bank_mask:0xc
    v_add_f32_dpp v86, v198, v198 row_mirror row_mask:0xf bank_mask:0xc
    v_add_f32_dpp v87, v199, v199 row_mirror row_mask:0xf bank_mask:0xc
    v_add_f32_dpp v88, v202, v202 row_mirror row_mask:0xf bank_mask:0xc
    v_add_f32_dpp v89, v203, v203 row_mirror row_mask:0xf bank_mask:0xc
    v_add_f32_dpp v90, v206, v206 row_mirror row_mask:0xf bank_mask:0xc
    v_add_f32_dpp v91, v207, v207 row_mirror row_mask:0xf bank_mask:0xc
    s_add_u32 m0, s70, 30720
    s_mul_i32 s73, s98, 56
    s_add_u32 s73, s73, 57344
    buffer_load_dwordx4 v213, s[20:23], s73 offen lds
    v_add_f32_dpp v92, v70, v70 row_mirror row_mask:0xf bank_mask:0xc
    v_add_f32_dpp v93, v71, v71 row_mirror row_mask:0xf bank_mask:0xc
    v_add_f32_dpp v94, v74, v74 row_mirror row_mask:0xf bank_mask:0xc
    v_add_f32_dpp v95, v75, v75 row_mirror row_mask:0xf bank_mask:0xc
    v_add_f32_dpp v96, v78, v78 row_mirror row_mask:0xf bank_mask:0xc
    v_add_f32_dpp v97, v79, v79 row_mirror row_mask:0xf bank_mask:0xc
    v_add_f32_dpp v98, v82, v82 row_mirror row_mask:0xf bank_mask:0xc
    v_add_f32_dpp v99, v83, v83 row_mirror row_mask:0xf bank_mask:0xc
    s_add_u32 m0, s70, 31744
    s_mul_i32 s73, s98, 56
    s_add_u32 s73, s73, 86016
    buffer_load_dwordx4 v213, s[20:23], s73 offen lds
    v_add_f32_dpp v84, v84, v84 row_half_mirror row_mask:0xf bank_mask:0x5
    v_add_f32_dpp v86, v86, v86 row_half_mirror row_mask:0xf bank_mask:0x5
    v_add_f32_dpp v88, v88, v88 row_half_mirror row_mask:0xf bank_mask:0x5
    v_add_f32_dpp v90, v90, v90 row_half_mirror row_mask:0xf bank_mask:0x5
    v_add_f32_dpp v92, v92, v92 row_half_mirror row_mask:0xf bank_mask:0x5
    v_add_f32_dpp v94, v94, v94 row_half_mirror row_mask:0xf bank_mask:0x5
    v_add_f32_dpp v96, v96, v96 row_half_mirror row_mask:0xf bank_mask:0x5
    v_add_f32_dpp v98, v98, v98 row_half_mirror row_mask:0xf bank_mask:0x5
    v_add_f32_dpp v84, v85, v85 row_half_mirror row_mask:0xf bank_mask:0xa
    v_add_f32_dpp v86, v87, v87 row_half_mirror row_mask:0xf bank_mask:0xa
    v_add_f32_dpp v88, v89, v89 row_half_mirror row_mask:0xf bank_mask:0xa
    v_add_f32_dpp v90, v91, v91 row_half_mirror row_mask:0xf bank_mask:0xa
    v_add_f32_dpp v92, v93, v93 row_half_mirror row_mask:0xf bank_mask:0xa
    v_add_f32_dpp v94, v95, v95 row_half_mirror row_mask:0xf bank_mask:0xa
    v_add_f32_dpp v96, v97, v97 row_half_mirror row_mask:0xf bank_mask:0xa
    v_add_f32_dpp v98, v99, v99 row_half_mirror row_mask:0xf bank_mask:0xa
    v_add_f32_dpp v85, v84, v84 quad_perm:[1,0,3,2] row_mask:0xf bank_mask:0xf
    v_add_f32_dpp v87, v86, v86 quad_perm:[1,0,3,2] row_mask:0xf bank_mask:0xf
    v_add_f32_dpp v89, v88, v88 quad_perm:[1,0,3,2] row_mask:0xf bank_mask:0xf
    v_add_f32_dpp v91, v90, v90 quad_perm:[1,0,3,2] row_mask:0xf bank_mask:0xf
    v_add_f32_dpp v93, v92, v92 quad_perm:[1,0,3,2] row_mask:0xf bank_mask:0xf
    v_add_f32_dpp v95, v94, v94 quad_perm:[1,0,3,2] row_mask:0xf bank_mask:0xf
    v_add_f32_dpp v97, v96, v96 quad_perm:[1,0,3,2] row_mask:0xf bank_mask:0xf
    v_add_f32_dpp v99, v98, v98 quad_perm:[1,0,3,2] row_mask:0xf bank_mask:0xf
    v_add_f32_dpp v68, v85, v85 quad_perm:[2,3,0,1] row_mask:0xf bank_mask:0xf
    v_add_f32_dpp v69, v87, v87 quad_perm:[2,3,0,1] row_mask:0xf bank_mask:0xf
    v_add_f32_dpp v70, v89, v89 quad_perm:[2,3,0,1] row_mask:0xf bank_mask:0xf
    v_add_f32_dpp v71, v91, v91 quad_perm:[2,3,0,1] row_mask:0xf bank_mask:0xf
    v_add_f32_dpp v72, v93, v93 quad_perm:[2,3,0,1] row_mask:0xf bank_mask:0xf
    v_add_f32_dpp v73, v95, v95 quad_perm:[2,3,0,1] row_mask:0xf bank_mask:0xf
    v_add_f32_dpp v74, v97, v97 quad_perm:[2,3,0,1] row_mask:0xf bank_mask:0xf
    v_add_f32_dpp v75, v99, v99 quad_perm:[2,3,0,1] row_mask:0xf bank_mask:0xf
    v_permlane16_swap_b32 v68, v69
    v_permlane16_swap_b32 v70, v71
    v_permlane16_swap_b32 v72, v73
    v_permlane16_swap_b32 v74, v75
    v_add_f32 v84, v68, v69
    v_add_f32 v85, v72, v73
    v_add_f32 v86, v70, v71
    v_add_f32 v87, v74, v75
    v_and_b32 v65, 1, v3
    v_lshlrev_b32 v65, 6, v65
    v_lshrrev_b32 v66, 5, v1
    v_lshl_add_u32 v65, v66, 5, v65
    v_bfe_u32 v67, v1, 2, 2
    v_lshl_add_u32 v65, v67, 3, v65
    s_lshl_b32 s58, s3, 8
    v_add_u32 v65, s58, v65
    ds_write_b64 v65, v[84:85] offset:0
    ds_write_b64 v65, v[86:87] offset:128
    v_and_b32 v67, 31, v1
    v_lshlrev_b32 v65, 9, v66
    v_lshl_add_u32 v65, v67, 4, v65
    v_lshlrev_b32 v66, 8, v66
    v_lshl_add_u32 v66, v67, 3, v66
    s_and_b32 s58, s58, 512
    v_add_u32 v66, s58, v66
    s_lshl_b32 s58, s67, 1
    s_lshr_b32 s60, s3, 1
    s_add_u32 s58, s58, s60
    s_lshl_b32 s58, s58, 12
    s_add_u32 s58, s58, 0x548000
    s_lshl_b32 s60, s66, 9
    s_add_u32 s60, s60, s58
    s_waitcnt lgkmcnt(0)
    s_barrier
    ds_read_b64 v[84:85], v66 offset:0
    v_mov_b32 v89, s4
    v_mov_b32 v91, s4
    s_waitcnt lgkmcnt(0)
    v_mov_b32 v88, v84
    v_mov_b32 v90, v85
    s_nop 0
    v_permlane32_swap_b32 v88, v84
    v_permlane32_swap_b32 v90, v85
    v_add_f32 v88, v88, v84
    v_add_f32 v90, v90, v85
    s_bitcmp0_b32 s3, 0
    s_cselect_b32 exec_lo, -1, 0
    s_mov_b32 exec_hi, 0
    buffer_store_dwordx4 v[88:91], v65, s[40:43], s60 offen sc1
    s_mov_b64 exec, -1
    v_cvt_pk_bf16_f32 v240, v192, v193
    v_cvt_pk_bf16_f32 v241, v194, v195
    v_cvt_pk_bf16_f32 v242, v196, v197
    v_cvt_pk_bf16_f32 v243, v198, v199
    v_cvt_pk_bf16_f32 v244, v200, v201
    v_cvt_pk_bf16_f32 v245, v202, v203
    v_cvt_pk_bf16_f32 v246, v204, v205
    v_cvt_pk_bf16_f32 v247, v206, v207
    s_lshl_b32 s61, s66, 1
    s_and_b32 s60, s3, 1
    s_add_u32 s61, s61, s60
    s_lshl_b32 s61, s61, 7
    s_lshl_b32 s60, s67, 2
    s_add_u32 s61, s61, s60
    s_and_b32 s60, s3, 2
    s_add_u32 s61, s61, s60
    s_lshl_b32 s61, s61, 10
    s_add_u32 s61, s61, 0x200000
    v_lshlrev_b32 v66, 4, v67
    v_cmp_gt_u32 s[86:87], 32, v1
    s_add_u32 m0, s70, 0
    s_mul_i32 s73, s98, 56
    s_add_u32 s73, s73, 114688
    buffer_load_dwordx4 v213, s[20:23], s73 offen lds
    s_add_u32 m0, s70, 1024
    s_mul_i32 s73, s98, 56
    s_add_u32 s73, s73, 143360
    buffer_load_dwordx4 v213, s[20:23], s73 offen lds
    s_add_u32 m0, s70, 2048
    s_mul_i32 s73, s98, 56
    s_add_u32 s73, s73, 172032
    buffer_load_dwordx4 v213, s[20:23], s73 offen lds
    s_add_u32 m0, s70, 3072
    s_mul_i32 s73, s98, 56
    s_add_u32 s73, s73, 200704
    buffer_load_dwordx4 v213, s[20:23], s73 offen lds
    s_add_u32 m0, s70, 4096
    s_mul_i32 s73, s99, 56
    s_add_u32 s73, s73, 0
    buffer_load_dwordx4 v213, s[20:23], s73 offen lds
    s_add_u32 m0, s70, 5120
    s_mul_i32 s73, s99, 56
    s_add_u32 s73, s73, 28672
    buffer_load_dwordx4 v213, s[20:23], s73 offen lds
    s_add_u32 m0, s70, 6144
    s_mul_i32 s73, s99, 56
    s_add_u32 s73, s73, 57344
    buffer_load_dwordx4 v213, s[20:23], s73 offen lds
    s_add_u32 m0, s70, 7168
    s_mul_i32 s73, s99, 56
    s_add_u32 s73, s73, 86016
    buffer_load_dwordx4 v213, s[20:23], s73 offen lds
    s_add_u32 m0, s70, 8192
    s_mul_i32 s73, s99, 56
    s_add_u32 s73, s73, 114688
    buffer_load_dwordx4 v213, s[20:23], s73 offen lds
    s_add_u32 m0, s70, 9216
    s_mul_i32 s73, s99, 56
    s_add_u32 s73, s73, 143360
    buffer_load_dwordx4 v213, s[20:23], s73 offen lds
    s_add_u32 m0, s70, 10240
    s_mul_i32 s73, s99, 56
    s_add_u32 s73, s73, 172032
    buffer_load_dwordx4 v213, s[20:23], s73 offen lds
    s_add_u32 m0, s70, 11264
    s_mul_i32 s73, s99, 56
    s_add_u32 s73, s73, 200704
    buffer_load_dwordx4 v213, s[20:23], s73 offen lds
    s_add_u32 m0, s70, 12288
    s_mul_i32 s73, s100, 56
    s_add_u32 s73, s73, 0
    buffer_load_dwordx4 v213, s[20:23], s73 offen lds
    s_add_u32 m0, s70, 13312
    s_mul_i32 s73, s100, 56
    s_add_u32 s73, s73, 28672
    buffer_load_dwordx4 v213, s[20:23], s73 offen lds
    s_add_u32 m0, s70, 14336
    s_mul_i32 s73, s100, 56
    s_add_u32 s73, s73, 57344
    buffer_load_dwordx4 v213, s[20:23], s73 offen lds
    s_add_u32 m0, s70, 15360
    s_mul_i32 s73, s100, 56
    s_add_u32 s73, s73, 86016
    buffer_load_dwordx4 v213, s[20:23], s73 offen lds
    buffer_load_dwordx4 v[96:99], v65, s[40:43], s58 offen offset:0 sc1
    buffer_load_dwordx4 v[100:103], v65, s[40:43], s58 offen offset:1024 sc1
    buffer_load_dwordx4 v[104:107], v65, s[40:43], s58 offen offset:2048 sc1
    buffer_load_dwordx4 v[108:111], v66, s[40:43], s58 offen offset:3072 sc1
    s_sleep 5
    s_nop 0
Lst_P_6:
    s_sub_u32 s6, s6, 1
    s_cbranch_scc1 L_end_P
    buffer_load_dwordx4 v[112:115], v65, s[40:43], s58 offen offset:0 sc1
    buffer_load_dwordx4 v[116:119], v65, s[40:43], s58 offen offset:1024 sc1
    buffer_load_dwordx4 v[120:123], v65, s[40:43], s58 offen offset:2048 sc1
    buffer_load_dwordx4 v[124:127], v66, s[40:43], s58 offen offset:3072 sc1
    s_waitcnt vmcnt(4)
    v_xor_b32 v97, s4, v97
    v_xor_b32 v99, s4, v99
    v_xor_b32 v101, s4, v101
    v_xor_b32 v103, s4, v103
    v_xor_b32 v105, s4, v105
    v_xor_b32 v107, s4, v107
    v_xor_b32 v109, s4, v109
    v_xor_b32 v111, s4, v111
    v_cndmask_b32 v108, 0, v108, s[86:87]
    v_cndmask_b32 v110, 0, v110, s[86:87]
    v_or3_b32 v97, v97, v99, v101
    v_or3_b32 v103, v103, v105, v107
    v_or3_b32 v97, v97, v109, v111
    v_or_b32 v97, v97, v103
    v_cmp_ne_u32 vcc, 0, v97
    v_add_f32 v128, v96, v100
    v_add_f32 v129, v104, v108
    v_add_f32 v130, v98, v102
    v_add_f32 v131, v106, v110
    s_cbranch_vccz Lstd_P_7
    buffer_load_dwordx4 v[96:99], v65, s[40:43], s58 offen offset:0 sc1
    buffer_load_dwordx4 v[100:103], v65, s[40:43], s58 offen offset:1024 sc1
    buffer_load_dwordx4 v[104:107], v65, s[40:43], s58 offen offset:2048 sc1
    buffer_load_dwordx4 v[108:111], v66, s[40:43], s58 offen offset:3072 sc1
    s_waitcnt vmcnt(4)
    v_xor_b32 v113, s4, v113
    v_xor_b32 v115, s4, v115
    v_xor_b32 v117, s4, v117
    v_xor_b32 v119, s4, v119
    v_xor_b32 v121, s4, v121
    v_xor_b32 v123, s4, v123
    v_xor_b32 v125, s4, v125
    v_xor_b32 v127, s4, v127
    v_cndmask_b32 v124, 0, v124, s[86:87]
    v_cndmask_b32 v126, 0, v126, s[86:87]
    v_or3_b32 v113, v113, v115, v117
    v_or3_b32 v119, v119, v121, v123
    v_or3_b32 v113, v113, v125, v127
    v_or_b32 v113, v113, v119
    v_cmp_ne_u32 vcc, 0, v113
    v_add_f32 v128, v112, v116
    v_add_f32 v129, v120, v124
    v_add_f32 v130, v114, v118
    v_add_f32 v131, v122, v126
    s_cbranch_vccnz Lst_P_6
    s_nop 3
Lstd_P_7:
    v_add_f32 v128, v128, v129
    v_add_f32 v130, v130, v131
    v_mov_b32 v136, v128
    v_mov_b32 v138, v130
    s_nop 0
    v_permlane32_swap_b32 v128, v136
    v_permlane32_swap_b32 v130, v138
    v_add_f32 v128, v128, v136
    v_add_f32 v130, v130, v138
    v_mul_f32 v133, 0x3b124925, v128
    v_mul_f32 v130, 0x3b124925, v130
    v_fma_f32 v130, -v133, v133, v130
    v_max_f32 v130, 0, v130
    v_add_f32 v135, 0x3727c5ac, v130
    v_rsq_f32 v135, v135
    s_nop 0
    v_mul_f32 v130, v130, v135
    v_fmaak_f32 v130, v130, v135, 0x3727c5ac
    v_rsq_f32 v130, v130
    s_nop 0
    v_mul_f32 v135, v135, v130
    s_lshl_b32 s60, s3, 8
    v_lshl_add_u32 v66, v67, 2, s60
    ds_write_b32 v66, v133 offset:1024
    ds_write_b32 v66, v135 offset:1152
    v_lshrrev_b32 v66, 5, v1
    v_lshl_add_u32 v66, v66, 4, s60
    s_waitcnt lgkmcnt(0)
    ds_read_b128 v[140:143], v66 offset:1024
    ds_read_b128 v[156:159], v66 offset:1152
    ds_read_b128 v[144:147], v66 offset:1056
    ds_read_b128 v[160:163], v66 offset:1184
    ds_read_b128 v[148:151], v66 offset:1088
    ds_read_b128 v[164:167], v66 offset:1216
    ds_read_b128 v[152:155], v66 offset:1120
    ds_read_b128 v[168:171], v66 offset:1248
    s_waitcnt lgkmcnt(7)
    v_pk_add_f32 v[192:193], v[192:193], v[140:141] neg_lo:[0,1] neg_hi:[0,1]
    v_pk_add_f32 v[194:195], v[194:195], v[142:143] neg_lo:[0,1] neg_hi:[0,1]
    s_waitcnt lgkmcnt(5)
    v_pk_add_f32 v[196:197], v[196:197], v[144:145] neg_lo:[0,1] neg_hi:[0,1]
    v_pk_add_f32 v[198:199], v[198:199], v[146:147] neg_lo:[0,1] neg_hi:[0,1]
    v_pk_mul_f32 v[192:193], v[192:193], v[156:157]
    v_pk_mul_f32 v[194:195], v[194:195], v[158:159]
    s_waitcnt lgkmcnt(4)
    v_pk_mul_f32 v[196:197], v[196:197], v[160:161]
    v_pk_mul_f32 v[198:199], v[198:199], v[162:163]
    v_cvt_pk_bf16_f32 v84, v192, v193
    v_cvt_pk_bf16_f32 v85, v194, v195
    v_cvt_pk_bf16_f32 v86, v196, v197
    v_cvt_pk_bf16_f32 v87, v198, v199
    buffer_store_dwordx4 v[84:87], v4, s[40:43], s61 offen offset:0 sc1
    s_waitcnt lgkmcnt(3)
    v_pk_add_f32 v[200:201], v[200:201], v[148:149] neg_lo:[0,1] neg_hi:[0,1]
    v_pk_add_f32 v[202:203], v[202:203], v[150:151] neg_lo:[0,1] neg_hi:[0,1]
    s_waitcnt lgkmcnt(1)
    v_pk_add_f32 v[204:205], v[204:205], v[152:153] neg_lo:[0,1] neg_hi:[0,1]
    v_pk_add_f32 v[206:207], v[206:207], v[154:155] neg_lo:[0,1] neg_hi:[0,1]
    v_pk_mul_f32 v[200:201], v[200:201], v[164:165]
    v_pk_mul_f32 v[202:203], v[202:203], v[166:167]
    s_waitcnt lgkmcnt(0)
    v_pk_mul_f32 v[204:205], v[204:205], v[168:169]
    v_pk_mul_f32 v[206:207], v[206:207], v[170:171]
    v_cvt_pk_bf16_f32 v88, v200, v201
    v_cvt_pk_bf16_f32 v89, v202, v203
    v_cvt_pk_bf16_f32 v90, v204, v205
    v_cvt_pk_bf16_f32 v91, v206, v207
    buffer_store_dwordx4 v[88:91], v4, s[40:43], s61 offen offset:1024 sc1
    ds_read_b64_tr_b16 a[208:209], v215 offset:16384
    ds_read_b64_tr_b16 a[210:211], v215 offset:17408
    ds_read_b64_tr_b16 a[212:213], v216 offset:16384
    ds_read_b64_tr_b16 a[214:215], v216 offset:17408
    ds_read_b64_tr_b16 a[216:217], v215 offset:18432
    ds_read_b64_tr_b16 a[218:219], v215 offset:19456
    ds_read_b64_tr_b16 a[220:221], v216 offset:18432
    ds_read_b64_tr_b16 a[222:223], v216 offset:19456
    ds_read_b64_tr_b16 a[224:225], v215 offset:20480
    ds_read_b64_tr_b16 a[226:227], v215 offset:21504
    ds_read_b64_tr_b16 a[228:229], v216 offset:20480
    ds_read_b64_tr_b16 a[230:231], v216 offset:21504
    ds_read_b64_tr_b16 a[232:233], v215 offset:22528
    ds_read_b64_tr_b16 a[234:235], v215 offset:23552
    ds_read_b64_tr_b16 a[236:237], v216 offset:22528
    ds_read_b64_tr_b16 a[238:239], v216 offset:23552
    ds_read_b64_tr_b16 a[240:241], v215 offset:24576
    ds_read_b64_tr_b16 a[242:243], v215 offset:25600
    ds_read_b64_tr_b16 a[244:245], v216 offset:24576
    ds_read_b64_tr_b16 a[246:247], v216 offset:25600
    ds_read_b64_tr_b16 a[248:249], v215 offset:26624
    ds_read_b64_tr_b16 a[250:251], v215 offset:27648
    ds_read_b64_tr_b16 a[252:253], v216 offset:26624
    ds_read_b64_tr_b16 a[254:255], v216 offset:27648
    ds_read_b64_tr_b16 a[0:1], v215 offset:28672
    ds_read_b64_tr_b16 a[2:3], v215 offset:29696
    ds_read_b64_tr_b16 a[4:5], v216 offset:28672
    ds_read_b64_tr_b16 a[6:7], v216 offset:29696
    ds_read_b64_tr_b16 a[8:9], v215 offset:30720
    ds_read_b64_tr_b16 a[10:11], v215 offset:31744
    ds_read_b64_tr_b16 a[12:13], v216 offset:30720
    ds_read_b64_tr_b16 a[14:15], v216 offset:31744
    ds_read_b64_tr_b16 a[16:17], v215 offset:0
    ds_read_b64_tr_b16 a[18:19], v215 offset:1024
    ds_read_b64_tr_b16 a[20:21], v216 offset:0
    ds_read_b64_tr_b16 a[22:23], v216 offset:1024
    ds_read_b64_tr_b16 a[24:25], v215 offset:2048
    ds_read_b64_tr_b16 a[26:27], v215 offset:3072
    ds_read_b64_tr_b16 a[28:29], v216 offset:2048
    ds_read_b64_tr_b16 a[30:31], v216 offset:3072
    ds_read_b64_tr_b16 a[32:33], v215 offset:4096
    ds_read_b64_tr_b16 a[34:35], v215 offset:5120
    ds_read_b64_tr_b16 a[36:37], v216 offset:4096
    ds_read_b64_tr_b16 a[38:39], v216 offset:5120
    ds_read_b64_tr_b16 a[40:41], v215 offset:6144
    ds_read_b64_tr_b16 a[42:43], v215 offset:7168
    ds_read_b64_tr_b16 a[44:45], v216 offset:6144
    ds_read_b64_tr_b16 a[46:47], v216 offset:7168
    ds_read_b64_tr_b16 a[48:49], v215 offset:8192
    ds_read_b64_tr_b16 a[50:51], v215 offset:9216
    ds_read_b64_tr_b16 a[52:53], v216 offset:8192
    ds_read_b64_tr_b16 a[54:55], v216 offset:9216
    ds_read_b64_tr_b16 a[56:57], v215 offset:10240
    ds_read_b64_tr_b16 a[58:59], v215 offset:11264
    ds_read_b64_tr_b16 a[60:61], v216 offset:10240
    ds_read_b64_tr_b16 a[62:63], v216 offset:11264
    ds_read_b64_tr_b16 a[64:65], v215 offset:12288
    ds_read_b64_tr_b16 a[66:67], v215 offset:13312
    ds_read_b64_tr_b16 a[68:69], v216 offset:12288
    ds_read_b64_tr_b16 a[70:71], v216 offset:13312
    ds_read_b64_tr_b16 a[72:73], v215 offset:14336
    ds_read_b64_tr_b16 a[74:75], v215 offset:15360
    ds_read_b64_tr_b16 a[76:77], v216 offset:14336
    ds_read_b64_tr_b16 a[78:79], v216 offset:15360
    s_waitcnt vmcnt(0)
    v_mov_b32 v8, s4
    s_mov_b64 exec, 1
    buffer_store_dword v8, v9, s[40:43], s81 offen sc1
    s_mov_b64 exec, -1
    s_waitcnt lgkmcnt(4)
    s_add_u32 m0, s70, 12288
    s_mul_i32 s73, s100, 56
    s_add_u32 s73, s73, 114688
    buffer_load_dwordx4 v213, s[20:23], s73 offen lds
    s_add_u32 m0, s70, 13312
    s_mul_i32 s73, s100, 56
    s_add_u32 s73, s73, 143360
    buffer_load_dwordx4 v213, s[20:23], s73 offen lds
    s_waitcnt lgkmcnt(0)
    s_add_u32 m0, s70, 14336
    s_mul_i32 s73, s100, 56
    s_add_u32 s73, s73, 172032
    buffer_load_dwordx4 v213, s[20:23], s73 offen lds
    s_add_u32 m0, s70, 15360
    s_mul_i32 s73, s100, 56
    s_add_u32 s73, s73, 200704
    buffer_load_dwordx4 v213, s[20:23], s73 offen lds
    s_add_u32 m0, s70, 16384
    s_mul_i32 s73, s101, 56
    s_add_u32 s73, s73, 0
    buffer_load_dwordx4 v213, s[20:23], s73 offen lds
    s_add_u32 m0, s70, 17408
    s_mul_i32 s73, s101, 56
    s_add_u32 s73, s73, 28672
    buffer_load_dwordx4 v213, s[20:23], s73 offen lds
    s_add_u32 m0, s70, 18432
    s_mul_i32 s73, s101, 56
    s_add_u32 s73, s73, 57344
    buffer_load_dwordx4 v213, s[20:23], s73 offen lds
    s_add_u32 m0, s70, 19456
    s_mul_i32 s73, s101, 56
    s_add_u32 s73, s73, 86016
    buffer_load_dwordx4 v213, s[20:23], s73 offen lds
    s_add_u32 m0, s70, 20480
    s_mul_i32 s73, s101, 56
    s_add_u32 s73, s73, 114688
    buffer_load_dwordx4 v213, s[20:23], s73 offen lds
    s_add_u32 m0, s70, 21504
    s_mul_i32 s73, s101, 56
    s_add_u32 s73, s73, 143360
    buffer_load_dwordx4 v213, s[20:23], s73 offen lds
    s_add_u32 m0, s70, 22528
    s_mul_i32 s73, s101, 56
    s_add_u32 s73, s73, 172032
    buffer_load_dwordx4 v213, s[20:23], s73 offen lds
    s_add_u32 m0, s70, 23552
    s_mul_i32 s73, s101, 56
    s_add_u32 s73, s73, 200704
    buffer_load_dwordx4 v213, s[20:23], s73 offen lds
    s_add_u32 m0, s70, 24576
    s_mul_i32 s73, s48, 64
    s_add_u32 s73, s73, 0
    buffer_load_dwordx4 v214, s[24:27], s73 offen lds
    s_add_u32 m0, s70, 25600
    s_mul_i32 s73, s48, 64
    s_add_u32 s73, s73, 32768
    buffer_load_dwordx4 v214, s[24:27], s73 offen lds
    s_add_u32 m0, s70, 26624
    s_mul_i32 s73, s48, 64
    s_add_u32 s73, s73, 65536
    buffer_load_dwordx4 v214, s[24:27], s73 offen lds
    s_add_u32 m0, s70, 27648
    s_mul_i32 s73, s48, 64
    s_add_u32 s73, s73, 98304
    buffer_load_dwordx4 v214, s[24:27], s73 offen lds
    s_add_u32 m0, s70, 28672
    s_mul_i32 s73, s48, 64
    s_add_u32 s73, s73, 131072
    buffer_load_dwordx4 v214, s[24:27], s73 offen lds
    s_add_u32 m0, s70, 29696
    s_mul_i32 s73, s48, 64
    s_add_u32 s73, s73, 163840
    buffer_load_dwordx4 v214, s[24:27], s73 offen lds
    s_add_u32 m0, s70, 30720
    s_mul_i32 s73, s48, 64
    s_add_u32 s73, s73, 196608
    buffer_load_dwordx4 v214, s[24:27], s73 offen lds
    s_add_u32 m0, s70, 31744
    s_mul_i32 s73, s48, 64
    s_add_u32 s73, s73, 229376
    buffer_load_dwordx4 v214, s[24:27], s73 offen lds
    s_add_u32 m0, s70, 32768
    s_mul_i32 s73, s49, 64
    s_add_u32 s73, s73, 0
    buffer_load_dwordx4 v214, s[24:27], s73 offen lds
    s_add_u32 m0, s70, 33792
    s_mul_i32 s73, s49, 64
    s_add_u32 s73, s73, 32768
    buffer_load_dwordx4 v214, s[24:27], s73 offen lds
    s_add_u32 m0, s70, 34816
    s_mul_i32 s73, s49, 64
    s_add_u32 s73, s73, 65536
    buffer_load_dwordx4 v214, s[24:27], s73 offen lds
    s_add_u32 m0, s70, 35840
    s_mul_i32 s73, s49, 64
    s_add_u32 s73, s73, 98304
    buffer_load_dwordx4 v214, s[24:27], s73 offen lds
    v_lshrrev_b32 v220, 5, v1
    v_lshlrev_b32 v220, 3, v220
    s_lshl_b32 s68, s65, 7
    s_lshr_b32 s69, s3, 1
    s_lshl_b32 s69, s69, 6
    s_add_u32 s68, s68, s69
    buffer_load_dwordx2 v[222:223], v220, s[28:31], s68 offen offset:0
    buffer_load_dwordx2 v[224:225], v220, s[28:31], s68 offen offset:16
    buffer_load_dwordx2 v[226:227], v220, s[28:31], s68 offen offset:32
    buffer_load_dwordx2 v[228:229], v220, s[28:31], s68 offen offset:48
    s_lshl_b32 s68, s64, 1
    s_and_b32 s69, s3, 1
    s_add_u32 s71, s68, s69
    s_xor_b32 s72, s71, 1
    s_mul_i32 s68, s3, 32768
    s_add_u32 s68, s68, 0x200000
    s_mul_i32 s71, s71, 131072
    s_add_u32 s71, s71, s68
    s_mul_i32 s72, s72, 131072
    s_add_u32 s72, s72, s68
    buffer_load_dword v249, v11, s[40:43], s84 offen sc1
    s_sleep 3
    buffer_load_dword v250, v11, s[40:43], s84 offen sc1
    s_sleep 3
    s_nop 0
Lpoll_P_8:
    s_sub_u32 s6, s6, 1
    s_cbranch_scc1 L_end_P
    buffer_load_dword v251, v11, s[40:43], s84 offen sc1
    s_waitcnt vmcnt(2)
    v_cmp_ne_u32 vcc, s4, v249
    s_nop 1
    s_cbranch_vccz Lpd_P_9
    buffer_load_dword v249, v11, s[40:43], s84 offen sc1
    s_waitcnt vmcnt(2)
    v_cmp_ne_u32 vcc, s4, v250
    s_nop 1
    s_cbranch_vccz Lpd_P_9
    buffer_load_dword v250, v11, s[40:43], s84 offen sc1
    s_waitcnt vmcnt(2)
    v_cmp_ne_u32 vcc, s4, v251
    s_nop 1
    s_cbranch_vccnz Lpoll_P_8
    s_nop 1
Lpd_P_9:
    s_add_u32 s56, s71, s94
    s_add_u32 s57, s72, s94
    buffer_load_dwordx4 v[80:83], v5, s[40:43], s56 offen offset:0 sc1
    buffer_load_dwordx4 v[84:87], v5, s[40:43], s57 offen offset:0 sc1
    buffer_load_dwordx4 v[88:91], v5, s[40:43], s56 offen offset:1024 sc1
    buffer_load_dwordx4 v[92:95], v5, s[40:43], s57 offen offset:1024 sc1
    buffer_load_dwordx4 v[96:99], v5, s[40:43], s56 offen offset:2048 sc1
    buffer_load_dwordx4 v[100:103], v5, s[40:43], s57 offen offset:2048 sc1
    buffer_load_dwordx4 v[104:107], v5, s[40:43], s56 offen offset:3072 sc1
    buffer_load_dwordx4 v[108:111], v5, s[40:43], s57 offen offset:3072 sc1
    s_add_u32 s56, s71, s95
    s_add_u32 s57, s72, s95
    buffer_load_dwordx4 v[112:115], v5, s[40:43], s56 offen offset:0 sc1
    buffer_load_dwordx4 v[116:119], v5, s[40:43], s57 offen offset:0 sc1
    buffer_load_dwordx4 v[120:123], v5, s[40:43], s56 offen offset:1024 sc1
    buffer_load_dwordx4 v[124:127], v5, s[40:43], s57 offen offset:1024 sc1
    v_lshlrev_b32 v16, 16, v222
    v_and_b32 v17, 0xffff0000, v222
    v_lshlrev_b32 v18, 16, v223
    v_and_b32 v19, 0xffff0000, v223
    v_lshlrev_b32 v20, 16, v224
    v_and_b32 v21, 0xffff0000, v224
    v_lshlrev_b32 v22, 16, v225
    v_and_b32 v23, 0xffff0000, v225
    v_lshlrev_b32 v24, 16, v226
    v_and_b32 v25, 0xffff0000, v226
    v_lshlrev_b32 v26, 16, v227
    v_and_b32 v27, 0xffff0000, v227
    v_lshlrev_b32 v28, 16, v228
    v_and_b32 v29, 0xffff0000, v228
    v_lshlrev_b32 v30, 16, v229
    v_and_b32 v31, 0xffff0000, v229
    ds_read_b64_tr_b16 a[80:81], v215 offset:12288
    ds_read_b64_tr_b16 a[82:83], v215 offset:13312
    ds_read_b64_tr_b16 a[84:85], v216 offset:12288
    ds_read_b64_tr_b16 a[86:87], v216 offset:13312
    ds_read_b64_tr_b16 a[88:89], v215 offset:14336
    ds_read_b64_tr_b16 a[90:91], v215 offset:15360
    ds_read_b64_tr_b16 a[92:93], v216 offset:14336
    ds_read_b64_tr_b16 a[94:95], v216 offset:15360
    ds_read_b64_tr_b16 a[96:97], v215 offset:16384
    ds_read_b64_tr_b16 a[98:99], v215 offset:17408
    ds_read_b64_tr_b16 a[100:101], v216 offset:16384
    ds_read_b64_tr_b16 a[102:103], v216 offset:17408
    ds_read_b64_tr_b16 a[104:105], v215 offset:18432
    ds_read_b64_tr_b16 a[106:107], v215 offset:19456
    ds_read_b64_tr_b16 a[108:109], v216 offset:18432
    ds_read_b64_tr_b16 a[110:111], v216 offset:19456
    ds_read_b64_tr_b16 a[112:113], v215 offset:20480
    ds_read_b64_tr_b16 a[114:115], v215 offset:21504
    ds_read_b64_tr_b16 a[116:117], v216 offset:20480
    ds_read_b64_tr_b16 a[118:119], v216 offset:21504
    ds_read_b64_tr_b16 a[120:121], v215 offset:22528
    ds_read_b64_tr_b16 a[122:123], v215 offset:23552
    ds_read_b64_tr_b16 a[124:125], v216 offset:22528
    ds_read_b64_tr_b16 a[126:127], v216 offset:23552
    buffer_load_dwordx4 v[128:131], v5, s[40:43], s56 offen offset:2048 sc1
    buffer_load_dwordx4 v[132:135], v5, s[40:43], s57 offen offset:2048 sc1
    buffer_load_dwordx4 v[136:139], v5, s[40:43], s56 offen offset:3072 sc1
    buffer_load_dwordx4 v[140:143], v5, s[40:43], s57 offen offset:3072 sc1
    s_waitcnt vmcnt(15)
    v_mfma_f32_32x32x16_bf16 v[16:31], a[128:131], v[80:83], v[16:31]
    s_waitcnt vmcnt(14)
    v_mfma_f32_32x32x16_bf16 v[32:47], a[128:131], v[84:87], 0
    v_mfma_f32_32x32x16_bf16 v[48:63], a[132:135], v[80:83], 0
    v_mfma_f32_32x32x16_bf16 v[64:79], a[132:135], v[84:87], 0
    s_add_u32 s56, s71, s96
    s_add_u32 s57, s72, s96
    buffer_load_dwordx4 v[144:147], v5, s[40:43], s56 offen offset:0 sc1
    buffer_load_dwordx4 v[148:151], v5, s[40:43], s57 offen offset:0 sc1
    buffer_load_dwordx4 v[152:155], v5, s[40:43], s56 offen offset:1024 sc1
    buffer_load_dwordx4 v[156:159], v5, s[40:43], s57 offen offset:1024 sc1
    s_waitcnt vmcnt(17)
    v_mfma_f32_32x32x16_bf16 v[16:31], a[136:139], v[88:91], v[16:31]
    s_waitcnt vmcnt(16)
    v_mfma_f32_32x32x16_bf16 v[32:47], a[136:139], v[92:95], v[32:47]
    v_mfma_f32_32x32x16_bf16 v[48:63], a[140:143], v[88:91], v[48:63]
    v_mfma_f32_32x32x16_bf16 v[64:79], a[140:143], v[92:95], v[64:79]
    buffer_load_dwordx4 v[160:163], v5, s[40:43], s56 offen offset:2048 sc1
    buffer_load_dwordx4 v[164:167], v5, s[40:43], s57 offen offset:2048 sc1
    buffer_load_dwordx4 v[168:171], v5, s[40:43], s56 offen offset:3072 sc1
    buffer_load_dwordx4 v[172:175], v5, s[40:43], s57 offen offset:3072 sc1
    s_waitcnt vmcnt(19)
    v_mfma_f32_32x32x16_bf16 v[16:31], a[144:147], v[96:99], v[16:31]
    s_waitcnt vmcnt(18)
    v_mfma_f32_32x32x16_bf16 v[32:47], a[144:147], v[100:103], v[32:47]
    v_mfma_f32_32x32x16_bf16 v[48:63], a[148:151], v[96:99], v[48:63]
    v_mfma_f32_32x32x16_bf16 v[64:79], a[148:151], v[100:103], v[64:79]
    s_add_u32 s56, s71, s97
    s_add_u32 s57, s72, s97
    buffer_load_dwordx4 v[176:179], v5, s[40:43], s56 offen offset:0 sc1
    buffer_load_dwordx4 v[180:183], v5, s[40:43], s57 offen offset:0 sc1
    buffer_load_dwordx4 v[184:187], v5, s[40:43], s56 offen offset:1024 sc1
    buffer_load_dwordx4 v[188:191], v5, s[40:43], s57 offen offset:1024 sc1
    s_waitcnt vmcnt(21)
    v_mfma_f32_32x32x16_bf16 v[16:31], a[152:155], v[104:107], v[16:31]
    s_waitcnt vmcnt(20)
    v_mfma_f32_32x32x16_bf16 v[32:47], a[152:155], v[108:111], v[32:47]
    v_mfma_f32_32x32x16_bf16 v[48:63], a[156:159], v[104:107], v[48:63]
    v_mfma_f32_32x32x16_bf16 v[64:79], a[156:159], v[108:111], v[64:79]
    buffer_load_dwordx4 v[192:195], v5, s[40:43], s56 offen offset:2048 sc1
    buffer_load_dwordx4 v[196:199], v5, s[40:43], s57 offen offset:2048 sc1
    buffer_load_dwordx4 v[200:203], v5, s[40:43], s56 offen offset:3072 sc1
    buffer_load_dwordx4 v[204:207], v5, s[40:43], s57 offen offset:3072 sc1
    s_waitcnt vmcnt(23)
    v_mfma_f32_32x32x16_bf16 v[16:31], a[160:163], v[112:115], v[16:31]
    s_waitcnt vmcnt(22)
    v_mfma_f32_32x32x16_bf16 v[32:47], a[160:163], v[116:119], v[32:47]
    v_mfma_f32_32x32x16_bf16 v[48:63], a[164:167], v[112:115], v[48:63]
    v_mfma_f32_32x32x16_bf16 v[64:79], a[164:167], v[116:119], v[64:79]
    s_add_u32 s56, s71, s98
    s_add_u32 s57, s72, s98
    buffer_load_dwordx4 v[80:83], v5, s[40:43], s56 offen offset:0 sc1
    buffer_load_dwordx4 v[84:87], v5, s[40:43], s57 offen offset:0 sc1
    buffer_load_dwordx4 v[88:91], v5, s[40:43], s56 offen offset:1024 sc1
    buffer_load_dwordx4 v[92:95], v5, s[40:43], s57 offen offset:1024 sc1
    s_waitcnt vmcnt(25)
    v_mfma_f32_32x32x16_bf16 v[16:31], a[168:171], v[120:123], v[16:31]
    s_waitcnt vmcnt(24)
    v_mfma_f32_32x32x16_bf16 v[32:47], a[168:171], v[124:127], v[32:47]
    v_mfma_f32_32x32x16_bf16 v[48:63], a[172:175], v[120:123], v[48:63]
    v_mfma_f32_32x32x16_bf16 v[64:79], a[172:175], v[124:127], v[64:79]
    buffer_load_dwordx4 v[96:99], v5, s[40:43], s56 offen offset:2048 sc1
    buffer_load_dwordx4 v[100:103], v5, s[40:43], s57 offen offset:2048 sc1
    buffer_load_dwordx4 v[104:107], v5, s[40:43], s56 offen offset:3072 sc1
    buffer_load_dwordx4 v[108:111], v5, s[40:43], s57 offen offset:3072 sc1
    s_waitcnt vmcnt(27)
    v_mfma_f32_32x32x16_bf16 v[16:31], a[176:179], v[128:131], v[16:31]
    s_waitcnt vmcnt(26)
    v_mfma_f32_32x32x16_bf16 v[32:47], a[176:179], v[132:135], v[32:47]
    v_mfma_f32_32x32x16_bf16 v[48:63], a[180:183], v[128:131], v[48:63]
    v_mfma_f32_32x32x16_bf16 v[64:79], a[180:183], v[132:135], v[64:79]
    s_add_u32 s56, s71, s99
    s_add_u32 s57, s72, s99
    buffer_load_dwordx4 v[112:115], v5, s[40:43], s56 offen offset:0 sc1
    buffer_load_dwordx4 v[116:119], v5, s[40:43], s57 offen offset:0 sc1
    buffer_load_dwordx4 v[120:123], v5, s[40:43], s56 offen offset:1024 sc1
    buffer_load_dwordx4 v[124:127], v5, s[40:43], s57 offen offset:1024 sc1
    s_waitcnt vmcnt(29)
    v_mfma_f32_32x32x16_bf16 v[16:31], a[184:187], v[136:139], v[16:31]
    s_waitcnt vmcnt(28)
    v_mfma_f32_32x32x16_bf16 v[32:47], a[184:187], v[140:143], v[32:47]
    v_mfma_f32_32x32x16_bf16 v[48:63], a[188:191], v[136:139], v[48:63]
    v_mfma_f32_32x32x16_bf16 v[64:79], a[188:191], v[140:143], v[64:79]
    buffer_load_dwordx4 v[128:131], v5, s[40:43], s56 offen offset:2048 sc1
    buffer_load_dwordx4 v[132:135], v5, s[40:43], s57 offen offset:2048 sc1
    buffer_load_dwordx4 v[136:139], v5, s[40:43], s56 offen offset:3072 sc1
    buffer_load_dwordx4 v[140:143], v5, s[40:43], s57 offen offset:3072 sc1
    s_waitcnt vmcnt(31)
    v_mfma_f32_32x32x16_bf16 v[16:31], a[192:195], v[144:147], v[16:31]
    s_waitcnt vmcnt(30)
    v_mfma_f32_32x32x16_bf16 v[32:47], a[192:195], v[148:151], v[32:47]
    v_mfma_f32_32x32x16_bf16 v[48:63], a[196:199], v[144:147], v[48:63]
    v_mfma_f32_32x32x16_bf16 v[64:79], a[196:199], v[148:151], v[64:79]
    ds_read_b64_tr_b16 a[128:129], v217 offset:24576
    ds_read_b64_tr_b16 a[130:131], v217 offset:25600
    ds_read_b64_tr_b16 a[132:133], v218 offset:24576
    ds_read_b64_tr_b16 a[134:135], v218 offset:25600
    s_add_u32 s56, s71, s100
    s_add_u32 s57, s72, s100
    buffer_load_dwordx4 v[144:147], v5, s[40:43], s56 offen offset:0 sc1
    buffer_load_dwordx4 v[148:151], v5, s[40:43], s57 offen offset:0 sc1
    s_waitcnt vmcnt(31)
    v_mfma_f32_32x32x16_bf16 v[16:31], a[200:203], v[152:155], v[16:31]
    s_waitcnt vmcnt(30)
    v_mfma_f32_32x32x16_bf16 v[32:47], a[200:203], v[156:159], v[32:47]
    v_mfma_f32_32x32x16_bf16 v[48:63], a[204:207], v[152:155], v[48:63]
    v_mfma_f32_32x32x16_bf16 v[64:79], a[204:207], v[156:159], v[64:79]
    ds_read_b64_tr_b16 a[136:137], v217 offset:26624
    ds_read_b64_tr_b16 a[138:139], v217 offset:27648
    ds_read_b64_tr_b16 a[140:141], v218 offset:26624
    ds_read_b64_tr_b16 a[142:143], v218 offset:27648
    buffer_load_dwordx4 v[152:155], v5, s[40:43], s56 offen offset:1024 sc1
    buffer_load_dwordx4 v[156:159], v5, s[40:43], s57 offen offset:1024 sc1
    s_waitcnt vmcnt(31)
    v_mfma_f32_32x32x16_bf16 v[16:31], a[208:211], v[160:163], v[16:31]
    s_waitcnt vmcnt(30)
    v_mfma_f32_32x32x16_bf16 v[32:47], a[208:211], v[164:167], v[32:47]
    v_mfma_f32_32x32x16_bf16 v[48:63], a[212:215], v[160:163], v[48:63]
    v_mfma_f32_32x32x16_bf16 v[64:79], a[212:215], v[164:167], v[64:79]
    ds_read_b64_tr_b16 a[144:145], v217 offset:28672
    ds_read_b64_tr_b16 a[146:147], v217 offset:29696
    ds_read_b64_tr_b16 a[148:149], v218 offset:28672
    ds_read_b64_tr_b16 a[150:151], v218 offset:29696
    buffer_load_dwordx4 v[160:163], v5, s[40:43], s56 offen offset:2048 sc1
    buffer_load_dwordx4 v[164:167], v5, s[40:43], s57 offen offset:2048 sc1
    s_waitcnt vmcnt(31)
    v_mfma_f32_32x32x16_bf16 v[16:31], a[216:219], v[168:171], v[16:31]
    s_waitcnt vmcnt(30)
    v_mfma_f32_32x32x16_bf16 v[32:47], a[216:219], v[172:175], v[32:47]
    v_mfma_f32_32x32x16_bf16 v[48:63], a[220:223], v[168:171], v[48:63]
    v_mfma_f32_32x32x16_bf16 v[64:79], a[220:223], v[172:175], v[64:79]
    ds_read_b64_tr_b16 a[152:153], v217 offset:30720
    ds_read_b64_tr_b16 a[154:155], v217 offset:31744
    ds_read_b64_tr_b16 a[156:157], v218 offset:30720
    ds_read_b64_tr_b16 a[158:159], v218 offset:31744
    buffer_load_dwordx4 v[168:171], v5, s[40:43], s56 offen offset:3072 sc1
    buffer_load_dwordx4 v[172:175], v5, s[40:43], s57 offen offset:3072 sc1
    s_waitcnt vmcnt(31)
    v_mfma_f32_32x32x16_bf16 v[16:31], a[224:227], v[176:179], v[16:31]
    s_waitcnt vmcnt(30)
    v_mfma_f32_32x32x16_bf16 v[32:47], a[224:227], v[180:183], v[32:47]
    v_mfma_f32_32x32x16_bf16 v[48:63], a[228:231], v[176:179], v[48:63]
    v_mfma_f32_32x32x16_bf16 v[64:79], a[228:231], v[180:183], v[64:79]
    ds_read_b64_tr_b16 a[160:161], v217 offset:32768
    ds_read_b64_tr_b16 a[162:163], v217 offset:33792
    ds_read_b64_tr_b16 a[164:165], v218 offset:32768
    ds_read_b64_tr_b16 a[166:167], v218 offset:33792
    s_add_u32 s56, s71, s101
    s_add_u32 s57, s72, s101
    buffer_load_dwordx4 v[176:179], v5, s[40:43], s56 offen offset:0 sc1
    buffer_load_dwordx4 v[180:183], v5, s[40:43], s57 offen offset:0 sc1
    s_waitcnt vmcnt(31)
    v_mfma_f32_32x32x16_bf16 v[16:31], a[232:235], v[184:187], v[16:31]
    s_waitcnt vmcnt(30)
    v_mfma_f32_32x32x16_bf16 v[32:47], a[232:235], v[188:191], v[32:47]
    v_mfma_f32_32x32x16_bf16 v[48:63], a[236:239], v[184:187], v[48:63]
    v_mfma_f32_32x32x16_bf16 v[64:79], a[236:239], v[188:191], v[64:79]
    ds_read_b64_tr_b16 a[168:169], v217 offset:34816
    ds_read_b64_tr_b16 a[170:171], v217 offset:35840
    ds_read_b64_tr_b16 a[172:173], v218 offset:34816
    ds_read_b64_tr_b16 a[174:175], v218 offset:35840
    buffer_load_dwordx4 v[184:187], v5, s[40:43], s56 offen offset:1024 sc1
    buffer_load_dwordx4 v[188:191], v5, s[40:43], s57 offen offset:1024 sc1
    s_waitcnt vmcnt(31)
    v_mfma_f32_32x32x16_bf16 v[16:31], a[240:243], v[192:195], v[16:31]
    s_waitcnt vmcnt(30)
    v_mfma_f32_32x32x16_bf16 v[32:47], a[240:243], v[196:199], v[32:47]
    v_mfma_f32_32x32x16_bf16 v[48:63], a[244:247], v[192:195], v[48:63]
    v_mfma_f32_32x32x16_bf16 v[64:79], a[244:247], v[196:199], v[64:79]
    s_xor_b32 s68, s3, 1
    s_mul_i32 s68, s68, 36864
    s_add_u32 s68, s68, 12288
    v_add_u32 v221, s68, v4
    s_xor_b32 s68, s3, 2
    s_mul_i32 s68, s68, 36864
    s_add_u32 s68, s68, 16384
    v_add_u32 v222, s68, v4
    s_xor_b32 s68, s3, 3
    s_mul_i32 s68, s68, 36864
    s_add_u32 s68, s68, 20480
    v_add_u32 v223, s68, v4
    v_add_u32 v220, s70, v4
    s_lshl_b32 s68, s64, 1
    s_and_b32 s69, s3, 1
    s_add_u32 s68, s68, s69
    s_mul_i32 s68, s68, 112
    s_lshl_b32 s69, s65, 2
    s_add_u32 s68, s68, s69
    s_and_b32 s69, s3, 2
    s_add_u32 s68, s68, s69
    s_lshl_b32 s68, s68, 10
    s_add_u32 s68, s68, 0x3c0000
    s_mov_b32 s88, 0xc0135761
    s_mov_b32 s90, 0xbdd2d3e8
    v_mov_b32 v224, s88
    v_mov_b32 v225, s88
    buffer_load_dwordx4 v[192:195], v5, s[40:43], s56 offen offset:2048 sc1
    buffer_load_dwordx4 v[196:199], v5, s[40:43], s57 offen offset:2048 sc1
    s_waitcnt vmcnt(31)
    v_mfma_f32_32x32x16_bf16 v[16:31], a[248:251], v[200:203], v[16:31]
    s_waitcnt vmcnt(30)
    v_mfma_f32_32x32x16_bf16 v[32:47], a[248:251], v[204:207], v[32:47]
    v_mfma_f32_32x32x16_bf16 v[48:63], a[252:255], v[200:203], v[48:63]
    v_mfma_f32_32x32x16_bf16 v[64:79], a[252:255], v[204:207], v[64:79]
    buffer_load_dwordx4 v[200:203], v5, s[40:43], s56 offen offset:3072 sc1
    buffer_load_dwordx4 v[204:207], v5, s[40:43], s57 offen offset:3072 sc1
    s_waitcnt vmcnt(31)
    v_mfma_f32_32x32x16_bf16 v[16:31], a[0:3], v[80:83], v[16:31]
    s_waitcnt vmcnt(30)
    v_mfma_f32_32x32x16_bf16 v[32:47], a[0:3], v[84:87], v[32:47]
    v_mfma_f32_32x32x16_bf16 v[48:63], a[4:7], v[80:83], v[48:63]
    v_mfma_f32_32x32x16_bf16 v[64:79], a[4:7], v[84:87], v[64:79]
    s_barrier
    s_waitcnt lgkmcnt(15)
    s_add_u32 m0, s70, 12288
    s_mul_i32 s73, s49, 64
    s_add_u32 s73, s73, 131072
    buffer_load_dwordx4 v214, s[24:27], s73 offen lds
    s_add_u32 m0, s70, 13312
    s_mul_i32 s73, s49, 64
    s_add_u32 s73, s73, 163840
    buffer_load_dwordx4 v214, s[24:27], s73 offen lds
    s_waitcnt vmcnt(31)
    v_mfma_f32_32x32x16_bf16 v[16:31], a[8:11], v[88:91], v[16:31]
    s_waitcnt vmcnt(30)
    v_mfma_f32_32x32x16_bf16 v[32:47], a[8:11], v[92:95], v[32:47]
    v_mfma_f32_32x32x16_bf16 v[48:63], a[12:15], v[88:91], v[48:63]
    v_mfma_f32_32x32x16_bf16 v[64:79], a[12:15], v[92:95], v[64:79]
    s_add_u32 m0, s70, 14336
    s_mul_i32 s73, s49, 64
    s_add_u32 s73, s73, 196608
    buffer_load_dwordx4 v214, s[24:27], s73 offen lds
    s_add_u32 m0, s70, 15360
    s_mul_i32 s73, s49, 64
    s_add_u32 s73, s73, 229376
    buffer_load_dwordx4 v214, s[24:27], s73 offen lds
    s_waitcnt vmcnt(31)
    v_mfma_f32_32x32x16_bf16 v[16:31], a[16:19], v[96:99], v[16:31]
    s_waitcnt vmcnt(30)
    v_mfma_f32_32x32x16_bf16 v[32:47], a[16:19], v[100:103], v[32:47]
    v_mfma_f32_32x32x16_bf16 v[48:63], a[20:23], v[96:99], v[48:63]
    v_mfma_f32_32x32x16_bf16 v[64:79], a[20:23], v[100:103], v[64:79]
    s_add_u32 m0, s70, 16384
    s_mul_i32 s73, s50, 64
    s_add_u32 s73, s73, 0
    buffer_load_dwordx4 v214, s[24:27], s73 offen lds
    s_add_u32 m0, s70, 17408
    s_mul_i32 s73, s50, 64
    s_add_u32 s73, s73, 32768
    buffer_load_dwordx4 v214, s[24:27], s73 offen lds
    s_waitcnt vmcnt(31)
    v_mfma_f32_32x32x16_bf16 v[16:31], a[24:27], v[104:107], v[16:31]
    s_waitcnt vmcnt(30)
    v_mfma_f32_32x32x16_bf16 v[32:47], a[24:27], v[108:111], v[32:47]
    v_mfma_f32_32x32x16_bf16 v[48:63], a[28:31], v[104:107], v[48:63]
    v_mfma_f32_32x32x16_bf16 v[64:79], a[28:31], v[108:111], v[64:79]
    s_add_u32 m0, s70, 18432
    s_mul_i32 s73, s50, 64
    s_add_u32 s73, s73, 65536
    buffer_load_dwordx4 v214, s[24:27], s73 offen lds
    s_add_u32 m0, s70, 19456
    s_mul_i32 s73, s50, 64
    s_add_u32 s73, s73, 98304
    buffer_load_dwordx4 v214, s[24:27], s73 offen lds
    s_waitcnt vmcnt(31)
    v_mfma_f32_32x32x16_bf16 v[16:31], a[32:35], v[112:115], v[16:31]
    s_waitcnt vmcnt(30)
    v_mfma_f32_32x32x16_bf16 v[32:47], a[32:35], v[116:119], v[32:47]
    v_mfma_f32_32x32x16_bf16 v[48:63], a[36:39], v[112:115], v[48:63]
    v_mfma_f32_32x32x16_bf16 v[64:79], a[36:39], v[116:119], v[64:79]
    s_add_u32 m0, s70, 20480
    s_mul_i32 s73, s50, 64
    s_add_u32 s73, s73, 131072
    buffer_load_dwordx4 v214, s[24:27], s73 offen lds
    s_add_u32 m0, s70, 21504
    s_mul_i32 s73, s50, 64
    s_add_u32 s73, s73, 163840
    buffer_load_dwordx4 v214, s[24:27], s73 offen lds
    s_waitcnt vmcnt(31)
    v_mfma_f32_32x32x16_bf16 v[16:31], a[40:43], v[120:123], v[16:31]
    s_waitcnt vmcnt(30)
    v_mfma_f32_32x32x16_bf16 v[32:47], a[40:43], v[124:127], v[32:47]
    v_mfma_f32_32x32x16_bf16 v[48:63], a[44:47], v[120:123], v[48:63]
    v_mfma_f32_32x32x16_bf16 v[64:79], a[44:47], v[124:127], v[64:79]
    s_add_u32 m0, s70, 22528
    s_mul_i32 s73, s50, 64
    s_add_u32 s73, s73, 196608
    buffer_load_dwordx4 v214, s[24:27], s73 offen lds
    s_add_u32 m0, s70, 23552
    s_mul_i32 s73, s50, 64
    s_add_u32 s73, s73, 229376
    buffer_load_dwordx4 v214, s[24:27], s73 offen lds
    s_waitcnt vmcnt(31)
    v_mfma_f32_32x32x16_bf16 v[16:31], a[48:51], v[128:131], v[16:31]
    s_waitcnt vmcnt(30)
    v_mfma_f32_32x32x16_bf16 v[32:47], a[48:51], v[132:135], v[32:47]
    v_mfma_f32_32x32x16_bf16 v[48:63], a[52:55], v[128:131], v[48:63]
    v_mfma_f32_32x32x16_bf16 v[64:79], a[52:55], v[132:135], v[64:79]
    s_add_u32 m0, s70, 24576
    s_mul_i32 s73, s51, 64
    s_add_u32 s73, s73, 0
    buffer_load_dwordx4 v214, s[24:27], s73 offen lds
    s_add_u32 m0, s70, 25600
    s_mul_i32 s73, s51, 64
    s_add_u32 s73, s73, 32768
    buffer_load_dwordx4 v214, s[24:27], s73 offen lds
    s_waitcnt vmcnt(31)
    v_mfma_f32_32x32x16_bf16 v[16:31], a[56:59], v[136:139], v[16:31]
    s_waitcnt vmcnt(30)
    v_mfma_f32_32x32x16_bf16 v[32:47], a[56:59], v[140:143], v[32:47]
    v_mfma_f32_32x32x16_bf16 v[48:63], a[60:63], v[136:139], v[48:63]
    v_mfma_f32_32x32x16_bf16 v[64:79], a[60:63], v[140:143], v[64:79]
    s_add_u32 m0, s70, 26624
    s_mul_i32 s73, s51, 64
    s_add_u32 s73, s73, 65536
    buffer_load_dwordx4 v214, s[24:27], s73 offen lds
    s_add_u32 m0, s70, 27648
    s_mul_i32 s73, s51, 64
    s_add_u32 s73, s73, 98304
    buffer_load_dwordx4 v214, s[24:27], s73 offen lds
    s_waitcnt vmcnt(31)
    v_mfma_f32_32x32x16_bf16 v[16:31], a[64:67], v[144:147], v[16:31]
    s_waitcnt vmcnt(30)
    v_mfma_f32_32x32x16_bf16 v[32:47], a[64:67], v[148:151], v[32:47]
    v_mfma_f32_32x32x16_bf16 v[48:63], a[68:71], v[144:147], v[48:63]
    v_mfma_f32_32x32x16_bf16 v[64:79], a[68:71], v[148:151], v[64:79]
    s_waitcnt lgkmcnt(12)
    s_add_u32 m0, s70, 28672
    s_mul_i32 s73, s51, 64
    s_add_u32 s73, s73, 131072
    buffer_load_dwordx4 v214, s[24:27], s73 offen lds
    s_add_u32 m0, s70, 29696
    s_mul_i32 s73, s51, 64
    s_add_u32 s73, s73, 163840
    buffer_load_dwordx4 v214, s[24:27], s73 offen lds
    s_waitcnt vmcnt(31)
    v_mfma_f32_32x32x16_bf16 v[16:31], a[72:75], v[152:155], v[16:31]
    s_waitcnt vmcnt(30)
    v_mfma_f32_32x32x16_bf16 v[32:47], a[72:75], v[156:159], v[32:47]
    v_mfma_f32_32x32x16_bf16 v[48:63], a[76:79], v[152:155], v[48:63]
    v_mfma_f32_32x32x16_bf16 v[64:79], a[76:79], v[156:159], v[64:79]
    s_waitcnt lgkmcnt(8)
    s_add_u32 m0, s70, 30720
    s_mul_i32 s73, s51, 64
    s_add_u32 s73, s73, 196608
    buffer_load_dwordx4 v214, s[24:27], s73 offen lds
    s_add_u32 m0, s70, 31744
    s_mul_i32 s73, s51, 64
    s_add_u32 s73, s73, 229376
    buffer_load_dwordx4 v214, s[24:27], s73 offen lds
    s_waitcnt vmcnt(31)
    v_mfma_f32_32x32x16_bf16 v[16:31], a[80:83], v[160:163], v[16:31]
    s_waitcnt vmcnt(30)
    v_mfma_f32_32x32x16_bf16 v[32:47], a[80:83], v[164:167], v[32:47]
    v_mfma_f32_32x32x16_bf16 v[48:63], a[84:87], v[160:163], v[48:63]
    v_mfma_f32_32x32x16_bf16 v[64:79], a[84:87], v[164:167], v[64:79]
    s_waitcnt lgkmcnt(4)
    s_add_u32 m0, s70, 32768
    s_mul_i32 s73, s52, 64
    s_add_u32 s73, s73, 0
    buffer_load_dwordx4 v214, s[24:27], s73 offen lds
    s_add_u32 m0, s70, 33792
    s_mul_i32 s73, s52, 64
    s_add_u32 s73, s73, 32768
    buffer_load_dwordx4 v214, s[24:27], s73 offen lds
    s_waitcnt vmcnt(31)
    v_mfma_f32_32x32x16_bf16 v[16:31], a[88:91], v[168:171], v[16:31]
    s_waitcnt vmcnt(30)
    v_mfma_f32_32x32x16_bf16 v[32:47], a[88:91], v[172:175], v[32:47]
    v_mfma_f32_32x32x16_bf16 v[48:63], a[92:95], v[168:171], v[48:63]
    v_mfma_f32_32x32x16_bf16 v[64:79], a[92:95], v[172:175], v[64:79]
    s_waitcnt lgkmcnt(0)
    s_add_u32 m0, s70, 34816
    s_mul_i32 s73, s52, 64
    s_add_u32 s73, s73, 65536
    buffer_load_dwordx4 v214, s[24:27], s73 offen lds
    s_add_u32 m0, s70, 35840
    s_mul_i32 s73, s52, 64
    s_add_u32 s73, s73, 98304
    buffer_load_dwordx4 v214, s[24:27], s73 offen lds
    s_waitcnt vmcnt(30)
    v_mfma_f32_32x32x16_bf16 v[64:79], a[100:103], v[180:183], v[64:79]
    s_waitcnt vmcnt(28)
    v_mfma_f32_32x32x16_bf16 v[64:79], a[108:111], v[188:191], v[64:79]
    s_waitcnt vmcnt(26)
    v_mfma_f32_32x32x16_bf16 v[64:79], a[116:119], v[196:199], v[64:79]
    s_waitcnt vmcnt(24)
    v_mfma_f32_32x32x16_bf16 v[64:79], a[124:127], v[204:207], v[64:79]
    v_mfma_f32_32x32x16_bf16 v[48:63], a[100:103], v[176:179], v[48:63]
    v_mfma_f32_32x32x16_bf16 v[48:63], a[108:111], v[184:187], v[48:63]
    s_nop 9
    ds_write_b128 v223, v[64:67] offset:0
    ds_write_b128 v223, v[68:71] offset:1024
    v_mfma_f32_32x32x16_bf16 v[48:63], a[116:119], v[192:195], v[48:63]
    ds_write_b128 v223, v[72:75] offset:2048
    v_mfma_f32_32x32x16_bf16 v[48:63], a[124:127], v[200:203], v[48:63]
    ds_write_b128 v223, v[76:79] offset:3072
    v_mfma_f32_32x32x16_bf16 v[32:47], a[96:99], v[180:183], v[32:47]
    v_mfma_f32_32x32x16_bf16 v[32:47], a[104:107], v[188:191], v[32:47]
    s_nop 8
    ds_write_b128 v222, v[48:51] offset:0
    ds_write_b128 v222, v[52:55] offset:1024
    v_mfma_f32_32x32x16_bf16 v[32:47], a[112:115], v[196:199], v[32:47]
    ds_write_b128 v222, v[56:59] offset:2048
    v_mfma_f32_32x32x16_bf16 v[32:47], a[120:123], v[204:207], v[32:47]
    ds_write_b128 v222, v[60:63] offset:3072
    v_mfma_f32_32x32x16_bf16 v[16:31], a[96:99], v[176:179], v[16:31]
    v_mfma_f32_32x32x16_bf16 v[16:31], a[104:107], v[184:187], v[16:31]
    s_nop 8
    ds_write_b128 v221, v[32:35] offset:0
    ds_write_b128 v221, v[36:39] offset:1024
    v_mfma_f32_32x32x16_bf16 v[16:31], a[112:115], v[192:195], v[16:31]
    ds_write_b128 v221, v[40:43] offset:2048
    v_mfma_f32_32x32x16_bf16 v[16:31], a[120:123], v[200:203], v[16:31]
    ds_write_b128 v221, v[44:47] offset:3072
    s_waitcnt lgkmcnt(0)
    s_barrier
    ds_read_b128 v[32:35], v220 offset:0
    ds_read_b128 v[48:51], v220 offset:4096
    ds_read_b128 v[64:67], v220 offset:8192
    ds_read_b128 v[36:39], v220 offset:1024
    ds_read_b128 v[52:55], v220 offset:5120
    ds_read_b128 v[68:71], v220 offset:9216
    ds_read_b128 v[40:43], v220 offset:2048
    ds_read_b128 v[56:59], v220 offset:6144
    ds_read_b128 v[72:75], v220 offset:10240
    ds_read_b128 v[44:47], v220 offset:3072
    ds_read_b128 v[60:63], v220 offset:7168
    ds_read_b128 v[76:79], v220 offset:11264
    s_waitcnt lgkmcnt(10)
    v_pk_add_f32 v[32:33], v[32:33], v[48:49]
    s_waitcnt lgkmcnt(9)
    v_pk_add_f32 v[16:17], v[16:17], v[64:65]
    v_pk_add_f32 v[34:35], v[34:35], v[50:51]
    v_pk_add_f32 v[18:19], v[18:19], v[66:67]
    s_waitcnt lgkmcnt(7)
    v_pk_add_f32 v[36:37], v[36:37], v[52:53]
    s_waitcnt lgkmcnt(6)
    v_pk_add_f32 v[20:21], v[20:21], v[68:69]
    v_pk_add_f32 v[38:39], v[38:39], v[54:55]
    v_pk_add_f32 v[22:23], v[22:23], v[70:71]
    v_pk_add_f32 v[16:17], v[16:17], v[32:33]
    v_pk_add_f32 v[18:19], v[18:19], v[34:35]
    v_pk_add_f32 v[20:21], v[20:21], v[36:37]
    v_pk_add_f32 v[22:23], v[22:23], v[38:39]
    v_pk_mul_f32 v[80:81], v[16:17], v[16:17]
    v_pk_mul_f32 v[82:83], v[18:19], v[18:19]
    v_pk_mul_f32 v[84:85], v[20:21], v[20:21]
    v_pk_mul_f32 v[86:87], v[22:23], v[22:23]
    v_pk_fma_f32 v[80:81], v[80:81], s[90:91], v[224:225] op_sel_hi:[1,0,1]
    v_pk_fma_f32 v[82:83], v[82:83], s[90:91], v[224:225] op_sel_hi:[1,0,1]
    v_pk_fma_f32 v[84:85], v[84:85], s[90:91], v[224:225] op_sel_hi:[1,0,1]
    v_pk_fma_f32 v[86:87], v[86:87], s[90:91], v[224:225] op_sel_hi:[1,0,1]
    v_pk_mul_f32 v[80:81], v[80:81], v[16:17]
    v_pk_mul_f32 v[82:83], v[82:83], v[18:19]
    v_pk_mul_f32 v[84:85], v[84:85], v[20:21]
    v_pk_mul_f32 v[86:87], v[86:87], v[22:23]
    v_exp_f32 v80, v80
    v_exp_f32 v81, v81
    v_exp_f32 v82, v82
    v_exp_f32 v83, v83
    v_exp_f32 v84, v84
    v_exp_f32 v85, v85
    v_exp_f32 v86, v86
    v_exp_f32 v87, v87
    v_pk_add_f32 v[80:81], v[80:81], 1.0 op_sel_hi:[1,0]
    v_pk_add_f32 v[82:83], v[82:83], 1.0 op_sel_hi:[1,0]
    v_pk_add_f32 v[84:85], v[84:85], 1.0 op_sel_hi:[1,0]
    v_pk_add_f32 v[86:87], v[86:87], 1.0 op_sel_hi:[1,0]
    v_rcp_f32 v80, v80
    v_rcp_f32 v81, v81
    v_rcp_f32 v82, v82
    v_rcp_f32 v83, v83
    v_rcp_f32 v84, v84
    v_rcp_f32 v85, v85
    v_rcp_f32 v86, v86
    v_rcp_f32 v87, v87
    v_pk_mul_f32 v[80:81], v[80:81], v[16:17]
    v_pk_mul_f32 v[82:83], v[82:83], v[18:19]
    v_pk_mul_f32 v[84:85], v[84:85], v[20:21]
    v_pk_mul_f32 v[86:87], v[86:87], v[22:23]
    v_cvt_pk_bf16_f32 v96, v80, v81
    v_cvt_pk_bf16_f32 v97, v82, v83
    v_cvt_pk_bf16_f32 v98, v84, v85
    v_cvt_pk_bf16_f32 v99, v86, v87
    buffer_store_dwordx4 v[96:99], v5, s[40:43], s68 offen offset:0 sc1
    s_waitcnt lgkmcnt(4)
    v_pk_add_f32 v[40:41], v[40:41], v[56:57]
    s_waitcnt lgkmcnt(3)
    v_pk_add_f32 v[24:25], v[24:25], v[72:73]
    v_pk_add_f32 v[42:43], v[42:43], v[58:59]
    v_pk_add_f32 v[26:27], v[26:27], v[74:75]
    s_waitcnt lgkmcnt(1)
    v_pk_add_f32 v[44:45], v[44:45], v[60:61]
    s_waitcnt lgkmcnt(0)
    v_pk_add_f32 v[28:29], v[28:29], v[76:77]
    v_pk_add_f32 v[46:47], v[46:47], v[62:63]
    v_pk_add_f32 v[30:31], v[30:31], v[78:79]
    v_pk_add_f32 v[24:25], v[24:25], v[40:41]
    v_pk_add_f32 v[26:27], v[26:27], v[42:43]
    v_pk_add_f32 v[28:29], v[28:29], v[44:45]
    v_pk_add_f32 v[30:31], v[30:31], v[46:47]
    v_pk_mul_f32 v[88:89], v[24:25], v[24:25]
    v_pk_mul_f32 v[90:91], v[26:27], v[26:27]
    v_pk_mul_f32 v[92:93], v[28:29], v[28:29]
    v_pk_mul_f32 v[94:95], v[30:31], v[30:31]
    v_pk_fma_f32 v[88:89], v[88:89], s[90:91], v[224:225] op_sel_hi:[1,0,1]
    v_pk_fma_f32 v[90:91], v[90:91], s[90:91], v[224:225] op_sel_hi:[1,0,1]
    v_pk_fma_f32 v[92:93], v[92:93], s[90:91], v[224:225] op_sel_hi:[1,0,1]
    v_pk_fma_f32 v[94:95], v[94:95], s[90:91], v[224:225] op_sel_hi:[1,0,1]
    v_pk_mul_f32 v[88:89], v[88:89], v[24:25]
    v_pk_mul_f32 v[90:91], v[90:91], v[26:27]
    v_pk_mul_f32 v[92:93], v[92:93], v[28:29]
    v_pk_mul_f32 v[94:95], v[94:95], v[30:31]
    v_exp_f32 v88, v88
    v_exp_f32 v89, v89
    v_exp_f32 v90, v90
    v_exp_f32 v91, v91
    v_exp_f32 v92, v92
    v_exp_f32 v93, v93
    v_exp_f32 v94, v94
    v_exp_f32 v95, v95
    v_pk_add_f32 v[88:89], v[88:89], 1.0 op_sel_hi:[1,0]
    v_pk_add_f32 v[90:91], v[90:91], 1.0 op_sel_hi:[1,0]
    v_pk_add_f32 v[92:93], v[92:93], 1.0 op_sel_hi:[1,0]
    v_pk_add_f32 v[94:95], v[94:95], 1.0 op_sel_hi:[1,0]
    v_rcp_f32 v88, v88
    v_rcp_f32 v89, v89
    v_rcp_f32 v90, v90
    v_rcp_f32 v91, v91
    v_rcp_f32 v92, v92
    v_rcp_f32 v93, v93
    v_rcp_f32 v94, v94
    v_rcp_f32 v95, v95
    v_pk_mul_f32 v[88:89], v[88:89], v[24:25]
    v_pk_mul_f32 v[90:91], v[90:91], v[26:27]
    v_pk_mul_f32 v[92:93], v[92:93], v[28:29]
    v_pk_mul_f32 v[94:95], v[94:95], v[30:31]
    v_cvt_pk_bf16_f32 v100, v88, v89
    v_cvt_pk_bf16_f32 v101, v90, v91
    v_cvt_pk_bf16_f32 v102, v92, v93
    v_cvt_pk_bf16_f32 v103, v94, v95
    buffer_store_dwordx4 v[100:103], v5, s[40:43], s68 offen offset:1024 sc1
    v_mov_b32 v9, v5
    s_waitcnt vmcnt(24)
    ds_read_b64_tr_b16 a[176:177], v217 offset:12288
    ds_read_b64_tr_b16 a[178:179], v217 offset:13312
    ds_read_b64_tr_b16 a[180:181], v218 offset:12288
    ds_read_b64_tr_b16 a[182:183], v218 offset:13312
    s_waitcnt vmcnt(22)
    ds_read_b64_tr_b16 a[184:185], v217 offset:14336
    ds_read_b64_tr_b16 a[186:187], v217 offset:15360
    ds_read_b64_tr_b16 a[188:189], v218 offset:14336
    ds_read_b64_tr_b16 a[190:191], v218 offset:15360
    s_waitcnt vmcnt(20)
    ds_read_b64_tr_b16 a[192:193], v217 offset:16384
    ds_read_b64_tr_b16 a[194:195], v217 offset:17408
    ds_read_b64_tr_b16 a[196:197], v218 offset:16384
    ds_read_b64_tr_b16 a[198:199], v218 offset:17408
    s_waitcnt vmcnt(18)
    ds_read_b64_tr_b16 a[200:201], v217 offset:18432
    ds_read_b64_tr_b16 a[202:203], v217 offset:19456
    ds_read_b64_tr_b16 a[204:205], v218 offset:18432
    ds_read_b64_tr_b16 a[206:207], v218 offset:19456
    s_waitcnt vmcnt(16)
    ds_read_b64_tr_b16 a[208:209], v217 offset:20480
    ds_read_b64_tr_b16 a[210:211], v217 offset:21504
    ds_read_b64_tr_b16 a[212:213], v218 offset:20480
    ds_read_b64_tr_b16 a[214:215], v218 offset:21504
    s_waitcnt vmcnt(14)
    ds_read_b64_tr_b16 a[216:217], v217 offset:22528
    ds_read_b64_tr_b16 a[218:219], v217 offset:23552
    ds_read_b64_tr_b16 a[220:221], v218 offset:22528
    ds_read_b64_tr_b16 a[222:223], v218 offset:23552
    s_waitcnt vmcnt(12)
    ds_read_b64_tr_b16 a[224:225], v217 offset:24576
    ds_read_b64_tr_b16 a[226:227], v217 offset:25600
    ds_read_b64_tr_b16 a[228:229], v218 offset:24576
    ds_read_b64_tr_b16 a[230:231], v218 offset:25600
    s_waitcnt vmcnt(10)
    ds_read_b64_tr_b16 a[232:233], v217 offset:26624
    ds_read_b64_tr_b16 a[234:235], v217 offset:27648
    ds_read_b64_tr_b16 a[236:237], v218 offset:26624
    ds_read_b64_tr_b16 a[238:239], v218 offset:27648
    s_waitcnt vmcnt(8)
    ds_read_b64_tr_b16 a[240:241], v217 offset:28672
    ds_read_b64_tr_b16 a[242:243], v217 offset:29696
    ds_read_b64_tr_b16 a[244:245], v218 offset:28672
    ds_read_b64_tr_b16 a[246:247], v218 offset:29696
    s_waitcnt vmcnt(6)
    ds_read_b64_tr_b16 a[248:249], v217 offset:30720
    ds_read_b64_tr_b16 a[250:251], v217 offset:31744
    ds_read_b64_tr_b16 a[252:253], v218 offset:30720
    ds_read_b64_tr_b16 a[254:255], v218 offset:31744
    s_waitcnt vmcnt(4)
    ds_read_b64_tr_b16 a[0:1], v217 offset:32768
    ds_read_b64_tr_b16 a[2:3], v217 offset:33792
    ds_read_b64_tr_b16 a[4:5], v218 offset:32768
    ds_read_b64_tr_b16 a[6:7], v218 offset:33792
    s_waitcnt vmcnt(2)
    ds_read_b64_tr_b16 a[8:9], v217 offset:34816
    ds_read_b64_tr_b16 a[10:11], v217 offset:35840
    ds_read_b64_tr_b16 a[12:13], v218 offset:34816
    ds_read_b64_tr_b16 a[14:15], v218 offset:35840
    s_waitcnt vmcnt(0)
    v_mov_b32 v8, s4
    s_mov_b64 exec, 1
    buffer_store_dword v8, v9, s[40:43], s82 offen sc1
    s_mov_b64 exec, -1
    s_add_u32 m0, s70, 0
    s_mul_i32 s73, s52, 64
    s_add_u32 s73, s73, 131072
    buffer_load_dwordx4 v214, s[24:27], s73 offen lds
    s_add_u32 m0, s70, 1024
    s_mul_i32 s73, s52, 64
    s_add_u32 s73, s73, 163840
    buffer_load_dwordx4 v214, s[24:27], s73 offen lds
    s_add_u32 m0, s70, 2048
    s_mul_i32 s73, s52, 64
    s_add_u32 s73, s73, 196608
    buffer_load_dwordx4 v214, s[24:27], s73 offen lds
    s_add_u32 m0, s70, 3072
    s_mul_i32 s73, s52, 64
    s_add_u32 s73, s73, 229376
    buffer_load_dwordx4 v214, s[24:27], s73 offen lds
    s_add_u32 m0, s70, 4096
    s_mul_i32 s73, s53, 64
    s_add_u32 s73, s73, 0
    buffer_load_dwordx4 v214, s[24:27], s73 offen lds
    s_add_u32 m0, s70, 5120
    s_mul_i32 s73, s53, 64
    s_add_u32 s73, s73, 32768
    buffer_load_dwordx4 v214, s[24:27], s73 offen lds
    s_add_u32 m0, s70, 6144
    s_mul_i32 s73, s53, 64
    s_add_u32 s73, s73, 65536
    buffer_load_dwordx4 v214, s[24:27], s73 offen lds
    s_add_u32 m0, s70, 7168
    s_mul_i32 s73, s53, 64
    s_add_u32 s73, s73, 98304
    buffer_load_dwordx4 v214, s[24:27], s73 offen lds
    s_add_u32 m0, s70, 8192
    s_mul_i32 s73, s53, 64
    s_add_u32 s73, s73, 131072
    buffer_load_dwordx4 v214, s[24:27], s73 offen lds
    s_add_u32 m0, s70, 9216
    s_mul_i32 s73, s53, 64
    s_add_u32 s73, s73, 163840
    buffer_load_dwordx4 v214, s[24:27], s73 offen lds
    s_add_u32 m0, s70, 10240
    s_mul_i32 s73, s53, 64
    s_add_u32 s73, s73, 196608
    buffer_load_dwordx4 v214, s[24:27], s73 offen lds
    s_add_u32 m0, s70, 11264
    s_mul_i32 s73, s53, 64
    s_add_u32 s73, s73, 229376
    buffer_load_dwordx4 v214, s[24:27], s73 offen lds
    s_waitcnt lgkmcnt(15)
    s_add_u32 m0, s70, 12288
    s_mul_i32 s73, s54, 64
    s_add_u32 s73, s73, 0
    buffer_load_dwordx4 v214, s[24:27], s73 offen lds
    s_add_u32 m0, s70, 13312
    s_mul_i32 s73, s54, 64
    s_add_u32 s73, s73, 32768
    buffer_load_dwordx4 v214, s[24:27], s73 offen lds
    s_add_u32 m0, s70, 14336
    s_mul_i32 s73, s54, 64
    s_add_u32 s73, s73, 65536
    buffer_load_dwordx4 v214, s[24:27], s73 offen lds
    s_add_u32 m0, s70, 15360
    s_mul_i32 s73, s54, 64
    s_add_u32 s73, s73, 98304
    buffer_load_dwordx4 v214, s[24:27], s73 offen lds
    s_add_u32 m0, s70, 16384
    s_mul_i32 s73, s54, 64
    s_add_u32 s73, s73, 131072
    buffer_load_dwordx4 v214, s[24:27], s73 offen lds
    s_add_u32 m0, s70, 17408
    s_mul_i32 s73, s54, 64
    s_add_u32 s73, s73, 163840
    buffer_load_dwordx4 v214, s[24:27], s73 offen lds
    s_add_u32 m0, s70, 18432
    s_mul_i32 s73, s54, 64
    s_add_u32 s73, s73, 196608
    buffer_load_dwordx4 v214, s[24:27], s73 offen lds
    s_add_u32 m0, s70, 19456
    s_mul_i32 s73, s54, 64
    s_add_u32 s73, s73, 229376
    buffer_load_dwordx4 v214, s[24:27], s73 offen lds
    v_lshrrev_b32 v220, 5, v1
    v_lshlrev_b32 v220, 3, v220
    s_lshl_b32 s68, s67, 7
    s_lshr_b32 s69, s3, 1
    s_lshl_b32 s69, s69, 6
    s_add_u32 s68, s68, s69
    buffer_load_dwordx2 v[222:223], v220, s[32:35], s68 offen offset:0
    buffer_load_dwordx2 v[224:225], v220, s[32:35], s68 offen offset:16
    buffer_load_dwordx2 v[226:227], v220, s[32:35], s68 offen offset:32
    buffer_load_dwordx2 v[228:229], v220, s[32:35], s68 offen offset:48
    s_lshl_b32 s68, s66, 1
    s_and_b32 s69, s3, 1
    s_add_u32 s71, s68, s69
    s_xor_b32 s72, s71, 1
    s_mul_i32 s68, s3, 28672
    s_add_u32 s68, s68, 0x3c0000
    s_mul_i32 s71, s71, 114688
    s_add_u32 s71, s71, s68
    s_mul_i32 s72, s72, 114688
    s_add_u32 s72, s72, s68
    buffer_load_dword v249, v12, s[40:43], s85 offen sc1
    s_sleep 3
    buffer_load_dword v250, v12, s[40:43], s85 offen sc1
    s_sleep 3
    s_nop 0
Lpoll_P_10:
    s_sub_u32 s6, s6, 1
    s_cbranch_scc1 L_end_P
    buffer_load_dword v251, v12, s[40:43], s85 offen sc1
    s_waitcnt vmcnt(2)
    v_cmp_ne_u32 vcc, s4, v249
    s_nop 1
    s_cbranch_vccz Lpd_P_11
    buffer_load_dword v249, v12, s[40:43], s85 offen sc1
    s_waitcnt vmcnt(2)
    v_cmp_ne_u32 vcc, s4, v250
    s_nop 1
    s_cbranch_vccz Lpd_P_11
    buffer_load_dword v250, v12, s[40:43], s85 offen sc1
    s_waitcnt vmcnt(2)
    v_cmp_ne_u32 vcc, s4, v251
    s_nop 1
    s_cbranch_vccnz Lpoll_P_10
    s_nop 1
Lpd_P_11:
    s_add_u32 s56, s71, s48
    s_add_u32 s57, s72, s48
    buffer_load_dwordx4 v[80:83], v4, s[40:43], s56 offen offset:0 sc1
    buffer_load_dwordx4 v[84:87], v4, s[40:43], s57 offen offset:0 sc1
    buffer_load_dwordx4 v[88:91], v4, s[40:43], s56 offen offset:1024 sc1
    buffer_load_dwordx4 v[92:95], v4, s[40:43], s57 offen offset:1024 sc1
    buffer_load_dwordx4 v[96:99], v4, s[40:43], s56 offen offset:2048 sc1
    buffer_load_dwordx4 v[100:103], v4, s[40:43], s57 offen offset:2048 sc1
    buffer_load_dwordx4 v[104:107], v4, s[40:43], s56 offen offset:3072 sc1
    buffer_load_dwordx4 v[108:111], v4, s[40:43], s57 offen offset:3072 sc1
    s_add_u32 s56, s71, s49
    s_add_u32 s57, s72, s49
    buffer_load_dwordx4 v[112:115], v4, s[40:43], s56 offen offset:0 sc1
    buffer_load_dwordx4 v[116:119], v4, s[40:43], s57 offen offset:0 sc1
    buffer_load_dwordx4 v[120:123], v4, s[40:43], s56 offen offset:1024 sc1
    buffer_load_dwordx4 v[124:127], v4, s[40:43], s57 offen offset:1024 sc1
    v_lshlrev_b32 v16, 16, v222
    v_and_b32 v17, 0xffff0000, v222
    v_lshlrev_b32 v238, 16, v240
    v_and_b32 v239, 0xffff0000, v240
    v_pk_add_f32 v[16:17], v[16:17], v[238:239]
    v_lshlrev_b32 v18, 16, v223
    v_and_b32 v19, 0xffff0000, v223
    v_lshlrev_b32 v238, 16, v241
    v_and_b32 v239, 0xffff0000, v241
    v_pk_add_f32 v[18:19], v[18:19], v[238:239]
    v_lshlrev_b32 v20, 16, v224
    v_and_b32 v21, 0xffff0000, v224
    v_lshlrev_b32 v238, 16, v242
    v_and_b32 v239, 0xffff0000, v242
    v_pk_add_f32 v[20:21], v[20:21], v[238:239]
    v_lshlrev_b32 v22, 16, v225
    v_and_b32 v23, 0xffff0000, v225
    v_lshlrev_b32 v238, 16, v243
    v_and_b32 v239, 0xffff0000, v243
    v_pk_add_f32 v[22:23], v[22:23], v[238:239]
    v_lshlrev_b32 v24, 16, v226
    v_and_b32 v25, 0xffff0000, v226
    v_lshlrev_b32 v238, 16, v244
    v_and_b32 v239, 0xffff0000, v244
    v_pk_add_f32 v[24:25], v[24:25], v[238:239]
    v_lshlrev_b32 v26, 16, v227
    v_and_b32 v27, 0xffff0000, v227
    v_lshlrev_b32 v238, 16, v245
    v_and_b32 v239, 0xffff0000, v245
    v_pk_add_f32 v[26:27], v[26:27], v[238:239]
    v_lshlrev_b32 v28, 16, v228
    v_and_b32 v29, 0xffff0000, v228
    v_lshlrev_b32 v238, 16, v246
    v_and_b32 v239, 0xffff0000, v246
    v_pk_add_f32 v[28:29], v[28:29], v[238:239]
    v_lshlrev_b32 v30, 16, v229
    v_and_b32 v31, 0xffff0000, v229
    v_lshlrev_b32 v238, 16, v247
    v_and_b32 v239, 0xffff0000, v247
    v_pk_add_f32 v[30:31], v[30:31], v[238:239]
    buffer_load_dwordx4 v[128:131], v4, s[40:43], s56 offen offset:2048 sc1
    buffer_load_dwordx4 v[132:135], v4, s[40:43], s57 offen offset:2048 sc1
    buffer_load_dwordx4 v[136:139], v4, s[40:43], s56 offen offset:3072 sc1
    buffer_load_dwordx4 v[140:143], v4, s[40:43], s57 offen offset:3072 sc1
    s_waitcnt vmcnt(15)
    v_mfma_f32_32x32x16_bf16 v[16:31], a[128:131], v[80:83], v[16:31]
    s_waitcnt vmcnt(14)
    v_mfma_f32_32x32x16_bf16 v[32:47], a[128:131], v[84:87], 0
    v_mfma_f32_32x32x16_bf16 v[48:63], a[132:135], v[80:83], 0
    v_mfma_f32_32x32x16_bf16 v[64:79], a[132:135], v[84:87], 0
    ds_read_b64_tr_b16 a[16:17], v217 offset:0
    ds_read_b64_tr_b16 a[18:19], v217 offset:1024
    ds_read_b64_tr_b16 a[20:21], v218 offset:0
    ds_read_b64_tr_b16 a[22:23], v218 offset:1024
    s_add_u32 s56, s71, s50
    s_add_u32 s57, s72, s50
    buffer_load_dwordx4 v[144:147], v4, s[40:43], s56 offen offset:0 sc1
    buffer_load_dwordx4 v[148:151], v4, s[40:43], s57 offen offset:0 sc1
    buffer_load_dwordx4 v[152:155], v4, s[40:43], s56 offen offset:1024 sc1
    buffer_load_dwordx4 v[156:159], v4, s[40:43], s57 offen offset:1024 sc1
    s_waitcnt vmcnt(17)
    v_mfma_f32_32x32x16_bf16 v[16:31], a[136:139], v[88:91], v[16:31]
    s_waitcnt vmcnt(16)
    v_mfma_f32_32x32x16_bf16 v[32:47], a[136:139], v[92:95], v[32:47]
    v_mfma_f32_32x32x16_bf16 v[48:63], a[140:143], v[88:91], v[48:63]
    v_mfma_f32_32x32x16_bf16 v[64:79], a[140:143], v[92:95], v[64:79]
    ds_read_b64_tr_b16 a[24:25], v217 offset:2048
    ds_read_b64_tr_b16 a[26:27], v217 offset:3072
    ds_read_b64_tr_b16 a[28:29], v218 offset:2048
    ds_read_b64_tr_b16 a[30:31], v218 offset:3072
    buffer_load_dwordx4 v[160:163], v4, s[40:43], s56 offen offset:2048 sc1
    buffer_load_dwordx4 v[164:167], v4, s[40:43], s57 offen offset:2048 sc1
    buffer_load_dwordx4 v[168:171], v4, s[40:43], s56 offen offset:3072 sc1
    buffer_load_dwordx4 v[172:175], v4, s[40:43], s57 offen offset:3072 sc1
    s_waitcnt vmcnt(19)
    v_mfma_f32_32x32x16_bf16 v[16:31], a[144:147], v[96:99], v[16:31]
    s_waitcnt vmcnt(18)
    v_mfma_f32_32x32x16_bf16 v[32:47], a[144:147], v[100:103], v[32:47]
    v_mfma_f32_32x32x16_bf16 v[48:63], a[148:151], v[96:99], v[48:63]
    v_mfma_f32_32x32x16_bf16 v[64:79], a[148:151], v[100:103], v[64:79]
    ds_read_b64_tr_b16 a[32:33], v217 offset:4096
    ds_read_b64_tr_b16 a[34:35], v217 offset:5120
    ds_read_b64_tr_b16 a[36:37], v218 offset:4096
    ds_read_b64_tr_b16 a[38:39], v218 offset:5120
    s_add_u32 s56, s71, s51
    s_add_u32 s57, s72, s51
    buffer_load_dwordx4 v[176:179], v4, s[40:43], s56 offen offset:0 sc1
    buffer_load_dwordx4 v[180:183], v4, s[40:43], s57 offen offset:0 sc1
    buffer_load_dwordx4 v[184:187], v4, s[40:43], s56 offen offset:1024 sc1
    buffer_load_dwordx4 v[188:191], v4, s[40:43], s57 offen offset:1024 sc1
    s_waitcnt vmcnt(21)
    v_mfma_f32_32x32x16_bf16 v[16:31], a[152:155], v[104:107], v[16:31]
    s_waitcnt vmcnt(20)
    v_mfma_f32_32x32x16_bf16 v[32:47], a[152:155], v[108:111], v[32:47]
    v_mfma_f32_32x32x16_bf16 v[48:63], a[156:159], v[104:107], v[48:63]
    v_mfma_f32_32x32x16_bf16 v[64:79], a[156:159], v[108:111], v[64:79]
    ds_read_b64_tr_b16 a[40:41], v217 offset:6144
    ds_read_b64_tr_b16 a[42:43], v217 offset:7168
    ds_read_b64_tr_b16 a[44:45], v218 offset:6144
    ds_read_b64_tr_b16 a[46:47], v218 offset:7168
    buffer_load_dwordx4 v[192:195], v4, s[40:43], s56 offen offset:2048 sc1
    buffer_load_dwordx4 v[196:199], v4, s[40:43], s57 offen offset:2048 sc1
    buffer_load_dwordx4 v[200:203], v4, s[40:43], s56 offen offset:3072 sc1
    buffer_load_dwordx4 v[204:207], v4, s[40:43], s57 offen offset:3072 sc1
    s_waitcnt vmcnt(23)
    v_mfma_f32_32x32x16_bf16 v[16:31], a[160:163], v[112:115], v[16:31]
    s_waitcnt vmcnt(22)
    v_mfma_f32_32x32x16_bf16 v[32:47], a[160:163], v[116:119], v[32:47]
    v_mfma_f32_32x32x16_bf16 v[48:63], a[164:167], v[112:115], v[48:63]
    v_mfma_f32_32x32x16_bf16 v[64:79], a[164:167], v[116:119], v[64:79]
    ds_read_b64_tr_b16 a[48:49], v217 offset:8192
    ds_read_b64_tr_b16 a[50:51], v217 offset:9216
    ds_read_b64_tr_b16 a[52:53], v218 offset:8192
    ds_read_b64_tr_b16 a[54:55], v218 offset:9216
    s_add_u32 s56, s71, s52
    s_add_u32 s57, s72, s52
    buffer_load_dwordx4 v[80:83], v4, s[40:43], s56 offen offset:0 sc1
    buffer_load_dwordx4 v[84:87], v4, s[40:43], s57 offen offset:0 sc1
    buffer_load_dwordx4 v[88:91], v4, s[40:43], s56 offen offset:1024 sc1
    buffer_load_dwordx4 v[92:95], v4, s[40:43], s57 offen offset:1024 sc1
    s_waitcnt vmcnt(25)
    v_mfma_f32_32x32x16_bf16 v[16:31], a[168:171], v[120:123], v[16:31]
    s_waitcnt vmcnt(24)
    v_mfma_f32_32x32x16_bf16 v[32:47], a[168:171], v[124:127], v[32:47]
    v_mfma_f32_32x32x16_bf16 v[48:63], a[172:175], v[120:123], v[48:63]
    v_mfma_f32_32x32x16_bf16 v[64:79], a[172:175], v[124:127], v[64:79]
    ds_read_b64_tr_b16 a[56:57], v217 offset:10240
    ds_read_b64_tr_b16 a[58:59], v217 offset:11264
    ds_read_b64_tr_b16 a[60:61], v218 offset:10240
    ds_read_b64_tr_b16 a[62:63], v218 offset:11264
    buffer_load_dwordx4 v[96:99], v4, s[40:43], s56 offen offset:2048 sc1
    buffer_load_dwordx4 v[100:103], v4, s[40:43], s57 offen offset:2048 sc1
    buffer_load_dwordx4 v[104:107], v4, s[40:43], s56 offen offset:3072 sc1
    buffer_load_dwordx4 v[108:111], v4, s[40:43], s57 offen offset:3072 sc1
    s_waitcnt vmcnt(27)
    v_mfma_f32_32x32x16_bf16 v[16:31], a[176:179], v[128:131], v[16:31]
    s_waitcnt vmcnt(26)
    v_mfma_f32_32x32x16_bf16 v[32:47], a[176:179], v[132:135], v[32:47]
    v_mfma_f32_32x32x16_bf16 v[48:63], a[180:183], v[128:131], v[48:63]
    v_mfma_f32_32x32x16_bf16 v[64:79], a[180:183], v[132:135], v[64:79]
    ds_read_b64_tr_b16 a[64:65], v217 offset:12288
    ds_read_b64_tr_b16 a[66:67], v217 offset:13312
    ds_read_b64_tr_b16 a[68:69], v218 offset:12288
    ds_read_b64_tr_b16 a[70:71], v218 offset:13312
    s_add_u32 s56, s71, s53
    s_add_u32 s57, s72, s53
    buffer_load_dwordx4 v[112:115], v4, s[40:43], s56 offen offset:0 sc1
    buffer_load_dwordx4 v[116:119], v4, s[40:43], s57 offen offset:0 sc1
    buffer_load_dwordx4 v[120:123], v4, s[40:43], s56 offen offset:1024 sc1
    buffer_load_dwordx4 v[124:127], v4, s[40:43], s57 offen offset:1024 sc1
    s_waitcnt vmcnt(29)
    v_mfma_f32_32x32x16_bf16 v[16:31], a[184:187], v[136:139], v[16:31]
    s_waitcnt vmcnt(28)
    v_mfma_f32_32x32x16_bf16 v[32:47], a[184:187], v[140:143], v[32:47]
    v_mfma_f32_32x32x16_bf16 v[48:63], a[188:191], v[136:139], v[48:63]
    v_mfma_f32_32x32x16_bf16 v[64:79], a[188:191], v[140:143], v[64:79]
    ds_read_b64_tr_b16 a[72:73], v217 offset:14336
    ds_read_b64_tr_b16 a[74:75], v217 offset:15360
    ds_read_b64_tr_b16 a[76:77], v218 offset:14336
    ds_read_b64_tr_b16 a[78:79], v218 offset:15360
    buffer_load_dwordx4 v[128:131], v4, s[40:43], s56 offen offset:2048 sc1
    buffer_load_dwordx4 v[132:135], v4, s[40:43], s57 offen offset:2048 sc1
    buffer_load_dwordx4 v[136:139], v4, s[40:43], s56 offen offset:3072 sc1
    buffer_load_dwordx4 v[140:143], v4, s[40:43], s57 offen offset:3072 sc1
    s_waitcnt vmcnt(31)
    v_mfma_f32_32x32x16_bf16 v[16:31], a[192:195], v[144:147], v[16:31]
    s_waitcnt vmcnt(30)
    v_mfma_f32_32x32x16_bf16 v[32:47], a[192:195], v[148:151], v[32:47]
    v_mfma_f32_32x32x16_bf16 v[48:63], a[196:199], v[144:147], v[48:63]
    v_mfma_f32_32x32x16_bf16 v[64:79], a[196:199], v[148:151], v[64:79]
    ds_read_b64_tr_b16 a[80:81], v217 offset:16384
    ds_read_b64_tr_b16 a[82:83], v217 offset:17408
    ds_read_b64_tr_b16 a[84:85], v218 offset:16384
    ds_read_b64_tr_b16 a[86:87], v218 offset:17408
    s_add_u32 s56, s71, s54
    s_add_u32 s57, s72, s54
    buffer_load_dwordx4 v[144:147], v4, s[40:43], s56 offen offset:0 sc1
    buffer_load_dwordx4 v[148:151], v4, s[40:43], s57 offen offset:0 sc1
    s_waitcnt vmcnt(31)
    v_mfma_f32_32x32x16_bf16 v[16:31], a[200:203], v[152:155], v[16:31]
    s_waitcnt vmcnt(30)
    v_mfma_f32_32x32x16_bf16 v[32:47], a[200:203], v[156:159], v[32:47]
    v_mfma_f32_32x32x16_bf16 v[48:63], a[204:207], v[152:155], v[48:63]
    v_mfma_f32_32x32x16_bf16 v[64:79], a[204:207], v[156:159], v[64:79]
    ds_read_b64_tr_b16 a[88:89], v217 offset:18432
    ds_read_b64_tr_b16 a[90:91], v217 offset:19456
    ds_read_b64_tr_b16 a[92:93], v218 offset:18432
    ds_read_b64_tr_b16 a[94:95], v218 offset:19456
    buffer_load_dwordx4 v[152:155], v4, s[40:43], s56 offen offset:1024 sc1
    buffer_load_dwordx4 v[156:159], v4, s[40:43], s57 offen offset:1024 sc1
    s_waitcnt vmcnt(31)
    v_mfma_f32_32x32x16_bf16 v[16:31], a[208:211], v[160:163], v[16:31]
    s_waitcnt vmcnt(30)
    v_mfma_f32_32x32x16_bf16 v[32:47], a[208:211], v[164:167], v[32:47]
    v_mfma_f32_32x32x16_bf16 v[48:63], a[212:215], v[160:163], v[48:63]
    v_mfma_f32_32x32x16_bf16 v[64:79], a[212:215], v[164:167], v[64:79]
    buffer_load_dwordx4 v[160:163], v4, s[40:43], s56 offen offset:2048 sc1
    buffer_load_dwordx4 v[164:167], v4, s[40:43], s57 offen offset:2048 sc1
    s_waitcnt vmcnt(31)
    v_mfma_f32_32x32x16_bf16 v[16:31], a[216:219], v[168:171], v[16:31]
    s_waitcnt vmcnt(30)
    v_mfma_f32_32x32x16_bf16 v[32:47], a[216:219], v[172:175], v[32:47]
    v_mfma_f32_32x32x16_bf16 v[48:63], a[220:223], v[168:171], v[48:63]
    v_mfma_f32_32x32x16_bf16 v[64:79], a[220:223], v[172:175], v[64:79]
    buffer_load_dwordx4 v[168:171], v4, s[40:43], s56 offen offset:3072 sc1
    buffer_load_dwordx4 v[172:175], v4, s[40:43], s57 offen offset:3072 sc1
    s_waitcnt vmcnt(31)
    v_mfma_f32_32x32x16_bf16 v[16:31], a[224:227], v[176:179], v[16:31]
    s_waitcnt vmcnt(30)
    v_mfma_f32_32x32x16_bf16 v[32:47], a[224:227], v[180:183], v[32:47]
    v_mfma_f32_32x32x16_bf16 v[48:63], a[228:231], v[176:179], v[48:63]
    v_mfma_f32_32x32x16_bf16 v[64:79], a[228:231], v[180:183], v[64:79]
    s_waitcnt vmcnt(29)
    v_mfma_f32_32x32x16_bf16 v[16:31], a[232:235], v[184:187], v[16:31]
    s_waitcnt vmcnt(28)
    v_mfma_f32_32x32x16_bf16 v[32:47], a[232:235], v[188:191], v[32:47]
    v_mfma_f32_32x32x16_bf16 v[48:63], a[236:239], v[184:187], v[48:63]
    v_mfma_f32_32x32x16_bf16 v[64:79], a[236:239], v[188:191], v[64:79]
    s_waitcnt vmcnt(27) lgkmcnt(15)
    v_mfma_f32_32x32x16_bf16 v[16:31], a[240:243], v[192:195], v[16:31]
    s_waitcnt vmcnt(26)
    v_mfma_f32_32x32x16_bf16 v[32:47], a[240:243], v[196:199], v[32:47]
    v_mfma_f32_32x32x16_bf16 v[48:63], a[244:247], v[192:195], v[48:63]
    v_mfma_f32_32x32x16_bf16 v[64:79], a[244:247], v[196:199], v[64:79]
    s_waitcnt vmcnt(25)
    v_mfma_f32_32x32x16_bf16 v[16:31], a[248:251], v[200:203], v[16:31]
    s_waitcnt vmcnt(24)
    v_mfma_f32_32x32x16_bf16 v[32:47], a[248:251], v[204:207], v[32:47]
    v_mfma_f32_32x32x16_bf16 v[48:63], a[252:255], v[200:203], v[48:63]
    v_mfma_f32_32x32x16_bf16 v[64:79], a[252:255], v[204:207], v[64:79]
    s_waitcnt vmcnt(23)
    v_mfma_f32_32x32x16_bf16 v[16:31], a[0:3], v[80:83], v[16:31]
    s_waitcnt vmcnt(22)
    v_mfma_f32_32x32x16_bf16 v[32:47], a[0:3], v[84:87], v[32:47]
    v_mfma_f32_32x32x16_bf16 v[48:63], a[4:7], v[80:83], v[48:63]
    v_mfma_f32_32x32x16_bf16 v[64:79], a[4:7], v[84:87], v[64:79]
    s_waitcnt vmcnt(21)
    v_mfma_f32_32x32x16_bf16 v[16:31], a[8:11], v[88:91], v[16:31]
    s_waitcnt vmcnt(20)
    v_mfma_f32_32x32x16_bf16 v[32:47], a[8:11], v[92:95], v[32:47]
    v_mfma_f32_32x32x16_bf16 v[48:63], a[12:15], v[88:91], v[48:63]
    v_mfma_f32_32x32x16_bf16 v[64:79], a[12:15], v[92:95], v[64:79]
    v_lshrrev_b32 v220, 5, v1
    v_lshlrev_b32 v220, 10, v220
    v_and_b32 v221, 31, v1
    v_lshl_add_u32 v220, v221, 2, v220
    s_lshr_b32 s69, s3, 1
    s_lshl_b32 s68, s69, 13
    s_and_b32 s69, s3, 1
    s_lshl_b32 s69, s69, 7
    s_add_u32 s68, s68, s69
    v_add_u32 v220, s68, v220
    v_xor_b32 v221, 128, v220
    v_xor_b32 v222, 0x2000, v220
    v_xor_b32 v223, 0x2080, v220
    s_mul_i32 s68, s3, 36864
    s_add_u32 s68, s68, 12288
    v_add_u32 v220, s68, v220
    v_add_u32 v221, s68, v221
    v_add_u32 v222, s68, v222
    v_add_u32 v223, s68, v223
    s_lshl_b32 s68, s3, 12
    s_add_u32 s68, s68, 12288
    v_add_u32 v224, s68, v4
    v_add_u32 v226, 73728, v224
    v_mul_u32_u24 v225, 896, v3
    v_lshl_add_u32 v225, v2, 3, v225
    s_lshl_b32 s68, s67, 2
    s_add_u32 s68, s68, s3
    s_mul_i32 s68, s68, 14336
    s_lshl_b32 s69, s66, 7
    s_add_u32 s68, s68, s69
    s_add_u32 s69, s68, 7168
    s_waitcnt vmcnt(19)
    v_mfma_f32_32x32x16_bf16 v[16:31], a[16:19], v[96:99], v[16:31]
    s_waitcnt vmcnt(18)
    v_mfma_f32_32x32x16_bf16 v[32:47], a[16:19], v[100:103], v[32:47]
    v_mfma_f32_32x32x16_bf16 v[48:63], a[20:23], v[96:99], v[48:63]
    v_mfma_f32_32x32x16_bf16 v[64:79], a[20:23], v[100:103], v[64:79]
    s_waitcnt vmcnt(17)
    v_mfma_f32_32x32x16_bf16 v[16:31], a[24:27], v[104:107], v[16:31]
    s_waitcnt vmcnt(16)
    v_mfma_f32_32x32x16_bf16 v[32:47], a[24:27], v[108:111], v[32:47]
    v_mfma_f32_32x32x16_bf16 v[48:63], a[28:31], v[104:107], v[48:63]
    v_mfma_f32_32x32x16_bf16 v[64:79], a[28:31], v[108:111], v[64:79]
    s_waitcnt vmcnt(15)
    v_mfma_f32_32x32x16_bf16 v[16:31], a[32:35], v[112:115], v[16:31]
    s_waitcnt vmcnt(14)
    v_mfma_f32_32x32x16_bf16 v[32:47], a[32:35], v[116:119], v[32:47]
    v_mfma_f32_32x32x16_bf16 v[48:63], a[36:39], v[112:115], v[48:63]
    v_mfma_f32_32x32x16_bf16 v[64:79], a[36:39], v[116:119], v[64:79]
    s_waitcnt vmcnt(13)
    v_mfma_f32_32x32x16_bf16 v[16:31], a[40:43], v[120:123], v[16:31]
    s_waitcnt vmcnt(12)
    v_mfma_f32_32x32x16_bf16 v[32:47], a[40:43], v[124:127], v[32:47]
    v_mfma_f32_32x32x16_bf16 v[48:63], a[44:47], v[120:123], v[48:63]
    v_mfma_f32_32x32x16_bf16 v[64:79], a[44:47], v[124:127], v[64:79]
    s_waitcnt vmcnt(11)
    v_mfma_f32_32x32x16_bf16 v[16:31], a[48:51], v[128:131], v[16:31]
    s_waitcnt vmcnt(10)
    v_mfma_f32_32x32x16_bf16 v[32:47], a[48:51], v[132:135], v[32:47]
    v_mfma_f32_32x32x16_bf16 v[48:63], a[52:55], v[128:131], v[48:63]
    v_mfma_f32_32x32x16_bf16 v[64:79], a[52:55], v[132:135], v[64:79]
    s_waitcnt vmcnt(9)
    v_mfma_f32_32x32x16_bf16 v[16:31], a[56:59], v[136:139], v[16:31]
    s_waitcnt vmcnt(8)
    v_mfma_f32_32x32x16_bf16 v[32:47], a[56:59], v[140:143], v[32:47]
    v_mfma_f32_32x32x16_bf16 v[48:63], a[60:63], v[136:139], v[48:63]
    v_mfma_f32_32x32x16_bf16 v[64:79], a[60:63], v[140:143], v[64:79]
    s_waitcnt vmcnt(6) lgkmcnt(12)
    v_mfma_f32_32x32x16_bf16 v[64:79], a[68:71], v[148:151], v[64:79]
    s_waitcnt vmcnt(4) lgkmcnt(8)
    v_mfma_f32_32x32x16_bf16 v[64:79], a[76:79], v[156:159], v[64:79]
    s_waitcnt vmcnt(2) lgkmcnt(4)
    v_mfma_f32_32x32x16_bf16 v[64:79], a[84:87], v[164:167], v[64:79]
    s_waitcnt vmcnt(0) lgkmcnt(0)
    v_mfma_f32_32x32x16_bf16 v[64:79], a[92:95], v[172:175], v[64:79]
    v_mfma_f32_32x32x16_bf16 v[48:63], a[68:71], v[144:147], v[48:63]
    v_mfma_f32_32x32x16_bf16 v[48:63], a[76:79], v[152:155], v[48:63]
    s_nop 9
    ds_write2st64_b32 v223, v64, v65 offset0:0 offset1:1
    ds_write2st64_b32 v223, v66, v67 offset0:2 offset1:3
    ds_write2st64_b32 v223, v68, v69 offset0:8 offset1:9
    v_mfma_f32_32x32x16_bf16 v[48:63], a[84:87], v[160:163], v[48:63]
    ds_write2st64_b32 v223, v70, v71 offset0:10 offset1:11
    ds_write2st64_b32 v223, v72, v73 offset0:16 offset1:17
    ds_write2st64_b32 v223, v74, v75 offset0:18 offset1:19
    v_mfma_f32_32x32x16_bf16 v[48:63], a[92:95], v[168:171], v[48:63]
    ds_write2st64_b32 v223, v76, v77 offset0:24 offset1:25
    ds_write2st64_b32 v223, v78, v79 offset0:26 offset1:27
    v_mfma_f32_32x32x16_bf16 v[32:47], a[64:67], v[148:151], v[32:47]
    v_mfma_f32_32x32x16_bf16 v[32:47], a[72:75], v[156:159], v[32:47]
    s_nop 7
    ds_write2st64_b32 v222, v48, v49 offset0:0 offset1:1
    ds_write2st64_b32 v222, v50, v51 offset0:2 offset1:3
    ds_write2st64_b32 v222, v52, v53 offset0:8 offset1:9
    v_mfma_f32_32x32x16_bf16 v[32:47], a[80:83], v[164:167], v[32:47]
    ds_write2st64_b32 v222, v54, v55 offset0:10 offset1:11
    ds_write2st64_b32 v222, v56, v57 offset0:16 offset1:17
    ds_write2st64_b32 v222, v58, v59 offset0:18 offset1:19
    v_mfma_f32_32x32x16_bf16 v[32:47], a[88:91], v[172:175], v[32:47]
    ds_write2st64_b32 v222, v60, v61 offset0:24 offset1:25
    ds_write2st64_b32 v222, v62, v63 offset0:26 offset1:27
    v_mfma_f32_32x32x16_bf16 v[16:31], a[64:67], v[144:147], v[16:31]
    v_mfma_f32_32x32x16_bf16 v[16:31], a[72:75], v[152:155], v[16:31]
    s_nop 7
    ds_write2st64_b32 v221, v32, v33 offset0:0 offset1:1
    ds_write2st64_b32 v221, v34, v35 offset0:2 offset1:3
    ds_write2st64_b32 v221, v36, v37 offset0:8 offset1:9
    v_mfma_f32_32x32x16_bf16 v[16:31], a[80:83], v[160:163], v[16:31]
    ds_write2st64_b32 v221, v38, v39 offset0:10 offset1:11
    ds_write2st64_b32 v221, v40, v41 offset0:16 offset1:17
    ds_write2st64_b32 v221, v42, v43 offset0:18 offset1:19
    v_mfma_f32_32x32x16_bf16 v[16:31], a[88:91], v[168:171], v[16:31]
    ds_write2st64_b32 v221, v44, v45 offset0:24 offset1:25
    ds_write2st64_b32 v221, v46, v47 offset0:26 offset1:27
    s_nop 9
    ds_write2st64_b32 v220, v16, v17 offset0:0 offset1:1
    ds_write2st64_b32 v220, v18, v19 offset0:2 offset1:3
    ds_write2st64_b32 v220, v20, v21 offset0:8 offset1:9
    ds_write2st64_b32 v220, v22, v23 offset0:10 offset1:11
    ds_write2st64_b32 v220, v24, v25 offset0:16 offset1:17
    ds_write2st64_b32 v220, v26, v27 offset0:18 offset1:19
    ds_write2st64_b32 v220, v28, v29 offset0:24 offset1:25
    ds_write2st64_b32 v220, v30, v31 offset0:26 offset1:27
    s_waitcnt lgkmcnt(0)
    s_barrier
    ds_read_b128 v[16:19], v224 offset:0
    ds_read_b128 v[20:23], v224 offset:36864
    ds_read_b128 v[24:27], v226 offset:0
    ds_read_b128 v[28:31], v226 offset:36864
    ds_read_b128 v[32:35], v224 offset:1024
    ds_read_b128 v[36:39], v224 offset:37888
    ds_read_b128 v[40:43], v226 offset:1024
    ds_read_b128 v[44:47], v226 offset:37888
    ds_read_b128 v[48:51], v224 offset:2048
    ds_read_b128 v[52:55], v224 offset:38912
    ds_read_b128 v[56:59], v226 offset:2048
    ds_read_b128 v[60:63], v226 offset:38912
    ds_read_b128 v[64:67], v224 offset:3072
    ds_read_b128 v[68:71], v224 offset:39936
    ds_read_b128 v[72:75], v226 offset:3072
    ds_read_b128 v[76:79], v226 offset:39936
    s_waitcnt lgkmcnt(14)
    v_pk_add_f32 v[16:17], v[16:17], v[20:21]
    s_waitcnt lgkmcnt(12)
    v_pk_add_f32 v[24:25], v[24:25], v[28:29]
    v_pk_add_f32 v[18:19], v[18:19], v[22:23]
    v_pk_add_f32 v[26:27], v[26:27], v[30:31]
    v_pk_add_f32 v[16:17], v[16:17], v[24:25]
    v_pk_add_f32 v[18:19], v[18:19], v[26:27]
    v_cvt_pk_bf16_f32 v20, v16, v17
    v_cvt_pk_bf16_f32 v21, v18, v19
    buffer_store_dwordx2 v[20:21], v225, s[36:39], s68 offen offset:0
    s_waitcnt lgkmcnt(10)
    v_pk_add_f32 v[32:33], v[32:33], v[36:37]
    s_waitcnt lgkmcnt(8)
    v_pk_add_f32 v[40:41], v[40:41], v[44:45]
    v_pk_add_f32 v[34:35], v[34:35], v[38:39]
    v_pk_add_f32 v[42:43], v[42:43], v[46:47]
    v_pk_add_f32 v[32:33], v[32:33], v[40:41]
    v_pk_add_f32 v[34:35], v[34:35], v[42:43]
    v_cvt_pk_bf16_f32 v36, v32, v33
    v_cvt_pk_bf16_f32 v37, v34, v35
    buffer_store_dwordx2 v[36:37], v225, s[36:39], s68 offen offset:3584
    s_waitcnt lgkmcnt(6)
    v_pk_add_f32 v[48:49], v[48:49], v[52:53]
    s_waitcnt lgkmcnt(4)
    v_pk_add_f32 v[56:57], v[56:57], v[60:61]
    v_pk_add_f32 v[50:51], v[50:51], v[54:55]
    v_pk_add_f32 v[58:59], v[58:59], v[62:63]
    v_pk_add_f32 v[48:49], v[48:49], v[56:57]
    v_pk_add_f32 v[50:51], v[50:51], v[58:59]
    v_cvt_pk_bf16_f32 v52, v48, v49
    v_cvt_pk_bf16_f32 v53, v50, v51
    buffer_store_dwordx2 v[52:53], v225, s[36:39], s69 offen offset:0
    s_waitcnt lgkmcnt(2)
    v_pk_add_f32 v[64:65], v[64:65], v[68:69]
    s_waitcnt lgkmcnt(0)
    v_pk_add_f32 v[72:73], v[72:73], v[76:77]
    v_pk_add_f32 v[66:67], v[66:67], v[70:71]
    v_pk_add_f32 v[74:75], v[74:75], v[78:79]
    v_pk_add_f32 v[64:65], v[64:65], v[72:73]
    v_pk_add_f32 v[66:67], v[66:67], v[74:75]
    v_cvt_pk_bf16_f32 v68, v64, v65
    v_cvt_pk_bf16_f32 v69, v66, v67
    buffer_store_dwordx2 v[68:69], v225, s[36:39], s69 offen offset:3584
L_end_P:
    s_endpgm

.section .rodata,"a"
.p2align 6
.amdhsa_kernel sequential_preLN__sliding_local_dilated__mixer_token_mlp__prompt_kernel
  .amdhsa_next_free_vgpr 508
  .amdhsa_next_free_sgpr 102
  .amdhsa_accum_offset 252
  .amdhsa_group_segment_fixed_size 0
  .amdhsa_kernarg_size 88
  .amdhsa_user_sgpr_count 2
  .amdhsa_user_sgpr_kernarg_segment_ptr 1
  .amdhsa_system_sgpr_workgroup_id_x 1
.end_amdhsa_kernel
```

```asm
; @launch grid=(256,1,1) block=(256,1,1) lds=163840
.amdgcn_target "amdgcn-amd-amdhsa--gfx950"
.text
.globl sequential_preLN__sliding_local_dilated__mixer_token_mlp__prompt_kernel
.p2align 8
.type sequential_preLN__sliding_local_dilated__mixer_token_mlp__prompt_kernel,@function
sequential_preLN__sliding_local_dilated__mixer_token_mlp__prompt_kernel:
    s_cmp_ge_u32 s2, 256
    s_cbranch_scc1 L_end_P
    s_load_dwordx2 s[8:9], s[0:1], 0
    s_load_dwordx2 s[12:13], s[0:1], 8
    s_load_dwordx2 s[44:45], s[0:1], 72
    s_load_dwordx2 s[40:41], s[0:1], 80
    s_load_dwordx2 s[16:17], s[0:1], 16
    s_load_dwordx2 s[20:21], s[0:1], 32
    s_load_dwordx2 s[24:25], s[0:1], 48
    s_load_dwordx2 s[28:29], s[0:1], 40
    s_load_dwordx2 s[32:33], s[0:1], 56
    s_load_dwordx2 s[36:37], s[0:1], 64
    v_lshrrev_b32 v1, 6, v0
    s_nop 0
    v_readfirstlane_b32 s3, v1
    v_and_b32 v1, 63, v0
    v_and_b32 v2, 15, v0
    v_lshrrev_b32 v3, 4, v1
    v_lshlrev_b32 v4, 4, v1
    s_mov_b32 s10, 0x1c0000
    s_mov_b32 s11, 0x00020000
    s_mov_b32 s14, 0x126000
    s_mov_b32 s15, 0x00020000
    s_mov_b32 s46, 0x100
    s_mov_b32 s47, 0x00020000
    s_mov_b32 s42, 0x5c0000
    s_mov_b32 s43, 0x00020000
    s_mov_b32 s18, 0x62000
    s_mov_b32 s19, 0x00020000
    s_mov_b32 s22, 0x700000
    s_mov_b32 s23, 0x00020000
    s_mov_b32 s26, 0x700000
    s_mov_b32 s27, 0x00020000
    s_mov_b32 s30, 0xe00
    s_mov_b32 s31, 0x00020000
    s_mov_b32 s34, 0x1000
    s_mov_b32 s35, 0x00020000
    s_mov_b32 s38, 0x1c0000
    s_mov_b32 s39, 0x00020000
    s_mov_b32 s5, 0x3f803f80
    s_mov_b32 s6, 0x40000
    s_bfe_u32 s48, s2, 0x20001
    s_lshl_b32 s48, s48, 2
    s_lshr_b32 s53, s2, 6
    s_add_u32 s48, s48, s53
    s_bfe_u32 s49, s2, 0x30003
    s_and_b32 s53, s2, 1
    s_lshl_b32 s53, s53, 3
    s_add_u32 s49, s49, s53
    v_lshrrev_b32 v237, 2, v1
    v_mul_u32_u24 v123, 2688, v237
    v_lshrrev_b32 v237, 5, v1
    v_lshlrev_b32 v237, 1, v237
    v_and_b32 v238, 3, v1
    v_xor_b32 v237, v237, v238
    v_lshl_add_u32 v123, v237, 4, v123
    s_mul_i32 s53, s49, 56
    s_min_u32 s53, s53, 832
    s_mul_i32 s51, s3, 43008
    s_add_u32 s53, s53, s51
    v_add_u32 v123, s53, v123
    s_lshr_b32 s53, s3, 1
    s_mul_i32 s51, s53, 6144
    s_and_b32 s53, s3, 1
    s_lshl_b32 s53, s53, 10
    s_add_u32 s51, s51, s53
    v_lshrrev_b32 v237, 3, v1
    v_mul_u32_u24 v122, 896, v237
    v_and_b32 v237, 7, v1
    v_xor_b32 v237, v237, v3
    v_lshl_add_u32 v120, v237, 4, v122
    s_lshl_b32 s50, s48, 7
    s_lshl_b32 s53, s3, 5
    s_add_u32 s53, s53, s50
    s_mul_i32 s53, s53, 896
    v_xor_b32 v121, 64, v120
    v_add_u32 v120, s53, v120
    s_add_u32 s53, s53, 7168
    v_add_u32 v121, s53, v121
    s_lshl_b32 s53, s3, 1
    v_xor_b32 v237, s53, v237
    v_lshl_add_u32 v122, v237, 4, v122
    s_lshl_b32 s53, s3, 2
    s_add_u32 s53, s53, s50
    s_sub_u32 s53, s53, 16
    s_mul_i32 s53, s53, 896
    s_cmp_eq_u32 s48, 0
    s_cselect_b32 s53, 0x40000000, s53
    v_add_u32 v122, s53, v122
    s_lshl_b32 s52, s3, 12
    s_add_u32 s52, s52, 63488
    s_lshl_b32 s7, s3, 9
    s_cmp_eq_u32 s3, 0
    s_cselect_b32 s54, 0xffffff00, -1
    s_mov_b32 s55, 0
    s_memrealtime s[86:87]
    v_mov_b32 v7, 0
    s_waitcnt lgkmcnt(0)
    s_or_b32 s86, s86, 1
    v_mov_b32 v6, s86
    s_or_b32 s86, s2, s3
    s_cmp_eq_u32 s86, 0
    s_cselect_b64 exec, 1, 0
    buffer_store_dword v6, v7, s[44:47], 0 offen sc1
    s_mov_b64 exec, -1
    s_add_u32 m0, s51, 12288
    s_mov_b32 s73, 0
    buffer_load_dwordx4 v123, s[12:15], s73 offen lds
    s_add_u32 m0, s51, 14336
    s_mov_b32 s73, 896
    buffer_load_dwordx4 v123, s[12:15], s73 offen lds
    s_add_u32 m0, s51, 16384
    s_mov_b32 s73, 1792
    buffer_load_dwordx4 v123, s[12:15], s73 offen lds
    s_add_u32 m0, s52, 36864
    s_mov_b32 s73, 0
    buffer_load_dwordx4 v120, s[8:11], s73 offen lds
    s_add_u32 m0, s52, 37888
    s_mov_b32 s73, 0
    buffer_load_dwordx4 v121, s[8:11], s73 offen lds
    s_add_u32 m0, s52, 38912
    s_mov_b32 s73, 14336
    buffer_load_dwordx4 v120, s[8:11], s73 offen lds
    s_add_u32 m0, s52, 39936
    s_mov_b32 s73, 14336
    buffer_load_dwordx4 v121, s[8:11], s73 offen lds
    s_add_u32 m0, s7, 98304
    s_mov_b32 s73, 0
    s_mov_b64 exec, s[54:55]
    buffer_load_dwordx4 v122, s[8:11], s73 offen lds
    s_mov_b64 exec, -1
    s_bfe_u32 s53, s2, 0x30003
    s_add_u32 s86, s53, 1
    s_lshr_b32 s86, s86, 1
    s_lshr_b32 s87, s2, 6
    s_mul_i32 s87, s87, 5
    s_add_u32 s86, s86, s87
    s_lshl_b32 s86, s86, 2
    s_add_u32 s53, s86, s3
    s_mov_b32 s56, s53
    s_mov_b32 s86, 0x2a54
    s_bitcmp1_b32 s86, s49
    s_cselect_b32 s57, 0x40000000, 0
    s_mul_i32 s86, s53, 48
    v_add_u32 v237, s86, v1
    v_mul_u32_u24 v238, 43691, v237
    v_lshrrev_b32 v238, 19, v238
    v_mul_u32_u24 v239, 12, v238
    v_sub_u32 v239, v237, v239
    v_lshrrev_b32 v239, 2, v239
    v_mul_u32_u24 v239, 896, v239
    v_mul_u32_u24 v238, 2688, v238
    v_and_b32 v237, 3, v237
    v_lshlrev_b32 v237, 7, v237
    v_add3_u32 v237, v237, v238, v239
    v_add_u32 v237, s57, v237
    s_and_b32 s86, s2, 1
    s_mul_i32 s86, s86, 384
    s_add_u32 s86, s86, 344064
    s_mov_b32 exec_hi, 0xffff
    buffer_load_dword v232, v237, s[12:15], s86 offen
    v_lshlrev_b32 v237, 7, v1
    v_add_u32 v238, s57, v237
    s_mul_i32 s86, s53, 6016
    s_bfe_u32 s87, s2, 0x20001
    s_mul_i32 s87, s87, 458752
    s_add_u32 s86, s86, s87
    s_max_u32 s86, s86, 14336
    s_sub_u32 s86, s86, 14336
    s_mov_b32 exec_hi, 0x7fff
    buffer_load_dword v233, v238, s[8:11], s86 offen
    s_getpc_b64 s[86:87]
Lpc_P:
    s_mul_i32 s53, s53, 384
    v_add_u32 v237, s53, v237
    v_min_u32 v237, L_end_P-Lpc_P, v237
    s_mov_b64 exec, 7
    global_load_dword v236, v237, s[86:87]
    s_mov_b64 exec, -1
    v_mul_u32_u24 v237, 18432, v3
    v_lshl_add_u32 v237, v2, 3, v237
    v_mov_b32 v238, s5
    v_add_u32 v237, 61440, v237
    ds_write2_b32 v237, v238, v238 offset0:0 offset1:1
    s_lshr_b32 s68, s2, 3
    s_mul_i32 s69, s68, 37
    s_lshr_b32 s69, s69, 8
    s_mul_i32 s64, s69, 7
    s_sub_u32 s64, s68, s64
    s_mov_b32 s66, s64
    s_and_b32 s68, s2, 7
    s_lshl_b32 s67, s68, 2
    s_add_u32 s67, s67, s69
    s_cmp_ge_u32 s69, 4
    s_cselect_b32 s67, 99, s67
    s_mul_i32 s71, s68, 3
    s_add_u32 s71, s71, 4
    s_lshl_b32 s72, s68, 2
    s_cmp_lt_u32 s68, 4
    s_cselect_b32 s65, s72, s71
    s_cselect_b32 s71, 4, 3
    s_add_u32 s65, s65, s69
    s_cmp_ge_u32 s69, s71
    s_cselect_b32 s65, 99, s65
    v_lshrrev_b32 v219, 3, v1
    v_mul_u32_u24 v208, 896, v219
    v_and_b32 v219, 1, v3
    v_lshlrev_b32 v219, 2, v219
    v_and_b32 v220, 7, v1
    v_xor_b32 v219, v219, v220
    v_lshl_add_u32 v208, v219, 4, v208
    s_lshl_b32 s58, s66, 7
    s_mul_i32 s60, s3, 100352
    s_add_u32 s58, s58, s60
    v_add_u32 v208, s58, v208
    s_mul_i32 s59, s3, 14336
    s_add_u32 s59, s59, 106496
    v_lshrrev_b32 v219, 5, v1
    v_lshlrev_b32 v209, 9, v219
    v_bfe_u32 v219, v1, 2, 2
    v_lshl_add_u32 v209, v219, 7, v209
    v_lshrrev_b32 v219, 1, v219
    s_and_b32 s58, s3, 1
    v_xor_b32 v219, s58, v219
    v_lshl_add_u32 v209, v219, 6, v209
    v_and_b32 v219, 1, v3
    v_lshl_add_u32 v209, v219, 5, v209
    v_and_b32 v219, 3, v1
    v_lshl_add_u32 v209, v219, 3, v209
    v_add_u32 v209, 106496, v209
    s_mul_i32 s70, s3, 36864
    s_add_u32 s70, s70, 12288
    v_lshrrev_b32 v219, 3, v1
    v_mul_u32_u24 v213, 3584, v219
    v_and_b32 v219, 1, v3
    v_lshlrev_b32 v219, 2, v219
    v_and_b32 v220, 7, v1
    v_xor_b32 v219, v219, v220
    v_lshl_add_u32 v213, v219, 4, v213
    s_mul_i32 s68, s3, 1835008
    s_lshl_b32 s69, s65, 7
    s_add_u32 s68, s68, s69
    s_cmp_ge_u32 s65, 99
    s_cselect_b32 s68, 0x40000000, s68
    v_add_u32 v213, s68, v213
    s_cselect_b32 s68, 0x40000000, 0
    v_add_u32 v5, s68, v4
    v_lshrrev_b32 v219, 5, v1
    v_lshlrev_b32 v215, 9, v219
    v_bfe_u32 v219, v1, 2, 2
    v_lshl_add_u32 v215, v219, 7, v215
    v_lshrrev_b32 v219, 1, v219
    s_lshr_b32 s68, s3, 1
    v_xor_b32 v219, s68, v219
    v_lshl_add_u32 v215, v219, 6, v215
    v_and_b32 v219, 1, v3
    v_lshl_add_u32 v215, v219, 5, v215
    v_and_b32 v219, 3, v1
    v_lshl_add_u32 v215, v219, 3, v215
    v_add_u32 v215, s70, v215
    v_xor_b32 v216, 64, v215
    s_mul_i32 s70, s3, 36864
    s_add_u32 s70, s70, 12288
    v_lshrrev_b32 v219, 3, v1
    v_mul_u32_u24 v214, 4096, v219
    v_and_b32 v219, 1, v3
    v_lshlrev_b32 v219, 2, v219
    v_and_b32 v220, 7, v1
    v_xor_b32 v219, v219, v220
    v_lshl_add_u32 v214, v219, 4, v214
    s_mul_i32 s68, s3, 1835008
    s_lshl_b32 s69, s67, 7
    s_add_u32 s68, s68, s69
    s_cmp_ge_u32 s67, 99
    s_cselect_b32 s68, 0x40000000, s68
    v_add_u32 v214, s68, v214
    v_lshrrev_b32 v219, 5, v1
    v_lshlrev_b32 v217, 9, v219
    v_bfe_u32 v219, v1, 2, 2
    v_lshl_add_u32 v217, v219, 7, v217
    v_lshrrev_b32 v219, 1, v219
    s_lshr_b32 s68, s3, 1
    v_xor_b32 v219, s68, v219
    v_lshl_add_u32 v217, v219, 6, v217
    v_and_b32 v219, 1, v3
    v_lshl_add_u32 v217, v219, 5, v217
    v_and_b32 v219, 3, v1
    v_lshl_add_u32 v217, v219, 3, v217
    v_add_u32 v217, s70, v217
    v_xor_b32 v218, 64, v217
    s_and_b32 s68, s2, 7
    s_cmp_ge_u32 s68, 8
    s_cselect_b32 s94, 8, 0
    s_sub_u32 s68, s68, s94
    s_lshl_b32 s94, s68, 12
    s_add_u32 s68, s68, 1
    s_cmp_ge_u32 s68, 8
    s_cselect_b32 s95, 8, 0
    s_sub_u32 s68, s68, s95
    s_lshl_b32 s95, s68, 12
    s_add_u32 s68, s68, 1
    s_cmp_ge_u32 s68, 8
    s_cselect_b32 s96, 8, 0
    s_sub_u32 s68, s68, s96
    s_lshl_b32 s96, s68, 12
    s_add_u32 s68, s68, 1
    s_cmp_ge_u32 s68, 8
    s_cselect_b32 s97, 8, 0
    s_sub_u32 s68, s68, s97
    s_lshl_b32 s97, s68, 12
    s_add_u32 s68, s68, 1
    s_cmp_ge_u32 s68, 8
    s_cselect_b32 s98, 8, 0
    s_sub_u32 s68, s68, s98
    s_lshl_b32 s98, s68, 12
    s_add_u32 s68, s68, 1
    s_cmp_ge_u32 s68, 8
    s_cselect_b32 s99, 8, 0
    s_sub_u32 s68, s68, s99
    s_lshl_b32 s99, s68, 12
    s_add_u32 s68, s68, 1
    s_cmp_ge_u32 s68, 8
    s_cselect_b32 s100, 8, 0
    s_sub_u32 s68, s68, s100
    s_lshl_b32 s100, s68, 12
    s_add_u32 s68, s68, 1
    s_cmp_ge_u32 s68, 8
    s_cselect_b32 s101, 8, 0
    s_sub_u32 s68, s68, s101
    s_lshl_b32 s101, s68, 12
    s_lshl_b32 s80, s48, 2
    s_add_u32 s80, s80, s3
    s_lshl_b32 s80, s80, 11
    s_lshr_b32 s79, s49, 2
    s_lshl_b32 s79, s79, 7
    s_add_u32 s80, s80, s79
    s_and_b32 s79, s49, 3
    s_lshl_b32 s79, s79, 2
    s_add_u32 s80, s80, s79
    s_add_u32 s80, s80, 0x588000
    s_lshl_b32 s83, s67, 1
    s_lshr_b32 s79, s3, 1
    s_add_u32 s83, s83, s79
    s_lshl_b32 s83, s83, 11
    s_add_u32 s83, s83, 0x588000
    v_lshrrev_b32 v10, 2, v2
    v_lshlrev_b32 v10, 7, v10
    v_and_b32 v219, 3, v2
    v_lshl_add_u32 v10, v219, 2, v10
    s_lshl_b32 s84, s64, 12
    s_add_u32 s85, s84, 0x5b0000
    s_add_u32 s84, s84, 0x5a8000
    s_lshl_b32 s81, s67, 5
    s_add_u32 s81, s81, s3
    s_lshl_b32 s81, s81, 2
    s_add_u32 s81, s81, s84
    s_lshl_b32 s79, s3, 10
    s_add_u32 s84, s84, s79
    v_bfe_u32 v11, v1, 2, 3
    v_min_u32 v12, 6, v11
    v_and_b32 v219, 3, v1
    v_lshlrev_b32 v219, 2, v219
    v_lshl_add_u32 v11, v11, 7, v219
    v_lshl_add_u32 v12, v12, 7, v219
    s_lshl_b32 s82, s65, 5
    s_add_u32 s82, s82, s3
    s_lshl_b32 s82, s82, 2
    s_add_u32 s82, s82, s85
    s_mul_i32 s79, s3, 896
    s_add_u32 s85, s85, s79
    v_mov_b32 v9, 0
    v_lshlrev_b32 v124, 9, v3
    v_bfe_u32 v237, v1, 2, 2
    v_lshl_add_u32 v124, v237, 6, v124
    v_and_b32 v237, 3, v1
    v_lshl_add_u32 v124, v237, 3, v124
    v_and_b32 v237, 1, v3
    v_lshlrev_b32 v237, 5, v237
    v_add_u32 v124, v124, v237
    v_add_u32 v124, 12288, v124
    v_xor_b32 v125, 32, v124
    s_and_b32 s53, s3, 1
    s_lshl_b32 s53, s53, 5
    v_xor_b32 v127, s53, v124
    s_lshr_b32 s53, s3, 1
    s_lshl_b32 s53, s53, 11
    s_add_u32 s53, s53, 2048
    v_add_u32 v126, s53, v127
    v_lshrrev_b32 v237, 1, v2
    v_xor_b32 v237, v237, v3
    v_lshlrev_b32 v237, 4, v237
    v_lshl_add_u32 v237, v2, 7, v237
    v_add_u32 v130, 61440, v237
    v_xor_b32 v131, 64, v130
    v_add_u32 v128, s52, v237
    v_xor_b32 v129, 64, v128
    v_lshlrev_b32 v237, 2, v3
    v_sub_u32 v237, v2, v237
    v_mov_b32 v239, 0xf149f2ca
    v_add_u32 v238, 16, v237
    v_and_b32 v238, 0xfffffff1, v238
    v_cmp_eq_u32 vcc, 0, v238
    s_nop 1
    v_cndmask_b32 v240, v239, 0, vcc
    v_add_u32 v238, 15, v237
    v_and_b32 v238, 0xfffffff1, v238
    v_cmp_eq_u32 vcc, 0, v238
    s_nop 1
    v_cndmask_b32 v241, v239, 0, vcc
    v_add_u32 v238, 14, v237
    v_and_b32 v238, 0xfffffff1, v238
    v_cmp_eq_u32 vcc, 0, v238
    s_nop 1
    v_cndmask_b32 v242, v239, 0, vcc
    v_add_u32 v238, 13, v237
    v_and_b32 v238, 0xfffffff1, v238
    v_cmp_eq_u32 vcc, 0, v238
    s_nop 1
    v_cndmask_b32 v243, v239, 0, vcc
    v_add_u32 v238, 0, v237
    v_and_b32 v238, 0xfffffff1, v238
    v_cmp_eq_u32 vcc, 0, v238
    s_nop 1
    v_cndmask_b32 v244, v239, 0, vcc
    v_add_u32 v238, -1, v237
    v_and_b32 v238, 0xfffffff1, v238
    v_cmp_eq_u32 vcc, 0, v238
    s_nop 1
    v_cndmask_b32 v245, v239, 0, vcc
    v_add_u32 v238, -2, v237
    v_and_b32 v238, 0xfffffff1, v238
    v_cmp_eq_u32 vcc, 0, v238
    s_nop 1
    v_cndmask_b32 v246, v239, 0, vcc
    v_add_u32 v238, -3, v237
    v_and_b32 v238, 0xfffffff1, v238
    v_cmp_eq_u32 vcc, 0, v238
    s_nop 1
    v_cndmask_b32 v247, v239, 0, vcc
    s_or_b32 s53, s48, s3
    s_cmp_eq_u32 s53, 0
    s_cselect_b64 vcc, -1, 0
    v_cndmask_b32 v248, v240, v239, vcc
    v_cndmask_b32 v249, v241, v239, vcc
    v_cndmask_b32 v250, v242, v239, vcc
    v_cndmask_b32 v251, v243, v239, vcc
    v_mov_b32 v40, s5
    v_mov_b32 v41, s5
    v_mov_b32 v42, s5
    v_mov_b32 v43, s5
    s_mov_b32 s88, 0x22222222
    s_mov_b32 s89, 0x22222222
    s_mov_b32 s90, 0x44444444
    s_mov_b32 s91, 0x44444444
    s_mov_b32 s92, 0x88888888
    s_mov_b32 s93, 0x88888888
    v_lshlrev_b32 v72, 4, v3
    s_lshl_b32 s53, s3, 6
    v_add_u32 v73, s53, v72
    s_and_b32 s53, s53, 64
    v_add_u32 v74, s53, v72
    s_mul_i32 s53, s3, 384
    v_lshl_add_u32 v75, v2, 2, s53
    v_add_u32 v76, s53, v72
    s_and_b32 s53, s3, 1
    s_lshl_b32 s53, s53, 3
    v_add_u32 v80, s53, v4
    v_lshrrev_b32 v81, 2, v2
    v_lshlrev_b32 v81, 8, v81
    v_lshl_add_u32 v81, v3, 6, v81
    v_and_b32 v82, 3, v2
    v_lshl_add_u32 v81, v82, 1, v81
    v_add_u32 v81, s53, v81
    v_add_u32 v81, 1024, v81
    s_cmp_lt_u32 s3, 2
    s_cselect_b64 vcc, -1, 0
    s_cselect_b32 s53, 2, 16
    v_cndmask_b32 v80, v81, v80, vcc
    v_add_u32 v81, s53, v80
    v_add_u32 v82, s53, v81
    v_add_u32 v83, s53, v82
    v_lshlrev_b32 v77, 2, v2
    s_lshl_b32 s53, s3, 11
    v_add_u32 v78, s53, v4
    s_lshl_b32 s62, s48, 3
    s_lshl_b32 s63, s3, 1
    s_add_u32 s62, s62, s63
    s_lshl_b32 s62, s62, 4
    s_add_u32 s62, s62, s49
    s_lshl_b32 s62, s62, 10
    s_add_u32 s63, s62, 16384
    s_add_u32 m0, s51, 24576
    s_mov_b32 s73, 172032
    buffer_load_dwordx4 v123, s[12:15], s73 offen lds
    s_add_u32 m0, s51, 26624
    s_mov_b32 s73, 172928
    buffer_load_dwordx4 v123, s[12:15], s73 offen lds
    s_add_u32 m0, s51, 28672
    s_mov_b32 s73, 173824
    buffer_load_dwordx4 v123, s[12:15], s73 offen lds
    s_add_u32 m0, s52, 18432
    s_mov_b32 s73, 128
    buffer_load_dwordx4 v120, s[8:11], s73 offen lds
    s_add_u32 m0, s52, 19456
    s_mov_b32 s73, 128
    buffer_load_dwordx4 v121, s[8:11], s73 offen lds
    s_add_u32 m0, s52, 20480
    s_mov_b32 s73, 14464
    buffer_load_dwordx4 v120, s[8:11], s73 offen lds
    s_add_u32 m0, s52, 21504
    s_mov_b32 s73, 14464
    buffer_load_dwordx4 v121, s[8:11], s73 offen lds
    s_add_u32 m0, s7, 79872
    s_mov_b32 s73, 128
    s_mov_b64 exec, s[54:55]
    buffer_load_dwordx4 v122, s[8:11], s73 offen lds
    s_mov_b64 exec, -1
    s_waitcnt vmcnt(11)
    s_waitcnt lgkmcnt(0)
    s_barrier
    ds_read_b128 v[16:19], v128 offset:36864
    ds_read_b128 v[20:23], v128 offset:38912
    ds_read_b128 v[24:27], v130 offset:36864
    ds_read_b64_tr_b16 v[88:89], v124 offset:0
    ds_read_b64_tr_b16 v[90:91], v124 offset:256
    ds_read_b64_tr_b16 v[92:93], v125 offset:0
    ds_read_b64_tr_b16 v[94:95], v125 offset:256
    ds_read_b64_tr_b16 v[96:97], v124 offset:2048
    ds_read_b64_tr_b16 v[98:99], v124 offset:2304
    ds_read_b64_tr_b16 v[100:101], v125 offset:2048
    ds_read_b64_tr_b16 v[102:103], v125 offset:2304
    ds_read_b64_tr_b16 v[104:105], v124 offset:4096
    ds_read_b64_tr_b16 v[106:107], v124 offset:4352
    ds_read_b64_tr_b16 v[108:109], v125 offset:4096
    ds_read_b64_tr_b16 v[110:111], v125 offset:4352
    ds_read_b64_tr_b16 v[112:113], v126 offset:0
    ds_read_b64_tr_b16 v[114:115], v126 offset:256
    ds_read_b64_tr_b16 v[116:117], v127 offset:0
    ds_read_b64_tr_b16 v[118:119], v127 offset:256
    s_waitcnt lgkmcnt(8)
    v_mfma_f32_16x16x32_bf16 v[136:139], v[88:91], v[16:19], 0
    ds_read_b128 v[28:31], v129 offset:36864
    v_mfma_f32_16x16x32_bf16 v[160:163], v[88:91], v[20:23], 0
    ds_read_b128 v[32:35], v129 offset:38912
    v_mfma_f32_16x16x32_bf16 v[140:143], v[92:95], v[16:19], 0
    ds_read_b128 v[36:39], v131 offset:36864
    v_mfma_f32_16x16x32_bf16 v[164:167], v[92:95], v[20:23], 0
    ds_read_b64_tr_b16 v[88:89], v124 offset:6144
    v_mfma_f32_16x16x32_bf16 v[144:147], v[96:99], v[16:19], 0
    ds_read_b64_tr_b16 v[90:91], v124 offset:6400
    s_add_u32 m0, s51, 36864
    s_mov_b32 s73, 344064
    buffer_load_dwordx4 v123, s[12:15], s73 offen lds
    v_mfma_f32_16x16x32_bf16 v[168:171], v[96:99], v[20:23], 0
    ds_read_b64_tr_b16 v[92:93], v125 offset:6144
    v_mfma_f32_16x16x32_bf16 v[148:151], v[100:103], v[16:19], 0
    ds_read_b64_tr_b16 v[94:95], v125 offset:6400
    v_mfma_f32_16x16x32_bf16 v[172:175], v[100:103], v[20:23], 0
    ds_read_b64_tr_b16 v[96:97], v124 offset:8192
    s_waitcnt lgkmcnt(8)
    v_mfma_f32_16x16x32_bf16 v[152:155], v[16:19], v[104:107], 0
    ds_read_b64_tr_b16 v[98:99], v124 offset:8448
    v_mfma_f32_16x16x32_bf16 v[176:179], v[20:23], v[104:107], 0
    ds_read_b64_tr_b16 v[100:101], v125 offset:8192
    s_add_u32 m0, s51, 38912
    s_mov_b32 s73, 344960
    buffer_load_dwordx4 v123, s[12:15], s73 offen lds
    v_mfma_f32_16x16x32_bf16 v[156:159], v[16:19], v[108:111], 0
    ds_read_b64_tr_b16 v[102:103], v125 offset:8448
    v_mfma_f32_16x16x32_bf16 v[180:183], v[20:23], v[108:111], 0
    ds_read_b64_tr_b16 v[104:105], v124 offset:10240
    v_mfma_f32_16x16x32_bf16 v[184:187], v[112:115], v[24:27], 0
    ds_read_b64_tr_b16 v[106:107], v124 offset:10496
    v_mfma_f32_16x16x32_bf16 v[188:191], v[116:119], v[24:27], 0
    ds_read_b64_tr_b16 v[108:109], v125 offset:10240
    v_mfma_f32_16x16x32_bf16 v[48:51], v[16:19], v[16:19], 0
    ds_read_b64_tr_b16 v[110:111], v125 offset:10496
    s_add_u32 m0, s51, 40960
    s_mov_b32 s73, 345856
    buffer_load_dwordx4 v123, s[12:15], s73 offen lds
    v_mfma_f32_16x16x32_bf16 v[52:55], v[20:23], v[20:23], 0
    ds_read_b64_tr_b16 v[112:113], v126 offset:6144
    v_mfma_f32_16x16x32_bf16 v[56:59], v[24:27], v[24:27], 0
    ds_read_b64_tr_b16 v[114:115], v126 offset:6400
    v_mfma_f32_16x16x32_bf16 v[60:63], v[40:43], v[16:19], 0
    ds_read_b64_tr_b16 v[116:117], v127 offset:6144
    v_mfma_f32_16x16x32_bf16 v[64:67], v[40:43], v[20:23], 0
    ds_read_b64_tr_b16 v[118:119], v127 offset:6400
    v_mfma_f32_16x16x32_bf16 v[68:71], v[40:43], v[24:27], 0
    s_add_u32 m0, s52, 0
    s_mov_b32 s73, 256
    buffer_load_dwordx4 v120, s[8:11], s73 offen lds
    s_add_u32 m0, s52, 1024
    s_mov_b32 s73, 256
    buffer_load_dwordx4 v121, s[8:11], s73 offen lds
    s_add_u32 m0, s52, 2048
    s_mov_b32 s73, 14592
    buffer_load_dwordx4 v120, s[8:11], s73 offen lds
    s_add_u32 m0, s52, 3072
    s_mov_b32 s73, 14592
    buffer_load_dwordx4 v121, s[8:11], s73 offen lds
    s_add_u32 m0, s7, 61440
    s_mov_b32 s73, 256
    s_mov_b64 exec, s[54:55]
    buffer_load_dwordx4 v122, s[8:11], s73 offen lds
    s_mov_b64 exec, -1
    s_waitcnt vmcnt(8)
    s_barrier
    s_waitcnt lgkmcnt(8)
    v_mfma_f32_16x16x32_bf16 v[136:139], v[88:91], v[28:31], v[136:139]
    ds_read_b128 v[16:19], v128 offset:18432
    v_mfma_f32_16x16x32_bf16 v[160:163], v[88:91], v[32:35], v[160:163]
    ds_read_b128 v[20:23], v128 offset:20480
    v_mfma_f32_16x16x32_bf16 v[140:143], v[92:95], v[28:31], v[140:143]
    ds_read_b128 v[24:27], v130 offset:18432
    v_mfma_f32_16x16x32_bf16 v[164:167], v[92:95], v[32:35], v[164:167]
    ds_read_b64_tr_b16 v[88:89], v124 offset:12288
    v_mfma_f32_16x16x32_bf16 v[144:147], v[96:99], v[28:31], v[144:147]
    ds_read_b64_tr_b16 v[90:91], v124 offset:12544
    s_add_u32 m0, s51, 49152
    s_mov_b32 s73, 516096
    buffer_load_dwordx4 v123, s[12:15], s73 offen lds
    v_mfma_f32_16x16x32_bf16 v[168:171], v[96:99], v[32:35], v[168:171]
    ds_read_b64_tr_b16 v[92:93], v125 offset:12288
    v_mfma_f32_16x16x32_bf16 v[148:151], v[100:103], v[28:31], v[148:151]
    ds_read_b64_tr_b16 v[94:95], v125 offset:12544
    v_mfma_f32_16x16x32_bf16 v[172:175], v[100:103], v[32:35], v[172:175]
    ds_read_b64_tr_b16 v[96:97], v124 offset:14336
    s_waitcnt lgkmcnt(8)
    v_mfma_f32_16x16x32_bf16 v[152:155], v[28:31], v[104:107], v[152:155]
    ds_read_b64_tr_b16 v[98:99], v124 offset:14592
    v_mfma_f32_16x16x32_bf16 v[176:179], v[32:35], v[104:107], v[176:179]
    ds_read_b64_tr_b16 v[100:101], v125 offset:14336
    s_add_u32 m0, s51, 51200
    s_mov_b32 s73, 516992
    buffer_load_dwordx4 v123, s[12:15], s73 offen lds
    v_mfma_f32_16x16x32_bf16 v[156:159], v[28:31], v[108:111], v[156:159]
    ds_read_b64_tr_b16 v[102:103], v125 offset:14592
    v_mfma_f32_16x16x32_bf16 v[180:183], v[32:35], v[108:111], v[180:183]
    ds_read_b64_tr_b16 v[104:105], v124 offset:16384
    v_mfma_f32_16x16x32_bf16 v[184:187], v[112:115], v[36:39], v[184:187]
    ds_read_b64_tr_b16 v[106:107], v124 offset:16640
    v_mfma_f32_16x16x32_bf16 v[188:191], v[116:119], v[36:39], v[188:191]
    ds_read_b64_tr_b16 v[108:109], v125 offset:16384
    v_mfma_f32_16x16x32_bf16 v[48:51], v[28:31], v[28:31], v[48:51]
    ds_read_b64_tr_b16 v[110:111], v125 offset:16640
    s_add_u32 m0, s51, 53248
    s_mov_b32 s73, 517888
    buffer_load_dwordx4 v123, s[12:15], s73 offen lds
    v_mfma_f32_16x16x32_bf16 v[52:55], v[32:35], v[32:35], v[52:55]
    ds_read_b64_tr_b16 v[112:113], v126 offset:12288
    v_mfma_f32_16x16x32_bf16 v[56:59], v[36:39], v[36:39], v[56:59]
    ds_read_b64_tr_b16 v[114:115], v126 offset:12544
    v_mfma_f32_16x16x32_bf16 v[60:63], v[40:43], v[28:31], v[60:63]
    ds_read_b64_tr_b16 v[116:117], v127 offset:12288
    v_mfma_f32_16x16x32_bf16 v[64:67], v[40:43], v[32:35], v[64:67]
    ds_read_b64_tr_b16 v[118:119], v127 offset:12544
    v_mfma_f32_16x16x32_bf16 v[68:71], v[40:43], v[36:39], v[68:71]
    s_add_u32 m0, s52, 55296
    s_mov_b32 s73, 384
    buffer_load_dwordx4 v120, s[8:11], s73 offen lds
    s_waitcnt lgkmcnt(8)
    v_mfma_f32_16x16x32_bf16 v[136:139], v[88:91], v[16:19], v[136:139]
    ds_read_b128 v[28:31], v129 offset:18432
    v_mfma_f32_16x16x32_bf16 v[160:163], v[88:91], v[20:23], v[160:163]
    ds_read_b128 v[32:35], v129 offset:20480
    v_mfma_f32_16x16x32_bf16 v[140:143], v[92:95], v[16:19], v[140:143]
    ds_read_b128 v[36:39], v131 offset:18432
    v_mfma_f32_16x16x32_bf16 v[164:167], v[92:95], v[20:23], v[164:167]
    ds_read_b64_tr_b16 v[88:89], v124 offset:18432
    v_mfma_f32_16x16x32_bf16 v[144:147], v[96:99], v[16:19], v[144:147]
    ds_read_b64_tr_b16 v[90:91], v124 offset:18688
    s_add_u32 m0, s52, 56320
    s_mov_b32 s73, 384
    buffer_load_dwordx4 v121, s[8:11], s73 offen lds
    v_mfma_f32_16x16x32_bf16 v[168:171], v[96:99], v[20:23], v[168:171]
    ds_read_b64_tr_b16 v[92:93], v125 offset:18432
    v_mfma_f32_16x16x32_bf16 v[148:151], v[100:103], v[16:19], v[148:151]
    ds_read_b64_tr_b16 v[94:95], v125 offset:18688
    v_mfma_f32_16x16x32_bf16 v[172:175], v[100:103], v[20:23], v[172:175]
    ds_read_b64_tr_b16 v[96:97], v124 offset:20480
    s_waitcnt lgkmcnt(8)
    v_mfma_f32_16x16x32_bf16 v[152:155], v[16:19], v[104:107], v[152:155]
    ds_read_b64_tr_b16 v[98:99], v124 offset:20736
    v_mfma_f32_16x16x32_bf16 v[176:179], v[20:23], v[104:107], v[176:179]
    ds_read_b64_tr_b16 v[100:101], v125 offset:20480
    s_add_u32 m0, s52, 57344
    s_mov_b32 s73, 14720
    buffer_load_dwordx4 v120, s[8:11], s73 offen lds
    v_mfma_f32_16x16x32_bf16 v[156:159], v[16:19], v[108:111], v[156:159]
    ds_read_b64_tr_b16 v[102:103], v125 offset:20736
    v_mfma_f32_16x16x32_bf16 v[180:183], v[20:23], v[108:111], v[180:183]
    ds_read_b64_tr_b16 v[104:105], v124 offset:22528
    v_mfma_f32_16x16x32_bf16 v[184:187], v[112:115], v[24:27], v[184:187]
    ds_read_b64_tr_b16 v[106:107], v124 offset:22784
    v_mfma_f32_16x16x32_bf16 v[188:191], v[116:119], v[24:27], v[188:191]
    ds_read_b64_tr_b16 v[108:109], v125 offset:22528
    v_mfma_f32_16x16x32_bf16 v[48:51], v[16:19], v[16:19], v[48:51]
    ds_read_b64_tr_b16 v[110:111], v125 offset:22784
    s_add_u32 m0, s52, 58368
    s_mov_b32 s73, 14720
    buffer_load_dwordx4 v121, s[8:11], s73 offen lds
    v_mfma_f32_16x16x32_bf16 v[52:55], v[20:23], v[20:23], v[52:55]
    ds_read_b64_tr_b16 v[112:113], v126 offset:18432
    v_mfma_f32_16x16x32_bf16 v[56:59], v[24:27], v[24:27], v[56:59]
    ds_read_b64_tr_b16 v[114:115], v126 offset:18688
    v_mfma_f32_16x16x32_bf16 v[60:63], v[40:43], v[16:19], v[60:63]
    ds_read_b64_tr_b16 v[116:117], v127 offset:18432
    v_mfma_f32_16x16x32_bf16 v[64:67], v[40:43], v[20:23], v[64:67]
    ds_read_b64_tr_b16 v[118:119], v127 offset:18688
    v_mfma_f32_16x16x32_bf16 v[68:71], v[40:43], v[24:27], v[68:71]
    s_add_u32 m0, s7, 116736
    s_mov_b32 s73, 384
    s_mov_b64 exec, s[54:55]
    buffer_load_dwordx4 v122, s[8:11], s73 offen lds
    s_mov_b64 exec, -1
    s_waitcnt vmcnt(8)
    s_barrier
    s_waitcnt lgkmcnt(8)
    v_mfma_f32_16x16x32_bf16 v[136:139], v[88:91], v[28:31], v[136:139]
    ds_read_b128 v[16:19], v128 offset:0
    v_mfma_f32_16x16x32_bf16 v[160:163], v[88:91], v[32:35], v[160:163]
    ds_read_b128 v[20:23], v128 offset:2048
    v_mfma_f32_16x16x32_bf16 v[140:143], v[92:95], v[28:31], v[140:143]
    ds_read_b128 v[24:27], v130 offset:0
    v_mfma_f32_16x16x32_bf16 v[164:167], v[92:95], v[32:35], v[164:167]
    ds_read_b64_tr_b16 v[88:89], v124 offset:24576
    v_mfma_f32_16x16x32_bf16 v[144:147], v[96:99], v[28:31], v[144:147]
    ds_read_b64_tr_b16 v[90:91], v124 offset:24832
    s_add_u32 m0, s51, 12288
    s_mov_b32 s73, 688128
    buffer_load_dwordx4 v123, s[12:15], s73 offen lds
    v_mfma_f32_16x16x32_bf16 v[168:171], v[96:99], v[32:35], v[168:171]
    ds_read_b64_tr_b16 v[92:93], v125 offset:24576
    v_mfma_f32_16x16x32_bf16 v[148:151], v[100:103], v[28:31], v[148:151]
    ds_read_b64_tr_b16 v[94:95], v125 offset:24832
    v_mfma_f32_16x16x32_bf16 v[172:175], v[100:103], v[32:35], v[172:175]
    ds_read_b64_tr_b16 v[96:97], v124 offset:26624
    s_waitcnt lgkmcnt(8)
    v_mfma_f32_16x16x32_bf16 v[152:155], v[28:31], v[104:107], v[152:155]
    ds_read_b64_tr_b16 v[98:99], v124 offset:26880
    v_mfma_f32_16x16x32_bf16 v[176:179], v[32:35], v[104:107], v[176:179]
    ds_read_b64_tr_b16 v[100:101], v125 offset:26624
    s_add_u32 m0, s51, 14336
    s_mov_b32 s73, 689024
    buffer_load_dwordx4 v123, s[12:15], s73 offen lds
    v_mfma_f32_16x16x32_bf16 v[156:159], v[28:31], v[108:111], v[156:159]
    ds_read_b64_tr_b16 v[102:103], v125 offset:26880
    v_mfma_f32_16x16x32_bf16 v[180:183], v[32:35], v[108:111], v[180:183]
    ds_read_b64_tr_b16 v[104:105], v124 offset:28672
    v_mfma_f32_16x16x32_bf16 v[184:187], v[112:115], v[36:39], v[184:187]
    ds_read_b64_tr_b16 v[106:107], v124 offset:28928
    v_mfma_f32_16x16x32_bf16 v[188:191], v[116:119], v[36:39], v[188:191]
    ds_read_b64_tr_b16 v[108:109], v125 offset:28672
    v_mfma_f32_16x16x32_bf16 v[48:51], v[28:31], v[28:31], v[48:51]
    ds_read_b64_tr_b16 v[110:111], v125 offset:28928
    s_add_u32 m0, s51, 16384
    s_mov_b32 s73, 689920
    buffer_load_dwordx4 v123, s[12:15], s73 offen lds
    v_mfma_f32_16x16x32_bf16 v[52:55], v[32:35], v[32:35], v[52:55]
    ds_read_b64_tr_b16 v[112:113], v126 offset:24576
    v_mfma_f32_16x16x32_bf16 v[56:59], v[36:39], v[36:39], v[56:59]
    ds_read_b64_tr_b16 v[114:115], v126 offset:24832
    v_mfma_f32_16x16x32_bf16 v[60:63], v[40:43], v[28:31], v[60:63]
    ds_read_b64_tr_b16 v[116:117], v127 offset:24576
    v_mfma_f32_16x16x32_bf16 v[64:67], v[40:43], v[32:35], v[64:67]
    ds_read_b64_tr_b16 v[118:119], v127 offset:24832
    v_mfma_f32_16x16x32_bf16 v[68:71], v[40:43], v[36:39], v[68:71]
    s_add_u32 m0, s52, 36864
    s_mov_b32 s73, 512
    buffer_load_dwordx4 v120, s[8:11], s73 offen lds
    s_waitcnt lgkmcnt(8)
    v_mfma_f32_16x16x32_bf16 v[136:139], v[88:91], v[16:19], v[136:139]
    ds_read_b128 v[28:31], v129 offset:0
    v_mfma_f32_16x16x32_bf16 v[160:163], v[88:91], v[20:23], v[160:163]
    ds_read_b128 v[32:35], v129 offset:2048
    v_mfma_f32_16x16x32_bf16 v[140:143], v[92:95], v[16:19], v[140:143]
    ds_read_b128 v[36:39], v131 offset:0
    v_mfma_f32_16x16x32_bf16 v[164:167], v[92:95], v[20:23], v[164:167]
    ds_read_b64_tr_b16 v[88:89], v124 offset:30720
    v_mfma_f32_16x16x32_bf16 v[144:147], v[96:99], v[16:19], v[144:147]
    ds_read_b64_tr_b16 v[90:91], v124 offset:30976
    s_add_u32 m0, s52, 37888
    s_mov_b32 s73, 512
    buffer_load_dwordx4 v121, s[8:11], s73 offen lds
    v_mfma_f32_16x16x32_bf16 v[168:171], v[96:99], v[20:23], v[168:171]
    ds_read_b64_tr_b16 v[92:93], v125 offset:30720
    v_mfma_f32_16x16x32_bf16 v[148:151], v[100:103], v[16:19], v[148:151]
    ds_read_b64_tr_b16 v[94:95], v125 offset:30976
    v_mfma_f32_16x16x32_bf16 v[172:175], v[100:103], v[20:23], v[172:175]
    ds_read_b64_tr_b16 v[96:97], v124 offset:32768
    s_waitcnt lgkmcnt(8)
    v_mfma_f32_16x16x32_bf16 v[152:155], v[16:19], v[104:107], v[152:155]
    ds_read_b64_tr_b16 v[98:99], v124 offset:33024
    v_mfma_f32_16x16x32_bf16 v[176:179], v[20:23], v[104:107], v[176:179]
    ds_read_b64_tr_b16 v[100:101], v125 offset:32768
    s_add_u32 m0, s52, 38912
    s_mov_b32 s73, 14848
    buffer_load_dwordx4 v120, s[8:11], s73 offen lds
    v_mfma_f32_16x16x32_bf16 v[156:159], v[16:19], v[108:111], v[156:159]
    ds_read_b64_tr_b16 v[102:103], v125 offset:33024
    v_mfma_f32_16x16x32_bf16 v[180:183], v[20:23], v[108:111], v[180:183]
    ds_read_b64_tr_b16 v[104:105], v124 offset:34816
    v_mfma_f32_16x16x32_bf16 v[184:187], v[112:115], v[24:27], v[184:187]
    ds_read_b64_tr_b16 v[106:107], v124 offset:35072
    v_mfma_f32_16x16x32_bf16 v[188:191], v[116:119], v[24:27], v[188:191]
    ds_read_b64_tr_b16 v[108:109], v125 offset:34816
    v_mfma_f32_16x16x32_bf16 v[48:51], v[16:19], v[16:19], v[48:51]
    ds_read_b64_tr_b16 v[110:111], v125 offset:35072
    s_add_u32 m0, s52, 39936
    s_mov_b32 s73, 14848
    buffer_load_dwordx4 v121, s[8:11], s73 offen lds
    v_mfma_f32_16x16x32_bf16 v[52:55], v[20:23], v[20:23], v[52:55]
    ds_read_b64_tr_b16 v[112:113], v126 offset:30720
    v_mfma_f32_16x16x32_bf16 v[56:59], v[24:27], v[24:27], v[56:59]
    ds_read_b64_tr_b16 v[114:115], v126 offset:30976
    v_mfma_f32_16x16x32_bf16 v[60:63], v[40:43], v[16:19], v[60:63]
    ds_read_b64_tr_b16 v[116:117], v127 offset:30720
    v_mfma_f32_16x16x32_bf16 v[64:67], v[40:43], v[20:23], v[64:67]
    ds_read_b64_tr_b16 v[118:119], v127 offset:30976
    v_mfma_f32_16x16x32_bf16 v[68:71], v[40:43], v[24:27], v[68:71]
    s_add_u32 m0, s7, 98304
    s_mov_b32 s73, 512
    s_mov_b64 exec, s[54:55]
    buffer_load_dwordx4 v122, s[8:11], s73 offen lds
    s_mov_b64 exec, -1
    s_waitcnt vmcnt(8)
    s_barrier
    s_waitcnt lgkmcnt(8)
    v_mfma_f32_16x16x32_bf16 v[136:139], v[88:91], v[28:31], v[136:139]
    ds_read_b128 v[16:19], v128 offset:55296
    v_mfma_f32_16x16x32_bf16 v[160:163], v[88:91], v[32:35], v[160:163]
    ds_read_b128 v[20:23], v128 offset:57344
    v_mfma_f32_16x16x32_bf16 v[140:143], v[92:95], v[28:31], v[140:143]
    ds_read_b128 v[24:27], v130 offset:55296
    v_mfma_f32_16x16x32_bf16 v[164:167], v[92:95], v[32:35], v[164:167]
    ds_read_b64_tr_b16 v[88:89], v124 offset:36864
    v_mfma_f32_16x16x32_bf16 v[144:147], v[96:99], v[28:31], v[144:147]
    ds_read_b64_tr_b16 v[90:91], v124 offset:37120
    s_add_u32 m0, s51, 24576
    s_mov_b32 s73, 860160
    buffer_load_dwordx4 v123, s[12:15], s73 offen lds
    v_mfma_f32_16x16x32_bf16 v[168:171], v[96:99], v[32:35], v[168:171]
    ds_read_b64_tr_b16 v[92:93], v125 offset:36864
    v_mfma_f32_16x16x32_bf16 v[148:151], v[100:103], v[28:31], v[148:151]
    ds_read_b64_tr_b16 v[94:95], v125 offset:37120
    v_mfma_f32_16x16x32_bf16 v[172:175], v[100:103], v[32:35], v[172:175]
    ds_read_b64_tr_b16 v[96:97], v124 offset:38912
    s_waitcnt lgkmcnt(8)
    v_mfma_f32_16x16x32_bf16 v[152:155], v[28:31], v[104:107], v[152:155]
    ds_read_b64_tr_b16 v[98:99], v124 offset:39168
    v_mfma_f32_16x16x32_bf16 v[176:179], v[32:35], v[104:107], v[176:179]
    ds_read_b64_tr_b16 v[100:101], v125 offset:38912
    s_add_u32 m0, s51, 26624
    s_mov_b32 s73, 861056
    buffer_load_dwordx4 v123, s[12:15], s73 offen lds
    v_mfma_f32_16x16x32_bf16 v[156:159], v[28:31], v[108:111], v[156:159]
    ds_read_b64_tr_b16 v[102:103], v125 offset:39168
    v_mfma_f32_16x16x32_bf16 v[180:183], v[32:35], v[108:111], v[180:183]
    ds_read_b64_tr_b16 v[104:105], v124 offset:40960
    v_mfma_f32_16x16x32_bf16 v[184:187], v[112:115], v[36:39], v[184:187]
    ds_read_b64_tr_b16 v[106:107], v124 offset:41216
    v_mfma_f32_16x16x32_bf16 v[188:191], v[116:119], v[36:39], v[188:191]
    ds_read_b64_tr_b16 v[108:109], v125 offset:40960
    v_mfma_f32_16x16x32_bf16 v[48:51], v[28:31], v[28:31], v[48:51]
    ds_read_b64_tr_b16 v[110:111], v125 offset:41216
    s_add_u32 m0, s51, 28672
    s_mov_b32 s73, 861952
    buffer_load_dwordx4 v123, s[12:15], s73 offen lds
    v_mfma_f32_16x16x32_bf16 v[52:55], v[32:35], v[32:35], v[52:55]
    ds_read_b64_tr_b16 v[112:113], v126 offset:36864
    v_mfma_f32_16x16x32_bf16 v[56:59], v[36:39], v[36:39], v[56:59]
    ds_read_b64_tr_b16 v[114:115], v126 offset:37120
    v_mfma_f32_16x16x32_bf16 v[60:63], v[40:43], v[28:31], v[60:63]
    ds_read_b64_tr_b16 v[116:117], v127 offset:36864
    v_mfma_f32_16x16x32_bf16 v[64:67], v[40:43], v[32:35], v[64:67]
    ds_read_b64_tr_b16 v[118:119], v127 offset:37120
    v_mfma_f32_16x16x32_bf16 v[68:71], v[40:43], v[36:39], v[68:71]
    s_add_u32 m0, s52, 18432
    s_mov_b32 s73, 640
    buffer_load_dwordx4 v120, s[8:11], s73 offen lds
    s_waitcnt lgkmcnt(8)
    v_mfma_f32_16x16x32_bf16 v[136:139], v[88:91], v[16:19], v[136:139]
    ds_read_b128 v[28:31], v129 offset:55296
    v_mfma_f32_16x16x32_bf16 v[160:163], v[88:91], v[20:23], v[160:163]
    ds_read_b128 v[32:35], v129 offset:57344
    v_mfma_f32_16x16x32_bf16 v[140:143], v[92:95], v[16:19], v[140:143]
    ds_read_b128 v[36:39], v131 offset:55296
    v_mfma_f32_16x16x32_bf16 v[164:167], v[92:95], v[20:23], v[164:167]
    ds_read_b64_tr_b16 v[88:89], v124 offset:43008
    v_mfma_f32_16x16x32_bf16 v[144:147], v[96:99], v[16:19], v[144:147]
    ds_read_b64_tr_b16 v[90:91], v124 offset:43264
    s_add_u32 m0, s52, 19456
    s_mov_b32 s73, 640
    buffer_load_dwordx4 v121, s[8:11], s73 offen lds
    v_mfma_f32_16x16x32_bf16 v[168:171], v[96:99], v[20:23], v[168:171]
    ds_read_b64_tr_b16 v[92:93], v125 offset:43008
    v_mfma_f32_16x16x32_bf16 v[148:151], v[100:103], v[16:19], v[148:151]
    ds_read_b64_tr_b16 v[94:95], v125 offset:43264
    v_mfma_f32_16x16x32_bf16 v[172:175], v[100:103], v[20:23], v[172:175]
    ds_read_b64_tr_b16 v[96:97], v124 offset:45056
    s_waitcnt lgkmcnt(8)
    v_mfma_f32_16x16x32_bf16 v[152:155], v[16:19], v[104:107], v[152:155]
    ds_read_b64_tr_b16 v[98:99], v124 offset:45312
    v_mfma_f32_16x16x32_bf16 v[176:179], v[20:23], v[104:107], v[176:179]
    ds_read_b64_tr_b16 v[100:101], v125 offset:45056
    s_add_u32 m0, s52, 20480
    s_mov_b32 s73, 14976
    buffer_load_dwordx4 v120, s[8:11], s73 offen lds
    v_mfma_f32_16x16x32_bf16 v[156:159], v[16:19], v[108:111], v[156:159]
    ds_read_b64_tr_b16 v[102:103], v125 offset:45312
    v_mfma_f32_16x16x32_bf16 v[180:183], v[20:23], v[108:111], v[180:183]
    ds_read_b64_tr_b16 v[104:105], v124 offset:47104
    v_mfma_f32_16x16x32_bf16 v[184:187], v[112:115], v[24:27], v[184:187]
    ds_read_b64_tr_b16 v[106:107], v124 offset:47360
    v_mfma_f32_16x16x32_bf16 v[188:191], v[116:119], v[24:27], v[188:191]
    ds_read_b64_tr_b16 v[108:109], v125 offset:47104
    v_mfma_f32_16x16x32_bf16 v[48:51], v[16:19], v[16:19], v[48:51]
    ds_read_b64_tr_b16 v[110:111], v125 offset:47360
    s_add_u32 m0, s52, 21504
    s_mov_b32 s73, 14976
    buffer_load_dwordx4 v121, s[8:11], s73 offen lds
    v_mfma_f32_16x16x32_bf16 v[52:55], v[20:23], v[20:23], v[52:55]
    ds_read_b64_tr_b16 v[112:113], v126 offset:43008
    v_mfma_f32_16x16x32_bf16 v[56:59], v[24:27], v[24:27], v[56:59]
    ds_read_b64_tr_b16 v[114:115], v126 offset:43264
    v_mfma_f32_16x16x32_bf16 v[60:63], v[40:43], v[16:19], v[60:63]
    ds_read_b64_tr_b16 v[116:117], v127 offset:43008
    v_mfma_f32_16x16x32_bf16 v[64:67], v[40:43], v[20:23], v[64:67]
    ds_read_b64_tr_b16 v[118:119], v127 offset:43264
    v_mfma_f32_16x16x32_bf16 v[68:71], v[40:43], v[24:27], v[68:71]
    s_add_u32 m0, s7, 79872
    s_mov_b32 s73, 640
    s_mov_b64 exec, s[54:55]
    buffer_load_dwordx4 v122, s[8:11], s73 offen lds
    s_mov_b64 exec, -1
    s_waitcnt vmcnt(8)
    s_barrier
    s_waitcnt lgkmcnt(8)
    v_mfma_f32_16x16x32_bf16 v[136:139], v[88:91], v[28:31], v[136:139]
    ds_read_b128 v[16:19], v128 offset:36864
    v_mfma_f32_16x16x32_bf16 v[160:163], v[88:91], v[32:35], v[160:163]
    ds_read_b128 v[20:23], v128 offset:38912
    v_mfma_f32_16x16x32_bf16 v[140:143], v[92:95], v[28:31], v[140:143]
    ds_read_b128 v[24:27], v130 offset:36864
    v_mfma_f32_16x16x32_bf16 v[164:167], v[92:95], v[32:35], v[164:167]
    ds_read_b64_tr_b16 v[88:89], v124 offset:0
    v_mfma_f32_16x16x32_bf16 v[144:147], v[96:99], v[28:31], v[144:147]
    ds_read_b64_tr_b16 v[90:91], v124 offset:256
    s_add_u32 m0, s51, 36864
    s_mov_b32 s73, 1032192
    buffer_load_dwordx4 v123, s[12:15], s73 offen lds
    v_mfma_f32_16x16x32_bf16 v[168:171], v[96:99], v[32:35], v[168:171]
    ds_read_b64_tr_b16 v[92:93], v125 offset:0
    v_mfma_f32_16x16x32_bf16 v[148:151], v[100:103], v[28:31], v[148:151]
    ds_read_b64_tr_b16 v[94:95], v125 offset:256
    v_mfma_f32_16x16x32_bf16 v[172:175], v[100:103], v[32:35], v[172:175]
    ds_read_b64_tr_b16 v[96:97], v124 offset:2048
    s_waitcnt lgkmcnt(8)
    v_mfma_f32_16x16x32_bf16 v[152:155], v[28:31], v[104:107], v[152:155]
    ds_read_b64_tr_b16 v[98:99], v124 offset:2304
    v_mfma_f32_16x16x32_bf16 v[176:179], v[32:35], v[104:107], v[176:179]
    ds_read_b64_tr_b16 v[100:101], v125 offset:2048
    s_add_u32 m0, s51, 38912
    s_mov_b32 s73, 1033088
    buffer_load_dwordx4 v123, s[12:15], s73 offen lds
    v_mfma_f32_16x16x32_bf16 v[156:159], v[28:31], v[108:111], v[156:159]
    ds_read_b64_tr_b16 v[102:103], v125 offset:2304
    v_mfma_f32_16x16x32_bf16 v[180:183], v[32:35], v[108:111], v[180:183]
    ds_read_b64_tr_b16 v[104:105], v124 offset:4096
    v_mfma_f32_16x16x32_bf16 v[184:187], v[112:115], v[36:39], v[184:187]
    ds_read_b64_tr_b16 v[106:107], v124 offset:4352
    v_mfma_f32_16x16x32_bf16 v[188:191], v[116:119], v[36:39], v[188:191]
    ds_read_b64_tr_b16 v[108:109], v125 offset:4096
    v_mfma_f32_16x16x32_bf16 v[48:51], v[28:31], v[28:31], v[48:51]
    ds_read_b64_tr_b16 v[110:111], v125 offset:4352
    s_add_u32 m0, s51, 40960
    s_mov_b32 s73, 1033984
    buffer_load_dwordx4 v123, s[12:15], s73 offen lds
    v_mfma_f32_16x16x32_bf16 v[52:55], v[32:35], v[32:35], v[52:55]
    ds_read_b64_tr_b16 v[112:113], v126 offset:0
    v_mfma_f32_16x16x32_bf16 v[56:59], v[36:39], v[36:39], v[56:59]
    ds_read_b64_tr_b16 v[114:115], v126 offset:256
    v_mfma_f32_16x16x32_bf16 v[60:63], v[40:43], v[28:31], v[60:63]
    ds_read_b64_tr_b16 v[116:117], v127 offset:0
    v_mfma_f32_16x16x32_bf16 v[64:67], v[40:43], v[32:35], v[64:67]
    ds_read_b64_tr_b16 v[118:119], v127 offset:256
    v_mfma_f32_16x16x32_bf16 v[68:71], v[40:43], v[36:39], v[68:71]
    s_add_u32 m0, s52, 0
    s_mov_b32 s73, 768
    buffer_load_dwordx4 v120, s[8:11], s73 offen lds
    s_waitcnt lgkmcnt(8)
    v_mfma_f32_16x16x32_bf16 v[136:139], v[88:91], v[16:19], v[136:139]
    ds_read_b128 v[28:31], v129 offset:36864
    v_mfma_f32_16x16x32_bf16 v[160:163], v[88:91], v[20:23], v[160:163]
    ds_read_b128 v[32:35], v129 offset:38912
    v_mfma_f32_16x16x32_bf16 v[140:143], v[92:95], v[16:19], v[140:143]
    ds_read_b128 v[36:39], v131 offset:36864
    v_mfma_f32_16x16x32_bf16 v[164:167], v[92:95], v[20:23], v[164:167]
    ds_read_b64_tr_b16 v[88:89], v124 offset:6144
    v_mfma_f32_16x16x32_bf16 v[144:147], v[96:99], v[16:19], v[144:147]
    ds_read_b64_tr_b16 v[90:91], v124 offset:6400
    s_add_u32 m0, s52, 1024
    s_mov_b32 s73, 768
    buffer_load_dwordx4 v121, s[8:11], s73 offen lds
    v_mfma_f32_16x16x32_bf16 v[168:171], v[96:99], v[20:23], v[168:171]
    ds_read_b64_tr_b16 v[92:93], v125 offset:6144
    v_mfma_f32_16x16x32_bf16 v[148:151], v[100:103], v[16:19], v[148:151]
    ds_read_b64_tr_b16 v[94:95], v125 offset:6400
    v_mfma_f32_16x16x32_bf16 v[172:175], v[100:103], v[20:23], v[172:175]
    ds_read_b64_tr_b16 v[96:97], v124 offset:8192
    s_waitcnt lgkmcnt(8)
    v_mfma_f32_16x16x32_bf16 v[152:155], v[16:19], v[104:107], v[152:155]
    ds_read_b64_tr_b16 v[98:99], v124 offset:8448
    v_mfma_f32_16x16x32_bf16 v[176:179], v[20:23], v[104:107], v[176:179]
    ds_read_b64_tr_b16 v[100:101], v125 offset:8192
    s_add_u32 m0, s52, 2048
    s_mov_b32 s73, 15104
    buffer_load_dwordx4 v120, s[8:11], s73 offen lds
    v_mfma_f32_16x16x32_bf16 v[156:159], v[16:19], v[108:111], v[156:159]
    ds_read_b64_tr_b16 v[102:103], v125 offset:8448
    v_mfma_f32_16x16x32_bf16 v[180:183], v[20:23], v[108:111], v[180:183]
    ds_read_b64_tr_b16 v[104:105], v124 offset:10240
    v_mfma_f32_16x16x32_bf16 v[184:187], v[112:115], v[24:27], v[184:187]
    ds_read_b64_tr_b16 v[106:107], v124 offset:10496
    v_mfma_f32_16x16x32_bf16 v[188:191], v[116:119], v[24:27], v[188:191]
    ds_read_b64_tr_b16 v[108:109], v125 offset:10240
    v_mfma_f32_16x16x32_bf16 v[48:51], v[16:19], v[16:19], v[48:51]
    ds_read_b64_tr_b16 v[110:111], v125 offset:10496
    s_add_u32 m0, s52, 3072
    s_mov_b32 s73, 15104
    buffer_load_dwordx4 v121, s[8:11], s73 offen lds
    v_mfma_f32_16x16x32_bf16 v[52:55], v[20:23], v[20:23], v[52:55]
    ds_read_b64_tr_b16 v[112:113], v126 offset:6144
    v_mfma_f32_16x16x32_bf16 v[56:59], v[24:27], v[24:27], v[56:59]
    ds_read_b64_tr_b16 v[114:115], v126 offset:6400
    v_mfma_f32_16x16x32_bf16 v[60:63], v[40:43], v[16:19], v[60:63]
    ds_read_b64_tr_b16 v[116:117], v127 offset:6144
    v_mfma_f32_16x16x32_bf16 v[64:67], v[40:43], v[20:23], v[64:67]
    ds_read_b64_tr_b16 v[118:119], v127 offset:6400
    v_mfma_f32_16x16x32_bf16 v[68:71], v[40:43], v[24:27], v[68:71]
    s_add_u32 m0, s7, 61440
    s_mov_b32 s73, 768
    s_mov_b64 exec, s[54:55]
    buffer_load_dwordx4 v122, s[8:11], s73 offen lds
    s_mov_b64 exec, -1
    v_mov_b32 v7, 0
    buffer_load_dword v6, v7, s[44:47], 0 offen sc1
    s_lshr_b32 s68, s2, 3
    s_lshl_b32 s68, s68, 2
    s_add_u32 s68, s68, s3
    v_lshlrev_b32 v219, 7, v1
    s_mul_i32 s86, s68, 3200
    s_mov_b64 exec, 0x1ffffff
    buffer_load_dword v234, v219, s[16:19], s86 offen
    s_mov_b64 exec, -1
    v_lshrrev_b32 v219, 2, v1
    v_mul_u32_u24 v219, 3584, v219
    v_and_b32 v220, 3, v1
    v_lshl_add_u32 v219, v220, 7, v219
    s_mul_i32 s68, s68, 57344
    s_and_b32 s69, s2, 7
    s_mul_i32 s86, s69, 3
    s_add_u32 s86, s86, 4
    s_lshl_b32 s87, s69, 2
    s_min_u32 s86, s86, s87
    s_lshl_b32 s86, s86, 7
    s_add_u32 s86, s86, s68
    s_cmp_lt_u32 s69, 4
    s_cselect_b32 exec_lo, -1, 0x77777777
    s_cselect_b32 exec_hi, -1, 0x77777777
    buffer_load_dword v235, v219, s[20:23], s86 offen
    s_mov_b64 exec, -1
    s_waitcnt vmcnt(11)
    s_barrier
    s_waitcnt lgkmcnt(8)
    v_mfma_f32_16x16x32_bf16 v[136:139], v[88:91], v[28:31], v[136:139]
    ds_read_b128 v[16:19], v128 offset:18432
    v_mfma_f32_16x16x32_bf16 v[160:163], v[88:91], v[32:35], v[160:163]
    ds_read_b128 v[20:23], v128 offset:20480
    v_mfma_f32_16x16x32_bf16 v[140:143], v[92:95], v[28:31], v[140:143]
    ds_read_b128 v[24:27], v130 offset:18432
    v_mfma_f32_16x16x32_bf16 v[164:167], v[92:95], v[32:35], v[164:167]
    ds_read_b64_tr_b16 v[88:89], v124 offset:12288
    v_mfma_f32_16x16x32_bf16 v[144:147], v[96:99], v[28:31], v[144:147]
    ds_read_b64_tr_b16 v[90:91], v124 offset:12544
    v_mfma_f32_16x16x32_bf16 v[168:171], v[96:99], v[32:35], v[168:171]
    ds_read_b64_tr_b16 v[92:93], v125 offset:12288
    v_mfma_f32_16x16x32_bf16 v[148:151], v[100:103], v[28:31], v[148:151]
    ds_read_b64_tr_b16 v[94:95], v125 offset:12544
    v_mfma_f32_16x16x32_bf16 v[172:175], v[100:103], v[32:35], v[172:175]
    ds_read_b64_tr_b16 v[96:97], v124 offset:14336
    s_waitcnt lgkmcnt(8)
    v_mfma_f32_16x16x32_bf16 v[152:155], v[28:31], v[104:107], v[152:155]
    ds_read_b64_tr_b16 v[98:99], v124 offset:14592
    v_mfma_f32_16x16x32_bf16 v[176:179], v[32:35], v[104:107], v[176:179]
    ds_read_b64_tr_b16 v[100:101], v125 offset:14336
    v_mfma_f32_16x16x32_bf16 v[156:159], v[28:31], v[108:111], v[156:159]
    ds_read_b64_tr_b16 v[102:103], v125 offset:14592
    v_mfma_f32_16x16x32_bf16 v[180:183], v[32:35], v[108:111], v[180:183]
    ds_read_b64_tr_b16 v[104:105], v124 offset:16384
    v_mfma_f32_16x16x32_bf16 v[184:187], v[112:115], v[36:39], v[184:187]
    ds_read_b64_tr_b16 v[106:107], v124 offset:16640
    v_mfma_f32_16x16x32_bf16 v[188:191], v[116:119], v[36:39], v[188:191]
    ds_read_b64_tr_b16 v[108:109], v125 offset:16384
    v_mfma_f32_16x16x32_bf16 v[48:51], v[28:31], v[28:31], v[48:51]
    ds_read_b64_tr_b16 v[110:111], v125 offset:16640
    v_mfma_f32_16x16x32_bf16 v[52:55], v[32:35], v[32:35], v[52:55]
    ds_read_b64_tr_b16 v[112:113], v126 offset:12288
    v_mfma_f32_16x16x32_bf16 v[56:59], v[36:39], v[36:39], v[56:59]
    ds_read_b64_tr_b16 v[114:115], v126 offset:12544
    v_mfma_f32_16x16x32_bf16 v[60:63], v[40:43], v[28:31], v[60:63]
    ds_read_b64_tr_b16 v[116:117], v127 offset:12288
    v_mfma_f32_16x16x32_bf16 v[64:67], v[40:43], v[32:35], v[64:67]
    ds_read_b64_tr_b16 v[118:119], v127 offset:12544
    v_mfma_f32_16x16x32_bf16 v[68:71], v[40:43], v[36:39], v[68:71]
    s_waitcnt lgkmcnt(8)
    v_mfma_f32_16x16x32_bf16 v[136:139], v[88:91], v[16:19], v[136:139]
    ds_read_b128 v[28:31], v129 offset:18432
    v_mfma_f32_16x16x32_bf16 v[160:163], v[88:91], v[20:23], v[160:163]
    ds_read_b128 v[32:35], v129 offset:20480
    v_mfma_f32_16x16x32_bf16 v[140:143], v[92:95], v[16:19], v[140:143]
    ds_read_b128 v[36:39], v131 offset:18432
    v_mfma_f32_16x16x32_bf16 v[164:167], v[92:95], v[20:23], v[164:167]
    ds_read_b64_tr_b16 v[88:89], v124 offset:18432
    v_mfma_f32_16x16x32_bf16 v[144:147], v[96:99], v[16:19], v[144:147]
    ds_read_b64_tr_b16 v[90:91], v124 offset:18688
    v_mfma_f32_16x16x32_bf16 v[168:171], v[96:99], v[20:23], v[168:171]
    ds_read_b64_tr_b16 v[92:93], v125 offset:18432
    v_mfma_f32_16x16x32_bf16 v[148:151], v[100:103], v[16:19], v[148:151]
    ds_read_b64_tr_b16 v[94:95], v125 offset:18688
    v_mfma_f32_16x16x32_bf16 v[172:175], v[100:103], v[20:23], v[172:175]
    ds_read_b64_tr_b16 v[96:97], v124 offset:20480
    s_waitcnt lgkmcnt(8)
    v_mfma_f32_16x16x32_bf16 v[152:155], v[16:19], v[104:107], v[152:155]
    ds_read_b64_tr_b16 v[98:99], v124 offset:20736
    v_mfma_f32_16x16x32_bf16 v[176:179], v[20:23], v[104:107], v[176:179]
    ds_read_b64_tr_b16 v[100:101], v125 offset:20480
    v_mfma_f32_16x16x32_bf16 v[156:159], v[16:19], v[108:111], v[156:159]
    ds_read_b64_tr_b16 v[102:103], v125 offset:20736
    v_mfma_f32_16x16x32_bf16 v[180:183], v[20:23], v[108:111], v[180:183]
    ds_read_b64_tr_b16 v[104:105], v124 offset:22528
    v_mfma_f32_16x16x32_bf16 v[184:187], v[112:115], v[24:27], v[184:187]
    ds_read_b64_tr_b16 v[106:107], v124 offset:22784
    v_mfma_f32_16x16x32_bf16 v[188:191], v[116:119], v[24:27], v[188:191]
    ds_read_b64_tr_b16 v[108:109], v125 offset:22528
    v_mfma_f32_16x16x32_bf16 v[48:51], v[16:19], v[16:19], v[48:51]
    ds_read_b64_tr_b16 v[110:111], v125 offset:22784
    v_mfma_f32_16x16x32_bf16 v[52:55], v[20:23], v[20:23], v[52:55]
    ds_read_b64_tr_b16 v[112:113], v126 offset:18432
    v_mfma_f32_16x16x32_bf16 v[56:59], v[24:27], v[24:27], v[56:59]
    ds_read_b64_tr_b16 v[114:115], v126 offset:18688
    v_mfma_f32_16x16x32_bf16 v[60:63], v[40:43], v[16:19], v[60:63]
    ds_read_b64_tr_b16 v[116:117], v127 offset:18432
    v_mfma_f32_16x16x32_bf16 v[64:67], v[40:43], v[20:23], v[64:67]
    ds_read_b64_tr_b16 v[118:119], v127 offset:18688
    v_mfma_f32_16x16x32_bf16 v[68:71], v[40:43], v[24:27], v[68:71]
    s_waitcnt vmcnt(3)
    s_barrier
    s_waitcnt lgkmcnt(8)
    v_mfma_f32_16x16x32_bf16 v[136:139], v[88:91], v[28:31], v[136:139]
    ds_read_b128 v[16:19], v128 offset:0
    v_mfma_f32_16x16x32_bf16 v[160:163], v[88:91], v[32:35], v[160:163]
    ds_read_b128 v[20:23], v128 offset:2048
    v_mfma_f32_16x16x32_bf16 v[140:143], v[92:95], v[28:31], v[140:143]
    ds_read_b128 v[24:27], v130 offset:0
    v_mfma_f32_16x16x32_bf16 v[164:167], v[92:95], v[32:35], v[164:167]
    ds_read_b64_tr_b16 v[88:89], v124 offset:24576
    v_mfma_f32_16x16x32_bf16 v[144:147], v[96:99], v[28:31], v[144:147]
    ds_read_b64_tr_b16 v[90:91], v124 offset:24832
    v_mfma_f32_16x16x32_bf16 v[168:171], v[96:99], v[32:35], v[168:171]
    ds_read_b64_tr_b16 v[92:93], v125 offset:24576
    v_mfma_f32_16x16x32_bf16 v[148:151], v[100:103], v[28:31], v[148:151]
    ds_read_b64_tr_b16 v[94:95], v125 offset:24832
    v_mfma_f32_16x16x32_bf16 v[172:175], v[100:103], v[32:35], v[172:175]
    ds_read_b64_tr_b16 v[96:97], v124 offset:26624
    s_waitcnt lgkmcnt(8)
    v_mfma_f32_16x16x32_bf16 v[152:155], v[28:31], v[104:107], v[152:155]
    ds_read_b64_tr_b16 v[98:99], v124 offset:26880
    v_mfma_f32_16x16x32_bf16 v[176:179], v[32:35], v[104:107], v[176:179]
    ds_read_b64_tr_b16 v[100:101], v125 offset:26624
    v_mfma_f32_16x16x32_bf16 v[156:159], v[28:31], v[108:111], v[156:159]
    ds_read_b64_tr_b16 v[102:103], v125 offset:26880
    v_mfma_f32_16x16x32_bf16 v[180:183], v[32:35], v[108:111], v[180:183]
    ds_read_b64_tr_b16 v[104:105], v124 offset:28672
    v_mfma_f32_16x16x32_bf16 v[184:187], v[112:115], v[36:39], v[184:187]
    ds_read_b64_tr_b16 v[106:107], v124 offset:28928
    v_mfma_f32_16x16x32_bf16 v[188:191], v[116:119], v[36:39], v[188:191]
    ds_read_b64_tr_b16 v[108:109], v125 offset:28672
    v_mfma_f32_16x16x32_bf16 v[48:51], v[28:31], v[28:31], v[48:51]
    ds_read_b64_tr_b16 v[110:111], v125 offset:28928
    v_mfma_f32_16x16x32_bf16 v[52:55], v[32:35], v[32:35], v[52:55]
    ds_read_b64_tr_b16 v[112:113], v126 offset:24576
    v_mfma_f32_16x16x32_bf16 v[56:59], v[36:39], v[36:39], v[56:59]
    ds_read_b64_tr_b16 v[114:115], v126 offset:24832
    v_mfma_f32_16x16x32_bf16 v[60:63], v[40:43], v[28:31], v[60:63]
    ds_read_b64_tr_b16 v[116:117], v127 offset:24576
    v_mfma_f32_16x16x32_bf16 v[64:67], v[40:43], v[32:35], v[64:67]
    ds_read_b64_tr_b16 v[118:119], v127 offset:24832
    v_mfma_f32_16x16x32_bf16 v[68:71], v[40:43], v[36:39], v[68:71]
    s_waitcnt lgkmcnt(8)
    v_mfma_f32_16x16x32_bf16 v[136:139], v[88:91], v[16:19], v[136:139]
    ds_read_b128 v[28:31], v129 offset:0
    v_mfma_f32_16x16x32_bf16 v[160:163], v[88:91], v[20:23], v[160:163]
    ds_read_b128 v[32:35], v129 offset:2048
    v_mfma_f32_16x16x32_bf16 v[140:143], v[92:95], v[16:19], v[140:143]
    ds_read_b128 v[36:39], v131 offset:0
    v_mfma_f32_16x16x32_bf16 v[164:167], v[92:95], v[20:23], v[164:167]
    ds_read_b64_tr_b16 v[88:89], v124 offset:30720
    v_mfma_f32_16x16x32_bf16 v[144:147], v[96:99], v[16:19], v[144:147]
    ds_read_b64_tr_b16 v[90:91], v124 offset:30976
    v_mfma_f32_16x16x32_bf16 v[168:171], v[96:99], v[20:23], v[168:171]
    ds_read_b64_tr_b16 v[92:93], v125 offset:30720
    v_mfma_f32_16x16x32_bf16 v[148:151], v[100:103], v[16:19], v[148:151]
    ds_read_b64_tr_b16 v[94:95], v125 offset:30976
    v_mfma_f32_16x16x32_bf16 v[172:175], v[100:103], v[20:23], v[172:175]
    ds_read_b64_tr_b16 v[96:97], v124 offset:32768
    s_waitcnt lgkmcnt(8)
    v_mfma_f32_16x16x32_bf16 v[152:155], v[16:19], v[104:107], v[152:155]
    ds_read_b64_tr_b16 v[98:99], v124 offset:33024
    v_mfma_f32_16x16x32_bf16 v[176:179], v[20:23], v[104:107], v[176:179]
    ds_read_b64_tr_b16 v[100:101], v125 offset:32768
    v_mfma_f32_16x16x32_bf16 v[156:159], v[16:19], v[108:111], v[156:159]
    ds_read_b64_tr_b16 v[102:103], v125 offset:33024
    v_mfma_f32_16x16x32_bf16 v[180:183], v[20:23], v[108:111], v[180:183]
    ds_read_b64_tr_b16 v[104:105], v124 offset:34816
    v_mfma_f32_16x16x32_bf16 v[184:187], v[112:115], v[24:27], v[184:187]
    ds_read_b64_tr_b16 v[106:107], v124 offset:35072
    v_mfma_f32_16x16x32_bf16 v[188:191], v[116:119], v[24:27], v[188:191]
    ds_read_b64_tr_b16 v[108:109], v125 offset:34816
    v_mfma_f32_16x16x32_bf16 v[48:51], v[16:19], v[16:19], v[48:51]
    ds_read_b64_tr_b16 v[110:111], v125 offset:35072
    v_mfma_f32_16x16x32_bf16 v[52:55], v[20:23], v[20:23], v[52:55]
    ds_read_b64_tr_b16 v[112:113], v126 offset:30720
    v_mfma_f32_16x16x32_bf16 v[56:59], v[24:27], v[24:27], v[56:59]
    ds_read_b64_tr_b16 v[114:115], v126 offset:30976
    v_mfma_f32_16x16x32_bf16 v[60:63], v[40:43], v[16:19], v[60:63]
    ds_read_b64_tr_b16 v[116:117], v127 offset:30720
    v_mfma_f32_16x16x32_bf16 v[64:67], v[40:43], v[20:23], v[64:67]
    ds_read_b64_tr_b16 v[118:119], v127 offset:30976
    v_mfma_f32_16x16x32_bf16 v[68:71], v[40:43], v[24:27], v[68:71]
    s_waitcnt lgkmcnt(9)
    v_mfma_f32_16x16x32_bf16 v[48:51], v[28:31], v[28:31], v[48:51]
    v_mfma_f32_16x16x32_bf16 v[52:55], v[32:35], v[32:35], v[52:55]
    v_mfma_f32_16x16x32_bf16 v[56:59], v[36:39], v[36:39], v[56:59]
    v_mfma_f32_16x16x32_bf16 v[60:63], v[40:43], v[28:31], v[60:63]
    v_mfma_f32_16x16x32_bf16 v[64:67], v[40:43], v[32:35], v[64:67]
    v_mfma_f32_16x16x32_bf16 v[68:71], v[40:43], v[36:39], v[68:71]
    s_waitcnt lgkmcnt(2)
    v_mfma_f32_16x16x32_bf16 v[184:187], v[112:115], v[36:39], v[184:187]
    s_waitcnt lgkmcnt(0)
    v_mfma_f32_16x16x32_bf16 v[188:191], v[116:119], v[36:39], v[188:191]
    v_mfma_f32_16x16x32_bf16 v[144:147], v[96:99], v[28:31], v[144:147]
    v_cndmask_b32 v48, v48, v49, s[88:89]
    v_cndmask_b32 v52, v52, v53, s[88:89]
    v_cndmask_b32 v56, v56, v57, s[88:89]
    v_mfma_f32_16x16x32_bf16 v[168:171], v[96:99], v[32:35], v[168:171]
    v_cndmask_b32 v48, v48, v50, s[90:91]
    v_cndmask_b32 v52, v52, v54, s[90:91]
    v_cndmask_b32 v56, v56, v58, s[90:91]
    v_mfma_f32_16x16x32_bf16 v[148:151], v[100:103], v[28:31], v[148:151]
    v_cndmask_b32 v48, v48, v51, s[92:93]
    v_cndmask_b32 v52, v52, v55, s[92:93]
    v_cndmask_b32 v56, v56, v59, s[92:93]
    v_mfma_f32_16x16x32_bf16 v[172:175], v[100:103], v[32:35], v[172:175]
    v_mul_f32 v133, 0x3b124925, v60
    v_mul_f32 v135, 0x3b124925, v64
    v_mul_f32 v85, 0x3b124925, v68
    v_mfma_f32_16x16x32_bf16 v[152:155], v[28:31], v[104:107], v[152:155]
    v_mul_f32 v132, v133, v133
    v_mul_f32 v134, v135, v135
    v_mul_f32 v84, v85, v85
    v_mfma_f32_16x16x32_bf16 v[176:179], v[32:35], v[104:107], v[176:179]
    v_mul_f32 v48, 0x3b124925, v48
    v_mul_f32 v52, 0x3b124925, v52
    v_mul_f32 v56, 0x3b124925, v56
    v_mfma_f32_16x16x32_bf16 v[156:159], v[28:31], v[108:111], v[156:159]
    s_mov_b32 exec_lo, 0x00010001
    s_mov_b32 exec_hi, 0x00010001
    ds_write_b128 v73, v[184:187] offset:128
    ds_write_b128 v74, v[188:191] offset:0
    s_mov_b64 exec, -1
    v_sub_f32 v132, v48, v132
    v_sub_f32 v134, v52, v134
    v_mfma_f32_16x16x32_bf16 v[180:183], v[32:35], v[108:111], v[180:183]
    v_sub_f32 v84, v56, v84
    v_max_f32 v132, 0, v132
    v_max_f32 v134, 0, v134
    v_mfma_f32_16x16x32_bf16 v[136:139], v[88:91], v[28:31], v[136:139]
    v_max_f32 v84, 0, v84
    v_add_f32 v132, 0x3727c5ac, v132
    v_add_f32 v134, 0x3727c5ac, v134
    v_mfma_f32_16x16x32_bf16 v[160:163], v[88:91], v[32:35], v[160:163]
    v_add_f32 v84, 0x3727c5ac, v84
    v_rsq_f32 v132, v132
    v_rsq_f32 v134, v134
    v_mfma_f32_16x16x32_bf16 v[140:143], v[92:95], v[28:31], v[140:143]
    v_rsq_f32 v84, v84
    s_mov_b32 exec_lo, 0x00f0000f
    s_mov_b32 exec_hi, 0xf0000f00
    ds_write2_b32 v75, v132, v133 offset0:128 offset1:144
    ds_write2_b32 v75, v134, v135 offset0:160 offset1:176
    ds_write2_b32 v75, v84, v85 offset0:192 offset1:208
    s_mov_b64 exec, -1
    v_mov_b32_dpp v224, v184 row_newbcast:0 row_mask:0xf bank_mask:0xf
    v_mfma_f32_16x16x32_bf16 v[164:167], v[92:95], v[32:35], v[164:167]
    v_mov_b32_dpp v225, v185 row_newbcast:0 row_mask:0xf bank_mask:0xf
    v_mov_b32_dpp v226, v186 row_newbcast:0 row_mask:0xf bank_mask:0xf
    v_mov_b32_dpp v227, v187 row_newbcast:0 row_mask:0xf bank_mask:0xf
    v_fma_f32 v224, -v224, v85, v184
    v_fma_f32 v225, -v225, v85, v185
    v_fma_f32 v226, -v226, v85, v186
    v_fma_f32 v227, -v227, v85, v187
    s_cmp_eq_u32 s49, 15
    s_cselect_b32 s88, 0xffff0000, -1
    s_mov_b32 s89, -1
    s_mov_b32 s90, -1
    s_cselect_b32 s91, -1, 0xffff
    s_waitcnt lgkmcnt(0)
    s_barrier
    ds_read_b32 v134, v75 offset:640
    ds_read_b32 v84, v75 offset:768
    ds_read_b32 v132, v75 offset:512
    ds_read_b128 v[56:59], v72 offset:128
    ds_read_b128 v[60:63], v72 offset:192
    ds_read_b32 v64, v77 offset:256
    ds_read_b32 v65, v77 offset:320
    ds_read_b128 v[44:47], v76 offset:704
    ds_read_b128 v[40:43], v76 offset:640
    ds_read_b128 v[36:39], v76 offset:576
    ds_read_b128 v[32:35], v76 offset:512
    ds_read_b128 v[48:51], v72 offset:0
    ds_read_b128 v[52:55], v72 offset:64
    s_waitcnt lgkmcnt(9)
    v_pk_fma_f32 v[168:169], v[56:57], v[134:135], v[168:169] op_sel:[0,1,0] op_sel_hi:[1,1,1] neg_lo:[0,1,0] neg_hi:[0,1,0]
    v_pk_fma_f32 v[170:171], v[58:59], v[134:135], v[170:171] op_sel:[0,1,0] op_sel_hi:[1,1,1] neg_lo:[0,1,0] neg_hi:[0,1,0]
    v_pk_mul_f32 v[168:169], v[168:169], v[134:135] op_sel:[0,0] op_sel_hi:[1,0]
    v_pk_mul_f32 v[170:171], v[170:171], v[134:135] op_sel:[0,0] op_sel_hi:[1,0]
    v_cvt_pk_bf16_f32 v104, v168, v169
    v_cvt_pk_bf16_f32 v105, v170, v171
    s_waitcnt lgkmcnt(8)
    v_pk_fma_f32 v[172:173], v[60:61], v[134:135], v[172:173] op_sel:[0,1,0] op_sel_hi:[1,1,1] neg_lo:[0,1,0] neg_hi:[0,1,0]
    v_pk_fma_f32 v[174:175], v[62:63], v[134:135], v[174:175] op_sel:[0,1,0] op_sel_hi:[1,1,1] neg_lo:[0,1,0] neg_hi:[0,1,0]
    v_pk_mul_f32 v[172:173], v[172:173], v[134:135] op_sel:[0,0] op_sel_hi:[1,0]
    v_pk_mul_f32 v[174:175], v[174:175], v[134:135] op_sel:[0,0] op_sel_hi:[1,0]
    v_cvt_pk_bf16_f32 v106, v172, v173
    v_cvt_pk_bf16_f32 v107, v174, v175
    ds_write_b128 v78, v[104:107] offset:4096
    v_pk_mul_f32 v[224:225], v[224:225], v[84:85] op_sel_hi:[1,0]
    v_pk_mul_f32 v[226:227], v[226:227], v[84:85] op_sel_hi:[1,0]
    v_cvt_pk_bf16_f32 v224, v224, v225
    v_cvt_pk_bf16_f32 v226, v226, v227
    ds_write_b16 v80, v224 offset:2048
    ds_write_b16_d16_hi v81, v224 offset:2048
    ds_write_b16 v82, v226 offset:2048
    ds_write_b16_d16_hi v83, v226 offset:2048
    s_waitcnt lgkmcnt(10)
    v_pk_fma_f32 v[176:177], v[44:45], v[64:65], v[176:177] op_sel:[0,0,0] op_sel_hi:[1,0,1] neg_lo:[0,1,0] neg_hi:[0,1,0]
    v_pk_fma_f32 v[178:179], v[46:47], v[64:65], v[178:179] op_sel:[0,0,0] op_sel_hi:[1,0,1] neg_lo:[0,1,0] neg_hi:[0,1,0]
    s_waitcnt lgkmcnt(9)
    v_pk_mul_f32 v[176:177], v[176:177], v[40:41]
    v_pk_mul_f32 v[178:179], v[178:179], v[42:43]
    v_cvt_pk_bf16_f32 v112, v176, v177
    v_cvt_pk_bf16_f32 v113, v178, v179
    v_pk_fma_f32 v[180:181], v[44:45], v[64:65], v[180:181] op_sel:[0,1,0] op_sel_hi:[1,1,1] neg_lo:[0,1,0] neg_hi:[0,1,0]
    v_pk_fma_f32 v[182:183], v[46:47], v[64:65], v[182:183] op_sel:[0,1,0] op_sel_hi:[1,1,1] neg_lo:[0,1,0] neg_hi:[0,1,0]
    v_pk_mul_f32 v[180:181], v[180:181], v[40:41]
    v_pk_mul_f32 v[182:183], v[182:183], v[42:43]
    v_cvt_pk_bf16_f32 v118, v180, v181
    v_cvt_pk_bf16_f32 v119, v182, v183
    ds_write_b64 v78, v[112:113] offset:5120
    ds_write_b64 v78, v[118:119] offset:5128
    v_mul_f32 v68, 0x3e8b97f6, v132
    v_mul_f32 v70, 0x3e8b97f6, v134
    v_cndmask_b32 v69, 0, v68, s[90:91]
    v_cndmask_b32 v68, 0, v68, s[88:89]
    v_cndmask_b32 v71, 0, v70, s[90:91]
    v_cndmask_b32 v70, 0, v70, s[88:89]
    v_pk_fma_f32 v[144:145], v[56:57], v[132:133], v[144:145] op_sel:[0,1,0] op_sel_hi:[1,1,1] neg_lo:[0,1,0] neg_hi:[0,1,0]
    v_pk_fma_f32 v[146:147], v[58:59], v[132:133], v[146:147] op_sel:[0,1,0] op_sel_hi:[1,1,1] neg_lo:[0,1,0] neg_hi:[0,1,0]
    v_pk_mul_f32 v[144:145], v[144:145], v[132:133] op_sel:[0,0] op_sel_hi:[1,0]
    v_pk_mul_f32 v[146:147], v[146:147], v[132:133] op_sel:[0,0] op_sel_hi:[1,0]
    v_cvt_pk_bf16_f32 v100, v144, v145
    v_cvt_pk_bf16_f32 v101, v146, v147
    v_pk_fma_f32 v[148:149], v[60:61], v[132:133], v[148:149] op_sel:[0,1,0] op_sel_hi:[1,1,1] neg_lo:[0,1,0] neg_hi:[0,1,0]
    v_pk_fma_f32 v[150:151], v[62:63], v[132:133], v[150:151] op_sel:[0,1,0] op_sel_hi:[1,1,1] neg_lo:[0,1,0] neg_hi:[0,1,0]
    v_pk_mul_f32 v[148:149], v[148:149], v[132:133] op_sel:[0,0] op_sel_hi:[1,0]
    v_pk_mul_f32 v[150:151], v[150:151], v[132:133] op_sel:[0,0] op_sel_hi:[1,0]
    v_cvt_pk_bf16_f32 v102, v148, v149
    v_cvt_pk_bf16_f32 v103, v150, v151
    s_waitcnt lgkmcnt(0)
    s_barrier
    ds_read_b128 v[96:99], v78 offset:2048
    ds_read_b64 v[108:109], v78 offset:3072
    ds_read_b64 v[114:115], v78 offset:3080
    v_pk_fma_f32 v[160:161], v[48:49], v[134:135], v[160:161] op_sel:[0,1,0] op_sel_hi:[1,1,1] neg_lo:[0,1,0] neg_hi:[0,1,0]
    v_pk_fma_f32 v[162:163], v[50:51], v[134:135], v[162:163] op_sel:[0,1,0] op_sel_hi:[1,1,1] neg_lo:[0,1,0] neg_hi:[0,1,0]
    v_pk_mul_f32 v[160:161], v[160:161], v[70:71] op_sel:[0,0] op_sel_hi:[1,0]
    v_pk_mul_f32 v[162:163], v[162:163], v[70:71] op_sel:[0,0] op_sel_hi:[1,0]
    v_cvt_pk_bf16_f32 v92, v160, v161
    v_cvt_pk_bf16_f32 v93, v162, v163
    v_pk_fma_f32 v[164:165], v[52:53], v[134:135], v[164:165] op_sel:[0,1,0] op_sel_hi:[1,1,1] neg_lo:[0,1,0] neg_hi:[0,1,0]
    v_pk_fma_f32 v[166:167], v[54:55], v[134:135], v[166:167] op_sel:[0,1,0] op_sel_hi:[1,1,1] neg_lo:[0,1,0] neg_hi:[0,1,0]
    v_pk_mul_f32 v[164:165], v[164:165], v[70:71] op_sel:[0,1] op_sel_hi:[1,1]
    v_pk_mul_f32 v[166:167], v[166:167], v[70:71] op_sel:[0,1] op_sel_hi:[1,1]
    v_cvt_pk_bf16_f32 v94, v164, v165
    v_cvt_pk_bf16_f32 v95, v166, v167
    s_nop 1
    v_mfma_f32_16x16x32_bf16 v[24:27], v[100:103], v[92:95], v[240:243]
    v_mfma_f32_16x16x32_bf16 v[28:31], v[104:107], v[92:95], v[244:247]
    v_pk_fma_f32 v[136:137], v[48:49], v[132:133], v[136:137] op_sel:[0,1,0] op_sel_hi:[1,1,1] neg_lo:[0,1,0] neg_hi:[0,1,0]
    v_pk_fma_f32 v[138:139], v[50:51], v[132:133], v[138:139] op_sel:[0,1,0] op_sel_hi:[1,1,1] neg_lo:[0,1,0] neg_hi:[0,1,0]
    v_pk_mul_f32 v[136:137], v[136:137], v[68:69] op_sel:[0,0] op_sel_hi:[1,0]
    v_pk_mul_f32 v[138:139], v[138:139], v[68:69] op_sel:[0,0] op_sel_hi:[1,0]
    v_cvt_pk_bf16_f32 v88, v136, v137
    v_cvt_pk_bf16_f32 v89, v138, v139
    v_pk_fma_f32 v[140:141], v[52:53], v[132:133], v[140:141] op_sel:[0,1,0] op_sel_hi:[1,1,1] neg_lo:[0,1,0] neg_hi:[0,1,0]
    v_pk_fma_f32 v[142:143], v[54:55], v[132:133], v[142:143] op_sel:[0,1,0] op_sel_hi:[1,1,1] neg_lo:[0,1,0] neg_hi:[0,1,0]
    v_pk_mul_f32 v[140:141], v[140:141], v[68:69] op_sel:[0,1] op_sel_hi:[1,1]
    v_pk_mul_f32 v[142:143], v[142:143], v[68:69] op_sel:[0,1] op_sel_hi:[1,1]
    v_cvt_pk_bf16_f32 v90, v140, v141
    v_cvt_pk_bf16_f32 v91, v142, v143
    s_waitcnt lgkmcnt(2)
    s_nop 0
    v_mfma_f32_16x16x32_bf16 v[16:19], v[96:99], v[88:91], v[248:251]
    v_mfma_f32_16x16x32_bf16 v[20:23], v[100:103], v[88:91], v[244:247]
    v_pk_fma_f32 v[152:153], v[36:37], v[64:65], v[152:153] op_sel:[0,0,0] op_sel_hi:[1,0,1] neg_lo:[0,1,0] neg_hi:[0,1,0]
    v_pk_fma_f32 v[154:155], v[38:39], v[64:65], v[154:155] op_sel:[0,0,0] op_sel_hi:[1,0,1] neg_lo:[0,1,0] neg_hi:[0,1,0]
    v_pk_mul_f32 v[152:153], v[152:153], v[32:33]
    v_pk_mul_f32 v[154:155], v[154:155], v[34:35]
    v_cvt_pk_bf16_f32 v110, v152, v153
    v_cvt_pk_bf16_f32 v111, v154, v155
    v_pk_fma_f32 v[156:157], v[36:37], v[64:65], v[156:157] op_sel:[0,1,0] op_sel_hi:[1,1,1] neg_lo:[0,1,0] neg_hi:[0,1,0]
    v_pk_fma_f32 v[158:159], v[38:39], v[64:65], v[158:159] op_sel:[0,1,0] op_sel_hi:[1,1,1] neg_lo:[0,1,0] neg_hi:[0,1,0]
    v_pk_mul_f32 v[156:157], v[156:157], v[32:33]
    v_pk_mul_f32 v[158:159], v[158:159], v[34:35]
    v_cvt_pk_bf16_f32 v116, v156, v157
    v_cvt_pk_bf16_f32 v117, v158, v159
    v_max3_f32 v137, v24, v25, v26
    v_max3_f32 v139, v27, v28, v29
    v_max3_f32 v137, v137, v30, v31
    v_max_f32 v137, v137, v139
    v_max3_f32 v136, v16, v17, v18
    v_max3_f32 v138, v19, v20, v21
    v_max3_f32 v136, v136, v22, v23
    v_max_f32 v136, v136, v138
    v_mov_b32 v138, v136
    v_mov_b32 v139, v137
    s_nop 0
    v_permlane32_swap_b32 v136, v138
    v_permlane32_swap_b32 v137, v139
    v_max_f32 v136, v136, v138
    v_max_f32 v137, v137, v139
    v_mov_b32 v138, v136
    v_mov_b32 v139, v137
    s_nop 0
    v_permlane16_swap_b32 v136, v138
    v_permlane16_swap_b32 v137, v139
    v_max_f32 v136, v136, v138
    v_max_f32 v137, v137, v139
    v_pk_add_f32 v[24:25], v[24:25], v[136:137] op_sel:[0,1] op_sel_hi:[1,1] neg_lo:[0,1] neg_hi:[0,1]
    v_pk_add_f32 v[26:27], v[26:27], v[136:137] op_sel:[0,1] op_sel_hi:[1,1] neg_lo:[0,1] neg_hi:[0,1]
    v_pk_add_f32 v[28:29], v[28:29], v[136:137] op_sel:[0,1] op_sel_hi:[1,1] neg_lo:[0,1] neg_hi:[0,1]
    v_pk_add_f32 v[30:31], v[30:31], v[136:137] op_sel:[0,1] op_sel_hi:[1,1] neg_lo:[0,1] neg_hi:[0,1]
    v_exp_f32 v24, v24
    v_exp_f32 v25, v25
    v_exp_f32 v26, v26
    v_exp_f32 v27, v27
    v_exp_f32 v28, v28
    v_exp_f32 v29, v29
    v_exp_f32 v30, v30
    v_exp_f32 v31, v31
    v_cvt_pk_bf16_f32 v148, v24, v25
    v_cvt_pk_bf16_f32 v149, v26, v27
    v_cvt_pk_bf16_f32 v150, v28, v29
    v_cvt_pk_bf16_f32 v151, v30, v31
    s_nop 1
    v_mfma_f32_16x16x32_bf16 v[160:163], v[110:113], v[148:151], 0
    v_mfma_f32_16x16x32_bf16 v[164:167], v[116:119], v[148:151], 0
    v_pk_add_f32 v[16:17], v[16:17], v[136:137] op_sel:[0,0] op_sel_hi:[1,0] neg_lo:[0,1] neg_hi:[0,1]
    v_pk_add_f32 v[18:19], v[18:19], v[136:137] op_sel:[0,0] op_sel_hi:[1,0] neg_lo:[0,1] neg_hi:[0,1]
    v_pk_add_f32 v[20:21], v[20:21], v[136:137] op_sel:[0,0] op_sel_hi:[1,0] neg_lo:[0,1] neg_hi:[0,1]
    v_pk_add_f32 v[22:23], v[22:23], v[136:137] op_sel:[0,0] op_sel_hi:[1,0] neg_lo:[0,1] neg_hi:[0,1]
    v_exp_f32 v16, v16
    v_exp_f32 v17, v17
    v_exp_f32 v18, v18
    v_exp_f32 v19, v19
    v_exp_f32 v20, v20
    v_exp_f32 v21, v21
    v_exp_f32 v22, v22
    v_exp_f32 v23, v23
    v_cvt_pk_bf16_f32 v144, v16, v17
    v_cvt_pk_bf16_f32 v145, v18, v19
    v_cvt_pk_bf16_f32 v146, v20, v21
    v_cvt_pk_bf16_f32 v147, v22, v23
    s_waitcnt lgkmcnt(1)
    s_nop 0
    v_mfma_f32_16x16x32_bf16 v[152:155], v[108:111], v[144:147], 0
    s_waitcnt lgkmcnt(0)
    v_mfma_f32_16x16x32_bf16 v[156:159], v[114:117], v[144:147], 0
    v_pk_add_f32 v[16:17], v[16:17], v[18:19]
    v_pk_add_f32 v[20:21], v[20:21], v[22:23]
    v_pk_add_f32 v[24:25], v[24:25], v[26:27]
    v_pk_add_f32 v[28:29], v[28:29], v[30:31]
    v_pk_add_f32 v[16:17], v[16:17], v[20:21]
    v_pk_add_f32 v[24:25], v[24:25], v[28:29]
    v_add_f32 v140, v16, v17
    v_add_f32 v142, v24, v25
    v_mov_b32 v138, v140
    v_mov_b32 v139, v142
    s_nop 0
    v_permlane32_swap_b32 v140, v138
    v_permlane32_swap_b32 v142, v139
    v_add_f32 v140, v140, v138
    v_add_f32 v142, v142, v139
    v_mov_b32 v138, v140
    v_mov_b32 v139, v142
    s_nop 0
    v_permlane16_swap_b32 v140, v138
    v_permlane16_swap_b32 v142, v139
    v_add_f32 v140, v140, v138
    v_add_f32 v142, v142, v139
    v_rcp_f32 v140, v140
    v_rcp_f32 v142, v142
    v_cndmask_b32 v141, 0, v140, s[90:91]
    v_cndmask_b32 v140, 0, v140, s[88:89]
    v_cndmask_b32 v143, 0, v142, s[90:91]
    v_cndmask_b32 v142, 0, v142, s[88:89]
    v_pk_mul_f32 v[152:153], v[152:153], v[140:141] op_sel_hi:[1,0]
    v_pk_mul_f32 v[154:155], v[154:155], v[140:141] op_sel_hi:[1,0]
    v_pk_mul_f32 v[156:157], v[156:157], v[140:141] op_sel:[0,1] op_sel_hi:[1,1]
    v_pk_mul_f32 v[158:159], v[158:159], v[140:141] op_sel:[0,1] op_sel_hi:[1,1]
    v_cvt_pk_bf16_f32 v144, v152, v153
    v_cvt_pk_bf16_f32 v145, v154, v155
    v_cvt_pk_bf16_f32 v146, v156, v157
    v_cvt_pk_bf16_f32 v147, v158, v159
    buffer_store_dwordx4 v[144:147], v4, s[40:43], s62 offen sc1
    v_pk_mul_f32 v[160:161], v[160:161], v[142:143] op_sel_hi:[1,0]
    v_pk_mul_f32 v[162:163], v[162:163], v[142:143] op_sel_hi:[1,0]
    v_pk_mul_f32 v[164:165], v[164:165], v[142:143] op_sel:[0,1] op_sel_hi:[1,1]
    v_pk_mul_f32 v[166:167], v[166:167], v[142:143] op_sel:[0,1] op_sel_hi:[1,1]
    v_cvt_pk_bf16_f32 v148, v160, v161
    v_cvt_pk_bf16_f32 v149, v162, v163
    v_cvt_pk_bf16_f32 v150, v164, v165
    v_cvt_pk_bf16_f32 v151, v166, v167
    buffer_store_dwordx4 v[148:151], v4, s[40:43], s63 offen sc1
    s_add_u32 m0, s59, 0
    s_mov_b32 s73, 0
    buffer_load_dwordx4 v208, s[16:19], s73 offen lds
    s_add_u32 m0, s59, 1024
    s_mov_b32 s73, 7168
    buffer_load_dwordx4 v208, s[16:19], s73 offen lds
    s_add_u32 m0, s59, 2048
    s_mov_b32 s73, 14336
    buffer_load_dwordx4 v208, s[16:19], s73 offen lds
    s_add_u32 m0, s59, 3072
    s_mov_b32 s73, 21504
    buffer_load_dwordx4 v208, s[16:19], s73 offen lds
    s_add_u32 m0, s59, 4096
    s_mov_b32 s73, 28672
    buffer_load_dwordx4 v208, s[16:19], s73 offen lds
    s_add_u32 m0, s59, 5120
    s_mov_b32 s73, 35840
    buffer_load_dwordx4 v208, s[16:19], s73 offen lds
    s_add_u32 m0, s59, 6144
    s_mov_b32 s73, 43008
    buffer_load_dwordx4 v208, s[16:19], s73 offen lds
    s_add_u32 m0, s59, 7168
    s_mov_b32 s73, 50176
    buffer_load_dwordx4 v208, s[16:19], s73 offen lds
    s_add_u32 m0, s59, 8192
    s_mov_b32 s73, 57344
    buffer_load_dwordx4 v208, s[16:19], s73 offen lds
    s_add_u32 m0, s59, 9216
    s_mov_b32 s73, 64512
    buffer_load_dwordx4 v208, s[16:19], s73 offen lds
    s_add_u32 m0, s59, 10240
    s_mov_b32 s73, 71680
    buffer_load_dwordx4 v208, s[16:19], s73 offen lds
    s_add_u32 m0, s59, 11264
    s_mov_b32 s73, 78848
    buffer_load_dwordx4 v208, s[16:19], s73 offen lds
    s_add_u32 m0, s59, 12288
    s_mov_b32 s73, 86016
    buffer_load_dwordx4 v208, s[16:19], s73 offen lds
    s_add_u32 m0, s59, 13312
    s_mov_b32 s73, 93184
    buffer_load_dwordx4 v208, s[16:19], s73 offen lds
    s_waitcnt vmcnt(18)
    v_readfirstlane_b32 s4, v6
    s_nop 1
    s_cmp_lg_u32 s4, 0
    s_cbranch_scc1 Lepd_P_2
    s_nop 0
Lepg_P_1:
    s_sub_u32 s6, s6, 1
    s_cbranch_scc1 L_end_P
    buffer_load_dword v6, v7, s[44:47], 0 offen sc1
    s_waitcnt vmcnt(0)
    v_readfirstlane_b32 s4, v6
    s_nop 1
    s_cmp_eq_u32 s4, 0
    s_cbranch_scc1 Lepg_P_1
Lepd_P_2:
    s_waitcnt vmcnt(14)
    v_mov_b32 v8, s4
    s_mov_b64 exec, 1
    buffer_store_dword v8, v9, s[40:43], s80 offen sc1
    s_mov_b64 exec, -1
    s_cmp_lt_u32 s67, 99
    s_cbranch_scc1 Lnotag_P_3
    s_lshr_b32 s68, s2, 3
    s_sub_u32 s68, s68, 28
    s_lshl_b32 s68, s68, 2
    s_add_u32 s68, s68, s3
    s_lshl_b32 s68, s68, 16
    s_and_b32 s69, s2, 7
    s_lshl_b32 s69, s69, 9
    s_add_u32 s68, s68, s69
    v_lshrrev_b32 v16, 2, v1
    v_lshlrev_b32 v16, 12, v16
    v_and_b32 v17, 3, v1
    v_lshl_add_u32 v16, v17, 7, v16
    buffer_load_dword v18, v16, s[24:27], s68 offen
    s_add_u32 s68, s68, 0x100000
    s_waitcnt vmcnt(3)
    buffer_load_dword v19, v16, s[24:27], s68 offen
    s_add_u32 s68, s68, 0x100000
    s_waitcnt vmcnt(3)
    buffer_load_dword v20, v16, s[24:27], s68 offen
    s_add_u32 s68, s68, 0x100000
    s_waitcnt vmcnt(3)
    buffer_load_dword v21, v16, s[24:27], s68 offen
    s_add_u32 s68, s68, 0x100000
    s_waitcnt vmcnt(3)
    buffer_load_dword v22, v16, s[24:27], s68 offen
    s_add_u32 s68, s68, 0x100000
    s_waitcnt vmcnt(3)
    buffer_load_dword v23, v16, s[24:27], s68 offen
    s_add_u32 s68, s68, 0x100000
    s_waitcnt vmcnt(3)
    buffer_load_dword v24, v16, s[24:27], s68 offen
    s_add_u32 s68, s68, 0x100000
    s_waitcnt vmcnt(3)
    s_waitcnt vmcnt(0)
    s_branch L_end_P
Lnotag_P_3:
    v_lshrrev_b32 v221, 5, v1
    v_mul_u32_u24 v221, 3584, v221
    v_and_b32 v222, 31, v1
    v_lshl_add_u32 v221, v222, 1, v221
    s_lshl_b32 s58, s67, 1
    s_lshr_b32 s60, s3, 1
    s_add_u32 s58, s58, s60
    s_mul_i32 s58, s58, 28672
    s_lshl_b32 s60, s66, 7
    s_add_u32 s58, s58, s60
    s_and_b32 s60, s3, 1
    s_lshl_b32 s60, s60, 6
    s_add_u32 s58, s58, s60
    buffer_load_ushort v192, v221, s[8:11], s58 offen offset:0
    buffer_load_ushort v193, v221, s[8:11], s58 offen offset:896
    buffer_load_ushort v194, v221, s[8:11], s58 offen offset:1792
    buffer_load_ushort v195, v221, s[8:11], s58 offen offset:2688
    s_add_u32 s58, s58, 7168
    buffer_load_ushort v196, v221, s[8:11], s58 offen offset:0
    buffer_load_ushort v197, v221, s[8:11], s58 offen offset:896
    buffer_load_ushort v198, v221, s[8:11], s58 offen offset:1792
    buffer_load_ushort v199, v221, s[8:11], s58 offen offset:2688
    s_add_u32 s58, s58, 7168
    buffer_load_ushort v200, v221, s[8:11], s58 offen offset:0
    buffer_load_ushort v201, v221, s[8:11], s58 offen offset:896
    buffer_load_ushort v202, v221, s[8:11], s58 offen offset:1792
    buffer_load_ushort v203, v221, s[8:11], s58 offen offset:2688
    s_add_u32 s58, s58, 7168
    buffer_load_ushort v204, v221, s[8:11], s58 offen offset:0
    buffer_load_ushort v205, v221, s[8:11], s58 offen offset:896
    buffer_load_ushort v206, v221, s[8:11], s58 offen offset:1792
    buffer_load_ushort v207, v221, s[8:11], s58 offen offset:2688
    s_and_b32 s68, s2, 7
    s_cmp_ge_u32 s68, 7
    s_cselect_b32 s48, 7, 0
    s_sub_u32 s68, s68, s48
    s_lshl_b32 s48, s68, 12
    s_add_u32 s68, s68, 1
    s_cmp_ge_u32 s68, 7
    s_cselect_b32 s49, 7, 0
    s_sub_u32 s68, s68, s49
    s_lshl_b32 s49, s68, 12
    s_add_u32 s68, s68, 1
    s_cmp_ge_u32 s68, 7
    s_cselect_b32 s50, 7, 0
    s_sub_u32 s68, s68, s50
    s_lshl_b32 s50, s68, 12
    s_add_u32 s68, s68, 1
    s_cmp_ge_u32 s68, 7
    s_cselect_b32 s51, 7, 0
    s_sub_u32 s68, s68, s51
    s_lshl_b32 s51, s68, 12
    s_add_u32 s68, s68, 1
    s_cmp_ge_u32 s68, 7
    s_cselect_b32 s52, 7, 0
    s_sub_u32 s68, s68, s52
    s_lshl_b32 s52, s68, 12
    s_add_u32 s68, s68, 1
    s_cmp_ge_u32 s68, 7
    s_cselect_b32 s53, 7, 0
    s_sub_u32 s68, s68, s53
    s_lshl_b32 s53, s68, 12
    s_add_u32 s68, s68, 1
    s_cmp_ge_u32 s68, 7
    s_cselect_b32 s54, 7, 0
    s_sub_u32 s68, s68, s54
    s_lshl_b32 s54, s68, 12
    s_waitcnt vmcnt(17)
    s_barrier
    ds_read_b64_tr_b16 a[0:1], v209 offset:0
    ds_read_b64_tr_b16 a[2:3], v209 offset:2048
    ds_read_b64_tr_b16 a[4:5], v209 offset:1024
    ds_read_b64_tr_b16 a[6:7], v209 offset:3072
    ds_read_b64_tr_b16 a[8:9], v209 offset:3584
    ds_read_b64_tr_b16 a[10:11], v209 offset:5632
    ds_read_b64_tr_b16 a[12:13], v209 offset:4608
    ds_read_b64_tr_b16 a[14:15], v209 offset:6656
    ds_read_b64_tr_b16 a[16:17], v209 offset:7168
    ds_read_b64_tr_b16 a[18:19], v209 offset:9216
    ds_read_b64_tr_b16 a[20:21], v209 offset:8192
    ds_read_b64_tr_b16 a[22:23], v209 offset:10240
    ds_read_b64_tr_b16 a[24:25], v209 offset:10752
    ds_read_b64_tr_b16 a[26:27], v209 offset:12800
    ds_read_b64_tr_b16 a[28:29], v209 offset:11776
    ds_read_b64_tr_b16 a[30:31], v209 offset:13824
    ds_read_b64_tr_b16 a[32:33], v209 offset:14336
    ds_read_b64_tr_b16 a[34:35], v209 offset:16384
    ds_read_b64_tr_b16 a[36:37], v209 offset:15360
    ds_read_b64_tr_b16 a[38:39], v209 offset:17408
    ds_read_b64_tr_b16 a[40:41], v209 offset:17920
    ds_read_b64_tr_b16 a[42:43], v209 offset:19968
    ds_read_b64_tr_b16 a[44:45], v209 offset:18944
    ds_read_b64_tr_b16 a[46:47], v209 offset:20992
    ds_read_b64_tr_b16 a[48:49], v209 offset:21504
    ds_read_b64_tr_b16 a[50:51], v209 offset:23552
    ds_read_b64_tr_b16 a[52:53], v209 offset:22528
    ds_read_b64_tr_b16 a[54:55], v209 offset:24576
    ds_read_b64_tr_b16 a[56:57], v209 offset:25088
    ds_read_b64_tr_b16 a[58:59], v209 offset:27136
    ds_read_b64_tr_b16 a[60:61], v209 offset:26112
    ds_read_b64_tr_b16 a[62:63], v209 offset:28160
    ds_read_b64_tr_b16 a[64:65], v209 offset:28672
    ds_read_b64_tr_b16 a[66:67], v209 offset:30720
    ds_read_b64_tr_b16 a[68:69], v209 offset:29696
    ds_read_b64_tr_b16 a[70:71], v209 offset:31744
    ds_read_b64_tr_b16 a[72:73], v209 offset:32256
    ds_read_b64_tr_b16 a[74:75], v209 offset:34304
    ds_read_b64_tr_b16 a[76:77], v209 offset:33280
    ds_read_b64_tr_b16 a[78:79], v209 offset:35328
    ds_read_b64_tr_b16 a[80:81], v209 offset:35840
    ds_read_b64_tr_b16 a[82:83], v209 offset:37888
    ds_read_b64_tr_b16 a[84:85], v209 offset:36864
    ds_read_b64_tr_b16 a[86:87], v209 offset:38912
    ds_read_b64_tr_b16 a[88:89], v209 offset:39424
    ds_read_b64_tr_b16 a[90:91], v209 offset:41472
    ds_read_b64_tr_b16 a[92:93], v209 offset:40448
    ds_read_b64_tr_b16 a[94:95], v209 offset:42496
    ds_read_b64_tr_b16 a[96:97], v209 offset:43008
    ds_read_b64_tr_b16 a[98:99], v209 offset:45056
    ds_read_b64_tr_b16 a[100:101], v209 offset:44032
    ds_read_b64_tr_b16 a[102:103], v209 offset:46080
    ds_read_b64_tr_b16 a[104:105], v209 offset:46592
    ds_read_b64_tr_b16 a[106:107], v209 offset:48640
    ds_read_b64_tr_b16 a[108:109], v209 offset:47616
    ds_read_b64_tr_b16 a[110:111], v209 offset:49664
    ds_read_b64_tr_b16 a[112:113], v209 offset:50176
    ds_read_b64_tr_b16 a[114:115], v209 offset:52224
    ds_read_b64_tr_b16 a[116:117], v209 offset:51200
    ds_read_b64_tr_b16 a[118:119], v209 offset:53248
    ds_read_b64_tr_b16 a[120:121], v209 offset:53248
    ds_read_b64_tr_b16 a[122:123], v209 offset:55296
    ds_read_b64_tr_b16 a[124:125], v209 offset:54272
    ds_read_b64_tr_b16 a[126:127], v209 offset:56320
    s_waitcnt lgkmcnt(0)
    s_barrier
    s_add_u32 m0, s70, 16384
    s_mul_i32 s73, s94, 56
    s_add_u32 s73, s73, 0
    buffer_load_dwordx4 v213, s[20:23], s73 offen lds
    s_add_u32 m0, s70, 17408
    s_mul_i32 s73, s94, 56
    s_add_u32 s73, s73, 28672
    buffer_load_dwordx4 v213, s[20:23], s73 offen lds
    s_add_u32 m0, s70, 18432
    s_mul_i32 s73, s94, 56
    s_add_u32 s73, s73, 57344
    buffer_load_dwordx4 v213, s[20:23], s73 offen lds
    s_add_u32 m0, s70, 19456
    s_mul_i32 s73, s94, 56
    s_add_u32 s73, s73, 86016
    buffer_load_dwordx4 v213, s[20:23], s73 offen lds
    s_add_u32 m0, s70, 20480
    s_mul_i32 s73, s94, 56
    s_add_u32 s73, s73, 114688
    buffer_load_dwordx4 v213, s[20:23], s73 offen lds
    s_add_u32 m0, s70, 21504
    s_mul_i32 s73, s94, 56
    s_add_u32 s73, s73, 143360
    buffer_load_dwordx4 v213, s[20:23], s73 offen lds
    s_add_u32 m0, s70, 22528
    s_mul_i32 s73, s94, 56
    s_add_u32 s73, s73, 172032
    buffer_load_dwordx4 v213, s[20:23], s73 offen lds
    s_add_u32 m0, s70, 23552
    s_mul_i32 s73, s94, 56
    s_add_u32 s73, s73, 200704
    buffer_load_dwordx4 v213, s[20:23], s73 offen lds
    s_add_u32 m0, s70, 24576
    s_mul_i32 s73, s95, 56
    s_add_u32 s73, s73, 0
    buffer_load_dwordx4 v213, s[20:23], s73 offen lds
    s_add_u32 m0, s70, 25600
    s_mul_i32 s73, s95, 56
    s_add_u32 s73, s73, 28672
    buffer_load_dwordx4 v213, s[20:23], s73 offen lds
    s_add_u32 m0, s70, 26624
    s_mul_i32 s73, s95, 56
    s_add_u32 s73, s73, 57344
    buffer_load_dwordx4 v213, s[20:23], s73 offen lds
    s_add_u32 m0, s70, 27648
    s_mul_i32 s73, s95, 56
    s_add_u32 s73, s73, 86016
    buffer_load_dwordx4 v213, s[20:23], s73 offen lds
    s_add_u32 m0, s70, 28672
    s_mul_i32 s73, s95, 56
    s_add_u32 s73, s73, 114688
    buffer_load_dwordx4 v213, s[20:23], s73 offen lds
    s_add_u32 m0, s70, 29696
    s_mul_i32 s73, s95, 56
    s_add_u32 s73, s73, 143360
    buffer_load_dwordx4 v213, s[20:23], s73 offen lds
    s_add_u32 m0, s70, 30720
    s_mul_i32 s73, s95, 56
    s_add_u32 s73, s73, 172032
    buffer_load_dwordx4 v213, s[20:23], s73 offen lds
    s_add_u32 m0, s70, 31744
    s_mul_i32 s73, s95, 56
    s_add_u32 s73, s73, 200704
    buffer_load_dwordx4 v213, s[20:23], s73 offen lds
    s_add_u32 m0, s70, 32768
    s_mul_i32 s73, s96, 56
    s_add_u32 s73, s73, 0
    buffer_load_dwordx4 v213, s[20:23], s73 offen lds
    s_add_u32 m0, s70, 33792
    s_mul_i32 s73, s96, 56
    s_add_u32 s73, s73, 28672
    buffer_load_dwordx4 v213, s[20:23], s73 offen lds
    s_add_u32 m0, s70, 34816
    s_mul_i32 s73, s96, 56
    s_add_u32 s73, s73, 57344
    buffer_load_dwordx4 v213, s[20:23], s73 offen lds
    s_add_u32 m0, s70, 35840
    s_mul_i32 s73, s96, 56
    s_add_u32 s73, s73, 86016
    buffer_load_dwordx4 v213, s[20:23], s73 offen lds
    buffer_load_dword v249, v10, s[40:43], s83 offen sc1
    s_sleep 3
    buffer_load_dword v250, v10, s[40:43], s83 offen sc1
    s_sleep 3
    s_nop 0
Lpoll_P_4:
    s_sub_u32 s6, s6, 1
    s_cbranch_scc1 L_end_P
    buffer_load_dword v251, v10, s[40:43], s83 offen sc1
    s_waitcnt vmcnt(2)
    v_cmp_ne_u32 vcc, s4, v249
    s_nop 1
    s_cbranch_vccz Lpd_P_5
    buffer_load_dword v249, v10, s[40:43], s83 offen sc1
    s_waitcnt vmcnt(2)
    v_cmp_ne_u32 vcc, s4, v250
    s_nop 1
    s_cbranch_vccz Lpd_P_5
    buffer_load_dword v250, v10, s[40:43], s83 offen sc1
    s_waitcnt vmcnt(2)
    v_cmp_ne_u32 vcc, s4, v251
    s_nop 1
    s_cbranch_vccnz Lpoll_P_4
    s_nop 1
Lpd_P_5:
    s_lshl_b32 s58, s67, 16
    s_lshl_b32 s60, s3, 14
    s_add_u32 s58, s58, s60
    s_add_u32 m0, s70, 0
    s_nop 0
    buffer_load_dwordx4 v4, s[40:43], s58 offen offset:0 sc1 lds
    buffer_load_dwordx4 v4, s[40:43], s58 offen offset:1024 sc1 lds
    buffer_load_dwordx4 v4, s[40:43], s58 offen offset:2048 sc1 lds
    buffer_load_dwordx4 v4, s[40:43], s58 offen offset:3072 sc1 lds
    s_add_u32 m0, s70, 4096
    s_add_u32 s58, s58, 4096
    buffer_load_dwordx4 v4, s[40:43], s58 offen offset:0 sc1 lds
    buffer_load_dwordx4 v4, s[40:43], s58 offen offset:1024 sc1 lds
    buffer_load_dwordx4 v4, s[40:43], s58 offen offset:2048 sc1 lds
    buffer_load_dwordx4 v4, s[40:43], s58 offen offset:3072 sc1 lds
    s_add_u32 m0, s70, 8192
    s_add_u32 s58, s58, 4096
    buffer_load_dwordx4 v4, s[40:43], s58 offen offset:0 sc1 lds
    buffer_load_dwordx4 v4, s[40:43], s58 offen offset:1024 sc1 lds
    buffer_load_dwordx4 v4, s[40:43], s58 offen offset:2048 sc1 lds
    buffer_load_dwordx4 v4, s[40:43], s58 offen offset:3072 sc1 lds
    s_add_u32 m0, s70, 12288
    s_add_u32 s58, s58, 4096
    buffer_load_dwordx4 v4, s[40:43], s58 offen offset:0 sc1 lds
    buffer_load_dwordx4 v4, s[40:43], s58 offen offset:1024 sc1 lds
    buffer_load_dwordx4 v4, s[40:43], s58 offen offset:2048 sc1 lds
    buffer_load_dwordx4 v4, s[40:43], s58 offen offset:3072 sc1 lds
    v_and_b32 v64, 1, v3
    v_mul_u32_u24 v64, 36864, v64
    v_lshl_add_u32 v64, v2, 4, v64
    v_lshrrev_b32 v65, 5, v1
    v_lshl_add_u32 v64, v65, 8, v64
    s_lshr_b32 s60, s3, 1
    s_mul_i32 s60, s60, 73728
    s_add_u32 s60, s60, 12288
    v_add_u32 v64, s60, v64
    ds_read_b64_tr_b16 a[128:129], v215 offset:16384
    ds_read_b64_tr_b16 a[130:131], v215 offset:17408
    ds_read_b64_tr_b16 a[132:133], v216 offset:16384
    ds_read_b64_tr_b16 a[134:135], v216 offset:17408
    ds_read_b64_tr_b16 a[136:137], v215 offset:18432
    ds_read_b64_tr_b16 a[138:139], v215 offset:19456
    ds_read_b64_tr_b16 a[140:141], v216 offset:18432
    ds_read_b64_tr_b16 a[142:143], v216 offset:19456
    ds_read_b64_tr_b16 a[144:145], v215 offset:20480
    ds_read_b64_tr_b16 a[146:147], v215 offset:21504
    ds_read_b64_tr_b16 a[148:149], v216 offset:20480
    ds_read_b64_tr_b16 a[150:151], v216 offset:21504
    ds_read_b64_tr_b16 a[152:153], v215 offset:22528
    ds_read_b64_tr_b16 a[154:155], v215 offset:23552
    ds_read_b64_tr_b16 a[156:157], v216 offset:22528
    ds_read_b64_tr_b16 a[158:159], v216 offset:23552
    ds_read_b64_tr_b16 a[160:161], v215 offset:24576
    ds_read_b64_tr_b16 a[162:163], v215 offset:25600
    ds_read_b64_tr_b16 a[164:165], v216 offset:24576
    ds_read_b64_tr_b16 a[166:167], v216 offset:25600
    ds_read_b64_tr_b16 a[168:169], v215 offset:26624
    ds_read_b64_tr_b16 a[170:171], v215 offset:27648
    ds_read_b64_tr_b16 a[172:173], v216 offset:26624
    ds_read_b64_tr_b16 a[174:175], v216 offset:27648
    ds_read_b64_tr_b16 a[176:177], v215 offset:28672
    ds_read_b64_tr_b16 a[178:179], v215 offset:29696
    ds_read_b64_tr_b16 a[180:181], v216 offset:28672
    ds_read_b64_tr_b16 a[182:183], v216 offset:29696
    ds_read_b64_tr_b16 a[184:185], v215 offset:30720
    ds_read_b64_tr_b16 a[186:187], v215 offset:31744
    ds_read_b64_tr_b16 a[188:189], v216 offset:30720
    ds_read_b64_tr_b16 a[190:191], v216 offset:31744
    ds_read_b64_tr_b16 a[192:193], v215 offset:32768
    ds_read_b64_tr_b16 a[194:195], v215 offset:33792
    ds_read_b64_tr_b16 a[196:197], v216 offset:32768
    ds_read_b64_tr_b16 a[198:199], v216 offset:33792
    ds_read_b64_tr_b16 a[200:201], v215 offset:34816
    ds_read_b64_tr_b16 a[202:203], v215 offset:35840
    ds_read_b64_tr_b16 a[204:205], v216 offset:34816
    ds_read_b64_tr_b16 a[206:207], v216 offset:35840
    v_lshlrev_b32 v192, 16, v192
    v_lshlrev_b32 v193, 16, v193
    v_lshlrev_b32 v194, 16, v194
    v_lshlrev_b32 v195, 16, v195
    v_lshlrev_b32 v196, 16, v196
    v_lshlrev_b32 v197, 16, v197
    v_lshlrev_b32 v198, 16, v198
    v_lshlrev_b32 v199, 16, v199
    v_lshlrev_b32 v200, 16, v200
    v_lshlrev_b32 v201, 16, v201
    v_lshlrev_b32 v202, 16, v202
    v_lshlrev_b32 v203, 16, v203
    v_lshlrev_b32 v204, 16, v204
    v_lshlrev_b32 v205, 16, v205
    v_lshlrev_b32 v206, 16, v206
    v_lshlrev_b32 v207, 16, v207
    s_waitcnt vmcnt(8)
    s_barrier
    ds_read_b128 v[32:35], v64 offset:0
    ds_read_b128 v[36:39], v64 offset:512
    ds_read_b128 v[40:43], v64 offset:1024
    ds_read_b128 v[44:47], v64 offset:1536
    ds_read_b128 v[48:51], v64 offset:2048
    ds_read_b128 v[52:55], v64 offset:2560
    s_waitcnt lgkmcnt(5)
    v_mfma_f32_32x32x16_bf16 v[192:207], v[32:35], a[0:3], v[192:207]
    ds_read_b128 v[56:59], v64 offset:3072
    s_add_u32 m0, s70, 16384
    s_mul_i32 s73, s96, 56
    s_add_u32 s73, s73, 114688
    buffer_load_dwordx4 v213, s[20:23], s73 offen lds
    s_waitcnt lgkmcnt(5)
    v_mfma_f32_32x32x16_bf16 v[192:207], v[36:39], a[4:7], v[192:207]
    ds_read_b128 v[60:63], v64 offset:3584
    s_waitcnt lgkmcnt(5)
    v_mfma_f32_32x32x16_bf16 v[192:207], v[40:43], a[8:11], v[192:207]
    ds_read_b128 v[32:35], v64 offset:4096
    s_waitcnt lgkmcnt(5)
    v_mfma_f32_32x32x16_bf16 v[192:207], v[44:47], a[12:15], v[192:207]
    ds_read_b128 v[36:39], v64 offset:4608
    s_add_u32 m0, s70, 17408
    s_mul_i32 s73, s96, 56
    s_add_u32 s73, s73, 143360
    buffer_load_dwordx4 v213, s[20:23], s73 offen lds
    s_waitcnt lgkmcnt(5)
    v_mfma_f32_32x32x16_bf16 v[192:207], v[48:51], a[16:19], v[192:207]
    ds_read_b128 v[40:43], v64 offset:5120
    s_waitcnt lgkmcnt(5)
    v_mfma_f32_32x32x16_bf16 v[192:207], v[52:55], a[20:23], v[192:207]
    ds_read_b128 v[44:47], v64 offset:5632
    s_waitcnt lgkmcnt(5)
    v_mfma_f32_32x32x16_bf16 v[192:207], v[56:59], a[24:27], v[192:207]
    ds_read_b128 v[48:51], v64 offset:6144
    s_add_u32 m0, s70, 18432
    s_mul_i32 s73, s96, 56
    s_add_u32 s73, s73, 172032
    buffer_load_dwordx4 v213, s[20:23], s73 offen lds
    s_waitcnt lgkmcnt(5)
    v_mfma_f32_32x32x16_bf16 v[192:207], v[60:63], a[28:31], v[192:207]
    ds_read_b128 v[52:55], v64 offset:6656
    s_waitcnt lgkmcnt(5)
    v_mfma_f32_32x32x16_bf16 v[192:207], v[32:35], a[32:35], v[192:207]
    ds_read_b128 v[56:59], v64 offset:7168
    s_waitcnt lgkmcnt(5)
    v_mfma_f32_32x32x16_bf16 v[192:207], v[36:39], a[36:39], v[192:207]
    ds_read_b128 v[60:63], v64 offset:7680
    s_add_u32 m0, s70, 19456
    s_mul_i32 s73, s96, 56
    s_add_u32 s73, s73, 200704
    buffer_load_dwordx4 v213, s[20:23], s73 offen lds
    s_waitcnt lgkmcnt(5)
    v_mfma_f32_32x32x16_bf16 v[192:207], v[40:43], a[40:43], v[192:207]
    s_waitcnt lgkmcnt(4)
    v_mfma_f32_32x32x16_bf16 v[192:207], v[44:47], a[44:47], v[192:207]
    s_waitcnt vmcnt(4)
    s_barrier
    ds_read_b128 v[32:35], v64 offset:8192
    ds_read_b128 v[36:39], v64 offset:8704
    s_waitcnt lgkmcnt(5)
    v_mfma_f32_32x32x16_bf16 v[192:207], v[48:51], a[48:51], v[192:207]
    ds_read_b128 v[40:43], v64 offset:9216
    s_add_u32 m0, s70, 20480
    s_mul_i32 s73, s97, 56
    s_add_u32 s73, s73, 0
    buffer_load_dwordx4 v213, s[20:23], s73 offen lds
    s_waitcnt lgkmcnt(5)
    v_mfma_f32_32x32x16_bf16 v[192:207], v[52:55], a[52:55], v[192:207]
    ds_read_b128 v[44:47], v64 offset:9728
    s_waitcnt lgkmcnt(5)
    v_mfma_f32_32x32x16_bf16 v[192:207], v[56:59], a[56:59], v[192:207]
    ds_read_b128 v[48:51], v64 offset:10240
    s_waitcnt lgkmcnt(5)
    v_mfma_f32_32x32x16_bf16 v[192:207], v[60:63], a[60:63], v[192:207]
    ds_read_b128 v[52:55], v64 offset:10752
    s_add_u32 m0, s70, 21504
    s_mul_i32 s73, s97, 56
    s_add_u32 s73, s73, 28672
    buffer_load_dwordx4 v213, s[20:23], s73 offen lds
    s_waitcnt lgkmcnt(5)
    v_mfma_f32_32x32x16_bf16 v[192:207], v[32:35], a[64:67], v[192:207]
    ds_read_b128 v[56:59], v64 offset:11264
    s_waitcnt lgkmcnt(5)
    v_mfma_f32_32x32x16_bf16 v[192:207], v[36:39], a[68:71], v[192:207]
    ds_read_b128 v[60:63], v64 offset:11776
    s_waitcnt lgkmcnt(5)
    v_mfma_f32_32x32x16_bf16 v[192:207], v[40:43], a[72:75], v[192:207]
    ds_read_b128 v[32:35], v64 offset:12288
    s_add_u32 m0, s70, 22528
    s_mul_i32 s73, s97, 56
    s_add_u32 s73, s73, 57344
    buffer_load_dwordx4 v213, s[20:23], s73 offen lds
    s_waitcnt lgkmcnt(5)
    v_mfma_f32_32x32x16_bf16 v[192:207], v[44:47], a[76:79], v[192:207]
    ds_read_b128 v[36:39], v64 offset:12800
    s_waitcnt lgkmcnt(5)
    v_mfma_f32_32x32x16_bf16 v[192:207], v[48:51], a[80:83], v[192:207]
    ds_read_b128 v[40:43], v64 offset:13312
    s_waitcnt lgkmcnt(5)
    v_mfma_f32_32x32x16_bf16 v[192:207], v[52:55], a[84:87], v[192:207]
    ds_read_b128 v[44:47], v64 offset:13824
    s_add_u32 m0, s70, 23552
    s_mul_i32 s73, s97, 56
    s_add_u32 s73, s73, 86016
    buffer_load_dwordx4 v213, s[20:23], s73 offen lds
    s_waitcnt lgkmcnt(5)
    v_mfma_f32_32x32x16_bf16 v[192:207], v[56:59], a[88:91], v[192:207]
    ds_read_b128 v[48:51], v64 offset:14336
    s_waitcnt lgkmcnt(5)
    v_mfma_f32_32x32x16_bf16 v[192:207], v[60:63], a[92:95], v[192:207]
    ds_read_b128 v[52:55], v64 offset:14848
    s_waitcnt lgkmcnt(5)
    v_mfma_f32_32x32x16_bf16 v[192:207], v[32:35], a[96:99], v[192:207]
    ds_read_b128 v[56:59], v64 offset:15360
    s_add_u32 m0, s70, 24576
    s_mul_i32 s73, s97, 56
    s_add_u32 s73, s73, 114688
    buffer_load_dwordx4 v213, s[20:23], s73 offen lds
    s_waitcnt lgkmcnt(5)
    v_mfma_f32_32x32x16_bf16 v[192:207], v[36:39], a[100:103], v[192:207]
    ds_read_b128 v[60:63], v64 offset:15872
    s_waitcnt lgkmcnt(5)
    v_mfma_f32_32x32x16_bf16 v[192:207], v[40:43], a[104:107], v[192:207]
    s_waitcnt lgkmcnt(4)
    v_mfma_f32_32x32x16_bf16 v[192:207], v[44:47], a[108:111], v[192:207]
    s_add_u32 m0, s70, 25600
    s_mul_i32 s73, s97, 56
    s_add_u32 s73, s73, 143360
    buffer_load_dwordx4 v213, s[20:23], s73 offen lds
    s_waitcnt lgkmcnt(3)
    v_mfma_f32_32x32x16_bf16 v[192:207], v[48:51], a[112:115], v[192:207]
    s_waitcnt lgkmcnt(2)
    v_mfma_f32_32x32x16_bf16 v[192:207], v[52:55], a[116:119], v[192:207]
    s_waitcnt lgkmcnt(1)
    v_mfma_f32_32x32x16_bf16 v[192:207], v[56:59], a[120:123], v[192:207]
    s_add_u32 m0, s70, 26624
    s_mul_i32 s73, s97, 56
    s_add_u32 s73, s73, 172032
    buffer_load_dwordx4 v213, s[20:23], s73 offen lds
    s_waitcnt lgkmcnt(0)
    v_mfma_f32_32x32x16_bf16 v[192:207], v[60:63], a[124:127], v[192:207]
    s_nop 11
    v_pk_mul_f32 v[68:69], v[192:193], v[192:193]
    v_pk_mul_f32 v[70:71], v[194:195], v[194:195]
    v_pk_mul_f32 v[72:73], v[196:197], v[196:197]
    v_pk_mul_f32 v[74:75], v[198:199], v[198:199]
    v_pk_mul_f32 v[76:77], v[200:201], v[200:201]
    v_pk_mul_f32 v[78:79], v[202:203], v[202:203]
    v_pk_mul_f32 v[80:81], v[204:205], v[204:205]
    v_pk_mul_f32 v[82:83], v[206:207], v[206:207]
    s_add_u32 m0, s70, 27648
    s_mul_i32 s73, s97, 56
    s_add_u32 s73, s73, 200704
    buffer_load_dwordx4 v213, s[20:23], s73 offen lds
    v_add_f32_dpp v84, v192, v192 row_mirror row_mask:0xf bank_mask:0x3
    v_add_f32_dpp v85, v193, v193 row_mirror row_mask:0xf bank_mask:0x3
    v_add_f32_dpp v86, v196, v196 row_mirror row_mask:0xf bank_mask:0x3
    v_add_f32_dpp v87, v197, v197 row_mirror row_mask:0xf bank_mask:0x3
    v_add_f32_dpp v88, v200, v200 row_mirror row_mask:0xf bank_mask:0x3
    v_add_f32_dpp v89, v201, v201 row_mirror row_mask:0xf bank_mask:0x3
    v_add_f32_dpp v90, v204, v204 row_mirror row_mask:0xf bank_mask:0x3
    v_add_f32_dpp v91, v205, v205 row_mirror row_mask:0xf bank_mask:0x3
    s_add_u32 m0, s70, 28672
    s_mul_i32 s73, s98, 56
    s_add_u32 s73, s73, 0
    buffer_load_dwordx4 v213, s[20:23], s73 offen lds
    v_add_f32_dpp v92, v68, v68 row_mirror row_mask:0xf bank_mask:0x3
    v_add_f32_dpp v93, v69, v69 row_mirror row_mask:0xf bank_mask:0x3
    v_add_f32_dpp v94, v72, v72 row_mirror row_mask:0xf bank_mask:0x3
    v_add_f32_dpp v95, v73, v73 row_mirror row_mask:0xf bank_mask:0x3
    v_add_f32_dpp v96, v76, v76 row_mirror row_mask:0xf bank_mask:0x3
    v_add_f32_dpp v97, v77, v77 row_mirror row_mask:0xf bank_mask:0x3
    v_add_f32_dpp v98, v80, v80 row_mirror row_mask:0xf bank_mask:0x3
    v_add_f32_dpp v99, v81, v81 row_mirror row_mask:0xf bank_mask:0x3
    s_add_u32 m0, s70, 29696
    s_mul_i32 s73, s98, 56
    s_add_u32 s73, s73, 28672
    buffer_load_dwordx4 v213, s[20:23], s73 offen lds
    v_add_f32_dpp v84, v194, v194 row_mirror row_mask:0xf bank_mask:0xc
    v_add_f32_dpp v85, v195, v195 row_mirror row_mask:0xf bank_mask:0xc
    v_add_f32_dpp v86, v198, v198 row_mirror row_mask:0xf bank_mask:0xc
    v_add_f32_dpp v87, v199, v199 row_mirror row_mask:0xf bank_mask:0xc
    v_add_f32_dpp v88, v202, v202 row_mirror row_mask:0xf bank_mask:0xc
    v_add_f32_dpp v89, v203, v203 row_mirror row_mask:0xf bank_mask:0xc
    v_add_f32_dpp v90, v206, v206 row_mirror row_mask:0xf bank_mask:0xc
    v_add_f32_dpp v91, v207, v207 row_mirror row_mask:0xf bank_mask:0xc
    s_add_u32 m0, s70, 30720
    s_mul_i32 s73, s98, 56
    s_add_u32 s73, s73, 57344
    buffer_load_dwordx4 v213, s[20:23], s73 offen lds
    v_add_f32_dpp v92, v70, v70 row_mirror row_mask:0xf bank_mask:0xc
    v_add_f32_dpp v93, v71, v71 row_mirror row_mask:0xf bank_mask:0xc
    v_add_f32_dpp v94, v74, v74 row_mirror row_mask:0xf bank_mask:0xc
    v_add_f32_dpp v95, v75, v75 row_mirror row_mask:0xf bank_mask:0xc
    v_add_f32_dpp v96, v78, v78 row_mirror row_mask:0xf bank_mask:0xc
    v_add_f32_dpp v97, v79, v79 row_mirror row_mask:0xf bank_mask:0xc
    v_add_f32_dpp v98, v82, v82 row_mirror row_mask:0xf bank_mask:0xc
    v_add_f32_dpp v99, v83, v83 row_mirror row_mask:0xf bank_mask:0xc
    s_add_u32 m0, s70, 31744
    s_mul_i32 s73, s98, 56
    s_add_u32 s73, s73, 86016
    buffer_load_dwordx4 v213, s[20:23], s73 offen lds
    v_add_f32_dpp v84, v84, v84 row_half_mirror row_mask:0xf bank_mask:0x5
    v_add_f32_dpp v86, v86, v86 row_half_mirror row_mask:0xf bank_mask:0x5
    v_add_f32_dpp v88, v88, v88 row_half_mirror row_mask:0xf bank_mask:0x5
    v_add_f32_dpp v90, v90, v90 row_half_mirror row_mask:0xf bank_mask:0x5
    v_add_f32_dpp v92, v92, v92 row_half_mirror row_mask:0xf bank_mask:0x5
    v_add_f32_dpp v94, v94, v94 row_half_mirror row_mask:0xf bank_mask:0x5
    v_add_f32_dpp v96, v96, v96 row_half_mirror row_mask:0xf bank_mask:0x5
    v_add_f32_dpp v98, v98, v98 row_half_mirror row_mask:0xf bank_mask:0x5
    v_add_f32_dpp v84, v85, v85 row_half_mirror row_mask:0xf bank_mask:0xa
    v_add_f32_dpp v86, v87, v87 row_half_mirror row_mask:0xf bank_mask:0xa
    v_add_f32_dpp v88, v89, v89 row_half_mirror row_mask:0xf bank_mask:0xa
    v_add_f32_dpp v90, v91, v91 row_half_mirror row_mask:0xf bank_mask:0xa
    v_add_f32_dpp v92, v93, v93 row_half_mirror row_mask:0xf bank_mask:0xa
    v_add_f32_dpp v94, v95, v95 row_half_mirror row_mask:0xf bank_mask:0xa
    v_add_f32_dpp v96, v97, v97 row_half_mirror row_mask:0xf bank_mask:0xa
    v_add_f32_dpp v98, v99, v99 row_half_mirror row_mask:0xf bank_mask:0xa
    v_add_f32_dpp v85, v84, v84 quad_perm:[1,0,3,2] row_mask:0xf bank_mask:0xf
    v_add_f32_dpp v87, v86, v86 quad_perm:[1,0,3,2] row_mask:0xf bank_mask:0xf
    v_add_f32_dpp v89, v88, v88 quad_perm:[1,0,3,2] row_mask:0xf bank_mask:0xf
    v_add_f32_dpp v91, v90, v90 quad_perm:[1,0,3,2] row_mask:0xf bank_mask:0xf
    v_add_f32_dpp v93, v92, v92 quad_perm:[1,0,3,2] row_mask:0xf bank_mask:0xf
    v_add_f32_dpp v95, v94, v94 quad_perm:[1,0,3,2] row_mask:0xf bank_mask:0xf
    v_add_f32_dpp v97, v96, v96 quad_perm:[1,0,3,2] row_mask:0xf bank_mask:0xf
    v_add_f32_dpp v99, v98, v98 quad_perm:[1,0,3,2] row_mask:0xf bank_mask:0xf
    v_add_f32_dpp v68, v85, v85 quad_perm:[2,3,0,1] row_mask:0xf bank_mask:0xf
    v_add_f32_dpp v69, v87, v87 quad_perm:[2,3,0,1] row_mask:0xf bank_mask:0xf
    v_add_f32_dpp v70, v89, v89 quad_perm:[2,3,0,1] row_mask:0xf bank_mask:0xf
    v_add_f32_dpp v71, v91, v91 quad_perm:[2,3,0,1] row_mask:0xf bank_mask:0xf
    v_add_f32_dpp v72, v93, v93 quad_perm:[2,3,0,1] row_mask:0xf bank_mask:0xf
    v_add_f32_dpp v73, v95, v95 quad_perm:[2,3,0,1] row_mask:0xf bank_mask:0xf
    v_add_f32_dpp v74, v97, v97 quad_perm:[2,3,0,1] row_mask:0xf bank_mask:0xf
    v_add_f32_dpp v75, v99, v99 quad_perm:[2,3,0,1] row_mask:0xf bank_mask:0xf
    v_permlane16_swap_b32 v68, v69
    v_permlane16_swap_b32 v70, v71
    v_permlane16_swap_b32 v72, v73
    v_permlane16_swap_b32 v74, v75
    v_add_f32 v84, v68, v69
    v_add_f32 v85, v72, v73
    v_add_f32 v86, v70, v71
    v_add_f32 v87, v74, v75
    v_and_b32 v65, 1, v3
    v_lshlrev_b32 v65, 6, v65
    v_lshrrev_b32 v66, 5, v1
    v_lshl_add_u32 v65, v66, 5, v65
    v_bfe_u32 v67, v1, 2, 2
    v_lshl_add_u32 v65, v67, 3, v65
    s_lshl_b32 s58, s3, 8
    v_add_u32 v65, s58, v65
    ds_write_b64 v65, v[84:85] offset:0
    ds_write_b64 v65, v[86:87] offset:128
    v_and_b32 v67, 31, v1
    v_lshlrev_b32 v65, 9, v66
    v_lshl_add_u32 v65, v67, 4, v65
    v_lshlrev_b32 v66, 8, v66
    v_lshl_add_u32 v66, v67, 3, v66
    s_and_b32 s58, s58, 512
    v_add_u32 v66, s58, v66
    s_lshl_b32 s58, s67, 1
    s_lshr_b32 s60, s3, 1
    s_add_u32 s58, s58, s60
    s_lshl_b32 s58, s58, 12
    s_add_u32 s58, s58, 0x548000
    s_lshl_b32 s60, s66, 9
    s_add_u32 s60, s60, s58
    s_waitcnt lgkmcnt(0)
    s_barrier
    ds_read_b64 v[84:85], v66 offset:0
    v_mov_b32 v89, s4
    v_mov_b32 v91, s4
    s_waitcnt lgkmcnt(0)
    v_mov_b32 v88, v84
    v_mov_b32 v90, v85
    s_nop 0
    v_permlane32_swap_b32 v88, v84
    v_permlane32_swap_b32 v90, v85
    v_add_f32 v88, v88, v84
    v_add_f32 v90, v90, v85
    s_bitcmp0_b32 s3, 0
    s_cselect_b32 exec_lo, -1, 0
    s_mov_b32 exec_hi, 0
    buffer_store_dwordx4 v[88:91], v65, s[40:43], s60 offen sc1
    s_mov_b64 exec, -1
    v_cvt_pk_bf16_f32 v240, v192, v193
    v_cvt_pk_bf16_f32 v241, v194, v195
    v_cvt_pk_bf16_f32 v242, v196, v197
    v_cvt_pk_bf16_f32 v243, v198, v199
    v_cvt_pk_bf16_f32 v244, v200, v201
    v_cvt_pk_bf16_f32 v245, v202, v203
    v_cvt_pk_bf16_f32 v246, v204, v205
    v_cvt_pk_bf16_f32 v247, v206, v207
    s_lshl_b32 s61, s66, 1
    s_and_b32 s60, s3, 1
    s_add_u32 s61, s61, s60
    s_lshl_b32 s61, s61, 7
    s_lshl_b32 s60, s67, 2
    s_add_u32 s61, s61, s60
    s_and_b32 s60, s3, 2
    s_add_u32 s61, s61, s60
    s_lshl_b32 s61, s61, 10
    s_add_u32 s61, s61, 0x200000
    v_lshlrev_b32 v66, 4, v67
    v_cmp_gt_u32 s[86:87], 32, v1
    s_add_u32 m0, s70, 0
    s_mul_i32 s73, s98, 56
    s_add_u32 s73, s73, 114688
    buffer_load_dwordx4 v213, s[20:23], s73 offen lds
    s_add_u32 m0, s70, 1024
    s_mul_i32 s73, s98, 56
    s_add_u32 s73, s73, 143360
    buffer_load_dwordx4 v213, s[20:23], s73 offen lds
    s_add_u32 m0, s70, 2048
    s_mul_i32 s73, s98, 56
    s_add_u32 s73, s73, 172032
    buffer_load_dwordx4 v213, s[20:23], s73 offen lds
    s_add_u32 m0, s70, 3072
    s_mul_i32 s73, s98, 56
    s_add_u32 s73, s73, 200704
    buffer_load_dwordx4 v213, s[20:23], s73 offen lds
    s_add_u32 m0, s70, 4096
    s_mul_i32 s73, s99, 56
    s_add_u32 s73, s73, 0
    buffer_load_dwordx4 v213, s[20:23], s73 offen lds
    s_add_u32 m0, s70, 5120
    s_mul_i32 s73, s99, 56
    s_add_u32 s73, s73, 28672
    buffer_load_dwordx4 v213, s[20:23], s73 offen lds
    s_add_u32 m0, s70, 6144
    s_mul_i32 s73, s99, 56
    s_add_u32 s73, s73, 57344
    buffer_load_dwordx4 v213, s[20:23], s73 offen lds
    s_add_u32 m0, s70, 7168
    s_mul_i32 s73, s99, 56
    s_add_u32 s73, s73, 86016
    buffer_load_dwordx4 v213, s[20:23], s73 offen lds
    s_add_u32 m0, s70, 8192
    s_mul_i32 s73, s99, 56
    s_add_u32 s73, s73, 114688
    buffer_load_dwordx4 v213, s[20:23], s73 offen lds
    s_add_u32 m0, s70, 9216
    s_mul_i32 s73, s99, 56
    s_add_u32 s73, s73, 143360
    buffer_load_dwordx4 v213, s[20:23], s73 offen lds
    s_add_u32 m0, s70, 10240
    s_mul_i32 s73, s99, 56
    s_add_u32 s73, s73, 172032
    buffer_load_dwordx4 v213, s[20:23], s73 offen lds
    s_add_u32 m0, s70, 11264
    s_mul_i32 s73, s99, 56
    s_add_u32 s73, s73, 200704
    buffer_load_dwordx4 v213, s[20:23], s73 offen lds
    s_add_u32 m0, s70, 12288
    s_mul_i32 s73, s100, 56
    s_add_u32 s73, s73, 0
    buffer_load_dwordx4 v213, s[20:23], s73 offen lds
    s_add_u32 m0, s70, 13312
    s_mul_i32 s73, s100, 56
    s_add_u32 s73, s73, 28672
    buffer_load_dwordx4 v213, s[20:23], s73 offen lds
    s_add_u32 m0, s70, 14336
    s_mul_i32 s73, s100, 56
    s_add_u32 s73, s73, 57344
    buffer_load_dwordx4 v213, s[20:23], s73 offen lds
    s_add_u32 m0, s70, 15360
    s_mul_i32 s73, s100, 56
    s_add_u32 s73, s73, 86016
    buffer_load_dwordx4 v213, s[20:23], s73 offen lds
    buffer_load_dwordx4 v[96:99], v65, s[40:43], s58 offen offset:0 sc1
    buffer_load_dwordx4 v[100:103], v65, s[40:43], s58 offen offset:1024 sc1
    buffer_load_dwordx4 v[104:107], v65, s[40:43], s58 offen offset:2048 sc1
    buffer_load_dwordx4 v[108:111], v66, s[40:43], s58 offen offset:3072 sc1
    s_sleep 5
    s_nop 0
Lst_P_6:
    s_sub_u32 s6, s6, 1
    s_cbranch_scc1 L_end_P
    buffer_load_dwordx4 v[112:115], v65, s[40:43], s58 offen offset:0 sc1
    buffer_load_dwordx4 v[116:119], v65, s[40:43], s58 offen offset:1024 sc1
    buffer_load_dwordx4 v[120:123], v65, s[40:43], s58 offen offset:2048 sc1
    buffer_load_dwordx4 v[124:127], v66, s[40:43], s58 offen offset:3072 sc1
    s_waitcnt vmcnt(4)
    v_xor_b32 v97, s4, v97
    v_xor_b32 v99, s4, v99
    v_xor_b32 v101, s4, v101
    v_xor_b32 v103, s4, v103
    v_xor_b32 v105, s4, v105
    v_xor_b32 v107, s4, v107
    v_xor_b32 v109, s4, v109
    v_xor_b32 v111, s4, v111
    v_cndmask_b32 v108, 0, v108, s[86:87]
    v_cndmask_b32 v110, 0, v110, s[86:87]
    v_or3_b32 v97, v97, v99, v101
    v_or3_b32 v103, v103, v105, v107
    v_or3_b32 v97, v97, v109, v111
    v_or_b32 v97, v97, v103
    v_cmp_ne_u32 vcc, 0, v97
    v_add_f32 v128, v96, v100
    v_add_f32 v129, v104, v108
    v_add_f32 v130, v98, v102
    v_add_f32 v131, v106, v110
    s_cbranch_vccz Lstd_P_7
    buffer_load_dwordx4 v[96:99], v65, s[40:43], s58 offen offset:0 sc1
    buffer_load_dwordx4 v[100:103], v65, s[40:43], s58 offen offset:1024 sc1
    buffer_load_dwordx4 v[104:107], v65, s[40:43], s58 offen offset:2048 sc1
    buffer_load_dwordx4 v[108:111], v66, s[40:43], s58 offen offset:3072 sc1
    s_waitcnt vmcnt(4)
    v_xor_b32 v113, s4, v113
    v_xor_b32 v115, s4, v115
    v_xor_b32 v117, s4, v117
    v_xor_b32 v119, s4, v119
    v_xor_b32 v121, s4, v121
    v_xor_b32 v123, s4, v123
    v_xor_b32 v125, s4, v125
    v_xor_b32 v127, s4, v127
    v_cndmask_b32 v124, 0, v124, s[86:87]
    v_cndmask_b32 v126, 0, v126, s[86:87]
    v_or3_b32 v113, v113, v115, v117
    v_or3_b32 v119, v119, v121, v123
    v_or3_b32 v113, v113, v125, v127
    v_or_b32 v113, v113, v119
    v_cmp_ne_u32 vcc, 0, v113
    v_add_f32 v128, v112, v116
    v_add_f32 v129, v120, v124
    v_add_f32 v130, v114, v118
    v_add_f32 v131, v122, v126
    s_cbranch_vccnz Lst_P_6
    s_nop 3
Lstd_P_7:
    v_add_f32 v128, v128, v129
    v_add_f32 v130, v130, v131
    v_mov_b32 v136, v128
    v_mov_b32 v138, v130
    s_nop 0
    v_permlane32_swap_b32 v128, v136
    v_permlane32_swap_b32 v130, v138
    v_add_f32 v128, v128, v136
    v_add_f32 v130, v130, v138
    v_mul_f32 v133, 0x3b124925, v128
    v_mul_f32 v130, 0x3b124925, v130
    v_fma_f32 v130, -v133, v133, v130
    v_max_f32 v130, 0, v130
    v_add_f32 v135, 0x3727c5ac, v130
    v_rsq_f32 v135, v135
    s_nop 0
    v_mul_f32 v130, v130, v135
    v_fmaak_f32 v130, v130, v135, 0x3727c5ac
    v_rsq_f32 v130, v130
    s_nop 0
    v_mul_f32 v135, v135, v130
    s_lshl_b32 s60, s3, 8
    v_lshl_add_u32 v66, v67, 2, s60
    ds_write_b32 v66, v133 offset:1024
    ds_write_b32 v66, v135 offset:1152
    v_lshrrev_b32 v66, 5, v1
    v_lshl_add_u32 v66, v66, 4, s60
    s_waitcnt lgkmcnt(0)
    ds_read_b128 v[140:143], v66 offset:1024
    ds_read_b128 v[156:159], v66 offset:1152
    ds_read_b128 v[144:147], v66 offset:1056
    ds_read_b128 v[160:163], v66 offset:1184
    ds_read_b128 v[148:151], v66 offset:1088
    ds_read_b128 v[164:167], v66 offset:1216
    ds_read_b128 v[152:155], v66 offset:1120
    ds_read_b128 v[168:171], v66 offset:1248
    s_waitcnt lgkmcnt(7)
    v_pk_add_f32 v[192:193], v[192:193], v[140:141] neg_lo:[0,1] neg_hi:[0,1]
    v_pk_add_f32 v[194:195], v[194:195], v[142:143] neg_lo:[0,1] neg_hi:[0,1]
    s_waitcnt lgkmcnt(5)
    v_pk_add_f32 v[196:197], v[196:197], v[144:145] neg_lo:[0,1] neg_hi:[0,1]
    v_pk_add_f32 v[198:199], v[198:199], v[146:147] neg_lo:[0,1] neg_hi:[0,1]
    v_pk_mul_f32 v[192:193], v[192:193], v[156:157]
    v_pk_mul_f32 v[194:195], v[194:195], v[158:159]
    s_waitcnt lgkmcnt(4)
    v_pk_mul_f32 v[196:197], v[196:197], v[160:161]
    v_pk_mul_f32 v[198:199], v[198:199], v[162:163]
    v_cvt_pk_bf16_f32 v84, v192, v193
    v_cvt_pk_bf16_f32 v85, v194, v195
    v_cvt_pk_bf16_f32 v86, v196, v197
    v_cvt_pk_bf16_f32 v87, v198, v199
    buffer_store_dwordx4 v[84:87], v4, s[40:43], s61 offen offset:0 sc1
    s_waitcnt lgkmcnt(3)
    v_pk_add_f32 v[200:201], v[200:201], v[148:149] neg_lo:[0,1] neg_hi:[0,1]
    v_pk_add_f32 v[202:203], v[202:203], v[150:151] neg_lo:[0,1] neg_hi:[0,1]
    s_waitcnt lgkmcnt(1)
    v_pk_add_f32 v[204:205], v[204:205], v[152:153] neg_lo:[0,1] neg_hi:[0,1]
    v_pk_add_f32 v[206:207], v[206:207], v[154:155] neg_lo:[0,1] neg_hi:[0,1]
    v_pk_mul_f32 v[200:201], v[200:201], v[164:165]
    v_pk_mul_f32 v[202:203], v[202:203], v[166:167]
    s_waitcnt lgkmcnt(0)
    v_pk_mul_f32 v[204:205], v[204:205], v[168:169]
    v_pk_mul_f32 v[206:207], v[206:207], v[170:171]
    v_cvt_pk_bf16_f32 v88, v200, v201
    v_cvt_pk_bf16_f32 v89, v202, v203
    v_cvt_pk_bf16_f32 v90, v204, v205
    v_cvt_pk_bf16_f32 v91, v206, v207
    buffer_store_dwordx4 v[88:91], v4, s[40:43], s61 offen offset:1024 sc1
    ds_read_b64_tr_b16 a[208:209], v215 offset:16384
    ds_read_b64_tr_b16 a[210:211], v215 offset:17408
    ds_read_b64_tr_b16 a[212:213], v216 offset:16384
    ds_read_b64_tr_b16 a[214:215], v216 offset:17408
    ds_read_b64_tr_b16 a[216:217], v215 offset:18432
    ds_read_b64_tr_b16 a[218:219], v215 offset:19456
    ds_read_b64_tr_b16 a[220:221], v216 offset:18432
    ds_read_b64_tr_b16 a[222:223], v216 offset:19456
    ds_read_b64_tr_b16 a[224:225], v215 offset:20480
    ds_read_b64_tr_b16 a[226:227], v215 offset:21504
    ds_read_b64_tr_b16 a[228:229], v216 offset:20480
    ds_read_b64_tr_b16 a[230:231], v216 offset:21504
    ds_read_b64_tr_b16 a[232:233], v215 offset:22528
    ds_read_b64_tr_b16 a[234:235], v215 offset:23552
    ds_read_b64_tr_b16 a[236:237], v216 offset:22528
    ds_read_b64_tr_b16 a[238:239], v216 offset:23552
    ds_read_b64_tr_b16 a[240:241], v215 offset:24576
    ds_read_b64_tr_b16 a[242:243], v215 offset:25600
    ds_read_b64_tr_b16 a[244:245], v216 offset:24576
    ds_read_b64_tr_b16 a[246:247], v216 offset:25600
    ds_read_b64_tr_b16 a[248:249], v215 offset:26624
    ds_read_b64_tr_b16 a[250:251], v215 offset:27648
    ds_read_b64_tr_b16 a[252:253], v216 offset:26624
    ds_read_b64_tr_b16 a[254:255], v216 offset:27648
    ds_read_b64_tr_b16 a[0:1], v215 offset:28672
    ds_read_b64_tr_b16 a[2:3], v215 offset:29696
    ds_read_b64_tr_b16 a[4:5], v216 offset:28672
    ds_read_b64_tr_b16 a[6:7], v216 offset:29696
    ds_read_b64_tr_b16 a[8:9], v215 offset:30720
    ds_read_b64_tr_b16 a[10:11], v215 offset:31744
    ds_read_b64_tr_b16 a[12:13], v216 offset:30720
    ds_read_b64_tr_b16 a[14:15], v216 offset:31744
    ds_read_b64_tr_b16 a[16:17], v215 offset:0
    ds_read_b64_tr_b16 a[18:19], v215 offset:1024
    ds_read_b64_tr_b16 a[20:21], v216 offset:0
    ds_read_b64_tr_b16 a[22:23], v216 offset:1024
    ds_read_b64_tr_b16 a[24:25], v215 offset:2048
    ds_read_b64_tr_b16 a[26:27], v215 offset:3072
    ds_read_b64_tr_b16 a[28:29], v216 offset:2048
    ds_read_b64_tr_b16 a[30:31], v216 offset:3072
    ds_read_b64_tr_b16 a[32:33], v215 offset:4096
    ds_read_b64_tr_b16 a[34:35], v215 offset:5120
    ds_read_b64_tr_b16 a[36:37], v216 offset:4096
    ds_read_b64_tr_b16 a[38:39], v216 offset:5120
    ds_read_b64_tr_b16 a[40:41], v215 offset:6144
    ds_read_b64_tr_b16 a[42:43], v215 offset:7168
    ds_read_b64_tr_b16 a[44:45], v216 offset:6144
    ds_read_b64_tr_b16 a[46:47], v216 offset:7168
    ds_read_b64_tr_b16 a[48:49], v215 offset:8192
    ds_read_b64_tr_b16 a[50:51], v215 offset:9216
    ds_read_b64_tr_b16 a[52:53], v216 offset:8192
    ds_read_b64_tr_b16 a[54:55], v216 offset:9216
    ds_read_b64_tr_b16 a[56:57], v215 offset:10240
    ds_read_b64_tr_b16 a[58:59], v215 offset:11264
    ds_read_b64_tr_b16 a[60:61], v216 offset:10240
    ds_read_b64_tr_b16 a[62:63], v216 offset:11264
    ds_read_b64_tr_b16 a[64:65], v215 offset:12288
    ds_read_b64_tr_b16 a[66:67], v215 offset:13312
    ds_read_b64_tr_b16 a[68:69], v216 offset:12288
    ds_read_b64_tr_b16 a[70:71], v216 offset:13312
    ds_read_b64_tr_b16 a[72:73], v215 offset:14336
    ds_read_b64_tr_b16 a[74:75], v215 offset:15360
    ds_read_b64_tr_b16 a[76:77], v216 offset:14336
    ds_read_b64_tr_b16 a[78:79], v216 offset:15360
    s_waitcnt vmcnt(0)
    v_mov_b32 v8, s4
    s_mov_b64 exec, 1
    buffer_store_dword v8, v9, s[40:43], s81 offen sc1
    s_mov_b64 exec, -1
    s_waitcnt lgkmcnt(4)
    s_add_u32 m0, s70, 12288
    s_mul_i32 s73, s100, 56
    s_add_u32 s73, s73, 114688
    buffer_load_dwordx4 v213, s[20:23], s73 offen lds
    s_add_u32 m0, s70, 13312
    s_mul_i32 s73, s100, 56
    s_add_u32 s73, s73, 143360
    buffer_load_dwordx4 v213, s[20:23], s73 offen lds
    s_waitcnt lgkmcnt(0)
    s_add_u32 m0, s70, 14336
    s_mul_i32 s73, s100, 56
    s_add_u32 s73, s73, 172032
    buffer_load_dwordx4 v213, s[20:23], s73 offen lds
    s_add_u32 m0, s70, 15360
    s_mul_i32 s73, s100, 56
    s_add_u32 s73, s73, 200704
    buffer_load_dwordx4 v213, s[20:23], s73 offen lds
    s_add_u32 m0, s70, 16384
    s_mul_i32 s73, s101, 56
    s_add_u32 s73, s73, 0
    buffer_load_dwordx4 v213, s[20:23], s73 offen lds
    s_add_u32 m0, s70, 17408
    s_mul_i32 s73, s101, 56
    s_add_u32 s73, s73, 28672
    buffer_load_dwordx4 v213, s[20:23], s73 offen lds
    s_add_u32 m0, s70, 18432
    s_mul_i32 s73, s101, 56
    s_add_u32 s73, s73, 57344
    buffer_load_dwordx4 v213, s[20:23], s73 offen lds
    s_add_u32 m0, s70, 19456
    s_mul_i32 s73, s101, 56
    s_add_u32 s73, s73, 86016
    buffer_load_dwordx4 v213, s[20:23], s73 offen lds
    s_add_u32 m0, s70, 20480
    s_mul_i32 s73, s101, 56
    s_add_u32 s73, s73, 114688
    buffer_load_dwordx4 v213, s[20:23], s73 offen lds
    s_add_u32 m0, s70, 21504
    s_mul_i32 s73, s101, 56
    s_add_u32 s73, s73, 143360
    buffer_load_dwordx4 v213, s[20:23], s73 offen lds
    s_add_u32 m0, s70, 22528
    s_mul_i32 s73, s101, 56
    s_add_u32 s73, s73, 172032
    buffer_load_dwordx4 v213, s[20:23], s73 offen lds
    s_add_u32 m0, s70, 23552
    s_mul_i32 s73, s101, 56
    s_add_u32 s73, s73, 200704
    buffer_load_dwordx4 v213, s[20:23], s73 offen lds
    s_add_u32 m0, s70, 24576
    s_mul_i32 s73, s48, 64
    s_add_u32 s73, s73, 0
    buffer_load_dwordx4 v214, s[24:27], s73 offen lds
    s_add_u32 m0, s70, 25600
    s_mul_i32 s73, s48, 64
    s_add_u32 s73, s73, 32768
    buffer_load_dwordx4 v214, s[24:27], s73 offen lds
    s_add_u32 m0, s70, 26624
    s_mul_i32 s73, s48, 64
    s_add_u32 s73, s73, 65536
    buffer_load_dwordx4 v214, s[24:27], s73 offen lds
    s_add_u32 m0, s70, 27648
    s_mul_i32 s73, s48, 64
    s_add_u32 s73, s73, 98304
    buffer_load_dwordx4 v214, s[24:27], s73 offen lds
    s_add_u32 m0, s70, 28672
    s_mul_i32 s73, s48, 64
    s_add_u32 s73, s73, 131072
    buffer_load_dwordx4 v214, s[24:27], s73 offen lds
    s_add_u32 m0, s70, 29696
    s_mul_i32 s73, s48, 64
    s_add_u32 s73, s73, 163840
    buffer_load_dwordx4 v214, s[24:27], s73 offen lds
    s_add_u32 m0, s70, 30720
    s_mul_i32 s73, s48, 64
    s_add_u32 s73, s73, 196608
    buffer_load_dwordx4 v214, s[24:27], s73 offen lds
    s_add_u32 m0, s70, 31744
    s_mul_i32 s73, s48, 64
    s_add_u32 s73, s73, 229376
    buffer_load_dwordx4 v214, s[24:27], s73 offen lds
    s_add_u32 m0, s70, 32768
    s_mul_i32 s73, s49, 64
    s_add_u32 s73, s73, 0
    buffer_load_dwordx4 v214, s[24:27], s73 offen lds
    s_add_u32 m0, s70, 33792
    s_mul_i32 s73, s49, 64
    s_add_u32 s73, s73, 32768
    buffer_load_dwordx4 v214, s[24:27], s73 offen lds
    s_add_u32 m0, s70, 34816
    s_mul_i32 s73, s49, 64
    s_add_u32 s73, s73, 65536
    buffer_load_dwordx4 v214, s[24:27], s73 offen lds
    s_add_u32 m0, s70, 35840
    s_mul_i32 s73, s49, 64
    s_add_u32 s73, s73, 98304
    buffer_load_dwordx4 v214, s[24:27], s73 offen lds
    v_lshrrev_b32 v220, 5, v1
    v_lshlrev_b32 v220, 3, v220
    s_lshl_b32 s68, s65, 7
    s_lshr_b32 s69, s3, 1
    s_lshl_b32 s69, s69, 6
    s_add_u32 s68, s68, s69
    buffer_load_dwordx2 v[222:223], v220, s[28:31], s68 offen offset:0
    buffer_load_dwordx2 v[224:225], v220, s[28:31], s68 offen offset:16
    buffer_load_dwordx2 v[226:227], v220, s[28:31], s68 offen offset:32
    buffer_load_dwordx2 v[228:229], v220, s[28:31], s68 offen offset:48
    s_lshl_b32 s68, s64, 1
    s_and_b32 s69, s3, 1
    s_add_u32 s71, s68, s69
    s_xor_b32 s72, s71, 1
    s_mul_i32 s68, s3, 32768
    s_add_u32 s68, s68, 0x200000
    s_mul_i32 s71, s71, 131072
    s_add_u32 s71, s71, s68
    s_mul_i32 s72, s72, 131072
    s_add_u32 s72, s72, s68
    buffer_load_dword v249, v11, s[40:43], s84 offen sc1
    s_sleep 3
    buffer_load_dword v250, v11, s[40:43], s84 offen sc1
    s_sleep 3
    s_nop 0
Lpoll_P_8:
    s_sub_u32 s6, s6, 1
    s_cbranch_scc1 L_end_P
    buffer_load_dword v251, v11, s[40:43], s84 offen sc1
    s_waitcnt vmcnt(2)
    v_cmp_ne_u32 vcc, s4, v249
    s_nop 1
    s_cbranch_vccz Lpd_P_9
    buffer_load_dword v249, v11, s[40:43], s84 offen sc1
    s_waitcnt vmcnt(2)
    v_cmp_ne_u32 vcc, s4, v250
    s_nop 1
    s_cbranch_vccz Lpd_P_9
    buffer_load_dword v250, v11, s[40:43], s84 offen sc1
    s_waitcnt vmcnt(2)
    v_cmp_ne_u32 vcc, s4, v251
    s_nop 1
    s_cbranch_vccnz Lpoll_P_8
    s_nop 1
Lpd_P_9:
    s_add_u32 s56, s71, s94
    s_add_u32 s57, s72, s94
    buffer_load_dwordx4 v[80:83], v5, s[40:43], s56 offen offset:0 sc1
    buffer_load_dwordx4 v[84:87], v5, s[40:43], s57 offen offset:0 sc1
    buffer_load_dwordx4 v[88:91], v5, s[40:43], s56 offen offset:1024 sc1
    buffer_load_dwordx4 v[92:95], v5, s[40:43], s57 offen offset:1024 sc1
    buffer_load_dwordx4 v[96:99], v5, s[40:43], s56 offen offset:2048 sc1
    buffer_load_dwordx4 v[100:103], v5, s[40:43], s57 offen offset:2048 sc1
    buffer_load_dwordx4 v[104:107], v5, s[40:43], s56 offen offset:3072 sc1
    buffer_load_dwordx4 v[108:111], v5, s[40:43], s57 offen offset:3072 sc1
    s_add_u32 s56, s71, s95
    s_add_u32 s57, s72, s95
    buffer_load_dwordx4 v[112:115], v5, s[40:43], s56 offen offset:0 sc1
    buffer_load_dwordx4 v[116:119], v5, s[40:43], s57 offen offset:0 sc1
    buffer_load_dwordx4 v[120:123], v5, s[40:43], s56 offen offset:1024 sc1
    buffer_load_dwordx4 v[124:127], v5, s[40:43], s57 offen offset:1024 sc1
    v_lshlrev_b32 v16, 16, v222
    v_and_b32 v17, 0xffff0000, v222
    v_lshlrev_b32 v18, 16, v223
    v_and_b32 v19, 0xffff0000, v223
    v_lshlrev_b32 v20, 16, v224
    v_and_b32 v21, 0xffff0000, v224
    v_lshlrev_b32 v22, 16, v225
    v_and_b32 v23, 0xffff0000, v225
    v_lshlrev_b32 v24, 16, v226
    v_and_b32 v25, 0xffff0000, v226
    v_lshlrev_b32 v26, 16, v227
    v_and_b32 v27, 0xffff0000, v227
    v_lshlrev_b32 v28, 16, v228
    v_and_b32 v29, 0xffff0000, v228
    v_lshlrev_b32 v30, 16, v229
    v_and_b32 v31, 0xffff0000, v229
    ds_read_b64_tr_b16 a[80:81], v215 offset:12288
    ds_read_b64_tr_b16 a[82:83], v215 offset:13312
    ds_read_b64_tr_b16 a[84:85], v216 offset:12288
    ds_read_b64_tr_b16 a[86:87], v216 offset:13312
    ds_read_b64_tr_b16 a[88:89], v215 offset:14336
    ds_read_b64_tr_b16 a[90:91], v215 offset:15360
    ds_read_b64_tr_b16 a[92:93], v216 offset:14336
    ds_read_b64_tr_b16 a[94:95], v216 offset:15360
    ds_read_b64_tr_b16 a[96:97], v215 offset:16384
    ds_read_b64_tr_b16 a[98:99], v215 offset:17408
    ds_read_b64_tr_b16 a[100:101], v216 offset:16384
    ds_read_b64_tr_b16 a[102:103], v216 offset:17408
    ds_read_b64_tr_b16 a[104:105], v215 offset:18432
    ds_read_b64_tr_b16 a[106:107], v215 offset:19456
    ds_read_b64_tr_b16 a[108:109], v216 offset:18432
    ds_read_b64_tr_b16 a[110:111], v216 offset:19456
    ds_read_b64_tr_b16 a[112:113], v215 offset:20480
    ds_read_b64_tr_b16 a[114:115], v215 offset:21504
    ds_read_b64_tr_b16 a[116:117], v216 offset:20480
    ds_read_b64_tr_b16 a[118:119], v216 offset:21504
    ds_read_b64_tr_b16 a[120:121], v215 offset:22528
    ds_read_b64_tr_b16 a[122:123], v215 offset:23552
    ds_read_b64_tr_b16 a[124:125], v216 offset:22528
    ds_read_b64_tr_b16 a[126:127], v216 offset:23552
    buffer_load_dwordx4 v[128:131], v5, s[40:43], s56 offen offset:2048 sc1
    buffer_load_dwordx4 v[132:135], v5, s[40:43], s57 offen offset:2048 sc1
    buffer_load_dwordx4 v[136:139], v5, s[40:43], s56 offen offset:3072 sc1
    buffer_load_dwordx4 v[140:143], v5, s[40:43], s57 offen offset:3072 sc1
    s_waitcnt vmcnt(15)
    v_mfma_f32_32x32x16_bf16 v[16:31], a[128:131], v[80:83], v[16:31]
    s_waitcnt vmcnt(14)
    v_mfma_f32_32x32x16_bf16 v[32:47], a[128:131], v[84:87], 0
    v_mfma_f32_32x32x16_bf16 v[48:63], a[132:135], v[80:83], 0
    v_mfma_f32_32x32x16_bf16 v[64:79], a[132:135], v[84:87], 0
    s_add_u32 s56, s71, s96
    s_add_u32 s57, s72, s96
    buffer_load_dwordx4 v[144:147], v5, s[40:43], s56 offen offset:0 sc1
    buffer_load_dwordx4 v[148:151], v5, s[40:43], s57 offen offset:0 sc1
    buffer_load_dwordx4 v[152:155], v5, s[40:43], s56 offen offset:1024 sc1
    buffer_load_dwordx4 v[156:159], v5, s[40:43], s57 offen offset:1024 sc1
    s_waitcnt vmcnt(17)
    v_mfma_f32_32x32x16_bf16 v[16:31], a[136:139], v[88:91], v[16:31]
    s_waitcnt vmcnt(16)
    v_mfma_f32_32x32x16_bf16 v[32:47], a[136:139], v[92:95], v[32:47]
    v_mfma_f32_32x32x16_bf16 v[48:63], a[140:143], v[88:91], v[48:63]
    v_mfma_f32_32x32x16_bf16 v[64:79], a[140:143], v[92:95], v[64:79]
    buffer_load_dwordx4 v[160:163], v5, s[40:43], s56 offen offset:2048 sc1
    buffer_load_dwordx4 v[164:167], v5, s[40:43], s57 offen offset:2048 sc1
    buffer_load_dwordx4 v[168:171], v5, s[40:43], s56 offen offset:3072 sc1
    buffer_load_dwordx4 v[172:175], v5, s[40:43], s57 offen offset:3072 sc1
    s_waitcnt vmcnt(19)
    v_mfma_f32_32x32x16_bf16 v[16:31], a[144:147], v[96:99], v[16:31]
    s_waitcnt vmcnt(18)
    v_mfma_f32_32x32x16_bf16 v[32:47], a[144:147], v[100:103], v[32:47]
    v_mfma_f32_32x32x16_bf16 v[48:63], a[148:151], v[96:99], v[48:63]
    v_mfma_f32_32x32x16_bf16 v[64:79], a[148:151], v[100:103], v[64:79]
    s_add_u32 s56, s71, s97
    s_add_u32 s57, s72, s97
    buffer_load_dwordx4 v[176:179], v5, s[40:43], s56 offen offset:0 sc1
    buffer_load_dwordx4 v[180:183], v5, s[40:43], s57 offen offset:0 sc1
    buffer_load_dwordx4 v[184:187], v5, s[40:43], s56 offen offset:1024 sc1
    buffer_load_dwordx4 v[188:191], v5, s[40:43], s57 offen offset:1024 sc1
    s_waitcnt vmcnt(21)
    v_mfma_f32_32x32x16_bf16 v[16:31], a[152:155], v[104:107], v[16:31]
    s_waitcnt vmcnt(20)
    v_mfma_f32_32x32x16_bf16 v[32:47], a[152:155], v[108:111], v[32:47]
    v_mfma_f32_32x32x16_bf16 v[48:63], a[156:159], v[104:107], v[48:63]
    v_mfma_f32_32x32x16_bf16 v[64:79], a[156:159], v[108:111], v[64:79]
    buffer_load_dwordx4 v[192:195], v5, s[40:43], s56 offen offset:2048 sc1
    buffer_load_dwordx4 v[196:199], v5, s[40:43], s57 offen offset:2048 sc1
    buffer_load_dwordx4 v[200:203], v5, s[40:43], s56 offen offset:3072 sc1
    buffer_load_dwordx4 v[204:207], v5, s[40:43], s57 offen offset:3072 sc1
    s_waitcnt vmcnt(23)
    v_mfma_f32_32x32x16_bf16 v[16:31], a[160:163], v[112:115], v[16:31]
    s_waitcnt vmcnt(22)
    v_mfma_f32_32x32x16_bf16 v[32:47], a[160:163], v[116:119], v[32:47]
    v_mfma_f32_32x32x16_bf16 v[48:63], a[164:167], v[112:115], v[48:63]
    v_mfma_f32_32x32x16_bf16 v[64:79], a[164:167], v[116:119], v[64:79]
    s_add_u32 s56, s71, s98
    s_add_u32 s57, s72, s98
    buffer_load_dwordx4 v[80:83], v5, s[40:43], s56 offen offset:0 sc1
    buffer_load_dwordx4 v[84:87], v5, s[40:43], s57 offen offset:0 sc1
    buffer_load_dwordx4 v[88:91], v5, s[40:43], s56 offen offset:1024 sc1
    buffer_load_dwordx4 v[92:95], v5, s[40:43], s57 offen offset:1024 sc1
    s_waitcnt vmcnt(25)
    v_mfma_f32_32x32x16_bf16 v[16:31], a[168:171], v[120:123], v[16:31]
    s_waitcnt vmcnt(24)
    v_mfma_f32_32x32x16_bf16 v[32:47], a[168:171], v[124:127], v[32:47]
    v_mfma_f32_32x32x16_bf16 v[48:63], a[172:175], v[120:123], v[48:63]
    v_mfma_f32_32x32x16_bf16 v[64:79], a[172:175], v[124:127], v[64:79]
    buffer_load_dwordx4 v[96:99], v5, s[40:43], s56 offen offset:2048 sc1
    buffer_load_dwordx4 v[100:103], v5, s[40:43], s57 offen offset:2048 sc1
    buffer_load_dwordx4 v[104:107], v5, s[40:43], s56 offen offset:3072 sc1
    buffer_load_dwordx4 v[108:111], v5, s[40:43], s57 offen offset:3072 sc1
    s_waitcnt vmcnt(27)
    v_mfma_f32_32x32x16_bf16 v[16:31], a[176:179], v[128:131], v[16:31]
    s_waitcnt vmcnt(26)
    v_mfma_f32_32x32x16_bf16 v[32:47], a[176:179], v[132:135], v[32:47]
    v_mfma_f32_32x32x16_bf16 v[48:63], a[180:183], v[128:131], v[48:63]
    v_mfma_f32_32x32x16_bf16 v[64:79], a[180:183], v[132:135], v[64:79]
    s_add_u32 s56, s71, s99
    s_add_u32 s57, s72, s99
    buffer_load_dwordx4 v[112:115], v5, s[40:43], s56 offen offset:0 sc1
    buffer_load_dwordx4 v[116:119], v5, s[40:43], s57 offen offset:0 sc1
    buffer_load_dwordx4 v[120:123], v5, s[40:43], s56 offen offset:1024 sc1
    buffer_load_dwordx4 v[124:127], v5, s[40:43], s57 offen offset:1024 sc1
    s_waitcnt vmcnt(29)
    v_mfma_f32_32x32x16_bf16 v[16:31], a[184:187], v[136:139], v[16:31]
    s_waitcnt vmcnt(28)
    v_mfma_f32_32x32x16_bf16 v[32:47], a[184:187], v[140:143], v[32:47]
    v_mfma_f32_32x32x16_bf16 v[48:63], a[188:191], v[136:139], v[48:63]
    v_mfma_f32_32x32x16_bf16 v[64:79], a[188:191], v[140:143], v[64:79]
    buffer_load_dwordx4 v[128:131], v5, s[40:43], s56 offen offset:2048 sc1
    buffer_load_dwordx4 v[132:135], v5, s[40:43], s57 offen offset:2048 sc1
    buffer_load_dwordx4 v[136:139], v5, s[40:43], s56 offen offset:3072 sc1
    buffer_load_dwordx4 v[140:143], v5, s[40:43], s57 offen offset:3072 sc1
    s_waitcnt vmcnt(31)
    v_mfma_f32_32x32x16_bf16 v[16:31], a[192:195], v[144:147], v[16:31]
    s_waitcnt vmcnt(30)
    v_mfma_f32_32x32x16_bf16 v[32:47], a[192:195], v[148:151], v[32:47]
    v_mfma_f32_32x32x16_bf16 v[48:63], a[196:199], v[144:147], v[48:63]
    v_mfma_f32_32x32x16_bf16 v[64:79], a[196:199], v[148:151], v[64:79]
    ds_read_b64_tr_b16 a[128:129], v217 offset:24576
    ds_read_b64_tr_b16 a[130:131], v217 offset:25600
    ds_read_b64_tr_b16 a[132:133], v218 offset:24576
    ds_read_b64_tr_b16 a[134:135], v218 offset:25600
    s_add_u32 s56, s71, s100
    s_add_u32 s57, s72, s100
    buffer_load_dwordx4 v[144:147], v5, s[40:43], s56 offen offset:0 sc1
    buffer_load_dwordx4 v[148:151], v5, s[40:43], s57 offen offset:0 sc1
    s_waitcnt vmcnt(31)
    v_mfma_f32_32x32x16_bf16 v[16:31], a[200:203], v[152:155], v[16:31]
    s_waitcnt vmcnt(30)
    v_mfma_f32_32x32x16_bf16 v[32:47], a[200:203], v[156:159], v[32:47]
    v_mfma_f32_32x32x16_bf16 v[48:63], a[204:207], v[152:155], v[48:63]
    v_mfma_f32_32x32x16_bf16 v[64:79], a[204:207], v[156:159], v[64:79]
    ds_read_b64_tr_b16 a[136:137], v217 offset:26624
    ds_read_b64_tr_b16 a[138:139], v217 offset:27648
    ds_read_b64_tr_b16 a[140:141], v218 offset:26624
    ds_read_b64_tr_b16 a[142:143], v218 offset:27648
    buffer_load_dwordx4 v[152:155], v5, s[40:43], s56 offen offset:1024 sc1
    buffer_load_dwordx4 v[156:159], v5, s[40:43], s57 offen offset:1024 sc1
    s_waitcnt vmcnt(31)
    v_mfma_f32_32x32x16_bf16 v[16:31], a[208:211], v[160:163], v[16:31]
    s_waitcnt vmcnt(30)
    v_mfma_f32_32x32x16_bf16 v[32:47], a[208:211], v[164:167], v[32:47]
    v_mfma_f32_32x32x16_bf16 v[48:63], a[212:215], v[160:163], v[48:63]
    v_mfma_f32_32x32x16_bf16 v[64:79], a[212:215], v[164:167], v[64:79]
    ds_read_b64_tr_b16 a[144:145], v217 offset:28672
    ds_read_b64_tr_b16 a[146:147], v217 offset:29696
    ds_read_b64_tr_b16 a[148:149], v218 offset:28672
    ds_read_b64_tr_b16 a[150:151], v218 offset:29696
    buffer_load_dwordx4 v[160:163], v5, s[40:43], s56 offen offset:2048 sc1
    buffer_load_dwordx4 v[164:167], v5, s[40:43], s57 offen offset:2048 sc1
    s_waitcnt vmcnt(31)
    v_mfma_f32_32x32x16_bf16 v[16:31], a[216:219], v[168:171], v[16:31]
    s_waitcnt vmcnt(30)
    v_mfma_f32_32x32x16_bf16 v[32:47], a[216:219], v[172:175], v[32:47]
    v_mfma_f32_32x32x16_bf16 v[48:63], a[220:223], v[168:171], v[48:63]
    v_mfma_f32_32x32x16_bf16 v[64:79], a[220:223], v[172:175], v[64:79]
    ds_read_b64_tr_b16 a[152:153], v217 offset:30720
    ds_read_b64_tr_b16 a[154:155], v217 offset:31744
    ds_read_b64_tr_b16 a[156:157], v218 offset:30720
    ds_read_b64_tr_b16 a[158:159], v218 offset:31744
    buffer_load_dwordx4 v[168:171], v5, s[40:43], s56 offen offset:3072 sc1
    buffer_load_dwordx4 v[172:175], v5, s[40:43], s57 offen offset:3072 sc1
    s_waitcnt vmcnt(31)
    v_mfma_f32_32x32x16_bf16 v[16:31], a[224:227], v[176:179], v[16:31]
    s_waitcnt vmcnt(30)
    v_mfma_f32_32x32x16_bf16 v[32:47], a[224:227], v[180:183], v[32:47]
    v_mfma_f32_32x32x16_bf16 v[48:63], a[228:231], v[176:179], v[48:63]
    v_mfma_f32_32x32x16_bf16 v[64:79], a[228:231], v[180:183], v[64:79]
    ds_read_b64_tr_b16 a[160:161], v217 offset:32768
    ds_read_b64_tr_b16 a[162:163], v217 offset:33792
    ds_read_b64_tr_b16 a[164:165], v218 offset:32768
    ds_read_b64_tr_b16 a[166:167], v218 offset:33792
    s_add_u32 s56, s71, s101
    s_add_u32 s57, s72, s101
    buffer_load_dwordx4 v[176:179], v5, s[40:43], s56 offen offset:0 sc1
    buffer_load_dwordx4 v[180:183], v5, s[40:43], s57 offen offset:0 sc1
    s_waitcnt vmcnt(31)
    v_mfma_f32_32x32x16_bf16 v[16:31], a[232:235], v[184:187], v[16:31]
    s_waitcnt vmcnt(30)
    v_mfma_f32_32x32x16_bf16 v[32:47], a[232:235], v[188:191], v[32:47]
    v_mfma_f32_32x32x16_bf16 v[48:63], a[236:239], v[184:187], v[48:63]
    v_mfma_f32_32x32x16_bf16 v[64:79], a[236:239], v[188:191], v[64:79]
    ds_read_b64_tr_b16 a[168:169], v217 offset:34816
    ds_read_b64_tr_b16 a[170:171], v217 offset:35840
    ds_read_b64_tr_b16 a[172:173], v218 offset:34816
    ds_read_b64_tr_b16 a[174:175], v218 offset:35840
    buffer_load_dwordx4 v[184:187], v5, s[40:43], s56 offen offset:1024 sc1
    buffer_load_dwordx4 v[188:191], v5, s[40:43], s57 offen offset:1024 sc1
    s_waitcnt vmcnt(31)
    v_mfma_f32_32x32x16_bf16 v[16:31], a[240:243], v[192:195], v[16:31]
    s_waitcnt vmcnt(30)
    v_mfma_f32_32x32x16_bf16 v[32:47], a[240:243], v[196:199], v[32:47]
    v_mfma_f32_32x32x16_bf16 v[48:63], a[244:247], v[192:195], v[48:63]
    v_mfma_f32_32x32x16_bf16 v[64:79], a[244:247], v[196:199], v[64:79]
    s_xor_b32 s68, s3, 1
    s_mul_i32 s68, s68, 36864
    s_add_u32 s68, s68, 12288
    v_add_u32 v221, s68, v4
    s_xor_b32 s68, s3, 2
    s_mul_i32 s68, s68, 36864
    s_add_u32 s68, s68, 16384
    v_add_u32 v222, s68, v4
    s_xor_b32 s68, s3, 3
    s_mul_i32 s68, s68, 36864
    s_add_u32 s68, s68, 20480
    v_add_u32 v223, s68, v4
    v_add_u32 v220, s70, v4
    s_lshl_b32 s68, s64, 1
    s_and_b32 s69, s3, 1
    s_add_u32 s68, s68, s69
    s_mul_i32 s68, s68, 112
    s_lshl_b32 s69, s65, 2
    s_add_u32 s68, s68, s69
    s_and_b32 s69, s3, 2
    s_add_u32 s68, s68, s69
    s_lshl_b32 s68, s68, 10
    s_add_u32 s68, s68, 0x3c0000
    s_mov_b32 s88, 0xc0135761
    s_mov_b32 s90, 0xbdd2d3e8
    v_mov_b32 v224, s88
    v_mov_b32 v225, s88
    buffer_load_dwordx4 v[192:195], v5, s[40:43], s56 offen offset:2048 sc1
    buffer_load_dwordx4 v[196:199], v5, s[40:43], s57 offen offset:2048 sc1
    s_waitcnt vmcnt(31)
    v_mfma_f32_32x32x16_bf16 v[16:31], a[248:251], v[200:203], v[16:31]
    s_waitcnt vmcnt(30)
    v_mfma_f32_32x32x16_bf16 v[32:47], a[248:251], v[204:207], v[32:47]
    v_mfma_f32_32x32x16_bf16 v[48:63], a[252:255], v[200:203], v[48:63]
    v_mfma_f32_32x32x16_bf16 v[64:79], a[252:255], v[204:207], v[64:79]
    buffer_load_dwordx4 v[200:203], v5, s[40:43], s56 offen offset:3072 sc1
    buffer_load_dwordx4 v[204:207], v5, s[40:43], s57 offen offset:3072 sc1
    s_waitcnt vmcnt(31)
    v_mfma_f32_32x32x16_bf16 v[16:31], a[0:3], v[80:83], v[16:31]
    s_waitcnt vmcnt(30)
    v_mfma_f32_32x32x16_bf16 v[32:47], a[0:3], v[84:87], v[32:47]
    v_mfma_f32_32x32x16_bf16 v[48:63], a[4:7], v[80:83], v[48:63]
    v_mfma_f32_32x32x16_bf16 v[64:79], a[4:7], v[84:87], v[64:79]
    s_barrier
    s_waitcnt lgkmcnt(15)
    s_add_u32 m0, s70, 12288
    s_mul_i32 s73, s49, 64
    s_add_u32 s73, s73, 131072
    buffer_load_dwordx4 v214, s[24:27], s73 offen lds
    s_add_u32 m0, s70, 13312
    s_mul_i32 s73, s49, 64
    s_add_u32 s73, s73, 163840
    buffer_load_dwordx4 v214, s[24:27], s73 offen lds
    s_waitcnt vmcnt(31)
    v_mfma_f32_32x32x16_bf16 v[16:31], a[8:11], v[88:91], v[16:31]
    s_waitcnt vmcnt(30)
    v_mfma_f32_32x32x16_bf16 v[32:47], a[8:11], v[92:95], v[32:47]
    v_mfma_f32_32x32x16_bf16 v[48:63], a[12:15], v[88:91], v[48:63]
    v_mfma_f32_32x32x16_bf16 v[64:79], a[12:15], v[92:95], v[64:79]
    s_add_u32 m0, s70, 14336
    s_mul_i32 s73, s49, 64
    s_add_u32 s73, s73, 196608
    buffer_load_dwordx4 v214, s[24:27], s73 offen lds
    s_add_u32 m0, s70, 15360
    s_mul_i32 s73, s49, 64
    s_add_u32 s73, s73, 229376
    buffer_load_dwordx4 v214, s[24:27], s73 offen lds
    s_waitcnt vmcnt(31)
    v_mfma_f32_32x32x16_bf16 v[16:31], a[16:19], v[96:99], v[16:31]
    s_waitcnt vmcnt(30)
    v_mfma_f32_32x32x16_bf16 v[32:47], a[16:19], v[100:103], v[32:47]
    v_mfma_f32_32x32x16_bf16 v[48:63], a[20:23], v[96:99], v[48:63]
    v_mfma_f32_32x32x16_bf16 v[64:79], a[20:23], v[100:103], v[64:79]
    s_add_u32 m0, s70, 16384
    s_mul_i32 s73, s50, 64
    s_add_u32 s73, s73, 0
    buffer_load_dwordx4 v214, s[24:27], s73 offen lds
    s_add_u32 m0, s70, 17408
    s_mul_i32 s73, s50, 64
    s_add_u32 s73, s73, 32768
    buffer_load_dwordx4 v214, s[24:27], s73 offen lds
    s_waitcnt vmcnt(31)
    v_mfma_f32_32x32x16_bf16 v[16:31], a[24:27], v[104:107], v[16:31]
    s_waitcnt vmcnt(30)
    v_mfma_f32_32x32x16_bf16 v[32:47], a[24:27], v[108:111], v[32:47]
    v_mfma_f32_32x32x16_bf16 v[48:63], a[28:31], v[104:107], v[48:63]
    v_mfma_f32_32x32x16_bf16 v[64:79], a[28:31], v[108:111], v[64:79]
    s_add_u32 m0, s70, 18432
    s_mul_i32 s73, s50, 64
    s_add_u32 s73, s73, 65536
    buffer_load_dwordx4 v214, s[24:27], s73 offen lds
    s_add_u32 m0, s70, 19456
    s_mul_i32 s73, s50, 64
    s_add_u32 s73, s73, 98304
    buffer_load_dwordx4 v214, s[24:27], s73 offen lds
    s_waitcnt vmcnt(31)
    v_mfma_f32_32x32x16_bf16 v[16:31], a[32:35], v[112:115], v[16:31]
    s_waitcnt vmcnt(30)
    v_mfma_f32_32x32x16_bf16 v[32:47], a[32:35], v[116:119], v[32:47]
    v_mfma_f32_32x32x16_bf16 v[48:63], a[36:39], v[112:115], v[48:63]
    v_mfma_f32_32x32x16_bf16 v[64:79], a[36:39], v[116:119], v[64:79]
    s_add_u32 m0, s70, 20480
    s_mul_i32 s73, s50, 64
    s_add_u32 s73, s73, 131072
    buffer_load_dwordx4 v214, s[24:27], s73 offen lds
    s_add_u32 m0, s70, 21504
    s_mul_i32 s73, s50, 64
    s_add_u32 s73, s73, 163840
    buffer_load_dwordx4 v214, s[24:27], s73 offen lds
    s_waitcnt vmcnt(31)
    v_mfma_f32_32x32x16_bf16 v[16:31], a[40:43], v[120:123], v[16:31]
    s_waitcnt vmcnt(30)
    v_mfma_f32_32x32x16_bf16 v[32:47], a[40:43], v[124:127], v[32:47]
    v_mfma_f32_32x32x16_bf16 v[48:63], a[44:47], v[120:123], v[48:63]
    v_mfma_f32_32x32x16_bf16 v[64:79], a[44:47], v[124:127], v[64:79]
    s_add_u32 m0, s70, 22528
    s_mul_i32 s73, s50, 64
    s_add_u32 s73, s73, 196608
    buffer_load_dwordx4 v214, s[24:27], s73 offen lds
    s_add_u32 m0, s70, 23552
    s_mul_i32 s73, s50, 64
    s_add_u32 s73, s73, 229376
    buffer_load_dwordx4 v214, s[24:27], s73 offen lds
    s_waitcnt vmcnt(31)
    v_mfma_f32_32x32x16_bf16 v[16:31], a[48:51], v[128:131], v[16:31]
    s_waitcnt vmcnt(30)
    v_mfma_f32_32x32x16_bf16 v[32:47], a[48:51], v[132:135], v[32:47]
    v_mfma_f32_32x32x16_bf16 v[48:63], a[52:55], v[128:131], v[48:63]
    v_mfma_f32_32x32x16_bf16 v[64:79], a[52:55], v[132:135], v[64:79]
    s_add_u32 m0, s70, 24576
    s_mul_i32 s73, s51, 64
    s_add_u32 s73, s73, 0
    buffer_load_dwordx4 v214, s[24:27], s73 offen lds
    s_add_u32 m0, s70, 25600
    s_mul_i32 s73, s51, 64
    s_add_u32 s73, s73, 32768
    buffer_load_dwordx4 v214, s[24:27], s73 offen lds
    s_waitcnt vmcnt(31)
    v_mfma_f32_32x32x16_bf16 v[16:31], a[56:59], v[136:139], v[16:31]
    s_waitcnt vmcnt(30)
    v_mfma_f32_32x32x16_bf16 v[32:47], a[56:59], v[140:143], v[32:47]
    v_mfma_f32_32x32x16_bf16 v[48:63], a[60:63], v[136:139], v[48:63]
    v_mfma_f32_32x32x16_bf16 v[64:79], a[60:63], v[140:143], v[64:79]
    s_add_u32 m0, s70, 26624
    s_mul_i32 s73, s51, 64
    s_add_u32 s73, s73, 65536
    buffer_load_dwordx4 v214, s[24:27], s73 offen lds
    s_add_u32 m0, s70, 27648
    s_mul_i32 s73, s51, 64
    s_add_u32 s73, s73, 98304
    buffer_load_dwordx4 v214, s[24:27], s73 offen lds
    s_waitcnt vmcnt(31)
    v_mfma_f32_32x32x16_bf16 v[16:31], a[64:67], v[144:147], v[16:31]
    s_waitcnt vmcnt(30)
    v_mfma_f32_32x32x16_bf16 v[32:47], a[64:67], v[148:151], v[32:47]
    v_mfma_f32_32x32x16_bf16 v[48:63], a[68:71], v[144:147], v[48:63]
    v_mfma_f32_32x32x16_bf16 v[64:79], a[68:71], v[148:151], v[64:79]
    s_waitcnt lgkmcnt(12)
    s_add_u32 m0, s70, 28672
    s_mul_i32 s73, s51, 64
    s_add_u32 s73, s73, 131072
    buffer_load_dwordx4 v214, s[24:27], s73 offen lds
    s_add_u32 m0, s70, 29696
    s_mul_i32 s73, s51, 64
    s_add_u32 s73, s73, 163840
    buffer_load_dwordx4 v214, s[24:27], s73 offen lds
    s_waitcnt vmcnt(31)
    v_mfma_f32_32x32x16_bf16 v[16:31], a[72:75], v[152:155], v[16:31]
    s_waitcnt vmcnt(30)
    v_mfma_f32_32x32x16_bf16 v[32:47], a[72:75], v[156:159], v[32:47]
    v_mfma_f32_32x32x16_bf16 v[48:63], a[76:79], v[152:155], v[48:63]
    v_mfma_f32_32x32x16_bf16 v[64:79], a[76:79], v[156:159], v[64:79]
    s_waitcnt lgkmcnt(8)
    s_add_u32 m0, s70, 30720
    s_mul_i32 s73, s51, 64
    s_add_u32 s73, s73, 196608
    buffer_load_dwordx4 v214, s[24:27], s73 offen lds
    s_add_u32 m0, s70, 31744
    s_mul_i32 s73, s51, 64
    s_add_u32 s73, s73, 229376
    buffer_load_dwordx4 v214, s[24:27], s73 offen lds
    s_waitcnt vmcnt(31)
    v_mfma_f32_32x32x16_bf16 v[16:31], a[80:83], v[160:163], v[16:31]
    s_waitcnt vmcnt(30)
    v_mfma_f32_32x32x16_bf16 v[32:47], a[80:83], v[164:167], v[32:47]
    v_mfma_f32_32x32x16_bf16 v[48:63], a[84:87], v[160:163], v[48:63]
    v_mfma_f32_32x32x16_bf16 v[64:79], a[84:87], v[164:167], v[64:79]
    s_waitcnt lgkmcnt(4)
    s_add_u32 m0, s70, 32768
    s_mul_i32 s73, s52, 64
    s_add_u32 s73, s73, 0
    buffer_load_dwordx4 v214, s[24:27], s73 offen lds
    s_add_u32 m0, s70, 33792
    s_mul_i32 s73, s52, 64
    s_add_u32 s73, s73, 32768
    buffer_load_dwordx4 v214, s[24:27], s73 offen lds
    s_waitcnt vmcnt(31)
    v_mfma_f32_32x32x16_bf16 v[16:31], a[88:91], v[168:171], v[16:31]
    s_waitcnt vmcnt(30)
    v_mfma_f32_32x32x16_bf16 v[32:47], a[88:91], v[172:175], v[32:47]
    v_mfma_f32_32x32x16_bf16 v[48:63], a[92:95], v[168:171], v[48:63]
    v_mfma_f32_32x32x16_bf16 v[64:79], a[92:95], v[172:175], v[64:79]
    s_waitcnt lgkmcnt(0)
    s_add_u32 m0, s70, 34816
    s_mul_i32 s73, s52, 64
    s_add_u32 s73, s73, 65536
    buffer_load_dwordx4 v214, s[24:27], s73 offen lds
    s_add_u32 m0, s70, 35840
    s_mul_i32 s73, s52, 64
    s_add_u32 s73, s73, 98304
    buffer_load_dwordx4 v214, s[24:27], s73 offen lds
    s_waitcnt vmcnt(30)
    v_mfma_f32_32x32x16_bf16 v[64:79], a[100:103], v[180:183], v[64:79]
    s_waitcnt vmcnt(28)
    v_mfma_f32_32x32x16_bf16 v[64:79], a[108:111], v[188:191], v[64:79]
    s_waitcnt vmcnt(26)
    v_mfma_f32_32x32x16_bf16 v[64:79], a[116:119], v[196:199], v[64:79]
    s_waitcnt vmcnt(24)
    v_mfma_f32_32x32x16_bf16 v[64:79], a[124:127], v[204:207], v[64:79]
    v_mfma_f32_32x32x16_bf16 v[48:63], a[100:103], v[176:179], v[48:63]
    v_mfma_f32_32x32x16_bf16 v[48:63], a[108:111], v[184:187], v[48:63]
    s_nop 9
    ds_write_b128 v223, v[64:67] offset:0
    ds_write_b128 v223, v[68:71] offset:1024
    v_mfma_f32_32x32x16_bf16 v[48:63], a[116:119], v[192:195], v[48:63]
    ds_write_b128 v223, v[72:75] offset:2048
    v_mfma_f32_32x32x16_bf16 v[48:63], a[124:127], v[200:203], v[48:63]
    ds_write_b128 v223, v[76:79] offset:3072
    v_mfma_f32_32x32x16_bf16 v[32:47], a[96:99], v[180:183], v[32:47]
    v_mfma_f32_32x32x16_bf16 v[32:47], a[104:107], v[188:191], v[32:47]
    s_nop 8
    ds_write_b128 v222, v[48:51] offset:0
    ds_write_b128 v222, v[52:55] offset:1024
    v_mfma_f32_32x32x16_bf16 v[32:47], a[112:115], v[196:199], v[32:47]
    ds_write_b128 v222, v[56:59] offset:2048
    v_mfma_f32_32x32x16_bf16 v[32:47], a[120:123], v[204:207], v[32:47]
    ds_write_b128 v222, v[60:63] offset:3072
    v_mfma_f32_32x32x16_bf16 v[16:31], a[96:99], v[176:179], v[16:31]
    v_mfma_f32_32x32x16_bf16 v[16:31], a[104:107], v[184:187], v[16:31]
    s_nop 8
    ds_write_b128 v221, v[32:35] offset:0
    ds_write_b128 v221, v[36:39] offset:1024
    v_mfma_f32_32x32x16_bf16 v[16:31], a[112:115], v[192:195], v[16:31]
    ds_write_b128 v221, v[40:43] offset:2048
    v_mfma_f32_32x32x16_bf16 v[16:31], a[120:123], v[200:203], v[16:31]
    ds_write_b128 v221, v[44:47] offset:3072
    s_waitcnt lgkmcnt(0)
    s_barrier
    ds_read_b128 v[32:35], v220 offset:0
    ds_read_b128 v[48:51], v220 offset:4096
    ds_read_b128 v[64:67], v220 offset:8192
    ds_read_b128 v[36:39], v220 offset:1024
    ds_read_b128 v[52:55], v220 offset:5120
    ds_read_b128 v[68:71], v220 offset:9216
    ds_read_b128 v[40:43], v220 offset:2048
    ds_read_b128 v[56:59], v220 offset:6144
    ds_read_b128 v[72:75], v220 offset:10240
    ds_read_b128 v[44:47], v220 offset:3072
    ds_read_b128 v[60:63], v220 offset:7168
    ds_read_b128 v[76:79], v220 offset:11264
    s_waitcnt lgkmcnt(10)
    v_pk_add_f32 v[32:33], v[32:33], v[48:49]
    s_waitcnt lgkmcnt(9)
    v_pk_add_f32 v[16:17], v[16:17], v[64:65]
    v_pk_add_f32 v[34:35], v[34:35], v[50:51]
    v_pk_add_f32 v[18:19], v[18:19], v[66:67]
    s_waitcnt lgkmcnt(7)
    v_pk_add_f32 v[36:37], v[36:37], v[52:53]
    s_waitcnt lgkmcnt(6)
    v_pk_add_f32 v[20:21], v[20:21], v[68:69]
    v_pk_add_f32 v[38:39], v[38:39], v[54:55]
    v_pk_add_f32 v[22:23], v[22:23], v[70:71]
    v_pk_add_f32 v[16:17], v[16:17], v[32:33]
    v_pk_add_f32 v[18:19], v[18:19], v[34:35]
    v_pk_add_f32 v[20:21], v[20:21], v[36:37]
    v_pk_add_f32 v[22:23], v[22:23], v[38:39]
    v_pk_mul_f32 v[80:81], v[16:17], v[16:17]
    v_pk_mul_f32 v[82:83], v[18:19], v[18:19]
    v_pk_mul_f32 v[84:85], v[20:21], v[20:21]
    v_pk_mul_f32 v[86:87], v[22:23], v[22:23]
    v_pk_fma_f32 v[80:81], v[80:81], s[90:91], v[224:225] op_sel_hi:[1,0,1]
    v_pk_fma_f32 v[82:83], v[82:83], s[90:91], v[224:225] op_sel_hi:[1,0,1]
    v_pk_fma_f32 v[84:85], v[84:85], s[90:91], v[224:225] op_sel_hi:[1,0,1]
    v_pk_fma_f32 v[86:87], v[86:87], s[90:91], v[224:225] op_sel_hi:[1,0,1]
    v_pk_mul_f32 v[80:81], v[80:81], v[16:17]
    v_pk_mul_f32 v[82:83], v[82:83], v[18:19]
    v_pk_mul_f32 v[84:85], v[84:85], v[20:21]
    v_pk_mul_f32 v[86:87], v[86:87], v[22:23]
    v_exp_f32 v80, v80
    v_exp_f32 v81, v81
    v_exp_f32 v82, v82
    v_exp_f32 v83, v83
    v_exp_f32 v84, v84
    v_exp_f32 v85, v85
    v_exp_f32 v86, v86
    v_exp_f32 v87, v87
    v_pk_add_f32 v[80:81], v[80:81], 1.0 op_sel_hi:[1,0]
    v_pk_add_f32 v[82:83], v[82:83], 1.0 op_sel_hi:[1,0]
    v_pk_add_f32 v[84:85], v[84:85], 1.0 op_sel_hi:[1,0]
    v_pk_add_f32 v[86:87], v[86:87], 1.0 op_sel_hi:[1,0]
    v_rcp_f32 v80, v80
    v_rcp_f32 v81, v81
    v_rcp_f32 v82, v82
    v_rcp_f32 v83, v83
    v_rcp_f32 v84, v84
    v_rcp_f32 v85, v85
    v_rcp_f32 v86, v86
    v_rcp_f32 v87, v87
    v_pk_mul_f32 v[80:81], v[80:81], v[16:17]
    v_pk_mul_f32 v[82:83], v[82:83], v[18:19]
    v_pk_mul_f32 v[84:85], v[84:85], v[20:21]
    v_pk_mul_f32 v[86:87], v[86:87], v[22:23]
    v_cvt_pk_bf16_f32 v96, v80, v81
    v_cvt_pk_bf16_f32 v97, v82, v83
    v_cvt_pk_bf16_f32 v98, v84, v85
    v_cvt_pk_bf16_f32 v99, v86, v87
    buffer_store_dwordx4 v[96:99], v5, s[40:43], s68 offen offset:0 sc1
    s_waitcnt lgkmcnt(4)
    v_pk_add_f32 v[40:41], v[40:41], v[56:57]
    s_waitcnt lgkmcnt(3)
    v_pk_add_f32 v[24:25], v[24:25], v[72:73]
    v_pk_add_f32 v[42:43], v[42:43], v[58:59]
    v_pk_add_f32 v[26:27], v[26:27], v[74:75]
    s_waitcnt lgkmcnt(1)
    v_pk_add_f32 v[44:45], v[44:45], v[60:61]
    s_waitcnt lgkmcnt(0)
    v_pk_add_f32 v[28:29], v[28:29], v[76:77]
    v_pk_add_f32 v[46:47], v[46:47], v[62:63]
    v_pk_add_f32 v[30:31], v[30:31], v[78:79]
    v_pk_add_f32 v[24:25], v[24:25], v[40:41]
    v_pk_add_f32 v[26:27], v[26:27], v[42:43]
    v_pk_add_f32 v[28:29], v[28:29], v[44:45]
    v_pk_add_f32 v[30:31], v[30:31], v[46:47]
    v_pk_mul_f32 v[88:89], v[24:25], v[24:25]
    v_pk_mul_f32 v[90:91], v[26:27], v[26:27]
    v_pk_mul_f32 v[92:93], v[28:29], v[28:29]
    v_pk_mul_f32 v[94:95], v[30:31], v[30:31]
    v_pk_fma_f32 v[88:89], v[88:89], s[90:91], v[224:225] op_sel_hi:[1,0,1]
    v_pk_fma_f32 v[90:91], v[90:91], s[90:91], v[224:225] op_sel_hi:[1,0,1]
    v_pk_fma_f32 v[92:93], v[92:93], s[90:91], v[224:225] op_sel_hi:[1,0,1]
    v_pk_fma_f32 v[94:95], v[94:95], s[90:91], v[224:225] op_sel_hi:[1,0,1]
    v_pk_mul_f32 v[88:89], v[88:89], v[24:25]
    v_pk_mul_f32 v[90:91], v[90:91], v[26:27]
    v_pk_mul_f32 v[92:93], v[92:93], v[28:29]
    v_pk_mul_f32 v[94:95], v[94:95], v[30:31]
    v_exp_f32 v88, v88
    v_exp_f32 v89, v89
    v_exp_f32 v90, v90
    v_exp_f32 v91, v91
    v_exp_f32 v92, v92
    v_exp_f32 v93, v93
    v_exp_f32 v94, v94
    v_exp_f32 v95, v95
    v_pk_add_f32 v[88:89], v[88:89], 1.0 op_sel_hi:[1,0]
    v_pk_add_f32 v[90:91], v[90:91], 1.0 op_sel_hi:[1,0]
    v_pk_add_f32 v[92:93], v[92:93], 1.0 op_sel_hi:[1,0]
    v_pk_add_f32 v[94:95], v[94:95], 1.0 op_sel_hi:[1,0]
    v_rcp_f32 v88, v88
    v_rcp_f32 v89, v89
    v_rcp_f32 v90, v90
    v_rcp_f32 v91, v91
    v_rcp_f32 v92, v92
    v_rcp_f32 v93, v93
    v_rcp_f32 v94, v94
    v_rcp_f32 v95, v95
    v_pk_mul_f32 v[88:89], v[88:89], v[24:25]
    v_pk_mul_f32 v[90:91], v[90:91], v[26:27]
    v_pk_mul_f32 v[92:93], v[92:93], v[28:29]
    v_pk_mul_f32 v[94:95], v[94:95], v[30:31]
    v_cvt_pk_bf16_f32 v100, v88, v89
    v_cvt_pk_bf16_f32 v101, v90, v91
    v_cvt_pk_bf16_f32 v102, v92, v93
    v_cvt_pk_bf16_f32 v103, v94, v95
    buffer_store_dwordx4 v[100:103], v5, s[40:43], s68 offen offset:1024 sc1
    v_mov_b32 v9, v5
    s_waitcnt vmcnt(24)
    ds_read_b64_tr_b16 a[176:177], v217 offset:12288
    ds_read_b64_tr_b16 a[178:179], v217 offset:13312
    ds_read_b64_tr_b16 a[180:181], v218 offset:12288
    ds_read_b64_tr_b16 a[182:183], v218 offset:13312
    s_waitcnt vmcnt(22)
    ds_read_b64_tr_b16 a[184:185], v217 offset:14336
    ds_read_b64_tr_b16 a[186:187], v217 offset:15360
    ds_read_b64_tr_b16 a[188:189], v218 offset:14336
    ds_read_b64_tr_b16 a[190:191], v218 offset:15360
    s_waitcnt vmcnt(20)
    ds_read_b64_tr_b16 a[192:193], v217 offset:16384
    ds_read_b64_tr_b16 a[194:195], v217 offset:17408
    ds_read_b64_tr_b16 a[196:197], v218 offset:16384
    ds_read_b64_tr_b16 a[198:199], v218 offset:17408
    s_waitcnt vmcnt(18)
    ds_read_b64_tr_b16 a[200:201], v217 offset:18432
    ds_read_b64_tr_b16 a[202:203], v217 offset:19456
    ds_read_b64_tr_b16 a[204:205], v218 offset:18432
    ds_read_b64_tr_b16 a[206:207], v218 offset:19456
    s_waitcnt vmcnt(16)
    ds_read_b64_tr_b16 a[208:209], v217 offset:20480
    ds_read_b64_tr_b16 a[210:211], v217 offset:21504
    ds_read_b64_tr_b16 a[212:213], v218 offset:20480
    ds_read_b64_tr_b16 a[214:215], v218 offset:21504
    s_waitcnt vmcnt(14)
    ds_read_b64_tr_b16 a[216:217], v217 offset:22528
    ds_read_b64_tr_b16 a[218:219], v217 offset:23552
    ds_read_b64_tr_b16 a[220:221], v218 offset:22528
    ds_read_b64_tr_b16 a[222:223], v218 offset:23552
    s_waitcnt vmcnt(12)
    ds_read_b64_tr_b16 a[224:225], v217 offset:24576
    ds_read_b64_tr_b16 a[226:227], v217 offset:25600
    ds_read_b64_tr_b16 a[228:229], v218 offset:24576
    ds_read_b64_tr_b16 a[230:231], v218 offset:25600
    s_waitcnt vmcnt(10)
    ds_read_b64_tr_b16 a[232:233], v217 offset:26624
    ds_read_b64_tr_b16 a[234:235], v217 offset:27648
    ds_read_b64_tr_b16 a[236:237], v218 offset:26624
    ds_read_b64_tr_b16 a[238:239], v218 offset:27648
    s_waitcnt vmcnt(8)
    ds_read_b64_tr_b16 a[240:241], v217 offset:28672
    ds_read_b64_tr_b16 a[242:243], v217 offset:29696
    ds_read_b64_tr_b16 a[244:245], v218 offset:28672
    ds_read_b64_tr_b16 a[246:247], v218 offset:29696
    s_waitcnt vmcnt(6)
    ds_read_b64_tr_b16 a[248:249], v217 offset:30720
    ds_read_b64_tr_b16 a[250:251], v217 offset:31744
    ds_read_b64_tr_b16 a[252:253], v218 offset:30720
    ds_read_b64_tr_b16 a[254:255], v218 offset:31744
    s_waitcnt vmcnt(4)
    ds_read_b64_tr_b16 a[0:1], v217 offset:32768
    ds_read_b64_tr_b16 a[2:3], v217 offset:33792
    ds_read_b64_tr_b16 a[4:5], v218 offset:32768
    ds_read_b64_tr_b16 a[6:7], v218 offset:33792
    s_waitcnt vmcnt(2)
    ds_read_b64_tr_b16 a[8:9], v217 offset:34816
    ds_read_b64_tr_b16 a[10:11], v217 offset:35840
    ds_read_b64_tr_b16 a[12:13], v218 offset:34816
    ds_read_b64_tr_b16 a[14:15], v218 offset:35840
    s_waitcnt vmcnt(0)
    v_mov_b32 v8, s4
    s_mov_b64 exec, 1
    buffer_store_dword v8, v9, s[40:43], s82 offen sc1
    s_mov_b64 exec, -1
    s_add_u32 m0, s70, 0
    s_mul_i32 s73, s52, 64
    s_add_u32 s73, s73, 131072
    buffer_load_dwordx4 v214, s[24:27], s73 offen lds
    s_add_u32 m0, s70, 1024
    s_mul_i32 s73, s52, 64
    s_add_u32 s73, s73, 163840
    buffer_load_dwordx4 v214, s[24:27], s73 offen lds
    s_add_u32 m0, s70, 2048
    s_mul_i32 s73, s52, 64
    s_add_u32 s73, s73, 196608
    buffer_load_dwordx4 v214, s[24:27], s73 offen lds
    s_add_u32 m0, s70, 3072
    s_mul_i32 s73, s52, 64
    s_add_u32 s73, s73, 229376
    buffer_load_dwordx4 v214, s[24:27], s73 offen lds
    s_add_u32 m0, s70, 4096
    s_mul_i32 s73, s53, 64
    s_add_u32 s73, s73, 0
    buffer_load_dwordx4 v214, s[24:27], s73 offen lds
    s_add_u32 m0, s70, 5120
    s_mul_i32 s73, s53, 64
    s_add_u32 s73, s73, 32768
    buffer_load_dwordx4 v214, s[24:27], s73 offen lds
    s_add_u32 m0, s70, 6144
    s_mul_i32 s73, s53, 64
    s_add_u32 s73, s73, 65536
    buffer_load_dwordx4 v214, s[24:27], s73 offen lds
    s_add_u32 m0, s70, 7168
    s_mul_i32 s73, s53, 64
    s_add_u32 s73, s73, 98304
    buffer_load_dwordx4 v214, s[24:27], s73 offen lds
    s_add_u32 m0, s70, 8192
    s_mul_i32 s73, s53, 64
    s_add_u32 s73, s73, 131072
    buffer_load_dwordx4 v214, s[24:27], s73 offen lds
    s_add_u32 m0, s70, 9216
    s_mul_i32 s73, s53, 64
    s_add_u32 s73, s73, 163840
    buffer_load_dwordx4 v214, s[24:27], s73 offen lds
    s_add_u32 m0, s70, 10240
    s_mul_i32 s73, s53, 64
    s_add_u32 s73, s73, 196608
    buffer_load_dwordx4 v214, s[24:27], s73 offen lds
    s_add_u32 m0, s70, 11264
    s_mul_i32 s73, s53, 64
    s_add_u32 s73, s73, 229376
    buffer_load_dwordx4 v214, s[24:27], s73 offen lds
    s_waitcnt lgkmcnt(15)
    s_add_u32 m0, s70, 12288
    s_mul_i32 s73, s54, 64
    s_add_u32 s73, s73, 0
    buffer_load_dwordx4 v214, s[24:27], s73 offen lds
    s_add_u32 m0, s70, 13312
    s_mul_i32 s73, s54, 64
    s_add_u32 s73, s73, 32768
    buffer_load_dwordx4 v214, s[24:27], s73 offen lds
    s_add_u32 m0, s70, 14336
    s_mul_i32 s73, s54, 64
    s_add_u32 s73, s73, 65536
    buffer_load_dwordx4 v214, s[24:27], s73 offen lds
    s_add_u32 m0, s70, 15360
    s_mul_i32 s73, s54, 64
    s_add_u32 s73, s73, 98304
    buffer_load_dwordx4 v214, s[24:27], s73 offen lds
    s_add_u32 m0, s70, 16384
    s_mul_i32 s73, s54, 64
    s_add_u32 s73, s73, 131072
    buffer_load_dwordx4 v214, s[24:27], s73 offen lds
    s_add_u32 m0, s70, 17408
    s_mul_i32 s73, s54, 64
    s_add_u32 s73, s73, 163840
    buffer_load_dwordx4 v214, s[24:27], s73 offen lds
    s_add_u32 m0, s70, 18432
    s_mul_i32 s73, s54, 64
    s_add_u32 s73, s73, 196608
    buffer_load_dwordx4 v214, s[24:27], s73 offen lds
    s_add_u32 m0, s70, 19456
    s_mul_i32 s73, s54, 64
    s_add_u32 s73, s73, 229376
    buffer_load_dwordx4 v214, s[24:27], s73 offen lds
    v_lshrrev_b32 v220, 5, v1
    v_lshlrev_b32 v220, 3, v220
    s_lshl_b32 s68, s67, 7
    s_lshr_b32 s69, s3, 1
    s_lshl_b32 s69, s69, 6
    s_add_u32 s68, s68, s69
    buffer_load_dwordx2 v[222:223], v220, s[32:35], s68 offen offset:0
    buffer_load_dwordx2 v[224:225], v220, s[32:35], s68 offen offset:16
    buffer_load_dwordx2 v[226:227], v220, s[32:35], s68 offen offset:32
    buffer_load_dwordx2 v[228:229], v220, s[32:35], s68 offen offset:48
    s_lshl_b32 s68, s66, 1
    s_and_b32 s69, s3, 1
    s_add_u32 s71, s68, s69
    s_xor_b32 s72, s71, 1
    s_mul_i32 s68, s3, 28672
    s_add_u32 s68, s68, 0x3c0000
    s_mul_i32 s71, s71, 114688
    s_add_u32 s71, s71, s68
    s_mul_i32 s72, s72, 114688
    s_add_u32 s72, s72, s68
    buffer_load_dword v249, v12, s[40:43], s85 offen sc1
    s_sleep 3
    buffer_load_dword v250, v12, s[40:43], s85 offen sc1
    s_sleep 3
    s_nop 0
Lpoll_P_10:
    s_sub_u32 s6, s6, 1
    s_cbranch_scc1 L_end_P
    buffer_load_dword v251, v12, s[40:43], s85 offen sc1
    s_waitcnt vmcnt(2)
    v_cmp_ne_u32 vcc, s4, v249
    s_nop 1
    s_cbranch_vccz Lpd_P_11
    buffer_load_dword v249, v12, s[40:43], s85 offen sc1
    s_waitcnt vmcnt(2)
    v_cmp_ne_u32 vcc, s4, v250
    s_nop 1
    s_cbranch_vccz Lpd_P_11
    buffer_load_dword v250, v12, s[40:43], s85 offen sc1
    s_waitcnt vmcnt(2)
    v_cmp_ne_u32 vcc, s4, v251
    s_nop 1
    s_cbranch_vccnz Lpoll_P_10
    s_nop 1
Lpd_P_11:
    s_add_u32 s56, s71, s48
    s_add_u32 s57, s72, s48
    buffer_load_dwordx4 v[80:83], v4, s[40:43], s56 offen offset:0 sc1
    buffer_load_dwordx4 v[84:87], v4, s[40:43], s57 offen offset:0 sc1
    buffer_load_dwordx4 v[88:91], v4, s[40:43], s56 offen offset:1024 sc1
    buffer_load_dwordx4 v[92:95], v4, s[40:43], s57 offen offset:1024 sc1
    buffer_load_dwordx4 v[96:99], v4, s[40:43], s56 offen offset:2048 sc1
    buffer_load_dwordx4 v[100:103], v4, s[40:43], s57 offen offset:2048 sc1
    buffer_load_dwordx4 v[104:107], v4, s[40:43], s56 offen offset:3072 sc1
    buffer_load_dwordx4 v[108:111], v4, s[40:43], s57 offen offset:3072 sc1
    s_add_u32 s56, s71, s49
    s_add_u32 s57, s72, s49
    buffer_load_dwordx4 v[112:115], v4, s[40:43], s56 offen offset:0 sc1
    buffer_load_dwordx4 v[116:119], v4, s[40:43], s57 offen offset:0 sc1
    buffer_load_dwordx4 v[120:123], v4, s[40:43], s56 offen offset:1024 sc1
    buffer_load_dwordx4 v[124:127], v4, s[40:43], s57 offen offset:1024 sc1
    v_lshlrev_b32 v16, 16, v222
    v_and_b32 v17, 0xffff0000, v222
    v_lshlrev_b32 v238, 16, v240
    v_and_b32 v239, 0xffff0000, v240
    v_pk_add_f32 v[16:17], v[16:17], v[238:239]
    v_lshlrev_b32 v18, 16, v223
    v_and_b32 v19, 0xffff0000, v223
    v_lshlrev_b32 v238, 16, v241
    v_and_b32 v239, 0xffff0000, v241
    v_pk_add_f32 v[18:19], v[18:19], v[238:239]
    v_lshlrev_b32 v20, 16, v224
    v_and_b32 v21, 0xffff0000, v224
    v_lshlrev_b32 v238, 16, v242
    v_and_b32 v239, 0xffff0000, v242
    v_pk_add_f32 v[20:21], v[20:21], v[238:239]
    v_lshlrev_b32 v22, 16, v225
    v_and_b32 v23, 0xffff0000, v225
    v_lshlrev_b32 v238, 16, v243
    v_and_b32 v239, 0xffff0000, v243
    v_pk_add_f32 v[22:23], v[22:23], v[238:239]
    v_lshlrev_b32 v24, 16, v226
    v_and_b32 v25, 0xffff0000, v226
    v_lshlrev_b32 v238, 16, v244
    v_and_b32 v239, 0xffff0000, v244
    v_pk_add_f32 v[24:25], v[24:25], v[238:239]
    v_lshlrev_b32 v26, 16, v227
    v_and_b32 v27, 0xffff0000, v227
    v_lshlrev_b32 v238, 16, v245
    v_and_b32 v239, 0xffff0000, v245
    v_pk_add_f32 v[26:27], v[26:27], v[238:239]
    v_lshlrev_b32 v28, 16, v228
    v_and_b32 v29, 0xffff0000, v228
    v_lshlrev_b32 v238, 16, v246
    v_and_b32 v239, 0xffff0000, v246
    v_pk_add_f32 v[28:29], v[28:29], v[238:239]
    v_lshlrev_b32 v30, 16, v229
    v_and_b32 v31, 0xffff0000, v229
    v_lshlrev_b32 v238, 16, v247
    v_and_b32 v239, 0xffff0000, v247
    v_pk_add_f32 v[30:31], v[30:31], v[238:239]
    buffer_load_dwordx4 v[128:131], v4, s[40:43], s56 offen offset:2048 sc1
    buffer_load_dwordx4 v[132:135], v4, s[40:43], s57 offen offset:2048 sc1
    buffer_load_dwordx4 v[136:139], v4, s[40:43], s56 offen offset:3072 sc1
    buffer_load_dwordx4 v[140:143], v4, s[40:43], s57 offen offset:3072 sc1
    s_waitcnt vmcnt(15)
    v_mfma_f32_32x32x16_bf16 v[16:31], a[128:131], v[80:83], v[16:31]
    s_waitcnt vmcnt(14)
    v_mfma_f32_32x32x16_bf16 v[32:47], a[128:131], v[84:87], 0
    v_mfma_f32_32x32x16_bf16 v[48:63], a[132:135], v[80:83], 0
    v_mfma_f32_32x32x16_bf16 v[64:79], a[132:135], v[84:87], 0
    ds_read_b64_tr_b16 a[16:17], v217 offset:0
    ds_read_b64_tr_b16 a[18:19], v217 offset:1024
    ds_read_b64_tr_b16 a[20:21], v218 offset:0
    ds_read_b64_tr_b16 a[22:23], v218 offset:1024
    s_add_u32 s56, s71, s50
    s_add_u32 s57, s72, s50
    buffer_load_dwordx4 v[144:147], v4, s[40:43], s56 offen offset:0 sc1
    buffer_load_dwordx4 v[148:151], v4, s[40:43], s57 offen offset:0 sc1
    buffer_load_dwordx4 v[152:155], v4, s[40:43], s56 offen offset:1024 sc1
    buffer_load_dwordx4 v[156:159], v4, s[40:43], s57 offen offset:1024 sc1
    s_waitcnt vmcnt(17)
    v_mfma_f32_32x32x16_bf16 v[16:31], a[136:139], v[88:91], v[16:31]
    s_waitcnt vmcnt(16)
    v_mfma_f32_32x32x16_bf16 v[32:47], a[136:139], v[92:95], v[32:47]
    v_mfma_f32_32x32x16_bf16 v[48:63], a[140:143], v[88:91], v[48:63]
    v_mfma_f32_32x32x16_bf16 v[64:79], a[140:143], v[92:95], v[64:79]
    ds_read_b64_tr_b16 a[24:25], v217 offset:2048
    ds_read_b64_tr_b16 a[26:27], v217 offset:3072
    ds_read_b64_tr_b16 a[28:29], v218 offset:2048
    ds_read_b64_tr_b16 a[30:31], v218 offset:3072
    buffer_load_dwordx4 v[160:163], v4, s[40:43], s56 offen offset:2048 sc1
    buffer_load_dwordx4 v[164:167], v4, s[40:43], s57 offen offset:2048 sc1
    buffer_load_dwordx4 v[168:171], v4, s[40:43], s56 offen offset:3072 sc1
    buffer_load_dwordx4 v[172:175], v4, s[40:43], s57 offen offset:3072 sc1
    s_waitcnt vmcnt(19)
    v_mfma_f32_32x32x16_bf16 v[16:31], a[144:147], v[96:99], v[16:31]
    s_waitcnt vmcnt(18)
    v_mfma_f32_32x32x16_bf16 v[32:47], a[144:147], v[100:103], v[32:47]
    v_mfma_f32_32x32x16_bf16 v[48:63], a[148:151], v[96:99], v[48:63]
    v_mfma_f32_32x32x16_bf16 v[64:79], a[148:151], v[100:103], v[64:79]
    ds_read_b64_tr_b16 a[32:33], v217 offset:4096
    ds_read_b64_tr_b16 a[34:35], v217 offset:5120
    ds_read_b64_tr_b16 a[36:37], v218 offset:4096
    ds_read_b64_tr_b16 a[38:39], v218 offset:5120
    s_add_u32 s56, s71, s51
    s_add_u32 s57, s72, s51
    buffer_load_dwordx4 v[176:179], v4, s[40:43], s56 offen offset:0 sc1
    buffer_load_dwordx4 v[180:183], v4, s[40:43], s57 offen offset:0 sc1
    buffer_load_dwordx4 v[184:187], v4, s[40:43], s56 offen offset:1024 sc1
    buffer_load_dwordx4 v[188:191], v4, s[40:43], s57 offen offset:1024 sc1
    s_waitcnt vmcnt(21)
    v_mfma_f32_32x32x16_bf16 v[16:31], a[152:155], v[104:107], v[16:31]
    s_waitcnt vmcnt(20)
    v_mfma_f32_32x32x16_bf16 v[32:47], a[152:155], v[108:111], v[32:47]
    v_mfma_f32_32x32x16_bf16 v[48:63], a[156:159], v[104:107], v[48:63]
    v_mfma_f32_32x32x16_bf16 v[64:79], a[156:159], v[108:111], v[64:79]
    ds_read_b64_tr_b16 a[40:41], v217 offset:6144
    ds_read_b64_tr_b16 a[42:43], v217 offset:7168
    ds_read_b64_tr_b16 a[44:45], v218 offset:6144
    ds_read_b64_tr_b16 a[46:47], v218 offset:7168
    buffer_load_dwordx4 v[192:195], v4, s[40:43], s56 offen offset:2048 sc1
    buffer_load_dwordx4 v[196:199], v4, s[40:43], s57 offen offset:2048 sc1
    buffer_load_dwordx4 v[200:203], v4, s[40:43], s56 offen offset:3072 sc1
    buffer_load_dwordx4 v[204:207], v4, s[40:43], s57 offen offset:3072 sc1
    s_waitcnt vmcnt(23)
    v_mfma_f32_32x32x16_bf16 v[16:31], a[160:163], v[112:115], v[16:31]
    s_waitcnt vmcnt(22)
    v_mfma_f32_32x32x16_bf16 v[32:47], a[160:163], v[116:119], v[32:47]
    v_mfma_f32_32x32x16_bf16 v[48:63], a[164:167], v[112:115], v[48:63]
    v_mfma_f32_32x32x16_bf16 v[64:79], a[164:167], v[116:119], v[64:79]
    ds_read_b64_tr_b16 a[48:49], v217 offset:8192
    ds_read_b64_tr_b16 a[50:51], v217 offset:9216
    ds_read_b64_tr_b16 a[52:53], v218 offset:8192
    ds_read_b64_tr_b16 a[54:55], v218 offset:9216
    s_add_u32 s56, s71, s52
    s_add_u32 s57, s72, s52
    buffer_load_dwordx4 v[80:83], v4, s[40:43], s56 offen offset:0 sc1
    buffer_load_dwordx4 v[84:87], v4, s[40:43], s57 offen offset:0 sc1
    buffer_load_dwordx4 v[88:91], v4, s[40:43], s56 offen offset:1024 sc1
    buffer_load_dwordx4 v[92:95], v4, s[40:43], s57 offen offset:1024 sc1
    s_waitcnt vmcnt(25)
    v_mfma_f32_32x32x16_bf16 v[16:31], a[168:171], v[120:123], v[16:31]
    s_waitcnt vmcnt(24)
    v_mfma_f32_32x32x16_bf16 v[32:47], a[168:171], v[124:127], v[32:47]
    v_mfma_f32_32x32x16_bf16 v[48:63], a[172:175], v[120:123], v[48:63]
    v_mfma_f32_32x32x16_bf16 v[64:79], a[172:175], v[124:127], v[64:79]
    ds_read_b64_tr_b16 a[56:57], v217 offset:10240
    ds_read_b64_tr_b16 a[58:59], v217 offset:11264
    ds_read_b64_tr_b16 a[60:61], v218 offset:10240
    ds_read_b64_tr_b16 a[62:63], v218 offset:11264
    buffer_load_dwordx4 v[96:99], v4, s[40:43], s56 offen offset:2048 sc1
    buffer_load_dwordx4 v[100:103], v4, s[40:43], s57 offen offset:2048 sc1
    buffer_load_dwordx4 v[104:107], v4, s[40:43], s56 offen offset:3072 sc1
    buffer_load_dwordx4 v[108:111], v4, s[40:43], s57 offen offset:3072 sc1
    s_waitcnt vmcnt(27)
    v_mfma_f32_32x32x16_bf16 v[16:31], a[176:179], v[128:131], v[16:31]
    s_waitcnt vmcnt(26)
    v_mfma_f32_32x32x16_bf16 v[32:47], a[176:179], v[132:135], v[32:47]
    v_mfma_f32_32x32x16_bf16 v[48:63], a[180:183], v[128:131], v[48:63]
    v_mfma_f32_32x32x16_bf16 v[64:79], a[180:183], v[132:135], v[64:79]
    ds_read_b64_tr_b16 a[64:65], v217 offset:12288
    ds_read_b64_tr_b16 a[66:67], v217 offset:13312
    ds_read_b64_tr_b16 a[68:69], v218 offset:12288
    ds_read_b64_tr_b16 a[70:71], v218 offset:13312
    s_add_u32 s56, s71, s53
    s_add_u32 s57, s72, s53
    buffer_load_dwordx4 v[112:115], v4, s[40:43], s56 offen offset:0 sc1
    buffer_load_dwordx4 v[116:119], v4, s[40:43], s57 offen offset:0 sc1
    buffer_load_dwordx4 v[120:123], v4, s[40:43], s56 offen offset:1024 sc1
    buffer_load_dwordx4 v[124:127], v4, s[40:43], s57 offen offset:1024 sc1
    s_waitcnt vmcnt(29)
    v_mfma_f32_32x32x16_bf16 v[16:31], a[184:187], v[136:139], v[16:31]
    s_waitcnt vmcnt(28)
    v_mfma_f32_32x32x16_bf16 v[32:47], a[184:187], v[140:143], v[32:47]
    v_mfma_f32_32x32x16_bf16 v[48:63], a[188:191], v[136:139], v[48:63]
    v_mfma_f32_32x32x16_bf16 v[64:79], a[188:191], v[140:143], v[64:79]
    ds_read_b64_tr_b16 a[72:73], v217 offset:14336
    ds_read_b64_tr_b16 a[74:75], v217 offset:15360
    ds_read_b64_tr_b16 a[76:77], v218 offset:14336
    ds_read_b64_tr_b16 a[78:79], v218 offset:15360
    buffer_load_dwordx4 v[128:131], v4, s[40:43], s56 offen offset:2048 sc1
    buffer_load_dwordx4 v[132:135], v4, s[40:43], s57 offen offset:2048 sc1
    buffer_load_dwordx4 v[136:139], v4, s[40:43], s56 offen offset:3072 sc1
    buffer_load_dwordx4 v[140:143], v4, s[40:43], s57 offen offset:3072 sc1
    s_waitcnt vmcnt(31)
    v_mfma_f32_32x32x16_bf16 v[16:31], a[192:195], v[144:147], v[16:31]
    s_waitcnt vmcnt(30)
    v_mfma_f32_32x32x16_bf16 v[32:47], a[192:195], v[148:151], v[32:47]
    v_mfma_f32_32x32x16_bf16 v[48:63], a[196:199], v[144:147], v[48:63]
    v_mfma_f32_32x32x16_bf16 v[64:79], a[196:199], v[148:151], v[64:79]
    ds_read_b64_tr_b16 a[80:81], v217 offset:16384
    ds_read_b64_tr_b16 a[82:83], v217 offset:17408
    ds_read_b64_tr_b16 a[84:85], v218 offset:16384
    ds_read_b64_tr_b16 a[86:87], v218 offset:17408
    s_add_u32 s56, s71, s54
    s_add_u32 s57, s72, s54
    buffer_load_dwordx4 v[144:147], v4, s[40:43], s56 offen offset:0 sc1
    buffer_load_dwordx4 v[148:151], v4, s[40:43], s57 offen offset:0 sc1
    s_waitcnt vmcnt(31)
    v_mfma_f32_32x32x16_bf16 v[16:31], a[200:203], v[152:155], v[16:31]
    s_waitcnt vmcnt(30)
    v_mfma_f32_32x32x16_bf16 v[32:47], a[200:203], v[156:159], v[32:47]
    v_mfma_f32_32x32x16_bf16 v[48:63], a[204:207], v[152:155], v[48:63]
    v_mfma_f32_32x32x16_bf16 v[64:79], a[204:207], v[156:159], v[64:79]
    ds_read_b64_tr_b16 a[88:89], v217 offset:18432
    ds_read_b64_tr_b16 a[90:91], v217 offset:19456
    ds_read_b64_tr_b16 a[92:93], v218 offset:18432
    ds_read_b64_tr_b16 a[94:95], v218 offset:19456
    buffer_load_dwordx4 v[152:155], v4, s[40:43], s56 offen offset:1024 sc1
    buffer_load_dwordx4 v[156:159], v4, s[40:43], s57 offen offset:1024 sc1
    s_waitcnt vmcnt(31)
    v_mfma_f32_32x32x16_bf16 v[16:31], a[208:211], v[160:163], v[16:31]
    s_waitcnt vmcnt(30)
    v_mfma_f32_32x32x16_bf16 v[32:47], a[208:211], v[164:167], v[32:47]
    v_mfma_f32_32x32x16_bf16 v[48:63], a[212:215], v[160:163], v[48:63]
    v_mfma_f32_32x32x16_bf16 v[64:79], a[212:215], v[164:167], v[64:79]
    buffer_load_dwordx4 v[160:163], v4, s[40:43], s56 offen offset:2048 sc1
    buffer_load_dwordx4 v[164:167], v4, s[40:43], s57 offen offset:2048 sc1
    s_waitcnt vmcnt(31)
    v_mfma_f32_32x32x16_bf16 v[16:31], a[216:219], v[168:171], v[16:31]
    s_waitcnt vmcnt(30)
    v_mfma_f32_32x32x16_bf16 v[32:47], a[216:219], v[172:175], v[32:47]
    v_mfma_f32_32x32x16_bf16 v[48:63], a[220:223], v[168:171], v[48:63]
    v_mfma_f32_32x32x16_bf16 v[64:79], a[220:223], v[172:175], v[64:79]
    buffer_load_dwordx4 v[168:171], v4, s[40:43], s56 offen offset:3072 sc1
    buffer_load_dwordx4 v[172:175], v4, s[40:43], s57 offen offset:3072 sc1
    s_waitcnt vmcnt(31)
    v_mfma_f32_32x32x16_bf16 v[16:31], a[224:227], v[176:179], v[16:31]
    s_waitcnt vmcnt(30)
    v_mfma_f32_32x32x16_bf16 v[32:47], a[224:227], v[180:183], v[32:47]
    v_mfma_f32_32x32x16_bf16 v[48:63], a[228:231], v[176:179], v[48:63]
    v_mfma_f32_32x32x16_bf16 v[64:79], a[228:231], v[180:183], v[64:79]
    s_waitcnt vmcnt(29)
    v_mfma_f32_32x32x16_bf16 v[16:31], a[232:235], v[184:187], v[16:31]
    s_waitcnt vmcnt(28)
    v_mfma_f32_32x32x16_bf16 v[32:47], a[232:235], v[188:191], v[32:47]
    v_mfma_f32_32x32x16_bf16 v[48:63], a[236:239], v[184:187], v[48:63]
    v_mfma_f32_32x32x16_bf16 v[64:79], a[236:239], v[188:191], v[64:79]
    s_waitcnt vmcnt(27) lgkmcnt(15)
    v_mfma_f32_32x32x16_bf16 v[16:31], a[240:243], v[192:195], v[16:31]
    s_waitcnt vmcnt(26)
    v_mfma_f32_32x32x16_bf16 v[32:47], a[240:243], v[196:199], v[32:47]
    v_mfma_f32_32x32x16_bf16 v[48:63], a[244:247], v[192:195], v[48:63]
    v_mfma_f32_32x32x16_bf16 v[64:79], a[244:247], v[196:199], v[64:79]
    s_waitcnt vmcnt(25)
    v_mfma_f32_32x32x16_bf16 v[16:31], a[248:251], v[200:203], v[16:31]
    s_waitcnt vmcnt(24)
    v_mfma_f32_32x32x16_bf16 v[32:47], a[248:251], v[204:207], v[32:47]
    v_mfma_f32_32x32x16_bf16 v[48:63], a[252:255], v[200:203], v[48:63]
    v_mfma_f32_32x32x16_bf16 v[64:79], a[252:255], v[204:207], v[64:79]
    s_waitcnt vmcnt(23)
    v_mfma_f32_32x32x16_bf16 v[16:31], a[0:3], v[80:83], v[16:31]
    s_waitcnt vmcnt(22)
    v_mfma_f32_32x32x16_bf16 v[32:47], a[0:3], v[84:87], v[32:47]
    v_mfma_f32_32x32x16_bf16 v[48:63], a[4:7], v[80:83], v[48:63]
    v_mfma_f32_32x32x16_bf16 v[64:79], a[4:7], v[84:87], v[64:79]
    s_waitcnt vmcnt(21)
    v_mfma_f32_32x32x16_bf16 v[16:31], a[8:11], v[88:91], v[16:31]
    s_waitcnt vmcnt(20)
    v_mfma_f32_32x32x16_bf16 v[32:47], a[8:11], v[92:95], v[32:47]
    v_mfma_f32_32x32x16_bf16 v[48:63], a[12:15], v[88:91], v[48:63]
    v_mfma_f32_32x32x16_bf16 v[64:79], a[12:15], v[92:95], v[64:79]
    v_lshrrev_b32 v220, 5, v1
    v_lshlrev_b32 v220, 10, v220
    v_and_b32 v221, 31, v1
    v_lshl_add_u32 v220, v221, 2, v220
    s_lshr_b32 s69, s3, 1
    s_lshl_b32 s68, s69, 13
    s_and_b32 s69, s3, 1
    s_lshl_b32 s69, s69, 7
    s_add_u32 s68, s68, s69
    v_add_u32 v220, s68, v220
    v_xor_b32 v221, 128, v220
    v_xor_b32 v222, 0x2000, v220
    v_xor_b32 v223, 0x2080, v220
    s_mul_i32 s68, s3, 36864
    s_add_u32 s68, s68, 12288
    v_add_u32 v220, s68, v220
    v_add_u32 v221, s68, v221
    v_add_u32 v222, s68, v222
    v_add_u32 v223, s68, v223
    s_lshl_b32 s68, s3, 12
    s_add_u32 s68, s68, 12288
    v_add_u32 v224, s68, v4
    v_add_u32 v226, 73728, v224
    v_mul_u32_u24 v225, 896, v3
    v_lshl_add_u32 v225, v2, 3, v225
    s_lshl_b32 s68, s67, 2
    s_add_u32 s68, s68, s3
    s_mul_i32 s68, s68, 14336
    s_lshl_b32 s69, s66, 7
    s_add_u32 s68, s68, s69
    s_add_u32 s69, s68, 7168
    s_waitcnt vmcnt(19)
    v_mfma_f32_32x32x16_bf16 v[16:31], a[16:19], v[96:99], v[16:31]
    s_waitcnt vmcnt(18)
    v_mfma_f32_32x32x16_bf16 v[32:47], a[16:19], v[100:103], v[32:47]
    v_mfma_f32_32x32x16_bf16 v[48:63], a[20:23], v[96:99], v[48:63]
    v_mfma_f32_32x32x16_bf16 v[64:79], a[20:23], v[100:103], v[64:79]
    s_waitcnt vmcnt(17)
    v_mfma_f32_32x32x16_bf16 v[16:31], a[24:27], v[104:107], v[16:31]
    s_waitcnt vmcnt(16)
    v_mfma_f32_32x32x16_bf16 v[32:47], a[24:27], v[108:111], v[32:47]
    v_mfma_f32_32x32x16_bf16 v[48:63], a[28:31], v[104:107], v[48:63]
    v_mfma_f32_32x32x16_bf16 v[64:79], a[28:31], v[108:111], v[64:79]
    s_waitcnt vmcnt(15)
    v_mfma_f32_32x32x16_bf16 v[16:31], a[32:35], v[112:115], v[16:31]
    s_waitcnt vmcnt(14)
    v_mfma_f32_32x32x16_bf16 v[32:47], a[32:35], v[116:119], v[32:47]
    v_mfma_f32_32x32x16_bf16 v[48:63], a[36:39], v[112:115], v[48:63]
    v_mfma_f32_32x32x16_bf16 v[64:79], a[36:39], v[116:119], v[64:79]
    s_waitcnt vmcnt(13)
    v_mfma_f32_32x32x16_bf16 v[16:31], a[40:43], v[120:123], v[16:31]
    s_waitcnt vmcnt(12)
    v_mfma_f32_32x32x16_bf16 v[32:47], a[40:43], v[124:127], v[32:47]
    v_mfma_f32_32x32x16_bf16 v[48:63], a[44:47], v[120:123], v[48:63]
    v_mfma_f32_32x32x16_bf16 v[64:79], a[44:47], v[124:127], v[64:79]
    s_waitcnt vmcnt(11)
    v_mfma_f32_32x32x16_bf16 v[16:31], a[48:51], v[128:131], v[16:31]
    s_waitcnt vmcnt(10)
    v_mfma_f32_32x32x16_bf16 v[32:47], a[48:51], v[132:135], v[32:47]
    v_mfma_f32_32x32x16_bf16 v[48:63], a[52:55], v[128:131], v[48:63]
    v_mfma_f32_32x32x16_bf16 v[64:79], a[52:55], v[132:135], v[64:79]
    s_waitcnt vmcnt(9)
    v_mfma_f32_32x32x16_bf16 v[16:31], a[56:59], v[136:139], v[16:31]
    s_waitcnt vmcnt(8)
    v_mfma_f32_32x32x16_bf16 v[32:47], a[56:59], v[140:143], v[32:47]
    v_mfma_f32_32x32x16_bf16 v[48:63], a[60:63], v[136:139], v[48:63]
    v_mfma_f32_32x32x16_bf16 v[64:79], a[60:63], v[140:143], v[64:79]
    s_waitcnt vmcnt(6) lgkmcnt(12)
    v_mfma_f32_32x32x16_bf16 v[64:79], a[68:71], v[148:151], v[64:79]
    s_waitcnt vmcnt(4) lgkmcnt(8)
    v_mfma_f32_32x32x16_bf16 v[64:79], a[76:79], v[156:159], v[64:79]
    s_waitcnt vmcnt(2) lgkmcnt(4)
    v_mfma_f32_32x32x16_bf16 v[64:79], a[84:87], v[164:167], v[64:79]
    s_waitcnt vmcnt(0) lgkmcnt(0)
    v_mfma_f32_32x32x16_bf16 v[64:79], a[92:95], v[172:175], v[64:79]
    v_mfma_f32_32x32x16_bf16 v[48:63], a[68:71], v[144:147], v[48:63]
    v_mfma_f32_32x32x16_bf16 v[48:63], a[76:79], v[152:155], v[48:63]
    s_nop 9
    ds_write2st64_b32 v223, v64, v65 offset0:0 offset1:1
    ds_write2st64_b32 v223, v66, v67 offset0:2 offset1:3
    ds_write2st64_b32 v223, v68, v69 offset0:8 offset1:9
    v_mfma_f32_32x32x16_bf16 v[48:63], a[84:87], v[160:163], v[48:63]
    ds_write2st64_b32 v223, v70, v71 offset0:10 offset1:11
    ds_write2st64_b32 v223, v72, v73 offset0:16 offset1:17
    ds_write2st64_b32 v223, v74, v75 offset0:18 offset1:19
    v_mfma_f32_32x32x16_bf16 v[48:63], a[92:95], v[168:171], v[48:63]
    ds_write2st64_b32 v223, v76, v77 offset0:24 offset1:25
    ds_write2st64_b32 v223, v78, v79 offset0:26 offset1:27
    v_mfma_f32_32x32x16_bf16 v[32:47], a[64:67], v[148:151], v[32:47]
    v_mfma_f32_32x32x16_bf16 v[32:47], a[72:75], v[156:159], v[32:47]
    s_nop 7
    ds_write2st64_b32 v222, v48, v49 offset0:0 offset1:1
    ds_write2st64_b32 v222, v50, v51 offset0:2 offset1:3
    ds_write2st64_b32 v222, v52, v53 offset0:8 offset1:9
    v_mfma_f32_32x32x16_bf16 v[32:47], a[80:83], v[164:167], v[32:47]
    ds_write2st64_b32 v222, v54, v55 offset0:10 offset1:11
    ds_write2st64_b32 v222, v56, v57 offset0:16 offset1:17
    ds_write2st64_b32 v222, v58, v59 offset0:18 offset1:19
    v_mfma_f32_32x32x16_bf16 v[32:47], a[88:91], v[172:175], v[32:47]
    ds_write2st64_b32 v222, v60, v61 offset0:24 offset1:25
    ds_write2st64_b32 v222, v62, v63 offset0:26 offset1:27
    v_mfma_f32_32x32x16_bf16 v[16:31], a[64:67], v[144:147], v[16:31]
    v_mfma_f32_32x32x16_bf16 v[16:31], a[72:75], v[152:155], v[16:31]
    s_nop 7
    ds_write2st64_b32 v221, v32, v33 offset0:0 offset1:1
    ds_write2st64_b32 v221, v34, v35 offset0:2 offset1:3
    ds_write2st64_b32 v221, v36, v37 offset0:8 offset1:9
    v_mfma_f32_32x32x16_bf16 v[16:31], a[80:83], v[160:163], v[16:31]
    ds_write2st64_b32 v221, v38, v39 offset0:10 offset1:11
    ds_write2st64_b32 v221, v40, v41 offset0:16 offset1:17
    ds_write2st64_b32 v221, v42, v43 offset0:18 offset1:19
    v_mfma_f32_32x32x16_bf16 v[16:31], a[88:91], v[168:171], v[16:31]
    ds_write2st64_b32 v221, v44, v45 offset0:24 offset1:25
    ds_write2st64_b32 v221, v46, v47 offset0:26 offset1:27
    s_nop 9
    ds_write2st64_b32 v220, v16, v17 offset0:0 offset1:1
    ds_write2st64_b32 v220, v18, v19 offset0:2 offset1:3
    ds_write2st64_b32 v220, v20, v21 offset0:8 offset1:9
    ds_write2st64_b32 v220, v22, v23 offset0:10 offset1:11
    ds_write2st64_b32 v220, v24, v25 offset0:16 offset1:17
    ds_write2st64_b32 v220, v26, v27 offset0:18 offset1:19
    ds_write2st64_b32 v220, v28, v29 offset0:24 offset1:25
    ds_write2st64_b32 v220, v30, v31 offset0:26 offset1:27
    s_waitcnt lgkmcnt(0)
    s_barrier
    ds_read_b128 v[16:19], v224 offset:0
    ds_read_b128 v[20:23], v224 offset:36864
    ds_read_b128 v[24:27], v226 offset:0
    ds_read_b128 v[28:31], v226 offset:36864
    ds_read_b128 v[32:35], v224 offset:1024
    ds_read_b128 v[36:39], v224 offset:37888
    ds_read_b128 v[40:43], v226 offset:1024
    ds_read_b128 v[44:47], v226 offset:37888
    ds_read_b128 v[48:51], v224 offset:2048
    ds_read_b128 v[52:55], v224 offset:38912
    ds_read_b128 v[56:59], v226 offset:2048
    ds_read_b128 v[60:63], v226 offset:38912
    ds_read_b128 v[64:67], v224 offset:3072
    ds_read_b128 v[68:71], v224 offset:39936
    ds_read_b128 v[72:75], v226 offset:3072
    ds_read_b128 v[76:79], v226 offset:39936
    s_waitcnt lgkmcnt(14)
    v_pk_add_f32 v[16:17], v[16:17], v[20:21]
    s_waitcnt lgkmcnt(12)
    v_pk_add_f32 v[24:25], v[24:25], v[28:29]
    v_pk_add_f32 v[18:19], v[18:19], v[22:23]
    v_pk_add_f32 v[26:27], v[26:27], v[30:31]
    v_pk_add_f32 v[16:17], v[16:17], v[24:25]
    v_pk_add_f32 v[18:19], v[18:19], v[26:27]
    v_cvt_pk_bf16_f32 v20, v16, v17
    v_cvt_pk_bf16_f32 v21, v18, v19
    buffer_store_dwordx2 v[20:21], v225, s[36:39], s68 offen offset:0
    s_waitcnt lgkmcnt(10)
    v_pk_add_f32 v[32:33], v[32:33], v[36:37]
    s_waitcnt lgkmcnt(8)
    v_pk_add_f32 v[40:41], v[40:41], v[44:45]
    v_pk_add_f32 v[34:35], v[34:35], v[38:39]
    v_pk_add_f32 v[42:43], v[42:43], v[46:47]
    v_pk_add_f32 v[32:33], v[32:33], v[40:41]
    v_pk_add_f32 v[34:35], v[34:35], v[42:43]
    v_cvt_pk_bf16_f32 v36, v32, v33
    v_cvt_pk_bf16_f32 v37, v34, v35
    buffer_store_dwordx2 v[36:37], v225, s[36:39], s68 offen offset:3584
    s_waitcnt lgkmcnt(6)
    v_pk_add_f32 v[48:49], v[48:49], v[52:53]
    s_waitcnt lgkmcnt(4)
    v_pk_add_f32 v[56:57], v[56:57], v[60:61]
    v_pk_add_f32 v[50:51], v[50:51], v[54:55]
    v_pk_add_f32 v[58:59], v[58:59], v[62:63]
    v_pk_add_f32 v[48:49], v[48:49], v[56:57]
    v_pk_add_f32 v[50:51], v[50:51], v[58:59]
    v_cvt_pk_bf16_f32 v52, v48, v49
    v_cvt_pk_bf16_f32 v53, v50, v51
    buffer_store_dwordx2 v[52:53], v225, s[36:39], s69 offen offset:0
    s_waitcnt lgkmcnt(2)
    v_pk_add_f32 v[64:65], v[64:65], v[68:69]
    s_waitcnt lgkmcnt(0)
    v_pk_add_f32 v[72:73], v[72:73], v[76:77]
    v_pk_add_f32 v[66:67], v[66:67], v[70:71]
    v_pk_add_f32 v[74:75], v[74:75], v[78:79]
    v_pk_add_f32 v[64:65], v[64:65], v[72:73]
    v_pk_add_f32 v[66:67], v[66:67], v[74:75]
    v_cvt_pk_bf16_f32 v68, v64, v65
    v_cvt_pk_bf16_f32 v69, v66, v67
    buffer_store_dwordx2 v[68:69], v225, s[36:39], s69 offen offset:3584
L_end_P:
    s_endpgm

.section .rodata,"a"
.p2align 6
.amdhsa_kernel sequential_preLN__sliding_local_dilated__mixer_token_mlp__prompt_kernel
  .amdhsa_next_free_vgpr 508
  .amdhsa_next_free_sgpr 102
  .amdhsa_accum_offset 252
  .amdhsa_group_segment_fixed_size 0
  .amdhsa_kernarg_size 88
  .amdhsa_user_sgpr_count 2
  .amdhsa_user_sgpr_kernarg_segment_ptr 1
  .amdhsa_system_sgpr_workgroup_id_x 1
.end_amdhsa_kernel
```

```asm
; @launch grid=(256,1,1) block=(256,1,1) lds=163840
.amdgcn_target "amdgcn-amd-amdhsa--gfx950"
.text
.globl sequential_preLN__sliding_local_dilated__mixer_token_mlp__prompt_kernel
.p2align 8
.type sequential_preLN__sliding_local_dilated__mixer_token_mlp__prompt_kernel,@function
sequential_preLN__sliding_local_dilated__mixer_token_mlp__prompt_kernel:
    s_cmp_ge_u32 s2, 256
    s_cbranch_scc1 L_end_P
    s_load_dwordx2 s[8:9], s[0:1], 0
    s_load_dwordx2 s[12:13], s[0:1], 8
    s_load_dwordx2 s[44:45], s[0:1], 72
    s_load_dwordx2 s[40:41], s[0:1], 80
    s_load_dwordx2 s[16:17], s[0:1], 16
    s_load_dwordx2 s[20:21], s[0:1], 32
    s_load_dwordx2 s[24:25], s[0:1], 48
    s_load_dwordx2 s[28:29], s[0:1], 40
    s_load_dwordx2 s[32:33], s[0:1], 56
    s_load_dwordx2 s[36:37], s[0:1], 64
    v_lshrrev_b32 v1, 6, v0
    s_nop 0
    v_readfirstlane_b32 s3, v1
    v_and_b32 v1, 63, v0
    v_and_b32 v2, 15, v0
    v_lshrrev_b32 v3, 4, v1
    v_lshlrev_b32 v4, 4, v1
    s_mov_b32 s10, 0x1c0000
    s_mov_b32 s11, 0x00020000
    s_mov_b32 s14, 0x126000
    s_mov_b32 s15, 0x00020000
    s_mov_b32 s46, 0x100
    s_mov_b32 s47, 0x00020000
    s_mov_b32 s42, 0x5c0000
    s_mov_b32 s43, 0x00020000
    s_mov_b32 s18, 0x62000
    s_mov_b32 s19, 0x00020000
    s_mov_b32 s22, 0x700000
    s_mov_b32 s23, 0x00020000
    s_mov_b32 s26, 0x700000
    s_mov_b32 s27, 0x00020000
    s_mov_b32 s30, 0xe00
    s_mov_b32 s31, 0x00020000
    s_mov_b32 s34, 0x1000
    s_mov_b32 s35, 0x00020000
    s_mov_b32 s38, 0x1c0000
    s_mov_b32 s39, 0x00020000
    s_mov_b32 s5, 0x3f803f80
    s_mov_b32 s6, 0x40000
    s_bfe_u32 s48, s2, 0x20001
    s_lshl_b32 s48, s48, 2
    s_lshr_b32 s53, s2, 6
    s_add_u32 s48, s48, s53
    s_bfe_u32 s49, s2, 0x30003
    s_and_b32 s53, s2, 1
    s_lshl_b32 s53, s53, 3
    s_add_u32 s49, s49, s53
    v_lshrrev_b32 v237, 2, v1
    v_mul_u32_u24 v123, 2688, v237
    v_lshrrev_b32 v237, 5, v1
    v_lshlrev_b32 v237, 1, v237
    v_and_b32 v238, 3, v1
    v_xor_b32 v237, v237, v238
    v_lshl_add_u32 v123, v237, 4, v123
    s_mul_i32 s53, s49, 56
    s_min_u32 s53, s53, 832
    s_mul_i32 s51, s3, 43008
    s_add_u32 s53, s53, s51
    v_add_u32 v123, s53, v123
    s_lshr_b32 s53, s3, 1
    s_mul_i32 s51, s53, 6144
    s_and_b32 s53, s3, 1
    s_lshl_b32 s53, s53, 10
    s_add_u32 s51, s51, s53
    v_lshrrev_b32 v237, 3, v1
    v_mul_u32_u24 v122, 896, v237
    v_and_b32 v237, 7, v1
    v_xor_b32 v237, v237, v3
    v_lshl_add_u32 v120, v237, 4, v122
    s_lshl_b32 s50, s48, 7
    s_lshl_b32 s53, s3, 5
    s_add_u32 s53, s53, s50
    s_mul_i32 s53, s53, 896
    v_xor_b32 v121, 64, v120
    v_add_u32 v120, s53, v120
    s_add_u32 s53, s53, 7168
    v_add_u32 v121, s53, v121
    s_lshl_b32 s53, s3, 1
    v_xor_b32 v237, s53, v237
    v_lshl_add_u32 v122, v237, 4, v122
    s_lshl_b32 s53, s3, 2
    s_add_u32 s53, s53, s50
    s_sub_u32 s53, s53, 16
    s_mul_i32 s53, s53, 896
    s_cmp_eq_u32 s48, 0
    s_cselect_b32 s53, 0x40000000, s53
    v_add_u32 v122, s53, v122
    s_lshl_b32 s52, s3, 12
    s_add_u32 s52, s52, 63488
    s_lshl_b32 s7, s3, 9
    s_cmp_eq_u32 s3, 0
    s_cselect_b32 s54, 0xffffff00, -1
    s_mov_b32 s55, 0
    s_memrealtime s[86:87]
    v_mov_b32 v7, 0
    s_waitcnt lgkmcnt(0)
    s_or_b32 s86, s86, 1
    v_mov_b32 v6, s86
    s_or_b32 s86, s2, s3
    s_cmp_eq_u32 s86, 0
    s_cselect_b64 exec, 1, 0
    buffer_store_dword v6, v7, s[44:47], 0 offen sc1
    s_mov_b64 exec, -1
    s_add_u32 m0, s51, 12288
    s_mov_b32 s73, 0
    buffer_load_dwordx4 v123, s[12:15], s73 offen lds
    s_add_u32 m0, s51, 14336
    s_mov_b32 s73, 896
    buffer_load_dwordx4 v123, s[12:15], s73 offen lds
    s_add_u32 m0, s51, 16384
    s_mov_b32 s73, 1792
    buffer_load_dwordx4 v123, s[12:15], s73 offen lds
    s_add_u32 m0, s52, 36864
    s_mov_b32 s73, 0
    buffer_load_dwordx4 v120, s[8:11], s73 offen lds
    s_add_u32 m0, s52, 37888
    s_mov_b32 s73, 0
    buffer_load_dwordx4 v121, s[8:11], s73 offen lds
    s_add_u32 m0, s52, 38912
    s_mov_b32 s73, 14336
    buffer_load_dwordx4 v120, s[8:11], s73 offen lds
    s_add_u32 m0, s52, 39936
    s_mov_b32 s73, 14336
    buffer_load_dwordx4 v121, s[8:11], s73 offen lds
    s_add_u32 m0, s7, 98304
    s_mov_b32 s73, 0
    s_mov_b64 exec, s[54:55]
    buffer_load_dwordx4 v122, s[8:11], s73 offen lds
    s_mov_b64 exec, -1
    s_bfe_u32 s53, s2, 0x30003
    s_add_u32 s86, s53, 1
    s_lshr_b32 s86, s86, 1
    s_lshr_b32 s87, s2, 6
    s_mul_i32 s87, s87, 5
    s_add_u32 s86, s86, s87
    s_lshl_b32 s86, s86, 2
    s_add_u32 s53, s86, s3
    s_mov_b32 s56, s53
    s_mov_b32 s86, 0x2a54
    s_bitcmp1_b32 s86, s49
    s_cselect_b32 s57, 0x40000000, 0
    s_mul_i32 s86, s53, 48
    v_add_u32 v237, s86, v1
    v_mul_u32_u24 v238, 43691, v237
    v_lshrrev_b32 v238, 19, v238
    v_mul_u32_u24 v239, 12, v238
    v_sub_u32 v239, v237, v239
    v_lshrrev_b32 v239, 2, v239
    v_mul_u32_u24 v239, 896, v239
    v_mul_u32_u24 v238, 2688, v238
    v_and_b32 v237, 3, v237
    v_lshlrev_b32 v237, 7, v237
    v_add3_u32 v237, v237, v238, v239
    v_add_u32 v237, s57, v237
    s_and_b32 s86, s2, 1
    s_mul_i32 s86, s86, 384
    s_add_u32 s86, s86, 344064
    s_mov_b32 exec_hi, 0xffff
    buffer_load_dword v232, v237, s[12:15], s86 offen
    v_lshlrev_b32 v237, 7, v1
    v_add_u32 v238, s57, v237
    s_mul_i32 s86, s53, 6016
    s_bfe_u32 s87, s2, 0x20001
    s_mul_i32 s87, s87, 458752
    s_add_u32 s86, s86, s87
    s_max_u32 s86, s86, 14336
    s_sub_u32 s86, s86, 14336
    s_mov_b32 exec_hi, 0x7fff
    buffer_load_dword v233, v238, s[8:11], s86 offen
    s_getpc_b64 s[86:87]
Lpc_P:
    s_mul_i32 s53, s53, 384
    v_add_u32 v237, s53, v237
    v_min_u32 v237, L_end_P-Lpc_P, v237
    s_mov_b64 exec, 7
    global_load_dword v236, v237, s[86:87]
    s_mov_b64 exec, -1
    v_mul_u32_u24 v237, 18432, v3
    v_lshl_add_u32 v237, v2, 3, v237
    v_mov_b32 v238, s5
    v_add_u32 v237, 61440, v237
    ds_write2_b32 v237, v238, v238 offset0:0 offset1:1
    s_lshr_b32 s68, s2, 3
    s_mul_i32 s69, s68, 37
    s_lshr_b32 s69, s69, 8
    s_mul_i32 s64, s69, 7
    s_sub_u32 s64, s68, s64
    s_mov_b32 s66, s64
    s_and_b32 s68, s2, 7
    s_lshl_b32 s67, s68, 2
    s_add_u32 s67, s67, s69
    s_cmp_ge_u32 s69, 4
    s_cselect_b32 s67, 99, s67
    s_mul_i32 s71, s68, 3
    s_add_u32 s71, s71, 4
    s_lshl_b32 s72, s68, 2
    s_cmp_lt_u32 s68, 4
    s_cselect_b32 s65, s72, s71
    s_cselect_b32 s71, 4, 3
    s_add_u32 s65, s65, s69
    s_cmp_ge_u32 s69, s71
    s_cselect_b32 s65, 99, s65
    v_lshrrev_b32 v219, 3, v1
    v_mul_u32_u24 v208, 896, v219
    v_and_b32 v219, 1, v3
    v_lshlrev_b32 v219, 2, v219
    v_and_b32 v220, 7, v1
    v_xor_b32 v219, v219, v220
    v_lshl_add_u32 v208, v219, 4, v208
    s_lshl_b32 s58, s66, 7
    s_mul_i32 s60, s3, 100352
    s_add_u32 s58, s58, s60
    v_add_u32 v208, s58, v208
    s_mul_i32 s59, s3, 14336
    s_add_u32 s59, s59, 106496
    v_lshrrev_b32 v219, 5, v1
    v_lshlrev_b32 v209, 9, v219
    v_bfe_u32 v219, v1, 2, 2
    v_lshl_add_u32 v209, v219, 7, v209
    v_lshrrev_b32 v219, 1, v219
    s_and_b32 s58, s3, 1
    v_xor_b32 v219, s58, v219
    v_lshl_add_u32 v209, v219, 6, v209
    v_and_b32 v219, 1, v3
    v_lshl_add_u32 v209, v219, 5, v209
    v_and_b32 v219, 3, v1
    v_lshl_add_u32 v209, v219, 3, v209
    v_add_u32 v209, 106496, v209
    s_mul_i32 s70, s3, 36864
    s_add_u32 s70, s70, 12288
    v_lshrrev_b32 v219, 3, v1
    v_mul_u32_u24 v213, 3584, v219
    v_and_b32 v219, 1, v3
    v_lshlrev_b32 v219, 2, v219
    v_and_b32 v220, 7, v1
    v_xor_b32 v219, v219, v220
    v_lshl_add_u32 v213, v219, 4, v213
    s_mul_i32 s68, s3, 1835008
    s_lshl_b32 s69, s65, 7
    s_add_u32 s68, s68, s69
    s_cmp_ge_u32 s65, 99
    s_cselect_b32 s68, 0x40000000, s68
    v_add_u32 v213, s68, v213
    s_cselect_b32 s68, 0x40000000, 0
    v_add_u32 v5, s68, v4
    v_lshrrev_b32 v219, 5, v1
    v_lshlrev_b32 v215, 9, v219
    v_bfe_u32 v219, v1, 2, 2
    v_lshl_add_u32 v215, v219, 7, v215
    v_lshrrev_b32 v219, 1, v219
    s_lshr_b32 s68, s3, 1
    v_xor_b32 v219, s68, v219
    v_lshl_add_u32 v215, v219, 6, v215
    v_and_b32 v219, 1, v3
    v_lshl_add_u32 v215, v219, 5, v215
    v_and_b32 v219, 3, v1
    v_lshl_add_u32 v215, v219, 3, v215
    s_and_b32 s68, s3, 1
    s_lshl_b32 s68, s68, 5
    v_xor_b32 v215, s68, v215
    v_add_u32 v215, s70, v215
    v_xor_b32 v216, 64, v215
    s_mul_i32 s70, s3, 36864
    s_add_u32 s70, s70, 12288
    v_lshrrev_b32 v219, 3, v1
    v_mul_u32_u24 v214, 4096, v219
    v_and_b32 v219, 1, v3
    v_lshlrev_b32 v219, 2, v219
    v_and_b32 v220, 7, v1
    v_xor_b32 v219, v219, v220
    v_lshl_add_u32 v214, v219, 4, v214
    s_mul_i32 s68, s3, 1835008
    s_lshl_b32 s69, s67, 7
    s_add_u32 s68, s68, s69
    s_cmp_ge_u32 s67, 99
    s_cselect_b32 s68, 0x40000000, s68
    v_add_u32 v214, s68, v214
    v_lshrrev_b32 v219, 5, v1
    v_lshlrev_b32 v217, 9, v219
    v_bfe_u32 v219, v1, 2, 2
    v_lshl_add_u32 v217, v219, 7, v217
    v_lshrrev_b32 v219, 1, v219
    s_lshr_b32 s68, s3, 1
    v_xor_b32 v219, s68, v219
    v_lshl_add_u32 v217, v219, 6, v217
    v_and_b32 v219, 1, v3
    v_lshl_add_u32 v217, v219, 5, v217
    v_and_b32 v219, 3, v1
    v_lshl_add_u32 v217, v219, 3, v217
    v_add_u32 v217, s70, v217
    v_xor_b32 v218, 64, v217
    s_and_b32 s68, s2, 7
    s_cmp_ge_u32 s68, 8
    s_cselect_b32 s94, 8, 0
    s_sub_u32 s68, s68, s94
    s_lshl_b32 s94, s68, 12
    s_add_u32 s68, s68, 1
    s_cmp_ge_u32 s68, 8
    s_cselect_b32 s95, 8, 0
    s_sub_u32 s68, s68, s95
    s_lshl_b32 s95, s68, 12
    s_add_u32 s68, s68, 1
    s_cmp_ge_u32 s68, 8
    s_cselect_b32 s96, 8, 0
    s_sub_u32 s68, s68, s96
    s_lshl_b32 s96, s68, 12
    s_add_u32 s68, s68, 1
    s_cmp_ge_u32 s68, 8
    s_cselect_b32 s97, 8, 0
    s_sub_u32 s68, s68, s97
    s_lshl_b32 s97, s68, 12
    s_add_u32 s68, s68, 1
    s_cmp_ge_u32 s68, 8
    s_cselect_b32 s98, 8, 0
    s_sub_u32 s68, s68, s98
    s_lshl_b32 s98, s68, 12
    s_add_u32 s68, s68, 1
    s_cmp_ge_u32 s68, 8
    s_cselect_b32 s99, 8, 0
    s_sub_u32 s68, s68, s99
    s_lshl_b32 s99, s68, 12
    s_add_u32 s68, s68, 1
    s_cmp_ge_u32 s68, 8
    s_cselect_b32 s100, 8, 0
    s_sub_u32 s68, s68, s100
    s_lshl_b32 s100, s68, 12
    s_add_u32 s68, s68, 1
    s_cmp_ge_u32 s68, 8
    s_cselect_b32 s101, 8, 0
    s_sub_u32 s68, s68, s101
    s_lshl_b32 s101, s68, 12
    s_lshl_b32 s80, s48, 2
    s_add_u32 s80, s80, s3
    s_lshl_b32 s80, s80, 11
    s_lshr_b32 s79, s49, 2
    s_lshl_b32 s79, s79, 7
    s_add_u32 s80, s80, s79
    s_and_b32 s79, s49, 3
    s_lshl_b32 s79, s79, 2
    s_add_u32 s80, s80, s79
    s_add_u32 s80, s80, 0x588000
    s_lshl_b32 s83, s67, 1
    s_lshr_b32 s79, s3, 1
    s_add_u32 s83, s83, s79
    s_lshl_b32 s83, s83, 11
    s_add_u32 s83, s83, 0x588000
    v_lshrrev_b32 v10, 2, v2
    v_lshlrev_b32 v10, 7, v10
    v_and_b32 v219, 3, v2
    v_lshl_add_u32 v10, v219, 2, v10
    s_lshl_b32 s84, s64, 12
    s_lshl_b32 s85, s84, 1
    s_add_u32 s85, s85, 0x5b0000
    s_add_u32 s84, s84, 0x5a8000
    s_lshl_b32 s81, s67, 5
    s_add_u32 s81, s81, s3
    s_lshl_b32 s81, s81, 2
    s_add_u32 s81, s81, s84
    s_lshl_b32 s79, s3, 10
    s_add_u32 s84, s84, s79
    v_bfe_u32 v11, v1, 2, 3
    v_min_u32 v12, 6, v11
    v_and_b32 v219, 3, v1
    v_lshlrev_b32 v219, 2, v219
    v_lshl_add_u32 v11, v11, 7, v219
    v_lshl_add_u32 v12, v12, 7, v219
    s_lshl_b32 s82, s65, 5
    s_add_u32 s82, s82, s3
    s_lshl_b32 s82, s82, 2
    s_add_u32 s82, s82, s85
    s_mul_i32 s79, s3, 896
    s_add_u32 s85, s85, s79
    v_mov_b32 v9, 0
    v_lshlrev_b32 v124, 9, v3
    v_bfe_u32 v237, v1, 2, 2
    v_lshl_add_u32 v124, v237, 6, v124
    v_and_b32 v237, 3, v1
    v_lshl_add_u32 v124, v237, 3, v124
    v_and_b32 v237, 1, v3
    v_lshlrev_b32 v237, 5, v237
    v_add_u32 v124, v124, v237
    v_add_u32 v124, 12288, v124
    v_xor_b32 v125, 32, v124
    s_and_b32 s53, s3, 1
    s_lshl_b32 s53, s53, 5
    v_xor_b32 v127, s53, v124
    s_lshr_b32 s53, s3, 1
    s_lshl_b32 s53, s53, 11
    s_add_u32 s53, s53, 2048
    v_add_u32 v126, s53, v127
    v_lshrrev_b32 v237, 1, v2
    v_xor_b32 v237, v237, v3
    v_lshlrev_b32 v237, 4, v237
    v_lshl_add_u32 v237, v2, 7, v237
    v_add_u32 v130, 61440, v237
    v_xor_b32 v131, 64, v130
    v_add_u32 v128, s52, v237
    v_xor_b32 v129, 64, v128
    v_lshlrev_b32 v237, 2, v3
    v_sub_u32 v237, v2, v237
    v_mov_b32 v239, 0xf149f2ca
    v_add_u32 v238, 16, v237
    v_and_b32 v238, 0xfffffff1, v238
    v_cmp_eq_u32 vcc, 0, v238
    s_nop 1
    v_cndmask_b32 v240, v239, 0, vcc
    v_add_u32 v238, 15, v237
    v_and_b32 v238, 0xfffffff1, v238
    v_cmp_eq_u32 vcc, 0, v238
    s_nop 1
    v_cndmask_b32 v241, v239, 0, vcc
    v_add_u32 v238, 14, v237
    v_and_b32 v238, 0xfffffff1, v238
    v_cmp_eq_u32 vcc, 0, v238
    s_nop 1
    v_cndmask_b32 v242, v239, 0, vcc
    v_add_u32 v238, 13, v237
    v_and_b32 v238, 0xfffffff1, v238
    v_cmp_eq_u32 vcc, 0, v238
    s_nop 1
    v_cndmask_b32 v243, v239, 0, vcc
    v_add_u32 v238, 0, v237
    v_and_b32 v238, 0xfffffff1, v238
    v_cmp_eq_u32 vcc, 0, v238
    s_nop 1
    v_cndmask_b32 v244, v239, 0, vcc
    v_add_u32 v238, -1, v237
    v_and_b32 v238, 0xfffffff1, v238
    v_cmp_eq_u32 vcc, 0, v238
    s_nop 1
    v_cndmask_b32 v245, v239, 0, vcc
    v_add_u32 v238, -2, v237
    v_and_b32 v238, 0xfffffff1, v238
    v_cmp_eq_u32 vcc, 0, v238
    s_nop 1
    v_cndmask_b32 v246, v239, 0, vcc
    v_add_u32 v238, -3, v237
    v_and_b32 v238, 0xfffffff1, v238
    v_cmp_eq_u32 vcc, 0, v238
    s_nop 1
    v_cndmask_b32 v247, v239, 0, vcc
    s_or_b32 s53, s48, s3
    s_cmp_eq_u32 s53, 0
    s_cselect_b64 vcc, -1, 0
    v_cndmask_b32 v248, v240, v239, vcc
    v_cndmask_b32 v249, v241, v239, vcc
    v_cndmask_b32 v250, v242, v239, vcc
    v_cndmask_b32 v251, v243, v239, vcc
    v_mov_b32 v40, s5
    v_mov_b32 v41, s5
    v_mov_b32 v42, s5
    v_mov_b32 v43, s5
    s_mov_b32 s88, 0x22222222
    s_mov_b32 s89, 0x22222222
    s_mov_b32 s90, 0x44444444
    s_mov_b32 s91, 0x44444444
    s_mov_b32 s92, 0x88888888
    s_mov_b32 s93, 0x88888888
    v_lshlrev_b32 v72, 4, v3
    s_lshl_b32 s53, s3, 6
    v_add_u32 v73, s53, v72
    s_and_b32 s53, s53, 64
    v_add_u32 v74, s53, v72
    s_mul_i32 s53, s3, 384
    v_lshl_add_u32 v75, v2, 2, s53
    v_add_u32 v76, s53, v72
    s_and_b32 s53, s3, 1
    s_lshl_b32 s53, s53, 3
    v_add_u32 v80, s53, v4
    v_lshrrev_b32 v81, 2, v2
    v_lshlrev_b32 v81, 8, v81
    v_lshl_add_u32 v81, v3, 6, v81
    v_and_b32 v82, 3, v2
    v_lshl_add_u32 v81, v82, 1, v81
    v_add_u32 v81, s53, v81
    v_add_u32 v81, 1024, v81
    s_cmp_lt_u32 s3, 2
    s_cselect_b64 vcc, -1, 0
    s_cselect_b32 s53, 2, 16
    v_cndmask_b32 v80, v81, v80, vcc
    v_add_u32 v81, s53, v80
    v_add_u32 v82, s53, v81
    v_add_u32 v83, s53, v82
    v_lshlrev_b32 v77, 2, v2
    s_lshl_b32 s53, s3, 11
    v_add_u32 v78, s53, v4
    s_lshl_b32 s62, s48, 3
    s_lshl_b32 s63, s3, 1
    s_add_u32 s62, s62, s63
    s_lshl_b32 s62, s62, 4
    s_add_u32 s62, s62, s49
    s_lshl_b32 s62, s62, 10
    s_add_u32 s63, s62, 16384
    s_add_u32 m0, s51, 24576
    s_mov_b32 s73, 172032
    buffer_load_dwordx4 v123, s[12:15], s73 offen lds
    s_add_u32 m0, s51, 26624
    s_mov_b32 s73, 172928
    buffer_load_dwordx4 v123, s[12:15], s73 offen lds
    s_add_u32 m0, s51, 28672
    s_mov_b32 s73, 173824
    buffer_load_dwordx4 v123, s[12:15], s73 offen lds
    s_add_u32 m0, s52, 18432
    s_mov_b32 s73, 128
    buffer_load_dwordx4 v120, s[8:11], s73 offen lds
    s_add_u32 m0, s52, 19456
    s_mov_b32 s73, 128
    buffer_load_dwordx4 v121, s[8:11], s73 offen lds
    s_add_u32 m0, s52, 20480
    s_mov_b32 s73, 14464
    buffer_load_dwordx4 v120, s[8:11], s73 offen lds
    s_add_u32 m0, s52, 21504
    s_mov_b32 s73, 14464
    buffer_load_dwordx4 v121, s[8:11], s73 offen lds
    s_add_u32 m0, s7, 79872
    s_mov_b32 s73, 128
    s_mov_b64 exec, s[54:55]
    buffer_load_dwordx4 v122, s[8:11], s73 offen lds
    s_mov_b64 exec, -1
    s_waitcnt vmcnt(11)
    s_waitcnt lgkmcnt(0)
    s_barrier
    ds_read_b128 v[16:19], v128 offset:36864
    ds_read_b128 v[20:23], v128 offset:38912
    ds_read_b128 v[24:27], v130 offset:36864
    ds_read_b64_tr_b16 v[88:89], v124 offset:0
    ds_read_b64_tr_b16 v[90:91], v124 offset:256
    ds_read_b64_tr_b16 v[92:93], v125 offset:0
    ds_read_b64_tr_b16 v[94:95], v125 offset:256
    ds_read_b64_tr_b16 v[96:97], v124 offset:2048
    ds_read_b64_tr_b16 v[98:99], v124 offset:2304
    ds_read_b64_tr_b16 v[100:101], v125 offset:2048
    ds_read_b64_tr_b16 v[102:103], v125 offset:2304
    ds_read_b64_tr_b16 v[104:105], v124 offset:4096
    ds_read_b64_tr_b16 v[106:107], v124 offset:4352
    ds_read_b64_tr_b16 v[108:109], v125 offset:4096
    ds_read_b64_tr_b16 v[110:111], v125 offset:4352
    ds_read_b64_tr_b16 v[112:113], v126 offset:0
    ds_read_b64_tr_b16 v[114:115], v126 offset:256
    ds_read_b64_tr_b16 v[116:117], v127 offset:0
    ds_read_b64_tr_b16 v[118:119], v127 offset:256
    s_waitcnt lgkmcnt(8)
    v_mfma_f32_16x16x32_bf16 v[136:139], v[88:91], v[16:19], 0
    ds_read_b128 v[28:31], v129 offset:36864
    v_mfma_f32_16x16x32_bf16 v[160:163], v[88:91], v[20:23], 0
    ds_read_b128 v[32:35], v129 offset:38912
    v_mfma_f32_16x16x32_bf16 v[140:143], v[92:95], v[16:19], 0
    ds_read_b128 v[36:39], v131 offset:36864
    v_mfma_f32_16x16x32_bf16 v[164:167], v[92:95], v[20:23], 0
    ds_read_b64_tr_b16 v[88:89], v124 offset:6144
    v_mfma_f32_16x16x32_bf16 v[144:147], v[96:99], v[16:19], 0
    ds_read_b64_tr_b16 v[90:91], v124 offset:6400
    s_add_u32 m0, s51, 36864
    s_mov_b32 s73, 344064
    buffer_load_dwordx4 v123, s[12:15], s73 offen lds
    v_mfma_f32_16x16x32_bf16 v[168:171], v[96:99], v[20:23], 0
    ds_read_b64_tr_b16 v[92:93], v125 offset:6144
    v_mfma_f32_16x16x32_bf16 v[148:151], v[100:103], v[16:19], 0
    ds_read_b64_tr_b16 v[94:95], v125 offset:6400
    v_mfma_f32_16x16x32_bf16 v[172:175], v[100:103], v[20:23], 0
    ds_read_b64_tr_b16 v[96:97], v124 offset:8192
    s_waitcnt lgkmcnt(8)
    v_mfma_f32_16x16x32_bf16 v[152:155], v[16:19], v[104:107], 0
    ds_read_b64_tr_b16 v[98:99], v124 offset:8448
    v_mfma_f32_16x16x32_bf16 v[176:179], v[20:23], v[104:107], 0
    ds_read_b64_tr_b16 v[100:101], v125 offset:8192
    s_add_u32 m0, s51, 38912
    s_mov_b32 s73, 344960
    buffer_load_dwordx4 v123, s[12:15], s73 offen lds
    v_mfma_f32_16x16x32_bf16 v[156:159], v[16:19], v[108:111], 0
    ds_read_b64_tr_b16 v[102:103], v125 offset:8448
    v_mfma_f32_16x16x32_bf16 v[180:183], v[20:23], v[108:111], 0
    ds_read_b64_tr_b16 v[104:105], v124 offset:10240
    v_mfma_f32_16x16x32_bf16 v[184:187], v[112:115], v[24:27], 0
    ds_read_b64_tr_b16 v[106:107], v124 offset:10496
    v_mfma_f32_16x16x32_bf16 v[188:191], v[116:119], v[24:27], 0
    ds_read_b64_tr_b16 v[108:109], v125 offset:10240
    v_mfma_f32_16x16x32_bf16 v[48:51], v[16:19], v[16:19], 0
    ds_read_b64_tr_b16 v[110:111], v125 offset:10496
    s_add_u32 m0, s51, 40960
    s_mov_b32 s73, 345856
    buffer_load_dwordx4 v123, s[12:15], s73 offen lds
    v_mfma_f32_16x16x32_bf16 v[52:55], v[20:23], v[20:23], 0
    ds_read_b64_tr_b16 v[112:113], v126 offset:6144
    v_mfma_f32_16x16x32_bf16 v[56:59], v[24:27], v[24:27], 0
    ds_read_b64_tr_b16 v[114:115], v126 offset:6400
    v_mfma_f32_16x16x32_bf16 v[60:63], v[40:43], v[16:19], 0
    ds_read_b64_tr_b16 v[116:117], v127 offset:6144
    v_mfma_f32_16x16x32_bf16 v[64:67], v[40:43], v[20:23], 0
    ds_read_b64_tr_b16 v[118:119], v127 offset:6400
    v_mfma_f32_16x16x32_bf16 v[68:71], v[40:43], v[24:27], 0
    s_add_u32 m0, s52, 0
    s_mov_b32 s73, 256
    buffer_load_dwordx4 v120, s[8:11], s73 offen lds
    s_add_u32 m0, s52, 1024
    s_mov_b32 s73, 256
    buffer_load_dwordx4 v121, s[8:11], s73 offen lds
    s_add_u32 m0, s52, 2048
    s_mov_b32 s73, 14592
    buffer_load_dwordx4 v120, s[8:11], s73 offen lds
    s_add_u32 m0, s52, 3072
    s_mov_b32 s73, 14592
    buffer_load_dwordx4 v121, s[8:11], s73 offen lds
    s_add_u32 m0, s7, 61440
    s_mov_b32 s73, 256
    s_mov_b64 exec, s[54:55]
    buffer_load_dwordx4 v122, s[8:11], s73 offen lds
    s_mov_b64 exec, -1
    s_waitcnt vmcnt(8)
    s_barrier
    s_waitcnt lgkmcnt(8)
    v_mfma_f32_16x16x32_bf16 v[136:139], v[88:91], v[28:31], v[136:139]
    ds_read_b128 v[16:19], v128 offset:18432
    v_mfma_f32_16x16x32_bf16 v[160:163], v[88:91], v[32:35], v[160:163]
    ds_read_b128 v[20:23], v128 offset:20480
    v_mfma_f32_16x16x32_bf16 v[140:143], v[92:95], v[28:31], v[140:143]
    ds_read_b128 v[24:27], v130 offset:18432
    v_mfma_f32_16x16x32_bf16 v[164:167], v[92:95], v[32:35], v[164:167]
    ds_read_b64_tr_b16 v[88:89], v124 offset:12288
    v_mfma_f32_16x16x32_bf16 v[144:147], v[96:99], v[28:31], v[144:147]
    ds_read_b64_tr_b16 v[90:91], v124 offset:12544
    s_add_u32 m0, s51, 49152
    s_mov_b32 s73, 516096
    buffer_load_dwordx4 v123, s[12:15], s73 offen lds
    v_mfma_f32_16x16x32_bf16 v[168:171], v[96:99], v[32:35], v[168:171]
    ds_read_b64_tr_b16 v[92:93], v125 offset:12288
    v_mfma_f32_16x16x32_bf16 v[148:151], v[100:103], v[28:31], v[148:151]
    ds_read_b64_tr_b16 v[94:95], v125 offset:12544
    v_mfma_f32_16x16x32_bf16 v[172:175], v[100:103], v[32:35], v[172:175]
    ds_read_b64_tr_b16 v[96:97], v124 offset:14336
    s_waitcnt lgkmcnt(8)
    v_mfma_f32_16x16x32_bf16 v[152:155], v[28:31], v[104:107], v[152:155]
    ds_read_b64_tr_b16 v[98:99], v124 offset:14592
    v_mfma_f32_16x16x32_bf16 v[176:179], v[32:35], v[104:107], v[176:179]
    ds_read_b64_tr_b16 v[100:101], v125 offset:14336
    s_add_u32 m0, s51, 51200
    s_mov_b32 s73, 516992
    buffer_load_dwordx4 v123, s[12:15], s73 offen lds
    v_mfma_f32_16x16x32_bf16 v[156:159], v[28:31], v[108:111], v[156:159]
    ds_read_b64_tr_b16 v[102:103], v125 offset:14592
    v_mfma_f32_16x16x32_bf16 v[180:183], v[32:35], v[108:111], v[180:183]
    ds_read_b64_tr_b16 v[104:105], v124 offset:16384
    v_mfma_f32_16x16x32_bf16 v[184:187], v[112:115], v[36:39], v[184:187]
    ds_read_b64_tr_b16 v[106:107], v124 offset:16640
    v_mfma_f32_16x16x32_bf16 v[188:191], v[116:119], v[36:39], v[188:191]
    ds_read_b64_tr_b16 v[108:109], v125 offset:16384
    v_mfma_f32_16x16x32_bf16 v[48:51], v[28:31], v[28:31], v[48:51]
    ds_read_b64_tr_b16 v[110:111], v125 offset:16640
    s_add_u32 m0, s51, 53248
    s_mov_b32 s73, 517888
    buffer_load_dwordx4 v123, s[12:15], s73 offen lds
    v_mfma_f32_16x16x32_bf16 v[52:55], v[32:35], v[32:35], v[52:55]
    ds_read_b64_tr_b16 v[112:113], v126 offset:12288
    v_mfma_f32_16x16x32_bf16 v[56:59], v[36:39], v[36:39], v[56:59]
    ds_read_b64_tr_b16 v[114:115], v126 offset:12544
    v_mfma_f32_16x16x32_bf16 v[60:63], v[40:43], v[28:31], v[60:63]
    ds_read_b64_tr_b16 v[116:117], v127 offset:12288
    v_mfma_f32_16x16x32_bf16 v[64:67], v[40:43], v[32:35], v[64:67]
    ds_read_b64_tr_b16 v[118:119], v127 offset:12544
    v_mfma_f32_16x16x32_bf16 v[68:71], v[40:43], v[36:39], v[68:71]
    s_add_u32 m0, s52, 55296
    s_mov_b32 s73, 384
    buffer_load_dwordx4 v120, s[8:11], s73 offen lds
    s_waitcnt lgkmcnt(8)
    v_mfma_f32_16x16x32_bf16 v[136:139], v[88:91], v[16:19], v[136:139]
    ds_read_b128 v[28:31], v129 offset:18432
    v_mfma_f32_16x16x32_bf16 v[160:163], v[88:91], v[20:23], v[160:163]
    ds_read_b128 v[32:35], v129 offset:20480
    v_mfma_f32_16x16x32_bf16 v[140:143], v[92:95], v[16:19], v[140:143]
    ds_read_b128 v[36:39], v131 offset:18432
    v_mfma_f32_16x16x32_bf16 v[164:167], v[92:95], v[20:23], v[164:167]
    ds_read_b64_tr_b16 v[88:89], v124 offset:18432
    v_mfma_f32_16x16x32_bf16 v[144:147], v[96:99], v[16:19], v[144:147]
    ds_read_b64_tr_b16 v[90:91], v124 offset:18688
    s_add_u32 m0, s52, 56320
    s_mov_b32 s73, 384
    buffer_load_dwordx4 v121, s[8:11], s73 offen lds
    v_mfma_f32_16x16x32_bf16 v[168:171], v[96:99], v[20:23], v[168:171]
    ds_read_b64_tr_b16 v[92:93], v125 offset:18432
    v_mfma_f32_16x16x32_bf16 v[148:151], v[100:103], v[16:19], v[148:151]
    ds_read_b64_tr_b16 v[94:95], v125 offset:18688
    v_mfma_f32_16x16x32_bf16 v[172:175], v[100:103], v[20:23], v[172:175]
    ds_read_b64_tr_b16 v[96:97], v124 offset:20480
    s_waitcnt lgkmcnt(8)
    v_mfma_f32_16x16x32_bf16 v[152:155], v[16:19], v[104:107], v[152:155]
    ds_read_b64_tr_b16 v[98:99], v124 offset:20736
    v_mfma_f32_16x16x32_bf16 v[176:179], v[20:23], v[104:107], v[176:179]
    ds_read_b64_tr_b16 v[100:101], v125 offset:20480
    s_add_u32 m0, s52, 57344
    s_mov_b32 s73, 14720
    buffer_load_dwordx4 v120, s[8:11], s73 offen lds
    v_mfma_f32_16x16x32_bf16 v[156:159], v[16:19], v[108:111], v[156:159]
    ds_read_b64_tr_b16 v[102:103], v125 offset:20736
    v_mfma_f32_16x16x32_bf16 v[180:183], v[20:23], v[108:111], v[180:183]
    ds_read_b64_tr_b16 v[104:105], v124 offset:22528
    v_mfma_f32_16x16x32_bf16 v[184:187], v[112:115], v[24:27], v[184:187]
    ds_read_b64_tr_b16 v[106:107], v124 offset:22784
    v_mfma_f32_16x16x32_bf16 v[188:191], v[116:119], v[24:27], v[188:191]
    ds_read_b64_tr_b16 v[108:109], v125 offset:22528
    v_mfma_f32_16x16x32_bf16 v[48:51], v[16:19], v[16:19], v[48:51]
    ds_read_b64_tr_b16 v[110:111], v125 offset:22784
    s_add_u32 m0, s52, 58368
    s_mov_b32 s73, 14720
    buffer_load_dwordx4 v121, s[8:11], s73 offen lds
    v_mfma_f32_16x16x32_bf16 v[52:55], v[20:23], v[20:23], v[52:55]
    ds_read_b64_tr_b16 v[112:113], v126 offset:18432
    v_mfma_f32_16x16x32_bf16 v[56:59], v[24:27], v[24:27], v[56:59]
    ds_read_b64_tr_b16 v[114:115], v126 offset:18688
    v_mfma_f32_16x16x32_bf16 v[60:63], v[40:43], v[16:19], v[60:63]
    ds_read_b64_tr_b16 v[116:117], v127 offset:18432
    v_mfma_f32_16x16x32_bf16 v[64:67], v[40:43], v[20:23], v[64:67]
    ds_read_b64_tr_b16 v[118:119], v127 offset:18688
    v_mfma_f32_16x16x32_bf16 v[68:71], v[40:43], v[24:27], v[68:71]
    s_add_u32 m0, s7, 116736
    s_mov_b32 s73, 384
    s_mov_b64 exec, s[54:55]
    buffer_load_dwordx4 v122, s[8:11], s73 offen lds
    s_mov_b64 exec, -1
    s_waitcnt vmcnt(8)
    s_barrier
    s_waitcnt lgkmcnt(8)
    v_mfma_f32_16x16x32_bf16 v[136:139], v[88:91], v[28:31], v[136:139]
    ds_read_b128 v[16:19], v128 offset:0
    v_mfma_f32_16x16x32_bf16 v[160:163], v[88:91], v[32:35], v[160:163]
    ds_read_b128 v[20:23], v128 offset:2048
    v_mfma_f32_16x16x32_bf16 v[140:143], v[92:95], v[28:31], v[140:143]
    ds_read_b128 v[24:27], v130 offset:0
    v_mfma_f32_16x16x32_bf16 v[164:167], v[92:95], v[32:35], v[164:167]
    ds_read_b64_tr_b16 v[88:89], v124 offset:24576
    v_mfma_f32_16x16x32_bf16 v[144:147], v[96:99], v[28:31], v[144:147]
    ds_read_b64_tr_b16 v[90:91], v124 offset:24832
    s_add_u32 m0, s51, 12288
    s_mov_b32 s73, 688128
    buffer_load_dwordx4 v123, s[12:15], s73 offen lds
    v_mfma_f32_16x16x32_bf16 v[168:171], v[96:99], v[32:35], v[168:171]
    ds_read_b64_tr_b16 v[92:93], v125 offset:24576
    v_mfma_f32_16x16x32_bf16 v[148:151], v[100:103], v[28:31], v[148:151]
    ds_read_b64_tr_b16 v[94:95], v125 offset:24832
    v_mfma_f32_16x16x32_bf16 v[172:175], v[100:103], v[32:35], v[172:175]
    ds_read_b64_tr_b16 v[96:97], v124 offset:26624
    s_waitcnt lgkmcnt(8)
    v_mfma_f32_16x16x32_bf16 v[152:155], v[28:31], v[104:107], v[152:155]
    ds_read_b64_tr_b16 v[98:99], v124 offset:26880
    v_mfma_f32_16x16x32_bf16 v[176:179], v[32:35], v[104:107], v[176:179]
    ds_read_b64_tr_b16 v[100:101], v125 offset:26624
    s_add_u32 m0, s51, 14336
    s_mov_b32 s73, 689024
    buffer_load_dwordx4 v123, s[12:15], s73 offen lds
    v_mfma_f32_16x16x32_bf16 v[156:159], v[28:31], v[108:111], v[156:159]
    ds_read_b64_tr_b16 v[102:103], v125 offset:26880
    v_mfma_f32_16x16x32_bf16 v[180:183], v[32:35], v[108:111], v[180:183]
    ds_read_b64_tr_b16 v[104:105], v124 offset:28672
    v_mfma_f32_16x16x32_bf16 v[184:187], v[112:115], v[36:39], v[184:187]
    ds_read_b64_tr_b16 v[106:107], v124 offset:28928
    v_mfma_f32_16x16x32_bf16 v[188:191], v[116:119], v[36:39], v[188:191]
    ds_read_b64_tr_b16 v[108:109], v125 offset:28672
    v_mfma_f32_16x16x32_bf16 v[48:51], v[28:31], v[28:31], v[48:51]
    ds_read_b64_tr_b16 v[110:111], v125 offset:28928
    s_add_u32 m0, s51, 16384
    s_mov_b32 s73, 689920
    buffer_load_dwordx4 v123, s[12:15], s73 offen lds
    v_mfma_f32_16x16x32_bf16 v[52:55], v[32:35], v[32:35], v[52:55]
    ds_read_b64_tr_b16 v[112:113], v126 offset:24576
    v_mfma_f32_16x16x32_bf16 v[56:59], v[36:39], v[36:39], v[56:59]
    ds_read_b64_tr_b16 v[114:115], v126 offset:24832
    v_mfma_f32_16x16x32_bf16 v[60:63], v[40:43], v[28:31], v[60:63]
    ds_read_b64_tr_b16 v[116:117], v127 offset:24576
    v_mfma_f32_16x16x32_bf16 v[64:67], v[40:43], v[32:35], v[64:67]
    ds_read_b64_tr_b16 v[118:119], v127 offset:24832
    v_mfma_f32_16x16x32_bf16 v[68:71], v[40:43], v[36:39], v[68:71]
    s_add_u32 m0, s52, 36864
    s_mov_b32 s73, 512
    buffer_load_dwordx4 v120, s[8:11], s73 offen lds
    s_waitcnt lgkmcnt(8)
    v_mfma_f32_16x16x32_bf16 v[136:139], v[88:91], v[16:19], v[136:139]
    ds_read_b128 v[28:31], v129 offset:0
    v_mfma_f32_16x16x32_bf16 v[160:163], v[88:91], v[20:23], v[160:163]
    ds_read_b128 v[32:35], v129 offset:2048
    v_mfma_f32_16x16x32_bf16 v[140:143], v[92:95], v[16:19], v[140:143]
    ds_read_b128 v[36:39], v131 offset:0
    v_mfma_f32_16x16x32_bf16 v[164:167], v[92:95], v[20:23], v[164:167]
    ds_read_b64_tr_b16 v[88:89], v124 offset:30720
    v_mfma_f32_16x16x32_bf16 v[144:147], v[96:99], v[16:19], v[144:147]
    ds_read_b64_tr_b16 v[90:91], v124 offset:30976
    s_add_u32 m0, s52, 37888
    s_mov_b32 s73, 512
    buffer_load_dwordx4 v121, s[8:11], s73 offen lds
    v_mfma_f32_16x16x32_bf16 v[168:171], v[96:99], v[20:23], v[168:171]
    ds_read_b64_tr_b16 v[92:93], v125 offset:30720
    v_mfma_f32_16x16x32_bf16 v[148:151], v[100:103], v[16:19], v[148:151]
    ds_read_b64_tr_b16 v[94:95], v125 offset:30976
    v_mfma_f32_16x16x32_bf16 v[172:175], v[100:103], v[20:23], v[172:175]
    ds_read_b64_tr_b16 v[96:97], v124 offset:32768
    s_waitcnt lgkmcnt(8)
    v_mfma_f32_16x16x32_bf16 v[152:155], v[16:19], v[104:107], v[152:155]
    ds_read_b64_tr_b16 v[98:99], v124 offset:33024
    v_mfma_f32_16x16x32_bf16 v[176:179], v[20:23], v[104:107], v[176:179]
    ds_read_b64_tr_b16 v[100:101], v125 offset:32768
    s_add_u32 m0, s52, 38912
    s_mov_b32 s73, 14848
    buffer_load_dwordx4 v120, s[8:11], s73 offen lds
    v_mfma_f32_16x16x32_bf16 v[156:159], v[16:19], v[108:111], v[156:159]
    ds_read_b64_tr_b16 v[102:103], v125 offset:33024
    v_mfma_f32_16x16x32_bf16 v[180:183], v[20:23], v[108:111], v[180:183]
    ds_read_b64_tr_b16 v[104:105], v124 offset:34816
    v_mfma_f32_16x16x32_bf16 v[184:187], v[112:115], v[24:27], v[184:187]
    ds_read_b64_tr_b16 v[106:107], v124 offset:35072
    v_mfma_f32_16x16x32_bf16 v[188:191], v[116:119], v[24:27], v[188:191]
    ds_read_b64_tr_b16 v[108:109], v125 offset:34816
    v_mfma_f32_16x16x32_bf16 v[48:51], v[16:19], v[16:19], v[48:51]
    ds_read_b64_tr_b16 v[110:111], v125 offset:35072
    s_add_u32 m0, s52, 39936
    s_mov_b32 s73, 14848
    buffer_load_dwordx4 v121, s[8:11], s73 offen lds
    v_mfma_f32_16x16x32_bf16 v[52:55], v[20:23], v[20:23], v[52:55]
    ds_read_b64_tr_b16 v[112:113], v126 offset:30720
    v_mfma_f32_16x16x32_bf16 v[56:59], v[24:27], v[24:27], v[56:59]
    ds_read_b64_tr_b16 v[114:115], v126 offset:30976
    v_mfma_f32_16x16x32_bf16 v[60:63], v[40:43], v[16:19], v[60:63]
    ds_read_b64_tr_b16 v[116:117], v127 offset:30720
    v_mfma_f32_16x16x32_bf16 v[64:67], v[40:43], v[20:23], v[64:67]
    ds_read_b64_tr_b16 v[118:119], v127 offset:30976
    v_mfma_f32_16x16x32_bf16 v[68:71], v[40:43], v[24:27], v[68:71]
    s_add_u32 m0, s7, 98304
    s_mov_b32 s73, 512
    s_mov_b64 exec, s[54:55]
    buffer_load_dwordx4 v122, s[8:11], s73 offen lds
    s_mov_b64 exec, -1
    s_waitcnt vmcnt(8)
    s_barrier
    s_waitcnt lgkmcnt(8)
    v_mfma_f32_16x16x32_bf16 v[136:139], v[88:91], v[28:31], v[136:139]
    ds_read_b128 v[16:19], v128 offset:55296
    v_mfma_f32_16x16x32_bf16 v[160:163], v[88:91], v[32:35], v[160:163]
    ds_read_b128 v[20:23], v128 offset:57344
    v_mfma_f32_16x16x32_bf16 v[140:143], v[92:95], v[28:31], v[140:143]
    ds_read_b128 v[24:27], v130 offset:55296
    v_mfma_f32_16x16x32_bf16 v[164:167], v[92:95], v[32:35], v[164:167]
    ds_read_b64_tr_b16 v[88:89], v124 offset:36864
    v_mfma_f32_16x16x32_bf16 v[144:147], v[96:99], v[28:31], v[144:147]
    ds_read_b64_tr_b16 v[90:91], v124 offset:37120
    s_add_u32 m0, s51, 24576
    s_mov_b32 s73, 860160
    buffer_load_dwordx4 v123, s[12:15], s73 offen lds
    v_mfma_f32_16x16x32_bf16 v[168:171], v[96:99], v[32:35], v[168:171]
    ds_read_b64_tr_b16 v[92:93], v125 offset:36864
    v_mfma_f32_16x16x32_bf16 v[148:151], v[100:103], v[28:31], v[148:151]
    ds_read_b64_tr_b16 v[94:95], v125 offset:37120
    v_mfma_f32_16x16x32_bf16 v[172:175], v[100:103], v[32:35], v[172:175]
    ds_read_b64_tr_b16 v[96:97], v124 offset:38912
    s_waitcnt lgkmcnt(8)
    v_mfma_f32_16x16x32_bf16 v[152:155], v[28:31], v[104:107], v[152:155]
    ds_read_b64_tr_b16 v[98:99], v124 offset:39168
    v_mfma_f32_16x16x32_bf16 v[176:179], v[32:35], v[104:107], v[176:179]
    ds_read_b64_tr_b16 v[100:101], v125 offset:38912
    s_add_u32 m0, s51, 26624
    s_mov_b32 s73, 861056
    buffer_load_dwordx4 v123, s[12:15], s73 offen lds
    v_mfma_f32_16x16x32_bf16 v[156:159], v[28:31], v[108:111], v[156:159]
    ds_read_b64_tr_b16 v[102:103], v125 offset:39168
    v_mfma_f32_16x16x32_bf16 v[180:183], v[32:35], v[108:111], v[180:183]
    ds_read_b64_tr_b16 v[104:105], v124 offset:40960
    v_mfma_f32_16x16x32_bf16 v[184:187], v[112:115], v[36:39], v[184:187]
    ds_read_b64_tr_b16 v[106:107], v124 offset:41216
    v_mfma_f32_16x16x32_bf16 v[188:191], v[116:119], v[36:39], v[188:191]
    ds_read_b64_tr_b16 v[108:109], v125 offset:40960
    v_mfma_f32_16x16x32_bf16 v[48:51], v[28:31], v[28:31], v[48:51]
    ds_read_b64_tr_b16 v[110:111], v125 offset:41216
    s_add_u32 m0, s51, 28672
    s_mov_b32 s73, 861952
    buffer_load_dwordx4 v123, s[12:15], s73 offen lds
    v_mfma_f32_16x16x32_bf16 v[52:55], v[32:35], v[32:35], v[52:55]
    ds_read_b64_tr_b16 v[112:113], v126 offset:36864
    v_mfma_f32_16x16x32_bf16 v[56:59], v[36:39], v[36:39], v[56:59]
    ds_read_b64_tr_b16 v[114:115], v126 offset:37120
    v_mfma_f32_16x16x32_bf16 v[60:63], v[40:43], v[28:31], v[60:63]
    ds_read_b64_tr_b16 v[116:117], v127 offset:36864
    v_mfma_f32_16x16x32_bf16 v[64:67], v[40:43], v[32:35], v[64:67]
    ds_read_b64_tr_b16 v[118:119], v127 offset:37120
    v_mfma_f32_16x16x32_bf16 v[68:71], v[40:43], v[36:39], v[68:71]
    s_add_u32 m0, s52, 18432
    s_mov_b32 s73, 640
    buffer_load_dwordx4 v120, s[8:11], s73 offen lds
    s_waitcnt lgkmcnt(8)
    v_mfma_f32_16x16x32_bf16 v[136:139], v[88:91], v[16:19], v[136:139]
    ds_read_b128 v[28:31], v129 offset:55296
    v_mfma_f32_16x16x32_bf16 v[160:163], v[88:91], v[20:23], v[160:163]
    ds_read_b128 v[32:35], v129 offset:57344
    v_mfma_f32_16x16x32_bf16 v[140:143], v[92:95], v[16:19], v[140:143]
    ds_read_b128 v[36:39], v131 offset:55296
    v_mfma_f32_16x16x32_bf16 v[164:167], v[92:95], v[20:23], v[164:167]
    ds_read_b64_tr_b16 v[88:89], v124 offset:43008
    v_mfma_f32_16x16x32_bf16 v[144:147], v[96:99], v[16:19], v[144:147]
    ds_read_b64_tr_b16 v[90:91], v124 offset:43264
    s_add_u32 m0, s52, 19456
    s_mov_b32 s73, 640
    buffer_load_dwordx4 v121, s[8:11], s73 offen lds
    v_mfma_f32_16x16x32_bf16 v[168:171], v[96:99], v[20:23], v[168:171]
    ds_read_b64_tr_b16 v[92:93], v125 offset:43008
    v_mfma_f32_16x16x32_bf16 v[148:151], v[100:103], v[16:19], v[148:151]
    ds_read_b64_tr_b16 v[94:95], v125 offset:43264
    v_mfma_f32_16x16x32_bf16 v[172:175], v[100:103], v[20:23], v[172:175]
    ds_read_b64_tr_b16 v[96:97], v124 offset:45056
    s_waitcnt lgkmcnt(8)
    v_mfma_f32_16x16x32_bf16 v[152:155], v[16:19], v[104:107], v[152:155]
    ds_read_b64_tr_b16 v[98:99], v124 offset:45312
    v_mfma_f32_16x16x32_bf16 v[176:179], v[20:23], v[104:107], v[176:179]
    ds_read_b64_tr_b16 v[100:101], v125 offset:45056
    s_add_u32 m0, s52, 20480
    s_mov_b32 s73, 14976
    buffer_load_dwordx4 v120, s[8:11], s73 offen lds
    v_mfma_f32_16x16x32_bf16 v[156:159], v[16:19], v[108:111], v[156:159]
    ds_read_b64_tr_b16 v[102:103], v125 offset:45312
    v_mfma_f32_16x16x32_bf16 v[180:183], v[20:23], v[108:111], v[180:183]
    ds_read_b64_tr_b16 v[104:105], v124 offset:47104
    v_mfma_f32_16x16x32_bf16 v[184:187], v[112:115], v[24:27], v[184:187]
    ds_read_b64_tr_b16 v[106:107], v124 offset:47360
    v_mfma_f32_16x16x32_bf16 v[188:191], v[116:119], v[24:27], v[188:191]
    ds_read_b64_tr_b16 v[108:109], v125 offset:47104
    v_mfma_f32_16x16x32_bf16 v[48:51], v[16:19], v[16:19], v[48:51]
    ds_read_b64_tr_b16 v[110:111], v125 offset:47360
    s_add_u32 m0, s52, 21504
    s_mov_b32 s73, 14976
    buffer_load_dwordx4 v121, s[8:11], s73 offen lds
    v_mfma_f32_16x16x32_bf16 v[52:55], v[20:23], v[20:23], v[52:55]
    ds_read_b64_tr_b16 v[112:113], v126 offset:43008
    v_mfma_f32_16x16x32_bf16 v[56:59], v[24:27], v[24:27], v[56:59]
    ds_read_b64_tr_b16 v[114:115], v126 offset:43264
    v_mfma_f32_16x16x32_bf16 v[60:63], v[40:43], v[16:19], v[60:63]
    ds_read_b64_tr_b16 v[116:117], v127 offset:43008
    v_mfma_f32_16x16x32_bf16 v[64:67], v[40:43], v[20:23], v[64:67]
    ds_read_b64_tr_b16 v[118:119], v127 offset:43264
    v_mfma_f32_16x16x32_bf16 v[68:71], v[40:43], v[24:27], v[68:71]
    s_add_u32 m0, s7, 79872
    s_mov_b32 s73, 640
    s_mov_b64 exec, s[54:55]
    buffer_load_dwordx4 v122, s[8:11], s73 offen lds
    s_mov_b64 exec, -1
    s_waitcnt vmcnt(8)
    s_barrier
    s_waitcnt lgkmcnt(8)
    v_mfma_f32_16x16x32_bf16 v[136:139], v[88:91], v[28:31], v[136:139]
    ds_read_b128 v[16:19], v128 offset:36864
    v_mfma_f32_16x16x32_bf16 v[160:163], v[88:91], v[32:35], v[160:163]
    ds_read_b128 v[20:23], v128 offset:38912
    v_mfma_f32_16x16x32_bf16 v[140:143], v[92:95], v[28:31], v[140:143]
    ds_read_b128 v[24:27], v130 offset:36864
    v_mfma_f32_16x16x32_bf16 v[164:167], v[92:95], v[32:35], v[164:167]
    ds_read_b64_tr_b16 v[88:89], v124 offset:0
    v_mfma_f32_16x16x32_bf16 v[144:147], v[96:99], v[28:31], v[144:147]
    ds_read_b64_tr_b16 v[90:91], v124 offset:256
    s_add_u32 m0, s51, 36864
    s_mov_b32 s73, 1032192
    buffer_load_dwordx4 v123, s[12:15], s73 offen lds
    v_mfma_f32_16x16x32_bf16 v[168:171], v[96:99], v[32:35], v[168:171]
    ds_read_b64_tr_b16 v[92:93], v125 offset:0
    v_mfma_f32_16x16x32_bf16 v[148:151], v[100:103], v[28:31], v[148:151]
    ds_read_b64_tr_b16 v[94:95], v125 offset:256
    v_mfma_f32_16x16x32_bf16 v[172:175], v[100:103], v[32:35], v[172:175]
    ds_read_b64_tr_b16 v[96:97], v124 offset:2048
    s_waitcnt lgkmcnt(8)
    v_mfma_f32_16x16x32_bf16 v[152:155], v[28:31], v[104:107], v[152:155]
    ds_read_b64_tr_b16 v[98:99], v124 offset:2304
    v_mfma_f32_16x16x32_bf16 v[176:179], v[32:35], v[104:107], v[176:179]
    ds_read_b64_tr_b16 v[100:101], v125 offset:2048
    s_add_u32 m0, s51, 38912
    s_mov_b32 s73, 1033088
    buffer_load_dwordx4 v123, s[12:15], s73 offen lds
    v_mfma_f32_16x16x32_bf16 v[156:159], v[28:31], v[108:111], v[156:159]
    ds_read_b64_tr_b16 v[102:103], v125 offset:2304
    v_mfma_f32_16x16x32_bf16 v[180:183], v[32:35], v[108:111], v[180:183]
    ds_read_b64_tr_b16 v[104:105], v124 offset:4096
    v_mfma_f32_16x16x32_bf16 v[184:187], v[112:115], v[36:39], v[184:187]
    ds_read_b64_tr_b16 v[106:107], v124 offset:4352
    v_mfma_f32_16x16x32_bf16 v[188:191], v[116:119], v[36:39], v[188:191]
    ds_read_b64_tr_b16 v[108:109], v125 offset:4096
    v_mfma_f32_16x16x32_bf16 v[48:51], v[28:31], v[28:31], v[48:51]
    ds_read_b64_tr_b16 v[110:111], v125 offset:4352
    s_add_u32 m0, s51, 40960
    s_mov_b32 s73, 1033984
    buffer_load_dwordx4 v123, s[12:15], s73 offen lds
    v_mfma_f32_16x16x32_bf16 v[52:55], v[32:35], v[32:35], v[52:55]
    ds_read_b64_tr_b16 v[112:113], v126 offset:0
    v_mfma_f32_16x16x32_bf16 v[56:59], v[36:39], v[36:39], v[56:59]
    ds_read_b64_tr_b16 v[114:115], v126 offset:256
    v_mfma_f32_16x16x32_bf16 v[60:63], v[40:43], v[28:31], v[60:63]
    ds_read_b64_tr_b16 v[116:117], v127 offset:0
    v_mfma_f32_16x16x32_bf16 v[64:67], v[40:43], v[32:35], v[64:67]
    ds_read_b64_tr_b16 v[118:119], v127 offset:256
    v_mfma_f32_16x16x32_bf16 v[68:71], v[40:43], v[36:39], v[68:71]
    s_add_u32 m0, s52, 0
    s_mov_b32 s73, 768
    buffer_load_dwordx4 v120, s[8:11], s73 offen lds
    s_waitcnt lgkmcnt(8)
    v_mfma_f32_16x16x32_bf16 v[136:139], v[88:91], v[16:19], v[136:139]
    ds_read_b128 v[28:31], v129 offset:36864
    v_mfma_f32_16x16x32_bf16 v[160:163], v[88:91], v[20:23], v[160:163]
    ds_read_b128 v[32:35], v129 offset:38912
    v_mfma_f32_16x16x32_bf16 v[140:143], v[92:95], v[16:19], v[140:143]
    ds_read_b128 v[36:39], v131 offset:36864
    v_mfma_f32_16x16x32_bf16 v[164:167], v[92:95], v[20:23], v[164:167]
    ds_read_b64_tr_b16 v[88:89], v124 offset:6144
    v_mfma_f32_16x16x32_bf16 v[144:147], v[96:99], v[16:19], v[144:147]
    ds_read_b64_tr_b16 v[90:91], v124 offset:6400
    s_add_u32 m0, s52, 1024
    s_mov_b32 s73, 768
    buffer_load_dwordx4 v121, s[8:11], s73 offen lds
    v_mfma_f32_16x16x32_bf16 v[168:171], v[96:99], v[20:23], v[168:171]
    ds_read_b64_tr_b16 v[92:93], v125 offset:6144
    v_mfma_f32_16x16x32_bf16 v[148:151], v[100:103], v[16:19], v[148:151]
    ds_read_b64_tr_b16 v[94:95], v125 offset:6400
    v_mfma_f32_16x16x32_bf16 v[172:175], v[100:103], v[20:23], v[172:175]
    ds_read_b64_tr_b16 v[96:97], v124 offset:8192
    s_waitcnt lgkmcnt(8)
    v_mfma_f32_16x16x32_bf16 v[152:155], v[16:19], v[104:107], v[152:155]
    ds_read_b64_tr_b16 v[98:99], v124 offset:8448
    v_mfma_f32_16x16x32_bf16 v[176:179], v[20:23], v[104:107], v[176:179]
    ds_read_b64_tr_b16 v[100:101], v125 offset:8192
    s_add_u32 m0, s52, 2048
    s_mov_b32 s73, 15104
    buffer_load_dwordx4 v120, s[8:11], s73 offen lds
    v_mfma_f32_16x16x32_bf16 v[156:159], v[16:19], v[108:111], v[156:159]
    ds_read_b64_tr_b16 v[102:103], v125 offset:8448
    v_mfma_f32_16x16x32_bf16 v[180:183], v[20:23], v[108:111], v[180:183]
    ds_read_b64_tr_b16 v[104:105], v124 offset:10240
    v_mfma_f32_16x16x32_bf16 v[184:187], v[112:115], v[24:27], v[184:187]
    ds_read_b64_tr_b16 v[106:107], v124 offset:10496
    v_mfma_f32_16x16x32_bf16 v[188:191], v[116:119], v[24:27], v[188:191]
    ds_read_b64_tr_b16 v[108:109], v125 offset:10240
    v_mfma_f32_16x16x32_bf16 v[48:51], v[16:19], v[16:19], v[48:51]
    ds_read_b64_tr_b16 v[110:111], v125 offset:10496
    s_add_u32 m0, s52, 3072
    s_mov_b32 s73, 15104
    buffer_load_dwordx4 v121, s[8:11], s73 offen lds
    v_mfma_f32_16x16x32_bf16 v[52:55], v[20:23], v[20:23], v[52:55]
    ds_read_b64_tr_b16 v[112:113], v126 offset:6144
    v_mfma_f32_16x16x32_bf16 v[56:59], v[24:27], v[24:27], v[56:59]
    ds_read_b64_tr_b16 v[114:115], v126 offset:6400
    v_mfma_f32_16x16x32_bf16 v[60:63], v[40:43], v[16:19], v[60:63]
    ds_read_b64_tr_b16 v[116:117], v127 offset:6144
    v_mfma_f32_16x16x32_bf16 v[64:67], v[40:43], v[20:23], v[64:67]
    ds_read_b64_tr_b16 v[118:119], v127 offset:6400
    v_mfma_f32_16x16x32_bf16 v[68:71], v[40:43], v[24:27], v[68:71]
    s_add_u32 m0, s7, 61440
    s_mov_b32 s73, 768
    s_mov_b64 exec, s[54:55]
    buffer_load_dwordx4 v122, s[8:11], s73 offen lds
    s_mov_b64 exec, -1
    s_waitcnt vmcnt(8)
    s_barrier
    s_waitcnt lgkmcnt(8)
    v_mfma_f32_16x16x32_bf16 v[136:139], v[88:91], v[28:31], v[136:139]
    ds_read_b128 v[16:19], v128 offset:18432
    v_mfma_f32_16x16x32_bf16 v[160:163], v[88:91], v[32:35], v[160:163]
    ds_read_b128 v[20:23], v128 offset:20480
    v_mfma_f32_16x16x32_bf16 v[140:143], v[92:95], v[28:31], v[140:143]
    ds_read_b128 v[24:27], v130 offset:18432
    v_mfma_f32_16x16x32_bf16 v[164:167], v[92:95], v[32:35], v[164:167]
    ds_read_b64_tr_b16 v[88:89], v124 offset:12288
    v_mfma_f32_16x16x32_bf16 v[144:147], v[96:99], v[28:31], v[144:147]
    ds_read_b64_tr_b16 v[90:91], v124 offset:12544
    v_mfma_f32_16x16x32_bf16 v[168:171], v[96:99], v[32:35], v[168:171]
    ds_read_b64_tr_b16 v[92:93], v125 offset:12288
    v_mfma_f32_16x16x32_bf16 v[148:151], v[100:103], v[28:31], v[148:151]
    ds_read_b64_tr_b16 v[94:95], v125 offset:12544
    v_mfma_f32_16x16x32_bf16 v[172:175], v[100:103], v[32:35], v[172:175]
    ds_read_b64_tr_b16 v[96:97], v124 offset:14336
    s_waitcnt lgkmcnt(8)
    v_mfma_f32_16x16x32_bf16 v[152:155], v[28:31], v[104:107], v[152:155]
    ds_read_b64_tr_b16 v[98:99], v124 offset:14592
    v_mfma_f32_16x16x32_bf16 v[176:179], v[32:35], v[104:107], v[176:179]
    ds_read_b64_tr_b16 v[100:101], v125 offset:14336
    v_mfma_f32_16x16x32_bf16 v[156:159], v[28:31], v[108:111], v[156:159]
    ds_read_b64_tr_b16 v[102:103], v125 offset:14592
    v_mfma_f32_16x16x32_bf16 v[180:183], v[32:35], v[108:111], v[180:183]
    ds_read_b64_tr_b16 v[104:105], v124 offset:16384
    v_mfma_f32_16x16x32_bf16 v[184:187], v[112:115], v[36:39], v[184:187]
    ds_read_b64_tr_b16 v[106:107], v124 offset:16640
    v_mfma_f32_16x16x32_bf16 v[188:191], v[116:119], v[36:39], v[188:191]
    ds_read_b64_tr_b16 v[108:109], v125 offset:16384
    v_mfma_f32_16x16x32_bf16 v[48:51], v[28:31], v[28:31], v[48:51]
    ds_read_b64_tr_b16 v[110:111], v125 offset:16640
    v_mfma_f32_16x16x32_bf16 v[52:55], v[32:35], v[32:35], v[52:55]
    ds_read_b64_tr_b16 v[112:113], v126 offset:12288
    v_mfma_f32_16x16x32_bf16 v[56:59], v[36:39], v[36:39], v[56:59]
    ds_read_b64_tr_b16 v[114:115], v126 offset:12544
    v_mfma_f32_16x16x32_bf16 v[60:63], v[40:43], v[28:31], v[60:63]
    ds_read_b64_tr_b16 v[116:117], v127 offset:12288
    v_mfma_f32_16x16x32_bf16 v[64:67], v[40:43], v[32:35], v[64:67]
    ds_read_b64_tr_b16 v[118:119], v127 offset:12544
    v_mfma_f32_16x16x32_bf16 v[68:71], v[40:43], v[36:39], v[68:71]
    v_mov_b32 v7, 0
    buffer_load_dword v6, v7, s[44:47], 0 offen sc1
    s_lshr_b32 s68, s2, 3
    s_lshl_b32 s68, s68, 2
    s_add_u32 s68, s68, s3
    v_lshlrev_b32 v219, 7, v1
    s_mul_i32 s86, s68, 3200
    s_mov_b64 exec, 0x1ffffff
    buffer_load_dword v234, v219, s[16:19], s86 offen
    s_mov_b64 exec, -1
    v_lshrrev_b32 v219, 2, v1
    v_mul_u32_u24 v219, 3584, v219
    v_and_b32 v220, 3, v1
    v_lshl_add_u32 v219, v220, 7, v219
    s_mul_i32 s68, s68, 57344
    s_and_b32 s69, s2, 7
    s_mul_i32 s86, s69, 3
    s_add_u32 s86, s86, 4
    s_lshl_b32 s87, s69, 2
    s_min_u32 s86, s86, s87
    s_lshl_b32 s86, s86, 7
    s_add_u32 s86, s86, s68
    s_cmp_lt_u32 s69, 4
    s_cselect_b32 exec_lo, -1, 0x77777777
    s_cselect_b32 exec_hi, -1, 0x77777777
    buffer_load_dword v235, v219, s[20:23], s86 offen
    s_mov_b64 exec, -1
    s_waitcnt lgkmcnt(8)
    v_mfma_f32_16x16x32_bf16 v[136:139], v[88:91], v[16:19], v[136:139]
    ds_read_b128 v[28:31], v129 offset:18432
    v_mfma_f32_16x16x32_bf16 v[160:163], v[88:91], v[20:23], v[160:163]
    ds_read_b128 v[32:35], v129 offset:20480
    v_mfma_f32_16x16x32_bf16 v[140:143], v[92:95], v[16:19], v[140:143]
    ds_read_b128 v[36:39], v131 offset:18432
    v_mfma_f32_16x16x32_bf16 v[164:167], v[92:95], v[20:23], v[164:167]
    ds_read_b64_tr_b16 v[88:89], v124 offset:18432
    v_mfma_f32_16x16x32_bf16 v[144:147], v[96:99], v[16:19], v[144:147]
    ds_read_b64_tr_b16 v[90:91], v124 offset:18688
    v_mfma_f32_16x16x32_bf16 v[168:171], v[96:99], v[20:23], v[168:171]
    ds_read_b64_tr_b16 v[92:93], v125 offset:18432
    v_mfma_f32_16x16x32_bf16 v[148:151], v[100:103], v[16:19], v[148:151]
    ds_read_b64_tr_b16 v[94:95], v125 offset:18688
    v_mfma_f32_16x16x32_bf16 v[172:175], v[100:103], v[20:23], v[172:175]
    ds_read_b64_tr_b16 v[96:97], v124 offset:20480
    s_waitcnt lgkmcnt(8)
    v_mfma_f32_16x16x32_bf16 v[152:155], v[16:19], v[104:107], v[152:155]
    ds_read_b64_tr_b16 v[98:99], v124 offset:20736
    v_mfma_f32_16x16x32_bf16 v[176:179], v[20:23], v[104:107], v[176:179]
    ds_read_b64_tr_b16 v[100:101], v125 offset:20480
    v_mfma_f32_16x16x32_bf16 v[156:159], v[16:19], v[108:111], v[156:159]
    ds_read_b64_tr_b16 v[102:103], v125 offset:20736
    v_mfma_f32_16x16x32_bf16 v[180:183], v[20:23], v[108:111], v[180:183]
    ds_read_b64_tr_b16 v[104:105], v124 offset:22528
    v_mfma_f32_16x16x32_bf16 v[184:187], v[112:115], v[24:27], v[184:187]
    ds_read_b64_tr_b16 v[106:107], v124 offset:22784
    v_mfma_f32_16x16x32_bf16 v[188:191], v[116:119], v[24:27], v[188:191]
    ds_read_b64_tr_b16 v[108:109], v125 offset:22528
    v_mfma_f32_16x16x32_bf16 v[48:51], v[16:19], v[16:19], v[48:51]
    ds_read_b64_tr_b16 v[110:111], v125 offset:22784
    v_mfma_f32_16x16x32_bf16 v[52:55], v[20:23], v[20:23], v[52:55]
    ds_read_b64_tr_b16 v[112:113], v126 offset:18432
    v_mfma_f32_16x16x32_bf16 v[56:59], v[24:27], v[24:27], v[56:59]
    ds_read_b64_tr_b16 v[114:115], v126 offset:18688
    v_mfma_f32_16x16x32_bf16 v[60:63], v[40:43], v[16:19], v[60:63]
    ds_read_b64_tr_b16 v[116:117], v127 offset:18432
    v_mfma_f32_16x16x32_bf16 v[64:67], v[40:43], v[20:23], v[64:67]
    ds_read_b64_tr_b16 v[118:119], v127 offset:18688
    v_mfma_f32_16x16x32_bf16 v[68:71], v[40:43], v[24:27], v[68:71]
    s_waitcnt vmcnt(3)
    s_barrier
    s_waitcnt lgkmcnt(8)
    v_mfma_f32_16x16x32_bf16 v[136:139], v[88:91], v[28:31], v[136:139]
    ds_read_b128 v[16:19], v128 offset:0
    v_mfma_f32_16x16x32_bf16 v[160:163], v[88:91], v[32:35], v[160:163]
    ds_read_b128 v[20:23], v128 offset:2048
    v_mfma_f32_16x16x32_bf16 v[140:143], v[92:95], v[28:31], v[140:143]
    ds_read_b128 v[24:27], v130 offset:0
    v_mfma_f32_16x16x32_bf16 v[164:167], v[92:95], v[32:35], v[164:167]
    ds_read_b64_tr_b16 v[88:89], v124 offset:24576
    v_mfma_f32_16x16x32_bf16 v[144:147], v[96:99], v[28:31], v[144:147]
    ds_read_b64_tr_b16 v[90:91], v124 offset:24832
    v_mfma_f32_16x16x32_bf16 v[168:171], v[96:99], v[32:35], v[168:171]
    ds_read_b64_tr_b16 v[92:93], v125 offset:24576
    v_mfma_f32_16x16x32_bf16 v[148:151], v[100:103], v[28:31], v[148:151]
    ds_read_b64_tr_b16 v[94:95], v125 offset:24832
    v_mfma_f32_16x16x32_bf16 v[172:175], v[100:103], v[32:35], v[172:175]
    ds_read_b64_tr_b16 v[96:97], v124 offset:26624
    s_waitcnt lgkmcnt(8)
    v_mfma_f32_16x16x32_bf16 v[152:155], v[28:31], v[104:107], v[152:155]
    ds_read_b64_tr_b16 v[98:99], v124 offset:26880
    v_mfma_f32_16x16x32_bf16 v[176:179], v[32:35], v[104:107], v[176:179]
    ds_read_b64_tr_b16 v[100:101], v125 offset:26624
    v_mfma_f32_16x16x32_bf16 v[156:159], v[28:31], v[108:111], v[156:159]
    ds_read_b64_tr_b16 v[102:103], v125 offset:26880
    v_mfma_f32_16x16x32_bf16 v[180:183], v[32:35], v[108:111], v[180:183]
    ds_read_b64_tr_b16 v[104:105], v124 offset:28672
    v_mfma_f32_16x16x32_bf16 v[184:187], v[112:115], v[36:39], v[184:187]
    ds_read_b64_tr_b16 v[106:107], v124 offset:28928
    v_mfma_f32_16x16x32_bf16 v[188:191], v[116:119], v[36:39], v[188:191]
    ds_read_b64_tr_b16 v[108:109], v125 offset:28672
    v_mfma_f32_16x16x32_bf16 v[48:51], v[28:31], v[28:31], v[48:51]
    ds_read_b64_tr_b16 v[110:111], v125 offset:28928
    v_mfma_f32_16x16x32_bf16 v[52:55], v[32:35], v[32:35], v[52:55]
    ds_read_b64_tr_b16 v[112:113], v126 offset:24576
    v_mfma_f32_16x16x32_bf16 v[56:59], v[36:39], v[36:39], v[56:59]
    ds_read_b64_tr_b16 v[114:115], v126 offset:24832
    v_mfma_f32_16x16x32_bf16 v[60:63], v[40:43], v[28:31], v[60:63]
    ds_read_b64_tr_b16 v[116:117], v127 offset:24576
    v_mfma_f32_16x16x32_bf16 v[64:67], v[40:43], v[32:35], v[64:67]
    ds_read_b64_tr_b16 v[118:119], v127 offset:24832
    v_mfma_f32_16x16x32_bf16 v[68:71], v[40:43], v[36:39], v[68:71]
    s_waitcnt lgkmcnt(8)
    v_mfma_f32_16x16x32_bf16 v[136:139], v[88:91], v[16:19], v[136:139]
    ds_read_b128 v[28:31], v129 offset:0
    v_mfma_f32_16x16x32_bf16 v[160:163], v[88:91], v[20:23], v[160:163]
    ds_read_b128 v[32:35], v129 offset:2048
    v_mfma_f32_16x16x32_bf16 v[140:143], v[92:95], v[16:19], v[140:143]
    ds_read_b128 v[36:39], v131 offset:0
    v_mfma_f32_16x16x32_bf16 v[164:167], v[92:95], v[20:23], v[164:167]
    ds_read_b64_tr_b16 v[88:89], v124 offset:30720
    v_mfma_f32_16x16x32_bf16 v[144:147], v[96:99], v[16:19], v[144:147]
    ds_read_b64_tr_b16 v[90:91], v124 offset:30976
    v_mfma_f32_16x16x32_bf16 v[168:171], v[96:99], v[20:23], v[168:171]
    ds_read_b64_tr_b16 v[92:93], v125 offset:30720
    v_mfma_f32_16x16x32_bf16 v[148:151], v[100:103], v[16:19], v[148:151]
    ds_read_b64_tr_b16 v[94:95], v125 offset:30976
    v_mfma_f32_16x16x32_bf16 v[172:175], v[100:103], v[20:23], v[172:175]
    ds_read_b64_tr_b16 v[96:97], v124 offset:32768
    s_waitcnt lgkmcnt(8)
    v_mfma_f32_16x16x32_bf16 v[152:155], v[16:19], v[104:107], v[152:155]
    ds_read_b64_tr_b16 v[98:99], v124 offset:33024
    v_mfma_f32_16x16x32_bf16 v[176:179], v[20:23], v[104:107], v[176:179]
    ds_read_b64_tr_b16 v[100:101], v125 offset:32768
    v_mfma_f32_16x16x32_bf16 v[156:159], v[16:19], v[108:111], v[156:159]
    ds_read_b64_tr_b16 v[102:103], v125 offset:33024
    v_mfma_f32_16x16x32_bf16 v[180:183], v[20:23], v[108:111], v[180:183]
    ds_read_b64_tr_b16 v[104:105], v124 offset:34816
    v_mfma_f32_16x16x32_bf16 v[184:187], v[112:115], v[24:27], v[184:187]
    ds_read_b64_tr_b16 v[106:107], v124 offset:35072
    v_mfma_f32_16x16x32_bf16 v[188:191], v[116:119], v[24:27], v[188:191]
    ds_read_b64_tr_b16 v[108:109], v125 offset:34816
    v_mfma_f32_16x16x32_bf16 v[48:51], v[16:19], v[16:19], v[48:51]
    ds_read_b64_tr_b16 v[110:111], v125 offset:35072
    v_mfma_f32_16x16x32_bf16 v[52:55], v[20:23], v[20:23], v[52:55]
    ds_read_b64_tr_b16 v[112:113], v126 offset:30720
    v_mfma_f32_16x16x32_bf16 v[56:59], v[24:27], v[24:27], v[56:59]
    ds_read_b64_tr_b16 v[114:115], v126 offset:30976
    v_mfma_f32_16x16x32_bf16 v[60:63], v[40:43], v[16:19], v[60:63]
    ds_read_b64_tr_b16 v[116:117], v127 offset:30720
    v_mfma_f32_16x16x32_bf16 v[64:67], v[40:43], v[20:23], v[64:67]
    ds_read_b64_tr_b16 v[118:119], v127 offset:30976
    v_mfma_f32_16x16x32_bf16 v[68:71], v[40:43], v[24:27], v[68:71]
    s_waitcnt lgkmcnt(9)
    v_mfma_f32_16x16x32_bf16 v[48:51], v[28:31], v[28:31], v[48:51]
    v_mfma_f32_16x16x32_bf16 v[52:55], v[32:35], v[32:35], v[52:55]
    v_mfma_f32_16x16x32_bf16 v[56:59], v[36:39], v[36:39], v[56:59]
    v_mfma_f32_16x16x32_bf16 v[60:63], v[40:43], v[28:31], v[60:63]
    v_mfma_f32_16x16x32_bf16 v[64:67], v[40:43], v[32:35], v[64:67]
    v_mfma_f32_16x16x32_bf16 v[68:71], v[40:43], v[36:39], v[68:71]
    s_waitcnt lgkmcnt(2)
    v_mfma_f32_16x16x32_bf16 v[184:187], v[112:115], v[36:39], v[184:187]
    s_waitcnt lgkmcnt(0)
    v_mfma_f32_16x16x32_bf16 v[188:191], v[116:119], v[36:39], v[188:191]
    v_mfma_f32_16x16x32_bf16 v[144:147], v[96:99], v[28:31], v[144:147]
    v_cndmask_b32 v48, v48, v49, s[88:89]
    v_cndmask_b32 v52, v52, v53, s[88:89]
    v_cndmask_b32 v56, v56, v57, s[88:89]
    v_mfma_f32_16x16x32_bf16 v[168:171], v[96:99], v[32:35], v[168:171]
    v_cndmask_b32 v48, v48, v50, s[90:91]
    v_cndmask_b32 v52, v52, v54, s[90:91]
    v_cndmask_b32 v56, v56, v58, s[90:91]
    v_mfma_f32_16x16x32_bf16 v[148:151], v[100:103], v[28:31], v[148:151]
    v_cndmask_b32 v48, v48, v51, s[92:93]
    v_cndmask_b32 v52, v52, v55, s[92:93]
    v_cndmask_b32 v56, v56, v59, s[92:93]
    v_mfma_f32_16x16x32_bf16 v[172:175], v[100:103], v[32:35], v[172:175]
    v_mul_f32 v133, 0x3b124925, v60
    v_mul_f32 v135, 0x3b124925, v64
    v_mul_f32 v85, 0x3b124925, v68
    v_mfma_f32_16x16x32_bf16 v[152:155], v[28:31], v[104:107], v[152:155]
    v_mul_f32 v132, v133, v133
    v_mul_f32 v134, v135, v135
    v_mul_f32 v84, v85, v85
    v_mfma_f32_16x16x32_bf16 v[176:179], v[32:35], v[104:107], v[176:179]
    v_mul_f32 v48, 0x3b124925, v48
    v_mul_f32 v52, 0x3b124925, v52
    v_mul_f32 v56, 0x3b124925, v56
    v_mfma_f32_16x16x32_bf16 v[156:159], v[28:31], v[108:111], v[156:159]
    s_mov_b32 exec_lo, 0x00010001
    s_mov_b32 exec_hi, 0x00010001
    ds_write_b128 v73, v[184:187] offset:128
    ds_write_b128 v74, v[188:191] offset:0
    s_mov_b64 exec, -1
    v_sub_f32 v132, v48, v132
    v_sub_f32 v134, v52, v134
    v_mfma_f32_16x16x32_bf16 v[180:183], v[32:35], v[108:111], v[180:183]
    v_sub_f32 v84, v56, v84
    v_max_f32 v132, 0, v132
    v_max_f32 v134, 0, v134
    v_mfma_f32_16x16x32_bf16 v[136:139], v[88:91], v[28:31], v[136:139]
    v_max_f32 v84, 0, v84
    v_add_f32 v132, 0x3727c5ac, v132
    v_add_f32 v134, 0x3727c5ac, v134
    v_mfma_f32_16x16x32_bf16 v[160:163], v[88:91], v[32:35], v[160:163]
    v_add_f32 v84, 0x3727c5ac, v84
    v_rsq_f32 v132, v132
    v_rsq_f32 v134, v134
    v_mfma_f32_16x16x32_bf16 v[140:143], v[92:95], v[28:31], v[140:143]
    v_rsq_f32 v84, v84
    s_mov_b32 exec_lo, 0x00f0000f
    s_mov_b32 exec_hi, 0xf0000f00
    ds_write2_b32 v75, v132, v133 offset0:128 offset1:144
    ds_write2_b32 v75, v134, v135 offset0:160 offset1:176
    ds_write2_b32 v75, v84, v85 offset0:192 offset1:208
    s_mov_b64 exec, -1
    v_mov_b32_dpp v224, v184 row_newbcast:0 row_mask:0xf bank_mask:0xf
    v_mfma_f32_16x16x32_bf16 v[164:167], v[92:95], v[32:35], v[164:167]
    v_mov_b32_dpp v225, v185 row_newbcast:0 row_mask:0xf bank_mask:0xf
    v_mov_b32_dpp v226, v186 row_newbcast:0 row_mask:0xf bank_mask:0xf
    v_mov_b32_dpp v227, v187 row_newbcast:0 row_mask:0xf bank_mask:0xf
    v_fma_f32 v224, -v224, v85, v184
    v_fma_f32 v225, -v225, v85, v185
    v_fma_f32 v226, -v226, v85, v186
    v_fma_f32 v227, -v227, v85, v187
    s_cmp_eq_u32 s49, 15
    s_cselect_b32 s88, 0xffff0000, -1
    s_mov_b32 s89, -1
    s_mov_b32 s90, -1
    s_cselect_b32 s91, -1, 0xffff
    s_waitcnt lgkmcnt(0)
    s_barrier
    ds_read_b32 v134, v75 offset:640
    ds_read_b32 v84, v75 offset:768
    ds_read_b32 v132, v75 offset:512
    ds_read_b128 v[56:59], v72 offset:128
    ds_read_b128 v[60:63], v72 offset:192
    ds_read_b32 v64, v77 offset:256
    ds_read_b32 v65, v77 offset:320
    ds_read_b128 v[44:47], v76 offset:704
    ds_read_b128 v[40:43], v76 offset:640
    ds_read_b128 v[36:39], v76 offset:576
    ds_read_b128 v[32:35], v76 offset:512
    ds_read_b128 v[48:51], v72 offset:0
    ds_read_b128 v[52:55], v72 offset:64
    s_waitcnt lgkmcnt(9)
    v_pk_fma_f32 v[168:169], v[56:57], v[134:135], v[168:169] op_sel:[0,1,0] op_sel_hi:[1,1,1] neg_lo:[0,1,0] neg_hi:[0,1,0]
    v_pk_fma_f32 v[170:171], v[58:59], v[134:135], v[170:171] op_sel:[0,1,0] op_sel_hi:[1,1,1] neg_lo:[0,1,0] neg_hi:[0,1,0]
    v_pk_mul_f32 v[168:169], v[168:169], v[134:135] op_sel:[0,0] op_sel_hi:[1,0]
    v_pk_mul_f32 v[170:171], v[170:171], v[134:135] op_sel:[0,0] op_sel_hi:[1,0]
    v_cvt_pk_bf16_f32 v104, v168, v169
    v_cvt_pk_bf16_f32 v105, v170, v171
    s_waitcnt lgkmcnt(8)
    v_pk_fma_f32 v[172:173], v[60:61], v[134:135], v[172:173] op_sel:[0,1,0] op_sel_hi:[1,1,1] neg_lo:[0,1,0] neg_hi:[0,1,0]
    v_pk_fma_f32 v[174:175], v[62:63], v[134:135], v[174:175] op_sel:[0,1,0] op_sel_hi:[1,1,1] neg_lo:[0,1,0] neg_hi:[0,1,0]
    v_pk_mul_f32 v[172:173], v[172:173], v[134:135] op_sel:[0,0] op_sel_hi:[1,0]
    v_pk_mul_f32 v[174:175], v[174:175], v[134:135] op_sel:[0,0] op_sel_hi:[1,0]
    v_cvt_pk_bf16_f32 v106, v172, v173
    v_cvt_pk_bf16_f32 v107, v174, v175
    ds_write_b128 v78, v[104:107] offset:4096
    v_pk_mul_f32 v[224:225], v[224:225], v[84:85] op_sel_hi:[1,0]
    v_pk_mul_f32 v[226:227], v[226:227], v[84:85] op_sel_hi:[1,0]
    v_cvt_pk_bf16_f32 v224, v224, v225
    v_cvt_pk_bf16_f32 v226, v226, v227
    ds_write_b16 v80, v224 offset:2048
    ds_write_b16_d16_hi v81, v224 offset:2048
    ds_write_b16 v82, v226 offset:2048
    ds_write_b16_d16_hi v83, v226 offset:2048
    s_waitcnt lgkmcnt(10)
    v_pk_fma_f32 v[176:177], v[44:45], v[64:65], v[176:177] op_sel:[0,0,0] op_sel_hi:[1,0,1] neg_lo:[0,1,0] neg_hi:[0,1,0]
    v_pk_fma_f32 v[178:179], v[46:47], v[64:65], v[178:179] op_sel:[0,0,0] op_sel_hi:[1,0,1] neg_lo:[0,1,0] neg_hi:[0,1,0]
    s_waitcnt lgkmcnt(9)
    v_pk_mul_f32 v[176:177], v[176:177], v[40:41]
    v_pk_mul_f32 v[178:179], v[178:179], v[42:43]
    v_cvt_pk_bf16_f32 v112, v176, v177
    v_cvt_pk_bf16_f32 v113, v178, v179
    v_pk_fma_f32 v[180:181], v[44:45], v[64:65], v[180:181] op_sel:[0,1,0] op_sel_hi:[1,1,1] neg_lo:[0,1,0] neg_hi:[0,1,0]
    v_pk_fma_f32 v[182:183], v[46:47], v[64:65], v[182:183] op_sel:[0,1,0] op_sel_hi:[1,1,1] neg_lo:[0,1,0] neg_hi:[0,1,0]
    v_pk_mul_f32 v[180:181], v[180:181], v[40:41]
    v_pk_mul_f32 v[182:183], v[182:183], v[42:43]
    v_cvt_pk_bf16_f32 v118, v180, v181
    v_cvt_pk_bf16_f32 v119, v182, v183
    ds_write_b64 v78, v[112:113] offset:5120
    ds_write_b64 v78, v[118:119] offset:5128
    v_mul_f32 v68, 0x3e8b97f6, v132
    v_mul_f32 v70, 0x3e8b97f6, v134
    v_cndmask_b32 v69, 0, v68, s[90:91]
    v_cndmask_b32 v68, 0, v68, s[88:89]
    v_cndmask_b32 v71, 0, v70, s[90:91]
    v_cndmask_b32 v70, 0, v70, s[88:89]
    v_pk_fma_f32 v[144:145], v[56:57], v[132:133], v[144:145] op_sel:[0,1,0] op_sel_hi:[1,1,1] neg_lo:[0,1,0] neg_hi:[0,1,0]
    v_pk_fma_f32 v[146:147], v[58:59], v[132:133], v[146:147] op_sel:[0,1,0] op_sel_hi:[1,1,1] neg_lo:[0,1,0] neg_hi:[0,1,0]
    v_pk_mul_f32 v[144:145], v[144:145], v[132:133] op_sel:[0,0] op_sel_hi:[1,0]
    v_pk_mul_f32 v[146:147], v[146:147], v[132:133] op_sel:[0,0] op_sel_hi:[1,0]
    v_cvt_pk_bf16_f32 v100, v144, v145
    v_cvt_pk_bf16_f32 v101, v146, v147
    v_pk_fma_f32 v[148:149], v[60:61], v[132:133], v[148:149] op_sel:[0,1,0] op_sel_hi:[1,1,1] neg_lo:[0,1,0] neg_hi:[0,1,0]
    v_pk_fma_f32 v[150:151], v[62:63], v[132:133], v[150:151] op_sel:[0,1,0] op_sel_hi:[1,1,1] neg_lo:[0,1,0] neg_hi:[0,1,0]
    v_pk_mul_f32 v[148:149], v[148:149], v[132:133] op_sel:[0,0] op_sel_hi:[1,0]
    v_pk_mul_f32 v[150:151], v[150:151], v[132:133] op_sel:[0,0] op_sel_hi:[1,0]
    v_cvt_pk_bf16_f32 v102, v148, v149
    v_cvt_pk_bf16_f32 v103, v150, v151
    s_waitcnt lgkmcnt(0)
    s_barrier
    ds_read_b128 v[96:99], v78 offset:2048
    ds_read_b64 v[108:109], v78 offset:3072
    ds_read_b64 v[114:115], v78 offset:3080
    v_pk_fma_f32 v[160:161], v[48:49], v[134:135], v[160:161] op_sel:[0,1,0] op_sel_hi:[1,1,1] neg_lo:[0,1,0] neg_hi:[0,1,0]
    v_pk_fma_f32 v[162:163], v[50:51], v[134:135], v[162:163] op_sel:[0,1,0] op_sel_hi:[1,1,1] neg_lo:[0,1,0] neg_hi:[0,1,0]
    v_pk_mul_f32 v[160:161], v[160:161], v[70:71] op_sel:[0,0] op_sel_hi:[1,0]
    v_pk_mul_f32 v[162:163], v[162:163], v[70:71] op_sel:[0,0] op_sel_hi:[1,0]
    v_cvt_pk_bf16_f32 v92, v160, v161
    v_cvt_pk_bf16_f32 v93, v162, v163
    v_pk_fma_f32 v[164:165], v[52:53], v[134:135], v[164:165] op_sel:[0,1,0] op_sel_hi:[1,1,1] neg_lo:[0,1,0] neg_hi:[0,1,0]
    v_pk_fma_f32 v[166:167], v[54:55], v[134:135], v[166:167] op_sel:[0,1,0] op_sel_hi:[1,1,1] neg_lo:[0,1,0] neg_hi:[0,1,0]
    v_pk_mul_f32 v[164:165], v[164:165], v[70:71] op_sel:[0,1] op_sel_hi:[1,1]
    v_pk_mul_f32 v[166:167], v[166:167], v[70:71] op_sel:[0,1] op_sel_hi:[1,1]
    v_cvt_pk_bf16_f32 v94, v164, v165
    v_cvt_pk_bf16_f32 v95, v166, v167
    s_nop 1
    v_mfma_f32_16x16x32_bf16 v[24:27], v[100:103], v[92:95], v[240:243]
    v_mfma_f32_16x16x32_bf16 v[28:31], v[104:107], v[92:95], v[244:247]
    v_pk_fma_f32 v[136:137], v[48:49], v[132:133], v[136:137] op_sel:[0,1,0] op_sel_hi:[1,1,1] neg_lo:[0,1,0] neg_hi:[0,1,0]
    v_pk_fma_f32 v[138:139], v[50:51], v[132:133], v[138:139] op_sel:[0,1,0] op_sel_hi:[1,1,1] neg_lo:[0,1,0] neg_hi:[0,1,0]
    v_pk_mul_f32 v[136:137], v[136:137], v[68:69] op_sel:[0,0] op_sel_hi:[1,0]
    v_pk_mul_f32 v[138:139], v[138:139], v[68:69] op_sel:[0,0] op_sel_hi:[1,0]
    v_cvt_pk_bf16_f32 v88, v136, v137
    v_cvt_pk_bf16_f32 v89, v138, v139
    v_pk_fma_f32 v[140:141], v[52:53], v[132:133], v[140:141] op_sel:[0,1,0] op_sel_hi:[1,1,1] neg_lo:[0,1,0] neg_hi:[0,1,0]
    v_pk_fma_f32 v[142:143], v[54:55], v[132:133], v[142:143] op_sel:[0,1,0] op_sel_hi:[1,1,1] neg_lo:[0,1,0] neg_hi:[0,1,0]
    v_pk_mul_f32 v[140:141], v[140:141], v[68:69] op_sel:[0,1] op_sel_hi:[1,1]
    v_pk_mul_f32 v[142:143], v[142:143], v[68:69] op_sel:[0,1] op_sel_hi:[1,1]
    v_cvt_pk_bf16_f32 v90, v140, v141
    v_cvt_pk_bf16_f32 v91, v142, v143
    s_waitcnt lgkmcnt(2)
    s_nop 0
    v_mfma_f32_16x16x32_bf16 v[16:19], v[96:99], v[88:91], v[248:251]
    v_mfma_f32_16x16x32_bf16 v[20:23], v[100:103], v[88:91], v[244:247]
    v_pk_fma_f32 v[152:153], v[36:37], v[64:65], v[152:153] op_sel:[0,0,0] op_sel_hi:[1,0,1] neg_lo:[0,1,0] neg_hi:[0,1,0]
    v_pk_fma_f32 v[154:155], v[38:39], v[64:65], v[154:155] op_sel:[0,0,0] op_sel_hi:[1,0,1] neg_lo:[0,1,0] neg_hi:[0,1,0]
    v_pk_mul_f32 v[152:153], v[152:153], v[32:33]
    v_pk_mul_f32 v[154:155], v[154:155], v[34:35]
    v_cvt_pk_bf16_f32 v110, v152, v153
    v_cvt_pk_bf16_f32 v111, v154, v155
    v_pk_fma_f32 v[156:157], v[36:37], v[64:65], v[156:157] op_sel:[0,1,0] op_sel_hi:[1,1,1] neg_lo:[0,1,0] neg_hi:[0,1,0]
    v_pk_fma_f32 v[158:159], v[38:39], v[64:65], v[158:159] op_sel:[0,1,0] op_sel_hi:[1,1,1] neg_lo:[0,1,0] neg_hi:[0,1,0]
    v_pk_mul_f32 v[156:157], v[156:157], v[32:33]
    v_pk_mul_f32 v[158:159], v[158:159], v[34:35]
    v_cvt_pk_bf16_f32 v116, v156, v157
    v_cvt_pk_bf16_f32 v117, v158, v159
    v_max3_f32 v137, v24, v25, v26
    v_max3_f32 v139, v27, v28, v29
    v_max3_f32 v137, v137, v30, v31
    v_max_f32 v137, v137, v139
    v_max3_f32 v136, v16, v17, v18
    v_max3_f32 v138, v19, v20, v21
    v_max3_f32 v136, v136, v22, v23
    v_max_f32 v136, v136, v138
    v_mov_b32 v138, v136
    v_mov_b32 v139, v137
    s_nop 0
    v_permlane32_swap_b32 v136, v138
    v_permlane32_swap_b32 v137, v139
    v_max_f32 v136, v136, v138
    v_max_f32 v137, v137, v139
    v_mov_b32 v138, v136
    v_mov_b32 v139, v137
    s_nop 0
    v_permlane16_swap_b32 v136, v138
    v_permlane16_swap_b32 v137, v139
    v_max_f32 v136, v136, v138
    v_max_f32 v137, v137, v139
    v_pk_add_f32 v[24:25], v[24:25], v[136:137] op_sel:[0,1] op_sel_hi:[1,1] neg_lo:[0,1] neg_hi:[0,1]
    v_pk_add_f32 v[26:27], v[26:27], v[136:137] op_sel:[0,1] op_sel_hi:[1,1] neg_lo:[0,1] neg_hi:[0,1]
    v_pk_add_f32 v[28:29], v[28:29], v[136:137] op_sel:[0,1] op_sel_hi:[1,1] neg_lo:[0,1] neg_hi:[0,1]
    v_pk_add_f32 v[30:31], v[30:31], v[136:137] op_sel:[0,1] op_sel_hi:[1,1] neg_lo:[0,1] neg_hi:[0,1]
    v_exp_f32 v24, v24
    v_exp_f32 v25, v25
    v_exp_f32 v26, v26
    v_exp_f32 v27, v27
    v_exp_f32 v28, v28
    v_exp_f32 v29, v29
    v_exp_f32 v30, v30
    v_exp_f32 v31, v31
    v_cvt_pk_bf16_f32 v148, v24, v25
    v_cvt_pk_bf16_f32 v149, v26, v27
    v_cvt_pk_bf16_f32 v150, v28, v29
    v_cvt_pk_bf16_f32 v151, v30, v31
    s_nop 1
    v_mfma_f32_16x16x32_bf16 v[160:163], v[110:113], v[148:151], 0
    v_mfma_f32_16x16x32_bf16 v[164:167], v[116:119], v[148:151], 0
    v_pk_add_f32 v[16:17], v[16:17], v[136:137] op_sel:[0,0] op_sel_hi:[1,0] neg_lo:[0,1] neg_hi:[0,1]
    v_pk_add_f32 v[18:19], v[18:19], v[136:137] op_sel:[0,0] op_sel_hi:[1,0] neg_lo:[0,1] neg_hi:[0,1]
    v_pk_add_f32 v[20:21], v[20:21], v[136:137] op_sel:[0,0] op_sel_hi:[1,0] neg_lo:[0,1] neg_hi:[0,1]
    v_pk_add_f32 v[22:23], v[22:23], v[136:137] op_sel:[0,0] op_sel_hi:[1,0] neg_lo:[0,1] neg_hi:[0,1]
    v_exp_f32 v16, v16
    v_exp_f32 v17, v17
    v_exp_f32 v18, v18
    v_exp_f32 v19, v19
    v_exp_f32 v20, v20
    v_exp_f32 v21, v21
    v_exp_f32 v22, v22
    v_exp_f32 v23, v23
    v_cvt_pk_bf16_f32 v144, v16, v17
    v_cvt_pk_bf16_f32 v145, v18, v19
    v_cvt_pk_bf16_f32 v146, v20, v21
    v_cvt_pk_bf16_f32 v147, v22, v23
    s_waitcnt lgkmcnt(1)
    s_nop 0
    v_mfma_f32_16x16x32_bf16 v[152:155], v[108:111], v[144:147], 0
    s_waitcnt lgkmcnt(0)
    v_mfma_f32_16x16x32_bf16 v[156:159], v[114:117], v[144:147], 0
    v_pk_add_f32 v[16:17], v[16:17], v[18:19]
    v_pk_add_f32 v[20:21], v[20:21], v[22:23]
    v_pk_add_f32 v[24:25], v[24:25], v[26:27]
    v_pk_add_f32 v[28:29], v[28:29], v[30:31]
    v_pk_add_f32 v[16:17], v[16:17], v[20:21]
    v_pk_add_f32 v[24:25], v[24:25], v[28:29]
    v_add_f32 v140, v16, v17
    v_add_f32 v142, v24, v25
    v_mov_b32 v138, v140
    v_mov_b32 v139, v142
    s_nop 0
    v_permlane32_swap_b32 v140, v138
    v_permlane32_swap_b32 v142, v139
    v_add_f32 v140, v140, v138
    v_add_f32 v142, v142, v139
    v_mov_b32 v138, v140
    v_mov_b32 v139, v142
    s_nop 0
    v_permlane16_swap_b32 v140, v138
    v_permlane16_swap_b32 v142, v139
    v_add_f32 v140, v140, v138
    v_add_f32 v142, v142, v139
    v_rcp_f32 v140, v140
    v_rcp_f32 v142, v142
    v_cndmask_b32 v141, 0, v140, s[90:91]
    v_cndmask_b32 v140, 0, v140, s[88:89]
    v_cndmask_b32 v143, 0, v142, s[90:91]
    v_cndmask_b32 v142, 0, v142, s[88:89]
    v_pk_mul_f32 v[152:153], v[152:153], v[140:141] op_sel_hi:[1,0]
    v_pk_mul_f32 v[154:155], v[154:155], v[140:141] op_sel_hi:[1,0]
    v_pk_mul_f32 v[156:157], v[156:157], v[140:141] op_sel:[0,1] op_sel_hi:[1,1]
    v_pk_mul_f32 v[158:159], v[158:159], v[140:141] op_sel:[0,1] op_sel_hi:[1,1]
    v_cvt_pk_bf16_f32 v144, v152, v153
    v_cvt_pk_bf16_f32 v145, v154, v155
    v_cvt_pk_bf16_f32 v146, v156, v157
    v_cvt_pk_bf16_f32 v147, v158, v159
    buffer_store_dwordx4 v[144:147], v4, s[40:43], s62 offen sc1
    v_pk_mul_f32 v[160:161], v[160:161], v[142:143] op_sel_hi:[1,0]
    v_pk_mul_f32 v[162:163], v[162:163], v[142:143] op_sel_hi:[1,0]
    v_pk_mul_f32 v[164:165], v[164:165], v[142:143] op_sel:[0,1] op_sel_hi:[1,1]
    v_pk_mul_f32 v[166:167], v[166:167], v[142:143] op_sel:[0,1] op_sel_hi:[1,1]
    v_cvt_pk_bf16_f32 v148, v160, v161
    v_cvt_pk_bf16_f32 v149, v162, v163
    v_cvt_pk_bf16_f32 v150, v164, v165
    v_cvt_pk_bf16_f32 v151, v166, v167
    buffer_store_dwordx4 v[148:151], v4, s[40:43], s63 offen sc1
    s_add_u32 m0, s59, 0
    s_mov_b32 s73, 0
    buffer_load_dwordx4 v208, s[16:19], s73 offen lds
    s_add_u32 m0, s59, 1024
    s_mov_b32 s73, 7168
    buffer_load_dwordx4 v208, s[16:19], s73 offen lds
    s_add_u32 m0, s59, 2048
    s_mov_b32 s73, 14336
    buffer_load_dwordx4 v208, s[16:19], s73 offen lds
    s_add_u32 m0, s59, 3072
    s_mov_b32 s73, 21504
    buffer_load_dwordx4 v208, s[16:19], s73 offen lds
    s_add_u32 m0, s59, 4096
    s_mov_b32 s73, 28672
    buffer_load_dwordx4 v208, s[16:19], s73 offen lds
    s_add_u32 m0, s59, 5120
    s_mov_b32 s73, 35840
    buffer_load_dwordx4 v208, s[16:19], s73 offen lds
    s_add_u32 m0, s59, 6144
    s_mov_b32 s73, 43008
    buffer_load_dwordx4 v208, s[16:19], s73 offen lds
    s_add_u32 m0, s59, 7168
    s_mov_b32 s73, 50176
    buffer_load_dwordx4 v208, s[16:19], s73 offen lds
    s_add_u32 m0, s59, 8192
    s_mov_b32 s73, 57344
    buffer_load_dwordx4 v208, s[16:19], s73 offen lds
    s_add_u32 m0, s59, 9216
    s_mov_b32 s73, 64512
    buffer_load_dwordx4 v208, s[16:19], s73 offen lds
    s_add_u32 m0, s59, 10240
    s_mov_b32 s73, 71680
    buffer_load_dwordx4 v208, s[16:19], s73 offen lds
    s_add_u32 m0, s59, 11264
    s_mov_b32 s73, 78848
    buffer_load_dwordx4 v208, s[16:19], s73 offen lds
    s_add_u32 m0, s59, 12288
    s_mov_b32 s73, 86016
    buffer_load_dwordx4 v208, s[16:19], s73 offen lds
    s_add_u32 m0, s59, 13312
    s_mov_b32 s73, 93184
    buffer_load_dwordx4 v208, s[16:19], s73 offen lds
    s_waitcnt vmcnt(18)
    v_readfirstlane_b32 s4, v6
    s_nop 1
    s_cmp_lg_u32 s4, 0
    s_cbranch_scc1 Lepd_P_2
    s_nop 0
Lepg_P_1:
    s_sub_u32 s6, s6, 1
    s_cbranch_scc1 L_end_P
    buffer_load_dword v6, v7, s[44:47], 0 offen sc1
    s_waitcnt vmcnt(0)
    v_readfirstlane_b32 s4, v6
    s_nop 1
    s_cmp_eq_u32 s4, 0
    s_cbranch_scc1 Lepg_P_1
Lepd_P_2:
    s_waitcnt vmcnt(14)
    v_mov_b32 v8, s4
    s_mov_b64 exec, 1
    buffer_store_dword v8, v9, s[40:43], s80 offen sc1
    s_mov_b64 exec, -1
    s_cmp_lt_u32 s67, 99
    s_cbranch_scc1 Lnotag_P_3
    s_lshr_b32 s68, s2, 3
    s_sub_u32 s68, s68, 28
    s_lshl_b32 s68, s68, 2
    s_add_u32 s68, s68, s3
    s_lshl_b32 s68, s68, 16
    s_and_b32 s69, s2, 7
    s_lshl_b32 s69, s69, 9
    s_add_u32 s68, s68, s69
    v_lshrrev_b32 v16, 2, v1
    v_lshlrev_b32 v16, 12, v16
    v_and_b32 v17, 3, v1
    v_lshl_add_u32 v16, v17, 7, v16
    buffer_load_dword v18, v16, s[24:27], s68 offen
    s_add_u32 s68, s68, 0x100000
    s_waitcnt vmcnt(3)
    buffer_load_dword v19, v16, s[24:27], s68 offen
    s_add_u32 s68, s68, 0x100000
    s_waitcnt vmcnt(3)
    buffer_load_dword v20, v16, s[24:27], s68 offen
    s_add_u32 s68, s68, 0x100000
    s_waitcnt vmcnt(3)
    buffer_load_dword v21, v16, s[24:27], s68 offen
    s_add_u32 s68, s68, 0x100000
    s_waitcnt vmcnt(3)
    buffer_load_dword v22, v16, s[24:27], s68 offen
    s_add_u32 s68, s68, 0x100000
    s_waitcnt vmcnt(3)
    buffer_load_dword v23, v16, s[24:27], s68 offen
    s_add_u32 s68, s68, 0x100000
    s_waitcnt vmcnt(3)
    buffer_load_dword v24, v16, s[24:27], s68 offen
    s_add_u32 s68, s68, 0x100000
    s_waitcnt vmcnt(3)
    s_waitcnt vmcnt(0)
    s_branch L_end_P
Lnotag_P_3:
    v_lshrrev_b32 v221, 5, v1
    v_mul_u32_u24 v221, 3584, v221
    v_and_b32 v222, 31, v1
    v_lshl_add_u32 v221, v222, 1, v221
    s_lshl_b32 s58, s67, 1
    s_lshr_b32 s60, s3, 1
    s_add_u32 s58, s58, s60
    s_mul_i32 s58, s58, 28672
    s_lshl_b32 s60, s66, 7
    s_add_u32 s58, s58, s60
    s_and_b32 s60, s3, 1
    s_lshl_b32 s60, s60, 6
    s_add_u32 s58, s58, s60
    buffer_load_ushort v192, v221, s[8:11], s58 offen offset:0
    buffer_load_ushort v193, v221, s[8:11], s58 offen offset:896
    buffer_load_ushort v194, v221, s[8:11], s58 offen offset:1792
    buffer_load_ushort v195, v221, s[8:11], s58 offen offset:2688
    s_add_u32 s58, s58, 7168
    buffer_load_ushort v196, v221, s[8:11], s58 offen offset:0
    buffer_load_ushort v197, v221, s[8:11], s58 offen offset:896
    buffer_load_ushort v198, v221, s[8:11], s58 offen offset:1792
    buffer_load_ushort v199, v221, s[8:11], s58 offen offset:2688
    s_add_u32 s58, s58, 7168
    buffer_load_ushort v200, v221, s[8:11], s58 offen offset:0
    buffer_load_ushort v201, v221, s[8:11], s58 offen offset:896
    buffer_load_ushort v202, v221, s[8:11], s58 offen offset:1792
    buffer_load_ushort v203, v221, s[8:11], s58 offen offset:2688
    s_add_u32 s58, s58, 7168
    buffer_load_ushort v204, v221, s[8:11], s58 offen offset:0
    buffer_load_ushort v205, v221, s[8:11], s58 offen offset:896
    buffer_load_ushort v206, v221, s[8:11], s58 offen offset:1792
    buffer_load_ushort v207, v221, s[8:11], s58 offen offset:2688
    s_and_b32 s68, s2, 7
    s_cmp_ge_u32 s68, 7
    s_cselect_b32 s48, 7, 0
    s_sub_u32 s68, s68, s48
    s_lshl_b32 s48, s68, 12
    s_add_u32 s68, s68, 1
    s_cmp_ge_u32 s68, 7
    s_cselect_b32 s49, 7, 0
    s_sub_u32 s68, s68, s49
    s_lshl_b32 s49, s68, 12
    s_add_u32 s68, s68, 1
    s_cmp_ge_u32 s68, 7
    s_cselect_b32 s50, 7, 0
    s_sub_u32 s68, s68, s50
    s_lshl_b32 s50, s68, 12
    s_add_u32 s68, s68, 1
    s_cmp_ge_u32 s68, 7
    s_cselect_b32 s51, 7, 0
    s_sub_u32 s68, s68, s51
    s_lshl_b32 s51, s68, 12
    s_add_u32 s68, s68, 1
    s_cmp_ge_u32 s68, 7
    s_cselect_b32 s52, 7, 0
    s_sub_u32 s68, s68, s52
    s_lshl_b32 s52, s68, 12
    s_add_u32 s68, s68, 1
    s_cmp_ge_u32 s68, 7
    s_cselect_b32 s53, 7, 0
    s_sub_u32 s68, s68, s53
    s_lshl_b32 s53, s68, 12
    s_add_u32 s68, s68, 1
    s_cmp_ge_u32 s68, 7
    s_cselect_b32 s54, 7, 0
    s_sub_u32 s68, s68, s54
    s_lshl_b32 s54, s68, 12
    s_waitcnt vmcnt(17)
    s_barrier
    ds_read_b64_tr_b16 a[0:1], v209 offset:0
    ds_read_b64_tr_b16 a[2:3], v209 offset:2048
    ds_read_b64_tr_b16 a[4:5], v209 offset:1024
    ds_read_b64_tr_b16 a[6:7], v209 offset:3072
    ds_read_b64_tr_b16 a[8:9], v209 offset:3584
    ds_read_b64_tr_b16 a[10:11], v209 offset:5632
    ds_read_b64_tr_b16 a[12:13], v209 offset:4608
    ds_read_b64_tr_b16 a[14:15], v209 offset:6656
    ds_read_b64_tr_b16 a[16:17], v209 offset:7168
    ds_read_b64_tr_b16 a[18:19], v209 offset:9216
    ds_read_b64_tr_b16 a[20:21], v209 offset:8192
    ds_read_b64_tr_b16 a[22:23], v209 offset:10240
    ds_read_b64_tr_b16 a[24:25], v209 offset:10752
    ds_read_b64_tr_b16 a[26:27], v209 offset:12800
    ds_read_b64_tr_b16 a[28:29], v209 offset:11776
    ds_read_b64_tr_b16 a[30:31], v209 offset:13824
    ds_read_b64_tr_b16 a[32:33], v209 offset:14336
    ds_read_b64_tr_b16 a[34:35], v209 offset:16384
    ds_read_b64_tr_b16 a[36:37], v209 offset:15360
    ds_read_b64_tr_b16 a[38:39], v209 offset:17408
    ds_read_b64_tr_b16 a[40:41], v209 offset:17920
    ds_read_b64_tr_b16 a[42:43], v209 offset:19968
    ds_read_b64_tr_b16 a[44:45], v209 offset:18944
    ds_read_b64_tr_b16 a[46:47], v209 offset:20992
    ds_read_b64_tr_b16 a[48:49], v209 offset:21504
    ds_read_b64_tr_b16 a[50:51], v209 offset:23552
    ds_read_b64_tr_b16 a[52:53], v209 offset:22528
    ds_read_b64_tr_b16 a[54:55], v209 offset:24576
    ds_read_b64_tr_b16 a[56:57], v209 offset:25088
    ds_read_b64_tr_b16 a[58:59], v209 offset:27136
    ds_read_b64_tr_b16 a[60:61], v209 offset:26112
    ds_read_b64_tr_b16 a[62:63], v209 offset:28160
    ds_read_b64_tr_b16 a[64:65], v209 offset:28672
    ds_read_b64_tr_b16 a[66:67], v209 offset:30720
    ds_read_b64_tr_b16 a[68:69], v209 offset:29696
    ds_read_b64_tr_b16 a[70:71], v209 offset:31744
    ds_read_b64_tr_b16 a[72:73], v209 offset:32256
    ds_read_b64_tr_b16 a[74:75], v209 offset:34304
    ds_read_b64_tr_b16 a[76:77], v209 offset:33280
    ds_read_b64_tr_b16 a[78:79], v209 offset:35328
    ds_read_b64_tr_b16 a[80:81], v209 offset:35840
    ds_read_b64_tr_b16 a[82:83], v209 offset:37888
    ds_read_b64_tr_b16 a[84:85], v209 offset:36864
    ds_read_b64_tr_b16 a[86:87], v209 offset:38912
    ds_read_b64_tr_b16 a[88:89], v209 offset:39424
    ds_read_b64_tr_b16 a[90:91], v209 offset:41472
    ds_read_b64_tr_b16 a[92:93], v209 offset:40448
    ds_read_b64_tr_b16 a[94:95], v209 offset:42496
    ds_read_b64_tr_b16 a[96:97], v209 offset:43008
    ds_read_b64_tr_b16 a[98:99], v209 offset:45056
    ds_read_b64_tr_b16 a[100:101], v209 offset:44032
    ds_read_b64_tr_b16 a[102:103], v209 offset:46080
    ds_read_b64_tr_b16 a[104:105], v209 offset:46592
    ds_read_b64_tr_b16 a[106:107], v209 offset:48640
    ds_read_b64_tr_b16 a[108:109], v209 offset:47616
    ds_read_b64_tr_b16 a[110:111], v209 offset:49664
    ds_read_b64_tr_b16 a[112:113], v209 offset:50176
    ds_read_b64_tr_b16 a[114:115], v209 offset:52224
    ds_read_b64_tr_b16 a[116:117], v209 offset:51200
    ds_read_b64_tr_b16 a[118:119], v209 offset:53248
    ds_read_b64_tr_b16 a[120:121], v209 offset:53248
    ds_read_b64_tr_b16 a[122:123], v209 offset:55296
    ds_read_b64_tr_b16 a[124:125], v209 offset:54272
    ds_read_b64_tr_b16 a[126:127], v209 offset:56320
    s_waitcnt lgkmcnt(0)
    s_barrier
    s_add_u32 m0, s70, 16384
    s_mul_i32 s73, s94, 56
    s_add_u32 s73, s73, 0
    buffer_load_dwordx4 v213, s[20:23], s73 offen lds
    s_add_u32 m0, s70, 17408
    s_mul_i32 s73, s94, 56
    s_add_u32 s73, s73, 28672
    buffer_load_dwordx4 v213, s[20:23], s73 offen lds
    s_add_u32 m0, s70, 18432
    s_mul_i32 s73, s94, 56
    s_add_u32 s73, s73, 57344
    buffer_load_dwordx4 v213, s[20:23], s73 offen lds
    s_add_u32 m0, s70, 19456
    s_mul_i32 s73, s94, 56
    s_add_u32 s73, s73, 86016
    buffer_load_dwordx4 v213, s[20:23], s73 offen lds
    s_add_u32 m0, s70, 20480
    s_mul_i32 s73, s94, 56
    s_add_u32 s73, s73, 114688
    buffer_load_dwordx4 v213, s[20:23], s73 offen lds
    s_add_u32 m0, s70, 21504
    s_mul_i32 s73, s94, 56
    s_add_u32 s73, s73, 143360
    buffer_load_dwordx4 v213, s[20:23], s73 offen lds
    s_add_u32 m0, s70, 22528
    s_mul_i32 s73, s94, 56
    s_add_u32 s73, s73, 172032
    buffer_load_dwordx4 v213, s[20:23], s73 offen lds
    s_add_u32 m0, s70, 23552
    s_mul_i32 s73, s94, 56
    s_add_u32 s73, s73, 200704
    buffer_load_dwordx4 v213, s[20:23], s73 offen lds
    s_add_u32 m0, s70, 24576
    s_mul_i32 s73, s95, 56
    s_add_u32 s73, s73, 0
    buffer_load_dwordx4 v213, s[20:23], s73 offen lds
    s_add_u32 m0, s70, 25600
    s_mul_i32 s73, s95, 56
    s_add_u32 s73, s73, 28672
    buffer_load_dwordx4 v213, s[20:23], s73 offen lds
    s_add_u32 m0, s70, 26624
    s_mul_i32 s73, s95, 56
    s_add_u32 s73, s73, 57344
    buffer_load_dwordx4 v213, s[20:23], s73 offen lds
    s_add_u32 m0, s70, 27648
    s_mul_i32 s73, s95, 56
    s_add_u32 s73, s73, 86016
    buffer_load_dwordx4 v213, s[20:23], s73 offen lds
    s_add_u32 m0, s70, 28672
    s_mul_i32 s73, s95, 56
    s_add_u32 s73, s73, 114688
    buffer_load_dwordx4 v213, s[20:23], s73 offen lds
    s_add_u32 m0, s70, 29696
    s_mul_i32 s73, s95, 56
    s_add_u32 s73, s73, 143360
    buffer_load_dwordx4 v213, s[20:23], s73 offen lds
    s_add_u32 m0, s70, 30720
    s_mul_i32 s73, s95, 56
    s_add_u32 s73, s73, 172032
    buffer_load_dwordx4 v213, s[20:23], s73 offen lds
    s_add_u32 m0, s70, 31744
    s_mul_i32 s73, s95, 56
    s_add_u32 s73, s73, 200704
    buffer_load_dwordx4 v213, s[20:23], s73 offen lds
    s_add_u32 m0, s70, 32768
    s_mul_i32 s73, s96, 56
    s_add_u32 s73, s73, 0
    buffer_load_dwordx4 v213, s[20:23], s73 offen lds
    s_add_u32 m0, s70, 33792
    s_mul_i32 s73, s96, 56
    s_add_u32 s73, s73, 28672
    buffer_load_dwordx4 v213, s[20:23], s73 offen lds
    s_add_u32 m0, s70, 34816
    s_mul_i32 s73, s96, 56
    s_add_u32 s73, s73, 57344
    buffer_load_dwordx4 v213, s[20:23], s73 offen lds
    s_add_u32 m0, s70, 35840
    s_mul_i32 s73, s96, 56
    s_add_u32 s73, s73, 86016
    buffer_load_dwordx4 v213, s[20:23], s73 offen lds
    buffer_load_dword v249, v10, s[40:43], s83 offen sc1
    s_sleep 3
    buffer_load_dword v250, v10, s[40:43], s83 offen sc1
    s_sleep 3
    s_nop 0
Lpoll_P_4:
    s_sub_u32 s6, s6, 1
    s_cbranch_scc1 L_end_P
    buffer_load_dword v251, v10, s[40:43], s83 offen sc1
    s_waitcnt vmcnt(2)
    v_cmp_ne_u32 vcc, s4, v249
    s_nop 1
    s_cbranch_vccz Lpd_P_5
    buffer_load_dword v249, v10, s[40:43], s83 offen sc1
    s_waitcnt vmcnt(2)
    v_cmp_ne_u32 vcc, s4, v250
    s_nop 1
    s_cbranch_vccz Lpd_P_5
    buffer_load_dword v250, v10, s[40:43], s83 offen sc1
    s_waitcnt vmcnt(2)
    v_cmp_ne_u32 vcc, s4, v251
    s_nop 1
    s_cbranch_vccnz Lpoll_P_4
    s_nop 1
Lpd_P_5:
    s_lshl_b32 s58, s67, 16
    s_lshl_b32 s60, s3, 14
    s_add_u32 s58, s58, s60
    s_add_u32 m0, s70, 0
    s_nop 0
    buffer_load_dwordx4 v4, s[40:43], s58 offen offset:0 sc1 lds
    buffer_load_dwordx4 v4, s[40:43], s58 offen offset:1024 sc1 lds
    buffer_load_dwordx4 v4, s[40:43], s58 offen offset:2048 sc1 lds
    buffer_load_dwordx4 v4, s[40:43], s58 offen offset:3072 sc1 lds
    s_add_u32 m0, s70, 4096
    s_add_u32 s58, s58, 4096
    buffer_load_dwordx4 v4, s[40:43], s58 offen offset:0 sc1 lds
    buffer_load_dwordx4 v4, s[40:43], s58 offen offset:1024 sc1 lds
    buffer_load_dwordx4 v4, s[40:43], s58 offen offset:2048 sc1 lds
    buffer_load_dwordx4 v4, s[40:43], s58 offen offset:3072 sc1 lds
    s_add_u32 m0, s70, 8192
    s_add_u32 s58, s58, 4096
    buffer_load_dwordx4 v4, s[40:43], s58 offen offset:0 sc1 lds
    buffer_load_dwordx4 v4, s[40:43], s58 offen offset:1024 sc1 lds
    buffer_load_dwordx4 v4, s[40:43], s58 offen offset:2048 sc1 lds
    buffer_load_dwordx4 v4, s[40:43], s58 offen offset:3072 sc1 lds
    s_add_u32 m0, s70, 12288
    s_add_u32 s58, s58, 4096
    buffer_load_dwordx4 v4, s[40:43], s58 offen offset:0 sc1 lds
    buffer_load_dwordx4 v4, s[40:43], s58 offen offset:1024 sc1 lds
    buffer_load_dwordx4 v4, s[40:43], s58 offen offset:2048 sc1 lds
    buffer_load_dwordx4 v4, s[40:43], s58 offen offset:3072 sc1 lds
    v_and_b32 v64, 1, v3
    v_mul_u32_u24 v64, 36864, v64
    v_lshl_add_u32 v64, v2, 4, v64
    v_lshrrev_b32 v65, 5, v1
    v_lshl_add_u32 v64, v65, 8, v64
    s_lshr_b32 s60, s3, 1
    s_mul_i32 s60, s60, 73728
    s_add_u32 s60, s60, 12288
    v_add_u32 v64, s60, v64
    ds_read_b64_tr_b16 a[128:129], v215 offset:16384
    ds_read_b64_tr_b16 a[130:131], v215 offset:17408
    ds_read_b64_tr_b16 a[132:133], v216 offset:16384
    ds_read_b64_tr_b16 a[134:135], v216 offset:17408
    ds_read_b64_tr_b16 a[136:137], v215 offset:18432
    ds_read_b64_tr_b16 a[138:139], v215 offset:19456
    ds_read_b64_tr_b16 a[140:141], v216 offset:18432
    ds_read_b64_tr_b16 a[142:143], v216 offset:19456
    ds_read_b64_tr_b16 a[144:145], v215 offset:20480
    ds_read_b64_tr_b16 a[146:147], v215 offset:21504
    ds_read_b64_tr_b16 a[148:149], v216 offset:20480
    ds_read_b64_tr_b16 a[150:151], v216 offset:21504
    ds_read_b64_tr_b16 a[152:153], v215 offset:22528
    ds_read_b64_tr_b16 a[154:155], v215 offset:23552
    ds_read_b64_tr_b16 a[156:157], v216 offset:22528
    ds_read_b64_tr_b16 a[158:159], v216 offset:23552
    ds_read_b64_tr_b16 a[160:161], v215 offset:24576
    ds_read_b64_tr_b16 a[162:163], v215 offset:25600
    ds_read_b64_tr_b16 a[164:165], v216 offset:24576
    ds_read_b64_tr_b16 a[166:167], v216 offset:25600
    ds_read_b64_tr_b16 a[168:169], v215 offset:26624
    ds_read_b64_tr_b16 a[170:171], v215 offset:27648
    ds_read_b64_tr_b16 a[172:173], v216 offset:26624
    ds_read_b64_tr_b16 a[174:175], v216 offset:27648
    ds_read_b64_tr_b16 a[176:177], v215 offset:28672
    ds_read_b64_tr_b16 a[178:179], v215 offset:29696
    ds_read_b64_tr_b16 a[180:181], v216 offset:28672
    ds_read_b64_tr_b16 a[182:183], v216 offset:29696
    ds_read_b64_tr_b16 a[184:185], v215 offset:30720
    ds_read_b64_tr_b16 a[186:187], v215 offset:31744
    ds_read_b64_tr_b16 a[188:189], v216 offset:30720
    ds_read_b64_tr_b16 a[190:191], v216 offset:31744
    ds_read_b64_tr_b16 a[192:193], v215 offset:32768
    ds_read_b64_tr_b16 a[194:195], v215 offset:33792
    ds_read_b64_tr_b16 a[196:197], v216 offset:32768
    ds_read_b64_tr_b16 a[198:199], v216 offset:33792
    ds_read_b64_tr_b16 a[200:201], v215 offset:34816
    ds_read_b64_tr_b16 a[202:203], v215 offset:35840
    ds_read_b64_tr_b16 a[204:205], v216 offset:34816
    ds_read_b64_tr_b16 a[206:207], v216 offset:35840
    v_lshlrev_b32 v192, 16, v192
    v_lshlrev_b32 v193, 16, v193
    v_lshlrev_b32 v194, 16, v194
    v_lshlrev_b32 v195, 16, v195
    v_lshlrev_b32 v196, 16, v196
    v_lshlrev_b32 v197, 16, v197
    v_lshlrev_b32 v198, 16, v198
    v_lshlrev_b32 v199, 16, v199
    v_lshlrev_b32 v200, 16, v200
    v_lshlrev_b32 v201, 16, v201
    v_lshlrev_b32 v202, 16, v202
    v_lshlrev_b32 v203, 16, v203
    v_lshlrev_b32 v204, 16, v204
    v_lshlrev_b32 v205, 16, v205
    v_lshlrev_b32 v206, 16, v206
    v_lshlrev_b32 v207, 16, v207
    s_waitcnt vmcnt(8)
    s_barrier
    ds_read_b128 v[32:35], v64 offset:0
    ds_read_b128 v[36:39], v64 offset:512
    ds_read_b128 v[40:43], v64 offset:1024
    ds_read_b128 v[44:47], v64 offset:1536
    ds_read_b128 v[48:51], v64 offset:2048
    ds_read_b128 v[52:55], v64 offset:2560
    s_waitcnt lgkmcnt(5)
    v_mfma_f32_32x32x16_bf16 v[192:207], v[32:35], a[0:3], v[192:207]
    ds_read_b128 v[56:59], v64 offset:3072
    s_add_u32 m0, s70, 16384
    s_mul_i32 s73, s96, 56
    s_add_u32 s73, s73, 114688
    buffer_load_dwordx4 v213, s[20:23], s73 offen lds
    s_waitcnt lgkmcnt(5)
    v_mfma_f32_32x32x16_bf16 v[192:207], v[36:39], a[4:7], v[192:207]
    ds_read_b128 v[60:63], v64 offset:3584
    s_waitcnt lgkmcnt(5)
    v_mfma_f32_32x32x16_bf16 v[192:207], v[40:43], a[8:11], v[192:207]
    ds_read_b128 v[32:35], v64 offset:4096
    s_waitcnt lgkmcnt(5)
    v_mfma_f32_32x32x16_bf16 v[192:207], v[44:47], a[12:15], v[192:207]
    ds_read_b128 v[36:39], v64 offset:4608
    s_add_u32 m0, s70, 17408
    s_mul_i32 s73, s96, 56
    s_add_u32 s73, s73, 143360
    buffer_load_dwordx4 v213, s[20:23], s73 offen lds
    s_waitcnt lgkmcnt(5)
    v_mfma_f32_32x32x16_bf16 v[192:207], v[48:51], a[16:19], v[192:207]
    ds_read_b128 v[40:43], v64 offset:5120
    s_waitcnt lgkmcnt(5)
    v_mfma_f32_32x32x16_bf16 v[192:207], v[52:55], a[20:23], v[192:207]
    ds_read_b128 v[44:47], v64 offset:5632
    s_waitcnt lgkmcnt(5)
    v_mfma_f32_32x32x16_bf16 v[192:207], v[56:59], a[24:27], v[192:207]
    ds_read_b128 v[48:51], v64 offset:6144
    s_add_u32 m0, s70, 18432
    s_mul_i32 s73, s96, 56
    s_add_u32 s73, s73, 172032
    buffer_load_dwordx4 v213, s[20:23], s73 offen lds
    s_waitcnt lgkmcnt(5)
    v_mfma_f32_32x32x16_bf16 v[192:207], v[60:63], a[28:31], v[192:207]
    ds_read_b128 v[52:55], v64 offset:6656
    s_waitcnt lgkmcnt(5)
    v_mfma_f32_32x32x16_bf16 v[192:207], v[32:35], a[32:35], v[192:207]
    ds_read_b128 v[56:59], v64 offset:7168
    s_waitcnt lgkmcnt(5)
    v_mfma_f32_32x32x16_bf16 v[192:207], v[36:39], a[36:39], v[192:207]
    ds_read_b128 v[60:63], v64 offset:7680
    s_add_u32 m0, s70, 19456
    s_mul_i32 s73, s96, 56
    s_add_u32 s73, s73, 200704
    buffer_load_dwordx4 v213, s[20:23], s73 offen lds
    s_waitcnt lgkmcnt(5)
    v_mfma_f32_32x32x16_bf16 v[192:207], v[40:43], a[40:43], v[192:207]
    s_waitcnt lgkmcnt(4)
    v_mfma_f32_32x32x16_bf16 v[192:207], v[44:47], a[44:47], v[192:207]
    s_waitcnt vmcnt(4)
    s_barrier
    ds_read_b128 v[32:35], v64 offset:8192
    ds_read_b128 v[36:39], v64 offset:8704
    s_waitcnt lgkmcnt(5)
    v_mfma_f32_32x32x16_bf16 v[192:207], v[48:51], a[48:51], v[192:207]
    ds_read_b128 v[40:43], v64 offset:9216
    s_add_u32 m0, s70, 20480
    s_mul_i32 s73, s97, 56
    s_add_u32 s73, s73, 0
    buffer_load_dwordx4 v213, s[20:23], s73 offen lds
    s_waitcnt lgkmcnt(5)
    v_mfma_f32_32x32x16_bf16 v[192:207], v[52:55], a[52:55], v[192:207]
    ds_read_b128 v[44:47], v64 offset:9728
    s_waitcnt lgkmcnt(5)
    v_mfma_f32_32x32x16_bf16 v[192:207], v[56:59], a[56:59], v[192:207]
    ds_read_b128 v[48:51], v64 offset:10240
    s_waitcnt lgkmcnt(5)
    v_mfma_f32_32x32x16_bf16 v[192:207], v[60:63], a[60:63], v[192:207]
    ds_read_b128 v[52:55], v64 offset:10752
    s_add_u32 m0, s70, 21504
    s_mul_i32 s73, s97, 56
    s_add_u32 s73, s73, 28672
    buffer_load_dwordx4 v213, s[20:23], s73 offen lds
    s_waitcnt lgkmcnt(5)
    v_mfma_f32_32x32x16_bf16 v[192:207], v[32:35], a[64:67], v[192:207]
    ds_read_b128 v[56:59], v64 offset:11264
    s_waitcnt lgkmcnt(5)
    v_mfma_f32_32x32x16_bf16 v[192:207], v[36:39], a[68:71], v[192:207]
    ds_read_b128 v[60:63], v64 offset:11776
    s_waitcnt lgkmcnt(5)
    v_mfma_f32_32x32x16_bf16 v[192:207], v[40:43], a[72:75], v[192:207]
    ds_read_b128 v[32:35], v64 offset:12288
    s_add_u32 m0, s70, 22528
    s_mul_i32 s73, s97, 56
    s_add_u32 s73, s73, 57344
    buffer_load_dwordx4 v213, s[20:23], s73 offen lds
    s_waitcnt lgkmcnt(5)
    v_mfma_f32_32x32x16_bf16 v[192:207], v[44:47], a[76:79], v[192:207]
    ds_read_b128 v[36:39], v64 offset:12800
    s_waitcnt lgkmcnt(5)
    v_mfma_f32_32x32x16_bf16 v[192:207], v[48:51], a[80:83], v[192:207]
    ds_read_b128 v[40:43], v64 offset:13312
    s_waitcnt lgkmcnt(5)
    v_mfma_f32_32x32x16_bf16 v[192:207], v[52:55], a[84:87], v[192:207]
    ds_read_b128 v[44:47], v64 offset:13824
    s_add_u32 m0, s70, 23552
    s_mul_i32 s73, s97, 56
    s_add_u32 s73, s73, 86016
    buffer_load_dwordx4 v213, s[20:23], s73 offen lds
    s_waitcnt lgkmcnt(5)
    v_mfma_f32_32x32x16_bf16 v[192:207], v[56:59], a[88:91], v[192:207]
    ds_read_b128 v[48:51], v64 offset:14336
    s_waitcnt lgkmcnt(5)
    v_mfma_f32_32x32x16_bf16 v[192:207], v[60:63], a[92:95], v[192:207]
    ds_read_b128 v[52:55], v64 offset:14848
    s_waitcnt lgkmcnt(5)
    v_mfma_f32_32x32x16_bf16 v[192:207], v[32:35], a[96:99], v[192:207]
    ds_read_b128 v[56:59], v64 offset:15360
    s_add_u32 m0, s70, 24576
    s_mul_i32 s73, s97, 56
    s_add_u32 s73, s73, 114688
    buffer_load_dwordx4 v213, s[20:23], s73 offen lds
    s_waitcnt lgkmcnt(5)
    v_mfma_f32_32x32x16_bf16 v[192:207], v[36:39], a[100:103], v[192:207]
    ds_read_b128 v[60:63], v64 offset:15872
    s_waitcnt lgkmcnt(5)
    v_mfma_f32_32x32x16_bf16 v[192:207], v[40:43], a[104:107], v[192:207]
    s_waitcnt lgkmcnt(4)
    v_mfma_f32_32x32x16_bf16 v[192:207], v[44:47], a[108:111], v[192:207]
    s_add_u32 m0, s70, 25600
    s_mul_i32 s73, s97, 56
    s_add_u32 s73, s73, 143360
    buffer_load_dwordx4 v213, s[20:23], s73 offen lds
    s_waitcnt lgkmcnt(3)
    v_mfma_f32_32x32x16_bf16 v[192:207], v[48:51], a[112:115], v[192:207]
    s_waitcnt lgkmcnt(2)
    v_mfma_f32_32x32x16_bf16 v[192:207], v[52:55], a[116:119], v[192:207]
    s_waitcnt lgkmcnt(1)
    v_mfma_f32_32x32x16_bf16 v[192:207], v[56:59], a[120:123], v[192:207]
    s_add_u32 m0, s70, 26624
    s_mul_i32 s73, s97, 56
    s_add_u32 s73, s73, 172032
    buffer_load_dwordx4 v213, s[20:23], s73 offen lds
    s_waitcnt lgkmcnt(0)
    v_mfma_f32_32x32x16_bf16 v[192:207], v[60:63], a[124:127], v[192:207]
    s_nop 11
    v_pk_mul_f32 v[68:69], v[192:193], v[192:193]
    v_pk_mul_f32 v[70:71], v[194:195], v[194:195]
    v_pk_mul_f32 v[72:73], v[196:197], v[196:197]
    v_pk_mul_f32 v[74:75], v[198:199], v[198:199]
    v_pk_mul_f32 v[76:77], v[200:201], v[200:201]
    v_pk_mul_f32 v[78:79], v[202:203], v[202:203]
    v_pk_mul_f32 v[80:81], v[204:205], v[204:205]
    v_pk_mul_f32 v[82:83], v[206:207], v[206:207]
    s_add_u32 m0, s70, 27648
    s_mul_i32 s73, s97, 56
    s_add_u32 s73, s73, 200704
    buffer_load_dwordx4 v213, s[20:23], s73 offen lds
    v_add_f32_dpp v84, v192, v192 row_mirror row_mask:0xf bank_mask:0x3
    v_add_f32_dpp v85, v193, v193 row_mirror row_mask:0xf bank_mask:0x3
    v_add_f32_dpp v86, v196, v196 row_mirror row_mask:0xf bank_mask:0x3
    v_add_f32_dpp v87, v197, v197 row_mirror row_mask:0xf bank_mask:0x3
    v_add_f32_dpp v88, v200, v200 row_mirror row_mask:0xf bank_mask:0x3
    v_add_f32_dpp v89, v201, v201 row_mirror row_mask:0xf bank_mask:0x3
    v_add_f32_dpp v90, v204, v204 row_mirror row_mask:0xf bank_mask:0x3
    v_add_f32_dpp v91, v205, v205 row_mirror row_mask:0xf bank_mask:0x3
    s_add_u32 m0, s70, 28672
    s_mul_i32 s73, s98, 56
    s_add_u32 s73, s73, 0
    buffer_load_dwordx4 v213, s[20:23], s73 offen lds
    v_add_f32_dpp v92, v68, v68 row_mirror row_mask:0xf bank_mask:0x3
    v_add_f32_dpp v93, v69, v69 row_mirror row_mask:0xf bank_mask:0x3
    v_add_f32_dpp v94, v72, v72 row_mirror row_mask:0xf bank_mask:0x3
    v_add_f32_dpp v95, v73, v73 row_mirror row_mask:0xf bank_mask:0x3
    v_add_f32_dpp v96, v76, v76 row_mirror row_mask:0xf bank_mask:0x3
    v_add_f32_dpp v97, v77, v77 row_mirror row_mask:0xf bank_mask:0x3
    v_add_f32_dpp v98, v80, v80 row_mirror row_mask:0xf bank_mask:0x3
    v_add_f32_dpp v99, v81, v81 row_mirror row_mask:0xf bank_mask:0x3
    s_add_u32 m0, s70, 29696
    s_mul_i32 s73, s98, 56
    s_add_u32 s73, s73, 28672
    buffer_load_dwordx4 v213, s[20:23], s73 offen lds
    v_add_f32_dpp v84, v194, v194 row_mirror row_mask:0xf bank_mask:0xc
    v_add_f32_dpp v85, v195, v195 row_mirror row_mask:0xf bank_mask:0xc
    v_add_f32_dpp v86, v198, v198 row_mirror row_mask:0xf bank_mask:0xc
    v_add_f32_dpp v87, v199, v199 row_mirror row_mask:0xf bank_mask:0xc
    v_add_f32_dpp v88, v202, v202 row_mirror row_mask:0xf bank_mask:0xc
    v_add_f32_dpp v89, v203, v203 row_mirror row_mask:0xf bank_mask:0xc
    v_add_f32_dpp v90, v206, v206 row_mirror row_mask:0xf bank_mask:0xc
    v_add_f32_dpp v91, v207, v207 row_mirror row_mask:0xf bank_mask:0xc
    s_add_u32 m0, s70, 30720
    s_mul_i32 s73, s98, 56
    s_add_u32 s73, s73, 57344
    buffer_load_dwordx4 v213, s[20:23], s73 offen lds
    v_add_f32_dpp v92, v70, v70 row_mirror row_mask:0xf bank_mask:0xc
    v_add_f32_dpp v93, v71, v71 row_mirror row_mask:0xf bank_mask:0xc
    v_add_f32_dpp v94, v74, v74 row_mirror row_mask:0xf bank_mask:0xc
    v_add_f32_dpp v95, v75, v75 row_mirror row_mask:0xf bank_mask:0xc
    v_add_f32_dpp v96, v78, v78 row_mirror row_mask:0xf bank_mask:0xc
    v_add_f32_dpp v97, v79, v79 row_mirror row_mask:0xf bank_mask:0xc
    v_add_f32_dpp v98, v82, v82 row_mirror row_mask:0xf bank_mask:0xc
    v_add_f32_dpp v99, v83, v83 row_mirror row_mask:0xf bank_mask:0xc
    s_add_u32 m0, s70, 31744
    s_mul_i32 s73, s98, 56
    s_add_u32 s73, s73, 86016
    buffer_load_dwordx4 v213, s[20:23], s73 offen lds
    v_add_f32_dpp v84, v84, v84 row_half_mirror row_mask:0xf bank_mask:0x5
    v_add_f32_dpp v86, v86, v86 row_half_mirror row_mask:0xf bank_mask:0x5
    v_add_f32_dpp v88, v88, v88 row_half_mirror row_mask:0xf bank_mask:0x5
    v_add_f32_dpp v90, v90, v90 row_half_mirror row_mask:0xf bank_mask:0x5
    v_add_f32_dpp v92, v92, v92 row_half_mirror row_mask:0xf bank_mask:0x5
    v_add_f32_dpp v94, v94, v94 row_half_mirror row_mask:0xf bank_mask:0x5
    v_add_f32_dpp v96, v96, v96 row_half_mirror row_mask:0xf bank_mask:0x5
    v_add_f32_dpp v98, v98, v98 row_half_mirror row_mask:0xf bank_mask:0x5
    v_add_f32_dpp v84, v85, v85 row_half_mirror row_mask:0xf bank_mask:0xa
    v_add_f32_dpp v86, v87, v87 row_half_mirror row_mask:0xf bank_mask:0xa
    v_add_f32_dpp v88, v89, v89 row_half_mirror row_mask:0xf bank_mask:0xa
    v_add_f32_dpp v90, v91, v91 row_half_mirror row_mask:0xf bank_mask:0xa
    v_add_f32_dpp v92, v93, v93 row_half_mirror row_mask:0xf bank_mask:0xa
    v_add_f32_dpp v94, v95, v95 row_half_mirror row_mask:0xf bank_mask:0xa
    v_add_f32_dpp v96, v97, v97 row_half_mirror row_mask:0xf bank_mask:0xa
    v_add_f32_dpp v98, v99, v99 row_half_mirror row_mask:0xf bank_mask:0xa
    v_add_f32_dpp v85, v84, v84 quad_perm:[1,0,3,2] row_mask:0xf bank_mask:0xf
    v_add_f32_dpp v87, v86, v86 quad_perm:[1,0,3,2] row_mask:0xf bank_mask:0xf
    v_add_f32_dpp v89, v88, v88 quad_perm:[1,0,3,2] row_mask:0xf bank_mask:0xf
    v_add_f32_dpp v91, v90, v90 quad_perm:[1,0,3,2] row_mask:0xf bank_mask:0xf
    v_add_f32_dpp v93, v92, v92 quad_perm:[1,0,3,2] row_mask:0xf bank_mask:0xf
    v_add_f32_dpp v95, v94, v94 quad_perm:[1,0,3,2] row_mask:0xf bank_mask:0xf
    v_add_f32_dpp v97, v96, v96 quad_perm:[1,0,3,2] row_mask:0xf bank_mask:0xf
    v_add_f32_dpp v99, v98, v98 quad_perm:[1,0,3,2] row_mask:0xf bank_mask:0xf
    v_add_f32_dpp v68, v85, v85 quad_perm:[2,3,0,1] row_mask:0xf bank_mask:0xf
    v_add_f32_dpp v69, v87, v87 quad_perm:[2,3,0,1] row_mask:0xf bank_mask:0xf
    v_add_f32_dpp v70, v89, v89 quad_perm:[2,3,0,1] row_mask:0xf bank_mask:0xf
    v_add_f32_dpp v71, v91, v91 quad_perm:[2,3,0,1] row_mask:0xf bank_mask:0xf
    v_add_f32_dpp v72, v93, v93 quad_perm:[2,3,0,1] row_mask:0xf bank_mask:0xf
    v_add_f32_dpp v73, v95, v95 quad_perm:[2,3,0,1] row_mask:0xf bank_mask:0xf
    v_add_f32_dpp v74, v97, v97 quad_perm:[2,3,0,1] row_mask:0xf bank_mask:0xf
    v_add_f32_dpp v75, v99, v99 quad_perm:[2,3,0,1] row_mask:0xf bank_mask:0xf
    v_permlane16_swap_b32 v68, v69
    v_permlane16_swap_b32 v70, v71
    v_permlane16_swap_b32 v72, v73
    v_permlane16_swap_b32 v74, v75
    v_add_f32 v84, v68, v69
    v_add_f32 v85, v72, v73
    v_add_f32 v86, v70, v71
    v_add_f32 v87, v74, v75
    v_and_b32 v65, 1, v3
    v_lshlrev_b32 v65, 6, v65
    v_lshrrev_b32 v66, 5, v1
    v_lshl_add_u32 v65, v66, 5, v65
    v_bfe_u32 v67, v1, 2, 2
    v_lshl_add_u32 v65, v67, 3, v65
    s_lshl_b32 s58, s3, 8
    v_add_u32 v65, s58, v65
    ds_write_b64 v65, v[84:85] offset:0
    ds_write_b64 v65, v[86:87] offset:128
    v_and_b32 v67, 31, v1
    v_lshlrev_b32 v65, 9, v66
    v_lshl_add_u32 v65, v67, 4, v65
    v_lshlrev_b32 v66, 8, v66
    v_lshl_add_u32 v66, v67, 3, v66
    s_and_b32 s58, s58, 512
    v_add_u32 v66, s58, v66
    s_lshl_b32 s58, s67, 1
    s_lshr_b32 s60, s3, 1
    s_add_u32 s58, s58, s60
    s_lshl_b32 s58, s58, 12
    s_add_u32 s58, s58, 0x548000
    s_lshl_b32 s60, s66, 9
    s_add_u32 s60, s60, s58
    s_waitcnt lgkmcnt(0)
    s_barrier
    ds_read_b64 v[84:85], v66 offset:0
    v_mov_b32 v89, s4
    v_mov_b32 v91, s4
    s_waitcnt lgkmcnt(0)
    v_mov_b32 v88, v84
    v_mov_b32 v90, v85
    s_nop 0
    v_permlane32_swap_b32 v88, v84
    v_permlane32_swap_b32 v90, v85
    v_add_f32 v88, v88, v84
    v_add_f32 v90, v90, v85
    s_bitcmp0_b32 s3, 0
    s_cselect_b32 exec_lo, -1, 0
    s_mov_b32 exec_hi, 0
    buffer_store_dwordx4 v[88:91], v65, s[40:43], s60 offen sc1
    s_mov_b64 exec, -1
    v_cvt_pk_bf16_f32 v240, v192, v193
    v_cvt_pk_bf16_f32 v241, v194, v195
    v_cvt_pk_bf16_f32 v242, v196, v197
    v_cvt_pk_bf16_f32 v243, v198, v199
    v_cvt_pk_bf16_f32 v244, v200, v201
    v_cvt_pk_bf16_f32 v245, v202, v203
    v_cvt_pk_bf16_f32 v246, v204, v205
    v_cvt_pk_bf16_f32 v247, v206, v207
    s_lshl_b32 s61, s66, 1
    s_and_b32 s60, s3, 1
    s_add_u32 s61, s61, s60
    s_lshl_b32 s61, s61, 7
    s_lshl_b32 s60, s67, 2
    s_add_u32 s61, s61, s60
    s_and_b32 s60, s3, 2
    s_add_u32 s61, s61, s60
    s_lshl_b32 s61, s61, 10
    s_add_u32 s61, s61, 0x200000
    v_lshlrev_b32 v66, 4, v67
    v_cmp_gt_u32 s[86:87], 32, v1
    s_add_u32 m0, s70, 0
    s_mul_i32 s73, s98, 56
    s_add_u32 s73, s73, 114688
    buffer_load_dwordx4 v213, s[20:23], s73 offen lds
    s_add_u32 m0, s70, 1024
    s_mul_i32 s73, s98, 56
    s_add_u32 s73, s73, 143360
    buffer_load_dwordx4 v213, s[20:23], s73 offen lds
    s_add_u32 m0, s70, 2048
    s_mul_i32 s73, s98, 56
    s_add_u32 s73, s73, 172032
    buffer_load_dwordx4 v213, s[20:23], s73 offen lds
    s_add_u32 m0, s70, 3072
    s_mul_i32 s73, s98, 56
    s_add_u32 s73, s73, 200704
    buffer_load_dwordx4 v213, s[20:23], s73 offen lds
    s_add_u32 m0, s70, 4096
    s_mul_i32 s73, s99, 56
    s_add_u32 s73, s73, 0
    buffer_load_dwordx4 v213, s[20:23], s73 offen lds
    s_add_u32 m0, s70, 5120
    s_mul_i32 s73, s99, 56
    s_add_u32 s73, s73, 28672
    buffer_load_dwordx4 v213, s[20:23], s73 offen lds
    s_add_u32 m0, s70, 6144
    s_mul_i32 s73, s99, 56
    s_add_u32 s73, s73, 57344
    buffer_load_dwordx4 v213, s[20:23], s73 offen lds
    s_add_u32 m0, s70, 7168
    s_mul_i32 s73, s99, 56
    s_add_u32 s73, s73, 86016
    buffer_load_dwordx4 v213, s[20:23], s73 offen lds
    s_add_u32 m0, s70, 8192
    s_mul_i32 s73, s99, 56
    s_add_u32 s73, s73, 114688
    buffer_load_dwordx4 v213, s[20:23], s73 offen lds
    s_add_u32 m0, s70, 9216
    s_mul_i32 s73, s99, 56
    s_add_u32 s73, s73, 143360
    buffer_load_dwordx4 v213, s[20:23], s73 offen lds
    s_add_u32 m0, s70, 10240
    s_mul_i32 s73, s99, 56
    s_add_u32 s73, s73, 172032
    buffer_load_dwordx4 v213, s[20:23], s73 offen lds
    s_add_u32 m0, s70, 11264
    s_mul_i32 s73, s99, 56
    s_add_u32 s73, s73, 200704
    buffer_load_dwordx4 v213, s[20:23], s73 offen lds
    s_add_u32 m0, s70, 12288
    s_mul_i32 s73, s100, 56
    s_add_u32 s73, s73, 0
    buffer_load_dwordx4 v213, s[20:23], s73 offen lds
    s_add_u32 m0, s70, 13312
    s_mul_i32 s73, s100, 56
    s_add_u32 s73, s73, 28672
    buffer_load_dwordx4 v213, s[20:23], s73 offen lds
    s_add_u32 m0, s70, 14336
    s_mul_i32 s73, s100, 56
    s_add_u32 s73, s73, 57344
    buffer_load_dwordx4 v213, s[20:23], s73 offen lds
    s_add_u32 m0, s70, 15360
    s_mul_i32 s73, s100, 56
    s_add_u32 s73, s73, 86016
    buffer_load_dwordx4 v213, s[20:23], s73 offen lds
    buffer_load_dwordx4 v[96:99], v65, s[40:43], s58 offen offset:0 sc1
    buffer_load_dwordx4 v[100:103], v65, s[40:43], s58 offen offset:1024 sc1
    buffer_load_dwordx4 v[104:107], v65, s[40:43], s58 offen offset:2048 sc1
    buffer_load_dwordx4 v[108:111], v66, s[40:43], s58 offen offset:3072 sc1
    s_sleep 5
    s_nop 0
Lst_P_6:
    s_sub_u32 s6, s6, 1
    s_cbranch_scc1 L_end_P
    buffer_load_dwordx4 v[112:115], v65, s[40:43], s58 offen offset:0 sc1
    buffer_load_dwordx4 v[116:119], v65, s[40:43], s58 offen offset:1024 sc1
    buffer_load_dwordx4 v[120:123], v65, s[40:43], s58 offen offset:2048 sc1
    buffer_load_dwordx4 v[124:127], v66, s[40:43], s58 offen offset:3072 sc1
    s_waitcnt vmcnt(4)
    v_xor_b32 v97, s4, v97
    v_xor_b32 v99, s4, v99
    v_xor_b32 v101, s4, v101
    v_xor_b32 v103, s4, v103
    v_xor_b32 v105, s4, v105
    v_xor_b32 v107, s4, v107
    v_xor_b32 v109, s4, v109
    v_xor_b32 v111, s4, v111
    v_cndmask_b32 v108, 0, v108, s[86:87]
    v_cndmask_b32 v110, 0, v110, s[86:87]
    v_or3_b32 v97, v97, v99, v101
    v_or3_b32 v103, v103, v105, v107
    v_or3_b32 v97, v97, v109, v111
    v_or_b32 v97, v97, v103
    v_cmp_ne_u32 vcc, 0, v97
    v_add_f32 v128, v96, v100
    v_add_f32 v129, v104, v108
    v_add_f32 v130, v98, v102
    v_add_f32 v131, v106, v110
    s_cbranch_vccz Lstd_P_7
    buffer_load_dwordx4 v[96:99], v65, s[40:43], s58 offen offset:0 sc1
    buffer_load_dwordx4 v[100:103], v65, s[40:43], s58 offen offset:1024 sc1
    buffer_load_dwordx4 v[104:107], v65, s[40:43], s58 offen offset:2048 sc1
    buffer_load_dwordx4 v[108:111], v66, s[40:43], s58 offen offset:3072 sc1
    s_waitcnt vmcnt(4)
    v_xor_b32 v113, s4, v113
    v_xor_b32 v115, s4, v115
    v_xor_b32 v117, s4, v117
    v_xor_b32 v119, s4, v119
    v_xor_b32 v121, s4, v121
    v_xor_b32 v123, s4, v123
    v_xor_b32 v125, s4, v125
    v_xor_b32 v127, s4, v127
    v_cndmask_b32 v124, 0, v124, s[86:87]
    v_cndmask_b32 v126, 0, v126, s[86:87]
    v_or3_b32 v113, v113, v115, v117
    v_or3_b32 v119, v119, v121, v123
    v_or3_b32 v113, v113, v125, v127
    v_or_b32 v113, v113, v119
    v_cmp_ne_u32 vcc, 0, v113
    v_add_f32 v128, v112, v116
    v_add_f32 v129, v120, v124
    v_add_f32 v130, v114, v118
    v_add_f32 v131, v122, v126
    s_cbranch_vccnz Lst_P_6
    s_nop 3
Lstd_P_7:
    v_add_f32 v128, v128, v129
    v_add_f32 v130, v130, v131
    v_mov_b32 v136, v128
    v_mov_b32 v138, v130
    s_nop 0
    v_permlane32_swap_b32 v128, v136
    v_permlane32_swap_b32 v130, v138
    v_add_f32 v128, v128, v136
    v_add_f32 v130, v130, v138
    v_mul_f32 v133, 0x3b124925, v128
    v_mul_f32 v130, 0x3b124925, v130
    v_fma_f32 v130, -v133, v133, v130
    v_max_f32 v130, 0, v130
    v_add_f32 v135, 0x3727c5ac, v130
    v_rsq_f32 v135, v135
    s_nop 0
    v_mul_f32 v130, v130, v135
    v_fmaak_f32 v130, v130, v135, 0x3727c5ac
    v_rsq_f32 v130, v130
    s_nop 0
    v_mul_f32 v135, v135, v130
    s_lshl_b32 s60, s3, 8
    v_lshl_add_u32 v66, v67, 2, s60
    ds_write_b32 v66, v133 offset:1024
    ds_write_b32 v66, v135 offset:1152
    v_lshrrev_b32 v66, 5, v1
    v_lshl_add_u32 v66, v66, 4, s60
    s_waitcnt lgkmcnt(0)
    ds_read_b128 v[140:143], v66 offset:1024
    ds_read_b128 v[156:159], v66 offset:1152
    ds_read_b128 v[144:147], v66 offset:1056
    ds_read_b128 v[160:163], v66 offset:1184
    ds_read_b128 v[148:151], v66 offset:1088
    ds_read_b128 v[164:167], v66 offset:1216
    ds_read_b128 v[152:155], v66 offset:1120
    ds_read_b128 v[168:171], v66 offset:1248
    s_waitcnt lgkmcnt(7)
    v_pk_add_f32 v[192:193], v[192:193], v[140:141] neg_lo:[0,1] neg_hi:[0,1]
    v_pk_add_f32 v[194:195], v[194:195], v[142:143] neg_lo:[0,1] neg_hi:[0,1]
    s_waitcnt lgkmcnt(5)
    v_pk_add_f32 v[196:197], v[196:197], v[144:145] neg_lo:[0,1] neg_hi:[0,1]
    v_pk_add_f32 v[198:199], v[198:199], v[146:147] neg_lo:[0,1] neg_hi:[0,1]
    v_pk_mul_f32 v[192:193], v[192:193], v[156:157]
    v_pk_mul_f32 v[194:195], v[194:195], v[158:159]
    s_waitcnt lgkmcnt(4)
    v_pk_mul_f32 v[196:197], v[196:197], v[160:161]
    v_pk_mul_f32 v[198:199], v[198:199], v[162:163]
    v_cvt_pk_bf16_f32 v84, v192, v193
    v_cvt_pk_bf16_f32 v85, v194, v195
    v_cvt_pk_bf16_f32 v86, v196, v197
    v_cvt_pk_bf16_f32 v87, v198, v199
    buffer_store_dwordx4 v[84:87], v4, s[40:43], s61 offen offset:0 sc1
    s_waitcnt lgkmcnt(3)
    v_pk_add_f32 v[200:201], v[200:201], v[148:149] neg_lo:[0,1] neg_hi:[0,1]
    v_pk_add_f32 v[202:203], v[202:203], v[150:151] neg_lo:[0,1] neg_hi:[0,1]
    s_waitcnt lgkmcnt(1)
    v_pk_add_f32 v[204:205], v[204:205], v[152:153] neg_lo:[0,1] neg_hi:[0,1]
    v_pk_add_f32 v[206:207], v[206:207], v[154:155] neg_lo:[0,1] neg_hi:[0,1]
    v_pk_mul_f32 v[200:201], v[200:201], v[164:165]
    v_pk_mul_f32 v[202:203], v[202:203], v[166:167]
    s_waitcnt lgkmcnt(0)
    v_pk_mul_f32 v[204:205], v[204:205], v[168:169]
    v_pk_mul_f32 v[206:207], v[206:207], v[170:171]
    v_cvt_pk_bf16_f32 v88, v200, v201
    v_cvt_pk_bf16_f32 v89, v202, v203
    v_cvt_pk_bf16_f32 v90, v204, v205
    v_cvt_pk_bf16_f32 v91, v206, v207
    buffer_store_dwordx4 v[88:91], v4, s[40:43], s61 offen offset:1024 sc1
    ds_read_b64_tr_b16 a[208:209], v215 offset:16384
    ds_read_b64_tr_b16 a[210:211], v215 offset:17408
    ds_read_b64_tr_b16 a[212:213], v216 offset:16384
    ds_read_b64_tr_b16 a[214:215], v216 offset:17408
    ds_read_b64_tr_b16 a[216:217], v215 offset:18432
    ds_read_b64_tr_b16 a[218:219], v215 offset:19456
    ds_read_b64_tr_b16 a[220:221], v216 offset:18432
    ds_read_b64_tr_b16 a[222:223], v216 offset:19456
    ds_read_b64_tr_b16 a[224:225], v215 offset:20480
    ds_read_b64_tr_b16 a[226:227], v215 offset:21504
    ds_read_b64_tr_b16 a[228:229], v216 offset:20480
    ds_read_b64_tr_b16 a[230:231], v216 offset:21504
    ds_read_b64_tr_b16 a[232:233], v215 offset:22528
    ds_read_b64_tr_b16 a[234:235], v215 offset:23552
    ds_read_b64_tr_b16 a[236:237], v216 offset:22528
    ds_read_b64_tr_b16 a[238:239], v216 offset:23552
    ds_read_b64_tr_b16 a[240:241], v215 offset:24576
    ds_read_b64_tr_b16 a[242:243], v215 offset:25600
    ds_read_b64_tr_b16 a[244:245], v216 offset:24576
    ds_read_b64_tr_b16 a[246:247], v216 offset:25600
    ds_read_b64_tr_b16 a[248:249], v215 offset:26624
    ds_read_b64_tr_b16 a[250:251], v215 offset:27648
    ds_read_b64_tr_b16 a[252:253], v216 offset:26624
    ds_read_b64_tr_b16 a[254:255], v216 offset:27648
    ds_read_b64_tr_b16 a[0:1], v215 offset:28672
    ds_read_b64_tr_b16 a[2:3], v215 offset:29696
    ds_read_b64_tr_b16 a[4:5], v216 offset:28672
    ds_read_b64_tr_b16 a[6:7], v216 offset:29696
    ds_read_b64_tr_b16 a[8:9], v215 offset:30720
    ds_read_b64_tr_b16 a[10:11], v215 offset:31744
    ds_read_b64_tr_b16 a[12:13], v216 offset:30720
    ds_read_b64_tr_b16 a[14:15], v216 offset:31744
    ds_read_b64_tr_b16 a[16:17], v215 offset:0
    ds_read_b64_tr_b16 a[18:19], v215 offset:1024
    ds_read_b64_tr_b16 a[20:21], v216 offset:0
    ds_read_b64_tr_b16 a[22:23], v216 offset:1024
    ds_read_b64_tr_b16 a[24:25], v215 offset:2048
    ds_read_b64_tr_b16 a[26:27], v215 offset:3072
    ds_read_b64_tr_b16 a[28:29], v216 offset:2048
    ds_read_b64_tr_b16 a[30:31], v216 offset:3072
    ds_read_b64_tr_b16 a[32:33], v215 offset:4096
    ds_read_b64_tr_b16 a[34:35], v215 offset:5120
    ds_read_b64_tr_b16 a[36:37], v216 offset:4096
    ds_read_b64_tr_b16 a[38:39], v216 offset:5120
    ds_read_b64_tr_b16 a[40:41], v215 offset:6144
    ds_read_b64_tr_b16 a[42:43], v215 offset:7168
    ds_read_b64_tr_b16 a[44:45], v216 offset:6144
    ds_read_b64_tr_b16 a[46:47], v216 offset:7168
    ds_read_b64_tr_b16 a[48:49], v215 offset:8192
    ds_read_b64_tr_b16 a[50:51], v215 offset:9216
    ds_read_b64_tr_b16 a[52:53], v216 offset:8192
    ds_read_b64_tr_b16 a[54:55], v216 offset:9216
    ds_read_b64_tr_b16 a[56:57], v215 offset:10240
    ds_read_b64_tr_b16 a[58:59], v215 offset:11264
    ds_read_b64_tr_b16 a[60:61], v216 offset:10240
    ds_read_b64_tr_b16 a[62:63], v216 offset:11264
    ds_read_b64_tr_b16 a[64:65], v215 offset:12288
    ds_read_b64_tr_b16 a[66:67], v215 offset:13312
    ds_read_b64_tr_b16 a[68:69], v216 offset:12288
    ds_read_b64_tr_b16 a[70:71], v216 offset:13312
    ds_read_b64_tr_b16 a[72:73], v215 offset:14336
    ds_read_b64_tr_b16 a[74:75], v215 offset:15360
    ds_read_b64_tr_b16 a[76:77], v216 offset:14336
    ds_read_b64_tr_b16 a[78:79], v216 offset:15360
    s_waitcnt vmcnt(0)
    v_mov_b32 v8, s4
    s_mov_b64 exec, 1
    buffer_store_dword v8, v9, s[40:43], s81 offen sc1
    s_mov_b64 exec, -1
    s_waitcnt lgkmcnt(4)
    s_add_u32 m0, s70, 12288
    s_mul_i32 s73, s100, 56
    s_add_u32 s73, s73, 114688
    buffer_load_dwordx4 v213, s[20:23], s73 offen lds
    s_add_u32 m0, s70, 13312
    s_mul_i32 s73, s100, 56
    s_add_u32 s73, s73, 143360
    buffer_load_dwordx4 v213, s[20:23], s73 offen lds
    s_waitcnt lgkmcnt(0)
    s_add_u32 m0, s70, 14336
    s_mul_i32 s73, s100, 56
    s_add_u32 s73, s73, 172032
    buffer_load_dwordx4 v213, s[20:23], s73 offen lds
    s_add_u32 m0, s70, 15360
    s_mul_i32 s73, s100, 56
    s_add_u32 s73, s73, 200704
    buffer_load_dwordx4 v213, s[20:23], s73 offen lds
    s_add_u32 m0, s70, 16384
    s_mul_i32 s73, s101, 56
    s_add_u32 s73, s73, 0
    buffer_load_dwordx4 v213, s[20:23], s73 offen lds
    s_add_u32 m0, s70, 17408
    s_mul_i32 s73, s101, 56
    s_add_u32 s73, s73, 28672
    buffer_load_dwordx4 v213, s[20:23], s73 offen lds
    s_add_u32 m0, s70, 18432
    s_mul_i32 s73, s101, 56
    s_add_u32 s73, s73, 57344
    buffer_load_dwordx4 v213, s[20:23], s73 offen lds
    s_add_u32 m0, s70, 19456
    s_mul_i32 s73, s101, 56
    s_add_u32 s73, s73, 86016
    buffer_load_dwordx4 v213, s[20:23], s73 offen lds
    s_add_u32 m0, s70, 20480
    s_mul_i32 s73, s101, 56
    s_add_u32 s73, s73, 114688
    buffer_load_dwordx4 v213, s[20:23], s73 offen lds
    s_add_u32 m0, s70, 21504
    s_mul_i32 s73, s101, 56
    s_add_u32 s73, s73, 143360
    buffer_load_dwordx4 v213, s[20:23], s73 offen lds
    s_add_u32 m0, s70, 22528
    s_mul_i32 s73, s101, 56
    s_add_u32 s73, s73, 172032
    buffer_load_dwordx4 v213, s[20:23], s73 offen lds
    s_add_u32 m0, s70, 23552
    s_mul_i32 s73, s101, 56
    s_add_u32 s73, s73, 200704
    buffer_load_dwordx4 v213, s[20:23], s73 offen lds
    s_add_u32 m0, s70, 24576
    s_mul_i32 s73, s48, 64
    s_add_u32 s73, s73, 0
    buffer_load_dwordx4 v214, s[24:27], s73 offen lds
    s_add_u32 m0, s70, 25600
    s_mul_i32 s73, s48, 64
    s_add_u32 s73, s73, 32768
    buffer_load_dwordx4 v214, s[24:27], s73 offen lds
    s_add_u32 m0, s70, 26624
    s_mul_i32 s73, s48, 64
    s_add_u32 s73, s73, 65536
    buffer_load_dwordx4 v214, s[24:27], s73 offen lds
    s_add_u32 m0, s70, 27648
    s_mul_i32 s73, s48, 64
    s_add_u32 s73, s73, 98304
    buffer_load_dwordx4 v214, s[24:27], s73 offen lds
    s_add_u32 m0, s70, 28672
    s_mul_i32 s73, s48, 64
    s_add_u32 s73, s73, 131072
    buffer_load_dwordx4 v214, s[24:27], s73 offen lds
    s_add_u32 m0, s70, 29696
    s_mul_i32 s73, s48, 64
    s_add_u32 s73, s73, 163840
    buffer_load_dwordx4 v214, s[24:27], s73 offen lds
    s_add_u32 m0, s70, 30720
    s_mul_i32 s73, s48, 64
    s_add_u32 s73, s73, 196608
    buffer_load_dwordx4 v214, s[24:27], s73 offen lds
    s_add_u32 m0, s70, 31744
    s_mul_i32 s73, s48, 64
    s_add_u32 s73, s73, 229376
    buffer_load_dwordx4 v214, s[24:27], s73 offen lds
    s_add_u32 m0, s70, 32768
    s_mul_i32 s73, s49, 64
    s_add_u32 s73, s73, 0
    buffer_load_dwordx4 v214, s[24:27], s73 offen lds
    s_add_u32 m0, s70, 33792
    s_mul_i32 s73, s49, 64
    s_add_u32 s73, s73, 32768
    buffer_load_dwordx4 v214, s[24:27], s73 offen lds
    s_add_u32 m0, s70, 34816
    s_mul_i32 s73, s49, 64
    s_add_u32 s73, s73, 65536
    buffer_load_dwordx4 v214, s[24:27], s73 offen lds
    s_add_u32 m0, s70, 35840
    s_mul_i32 s73, s49, 64
    s_add_u32 s73, s73, 98304
    buffer_load_dwordx4 v214, s[24:27], s73 offen lds
    s_lshl_b32 s71, s64, 18
    s_lshl_b32 s86, s3, 15
    s_add_u32 s71, s71, s86
    s_add_u32 s71, s71, 0x200000
    s_add_u32 s72, s71, 0x20000
    s_mul_i32 s58, s66, 229376
    s_add_u32 s58, s58, 0x3c0000
    s_lshl_b32 s86, s65, 2
    s_add_u32 s86, s86, s3
    s_lshl_b32 s86, s86, 10
    s_add_u32 s57, s58, s86
    s_mul_i32 s86, s3, 28672
    s_add_u32 s58, s58, s86
    s_add_u32 s59, s58, 114688
    v_lshrrev_b32 v208, 5, v1
    v_lshlrev_b32 v208, 3, v208
    s_lshl_b32 s86, s65, 7
    s_lshl_b32 s87, s3, 5
    s_add_u32 s86, s86, s87
    buffer_load_dwordx2 v[220:221], v208, s[28:31], s86 offen offset:0
    buffer_load_dwordx2 v[222:223], v208, s[28:31], s86 offen offset:16
    s_lshl_b32 s86, s67, 7
    s_lshr_b32 s87, s3, 1
    s_lshl_b32 s87, s87, 6
    s_add_u32 s86, s86, s87
    buffer_load_dwordx2 v[224:225], v208, s[32:35], s86 offen offset:0
    buffer_load_dwordx2 v[226:227], v208, s[32:35], s86 offen offset:16
    buffer_load_dwordx2 v[228:229], v208, s[32:35], s86 offen offset:32
    buffer_load_dwordx2 v[230:231], v208, s[32:35], s86 offen offset:48
    v_add_u32 v232, s70, v4
    s_xor_b32 s86, s3, 1
    s_mul_i32 s86, s86, 36864
    s_add_u32 s86, s86, 12288
    v_add_u32 v233, s86, v4
    s_xor_b32 s86, s3, 2
    s_mul_i32 s86, s86, 36864
    s_add_u32 s86, s86, 14336
    v_add_u32 v234, s86, v4
    s_xor_b32 s86, s3, 3
    s_mul_i32 s86, s86, 36864
    s_add_u32 s86, s86, 16384
    v_add_u32 v235, s86, v4
    v_lshrrev_b32 v208, 5, v1
    v_lshlrev_b32 v208, 9, v208
    v_and_b32 v209, 31, v1
    v_lshl_add_u32 v208, v209, 2, v208
    s_lshr_b32 s86, s3, 1
    s_lshl_b32 s86, s86, 12
    v_add_u32 v208, s86, v208
    v_xor_b32 v209, 0x1000, v208
    v_add_u32 v236, s70, v208
    v_add_u32 v237, s70, v209
    s_lshl_b32 s86, s3, 11
    s_add_u32 s86, s86, 12288
    v_add_u32 v238, s86, v4
    v_add_u32 v239, 73728, v238
    v_lshrrev_b32 v208, 3, v1
    v_mul_u32_u24 v212, 896, v208
    v_and_b32 v208, 7, v1
    v_lshl_add_u32 v212, v208, 3, v212
    s_lshl_b32 s68, s67, 2
    s_add_u32 s68, s68, s3
    s_mul_i32 s68, s68, 14336
    s_lshl_b32 s86, s66, 7
    s_add_u32 s68, s68, s86
    s_add_u32 s69, s68, 7168
    s_mov_b32 s88, 0xc0135761
    s_mov_b32 s89, 0xc0135761
    s_mov_b32 s90, 0xbdd2d3e8
    s_mov_b32 s91, 0xffff0000
    buffer_load_dword v249, v11, s[40:43], s84 offen sc1
    s_sleep 3
    buffer_load_dword v250, v11, s[40:43], s84 offen sc1
    s_sleep 3
    s_nop 0
Lpoll_P_8:
    s_sub_u32 s6, s6, 1
    s_cbranch_scc1 L_end_P
    buffer_load_dword v251, v11, s[40:43], s84 offen sc1
    s_waitcnt vmcnt(2)
    v_cmp_ne_u32 vcc, s4, v249
    s_nop 1
    s_cbranch_vccz Lpd_P_9
    buffer_load_dword v249, v11, s[40:43], s84 offen sc1
    s_waitcnt vmcnt(2)
    v_cmp_ne_u32 vcc, s4, v250
    s_nop 1
    s_cbranch_vccz Lpd_P_9
    buffer_load_dword v250, v11, s[40:43], s84 offen sc1
    s_waitcnt vmcnt(2)
    v_cmp_ne_u32 vcc, s4, v251
    s_nop 1
    s_cbranch_vccnz Lpoll_P_8
    s_nop 1
Lpd_P_9:
    s_add_u32 s56, s71, s94
    buffer_load_dwordx4 v[80:83], v5, s[40:43], s56 offen offset:0 sc1
    buffer_load_dwordx4 v[84:87], v5, s[40:43], s56 offen offset:1024 sc1
    buffer_load_dwordx4 v[88:91], v5, s[40:43], s56 offen offset:2048 sc1
    buffer_load_dwordx4 v[92:95], v5, s[40:43], s56 offen offset:3072 sc1
    s_add_u32 s56, s71, s95
    buffer_load_dwordx4 v[96:99], v5, s[40:43], s56 offen offset:0 sc1
    buffer_load_dwordx4 v[100:103], v5, s[40:43], s56 offen offset:1024 sc1
    buffer_load_dwordx4 v[104:107], v5, s[40:43], s56 offen offset:2048 sc1
    buffer_load_dwordx4 v[108:111], v5, s[40:43], s56 offen offset:3072 sc1
    v_lshlrev_b32 v16, 16, v220
    v_and_b32 v17, s91, v220
    v_lshlrev_b32 v18, 16, v221
    v_and_b32 v19, s91, v221
    v_lshlrev_b32 v20, 16, v222
    v_and_b32 v21, s91, v222
    v_lshlrev_b32 v22, 16, v223
    v_and_b32 v23, s91, v223
    v_mov_b64 v[24:25], 0
    v_mov_b64 v[26:27], 0
    v_mov_b64 v[28:29], 0
    v_mov_b64 v[30:31], 0
    ds_read_b64_tr_b16 a[80:81], v215 offset:12288
    ds_read_b64_tr_b16 a[82:83], v215 offset:13312
    ds_read_b64_tr_b16 a[84:85], v216 offset:12288
    ds_read_b64_tr_b16 a[86:87], v216 offset:13312
    ds_read_b64_tr_b16 a[88:89], v215 offset:14336
    ds_read_b64_tr_b16 a[90:91], v215 offset:15360
    ds_read_b64_tr_b16 a[92:93], v216 offset:14336
    ds_read_b64_tr_b16 a[94:95], v216 offset:15360
    ds_read_b64_tr_b16 a[96:97], v215 offset:16384
    ds_read_b64_tr_b16 a[98:99], v215 offset:17408
    ds_read_b64_tr_b16 a[100:101], v216 offset:16384
    ds_read_b64_tr_b16 a[102:103], v216 offset:17408
    ds_read_b64_tr_b16 a[104:105], v215 offset:18432
    ds_read_b64_tr_b16 a[106:107], v215 offset:19456
    ds_read_b64_tr_b16 a[108:109], v216 offset:18432
    ds_read_b64_tr_b16 a[110:111], v216 offset:19456
    ds_read_b64_tr_b16 a[112:113], v215 offset:20480
    ds_read_b64_tr_b16 a[114:115], v215 offset:21504
    ds_read_b64_tr_b16 a[116:117], v216 offset:20480
    ds_read_b64_tr_b16 a[118:119], v216 offset:21504
    ds_read_b64_tr_b16 a[120:121], v215 offset:22528
    ds_read_b64_tr_b16 a[122:123], v215 offset:23552
    ds_read_b64_tr_b16 a[124:125], v216 offset:22528
    ds_read_b64_tr_b16 a[126:127], v216 offset:23552
    v_mov_b32 v9, v5
    s_add_u32 s56, s71, s96
    buffer_load_dwordx4 v[112:115], v5, s[40:43], s56 offen offset:0 sc1
    buffer_load_dwordx4 v[116:119], v5, s[40:43], s56 offen offset:1024 sc1
    s_waitcnt vmcnt(9)
    v_mfma_f32_32x32x16_bf16 v[16:31], a[128:131], v[80:83], v[16:31]
    v_mfma_f32_32x32x16_bf16 v[32:47], a[132:135], v[80:83], 0
    buffer_load_dwordx4 v[120:123], v5, s[40:43], s56 offen offset:2048 sc1
    s_waitcnt vmcnt(9)
    v_mfma_f32_32x32x16_bf16 v[16:31], a[136:139], v[84:87], v[16:31]
    v_mfma_f32_32x32x16_bf16 v[32:47], a[140:143], v[84:87], v[32:47]
    buffer_load_dwordx4 v[124:127], v5, s[40:43], s56 offen offset:3072 sc1
    s_waitcnt vmcnt(9)
    v_mfma_f32_32x32x16_bf16 v[16:31], a[144:147], v[88:91], v[16:31]
    v_mfma_f32_32x32x16_bf16 v[32:47], a[148:151], v[88:91], v[32:47]
    s_add_u32 s56, s71, s97
    buffer_load_dwordx4 v[128:131], v5, s[40:43], s56 offen offset:0 sc1
    s_waitcnt vmcnt(9)
    v_mfma_f32_32x32x16_bf16 v[16:31], a[152:155], v[92:95], v[16:31]
    v_mfma_f32_32x32x16_bf16 v[32:47], a[156:159], v[92:95], v[32:47]
    buffer_load_dwordx4 v[132:135], v5, s[40:43], s56 offen offset:1024 sc1
    s_waitcnt vmcnt(9)
    v_mfma_f32_32x32x16_bf16 v[16:31], a[160:163], v[96:99], v[16:31]
    v_mfma_f32_32x32x16_bf16 v[32:47], a[164:167], v[96:99], v[32:47]
    buffer_load_dwordx4 v[136:139], v5, s[40:43], s56 offen offset:2048 sc1
    s_waitcnt vmcnt(9)
    v_mfma_f32_32x32x16_bf16 v[16:31], a[168:171], v[100:103], v[16:31]
    v_mfma_f32_32x32x16_bf16 v[32:47], a[172:175], v[100:103], v[32:47]
    buffer_load_dwordx4 v[140:143], v5, s[40:43], s56 offen offset:3072 sc1
    s_waitcnt vmcnt(9)
    v_mfma_f32_32x32x16_bf16 v[16:31], a[176:179], v[104:107], v[16:31]
    v_mfma_f32_32x32x16_bf16 v[32:47], a[180:183], v[104:107], v[32:47]
    s_add_u32 s56, s71, s98
    buffer_load_dwordx4 v[144:147], v5, s[40:43], s56 offen offset:0 sc1
    s_waitcnt vmcnt(9)
    v_mfma_f32_32x32x16_bf16 v[16:31], a[184:187], v[108:111], v[16:31]
    v_mfma_f32_32x32x16_bf16 v[32:47], a[188:191], v[108:111], v[32:47]
    buffer_load_dwordx4 v[148:151], v5, s[40:43], s56 offen offset:1024 sc1
    s_waitcnt vmcnt(9)
    v_mfma_f32_32x32x16_bf16 v[16:31], a[192:195], v[112:115], v[16:31]
    v_mfma_f32_32x32x16_bf16 v[32:47], a[196:199], v[112:115], v[32:47]
    buffer_load_dwordx4 v[152:155], v5, s[40:43], s56 offen offset:2048 sc1
    s_waitcnt vmcnt(9)
    v_mfma_f32_32x32x16_bf16 v[16:31], a[200:203], v[116:119], v[16:31]
    v_mfma_f32_32x32x16_bf16 v[32:47], a[204:207], v[116:119], v[32:47]
    buffer_load_dwordx4 v[156:159], v5, s[40:43], s56 offen offset:3072 sc1
    s_waitcnt vmcnt(9)
    v_mfma_f32_32x32x16_bf16 v[16:31], a[208:211], v[120:123], v[16:31]
    v_mfma_f32_32x32x16_bf16 v[32:47], a[212:215], v[120:123], v[32:47]
    s_add_u32 s56, s71, s99
    buffer_load_dwordx4 v[160:163], v5, s[40:43], s56 offen offset:0 sc1
    s_waitcnt vmcnt(9)
    v_mfma_f32_32x32x16_bf16 v[16:31], a[216:219], v[124:127], v[16:31]
    v_mfma_f32_32x32x16_bf16 v[32:47], a[220:223], v[124:127], v[32:47]
    buffer_load_dwordx4 v[164:167], v5, s[40:43], s56 offen offset:1024 sc1
    s_waitcnt vmcnt(9)
    v_mfma_f32_32x32x16_bf16 v[16:31], a[224:227], v[128:131], v[16:31]
    v_mfma_f32_32x32x16_bf16 v[32:47], a[228:231], v[128:131], v[32:47]
    buffer_load_dwordx4 v[168:171], v5, s[40:43], s56 offen offset:2048 sc1
    s_waitcnt vmcnt(9)
    v_mfma_f32_32x32x16_bf16 v[16:31], a[232:235], v[132:135], v[16:31]
    v_mfma_f32_32x32x16_bf16 v[32:47], a[236:239], v[132:135], v[32:47]
    buffer_load_dwordx4 v[172:175], v5, s[40:43], s56 offen offset:3072 sc1
    s_waitcnt vmcnt(9)
    v_mfma_f32_32x32x16_bf16 v[16:31], a[240:243], v[136:139], v[16:31]
    v_mfma_f32_32x32x16_bf16 v[32:47], a[244:247], v[136:139], v[32:47]
    s_add_u32 s56, s71, s100
    buffer_load_dwordx4 v[176:179], v5, s[40:43], s56 offen offset:0 sc1
    s_waitcnt vmcnt(9)
    v_mfma_f32_32x32x16_bf16 v[16:31], a[248:251], v[140:143], v[16:31]
    v_mfma_f32_32x32x16_bf16 v[32:47], a[252:255], v[140:143], v[32:47]
    buffer_load_dwordx4 v[180:183], v5, s[40:43], s56 offen offset:1024 sc1
    s_waitcnt vmcnt(9)
    v_mfma_f32_32x32x16_bf16 v[16:31], a[0:3], v[144:147], v[16:31]
    v_mfma_f32_32x32x16_bf16 v[32:47], a[4:7], v[144:147], v[32:47]
    s_barrier
    buffer_load_dwordx4 v[184:187], v5, s[40:43], s56 offen offset:2048 sc1
    s_waitcnt vmcnt(9)
    v_mfma_f32_32x32x16_bf16 v[16:31], a[8:11], v[148:151], v[16:31]
    v_mfma_f32_32x32x16_bf16 v[32:47], a[12:15], v[148:151], v[32:47]
    buffer_load_dwordx4 v[188:191], v5, s[40:43], s56 offen offset:3072 sc1
    s_waitcnt vmcnt(9)
    v_mfma_f32_32x32x16_bf16 v[16:31], a[16:19], v[152:155], v[16:31]
    v_mfma_f32_32x32x16_bf16 v[32:47], a[20:23], v[152:155], v[32:47]
    s_add_u32 s56, s71, s101
    buffer_load_dwordx4 v[192:195], v5, s[40:43], s56 offen offset:0 sc1
    s_waitcnt vmcnt(9)
    v_mfma_f32_32x32x16_bf16 v[16:31], a[24:27], v[156:159], v[16:31]
    v_mfma_f32_32x32x16_bf16 v[32:47], a[28:31], v[156:159], v[32:47]
    buffer_load_dwordx4 v[196:199], v5, s[40:43], s56 offen offset:1024 sc1
    s_waitcnt vmcnt(9)
    v_mfma_f32_32x32x16_bf16 v[16:31], a[32:35], v[160:163], v[16:31]
    v_mfma_f32_32x32x16_bf16 v[32:47], a[36:39], v[160:163], v[32:47]
    v_lshlrev_b32 v48, 16, v220
    v_and_b32 v49, s91, v220
    v_lshlrev_b32 v50, 16, v221
    v_and_b32 v51, s91, v221
    buffer_load_dwordx4 v[200:203], v5, s[40:43], s56 offen offset:2048 sc1
    s_waitcnt vmcnt(9)
    v_mfma_f32_32x32x16_bf16 v[16:31], a[40:43], v[164:167], v[16:31]
    v_mfma_f32_32x32x16_bf16 v[32:47], a[44:47], v[164:167], v[32:47]
    v_lshlrev_b32 v52, 16, v222
    v_and_b32 v53, s91, v222
    v_lshlrev_b32 v54, 16, v223
    v_and_b32 v55, s91, v223
    buffer_load_dwordx4 v[204:207], v5, s[40:43], s56 offen offset:3072 sc1
    s_waitcnt vmcnt(9)
    v_mfma_f32_32x32x16_bf16 v[16:31], a[48:51], v[168:171], v[16:31]
    v_mfma_f32_32x32x16_bf16 v[32:47], a[52:55], v[168:171], v[32:47]
    v_mov_b64 v[56:57], 0
    v_mov_b64 v[58:59], 0
    v_mov_b64 v[60:61], 0
    v_mov_b64 v[62:63], 0
    s_add_u32 s56, s72, s94
    buffer_load_dwordx4 v[80:83], v5, s[40:43], s56 offen offset:0 sc1
    s_waitcnt vmcnt(9)
    v_mfma_f32_32x32x16_bf16 v[16:31], a[56:59], v[172:175], v[16:31]
    v_mfma_f32_32x32x16_bf16 v[32:47], a[60:63], v[172:175], v[32:47]
    buffer_load_dwordx4 v[84:87], v5, s[40:43], s56 offen offset:1024 sc1
    s_waitcnt vmcnt(9)
    v_mfma_f32_32x32x16_bf16 v[16:31], a[64:67], v[176:179], v[16:31]
    v_mfma_f32_32x32x16_bf16 v[32:47], a[68:71], v[176:179], v[32:47]
    s_waitcnt lgkmcnt(15)
    s_add_u32 m0, s70, 12288
    s_mul_i32 s73, s49, 64
    s_add_u32 s73, s73, 131072
    buffer_load_dwordx4 v214, s[24:27], s73 offen lds
    s_add_u32 m0, s70, 13312
    s_mul_i32 s73, s49, 64
    s_add_u32 s73, s73, 163840
    buffer_load_dwordx4 v214, s[24:27], s73 offen lds
    buffer_load_dwordx4 v[88:91], v5, s[40:43], s56 offen offset:2048 sc1
    s_waitcnt vmcnt(11)
    v_mfma_f32_32x32x16_bf16 v[16:31], a[72:75], v[180:183], v[16:31]
    v_mfma_f32_32x32x16_bf16 v[32:47], a[76:79], v[180:183], v[32:47]
    s_add_u32 m0, s70, 14336
    s_mul_i32 s73, s49, 64
    s_add_u32 s73, s73, 196608
    buffer_load_dwordx4 v214, s[24:27], s73 offen lds
    s_add_u32 m0, s70, 15360
    s_mul_i32 s73, s49, 64
    s_add_u32 s73, s73, 229376
    buffer_load_dwordx4 v214, s[24:27], s73 offen lds
    buffer_load_dwordx4 v[92:95], v5, s[40:43], s56 offen offset:3072 sc1
    s_waitcnt vmcnt(13)
    v_mfma_f32_32x32x16_bf16 v[16:31], a[80:83], v[184:187], v[16:31]
    v_mfma_f32_32x32x16_bf16 v[32:47], a[84:87], v[184:187], v[32:47]
    s_waitcnt lgkmcnt(12)
    s_add_u32 m0, s70, 16384
    s_mul_i32 s73, s50, 64
    s_add_u32 s73, s73, 0
    buffer_load_dwordx4 v214, s[24:27], s73 offen lds
    s_add_u32 m0, s70, 17408
    s_mul_i32 s73, s50, 64
    s_add_u32 s73, s73, 32768
    buffer_load_dwordx4 v214, s[24:27], s73 offen lds
    s_add_u32 s56, s72, s95
    buffer_load_dwordx4 v[96:99], v5, s[40:43], s56 offen offset:0 sc1
    s_waitcnt vmcnt(15)
    v_mfma_f32_32x32x16_bf16 v[16:31], a[88:91], v[188:191], v[16:31]
    v_mfma_f32_32x32x16_bf16 v[32:47], a[92:95], v[188:191], v[32:47]
    s_waitcnt lgkmcnt(8)
    s_add_u32 m0, s70, 18432
    s_mul_i32 s73, s50, 64
    s_add_u32 s73, s73, 65536
    buffer_load_dwordx4 v214, s[24:27], s73 offen lds
    s_add_u32 m0, s70, 19456
    s_mul_i32 s73, s50, 64
    s_add_u32 s73, s73, 98304
    buffer_load_dwordx4 v214, s[24:27], s73 offen lds
    buffer_load_dwordx4 v[100:103], v5, s[40:43], s56 offen offset:1024 sc1
    s_waitcnt vmcnt(17)
    v_mfma_f32_32x32x16_bf16 v[16:31], a[96:99], v[192:195], v[16:31]
    v_mfma_f32_32x32x16_bf16 v[32:47], a[100:103], v[192:195], v[32:47]
    s_waitcnt lgkmcnt(4)
    s_add_u32 m0, s70, 20480
    s_mul_i32 s73, s50, 64
    s_add_u32 s73, s73, 131072
    buffer_load_dwordx4 v214, s[24:27], s73 offen lds
    s_add_u32 m0, s70, 21504
    s_mul_i32 s73, s50, 64
    s_add_u32 s73, s73, 163840
    buffer_load_dwordx4 v214, s[24:27], s73 offen lds
    buffer_load_dwordx4 v[104:107], v5, s[40:43], s56 offen offset:2048 sc1
    s_waitcnt vmcnt(19)
    v_mfma_f32_32x32x16_bf16 v[16:31], a[104:107], v[196:199], v[16:31]
    v_mfma_f32_32x32x16_bf16 v[32:47], a[108:111], v[196:199], v[32:47]
    s_waitcnt lgkmcnt(0)
    s_add_u32 m0, s70, 22528
    s_mul_i32 s73, s50, 64
    s_add_u32 s73, s73, 196608
    buffer_load_dwordx4 v214, s[24:27], s73 offen lds
    s_add_u32 m0, s70, 23552
    s_mul_i32 s73, s50, 64
    s_add_u32 s73, s73, 229376
    buffer_load_dwordx4 v214, s[24:27], s73 offen lds
    buffer_load_dwordx4 v[108:111], v5, s[40:43], s56 offen offset:3072 sc1
    s_waitcnt vmcnt(21)
    v_mfma_f32_32x32x16_bf16 v[16:31], a[112:115], v[200:203], v[16:31]
    v_mfma_f32_32x32x16_bf16 v[32:47], a[116:119], v[200:203], v[32:47]
    s_add_u32 s56, s72, s96
    buffer_load_dwordx4 v[112:115], v5, s[40:43], s56 offen offset:0 sc1
    s_waitcnt vmcnt(21)
    v_mfma_f32_32x32x16_bf16 v[16:31], a[120:123], v[204:207], v[16:31]
    v_mfma_f32_32x32x16_bf16 v[32:47], a[124:127], v[204:207], v[32:47]
    buffer_load_dwordx4 v[116:119], v5, s[40:43], s56 offen offset:1024 sc1
    s_waitcnt vmcnt(21)
    v_mfma_f32_32x32x16_bf16 v[48:63], a[128:131], v[80:83], v[48:63]
    v_mfma_f32_32x32x16_bf16 v[64:79], a[132:135], v[80:83], 0
    s_nop 7
    ds_write_b128 v235, v[40:43] offset:0
    ds_write_b128 v235, v[44:47] offset:1024
    ds_write_b128 v234, v[32:35] offset:0
    buffer_load_dwordx4 v[120:123], v5, s[40:43], s56 offen offset:2048 sc1
    s_waitcnt vmcnt(21)
    v_mfma_f32_32x32x16_bf16 v[48:63], a[136:139], v[84:87], v[48:63]
    v_mfma_f32_32x32x16_bf16 v[64:79], a[140:143], v[84:87], v[64:79]
    ds_write_b128 v234, v[36:39] offset:1024
    ds_write_b128 v233, v[24:27] offset:0
    ds_write_b128 v233, v[28:31] offset:1024
    buffer_load_dwordx4 v[124:127], v5, s[40:43], s56 offen offset:3072 sc1
    s_waitcnt vmcnt(19)
    v_mfma_f32_32x32x16_bf16 v[48:63], a[144:147], v[88:91], v[48:63]
    v_mfma_f32_32x32x16_bf16 v[64:79], a[148:151], v[88:91], v[64:79]
    s_waitcnt lgkmcnt(0)
    s_barrier
    ds_read_b128 v[24:27], v232 offset:0
    ds_read_b128 v[32:35], v232 offset:2048
    ds_read_b128 v[40:43], v232 offset:4096
    ds_read_b128 v[28:31], v232 offset:1024
    ds_read_b128 v[36:39], v232 offset:3072
    ds_read_b128 v[44:47], v232 offset:5120
    s_add_u32 s56, s72, s97
    buffer_load_dwordx4 v[128:131], v5, s[40:43], s56 offen offset:0 sc1
    s_waitcnt vmcnt(17)
    v_mfma_f32_32x32x16_bf16 v[48:63], a[152:155], v[92:95], v[48:63]
    v_mfma_f32_32x32x16_bf16 v[64:79], a[156:159], v[92:95], v[64:79]
    buffer_load_dwordx4 v[132:135], v5, s[40:43], s56 offen offset:1024 sc1
    s_waitcnt vmcnt(15)
    v_mfma_f32_32x32x16_bf16 v[48:63], a[160:163], v[96:99], v[48:63]
    v_mfma_f32_32x32x16_bf16 v[64:79], a[164:167], v[96:99], v[64:79]
    v_mov_b32 v211, s88
    s_waitcnt lgkmcnt(4)
    v_add_f32 v24, v24, v32
    s_waitcnt lgkmcnt(3)
    v_add_f32 v16, v16, v40
    v_add_f32 v25, v25, v33
    v_add_f32 v17, v17, v41
    v_add_f32 v26, v26, v34
    v_add_f32 v18, v18, v42
    v_add_f32 v27, v27, v35
    v_add_f32 v19, v19, v43
    s_waitcnt lgkmcnt(1)
    v_add_f32 v28, v28, v36
    s_waitcnt lgkmcnt(0)
    v_add_f32 v20, v20, v44
    v_add_f32 v29, v29, v37
    v_add_f32 v21, v21, v45
    v_add_f32 v30, v30, v38
    v_add_f32 v22, v22, v46
    v_add_f32 v31, v31, v39
    buffer_load_dwordx4 v[136:139], v5, s[40:43], s56 offen offset:2048 sc1
    s_waitcnt vmcnt(13)
    v_mfma_f32_32x32x16_bf16 v[48:63], a[168:171], v[100:103], v[48:63]
    v_mfma_f32_32x32x16_bf16 v[64:79], a[172:175], v[100:103], v[64:79]
    v_add_f32 v23, v23, v47
    v_add_f32 v16, v16, v24
    v_add_f32 v17, v17, v25
    v_add_f32 v18, v18, v26
    v_add_f32 v19, v19, v27
    v_add_f32 v20, v20, v28
    v_add_f32 v21, v21, v29
    v_add_f32 v22, v22, v30
    v_add_f32 v23, v23, v31
    v_mul_f32 v24, v16, v16
    v_mul_f32 v25, v17, v17
    v_mul_f32 v26, v18, v18
    v_mul_f32 v27, v19, v19
    v_mul_f32 v28, v20, v20
    v_mul_f32 v29, v21, v21
    v_mul_f32 v30, v22, v22
    buffer_load_dwordx4 v[140:143], v5, s[40:43], s56 offen offset:3072 sc1
    s_waitcnt vmcnt(11)
    v_mfma_f32_32x32x16_bf16 v[48:63], a[176:179], v[104:107], v[48:63]
    v_mfma_f32_32x32x16_bf16 v[64:79], a[180:183], v[104:107], v[64:79]
    v_mul_f32 v31, v23, v23
    v_fma_f32 v24, v24, s90, v211
    v_fma_f32 v25, v25, s90, v211
    v_fma_f32 v26, v26, s90, v211
    v_fma_f32 v27, v27, s90, v211
    v_fma_f32 v28, v28, s90, v211
    v_fma_f32 v29, v29, s90, v211
    v_fma_f32 v30, v30, s90, v211
    v_fma_f32 v31, v31, s90, v211
    v_mul_f32 v24, v24, v16
    v_mul_f32 v25, v25, v17
    v_mul_f32 v26, v26, v18
    v_mul_f32 v27, v27, v19
    v_mul_f32 v28, v28, v20
    v_mul_f32 v29, v29, v21
    v_mul_f32 v30, v30, v22
    s_add_u32 s56, s72, s98
    buffer_load_dwordx4 v[144:147], v5, s[40:43], s56 offen offset:0 sc1
    s_waitcnt vmcnt(9)
    v_mfma_f32_32x32x16_bf16 v[48:63], a[184:187], v[108:111], v[48:63]
    v_mfma_f32_32x32x16_bf16 v[64:79], a[188:191], v[108:111], v[64:79]
    v_mul_f32 v31, v31, v23
    v_exp_f32 v24, v24
    v_exp_f32 v25, v25
    v_exp_f32 v26, v26
    v_exp_f32 v27, v27
    v_exp_f32 v28, v28
    v_exp_f32 v29, v29
    v_exp_f32 v30, v30
    v_exp_f32 v31, v31
    v_add_f32 v24, 1.0, v24
    v_add_f32 v25, 1.0, v25
    v_add_f32 v26, 1.0, v26
    v_add_f32 v27, 1.0, v27
    v_add_f32 v28, 1.0, v28
    v_add_f32 v29, 1.0, v29
    v_add_f32 v30, 1.0, v30
    ds_read_b64_tr_b16 a[128:129], v217 offset:24576
    ds_read_b64_tr_b16 a[130:131], v217 offset:25600
    ds_read_b64_tr_b16 a[132:133], v218 offset:24576
    ds_read_b64_tr_b16 a[134:135], v218 offset:25600
    ds_read_b64_tr_b16 a[136:137], v217 offset:26624
    ds_read_b64_tr_b16 a[138:139], v217 offset:27648
    ds_read_b64_tr_b16 a[140:141], v218 offset:26624
    ds_read_b64_tr_b16 a[142:143], v218 offset:27648
    buffer_load_dwordx4 v[148:151], v5, s[40:43], s56 offen offset:1024 sc1
    s_waitcnt vmcnt(9)
    v_mfma_f32_32x32x16_bf16 v[48:63], a[192:195], v[112:115], v[48:63]
    v_mfma_f32_32x32x16_bf16 v[64:79], a[196:199], v[112:115], v[64:79]
    v_add_f32 v31, 1.0, v31
    v_rcp_f32 v24, v24
    v_rcp_f32 v25, v25
    v_rcp_f32 v26, v26
    v_rcp_f32 v27, v27
    v_rcp_f32 v28, v28
    v_rcp_f32 v29, v29
    v_rcp_f32 v30, v30
    v_rcp_f32 v31, v31
    v_mul_f32 v24, v24, v16
    v_mul_f32 v25, v25, v17
    v_mul_f32 v26, v26, v18
    v_mul_f32 v27, v27, v19
    v_mul_f32 v28, v28, v20
    v_mul_f32 v29, v29, v21
    v_mul_f32 v30, v30, v22
    ds_read_b64_tr_b16 a[144:145], v217 offset:28672
    ds_read_b64_tr_b16 a[146:147], v217 offset:29696
    ds_read_b64_tr_b16 a[148:149], v218 offset:28672
    ds_read_b64_tr_b16 a[150:151], v218 offset:29696
    ds_read_b64_tr_b16 a[152:153], v217 offset:30720
    ds_read_b64_tr_b16 a[154:155], v217 offset:31744
    ds_read_b64_tr_b16 a[156:157], v218 offset:30720
    ds_read_b64_tr_b16 a[158:159], v218 offset:31744
    buffer_load_dwordx4 v[152:155], v5, s[40:43], s56 offen offset:2048 sc1
    s_waitcnt vmcnt(9)
    v_mfma_f32_32x32x16_bf16 v[48:63], a[200:203], v[116:119], v[48:63]
    v_mfma_f32_32x32x16_bf16 v[64:79], a[204:207], v[116:119], v[64:79]
    v_mul_f32 v31, v31, v23
    v_cvt_pk_bf16_f32 v32, v24, v25
    v_cvt_pk_bf16_f32 v33, v26, v27
    v_cvt_pk_bf16_f32 v34, v28, v29
    v_cvt_pk_bf16_f32 v35, v30, v31
    buffer_store_dwordx4 v[32:35], v5, s[40:43], s57 offen sc1
    ds_read_b64_tr_b16 a[160:161], v217 offset:32768
    ds_read_b64_tr_b16 a[162:163], v217 offset:33792
    ds_read_b64_tr_b16 a[164:165], v218 offset:32768
    ds_read_b64_tr_b16 a[166:167], v218 offset:33792
    ds_read_b64_tr_b16 a[168:169], v217 offset:34816
    ds_read_b64_tr_b16 a[170:171], v217 offset:35840
    ds_read_b64_tr_b16 a[172:173], v218 offset:34816
    ds_read_b64_tr_b16 a[174:175], v218 offset:35840
    buffer_load_dwordx4 v[156:159], v5, s[40:43], s56 offen offset:3072 sc1
    s_waitcnt vmcnt(10)
    v_mfma_f32_32x32x16_bf16 v[48:63], a[208:211], v[120:123], v[48:63]
    v_mfma_f32_32x32x16_bf16 v[64:79], a[212:215], v[120:123], v[64:79]
    ds_read_b64_tr_b16 a[176:177], v217 offset:12288
    ds_read_b64_tr_b16 a[178:179], v217 offset:13312
    ds_read_b64_tr_b16 a[180:181], v218 offset:12288
    ds_read_b64_tr_b16 a[182:183], v218 offset:13312
    ds_read_b64_tr_b16 a[184:185], v217 offset:14336
    ds_read_b64_tr_b16 a[186:187], v217 offset:15360
    ds_read_b64_tr_b16 a[188:189], v218 offset:14336
    ds_read_b64_tr_b16 a[190:191], v218 offset:15360
    s_and_b32 s60, s3, 1
    s_cmp_eq_u32 s60, 0
    s_cselect_b32 s60, 1.0, 0
    v_lshlrev_b32 v16, 16, v224
    v_and_b32 v17, s91, v224
    v_lshlrev_b32 v208, 16, v240
    v_and_b32 v209, s91, v240
    v_add_f32 v16, v16, v208
    s_add_u32 s56, s72, s99
    buffer_load_dwordx4 v[160:163], v5, s[40:43], s56 offen offset:0 sc1
    s_waitcnt vmcnt(10)
    v_mfma_f32_32x32x16_bf16 v[48:63], a[216:219], v[124:127], v[48:63]
    v_mfma_f32_32x32x16_bf16 v[64:79], a[220:223], v[124:127], v[64:79]
    ds_read_b64_tr_b16 a[192:193], v217 offset:16384
    ds_read_b64_tr_b16 a[194:195], v217 offset:17408
    ds_read_b64_tr_b16 a[196:197], v218 offset:16384
    ds_read_b64_tr_b16 a[198:199], v218 offset:17408
    ds_read_b64_tr_b16 a[200:201], v217 offset:18432
    ds_read_b64_tr_b16 a[202:203], v217 offset:19456
    ds_read_b64_tr_b16 a[204:205], v218 offset:18432
    ds_read_b64_tr_b16 a[206:207], v218 offset:19456
    v_add_f32 v17, v17, v209
    v_mul_f32 v16, s60, v16
    v_mul_f32 v17, s60, v17
    v_lshlrev_b32 v18, 16, v225
    v_and_b32 v19, s91, v225
    v_lshlrev_b32 v210, 16, v241
    buffer_load_dwordx4 v[164:167], v5, s[40:43], s56 offen offset:1024 sc1
    s_waitcnt vmcnt(10)
    v_mfma_f32_32x32x16_bf16 v[48:63], a[224:227], v[128:131], v[48:63]
    v_mfma_f32_32x32x16_bf16 v[64:79], a[228:231], v[128:131], v[64:79]
    ds_read_b64_tr_b16 a[208:209], v217 offset:20480
    ds_read_b64_tr_b16 a[210:211], v217 offset:21504
    ds_read_b64_tr_b16 a[212:213], v218 offset:20480
    ds_read_b64_tr_b16 a[214:215], v218 offset:21504
    ds_read_b64_tr_b16 a[216:217], v217 offset:22528
    ds_read_b64_tr_b16 a[218:219], v217 offset:23552
    ds_read_b64_tr_b16 a[220:221], v218 offset:22528
    ds_read_b64_tr_b16 a[222:223], v218 offset:23552
    s_waitcnt lgkmcnt(15)
    s_add_u32 m0, s70, 24576
    s_mul_i32 s73, s51, 64
    s_add_u32 s73, s73, 0
    buffer_load_dwordx4 v214, s[24:27], s73 offen lds
    s_add_u32 m0, s70, 25600
    s_mul_i32 s73, s51, 64
    s_add_u32 s73, s73, 32768
    buffer_load_dwordx4 v214, s[24:27], s73 offen lds
    v_and_b32 v211, s91, v241
    v_add_f32 v18, v18, v210
    v_add_f32 v19, v19, v211
    v_mul_f32 v18, s60, v18
    v_mul_f32 v19, s60, v19
    v_lshlrev_b32 v20, 16, v226
    buffer_load_dwordx4 v[168:171], v5, s[40:43], s56 offen offset:2048 sc1
    s_waitcnt vmcnt(12)
    v_mfma_f32_32x32x16_bf16 v[48:63], a[232:235], v[132:135], v[48:63]
    v_mfma_f32_32x32x16_bf16 v[64:79], a[236:239], v[132:135], v[64:79]
    s_waitcnt vmcnt(6)
    v_mov_b32 v8, s4
    s_mov_b64 exec, 1
    buffer_store_dword v8, v9, s[40:43], s82 offen sc1
    s_mov_b64 exec, -1
    s_add_u32 m0, s70, 26624
    s_mul_i32 s73, s51, 64
    s_add_u32 s73, s73, 65536
    buffer_load_dwordx4 v214, s[24:27], s73 offen lds
    s_add_u32 m0, s70, 27648
    s_mul_i32 s73, s51, 64
    s_add_u32 s73, s73, 98304
    buffer_load_dwordx4 v214, s[24:27], s73 offen lds
    v_and_b32 v21, s91, v226
    v_lshlrev_b32 v208, 16, v242
    v_and_b32 v209, s91, v242
    v_add_f32 v20, v20, v208
    v_add_f32 v21, v21, v209
    v_mul_f32 v20, s60, v20
    buffer_load_dwordx4 v[172:175], v5, s[40:43], s56 offen offset:3072 sc1
    v_mfma_f32_32x32x16_bf16 v[48:63], a[240:243], v[136:139], v[48:63]
    v_mfma_f32_32x32x16_bf16 v[64:79], a[244:247], v[136:139], v[64:79]
    s_add_u32 m0, s70, 28672
    s_mul_i32 s73, s51, 64
    s_add_u32 s73, s73, 131072
    buffer_load_dwordx4 v214, s[24:27], s73 offen lds
    s_add_u32 m0, s70, 29696
    s_mul_i32 s73, s51, 64
    s_add_u32 s73, s73, 163840
    buffer_load_dwordx4 v214, s[24:27], s73 offen lds
    v_mul_f32 v21, s60, v21
    v_lshlrev_b32 v22, 16, v227
    v_and_b32 v23, s91, v227
    v_lshlrev_b32 v210, 16, v243
    v_and_b32 v211, s91, v243
    v_add_f32 v22, v22, v210
    s_add_u32 s56, s72, s100
    buffer_load_dwordx4 v[176:179], v5, s[40:43], s56 offen offset:0 sc1
    v_mfma_f32_32x32x16_bf16 v[48:63], a[248:251], v[140:143], v[48:63]
    v_mfma_f32_32x32x16_bf16 v[64:79], a[252:255], v[140:143], v[64:79]
    s_add_u32 m0, s70, 30720
    s_mul_i32 s73, s51, 64
    s_add_u32 s73, s73, 196608
    buffer_load_dwordx4 v214, s[24:27], s73 offen lds
    s_add_u32 m0, s70, 31744
    s_mul_i32 s73, s51, 64
    s_add_u32 s73, s73, 229376
    buffer_load_dwordx4 v214, s[24:27], s73 offen lds
    v_add_f32 v23, v23, v211
    v_mul_f32 v22, s60, v22
    v_mul_f32 v23, s60, v23
    v_lshlrev_b32 v24, 16, v228
    v_and_b32 v25, s91, v228
    v_lshlrev_b32 v208, 16, v244
    buffer_load_dwordx4 v[180:183], v5, s[40:43], s56 offen offset:1024 sc1
    v_mfma_f32_32x32x16_bf16 v[48:63], a[0:3], v[144:147], v[48:63]
    v_mfma_f32_32x32x16_bf16 v[64:79], a[4:7], v[144:147], v[64:79]
    s_add_u32 m0, s70, 32768
    s_mul_i32 s73, s52, 64
    s_add_u32 s73, s73, 0
    buffer_load_dwordx4 v214, s[24:27], s73 offen lds
    s_add_u32 m0, s70, 33792
    s_mul_i32 s73, s52, 64
    s_add_u32 s73, s73, 32768
    buffer_load_dwordx4 v214, s[24:27], s73 offen lds
    v_and_b32 v209, s91, v244
    v_add_f32 v24, v24, v208
    v_add_f32 v25, v25, v209
    v_mul_f32 v24, s60, v24
    v_mul_f32 v25, s60, v25
    v_lshlrev_b32 v26, 16, v229
    buffer_load_dwordx4 v[184:187], v5, s[40:43], s56 offen offset:2048 sc1
    v_mfma_f32_32x32x16_bf16 v[48:63], a[8:11], v[148:151], v[48:63]
    v_mfma_f32_32x32x16_bf16 v[64:79], a[12:15], v[148:151], v[64:79]
    s_add_u32 m0, s70, 34816
    s_mul_i32 s73, s52, 64
    s_add_u32 s73, s73, 65536
    buffer_load_dwordx4 v214, s[24:27], s73 offen lds
    s_add_u32 m0, s70, 35840
    s_mul_i32 s73, s52, 64
    s_add_u32 s73, s73, 98304
    buffer_load_dwordx4 v214, s[24:27], s73 offen lds
    v_and_b32 v27, s91, v229
    v_lshlrev_b32 v210, 16, v245
    v_and_b32 v211, s91, v245
    v_add_f32 v26, v26, v210
    v_add_f32 v27, v27, v211
    v_mul_f32 v26, s60, v26
    buffer_load_dwordx4 v[188:191], v5, s[40:43], s56 offen offset:3072 sc1
    v_mfma_f32_32x32x16_bf16 v[48:63], a[16:19], v[152:155], v[48:63]
    v_mfma_f32_32x32x16_bf16 v[64:79], a[20:23], v[152:155], v[64:79]
    s_add_u32 m0, s70, 12288
    s_mul_i32 s73, s52, 64
    s_add_u32 s73, s73, 131072
    buffer_load_dwordx4 v214, s[24:27], s73 offen lds
    s_add_u32 m0, s70, 13312
    s_mul_i32 s73, s52, 64
    s_add_u32 s73, s73, 163840
    buffer_load_dwordx4 v214, s[24:27], s73 offen lds
    v_mul_f32 v27, s60, v27
    v_lshlrev_b32 v28, 16, v230
    v_and_b32 v29, s91, v230
    v_lshlrev_b32 v208, 16, v246
    v_and_b32 v209, s91, v246
    v_add_f32 v28, v28, v208
    buffer_load_dword v248, v12, s[40:43], s85 offen offset:0 sc1
    s_add_u32 s56, s72, s101
    buffer_load_dwordx4 v[192:195], v5, s[40:43], s56 offen offset:0 sc1
    s_waitcnt vmcnt(25)
    v_mfma_f32_32x32x16_bf16 v[48:63], a[24:27], v[156:159], v[48:63]
    v_mfma_f32_32x32x16_bf16 v[64:79], a[28:31], v[156:159], v[64:79]
    s_add_u32 m0, s70, 14336
    s_mul_i32 s73, s52, 64
    s_add_u32 s73, s73, 196608
    buffer_load_dwordx4 v214, s[24:27], s73 offen lds
    s_add_u32 m0, s70, 15360
    s_mul_i32 s73, s52, 64
    s_add_u32 s73, s73, 229376
    buffer_load_dwordx4 v214, s[24:27], s73 offen lds
    v_add_f32 v29, v29, v209
    v_mul_f32 v28, s60, v28
    v_mul_f32 v29, s60, v29
    v_lshlrev_b32 v30, 16, v231
    v_and_b32 v31, s91, v231
    v_lshlrev_b32 v210, 16, v247
    buffer_load_dwordx4 v[196:199], v5, s[40:43], s56 offen offset:1024 sc1
    s_waitcnt vmcnt(27)
    v_mfma_f32_32x32x16_bf16 v[48:63], a[32:35], v[160:163], v[48:63]
    v_mfma_f32_32x32x16_bf16 v[64:79], a[36:39], v[160:163], v[64:79]
    s_waitcnt vmcnt(24)
    ds_read_b64_tr_b16 a[224:225], v217 offset:24576
    ds_read_b64_tr_b16 a[226:227], v217 offset:25600
    ds_read_b64_tr_b16 a[228:229], v218 offset:24576
    ds_read_b64_tr_b16 a[230:231], v218 offset:25600
    v_and_b32 v211, s91, v247
    v_add_f32 v30, v30, v210
    v_add_f32 v31, v31, v211
    v_mul_f32 v30, s60, v30
    v_mul_f32 v31, s60, v31
    buffer_load_dwordx4 v[200:203], v5, s[40:43], s56 offen offset:2048 sc1
    v_mfma_f32_32x32x16_bf16 v[48:63], a[40:43], v[164:167], v[48:63]
    v_mfma_f32_32x32x16_bf16 v[64:79], a[44:47], v[164:167], v[64:79]
    s_waitcnt vmcnt(21)
    ds_read_b64_tr_b16 a[232:233], v217 offset:26624
    ds_read_b64_tr_b16 a[234:235], v217 offset:27648
    ds_read_b64_tr_b16 a[236:237], v218 offset:26624
    ds_read_b64_tr_b16 a[238:239], v218 offset:27648
    buffer_load_dwordx4 v[204:207], v5, s[40:43], s56 offen offset:3072 sc1
    v_mfma_f32_32x32x16_bf16 v[48:63], a[48:51], v[168:171], v[48:63]
    v_mfma_f32_32x32x16_bf16 v[64:79], a[52:55], v[168:171], v[64:79]
    s_waitcnt vmcnt(19)
    ds_read_b64_tr_b16 a[240:241], v217 offset:28672
    ds_read_b64_tr_b16 a[242:243], v217 offset:29696
    ds_read_b64_tr_b16 a[244:245], v218 offset:28672
    ds_read_b64_tr_b16 a[246:247], v218 offset:29696
    s_waitcnt vmcnt(6)
    v_cmp_ne_u32 vcc, s4, v248
    s_nop 1
    s_cbranch_vccz Lpcd_P_11
    s_nop 1
Lpc_P_10:
    s_sub_u32 s6, s6, 1
    s_cbranch_scc1 L_end_P
    buffer_load_dword v248, v12, s[40:43], s85 offen offset:0 sc1
    s_waitcnt vmcnt(0)
    v_cmp_ne_u32 vcc, s4, v248
    s_nop 1
    s_cbranch_vccnz Lpc_P_10
Lpcd_P_11:
    s_add_u32 s56, s58, s48
    buffer_load_dwordx4 v[80:83], v4, s[40:43], s56 offen offset:0 sc1
    v_mfma_f32_32x32x16_bf16 v[48:63], a[56:59], v[172:175], v[48:63]
    v_mfma_f32_32x32x16_bf16 v[64:79], a[60:63], v[172:175], v[64:79]
    ds_read_b64_tr_b16 a[248:249], v217 offset:30720
    ds_read_b64_tr_b16 a[250:251], v217 offset:31744
    ds_read_b64_tr_b16 a[252:253], v218 offset:30720
    ds_read_b64_tr_b16 a[254:255], v218 offset:31744
    buffer_load_dwordx4 v[84:87], v4, s[40:43], s56 offen offset:1024 sc1
    v_mfma_f32_32x32x16_bf16 v[48:63], a[64:67], v[176:179], v[48:63]
    v_mfma_f32_32x32x16_bf16 v[64:79], a[68:71], v[176:179], v[64:79]
    ds_read_b64_tr_b16 a[0:1], v217 offset:32768
    ds_read_b64_tr_b16 a[2:3], v217 offset:33792
    ds_read_b64_tr_b16 a[4:5], v218 offset:32768
    ds_read_b64_tr_b16 a[6:7], v218 offset:33792
    buffer_load_dwordx4 v[88:91], v4, s[40:43], s56 offen offset:2048 sc1
    v_mfma_f32_32x32x16_bf16 v[48:63], a[72:75], v[180:183], v[48:63]
    v_mfma_f32_32x32x16_bf16 v[64:79], a[76:79], v[180:183], v[64:79]
    ds_read_b64_tr_b16 a[8:9], v217 offset:34816
    ds_read_b64_tr_b16 a[10:11], v217 offset:35840
    ds_read_b64_tr_b16 a[12:13], v218 offset:34816
    ds_read_b64_tr_b16 a[14:15], v218 offset:35840
    buffer_load_dwordx4 v[92:95], v4, s[40:43], s56 offen offset:3072 sc1
    v_mfma_f32_32x32x16_bf16 v[48:63], a[80:83], v[184:187], v[48:63]
    v_mfma_f32_32x32x16_bf16 v[64:79], a[84:87], v[184:187], v[64:79]
    ds_read_b64_tr_b16 a[16:17], v217 offset:12288
    ds_read_b64_tr_b16 a[18:19], v217 offset:13312
    ds_read_b64_tr_b16 a[20:21], v218 offset:12288
    ds_read_b64_tr_b16 a[22:23], v218 offset:13312
    s_add_u32 s56, s58, s49
    buffer_load_dwordx4 v[96:99], v4, s[40:43], s56 offen offset:0 sc1
    v_mfma_f32_32x32x16_bf16 v[48:63], a[88:91], v[188:191], v[48:63]
    v_mfma_f32_32x32x16_bf16 v[64:79], a[92:95], v[188:191], v[64:79]
    s_waitcnt vmcnt(8)
    ds_read_b64_tr_b16 a[24:25], v217 offset:14336
    ds_read_b64_tr_b16 a[26:27], v217 offset:15360
    ds_read_b64_tr_b16 a[28:29], v218 offset:14336
    ds_read_b64_tr_b16 a[30:31], v218 offset:15360
    buffer_load_dwordx4 v[100:103], v4, s[40:43], s56 offen offset:1024 sc1
    buffer_load_dwordx4 v[104:107], v4, s[40:43], s56 offen offset:2048 sc1
    buffer_load_dwordx4 v[108:111], v4, s[40:43], s56 offen offset:3072 sc1
    s_add_u32 s56, s58, s50
    buffer_load_dwordx4 v[112:115], v4, s[40:43], s56 offen offset:0 sc1
    v_mfma_f32_32x32x16_bf16 v[64:79], a[100:103], v[192:195], v[64:79]
    s_waitcnt vmcnt(11)
    v_mfma_f32_32x32x16_bf16 v[64:79], a[108:111], v[196:199], v[64:79]
    s_waitcnt vmcnt(10)
    v_mfma_f32_32x32x16_bf16 v[64:79], a[116:119], v[200:203], v[64:79]
    s_waitcnt vmcnt(9)
    v_mfma_f32_32x32x16_bf16 v[64:79], a[124:127], v[204:207], v[64:79]
    v_mfma_f32_32x32x16_bf16 v[48:63], a[96:99], v[192:195], v[48:63]
    v_mfma_f32_32x32x16_bf16 v[48:63], a[104:107], v[196:199], v[48:63]
    s_nop 9
    ds_write_b128 v235, v[72:75] offset:6144
    ds_write_b128 v235, v[76:79] offset:7168
    v_mfma_f32_32x32x16_bf16 v[48:63], a[112:115], v[200:203], v[48:63]
    ds_write_b128 v234, v[64:67] offset:6144
    ds_write_b128 v234, v[68:71] offset:7168
    v_mfma_f32_32x32x16_bf16 v[48:63], a[120:123], v[204:207], v[48:63]
    s_nop 11
    ds_write_b128 v233, v[56:59] offset:6144
    ds_write_b128 v233, v[60:63] offset:7168
    s_waitcnt lgkmcnt(0)
    s_barrier
    ds_read_b128 v[56:59], v232 offset:6144
    ds_read_b128 v[64:67], v232 offset:8192
    ds_read_b128 v[72:75], v232 offset:10240
    ds_read_b128 v[60:63], v232 offset:7168
    ds_read_b128 v[68:71], v232 offset:9216
    ds_read_b128 v[76:79], v232 offset:11264
    v_mov_b32 v211, s88
    s_waitcnt lgkmcnt(4)
    v_pk_add_f32 v[56:57], v[56:57], v[64:65]
    s_waitcnt lgkmcnt(3)
    v_pk_add_f32 v[48:49], v[48:49], v[72:73]
    v_pk_add_f32 v[58:59], v[58:59], v[66:67]
    v_pk_add_f32 v[50:51], v[50:51], v[74:75]
    s_waitcnt lgkmcnt(1)
    v_pk_add_f32 v[60:61], v[60:61], v[68:69]
    s_waitcnt lgkmcnt(0)
    v_pk_add_f32 v[52:53], v[52:53], v[76:77]
    v_pk_add_f32 v[62:63], v[62:63], v[70:71]
    v_pk_add_f32 v[54:55], v[54:55], v[78:79]
    v_pk_add_f32 v[48:49], v[48:49], v[56:57]
    v_pk_add_f32 v[50:51], v[50:51], v[58:59]
    v_pk_add_f32 v[52:53], v[52:53], v[60:61]
    v_pk_add_f32 v[54:55], v[54:55], v[62:63]
    v_pk_mul_f32 v[56:57], v[48:49], v[48:49]
    v_pk_mul_f32 v[58:59], v[50:51], v[50:51]
    v_pk_mul_f32 v[60:61], v[52:53], v[52:53]
    v_pk_mul_f32 v[62:63], v[54:55], v[54:55]
    v_fma_f32 v56, v56, s90, v211
    v_fma_f32 v57, v57, s90, v211
    v_fma_f32 v58, v58, s90, v211
    v_fma_f32 v59, v59, s90, v211
    v_fma_f32 v60, v60, s90, v211
    v_fma_f32 v61, v61, s90, v211
    v_fma_f32 v62, v62, s90, v211
    v_fma_f32 v63, v63, s90, v211
    v_pk_mul_f32 v[56:57], v[56:57], v[48:49]
    v_pk_mul_f32 v[58:59], v[58:59], v[50:51]
    v_pk_mul_f32 v[60:61], v[60:61], v[52:53]
    v_pk_mul_f32 v[62:63], v[62:63], v[54:55]
    v_exp_f32 v56, v56
    v_exp_f32 v57, v57
    v_exp_f32 v58, v58
    v_exp_f32 v59, v59
    v_exp_f32 v60, v60
    v_exp_f32 v61, v61
    v_exp_f32 v62, v62
    v_exp_f32 v63, v63
    v_add_f32 v56, 1.0, v56
    v_add_f32 v57, 1.0, v57
    v_add_f32 v58, 1.0, v58
    v_add_f32 v59, 1.0, v59
    v_add_f32 v60, 1.0, v60
    v_add_f32 v61, 1.0, v61
    v_add_f32 v62, 1.0, v62
    v_add_f32 v63, 1.0, v63
    v_rcp_f32 v56, v56
    v_rcp_f32 v57, v57
    v_rcp_f32 v58, v58
    v_rcp_f32 v59, v59
    v_rcp_f32 v60, v60
    v_rcp_f32 v61, v61
    v_rcp_f32 v62, v62
    v_rcp_f32 v63, v63
    v_mul_f32 v56, v56, v48
    v_mul_f32 v57, v57, v49
    v_mul_f32 v58, v58, v50
    v_mul_f32 v59, v59, v51
    v_mul_f32 v60, v60, v52
    v_mul_f32 v61, v61, v53
    v_mul_f32 v62, v62, v54
    v_mul_f32 v63, v63, v55
    v_cvt_pk_bf16_f32 v64, v56, v57
    v_cvt_pk_bf16_f32 v65, v58, v59
    v_cvt_pk_bf16_f32 v66, v60, v61
    v_cvt_pk_bf16_f32 v67, v62, v63
    s_add_u32 s57, s57, 114688
    buffer_store_dwordx4 v[64:67], v5, s[40:43], s57 offen sc1
    s_add_u32 s82, s82, 4096
    s_add_u32 s85, s85, 4096
    buffer_load_dwordx4 v[116:119], v4, s[40:43], s56 offen offset:1024 sc1
    s_waitcnt vmcnt(10)
    v_mfma_f32_32x32x16_bf16 v[16:31], a[128:131], v[80:83], v[16:31]
    v_mfma_f32_32x32x16_bf16 v[32:47], a[132:135], v[80:83], 0
    s_add_u32 m0, s70, 16384
    s_mul_i32 s73, s53, 64
    s_add_u32 s73, s73, 0
    buffer_load_dwordx4 v214, s[24:27], s73 offen lds
    s_add_u32 m0, s70, 17408
    s_mul_i32 s73, s53, 64
    s_add_u32 s73, s73, 32768
    buffer_load_dwordx4 v214, s[24:27], s73 offen lds
    buffer_load_dwordx4 v[120:123], v4, s[40:43], s56 offen offset:2048 sc1
    s_waitcnt vmcnt(12)
    v_mfma_f32_32x32x16_bf16 v[16:31], a[136:139], v[84:87], v[16:31]
    v_mfma_f32_32x32x16_bf16 v[32:47], a[140:143], v[84:87], v[32:47]
    s_add_u32 m0, s70, 18432
    s_mul_i32 s73, s53, 64
    s_add_u32 s73, s73, 65536
    buffer_load_dwordx4 v214, s[24:27], s73 offen lds
    s_add_u32 m0, s70, 19456
    s_mul_i32 s73, s53, 64
    s_add_u32 s73, s73, 98304
    buffer_load_dwordx4 v214, s[24:27], s73 offen lds
    buffer_load_dwordx4 v[124:127], v4, s[40:43], s56 offen offset:3072 sc1
    s_waitcnt vmcnt(14)
    v_mfma_f32_32x32x16_bf16 v[16:31], a[144:147], v[88:91], v[16:31]
    v_mfma_f32_32x32x16_bf16 v[32:47], a[148:151], v[88:91], v[32:47]
    s_add_u32 m0, s70, 20480
    s_mul_i32 s73, s53, 64
    s_add_u32 s73, s73, 131072
    buffer_load_dwordx4 v214, s[24:27], s73 offen lds
    s_add_u32 m0, s70, 21504
    s_mul_i32 s73, s53, 64
    s_add_u32 s73, s73, 163840
    buffer_load_dwordx4 v214, s[24:27], s73 offen lds
    s_add_u32 s56, s58, s51
    buffer_load_dwordx4 v[128:131], v4, s[40:43], s56 offen offset:0 sc1
    s_waitcnt vmcnt(16)
    v_mfma_f32_32x32x16_bf16 v[16:31], a[152:155], v[92:95], v[16:31]
    v_mfma_f32_32x32x16_bf16 v[32:47], a[156:159], v[92:95], v[32:47]
    s_add_u32 m0, s70, 22528
    s_mul_i32 s73, s53, 64
    s_add_u32 s73, s73, 196608
    buffer_load_dwordx4 v214, s[24:27], s73 offen lds
    s_add_u32 m0, s70, 23552
    s_mul_i32 s73, s53, 64
    s_add_u32 s73, s73, 229376
    buffer_load_dwordx4 v214, s[24:27], s73 offen lds
    buffer_load_dwordx4 v[132:135], v4, s[40:43], s56 offen offset:1024 sc1
    s_waitcnt vmcnt(18)
    v_mfma_f32_32x32x16_bf16 v[16:31], a[160:163], v[96:99], v[16:31]
    v_mfma_f32_32x32x16_bf16 v[32:47], a[164:167], v[96:99], v[32:47]
    s_add_u32 m0, s70, 24576
    s_mul_i32 s73, s54, 64
    s_add_u32 s73, s73, 0
    buffer_load_dwordx4 v214, s[24:27], s73 offen lds
    s_add_u32 m0, s70, 25600
    s_mul_i32 s73, s54, 64
    s_add_u32 s73, s73, 32768
    buffer_load_dwordx4 v214, s[24:27], s73 offen lds
    s_waitcnt vmcnt(15)
    v_mov_b32 v8, s4
    s_mov_b64 exec, 1
    buffer_store_dword v8, v9, s[40:43], s82 offen sc1
    s_mov_b64 exec, -1
    buffer_load_dwordx4 v[136:139], v4, s[40:43], s56 offen offset:2048 sc1
    v_mfma_f32_32x32x16_bf16 v[16:31], a[168:171], v[100:103], v[16:31]
    v_mfma_f32_32x32x16_bf16 v[32:47], a[172:175], v[100:103], v[32:47]
    s_add_u32 m0, s70, 26624
    s_mul_i32 s73, s54, 64
    s_add_u32 s73, s73, 65536
    buffer_load_dwordx4 v214, s[24:27], s73 offen lds
    s_add_u32 m0, s70, 27648
    s_mul_i32 s73, s54, 64
    s_add_u32 s73, s73, 98304
    buffer_load_dwordx4 v214, s[24:27], s73 offen lds
    buffer_load_dwordx4 v[140:143], v4, s[40:43], s56 offen offset:3072 sc1
    v_mfma_f32_32x32x16_bf16 v[16:31], a[176:179], v[104:107], v[16:31]
    v_mfma_f32_32x32x16_bf16 v[32:47], a[180:183], v[104:107], v[32:47]
    s_add_u32 m0, s70, 28672
    s_mul_i32 s73, s54, 64
    s_add_u32 s73, s73, 131072
    buffer_load_dwordx4 v214, s[24:27], s73 offen lds
    s_add_u32 m0, s70, 29696
    s_mul_i32 s73, s54, 64
    s_add_u32 s73, s73, 163840
    buffer_load_dwordx4 v214, s[24:27], s73 offen lds
    s_and_b32 s60, s3, 1
    s_cmp_eq_u32 s60, 1
    s_cselect_b32 s60, 1.0, 0
    v_lshlrev_b32 v48, 16, v224
    v_and_b32 v49, s91, v224
    v_lshlrev_b32 v208, 16, v240
    v_and_b32 v209, s91, v240
    v_add_f32 v48, v48, v208
    s_add_u32 s56, s58, s52
    buffer_load_dwordx4 v[144:147], v4, s[40:43], s56 offen offset:0 sc1
    v_mfma_f32_32x32x16_bf16 v[16:31], a[184:187], v[108:111], v[16:31]
    v_mfma_f32_32x32x16_bf16 v[32:47], a[188:191], v[108:111], v[32:47]
    s_add_u32 m0, s70, 30720
    s_mul_i32 s73, s54, 64
    s_add_u32 s73, s73, 196608
    buffer_load_dwordx4 v214, s[24:27], s73 offen lds
    s_add_u32 m0, s70, 31744
    s_mul_i32 s73, s54, 64
    s_add_u32 s73, s73, 229376
    buffer_load_dwordx4 v214, s[24:27], s73 offen lds
    v_add_f32 v49, v49, v209
    v_mul_f32 v48, s60, v48
    v_mul_f32 v49, s60, v49
    v_lshlrev_b32 v50, 16, v225
    v_and_b32 v51, s91, v225
    v_lshlrev_b32 v210, 16, v241
    buffer_load_dwordx4 v[148:151], v4, s[40:43], s56 offen offset:1024 sc1
    v_mfma_f32_32x32x16_bf16 v[16:31], a[192:195], v[112:115], v[16:31]
    v_mfma_f32_32x32x16_bf16 v[32:47], a[196:199], v[112:115], v[32:47]
    s_waitcnt vmcnt(23)
    ds_read_b64_tr_b16 a[32:33], v217 offset:16384
    ds_read_b64_tr_b16 a[34:35], v217 offset:17408
    ds_read_b64_tr_b16 a[36:37], v218 offset:16384
    ds_read_b64_tr_b16 a[38:39], v218 offset:17408
    v_and_b32 v211, s91, v241
    v_add_f32 v50, v50, v210
    v_add_f32 v51, v51, v211
    v_mul_f32 v50, s60, v50
    v_mul_f32 v51, s60, v51
    v_lshlrev_b32 v52, 16, v226
    buffer_load_dwordx4 v[152:155], v4, s[40:43], s56 offen offset:2048 sc1
    v_mfma_f32_32x32x16_bf16 v[16:31], a[200:203], v[116:119], v[16:31]
    v_mfma_f32_32x32x16_bf16 v[32:47], a[204:207], v[116:119], v[32:47]
    s_waitcnt vmcnt(21)
    ds_read_b64_tr_b16 a[40:41], v217 offset:18432
    ds_read_b64_tr_b16 a[42:43], v217 offset:19456
    ds_read_b64_tr_b16 a[44:45], v218 offset:18432
    ds_read_b64_tr_b16 a[46:47], v218 offset:19456
    v_and_b32 v53, s91, v226
    v_lshlrev_b32 v208, 16, v242
    v_and_b32 v209, s91, v242
    v_add_f32 v52, v52, v208
    v_add_f32 v53, v53, v209
    v_mul_f32 v52, s60, v52
    buffer_load_dwordx4 v[156:159], v4, s[40:43], s56 offen offset:3072 sc1
    v_mfma_f32_32x32x16_bf16 v[16:31], a[208:211], v[120:123], v[16:31]
    v_mfma_f32_32x32x16_bf16 v[32:47], a[212:215], v[120:123], v[32:47]
    s_waitcnt vmcnt(19)
    ds_read_b64_tr_b16 a[48:49], v217 offset:20480
    ds_read_b64_tr_b16 a[50:51], v217 offset:21504
    ds_read_b64_tr_b16 a[52:53], v218 offset:20480
    ds_read_b64_tr_b16 a[54:55], v218 offset:21504
    v_mul_f32 v53, s60, v53
    v_lshlrev_b32 v54, 16, v227
    v_and_b32 v55, s91, v227
    v_lshlrev_b32 v210, 16, v243
    v_and_b32 v211, s91, v243
    v_add_f32 v54, v54, v210
    s_add_u32 s56, s58, s53
    buffer_load_dwordx4 v[160:163], v4, s[40:43], s56 offen offset:0 sc1
    v_mfma_f32_32x32x16_bf16 v[16:31], a[216:219], v[124:127], v[16:31]
    v_mfma_f32_32x32x16_bf16 v[32:47], a[220:223], v[124:127], v[32:47]
    s_waitcnt vmcnt(17)
    ds_read_b64_tr_b16 a[56:57], v217 offset:22528
    ds_read_b64_tr_b16 a[58:59], v217 offset:23552
    ds_read_b64_tr_b16 a[60:61], v218 offset:22528
    ds_read_b64_tr_b16 a[62:63], v218 offset:23552
    v_add_f32 v55, v55, v211
    v_mul_f32 v54, s60, v54
    v_mul_f32 v55, s60, v55
    v_lshlrev_b32 v56, 16, v228
    v_and_b32 v57, s91, v228
    v_lshlrev_b32 v208, 16, v244
    buffer_load_dwordx4 v[164:167], v4, s[40:43], s56 offen offset:1024 sc1
    v_mfma_f32_32x32x16_bf16 v[16:31], a[224:227], v[128:131], v[16:31]
    v_mfma_f32_32x32x16_bf16 v[32:47], a[228:231], v[128:131], v[32:47]
    s_waitcnt vmcnt(15)
    ds_read_b64_tr_b16 a[64:65], v217 offset:24576
    ds_read_b64_tr_b16 a[66:67], v217 offset:25600
    ds_read_b64_tr_b16 a[68:69], v218 offset:24576
    ds_read_b64_tr_b16 a[70:71], v218 offset:25600
    v_and_b32 v209, s91, v244
    v_add_f32 v56, v56, v208
    v_add_f32 v57, v57, v209
    v_mul_f32 v56, s60, v56
    v_mul_f32 v57, s60, v57
    v_lshlrev_b32 v58, 16, v229
    buffer_load_dwordx4 v[168:171], v4, s[40:43], s56 offen offset:2048 sc1
    v_mfma_f32_32x32x16_bf16 v[16:31], a[232:235], v[132:135], v[16:31]
    v_mfma_f32_32x32x16_bf16 v[32:47], a[236:239], v[132:135], v[32:47]
    s_waitcnt vmcnt(12)
    ds_read_b64_tr_b16 a[72:73], v217 offset:26624
    ds_read_b64_tr_b16 a[74:75], v217 offset:27648
    ds_read_b64_tr_b16 a[76:77], v218 offset:26624
    ds_read_b64_tr_b16 a[78:79], v218 offset:27648
    v_and_b32 v59, s91, v229
    v_lshlrev_b32 v210, 16, v245
    v_and_b32 v211, s91, v245
    v_add_f32 v58, v58, v210
    v_add_f32 v59, v59, v211
    v_mul_f32 v58, s60, v58
    buffer_load_dwordx4 v[172:175], v4, s[40:43], s56 offen offset:3072 sc1
    v_mfma_f32_32x32x16_bf16 v[16:31], a[240:243], v[136:139], v[16:31]
    v_mfma_f32_32x32x16_bf16 v[32:47], a[244:247], v[136:139], v[32:47]
    s_waitcnt vmcnt(10)
    ds_read_b64_tr_b16 a[80:81], v217 offset:28672
    ds_read_b64_tr_b16 a[82:83], v217 offset:29696
    ds_read_b64_tr_b16 a[84:85], v218 offset:28672
    ds_read_b64_tr_b16 a[86:87], v218 offset:29696
    v_mul_f32 v59, s60, v59
    v_lshlrev_b32 v60, 16, v230
    v_and_b32 v61, s91, v230
    v_lshlrev_b32 v208, 16, v246
    v_and_b32 v209, s91, v246
    v_add_f32 v60, v60, v208
    s_add_u32 s56, s58, s54
    buffer_load_dwordx4 v[176:179], v4, s[40:43], s56 offen offset:0 sc1
    v_mfma_f32_32x32x16_bf16 v[16:31], a[248:251], v[140:143], v[16:31]
    v_mfma_f32_32x32x16_bf16 v[32:47], a[252:255], v[140:143], v[32:47]
    s_waitcnt vmcnt(8)
    ds_read_b64_tr_b16 a[88:89], v217 offset:30720
    ds_read_b64_tr_b16 a[90:91], v217 offset:31744
    ds_read_b64_tr_b16 a[92:93], v218 offset:30720
    ds_read_b64_tr_b16 a[94:95], v218 offset:31744
    v_add_f32 v61, v61, v209
    v_mul_f32 v60, s60, v60
    v_mul_f32 v61, s60, v61
    v_lshlrev_b32 v62, 16, v231
    v_and_b32 v63, s91, v231
    v_lshlrev_b32 v210, 16, v247
    buffer_load_dwordx4 v[180:183], v4, s[40:43], s56 offen offset:1024 sc1
    v_mfma_f32_32x32x16_bf16 v[16:31], a[0:3], v[144:147], v[16:31]
    v_mfma_f32_32x32x16_bf16 v[32:47], a[4:7], v[144:147], v[32:47]
    v_and_b32 v211, s91, v247
    v_add_f32 v62, v62, v210
    v_add_f32 v63, v63, v211
    v_mul_f32 v62, s60, v62
    v_mul_f32 v63, s60, v63
    buffer_load_dword v248, v12, s[40:43], s85 offen offset:0 sc1
    buffer_load_dwordx4 v[184:187], v4, s[40:43], s56 offen offset:2048 sc1
    s_waitcnt vmcnt(10)
    v_mfma_f32_32x32x16_bf16 v[16:31], a[8:11], v[148:151], v[16:31]
    v_mfma_f32_32x32x16_bf16 v[32:47], a[12:15], v[148:151], v[32:47]
    buffer_load_dwordx4 v[188:191], v4, s[40:43], s56 offen offset:3072 sc1
    s_waitcnt vmcnt(10)
    v_mfma_f32_32x32x16_bf16 v[16:31], a[16:19], v[152:155], v[16:31]
    v_mfma_f32_32x32x16_bf16 v[32:47], a[20:23], v[152:155], v[32:47]
    s_waitcnt vmcnt(9)
    v_mfma_f32_32x32x16_bf16 v[16:31], a[24:27], v[156:159], v[16:31]
    v_mfma_f32_32x32x16_bf16 v[32:47], a[28:31], v[156:159], v[32:47]
    s_waitcnt vmcnt(8) lgkmcnt(15)
    v_mfma_f32_32x32x16_bf16 v[16:31], a[32:35], v[160:163], v[16:31]
    v_mfma_f32_32x32x16_bf16 v[32:47], a[36:39], v[160:163], v[32:47]
    s_waitcnt vmcnt(2)
    v_cmp_ne_u32 vcc, s4, v248
    s_nop 1
    s_cbranch_vccz Lpcd_P_13
    s_nop 6
Lpc_P_12:
    s_sub_u32 s6, s6, 1
    s_cbranch_scc1 L_end_P
    buffer_load_dword v248, v12, s[40:43], s85 offen offset:0 sc1
    s_waitcnt vmcnt(0)
    v_cmp_ne_u32 vcc, s4, v248
    s_nop 1
    s_cbranch_vccnz Lpc_P_12
Lpcd_P_13:
    s_add_u32 s56, s59, s48
    buffer_load_dwordx4 v[192:195], v4, s[40:43], s56 offen offset:0 sc1
    buffer_load_dwordx4 v[196:199], v4, s[40:43], s56 offen offset:1024 sc1
    v_mfma_f32_32x32x16_bf16 v[16:31], a[40:43], v[164:167], v[16:31]
    v_mfma_f32_32x32x16_bf16 v[32:47], a[44:47], v[164:167], v[32:47]
    buffer_load_dwordx4 v[200:203], v4, s[40:43], s56 offen offset:2048 sc1
    buffer_load_dwordx4 v[204:207], v4, s[40:43], s56 offen offset:3072 sc1
    v_mfma_f32_32x32x16_bf16 v[16:31], a[48:51], v[168:171], v[16:31]
    v_mfma_f32_32x32x16_bf16 v[32:47], a[52:55], v[168:171], v[32:47]
    s_add_u32 s56, s59, s49
    buffer_load_dwordx4 v[80:83], v4, s[40:43], s56 offen offset:0 sc1
    v_mfma_f32_32x32x16_bf16 v[16:31], a[56:59], v[172:175], v[16:31]
    v_mfma_f32_32x32x16_bf16 v[32:47], a[60:63], v[172:175], v[32:47]
    buffer_load_dwordx4 v[84:87], v4, s[40:43], s56 offen offset:1024 sc1
    s_waitcnt lgkmcnt(14)
    v_mfma_f32_32x32x16_bf16 v[16:31], a[64:67], v[176:179], v[16:31]
    s_waitcnt lgkmcnt(12)
    v_mfma_f32_32x32x16_bf16 v[32:47], a[68:71], v[176:179], v[32:47]
    buffer_load_dwordx4 v[88:91], v4, s[40:43], s56 offen offset:2048 sc1
    s_waitcnt lgkmcnt(10)
    v_mfma_f32_32x32x16_bf16 v[16:31], a[72:75], v[180:183], v[16:31]
    s_waitcnt lgkmcnt(8)
    v_mfma_f32_32x32x16_bf16 v[32:47], a[76:79], v[180:183], v[32:47]
    buffer_load_dwordx4 v[92:95], v4, s[40:43], s56 offen offset:3072 sc1
    s_waitcnt vmcnt(9) lgkmcnt(6)
    v_mfma_f32_32x32x16_bf16 v[16:31], a[80:83], v[184:187], v[16:31]
    s_waitcnt lgkmcnt(4)
    v_mfma_f32_32x32x16_bf16 v[32:47], a[84:87], v[184:187], v[32:47]
    s_add_u32 s56, s59, s50
    buffer_load_dwordx4 v[96:99], v4, s[40:43], s56 offen offset:0 sc1
    s_waitcnt vmcnt(9) lgkmcnt(2)
    v_mfma_f32_32x32x16_bf16 v[16:31], a[88:91], v[188:191], v[16:31]
    s_waitcnt lgkmcnt(0)
    v_mfma_f32_32x32x16_bf16 v[32:47], a[92:95], v[188:191], v[32:47]
    buffer_load_dwordx4 v[100:103], v4, s[40:43], s56 offen offset:1024 sc1
    s_waitcnt vmcnt(9)
    v_mfma_f32_32x32x16_bf16 v[48:63], a[128:131], v[192:195], v[48:63]
    v_mfma_f32_32x32x16_bf16 v[64:79], a[132:135], v[192:195], 0
    s_nop 7
    ds_write_b32 v237, v32 offset:0
    ds_write_b32 v237, v34 offset:256
    ds_write_b32 v237, v33 offset:128
    ds_write_b32 v237, v35 offset:384
    ds_write_b32 v237, v36 offset:1024
    ds_write_b32 v237, v38 offset:1280
    buffer_load_dwordx4 v[104:107], v4, s[40:43], s56 offen offset:2048 sc1
    s_waitcnt vmcnt(9)
    v_mfma_f32_32x32x16_bf16 v[48:63], a[136:139], v[196:199], v[48:63]
    v_mfma_f32_32x32x16_bf16 v[64:79], a[140:143], v[196:199], v[64:79]
    ds_write_b32 v237, v37 offset:1152
    ds_write_b32 v237, v39 offset:1408
    ds_write_b32 v237, v40 offset:2048
    ds_write_b32 v237, v42 offset:2304
    ds_write_b32 v237, v41 offset:2176
    ds_write_b32 v237, v43 offset:2432
    buffer_load_dwordx4 v[108:111], v4, s[40:43], s56 offen offset:3072 sc1
    s_waitcnt vmcnt(9)
    v_mfma_f32_32x32x16_bf16 v[48:63], a[144:147], v[200:203], v[48:63]
    v_mfma_f32_32x32x16_bf16 v[64:79], a[148:151], v[200:203], v[64:79]
    ds_write_b32 v237, v44 offset:3072
    ds_write_b32 v237, v46 offset:3328
    ds_write_b32 v237, v45 offset:3200
    ds_write_b32 v237, v47 offset:3456
    ds_write_b32 v236, v16 offset:0
    ds_write_b32 v236, v18 offset:256
    s_add_u32 s56, s59, s51
    buffer_load_dwordx4 v[112:115], v4, s[40:43], s56 offen offset:0 sc1
    s_waitcnt vmcnt(9)
    v_mfma_f32_32x32x16_bf16 v[48:63], a[152:155], v[204:207], v[48:63]
    v_mfma_f32_32x32x16_bf16 v[64:79], a[156:159], v[204:207], v[64:79]
    ds_write_b32 v236, v17 offset:128
    ds_write_b32 v236, v19 offset:384
    ds_write_b32 v236, v20 offset:1024
    ds_write_b32 v236, v22 offset:1280
    ds_write_b32 v236, v21 offset:1152
    ds_write_b32 v236, v23 offset:1408
    buffer_load_dwordx4 v[116:119], v4, s[40:43], s56 offen offset:1024 sc1
    s_waitcnt vmcnt(9)
    v_mfma_f32_32x32x16_bf16 v[48:63], a[160:163], v[80:83], v[48:63]
    v_mfma_f32_32x32x16_bf16 v[64:79], a[164:167], v[80:83], v[64:79]
    ds_write_b32 v236, v24 offset:2048
    ds_write_b32 v236, v26 offset:2304
    ds_write_b32 v236, v25 offset:2176
    ds_write_b32 v236, v27 offset:2432
    ds_write_b32 v236, v28 offset:3072
    ds_write_b32 v236, v30 offset:3328
    buffer_load_dwordx4 v[120:123], v4, s[40:43], s56 offen offset:2048 sc1
    s_waitcnt vmcnt(9)
    v_mfma_f32_32x32x16_bf16 v[48:63], a[168:171], v[84:87], v[48:63]
    v_mfma_f32_32x32x16_bf16 v[64:79], a[172:175], v[84:87], v[64:79]
    ds_write_b32 v236, v29 offset:3200
    ds_write_b32 v236, v31 offset:3456
    buffer_load_dwordx4 v[124:127], v4, s[40:43], s56 offen offset:3072 sc1
    s_waitcnt vmcnt(9)
    v_mfma_f32_32x32x16_bf16 v[48:63], a[176:179], v[88:91], v[48:63]
    v_mfma_f32_32x32x16_bf16 v[64:79], a[180:183], v[88:91], v[64:79]
    s_add_u32 s56, s59, s52
    buffer_load_dwordx4 v[128:131], v4, s[40:43], s56 offen offset:0 sc1
    s_waitcnt vmcnt(9)
    v_mfma_f32_32x32x16_bf16 v[48:63], a[184:187], v[92:95], v[48:63]
    v_mfma_f32_32x32x16_bf16 v[64:79], a[188:191], v[92:95], v[64:79]
    s_waitcnt lgkmcnt(0)
    s_barrier
    ds_read_b128 v[16:19], v238 offset:0
    ds_read_b128 v[20:23], v238 offset:36864
    ds_read_b128 v[24:27], v239 offset:0
    ds_read_b128 v[28:31], v239 offset:36864
    ds_read_b128 v[32:35], v238 offset:1024
    ds_read_b128 v[36:39], v238 offset:37888
    ds_read_b128 v[40:43], v239 offset:1024
    ds_read_b128 v[44:47], v239 offset:37888
    buffer_load_dwordx4 v[132:135], v4, s[40:43], s56 offen offset:1024 sc1
    s_waitcnt vmcnt(9)
    v_mfma_f32_32x32x16_bf16 v[48:63], a[192:195], v[96:99], v[48:63]
    v_mfma_f32_32x32x16_bf16 v[64:79], a[196:199], v[96:99], v[64:79]
    buffer_load_dwordx4 v[136:139], v4, s[40:43], s56 offen offset:2048 sc1
    s_waitcnt vmcnt(9)
    v_mfma_f32_32x32x16_bf16 v[48:63], a[200:203], v[100:103], v[48:63]
    v_mfma_f32_32x32x16_bf16 v[64:79], a[204:207], v[100:103], v[64:79]
    s_waitcnt lgkmcnt(6)
    v_add_f32 v16, v16, v20
    s_waitcnt lgkmcnt(4)
    v_add_f32 v24, v24, v28
    v_add_f32 v17, v17, v21
    v_add_f32 v25, v25, v29
    v_add_f32 v18, v18, v22
    v_add_f32 v26, v26, v30
    buffer_load_dwordx4 v[140:143], v4, s[40:43], s56 offen offset:3072 sc1
    s_waitcnt vmcnt(9)
    v_mfma_f32_32x32x16_bf16 v[48:63], a[208:211], v[104:107], v[48:63]
    v_mfma_f32_32x32x16_bf16 v[64:79], a[212:215], v[104:107], v[64:79]
    v_add_f32 v19, v19, v23
    v_add_f32 v27, v27, v31
    v_add_f32 v16, v16, v24
    v_add_f32 v17, v17, v25
    v_add_f32 v18, v18, v26
    v_add_f32 v19, v19, v27
    s_add_u32 s56, s59, s53
    buffer_load_dwordx4 v[144:147], v4, s[40:43], s56 offen offset:0 sc1
    s_waitcnt vmcnt(9)
    v_mfma_f32_32x32x16_bf16 v[48:63], a[216:219], v[108:111], v[48:63]
    v_mfma_f32_32x32x16_bf16 v[64:79], a[220:223], v[108:111], v[64:79]
    v_cvt_pk_bf16_f32 v20, v16, v17
    v_cvt_pk_bf16_f32 v21, v18, v19
    buffer_store_dwordx2 v[20:21], v212, s[36:39], s68 offen offset:0
    s_waitcnt lgkmcnt(2)
    v_add_f32 v32, v32, v36
    s_waitcnt lgkmcnt(0)
    v_add_f32 v40, v40, v44
    v_add_f32 v33, v33, v37
    buffer_load_dwordx4 v[148:151], v4, s[40:43], s56 offen offset:1024 sc1
    s_waitcnt vmcnt(10)
    v_mfma_f32_32x32x16_bf16 v[48:63], a[224:227], v[112:115], v[48:63]
    v_mfma_f32_32x32x16_bf16 v[64:79], a[228:231], v[112:115], v[64:79]
    v_add_f32 v41, v41, v45
    v_add_f32 v34, v34, v38
    v_add_f32 v42, v42, v46
    v_add_f32 v35, v35, v39
    v_add_f32 v43, v43, v47
    v_add_f32 v32, v32, v40
    buffer_load_dwordx4 v[152:155], v4, s[40:43], s56 offen offset:2048 sc1
    s_waitcnt vmcnt(10)
    v_mfma_f32_32x32x16_bf16 v[48:63], a[232:235], v[116:119], v[48:63]
    v_mfma_f32_32x32x16_bf16 v[64:79], a[236:239], v[116:119], v[64:79]
    v_add_f32 v33, v33, v41
    v_add_f32 v34, v34, v42
    v_add_f32 v35, v35, v43
    v_cvt_pk_bf16_f32 v36, v32, v33
    v_cvt_pk_bf16_f32 v37, v34, v35
    buffer_store_dwordx2 v[36:37], v212, s[36:39], s69 offen offset:0
    buffer_load_dwordx4 v[156:159], v4, s[40:43], s56 offen offset:3072 sc1
    s_waitcnt vmcnt(11)
    v_mfma_f32_32x32x16_bf16 v[48:63], a[240:243], v[120:123], v[48:63]
    v_mfma_f32_32x32x16_bf16 v[64:79], a[244:247], v[120:123], v[64:79]
    s_add_u32 s56, s59, s54
    buffer_load_dwordx4 v[160:163], v4, s[40:43], s56 offen offset:0 sc1
    s_waitcnt vmcnt(11)
    v_mfma_f32_32x32x16_bf16 v[48:63], a[248:251], v[124:127], v[48:63]
    v_mfma_f32_32x32x16_bf16 v[64:79], a[252:255], v[124:127], v[64:79]
    buffer_load_dwordx4 v[164:167], v4, s[40:43], s56 offen offset:1024 sc1
    s_waitcnt vmcnt(11)
    v_mfma_f32_32x32x16_bf16 v[48:63], a[0:3], v[128:131], v[48:63]
    v_mfma_f32_32x32x16_bf16 v[64:79], a[4:7], v[128:131], v[64:79]
    buffer_load_dwordx4 v[168:171], v4, s[40:43], s56 offen offset:2048 sc1
    s_waitcnt vmcnt(11)
    v_mfma_f32_32x32x16_bf16 v[48:63], a[8:11], v[132:135], v[48:63]
    v_mfma_f32_32x32x16_bf16 v[64:79], a[12:15], v[132:135], v[64:79]
    buffer_load_dwordx4 v[172:175], v4, s[40:43], s56 offen offset:3072 sc1
    s_waitcnt vmcnt(11)
    v_mfma_f32_32x32x16_bf16 v[48:63], a[16:19], v[136:139], v[48:63]
    v_mfma_f32_32x32x16_bf16 v[64:79], a[20:23], v[136:139], v[64:79]
    s_waitcnt vmcnt(10)
    v_mfma_f32_32x32x16_bf16 v[48:63], a[24:27], v[140:143], v[48:63]
    v_mfma_f32_32x32x16_bf16 v[64:79], a[28:31], v[140:143], v[64:79]
    s_waitcnt vmcnt(9)
    v_mfma_f32_32x32x16_bf16 v[48:63], a[32:35], v[144:147], v[48:63]
    v_mfma_f32_32x32x16_bf16 v[64:79], a[36:39], v[144:147], v[64:79]
    s_waitcnt vmcnt(7)
    v_mfma_f32_32x32x16_bf16 v[48:63], a[40:43], v[148:151], v[48:63]
    v_mfma_f32_32x32x16_bf16 v[64:79], a[44:47], v[148:151], v[64:79]
    s_waitcnt vmcnt(6)
    v_mfma_f32_32x32x16_bf16 v[48:63], a[48:51], v[152:155], v[48:63]
    v_mfma_f32_32x32x16_bf16 v[64:79], a[52:55], v[152:155], v[64:79]
    s_waitcnt vmcnt(4)
    v_mfma_f32_32x32x16_bf16 v[48:63], a[56:59], v[156:159], v[48:63]
    v_mfma_f32_32x32x16_bf16 v[64:79], a[60:63], v[156:159], v[64:79]
    s_waitcnt vmcnt(3)
    v_mfma_f32_32x32x16_bf16 v[64:79], a[68:71], v[160:163], v[64:79]
    s_waitcnt vmcnt(2)
    v_mfma_f32_32x32x16_bf16 v[64:79], a[76:79], v[164:167], v[64:79]
    s_waitcnt vmcnt(1)
    v_mfma_f32_32x32x16_bf16 v[64:79], a[84:87], v[168:171], v[64:79]
    s_waitcnt vmcnt(0)
    v_mfma_f32_32x32x16_bf16 v[64:79], a[92:95], v[172:175], v[64:79]
    v_mfma_f32_32x32x16_bf16 v[48:63], a[64:67], v[160:163], v[48:63]
    v_mfma_f32_32x32x16_bf16 v[48:63], a[72:75], v[164:167], v[48:63]
    s_nop 9
    ds_write_b32 v237, v64 offset:8192
    ds_write_b32 v237, v66 offset:8448
    ds_write_b32 v237, v65 offset:8320
    ds_write_b32 v237, v67 offset:8576
    ds_write_b32 v237, v68 offset:9216
    ds_write_b32 v237, v70 offset:9472
    v_mfma_f32_32x32x16_bf16 v[48:63], a[80:83], v[168:171], v[48:63]
    ds_write_b32 v237, v69 offset:9344
    ds_write_b32 v237, v71 offset:9600
    ds_write_b32 v237, v72 offset:10240
    ds_write_b32 v237, v74 offset:10496
    ds_write_b32 v237, v73 offset:10368
    ds_write_b32 v237, v75 offset:10624
    v_mfma_f32_32x32x16_bf16 v[48:63], a[88:91], v[172:175], v[48:63]
    ds_write_b32 v237, v76 offset:11264
    ds_write_b32 v237, v78 offset:11520
    ds_write_b32 v237, v77 offset:11392
    ds_write_b32 v237, v79 offset:11648
    s_nop 7
    ds_write_b32 v236, v48 offset:8192
    ds_write_b32 v236, v50 offset:8448
    ds_write_b32 v236, v49 offset:8320
    ds_write_b32 v236, v51 offset:8576
    ds_write_b32 v236, v52 offset:9216
    ds_write_b32 v236, v54 offset:9472
    ds_write_b32 v236, v53 offset:9344
    ds_write_b32 v236, v55 offset:9600
    ds_write_b32 v236, v56 offset:10240
    ds_write_b32 v236, v58 offset:10496
    ds_write_b32 v236, v57 offset:10368
    ds_write_b32 v236, v59 offset:10624
    ds_write_b32 v236, v60 offset:11264
    ds_write_b32 v236, v62 offset:11520
    ds_write_b32 v236, v61 offset:11392
    ds_write_b32 v236, v63 offset:11648
    s_waitcnt lgkmcnt(0)
    s_barrier
    ds_read_b128 v[48:51], v238 offset:8192
    ds_read_b128 v[52:55], v238 offset:45056
    ds_read_b128 v[56:59], v239 offset:8192
    ds_read_b128 v[60:63], v239 offset:45056
    ds_read_b128 v[64:67], v238 offset:9216
    ds_read_b128 v[68:71], v238 offset:46080
    ds_read_b128 v[72:75], v239 offset:9216
    ds_read_b128 v[76:79], v239 offset:46080
    s_waitcnt lgkmcnt(6)
    v_pk_add_f32 v[48:49], v[48:49], v[52:53]
    s_waitcnt lgkmcnt(4)
    v_pk_add_f32 v[56:57], v[56:57], v[60:61]
    v_pk_add_f32 v[50:51], v[50:51], v[54:55]
    v_pk_add_f32 v[58:59], v[58:59], v[62:63]
    v_pk_add_f32 v[48:49], v[48:49], v[56:57]
    v_pk_add_f32 v[50:51], v[50:51], v[58:59]
    v_cvt_pk_bf16_f32 v52, v48, v49
    v_cvt_pk_bf16_f32 v53, v50, v51
    buffer_store_dwordx2 v[52:53], v212, s[36:39], s68 offen offset:64
    s_waitcnt lgkmcnt(2)
    v_pk_add_f32 v[64:65], v[64:65], v[68:69]
    s_waitcnt lgkmcnt(0)
    v_pk_add_f32 v[72:73], v[72:73], v[76:77]
    v_pk_add_f32 v[66:67], v[66:67], v[70:71]
    v_pk_add_f32 v[74:75], v[74:75], v[78:79]
    v_pk_add_f32 v[64:65], v[64:65], v[72:73]
    v_pk_add_f32 v[66:67], v[66:67], v[74:75]
    v_cvt_pk_bf16_f32 v68, v64, v65
    v_cvt_pk_bf16_f32 v69, v66, v67
    buffer_store_dwordx2 v[68:69], v212, s[36:39], s69 offen offset:64
L_end_P:
    s_endpgm

.section .rodata,"a"
.p2align 6
.amdhsa_kernel sequential_preLN__sliding_local_dilated__mixer_token_mlp__prompt_kernel
  .amdhsa_next_free_vgpr 508
  .amdhsa_next_free_sgpr 102
  .amdhsa_accum_offset 252
  .amdhsa_group_segment_fixed_size 0
  .amdhsa_kernarg_size 88
  .amdhsa_user_sgpr_count 2
  .amdhsa_user_sgpr_kernarg_segment_ptr 1
  .amdhsa_system_sgpr_workgroup_id_x 1
.end_amdhsa_kernel
```

```asm
; @launch grid=(256,1,1) block=(256,1,1) lds=163840
.amdgcn_target "amdgcn-amd-amdhsa--gfx950"
.text
.globl sequential_preLN__sliding_local_dilated__mixer_token_mlp__prompt_kernel
.p2align 8
.type sequential_preLN__sliding_local_dilated__mixer_token_mlp__prompt_kernel,@function
sequential_preLN__sliding_local_dilated__mixer_token_mlp__prompt_kernel:
    s_cmp_ge_u32 s2, 256
    s_cbranch_scc1 L_end_P
    s_load_dwordx2 s[8:9], s[0:1], 0
    s_load_dwordx2 s[12:13], s[0:1], 8
    s_load_dwordx2 s[44:45], s[0:1], 72
    s_load_dwordx2 s[40:41], s[0:1], 80
    s_load_dwordx2 s[16:17], s[0:1], 16
    s_load_dwordx2 s[20:21], s[0:1], 32
    s_load_dwordx2 s[24:25], s[0:1], 48
    s_load_dwordx2 s[28:29], s[0:1], 40
    s_load_dwordx2 s[32:33], s[0:1], 56
    s_load_dwordx2 s[36:37], s[0:1], 64
    v_lshrrev_b32 v1, 6, v0
    s_nop 0
    v_readfirstlane_b32 s3, v1
    v_and_b32 v1, 63, v0
    v_and_b32 v2, 15, v0
    v_lshrrev_b32 v3, 4, v1
    v_lshlrev_b32 v4, 4, v1
    s_mov_b32 s10, 0x1c0000
    s_mov_b32 s11, 0x00020000
    s_mov_b32 s14, 0x126000
    s_mov_b32 s15, 0x00020000
    s_mov_b32 s46, 0x100
    s_mov_b32 s47, 0x00020000
    s_mov_b32 s42, 0x5c0000
    s_mov_b32 s43, 0x00020000
    s_mov_b32 s18, 0x62000
    s_mov_b32 s19, 0x00020000
    s_mov_b32 s22, 0x700000
    s_mov_b32 s23, 0x00020000
    s_mov_b32 s26, 0x700000
    s_mov_b32 s27, 0x00020000
    s_mov_b32 s30, 0xe00
    s_mov_b32 s31, 0x00020000
    s_mov_b32 s34, 0x1000
    s_mov_b32 s35, 0x00020000
    s_mov_b32 s38, 0x1c0000
    s_mov_b32 s39, 0x00020000
    s_mov_b32 s5, 0x3f803f80
    s_mov_b32 s6, 0x200000
    s_bfe_u32 s48, s2, 0x20001
    s_lshl_b32 s48, s48, 2
    s_lshr_b32 s53, s2, 6
    s_add_u32 s48, s48, s53
    s_bfe_u32 s49, s2, 0x30003
    s_and_b32 s53, s2, 1
    s_lshl_b32 s53, s53, 3
    s_add_u32 s49, s49, s53
    v_lshrrev_b32 v237, 2, v1
    v_mul_u32_u24 v123, 2688, v237
    v_lshrrev_b32 v237, 5, v1
    v_lshlrev_b32 v237, 1, v237
    v_and_b32 v238, 3, v1
    v_xor_b32 v237, v237, v238
    v_lshl_add_u32 v123, v237, 4, v123
    s_mul_i32 s53, s49, 56
    s_min_u32 s53, s53, 832
    s_mul_i32 s51, s3, 43008
    s_add_u32 s53, s53, s51
    v_add_u32 v123, s53, v123
    s_lshr_b32 s53, s3, 1
    s_mul_i32 s51, s53, 6144
    s_and_b32 s53, s3, 1
    s_lshl_b32 s53, s53, 10
    s_add_u32 s51, s51, s53
    v_lshrrev_b32 v237, 3, v1
    v_mul_u32_u24 v122, 896, v237
    v_and_b32 v237, 7, v1
    v_xor_b32 v237, v237, v3
    v_lshl_add_u32 v120, v237, 4, v122
    s_lshl_b32 s50, s48, 7
    s_lshl_b32 s53, s3, 5
    s_add_u32 s53, s53, s50
    s_mul_i32 s53, s53, 896
    v_xor_b32 v121, 64, v120
    v_add_u32 v120, s53, v120
    s_add_u32 s53, s53, 7168
    v_add_u32 v121, s53, v121
    s_lshl_b32 s53, s3, 1
    v_xor_b32 v237, s53, v237
    v_lshl_add_u32 v122, v237, 4, v122
    s_lshl_b32 s53, s3, 2
    s_add_u32 s53, s53, s50
    s_sub_u32 s53, s53, 16
    s_mul_i32 s53, s53, 896
    s_cmp_eq_u32 s48, 0
    s_cselect_b32 s53, 0x40000000, s53
    v_add_u32 v122, s53, v122
    s_lshl_b32 s52, s3, 12
    s_add_u32 s52, s52, 63488
    s_lshl_b32 s7, s3, 9
    s_cmp_eq_u32 s3, 0
    s_cselect_b32 s54, 0xffffff00, -1
    s_mov_b32 s55, 0
    s_memrealtime s[86:87]
    v_mov_b32 v7, 0
    s_waitcnt lgkmcnt(0)
    s_or_b32 s86, s86, 1
    v_mov_b32 v6, s86
    s_or_b32 s86, s2, s3
    s_cmp_eq_u32 s86, 0
    s_cselect_b64 exec, 1, 0
    buffer_store_dword v6, v7, s[44:47], 0 offen sc1
    s_mov_b64 exec, -1
    s_add_u32 m0, s51, 12288
    s_mov_b32 s73, 0
    buffer_load_dwordx4 v123, s[12:15], s73 offen lds
    s_add_u32 m0, s51, 14336
    s_mov_b32 s73, 896
    buffer_load_dwordx4 v123, s[12:15], s73 offen lds
    s_add_u32 m0, s51, 16384
    s_mov_b32 s73, 1792
    buffer_load_dwordx4 v123, s[12:15], s73 offen lds
    s_add_u32 m0, s52, 36864
    s_mov_b32 s73, 0
    buffer_load_dwordx4 v120, s[8:11], s73 offen lds
    s_add_u32 m0, s52, 37888
    s_mov_b32 s73, 0
    buffer_load_dwordx4 v121, s[8:11], s73 offen lds
    s_add_u32 m0, s52, 38912
    s_mov_b32 s73, 14336
    buffer_load_dwordx4 v120, s[8:11], s73 offen lds
    s_add_u32 m0, s52, 39936
    s_mov_b32 s73, 14336
    buffer_load_dwordx4 v121, s[8:11], s73 offen lds
    s_add_u32 m0, s7, 98304
    s_mov_b32 s73, 0
    s_mov_b64 exec, s[54:55]
    buffer_load_dwordx4 v122, s[8:11], s73 offen lds
    s_mov_b64 exec, -1
    s_bfe_u32 s53, s2, 0x30003
    s_add_u32 s86, s53, 1
    s_lshr_b32 s86, s86, 1
    s_lshr_b32 s87, s2, 6
    s_mul_i32 s87, s87, 5
    s_add_u32 s86, s86, s87
    s_lshl_b32 s86, s86, 2
    s_add_u32 s53, s86, s3
    s_mov_b32 s56, s53
    s_mov_b32 s86, 0x2a54
    s_bitcmp1_b32 s86, s49
    s_cselect_b32 s57, 0x40000000, 0
    s_mul_i32 s86, s53, 48
    v_add_u32 v237, s86, v1
    v_mul_u32_u24 v238, 43691, v237
    v_lshrrev_b32 v238, 19, v238
    v_mul_u32_u24 v239, 12, v238
    v_sub_u32 v239, v237, v239
    v_lshrrev_b32 v239, 2, v239
    v_mul_u32_u24 v239, 896, v239
    v_mul_u32_u24 v238, 2688, v238
    v_and_b32 v237, 3, v237
    v_lshlrev_b32 v237, 7, v237
    v_add3_u32 v237, v237, v238, v239
    v_add_u32 v237, s57, v237
    s_and_b32 s86, s2, 1
    s_mul_i32 s86, s86, 384
    s_add_u32 s86, s86, 344064
    s_mov_b32 exec_hi, 0xffff
    buffer_load_dword v232, v237, s[12:15], s86 offen
    v_lshlrev_b32 v237, 7, v1
    v_add_u32 v238, s57, v237
    s_mul_i32 s86, s53, 6016
    s_bfe_u32 s87, s2, 0x20001
    s_mul_i32 s87, s87, 458752
    s_add_u32 s86, s86, s87
    s_max_u32 s86, s86, 14336
    s_sub_u32 s86, s86, 14336
    s_mov_b32 exec_hi, 0x7fff
    buffer_load_dword v233, v238, s[8:11], s86 offen
    s_getpc_b64 s[86:87]
Lpc_P:
    s_mul_i32 s53, s53, 384
    v_add_u32 v237, s53, v237
    v_min_u32 v237, L_end_P-Lpc_P, v237
    s_mov_b64 exec, 7
    global_load_dword v236, v237, s[86:87]
    s_mov_b64 exec, -1
    v_mul_u32_u24 v237, 18432, v3
    v_lshl_add_u32 v237, v2, 3, v237
    v_mov_b32 v238, s5
    v_add_u32 v237, 61440, v237
    ds_write2_b32 v237, v238, v238 offset0:0 offset1:1
    s_lshr_b32 s68, s2, 3
    s_mul_i32 s69, s68, 37
    s_lshr_b32 s69, s69, 8
    s_mul_i32 s64, s69, 7
    s_sub_u32 s64, s68, s64
    s_mov_b32 s66, s64
    s_and_b32 s68, s2, 7
    s_lshl_b32 s67, s68, 2
    s_add_u32 s67, s67, s69
    s_cmp_ge_u32 s69, 4
    s_cselect_b32 s67, 99, s67
    s_mul_i32 s71, s68, 3
    s_add_u32 s71, s71, 4
    s_lshl_b32 s72, s68, 2
    s_cmp_lt_u32 s68, 4
    s_cselect_b32 s65, s72, s71
    s_cselect_b32 s71, 4, 3
    s_add_u32 s65, s65, s69
    s_cmp_ge_u32 s69, s71
    s_cselect_b32 s65, 99, s65
    v_lshrrev_b32 v219, 3, v1
    v_mul_u32_u24 v208, 896, v219
    v_and_b32 v219, 1, v3
    v_lshlrev_b32 v219, 2, v219
    v_and_b32 v220, 7, v1
    v_xor_b32 v219, v219, v220
    v_lshl_add_u32 v208, v219, 4, v208
    s_lshl_b32 s58, s66, 7
    s_mul_i32 s60, s3, 100352
    s_add_u32 s58, s58, s60
    v_add_u32 v208, s58, v208
    s_mul_i32 s59, s3, 14336
    s_add_u32 s59, s59, 106496
    v_lshrrev_b32 v219, 5, v1
    v_lshlrev_b32 v209, 9, v219
    v_bfe_u32 v219, v1, 2, 2
    v_lshl_add_u32 v209, v219, 7, v209
    v_lshrrev_b32 v219, 1, v219
    s_and_b32 s58, s3, 1
    v_xor_b32 v219, s58, v219
    v_lshl_add_u32 v209, v219, 6, v209
    v_and_b32 v219, 1, v3
    v_lshl_add_u32 v209, v219, 5, v209
    v_and_b32 v219, 3, v1
    v_lshl_add_u32 v209, v219, 3, v209
    v_add_u32 v209, 106496, v209
    s_mul_i32 s70, s3, 36864
    s_add_u32 s70, s70, 12288
    v_lshrrev_b32 v219, 3, v1
    v_mul_u32_u24 v213, 3584, v219
    v_and_b32 v219, 1, v3
    v_lshlrev_b32 v219, 2, v219
    v_and_b32 v220, 7, v1
    v_xor_b32 v219, v219, v220
    v_lshl_add_u32 v213, v219, 4, v213
    s_mul_i32 s68, s3, 1835008
    s_lshl_b32 s69, s65, 7
    s_add_u32 s68, s68, s69
    s_cmp_ge_u32 s65, 99
    s_cselect_b32 s68, 0x40000000, s68
    v_add_u32 v213, s68, v213
    s_cselect_b32 s68, 0x40000000, 0
    v_add_u32 v5, s68, v4
    v_lshrrev_b32 v219, 5, v1
    v_lshlrev_b32 v215, 9, v219
    v_bfe_u32 v219, v1, 2, 2
    v_lshl_add_u32 v215, v219, 7, v215
    v_lshrrev_b32 v219, 1, v219
    s_lshr_b32 s68, s3, 1
    v_xor_b32 v219, s68, v219
    v_lshl_add_u32 v215, v219, 6, v215
    v_and_b32 v219, 1, v3
    v_lshl_add_u32 v215, v219, 5, v215
    v_and_b32 v219, 3, v1
    v_lshl_add_u32 v215, v219, 3, v215
    s_and_b32 s68, s3, 1
    s_lshl_b32 s68, s68, 5
    v_xor_b32 v215, s68, v215
    v_add_u32 v215, s70, v215
    v_xor_b32 v216, 64, v215
    s_mul_i32 s70, s3, 36864
    s_add_u32 s70, s70, 12288
    v_lshrrev_b32 v219, 3, v1
    v_mul_u32_u24 v214, 4096, v219
    v_and_b32 v219, 1, v3
    v_lshlrev_b32 v219, 2, v219
    v_and_b32 v220, 7, v1
    v_xor_b32 v219, v219, v220
    v_lshl_add_u32 v214, v219, 4, v214
    s_mul_i32 s68, s3, 1835008
    s_lshl_b32 s69, s67, 7
    s_add_u32 s68, s68, s69
    s_cmp_ge_u32 s67, 99
    s_cselect_b32 s68, 0x40000000, s68
    v_add_u32 v214, s68, v214
    v_lshrrev_b32 v219, 5, v1
    v_lshlrev_b32 v217, 9, v219
    v_bfe_u32 v219, v1, 2, 2
    v_lshl_add_u32 v217, v219, 7, v217
    v_lshrrev_b32 v219, 1, v219
    s_lshr_b32 s68, s3, 1
    v_xor_b32 v219, s68, v219
    v_lshl_add_u32 v217, v219, 6, v217
    v_and_b32 v219, 1, v3
    v_lshl_add_u32 v217, v219, 5, v217
    v_and_b32 v219, 3, v1
    v_lshl_add_u32 v217, v219, 3, v217
    v_add_u32 v217, s70, v217
    v_xor_b32 v218, 64, v217
    s_and_b32 s68, s2, 7
    s_cmp_ge_u32 s68, 8
    s_cselect_b32 s94, 8, 0
    s_sub_u32 s68, s68, s94
    s_lshl_b32 s94, s68, 12
    s_add_u32 s68, s68, 1
    s_cmp_ge_u32 s68, 8
    s_cselect_b32 s95, 8, 0
    s_sub_u32 s68, s68, s95
    s_lshl_b32 s95, s68, 12
    s_add_u32 s68, s68, 1
    s_cmp_ge_u32 s68, 8
    s_cselect_b32 s96, 8, 0
    s_sub_u32 s68, s68, s96
    s_lshl_b32 s96, s68, 12
    s_add_u32 s68, s68, 1
    s_cmp_ge_u32 s68, 8
    s_cselect_b32 s97, 8, 0
    s_sub_u32 s68, s68, s97
    s_lshl_b32 s97, s68, 12
    s_add_u32 s68, s68, 1
    s_cmp_ge_u32 s68, 8
    s_cselect_b32 s98, 8, 0
    s_sub_u32 s68, s68, s98
    s_lshl_b32 s98, s68, 12
    s_add_u32 s68, s68, 1
    s_cmp_ge_u32 s68, 8
    s_cselect_b32 s99, 8, 0
    s_sub_u32 s68, s68, s99
    s_lshl_b32 s99, s68, 12
    s_add_u32 s68, s68, 1
    s_cmp_ge_u32 s68, 8
    s_cselect_b32 s100, 8, 0
    s_sub_u32 s68, s68, s100
    s_lshl_b32 s100, s68, 12
    s_add_u32 s68, s68, 1
    s_cmp_ge_u32 s68, 8
    s_cselect_b32 s101, 8, 0
    s_sub_u32 s68, s68, s101
    s_lshl_b32 s101, s68, 12
    s_lshl_b32 s80, s48, 2
    s_add_u32 s80, s80, s3
    s_lshl_b32 s80, s80, 11
    s_lshr_b32 s79, s49, 2
    s_lshl_b32 s79, s79, 7
    s_add_u32 s80, s80, s79
    s_and_b32 s79, s49, 3
    s_lshl_b32 s79, s79, 2
    s_add_u32 s80, s80, s79
    s_add_u32 s80, s80, 0x588000
    s_lshl_b32 s83, s67, 1
    s_lshr_b32 s79, s3, 1
    s_add_u32 s83, s83, s79
    s_lshl_b32 s83, s83, 11
    s_add_u32 s83, s83, 0x588000
    v_lshrrev_b32 v10, 2, v2
    v_lshlrev_b32 v10, 7, v10
    v_and_b32 v219, 3, v2
    v_lshl_add_u32 v10, v219, 2, v10
    s_lshl_b32 s84, s64, 12
    s_lshl_b32 s85, s84, 1
    s_add_u32 s85, s85, 0x5b0000
    s_add_u32 s84, s84, 0x5a8000
    s_lshl_b32 s81, s67, 5
    s_add_u32 s81, s81, s3
    s_lshl_b32 s81, s81, 2
    s_add_u32 s81, s81, s84
    s_lshl_b32 s79, s3, 10
    s_add_u32 s84, s84, s79
    v_bfe_u32 v11, v1, 2, 3
    v_min_u32 v12, 6, v11
    v_and_b32 v219, 3, v1
    v_lshlrev_b32 v219, 2, v219
    v_lshl_add_u32 v11, v11, 7, v219
    v_lshl_add_u32 v12, v12, 7, v219
    s_lshl_b32 s82, s65, 5
    s_add_u32 s82, s82, s3
    s_lshl_b32 s82, s82, 2
    s_add_u32 s82, s82, s85
    s_mul_i32 s79, s3, 896
    s_add_u32 s85, s85, s79
    v_mov_b32 v9, 0
    v_lshlrev_b32 v124, 9, v3
    v_bfe_u32 v237, v1, 2, 2
    v_lshl_add_u32 v124, v237, 6, v124
    v_and_b32 v237, 3, v1
    v_lshl_add_u32 v124, v237, 3, v124
    v_and_b32 v237, 1, v3
    v_lshlrev_b32 v237, 5, v237
    v_add_u32 v124, v124, v237
    v_add_u32 v124, 12288, v124
    v_xor_b32 v125, 32, v124
    s_and_b32 s53, s3, 1
    s_lshl_b32 s53, s53, 5
    v_xor_b32 v127, s53, v124
    s_lshr_b32 s53, s3, 1
    s_lshl_b32 s53, s53, 11
    s_add_u32 s53, s53, 2048
    v_add_u32 v126, s53, v127
    v_lshrrev_b32 v237, 1, v2
    v_xor_b32 v237, v237, v3
    v_lshlrev_b32 v237, 4, v237
    v_lshl_add_u32 v237, v2, 7, v237
    v_add_u32 v130, 61440, v237
    v_xor_b32 v131, 64, v130
    v_add_u32 v128, s52, v237
    v_xor_b32 v129, 64, v128
    v_lshlrev_b32 v237, 2, v3
    v_sub_u32 v237, v2, v237
    v_mov_b32 v239, 0xf149f2ca
    v_add_u32 v238, 16, v237
    v_and_b32 v238, 0xfffffff1, v238
    v_cmp_eq_u32 vcc, 0, v238
    s_nop 1
    v_cndmask_b32 v240, v239, 0, vcc
    v_add_u32 v238, 15, v237
    v_and_b32 v238, 0xfffffff1, v238
    v_cmp_eq_u32 vcc, 0, v238
    s_nop 1
    v_cndmask_b32 v241, v239, 0, vcc
    v_add_u32 v238, 14, v237
    v_and_b32 v238, 0xfffffff1, v238
    v_cmp_eq_u32 vcc, 0, v238
    s_nop 1
    v_cndmask_b32 v242, v239, 0, vcc
    v_add_u32 v238, 13, v237
    v_and_b32 v238, 0xfffffff1, v238
    v_cmp_eq_u32 vcc, 0, v238
    s_nop 1
    v_cndmask_b32 v243, v239, 0, vcc
    v_add_u32 v238, 0, v237
    v_and_b32 v238, 0xfffffff1, v238
    v_cmp_eq_u32 vcc, 0, v238
    s_nop 1
    v_cndmask_b32 v244, v239, 0, vcc
    v_add_u32 v238, -1, v237
    v_and_b32 v238, 0xfffffff1, v238
    v_cmp_eq_u32 vcc, 0, v238
    s_nop 1
    v_cndmask_b32 v245, v239, 0, vcc
    v_add_u32 v238, -2, v237
    v_and_b32 v238, 0xfffffff1, v238
    v_cmp_eq_u32 vcc, 0, v238
    s_nop 1
    v_cndmask_b32 v246, v239, 0, vcc
    v_add_u32 v238, -3, v237
    v_and_b32 v238, 0xfffffff1, v238
    v_cmp_eq_u32 vcc, 0, v238
    s_nop 1
    v_cndmask_b32 v247, v239, 0, vcc
    s_or_b32 s53, s48, s3
    s_cmp_eq_u32 s53, 0
    s_cselect_b64 vcc, -1, 0
    v_cndmask_b32 v248, v240, v239, vcc
    v_cndmask_b32 v249, v241, v239, vcc
    v_cndmask_b32 v250, v242, v239, vcc
    v_cndmask_b32 v251, v243, v239, vcc
    v_mov_b32 v40, s5
    v_mov_b32 v41, s5
    v_mov_b32 v42, s5
    v_mov_b32 v43, s5
    s_mov_b32 s88, 0x22222222
    s_mov_b32 s89, 0x22222222
    s_mov_b32 s90, 0x44444444
    s_mov_b32 s91, 0x44444444
    s_mov_b32 s92, 0x88888888
    s_mov_b32 s93, 0x88888888
    v_lshlrev_b32 v72, 4, v3
    s_lshl_b32 s53, s3, 6
    v_add_u32 v73, s53, v72
    s_and_b32 s53, s53, 64
    v_add_u32 v74, s53, v72
    s_mul_i32 s53, s3, 384
    v_lshl_add_u32 v75, v2, 2, s53
    v_add_u32 v76, s53, v72
    s_and_b32 s53, s3, 1
    s_lshl_b32 s53, s53, 3
    v_add_u32 v80, s53, v4
    v_lshrrev_b32 v81, 2, v2
    v_lshlrev_b32 v81, 8, v81
    v_lshl_add_u32 v81, v3, 6, v81
    v_and_b32 v82, 3, v2
    v_lshl_add_u32 v81, v82, 1, v81
    v_add_u32 v81, s53, v81
    v_add_u32 v81, 1024, v81
    s_cmp_lt_u32 s3, 2
    s_cselect_b64 vcc, -1, 0
    s_cselect_b32 s53, 2, 16
    v_cndmask_b32 v80, v81, v80, vcc
    v_add_u32 v81, s53, v80
    v_add_u32 v82, s53, v81
    v_add_u32 v83, s53, v82
    v_lshlrev_b32 v77, 2, v2
    s_lshl_b32 s53, s3, 11
    v_add_u32 v78, s53, v4
    s_lshl_b32 s62, s48, 3
    s_lshl_b32 s63, s3, 1
    s_add_u32 s62, s62, s63
    s_lshl_b32 s62, s62, 4
    s_add_u32 s62, s62, s49
    s_lshl_b32 s62, s62, 10
    s_add_u32 s63, s62, 16384
    s_add_u32 m0, s51, 24576
    s_mov_b32 s73, 172032
    buffer_load_dwordx4 v123, s[12:15], s73 offen lds
    s_add_u32 m0, s51, 26624
    s_mov_b32 s73, 172928
    buffer_load_dwordx4 v123, s[12:15], s73 offen lds
    s_add_u32 m0, s51, 28672
    s_mov_b32 s73, 173824
    buffer_load_dwordx4 v123, s[12:15], s73 offen lds
    s_add_u32 m0, s52, 18432
    s_mov_b32 s73, 128
    buffer_load_dwordx4 v120, s[8:11], s73 offen lds
    s_add_u32 m0, s52, 19456
    s_mov_b32 s73, 128
    buffer_load_dwordx4 v121, s[8:11], s73 offen lds
    s_add_u32 m0, s52, 20480
    s_mov_b32 s73, 14464
    buffer_load_dwordx4 v120, s[8:11], s73 offen lds
    s_add_u32 m0, s52, 21504
    s_mov_b32 s73, 14464
    buffer_load_dwordx4 v121, s[8:11], s73 offen lds
    s_add_u32 m0, s7, 79872
    s_mov_b32 s73, 128
    s_mov_b64 exec, s[54:55]
    buffer_load_dwordx4 v122, s[8:11], s73 offen lds
    s_mov_b64 exec, -1
    s_waitcnt vmcnt(11)
    s_waitcnt lgkmcnt(0)
    s_barrier
    ds_read_b128 v[16:19], v128 offset:36864
    ds_read_b128 v[20:23], v128 offset:38912
    ds_read_b128 v[24:27], v130 offset:36864
    ds_read_b64_tr_b16 v[88:89], v124 offset:0
    ds_read_b64_tr_b16 v[90:91], v124 offset:256
    ds_read_b64_tr_b16 v[92:93], v125 offset:0
    ds_read_b64_tr_b16 v[94:95], v125 offset:256
    ds_read_b64_tr_b16 v[96:97], v124 offset:2048
    ds_read_b64_tr_b16 v[98:99], v124 offset:2304
    ds_read_b64_tr_b16 v[100:101], v125 offset:2048
    ds_read_b64_tr_b16 v[102:103], v125 offset:2304
    ds_read_b64_tr_b16 v[104:105], v124 offset:4096
    ds_read_b64_tr_b16 v[106:107], v124 offset:4352
    ds_read_b64_tr_b16 v[108:109], v125 offset:4096
    ds_read_b64_tr_b16 v[110:111], v125 offset:4352
    ds_read_b64_tr_b16 v[112:113], v126 offset:0
    ds_read_b64_tr_b16 v[114:115], v126 offset:256
    ds_read_b64_tr_b16 v[116:117], v127 offset:0
    ds_read_b64_tr_b16 v[118:119], v127 offset:256
    s_waitcnt lgkmcnt(8)
    v_mfma_f32_16x16x32_bf16 v[136:139], v[88:91], v[16:19], 0
    ds_read_b128 v[28:31], v129 offset:36864
    v_mfma_f32_16x16x32_bf16 v[160:163], v[88:91], v[20:23], 0
    ds_read_b128 v[32:35], v129 offset:38912
    v_mfma_f32_16x16x32_bf16 v[140:143], v[92:95], v[16:19], 0
    ds_read_b128 v[36:39], v131 offset:36864
    v_mfma_f32_16x16x32_bf16 v[164:167], v[92:95], v[20:23], 0
    ds_read_b64_tr_b16 v[88:89], v124 offset:6144
    v_mfma_f32_16x16x32_bf16 v[144:147], v[96:99], v[16:19], 0
    ds_read_b64_tr_b16 v[90:91], v124 offset:6400
    s_add_u32 m0, s51, 36864
    s_mov_b32 s73, 344064
    buffer_load_dwordx4 v123, s[12:15], s73 offen lds
    v_mfma_f32_16x16x32_bf16 v[168:171], v[96:99], v[20:23], 0
    ds_read_b64_tr_b16 v[92:93], v125 offset:6144
    v_mfma_f32_16x16x32_bf16 v[148:151], v[100:103], v[16:19], 0
    ds_read_b64_tr_b16 v[94:95], v125 offset:6400
    v_mfma_f32_16x16x32_bf16 v[172:175], v[100:103], v[20:23], 0
    ds_read_b64_tr_b16 v[96:97], v124 offset:8192
    s_waitcnt lgkmcnt(8)
    v_mfma_f32_16x16x32_bf16 v[152:155], v[16:19], v[104:107], 0
    ds_read_b64_tr_b16 v[98:99], v124 offset:8448
    v_mfma_f32_16x16x32_bf16 v[176:179], v[20:23], v[104:107], 0
    ds_read_b64_tr_b16 v[100:101], v125 offset:8192
    s_add_u32 m0, s51, 38912
    s_mov_b32 s73, 344960
    buffer_load_dwordx4 v123, s[12:15], s73 offen lds
    v_mfma_f32_16x16x32_bf16 v[156:159], v[16:19], v[108:111], 0
    ds_read_b64_tr_b16 v[102:103], v125 offset:8448
    v_mfma_f32_16x16x32_bf16 v[180:183], v[20:23], v[108:111], 0
    ds_read_b64_tr_b16 v[104:105], v124 offset:10240
    v_mfma_f32_16x16x32_bf16 v[184:187], v[112:115], v[24:27], 0
    ds_read_b64_tr_b16 v[106:107], v124 offset:10496
    v_mfma_f32_16x16x32_bf16 v[188:191], v[116:119], v[24:27], 0
    ds_read_b64_tr_b16 v[108:109], v125 offset:10240
    v_mfma_f32_16x16x32_bf16 v[48:51], v[16:19], v[16:19], 0
    ds_read_b64_tr_b16 v[110:111], v125 offset:10496
    s_add_u32 m0, s51, 40960
    s_mov_b32 s73, 345856
    buffer_load_dwordx4 v123, s[12:15], s73 offen lds
    v_mfma_f32_16x16x32_bf16 v[52:55], v[20:23], v[20:23], 0
    ds_read_b64_tr_b16 v[112:113], v126 offset:6144
    v_mfma_f32_16x16x32_bf16 v[56:59], v[24:27], v[24:27], 0
    ds_read_b64_tr_b16 v[114:115], v126 offset:6400
    v_mfma_f32_16x16x32_bf16 v[60:63], v[40:43], v[16:19], 0
    ds_read_b64_tr_b16 v[116:117], v127 offset:6144
    v_mfma_f32_16x16x32_bf16 v[64:67], v[40:43], v[20:23], 0
    ds_read_b64_tr_b16 v[118:119], v127 offset:6400
    v_mfma_f32_16x16x32_bf16 v[68:71], v[40:43], v[24:27], 0
    s_add_u32 m0, s52, 0
    s_mov_b32 s73, 256
    buffer_load_dwordx4 v120, s[8:11], s73 offen lds
    s_add_u32 m0, s52, 1024
    s_mov_b32 s73, 256
    buffer_load_dwordx4 v121, s[8:11], s73 offen lds
    s_add_u32 m0, s52, 2048
    s_mov_b32 s73, 14592
    buffer_load_dwordx4 v120, s[8:11], s73 offen lds
    s_add_u32 m0, s52, 3072
    s_mov_b32 s73, 14592
    buffer_load_dwordx4 v121, s[8:11], s73 offen lds
    s_add_u32 m0, s7, 61440
    s_mov_b32 s73, 256
    s_mov_b64 exec, s[54:55]
    buffer_load_dwordx4 v122, s[8:11], s73 offen lds
    s_mov_b64 exec, -1
    s_waitcnt vmcnt(8)
    s_barrier
    s_waitcnt lgkmcnt(8)
    v_mfma_f32_16x16x32_bf16 v[136:139], v[88:91], v[28:31], v[136:139]
    ds_read_b128 v[16:19], v128 offset:18432
    v_mfma_f32_16x16x32_bf16 v[160:163], v[88:91], v[32:35], v[160:163]
    ds_read_b128 v[20:23], v128 offset:20480
    v_mfma_f32_16x16x32_bf16 v[140:143], v[92:95], v[28:31], v[140:143]
    ds_read_b128 v[24:27], v130 offset:18432
    v_mfma_f32_16x16x32_bf16 v[164:167], v[92:95], v[32:35], v[164:167]
    ds_read_b64_tr_b16 v[88:89], v124 offset:12288
    v_mfma_f32_16x16x32_bf16 v[144:147], v[96:99], v[28:31], v[144:147]
    ds_read_b64_tr_b16 v[90:91], v124 offset:12544
    s_add_u32 m0, s51, 49152
    s_mov_b32 s73, 516096
    buffer_load_dwordx4 v123, s[12:15], s73 offen lds
    v_mfma_f32_16x16x32_bf16 v[168:171], v[96:99], v[32:35], v[168:171]
    ds_read_b64_tr_b16 v[92:93], v125 offset:12288
    v_mfma_f32_16x16x32_bf16 v[148:151], v[100:103], v[28:31], v[148:151]
    ds_read_b64_tr_b16 v[94:95], v125 offset:12544
    v_mfma_f32_16x16x32_bf16 v[172:175], v[100:103], v[32:35], v[172:175]
    ds_read_b64_tr_b16 v[96:97], v124 offset:14336
    s_waitcnt lgkmcnt(8)
    v_mfma_f32_16x16x32_bf16 v[152:155], v[28:31], v[104:107], v[152:155]
    ds_read_b64_tr_b16 v[98:99], v124 offset:14592
    v_mfma_f32_16x16x32_bf16 v[176:179], v[32:35], v[104:107], v[176:179]
    ds_read_b64_tr_b16 v[100:101], v125 offset:14336
    s_add_u32 m0, s51, 51200
    s_mov_b32 s73, 516992
    buffer_load_dwordx4 v123, s[12:15], s73 offen lds
    v_mfma_f32_16x16x32_bf16 v[156:159], v[28:31], v[108:111], v[156:159]
    ds_read_b64_tr_b16 v[102:103], v125 offset:14592
    v_mfma_f32_16x16x32_bf16 v[180:183], v[32:35], v[108:111], v[180:183]
    ds_read_b64_tr_b16 v[104:105], v124 offset:16384
    v_mfma_f32_16x16x32_bf16 v[184:187], v[112:115], v[36:39], v[184:187]
    ds_read_b64_tr_b16 v[106:107], v124 offset:16640
    v_mfma_f32_16x16x32_bf16 v[188:191], v[116:119], v[36:39], v[188:191]
    ds_read_b64_tr_b16 v[108:109], v125 offset:16384
    v_mfma_f32_16x16x32_bf16 v[48:51], v[28:31], v[28:31], v[48:51]
    ds_read_b64_tr_b16 v[110:111], v125 offset:16640
    s_add_u32 m0, s51, 53248
    s_mov_b32 s73, 517888
    buffer_load_dwordx4 v123, s[12:15], s73 offen lds
    v_mfma_f32_16x16x32_bf16 v[52:55], v[32:35], v[32:35], v[52:55]
    ds_read_b64_tr_b16 v[112:113], v126 offset:12288
    v_mfma_f32_16x16x32_bf16 v[56:59], v[36:39], v[36:39], v[56:59]
    ds_read_b64_tr_b16 v[114:115], v126 offset:12544
    v_mfma_f32_16x16x32_bf16 v[60:63], v[40:43], v[28:31], v[60:63]
    ds_read_b64_tr_b16 v[116:117], v127 offset:12288
    v_mfma_f32_16x16x32_bf16 v[64:67], v[40:43], v[32:35], v[64:67]
    ds_read_b64_tr_b16 v[118:119], v127 offset:12544
    v_mfma_f32_16x16x32_bf16 v[68:71], v[40:43], v[36:39], v[68:71]
    s_add_u32 m0, s52, 55296
    s_mov_b32 s73, 384
    buffer_load_dwordx4 v120, s[8:11], s73 offen lds
    s_waitcnt lgkmcnt(8)
    v_mfma_f32_16x16x32_bf16 v[136:139], v[88:91], v[16:19], v[136:139]
    ds_read_b128 v[28:31], v129 offset:18432
    v_mfma_f32_16x16x32_bf16 v[160:163], v[88:91], v[20:23], v[160:163]
    ds_read_b128 v[32:35], v129 offset:20480
    v_mfma_f32_16x16x32_bf16 v[140:143], v[92:95], v[16:19], v[140:143]
    ds_read_b128 v[36:39], v131 offset:18432
    v_mfma_f32_16x16x32_bf16 v[164:167], v[92:95], v[20:23], v[164:167]
    ds_read_b64_tr_b16 v[88:89], v124 offset:18432
    v_mfma_f32_16x16x32_bf16 v[144:147], v[96:99], v[16:19], v[144:147]
    ds_read_b64_tr_b16 v[90:91], v124 offset:18688
    s_add_u32 m0, s52, 56320
    s_mov_b32 s73, 384
    buffer_load_dwordx4 v121, s[8:11], s73 offen lds
    v_mfma_f32_16x16x32_bf16 v[168:171], v[96:99], v[20:23], v[168:171]
    ds_read_b64_tr_b16 v[92:93], v125 offset:18432
    v_mfma_f32_16x16x32_bf16 v[148:151], v[100:103], v[16:19], v[148:151]
    ds_read_b64_tr_b16 v[94:95], v125 offset:18688
    v_mfma_f32_16x16x32_bf16 v[172:175], v[100:103], v[20:23], v[172:175]
    ds_read_b64_tr_b16 v[96:97], v124 offset:20480
    s_waitcnt lgkmcnt(8)
    v_mfma_f32_16x16x32_bf16 v[152:155], v[16:19], v[104:107], v[152:155]
    ds_read_b64_tr_b16 v[98:99], v124 offset:20736
    v_mfma_f32_16x16x32_bf16 v[176:179], v[20:23], v[104:107], v[176:179]
    ds_read_b64_tr_b16 v[100:101], v125 offset:20480
    s_add_u32 m0, s52, 57344
    s_mov_b32 s73, 14720
    buffer_load_dwordx4 v120, s[8:11], s73 offen lds
    v_mfma_f32_16x16x32_bf16 v[156:159], v[16:19], v[108:111], v[156:159]
    ds_read_b64_tr_b16 v[102:103], v125 offset:20736
    v_mfma_f32_16x16x32_bf16 v[180:183], v[20:23], v[108:111], v[180:183]
    ds_read_b64_tr_b16 v[104:105], v124 offset:22528
    v_mfma_f32_16x16x32_bf16 v[184:187], v[112:115], v[24:27], v[184:187]
    ds_read_b64_tr_b16 v[106:107], v124 offset:22784
    v_mfma_f32_16x16x32_bf16 v[188:191], v[116:119], v[24:27], v[188:191]
    ds_read_b64_tr_b16 v[108:109], v125 offset:22528
    v_mfma_f32_16x16x32_bf16 v[48:51], v[16:19], v[16:19], v[48:51]
    ds_read_b64_tr_b16 v[110:111], v125 offset:22784
    s_add_u32 m0, s52, 58368
    s_mov_b32 s73, 14720
    buffer_load_dwordx4 v121, s[8:11], s73 offen lds
    v_mfma_f32_16x16x32_bf16 v[52:55], v[20:23], v[20:23], v[52:55]
    ds_read_b64_tr_b16 v[112:113], v126 offset:18432
    v_mfma_f32_16x16x32_bf16 v[56:59], v[24:27], v[24:27], v[56:59]
    ds_read_b64_tr_b16 v[114:115], v126 offset:18688
    v_mfma_f32_16x16x32_bf16 v[60:63], v[40:43], v[16:19], v[60:63]
    ds_read_b64_tr_b16 v[116:117], v127 offset:18432
    v_mfma_f32_16x16x32_bf16 v[64:67], v[40:43], v[20:23], v[64:67]
    ds_read_b64_tr_b16 v[118:119], v127 offset:18688
    v_mfma_f32_16x16x32_bf16 v[68:71], v[40:43], v[24:27], v[68:71]
    s_add_u32 m0, s7, 116736
    s_mov_b32 s73, 384
    s_mov_b64 exec, s[54:55]
    buffer_load_dwordx4 v122, s[8:11], s73 offen lds
    s_mov_b64 exec, -1
    s_waitcnt vmcnt(8)
    s_barrier
    s_waitcnt lgkmcnt(8)
    v_mfma_f32_16x16x32_bf16 v[136:139], v[88:91], v[28:31], v[136:139]
    ds_read_b128 v[16:19], v128 offset:0
    v_mfma_f32_16x16x32_bf16 v[160:163], v[88:91], v[32:35], v[160:163]
    ds_read_b128 v[20:23], v128 offset:2048
    v_mfma_f32_16x16x32_bf16 v[140:143], v[92:95], v[28:31], v[140:143]
    ds_read_b128 v[24:27], v130 offset:0
    v_mfma_f32_16x16x32_bf16 v[164:167], v[92:95], v[32:35], v[164:167]
    ds_read_b64_tr_b16 v[88:89], v124 offset:24576
    v_mfma_f32_16x16x32_bf16 v[144:147], v[96:99], v[28:31], v[144:147]
    ds_read_b64_tr_b16 v[90:91], v124 offset:24832
    s_add_u32 m0, s51, 12288
    s_mov_b32 s73, 688128
    buffer_load_dwordx4 v123, s[12:15], s73 offen lds
    v_mfma_f32_16x16x32_bf16 v[168:171], v[96:99], v[32:35], v[168:171]
    ds_read_b64_tr_b16 v[92:93], v125 offset:24576
    v_mfma_f32_16x16x32_bf16 v[148:151], v[100:103], v[28:31], v[148:151]
    ds_read_b64_tr_b16 v[94:95], v125 offset:24832
    v_mfma_f32_16x16x32_bf16 v[172:175], v[100:103], v[32:35], v[172:175]
    ds_read_b64_tr_b16 v[96:97], v124 offset:26624
    s_waitcnt lgkmcnt(8)
    v_mfma_f32_16x16x32_bf16 v[152:155], v[28:31], v[104:107], v[152:155]
    ds_read_b64_tr_b16 v[98:99], v124 offset:26880
    v_mfma_f32_16x16x32_bf16 v[176:179], v[32:35], v[104:107], v[176:179]
    ds_read_b64_tr_b16 v[100:101], v125 offset:26624
    s_add_u32 m0, s51, 14336
    s_mov_b32 s73, 689024
    buffer_load_dwordx4 v123, s[12:15], s73 offen lds
    v_mfma_f32_16x16x32_bf16 v[156:159], v[28:31], v[108:111], v[156:159]
    ds_read_b64_tr_b16 v[102:103], v125 offset:26880
    v_mfma_f32_16x16x32_bf16 v[180:183], v[32:35], v[108:111], v[180:183]
    ds_read_b64_tr_b16 v[104:105], v124 offset:28672
    v_mfma_f32_16x16x32_bf16 v[184:187], v[112:115], v[36:39], v[184:187]
    ds_read_b64_tr_b16 v[106:107], v124 offset:28928
    v_mfma_f32_16x16x32_bf16 v[188:191], v[116:119], v[36:39], v[188:191]
    ds_read_b64_tr_b16 v[108:109], v125 offset:28672
    v_mfma_f32_16x16x32_bf16 v[48:51], v[28:31], v[28:31], v[48:51]
    ds_read_b64_tr_b16 v[110:111], v125 offset:28928
    s_add_u32 m0, s51, 16384
    s_mov_b32 s73, 689920
    buffer_load_dwordx4 v123, s[12:15], s73 offen lds
    v_mfma_f32_16x16x32_bf16 v[52:55], v[32:35], v[32:35], v[52:55]
    ds_read_b64_tr_b16 v[112:113], v126 offset:24576
    v_mfma_f32_16x16x32_bf16 v[56:59], v[36:39], v[36:39], v[56:59]
    ds_read_b64_tr_b16 v[114:115], v126 offset:24832
    v_mfma_f32_16x16x32_bf16 v[60:63], v[40:43], v[28:31], v[60:63]
    ds_read_b64_tr_b16 v[116:117], v127 offset:24576
    v_mfma_f32_16x16x32_bf16 v[64:67], v[40:43], v[32:35], v[64:67]
    ds_read_b64_tr_b16 v[118:119], v127 offset:24832
    v_mfma_f32_16x16x32_bf16 v[68:71], v[40:43], v[36:39], v[68:71]
    s_add_u32 m0, s52, 36864
    s_mov_b32 s73, 512
    buffer_load_dwordx4 v120, s[8:11], s73 offen lds
    s_waitcnt lgkmcnt(8)
    v_mfma_f32_16x16x32_bf16 v[136:139], v[88:91], v[16:19], v[136:139]
    ds_read_b128 v[28:31], v129 offset:0
    v_mfma_f32_16x16x32_bf16 v[160:163], v[88:91], v[20:23], v[160:163]
    ds_read_b128 v[32:35], v129 offset:2048
    v_mfma_f32_16x16x32_bf16 v[140:143], v[92:95], v[16:19], v[140:143]
    ds_read_b128 v[36:39], v131 offset:0
    v_mfma_f32_16x16x32_bf16 v[164:167], v[92:95], v[20:23], v[164:167]
    ds_read_b64_tr_b16 v[88:89], v124 offset:30720
    v_mfma_f32_16x16x32_bf16 v[144:147], v[96:99], v[16:19], v[144:147]
    ds_read_b64_tr_b16 v[90:91], v124 offset:30976
    s_add_u32 m0, s52, 37888
    s_mov_b32 s73, 512
    buffer_load_dwordx4 v121, s[8:11], s73 offen lds
    v_mfma_f32_16x16x32_bf16 v[168:171], v[96:99], v[20:23], v[168:171]
    ds_read_b64_tr_b16 v[92:93], v125 offset:30720
    v_mfma_f32_16x16x32_bf16 v[148:151], v[100:103], v[16:19], v[148:151]
    ds_read_b64_tr_b16 v[94:95], v125 offset:30976
    v_mfma_f32_16x16x32_bf16 v[172:175], v[100:103], v[20:23], v[172:175]
    ds_read_b64_tr_b16 v[96:97], v124 offset:32768
    s_waitcnt lgkmcnt(8)
    v_mfma_f32_16x16x32_bf16 v[152:155], v[16:19], v[104:107], v[152:155]
    ds_read_b64_tr_b16 v[98:99], v124 offset:33024
    v_mfma_f32_16x16x32_bf16 v[176:179], v[20:23], v[104:107], v[176:179]
    ds_read_b64_tr_b16 v[100:101], v125 offset:32768
    s_add_u32 m0, s52, 38912
    s_mov_b32 s73, 14848
    buffer_load_dwordx4 v120, s[8:11], s73 offen lds
    v_mfma_f32_16x16x32_bf16 v[156:159], v[16:19], v[108:111], v[156:159]
    ds_read_b64_tr_b16 v[102:103], v125 offset:33024
    v_mfma_f32_16x16x32_bf16 v[180:183], v[20:23], v[108:111], v[180:183]
    ds_read_b64_tr_b16 v[104:105], v124 offset:34816
    v_mfma_f32_16x16x32_bf16 v[184:187], v[112:115], v[24:27], v[184:187]
    ds_read_b64_tr_b16 v[106:107], v124 offset:35072
    v_mfma_f32_16x16x32_bf16 v[188:191], v[116:119], v[24:27], v[188:191]
    ds_read_b64_tr_b16 v[108:109], v125 offset:34816
    v_mfma_f32_16x16x32_bf16 v[48:51], v[16:19], v[16:19], v[48:51]
    ds_read_b64_tr_b16 v[110:111], v125 offset:35072
    s_add_u32 m0, s52, 39936
    s_mov_b32 s73, 14848
    buffer_load_dwordx4 v121, s[8:11], s73 offen lds
    v_mfma_f32_16x16x32_bf16 v[52:55], v[20:23], v[20:23], v[52:55]
    ds_read_b64_tr_b16 v[112:113], v126 offset:30720
    v_mfma_f32_16x16x32_bf16 v[56:59], v[24:27], v[24:27], v[56:59]
    ds_read_b64_tr_b16 v[114:115], v126 offset:30976
    v_mfma_f32_16x16x32_bf16 v[60:63], v[40:43], v[16:19], v[60:63]
    ds_read_b64_tr_b16 v[116:117], v127 offset:30720
    v_mfma_f32_16x16x32_bf16 v[64:67], v[40:43], v[20:23], v[64:67]
    ds_read_b64_tr_b16 v[118:119], v127 offset:30976
    v_mfma_f32_16x16x32_bf16 v[68:71], v[40:43], v[24:27], v[68:71]
    s_add_u32 m0, s7, 98304
    s_mov_b32 s73, 512
    s_mov_b64 exec, s[54:55]
    buffer_load_dwordx4 v122, s[8:11], s73 offen lds
    s_mov_b64 exec, -1
    s_waitcnt vmcnt(8)
    s_barrier
    s_waitcnt lgkmcnt(8)
    v_mfma_f32_16x16x32_bf16 v[136:139], v[88:91], v[28:31], v[136:139]
    ds_read_b128 v[16:19], v128 offset:55296
    v_mfma_f32_16x16x32_bf16 v[160:163], v[88:91], v[32:35], v[160:163]
    ds_read_b128 v[20:23], v128 offset:57344
    v_mfma_f32_16x16x32_bf16 v[140:143], v[92:95], v[28:31], v[140:143]
    ds_read_b128 v[24:27], v130 offset:55296
    v_mfma_f32_16x16x32_bf16 v[164:167], v[92:95], v[32:35], v[164:167]
    ds_read_b64_tr_b16 v[88:89], v124 offset:36864
    v_mfma_f32_16x16x32_bf16 v[144:147], v[96:99], v[28:31], v[144:147]
    ds_read_b64_tr_b16 v[90:91], v124 offset:37120
    s_add_u32 m0, s51, 24576
    s_mov_b32 s73, 860160
    buffer_load_dwordx4 v123, s[12:15], s73 offen lds
    v_mfma_f32_16x16x32_bf16 v[168:171], v[96:99], v[32:35], v[168:171]
    ds_read_b64_tr_b16 v[92:93], v125 offset:36864
    v_mfma_f32_16x16x32_bf16 v[148:151], v[100:103], v[28:31], v[148:151]
    ds_read_b64_tr_b16 v[94:95], v125 offset:37120
    v_mfma_f32_16x16x32_bf16 v[172:175], v[100:103], v[32:35], v[172:175]
    ds_read_b64_tr_b16 v[96:97], v124 offset:38912
    s_waitcnt lgkmcnt(8)
    v_mfma_f32_16x16x32_bf16 v[152:155], v[28:31], v[104:107], v[152:155]
    ds_read_b64_tr_b16 v[98:99], v124 offset:39168
    v_mfma_f32_16x16x32_bf16 v[176:179], v[32:35], v[104:107], v[176:179]
    ds_read_b64_tr_b16 v[100:101], v125 offset:38912
    s_add_u32 m0, s51, 26624
    s_mov_b32 s73, 861056
    buffer_load_dwordx4 v123, s[12:15], s73 offen lds
    v_mfma_f32_16x16x32_bf16 v[156:159], v[28:31], v[108:111], v[156:159]
    ds_read_b64_tr_b16 v[102:103], v125 offset:39168
    v_mfma_f32_16x16x32_bf16 v[180:183], v[32:35], v[108:111], v[180:183]
    ds_read_b64_tr_b16 v[104:105], v124 offset:40960
    v_mfma_f32_16x16x32_bf16 v[184:187], v[112:115], v[36:39], v[184:187]
    ds_read_b64_tr_b16 v[106:107], v124 offset:41216
    v_mfma_f32_16x16x32_bf16 v[188:191], v[116:119], v[36:39], v[188:191]
    ds_read_b64_tr_b16 v[108:109], v125 offset:40960
    v_mfma_f32_16x16x32_bf16 v[48:51], v[28:31], v[28:31], v[48:51]
    ds_read_b64_tr_b16 v[110:111], v125 offset:41216
    s_add_u32 m0, s51, 28672
    s_mov_b32 s73, 861952
    buffer_load_dwordx4 v123, s[12:15], s73 offen lds
    v_mfma_f32_16x16x32_bf16 v[52:55], v[32:35], v[32:35], v[52:55]
    ds_read_b64_tr_b16 v[112:113], v126 offset:36864
    v_mfma_f32_16x16x32_bf16 v[56:59], v[36:39], v[36:39], v[56:59]
    ds_read_b64_tr_b16 v[114:115], v126 offset:37120
    v_mfma_f32_16x16x32_bf16 v[60:63], v[40:43], v[28:31], v[60:63]
    ds_read_b64_tr_b16 v[116:117], v127 offset:36864
    v_mfma_f32_16x16x32_bf16 v[64:67], v[40:43], v[32:35], v[64:67]
    ds_read_b64_tr_b16 v[118:119], v127 offset:37120
    v_mfma_f32_16x16x32_bf16 v[68:71], v[40:43], v[36:39], v[68:71]
    s_add_u32 m0, s52, 18432
    s_mov_b32 s73, 640
    buffer_load_dwordx4 v120, s[8:11], s73 offen lds
    s_waitcnt lgkmcnt(8)
    v_mfma_f32_16x16x32_bf16 v[136:139], v[88:91], v[16:19], v[136:139]
    ds_read_b128 v[28:31], v129 offset:55296
    v_mfma_f32_16x16x32_bf16 v[160:163], v[88:91], v[20:23], v[160:163]
    ds_read_b128 v[32:35], v129 offset:57344
    v_mfma_f32_16x16x32_bf16 v[140:143], v[92:95], v[16:19], v[140:143]
    ds_read_b128 v[36:39], v131 offset:55296
    v_mfma_f32_16x16x32_bf16 v[164:167], v[92:95], v[20:23], v[164:167]
    ds_read_b64_tr_b16 v[88:89], v124 offset:43008
    v_mfma_f32_16x16x32_bf16 v[144:147], v[96:99], v[16:19], v[144:147]
    ds_read_b64_tr_b16 v[90:91], v124 offset:43264
    s_add_u32 m0, s52, 19456
    s_mov_b32 s73, 640
    buffer_load_dwordx4 v121, s[8:11], s73 offen lds
    v_mfma_f32_16x16x32_bf16 v[168:171], v[96:99], v[20:23], v[168:171]
    ds_read_b64_tr_b16 v[92:93], v125 offset:43008
    v_mfma_f32_16x16x32_bf16 v[148:151], v[100:103], v[16:19], v[148:151]
    ds_read_b64_tr_b16 v[94:95], v125 offset:43264
    v_mfma_f32_16x16x32_bf16 v[172:175], v[100:103], v[20:23], v[172:175]
    ds_read_b64_tr_b16 v[96:97], v124 offset:45056
    s_waitcnt lgkmcnt(8)
    v_mfma_f32_16x16x32_bf16 v[152:155], v[16:19], v[104:107], v[152:155]
    ds_read_b64_tr_b16 v[98:99], v124 offset:45312
    v_mfma_f32_16x16x32_bf16 v[176:179], v[20:23], v[104:107], v[176:179]
    ds_read_b64_tr_b16 v[100:101], v125 offset:45056
    s_add_u32 m0, s52, 20480
    s_mov_b32 s73, 14976
    buffer_load_dwordx4 v120, s[8:11], s73 offen lds
    v_mfma_f32_16x16x32_bf16 v[156:159], v[16:19], v[108:111], v[156:159]
    ds_read_b64_tr_b16 v[102:103], v125 offset:45312
    v_mfma_f32_16x16x32_bf16 v[180:183], v[20:23], v[108:111], v[180:183]
    ds_read_b64_tr_b16 v[104:105], v124 offset:47104
    v_mfma_f32_16x16x32_bf16 v[184:187], v[112:115], v[24:27], v[184:187]
    ds_read_b64_tr_b16 v[106:107], v124 offset:47360
    v_mfma_f32_16x16x32_bf16 v[188:191], v[116:119], v[24:27], v[188:191]
    ds_read_b64_tr_b16 v[108:109], v125 offset:47104
    v_mfma_f32_16x16x32_bf16 v[48:51], v[16:19], v[16:19], v[48:51]
    ds_read_b64_tr_b16 v[110:111], v125 offset:47360
    s_add_u32 m0, s52, 21504
    s_mov_b32 s73, 14976
    buffer_load_dwordx4 v121, s[8:11], s73 offen lds
    v_mfma_f32_16x16x32_bf16 v[52:55], v[20:23], v[20:23], v[52:55]
    ds_read_b64_tr_b16 v[112:113], v126 offset:43008
    v_mfma_f32_16x16x32_bf16 v[56:59], v[24:27], v[24:27], v[56:59]
    ds_read_b64_tr_b16 v[114:115], v126 offset:43264
    v_mfma_f32_16x16x32_bf16 v[60:63], v[40:43], v[16:19], v[60:63]
    ds_read_b64_tr_b16 v[116:117], v127 offset:43008
    v_mfma_f32_16x16x32_bf16 v[64:67], v[40:43], v[20:23], v[64:67]
    ds_read_b64_tr_b16 v[118:119], v127 offset:43264
    v_mfma_f32_16x16x32_bf16 v[68:71], v[40:43], v[24:27], v[68:71]
    s_add_u32 m0, s7, 79872
    s_mov_b32 s73, 640
    s_mov_b64 exec, s[54:55]
    buffer_load_dwordx4 v122, s[8:11], s73 offen lds
    s_mov_b64 exec, -1
    s_waitcnt vmcnt(8)
    s_barrier
    s_waitcnt lgkmcnt(8)
    v_mfma_f32_16x16x32_bf16 v[136:139], v[88:91], v[28:31], v[136:139]
    ds_read_b128 v[16:19], v128 offset:36864
    v_mfma_f32_16x16x32_bf16 v[160:163], v[88:91], v[32:35], v[160:163]
    ds_read_b128 v[20:23], v128 offset:38912
    v_mfma_f32_16x16x32_bf16 v[140:143], v[92:95], v[28:31], v[140:143]
    ds_read_b128 v[24:27], v130 offset:36864
    v_mfma_f32_16x16x32_bf16 v[164:167], v[92:95], v[32:35], v[164:167]
    ds_read_b64_tr_b16 v[88:89], v124 offset:0
    v_mfma_f32_16x16x32_bf16 v[144:147], v[96:99], v[28:31], v[144:147]
    ds_read_b64_tr_b16 v[90:91], v124 offset:256
    s_add_u32 m0, s51, 36864
    s_mov_b32 s73, 1032192
    buffer_load_dwordx4 v123, s[12:15], s73 offen lds
    v_mfma_f32_16x16x32_bf16 v[168:171], v[96:99], v[32:35], v[168:171]
    ds_read_b64_tr_b16 v[92:93], v125 offset:0
    v_mfma_f32_16x16x32_bf16 v[148:151], v[100:103], v[28:31], v[148:151]
    ds_read_b64_tr_b16 v[94:95], v125 offset:256
    v_mfma_f32_16x16x32_bf16 v[172:175], v[100:103], v[32:35], v[172:175]
    ds_read_b64_tr_b16 v[96:97], v124 offset:2048
    s_waitcnt lgkmcnt(8)
    v_mfma_f32_16x16x32_bf16 v[152:155], v[28:31], v[104:107], v[152:155]
    ds_read_b64_tr_b16 v[98:99], v124 offset:2304
    v_mfma_f32_16x16x32_bf16 v[176:179], v[32:35], v[104:107], v[176:179]
    ds_read_b64_tr_b16 v[100:101], v125 offset:2048
    s_add_u32 m0, s51, 38912
    s_mov_b32 s73, 1033088
    buffer_load_dwordx4 v123, s[12:15], s73 offen lds
    v_mfma_f32_16x16x32_bf16 v[156:159], v[28:31], v[108:111], v[156:159]
    ds_read_b64_tr_b16 v[102:103], v125 offset:2304
    v_mfma_f32_16x16x32_bf16 v[180:183], v[32:35], v[108:111], v[180:183]
    ds_read_b64_tr_b16 v[104:105], v124 offset:4096
    v_mfma_f32_16x16x32_bf16 v[184:187], v[112:115], v[36:39], v[184:187]
    ds_read_b64_tr_b16 v[106:107], v124 offset:4352
    v_mfma_f32_16x16x32_bf16 v[188:191], v[116:119], v[36:39], v[188:191]
    ds_read_b64_tr_b16 v[108:109], v125 offset:4096
    v_mfma_f32_16x16x32_bf16 v[48:51], v[28:31], v[28:31], v[48:51]
    ds_read_b64_tr_b16 v[110:111], v125 offset:4352
    s_add_u32 m0, s51, 40960
    s_mov_b32 s73, 1033984
    buffer_load_dwordx4 v123, s[12:15], s73 offen lds
    v_mfma_f32_16x16x32_bf16 v[52:55], v[32:35], v[32:35], v[52:55]
    ds_read_b64_tr_b16 v[112:113], v126 offset:0
    v_mfma_f32_16x16x32_bf16 v[56:59], v[36:39], v[36:39], v[56:59]
    ds_read_b64_tr_b16 v[114:115], v126 offset:256
    v_mfma_f32_16x16x32_bf16 v[60:63], v[40:43], v[28:31], v[60:63]
    ds_read_b64_tr_b16 v[116:117], v127 offset:0
    v_mfma_f32_16x16x32_bf16 v[64:67], v[40:43], v[32:35], v[64:67]
    ds_read_b64_tr_b16 v[118:119], v127 offset:256
    v_mfma_f32_16x16x32_bf16 v[68:71], v[40:43], v[36:39], v[68:71]
    s_add_u32 m0, s52, 0
    s_mov_b32 s73, 768
    buffer_load_dwordx4 v120, s[8:11], s73 offen lds
    s_waitcnt lgkmcnt(8)
    v_mfma_f32_16x16x32_bf16 v[136:139], v[88:91], v[16:19], v[136:139]
    ds_read_b128 v[28:31], v129 offset:36864
    v_mfma_f32_16x16x32_bf16 v[160:163], v[88:91], v[20:23], v[160:163]
    ds_read_b128 v[32:35], v129 offset:38912
    v_mfma_f32_16x16x32_bf16 v[140:143], v[92:95], v[16:19], v[140:143]
    ds_read_b128 v[36:39], v131 offset:36864
    v_mfma_f32_16x16x32_bf16 v[164:167], v[92:95], v[20:23], v[164:167]
    ds_read_b64_tr_b16 v[88:89], v124 offset:6144
    v_mfma_f32_16x16x32_bf16 v[144:147], v[96:99], v[16:19], v[144:147]
    ds_read_b64_tr_b16 v[90:91], v124 offset:6400
    s_add_u32 m0, s52, 1024
    s_mov_b32 s73, 768
    buffer_load_dwordx4 v121, s[8:11], s73 offen lds
    v_mfma_f32_16x16x32_bf16 v[168:171], v[96:99], v[20:23], v[168:171]
    ds_read_b64_tr_b16 v[92:93], v125 offset:6144
    v_mfma_f32_16x16x32_bf16 v[148:151], v[100:103], v[16:19], v[148:151]
    ds_read_b64_tr_b16 v[94:95], v125 offset:6400
    v_mfma_f32_16x16x32_bf16 v[172:175], v[100:103], v[20:23], v[172:175]
    ds_read_b64_tr_b16 v[96:97], v124 offset:8192
    s_waitcnt lgkmcnt(8)
    v_mfma_f32_16x16x32_bf16 v[152:155], v[16:19], v[104:107], v[152:155]
    ds_read_b64_tr_b16 v[98:99], v124 offset:8448
    v_mfma_f32_16x16x32_bf16 v[176:179], v[20:23], v[104:107], v[176:179]
    ds_read_b64_tr_b16 v[100:101], v125 offset:8192
    s_add_u32 m0, s52, 2048
    s_mov_b32 s73, 15104
    buffer_load_dwordx4 v120, s[8:11], s73 offen lds
    v_mfma_f32_16x16x32_bf16 v[156:159], v[16:19], v[108:111], v[156:159]
    ds_read_b64_tr_b16 v[102:103], v125 offset:8448
    v_mfma_f32_16x16x32_bf16 v[180:183], v[20:23], v[108:111], v[180:183]
    ds_read_b64_tr_b16 v[104:105], v124 offset:10240
    v_mfma_f32_16x16x32_bf16 v[184:187], v[112:115], v[24:27], v[184:187]
    ds_read_b64_tr_b16 v[106:107], v124 offset:10496
    v_mfma_f32_16x16x32_bf16 v[188:191], v[116:119], v[24:27], v[188:191]
    ds_read_b64_tr_b16 v[108:109], v125 offset:10240
    v_mfma_f32_16x16x32_bf16 v[48:51], v[16:19], v[16:19], v[48:51]
    ds_read_b64_tr_b16 v[110:111], v125 offset:10496
    s_add_u32 m0, s52, 3072
    s_mov_b32 s73, 15104
    buffer_load_dwordx4 v121, s[8:11], s73 offen lds
    v_mfma_f32_16x16x32_bf16 v[52:55], v[20:23], v[20:23], v[52:55]
    ds_read_b64_tr_b16 v[112:113], v126 offset:6144
    v_mfma_f32_16x16x32_bf16 v[56:59], v[24:27], v[24:27], v[56:59]
    ds_read_b64_tr_b16 v[114:115], v126 offset:6400
    v_mfma_f32_16x16x32_bf16 v[60:63], v[40:43], v[16:19], v[60:63]
    ds_read_b64_tr_b16 v[116:117], v127 offset:6144
    v_mfma_f32_16x16x32_bf16 v[64:67], v[40:43], v[20:23], v[64:67]
    ds_read_b64_tr_b16 v[118:119], v127 offset:6400
    v_mfma_f32_16x16x32_bf16 v[68:71], v[40:43], v[24:27], v[68:71]
    s_add_u32 m0, s7, 61440
    s_mov_b32 s73, 768
    s_mov_b64 exec, s[54:55]
    buffer_load_dwordx4 v122, s[8:11], s73 offen lds
    s_mov_b64 exec, -1
    v_mov_b32 v7, 0
    buffer_load_dword v6, v7, s[44:47], 0 offen sc1
    s_lshr_b32 s68, s2, 3
    s_lshl_b32 s68, s68, 2
    s_add_u32 s68, s68, s3
    v_lshlrev_b32 v219, 7, v1
    s_mul_i32 s86, s68, 3200
    s_mov_b64 exec, 0x1ffffff
    buffer_load_dword v234, v219, s[16:19], s86 offen
    s_mov_b64 exec, -1
    v_lshrrev_b32 v219, 2, v1
    v_mul_u32_u24 v219, 3584, v219
    v_and_b32 v220, 3, v1
    v_lshl_add_u32 v219, v220, 7, v219
    s_mul_i32 s68, s68, 57344
    s_and_b32 s69, s2, 7
    s_mul_i32 s86, s69, 3
    s_add_u32 s86, s86, 4
    s_lshl_b32 s87, s69, 2
    s_min_u32 s86, s86, s87
    s_lshl_b32 s86, s86, 7
    s_add_u32 s86, s86, s68
    s_cmp_lt_u32 s69, 4
    s_cselect_b32 exec_lo, -1, 0x77777777
    s_cselect_b32 exec_hi, -1, 0x77777777
    buffer_load_dword v235, v219, s[20:23], s86 offen
    s_mov_b64 exec, -1
    s_waitcnt vmcnt(11)
    s_barrier
    s_waitcnt lgkmcnt(8)
    v_mfma_f32_16x16x32_bf16 v[136:139], v[88:91], v[28:31], v[136:139]
    ds_read_b128 v[16:19], v128 offset:18432
    v_mfma_f32_16x16x32_bf16 v[160:163], v[88:91], v[32:35], v[160:163]
    ds_read_b128 v[20:23], v128 offset:20480
    v_mfma_f32_16x16x32_bf16 v[140:143], v[92:95], v[28:31], v[140:143]
    ds_read_b128 v[24:27], v130 offset:18432
    v_mfma_f32_16x16x32_bf16 v[164:167], v[92:95], v[32:35], v[164:167]
    ds_read_b64_tr_b16 v[88:89], v124 offset:12288
    v_mfma_f32_16x16x32_bf16 v[144:147], v[96:99], v[28:31], v[144:147]
    ds_read_b64_tr_b16 v[90:91], v124 offset:12544
    v_mfma_f32_16x16x32_bf16 v[168:171], v[96:99], v[32:35], v[168:171]
    ds_read_b64_tr_b16 v[92:93], v125 offset:12288
    v_mfma_f32_16x16x32_bf16 v[148:151], v[100:103], v[28:31], v[148:151]
    ds_read_b64_tr_b16 v[94:95], v125 offset:12544
    v_mfma_f32_16x16x32_bf16 v[172:175], v[100:103], v[32:35], v[172:175]
    ds_read_b64_tr_b16 v[96:97], v124 offset:14336
    s_waitcnt lgkmcnt(8)
    v_mfma_f32_16x16x32_bf16 v[152:155], v[28:31], v[104:107], v[152:155]
    ds_read_b64_tr_b16 v[98:99], v124 offset:14592
    v_mfma_f32_16x16x32_bf16 v[176:179], v[32:35], v[104:107], v[176:179]
    ds_read_b64_tr_b16 v[100:101], v125 offset:14336
    v_mfma_f32_16x16x32_bf16 v[156:159], v[28:31], v[108:111], v[156:159]
    ds_read_b64_tr_b16 v[102:103], v125 offset:14592
    v_mfma_f32_16x16x32_bf16 v[180:183], v[32:35], v[108:111], v[180:183]
    ds_read_b64_tr_b16 v[104:105], v124 offset:16384
    v_mfma_f32_16x16x32_bf16 v[184:187], v[112:115], v[36:39], v[184:187]
    ds_read_b64_tr_b16 v[106:107], v124 offset:16640
    v_mfma_f32_16x16x32_bf16 v[188:191], v[116:119], v[36:39], v[188:191]
    ds_read_b64_tr_b16 v[108:109], v125 offset:16384
    v_mfma_f32_16x16x32_bf16 v[48:51], v[28:31], v[28:31], v[48:51]
    ds_read_b64_tr_b16 v[110:111], v125 offset:16640
    v_mfma_f32_16x16x32_bf16 v[52:55], v[32:35], v[32:35], v[52:55]
    ds_read_b64_tr_b16 v[112:113], v126 offset:12288
    v_mfma_f32_16x16x32_bf16 v[56:59], v[36:39], v[36:39], v[56:59]
    ds_read_b64_tr_b16 v[114:115], v126 offset:12544
    v_mfma_f32_16x16x32_bf16 v[60:63], v[40:43], v[28:31], v[60:63]
    ds_read_b64_tr_b16 v[116:117], v127 offset:12288
    v_mfma_f32_16x16x32_bf16 v[64:67], v[40:43], v[32:35], v[64:67]
    ds_read_b64_tr_b16 v[118:119], v127 offset:12544
    v_mfma_f32_16x16x32_bf16 v[68:71], v[40:43], v[36:39], v[68:71]
    s_waitcnt lgkmcnt(8)
    v_mfma_f32_16x16x32_bf16 v[136:139], v[88:91], v[16:19], v[136:139]
    ds_read_b128 v[28:31], v129 offset:18432
    v_mfma_f32_16x16x32_bf16 v[160:163], v[88:91], v[20:23], v[160:163]
    ds_read_b128 v[32:35], v129 offset:20480
    v_mfma_f32_16x16x32_bf16 v[140:143], v[92:95], v[16:19], v[140:143]
    ds_read_b128 v[36:39], v131 offset:18432
    v_mfma_f32_16x16x32_bf16 v[164:167], v[92:95], v[20:23], v[164:167]
    ds_read_b64_tr_b16 v[88:89], v124 offset:18432
    v_mfma_f32_16x16x32_bf16 v[144:147], v[96:99], v[16:19], v[144:147]
    ds_read_b64_tr_b16 v[90:91], v124 offset:18688
    v_mfma_f32_16x16x32_bf16 v[168:171], v[96:99], v[20:23], v[168:171]
    ds_read_b64_tr_b16 v[92:93], v125 offset:18432
    v_mfma_f32_16x16x32_bf16 v[148:151], v[100:103], v[16:19], v[148:151]
    ds_read_b64_tr_b16 v[94:95], v125 offset:18688
    v_mfma_f32_16x16x32_bf16 v[172:175], v[100:103], v[20:23], v[172:175]
    ds_read_b64_tr_b16 v[96:97], v124 offset:20480
    s_waitcnt lgkmcnt(8)
    v_mfma_f32_16x16x32_bf16 v[152:155], v[16:19], v[104:107], v[152:155]
    ds_read_b64_tr_b16 v[98:99], v124 offset:20736
    v_mfma_f32_16x16x32_bf16 v[176:179], v[20:23], v[104:107], v[176:179]
    ds_read_b64_tr_b16 v[100:101], v125 offset:20480
    v_mfma_f32_16x16x32_bf16 v[156:159], v[16:19], v[108:111], v[156:159]
    ds_read_b64_tr_b16 v[102:103], v125 offset:20736
    v_mfma_f32_16x16x32_bf16 v[180:183], v[20:23], v[108:111], v[180:183]
    ds_read_b64_tr_b16 v[104:105], v124 offset:22528
    v_mfma_f32_16x16x32_bf16 v[184:187], v[112:115], v[24:27], v[184:187]
    ds_read_b64_tr_b16 v[106:107], v124 offset:22784
    v_mfma_f32_16x16x32_bf16 v[188:191], v[116:119], v[24:27], v[188:191]
    ds_read_b64_tr_b16 v[108:109], v125 offset:22528
    v_mfma_f32_16x16x32_bf16 v[48:51], v[16:19], v[16:19], v[48:51]
    ds_read_b64_tr_b16 v[110:111], v125 offset:22784
    v_mfma_f32_16x16x32_bf16 v[52:55], v[20:23], v[20:23], v[52:55]
    ds_read_b64_tr_b16 v[112:113], v126 offset:18432
    v_mfma_f32_16x16x32_bf16 v[56:59], v[24:27], v[24:27], v[56:59]
    ds_read_b64_tr_b16 v[114:115], v126 offset:18688
    v_mfma_f32_16x16x32_bf16 v[60:63], v[40:43], v[16:19], v[60:63]
    ds_read_b64_tr_b16 v[116:117], v127 offset:18432
    v_mfma_f32_16x16x32_bf16 v[64:67], v[40:43], v[20:23], v[64:67]
    ds_read_b64_tr_b16 v[118:119], v127 offset:18688
    v_mfma_f32_16x16x32_bf16 v[68:71], v[40:43], v[24:27], v[68:71]
    s_waitcnt vmcnt(3)
    s_barrier
    s_waitcnt lgkmcnt(8)
    v_mfma_f32_16x16x32_bf16 v[136:139], v[88:91], v[28:31], v[136:139]
    ds_read_b128 v[16:19], v128 offset:0
    v_mfma_f32_16x16x32_bf16 v[160:163], v[88:91], v[32:35], v[160:163]
    ds_read_b128 v[20:23], v128 offset:2048
    v_mfma_f32_16x16x32_bf16 v[140:143], v[92:95], v[28:31], v[140:143]
    ds_read_b128 v[24:27], v130 offset:0
    v_mfma_f32_16x16x32_bf16 v[164:167], v[92:95], v[32:35], v[164:167]
    ds_read_b64_tr_b16 v[88:89], v124 offset:24576
    v_mfma_f32_16x16x32_bf16 v[144:147], v[96:99], v[28:31], v[144:147]
    ds_read_b64_tr_b16 v[90:91], v124 offset:24832
    v_mfma_f32_16x16x32_bf16 v[168:171], v[96:99], v[32:35], v[168:171]
    ds_read_b64_tr_b16 v[92:93], v125 offset:24576
    v_mfma_f32_16x16x32_bf16 v[148:151], v[100:103], v[28:31], v[148:151]
    ds_read_b64_tr_b16 v[94:95], v125 offset:24832
    v_mfma_f32_16x16x32_bf16 v[172:175], v[100:103], v[32:35], v[172:175]
    ds_read_b64_tr_b16 v[96:97], v124 offset:26624
    s_waitcnt lgkmcnt(8)
    v_mfma_f32_16x16x32_bf16 v[152:155], v[28:31], v[104:107], v[152:155]
    ds_read_b64_tr_b16 v[98:99], v124 offset:26880
    v_mfma_f32_16x16x32_bf16 v[176:179], v[32:35], v[104:107], v[176:179]
    ds_read_b64_tr_b16 v[100:101], v125 offset:26624
    v_mfma_f32_16x16x32_bf16 v[156:159], v[28:31], v[108:111], v[156:159]
    ds_read_b64_tr_b16 v[102:103], v125 offset:26880
    v_mfma_f32_16x16x32_bf16 v[180:183], v[32:35], v[108:111], v[180:183]
    ds_read_b64_tr_b16 v[104:105], v124 offset:28672
    v_mfma_f32_16x16x32_bf16 v[184:187], v[112:115], v[36:39], v[184:187]
    ds_read_b64_tr_b16 v[106:107], v124 offset:28928
    v_mfma_f32_16x16x32_bf16 v[188:191], v[116:119], v[36:39], v[188:191]
    ds_read_b64_tr_b16 v[108:109], v125 offset:28672
    v_mfma_f32_16x16x32_bf16 v[48:51], v[28:31], v[28:31], v[48:51]
    ds_read_b64_tr_b16 v[110:111], v125 offset:28928
    v_mfma_f32_16x16x32_bf16 v[52:55], v[32:35], v[32:35], v[52:55]
    ds_read_b64_tr_b16 v[112:113], v126 offset:24576
    v_mfma_f32_16x16x32_bf16 v[56:59], v[36:39], v[36:39], v[56:59]
    ds_read_b64_tr_b16 v[114:115], v126 offset:24832
    v_mfma_f32_16x16x32_bf16 v[60:63], v[40:43], v[28:31], v[60:63]
    ds_read_b64_tr_b16 v[116:117], v127 offset:24576
    v_mfma_f32_16x16x32_bf16 v[64:67], v[40:43], v[32:35], v[64:67]
    ds_read_b64_tr_b16 v[118:119], v127 offset:24832
    v_mfma_f32_16x16x32_bf16 v[68:71], v[40:43], v[36:39], v[68:71]
    s_waitcnt lgkmcnt(8)
    v_mfma_f32_16x16x32_bf16 v[136:139], v[88:91], v[16:19], v[136:139]
    ds_read_b128 v[28:31], v129 offset:0
    v_mfma_f32_16x16x32_bf16 v[160:163], v[88:91], v[20:23], v[160:163]
    ds_read_b128 v[32:35], v129 offset:2048
    v_mfma_f32_16x16x32_bf16 v[140:143], v[92:95], v[16:19], v[140:143]
    ds_read_b128 v[36:39], v131 offset:0
    v_mfma_f32_16x16x32_bf16 v[164:167], v[92:95], v[20:23], v[164:167]
    ds_read_b64_tr_b16 v[88:89], v124 offset:30720
    v_mfma_f32_16x16x32_bf16 v[144:147], v[96:99], v[16:19], v[144:147]
    ds_read_b64_tr_b16 v[90:91], v124 offset:30976
    v_mfma_f32_16x16x32_bf16 v[168:171], v[96:99], v[20:23], v[168:171]
    ds_read_b64_tr_b16 v[92:93], v125 offset:30720
    v_mfma_f32_16x16x32_bf16 v[148:151], v[100:103], v[16:19], v[148:151]
    ds_read_b64_tr_b16 v[94:95], v125 offset:30976
    v_mfma_f32_16x16x32_bf16 v[172:175], v[100:103], v[20:23], v[172:175]
    ds_read_b64_tr_b16 v[96:97], v124 offset:32768
    s_waitcnt lgkmcnt(8)
    v_mfma_f32_16x16x32_bf16 v[152:155], v[16:19], v[104:107], v[152:155]
    ds_read_b64_tr_b16 v[98:99], v124 offset:33024
    v_mfma_f32_16x16x32_bf16 v[176:179], v[20:23], v[104:107], v[176:179]
    ds_read_b64_tr_b16 v[100:101], v125 offset:32768
    v_mfma_f32_16x16x32_bf16 v[156:159], v[16:19], v[108:111], v[156:159]
    ds_read_b64_tr_b16 v[102:103], v125 offset:33024
    v_mfma_f32_16x16x32_bf16 v[180:183], v[20:23], v[108:111], v[180:183]
    ds_read_b64_tr_b16 v[104:105], v124 offset:34816
    v_mfma_f32_16x16x32_bf16 v[184:187], v[112:115], v[24:27], v[184:187]
    ds_read_b64_tr_b16 v[106:107], v124 offset:35072
    v_mfma_f32_16x16x32_bf16 v[188:191], v[116:119], v[24:27], v[188:191]
    ds_read_b64_tr_b16 v[108:109], v125 offset:34816
    v_mfma_f32_16x16x32_bf16 v[48:51], v[16:19], v[16:19], v[48:51]
    ds_read_b64_tr_b16 v[110:111], v125 offset:35072
    v_mfma_f32_16x16x32_bf16 v[52:55], v[20:23], v[20:23], v[52:55]
    ds_read_b64_tr_b16 v[112:113], v126 offset:30720
    v_mfma_f32_16x16x32_bf16 v[56:59], v[24:27], v[24:27], v[56:59]
    ds_read_b64_tr_b16 v[114:115], v126 offset:30976
    v_mfma_f32_16x16x32_bf16 v[60:63], v[40:43], v[16:19], v[60:63]
    ds_read_b64_tr_b16 v[116:117], v127 offset:30720
    v_mfma_f32_16x16x32_bf16 v[64:67], v[40:43], v[20:23], v[64:67]
    ds_read_b64_tr_b16 v[118:119], v127 offset:30976
    v_mfma_f32_16x16x32_bf16 v[68:71], v[40:43], v[24:27], v[68:71]
    s_waitcnt lgkmcnt(9)
    v_mfma_f32_16x16x32_bf16 v[48:51], v[28:31], v[28:31], v[48:51]
    v_mfma_f32_16x16x32_bf16 v[52:55], v[32:35], v[32:35], v[52:55]
    v_mfma_f32_16x16x32_bf16 v[56:59], v[36:39], v[36:39], v[56:59]
    v_mfma_f32_16x16x32_bf16 v[60:63], v[40:43], v[28:31], v[60:63]
    v_mfma_f32_16x16x32_bf16 v[64:67], v[40:43], v[32:35], v[64:67]
    v_mfma_f32_16x16x32_bf16 v[68:71], v[40:43], v[36:39], v[68:71]
    s_waitcnt lgkmcnt(2)
    v_mfma_f32_16x16x32_bf16 v[184:187], v[112:115], v[36:39], v[184:187]
    s_waitcnt lgkmcnt(0)
    v_mfma_f32_16x16x32_bf16 v[188:191], v[116:119], v[36:39], v[188:191]
    v_mfma_f32_16x16x32_bf16 v[144:147], v[96:99], v[28:31], v[144:147]
    v_cndmask_b32 v48, v48, v49, s[88:89]
    v_cndmask_b32 v52, v52, v53, s[88:89]
    v_cndmask_b32 v56, v56, v57, s[88:89]
    v_mfma_f32_16x16x32_bf16 v[168:171], v[96:99], v[32:35], v[168:171]
    v_cndmask_b32 v48, v48, v50, s[90:91]
    v_cndmask_b32 v52, v52, v54, s[90:91]
    v_cndmask_b32 v56, v56, v58, s[90:91]
    v_mfma_f32_16x16x32_bf16 v[148:151], v[100:103], v[28:31], v[148:151]
    v_cndmask_b32 v48, v48, v51, s[92:93]
    v_cndmask_b32 v52, v52, v55, s[92:93]
    v_cndmask_b32 v56, v56, v59, s[92:93]
    v_mfma_f32_16x16x32_bf16 v[172:175], v[100:103], v[32:35], v[172:175]
    v_mul_f32 v133, 0x3b124925, v60
    v_mul_f32 v135, 0x3b124925, v64
    v_mul_f32 v85, 0x3b124925, v68
    v_mfma_f32_16x16x32_bf16 v[152:155], v[28:31], v[104:107], v[152:155]
    v_mul_f32 v132, v133, v133
    v_mul_f32 v134, v135, v135
    v_mul_f32 v84, v85, v85
    v_mfma_f32_16x16x32_bf16 v[176:179], v[32:35], v[104:107], v[176:179]
    v_mul_f32 v48, 0x3b124925, v48
    v_mul_f32 v52, 0x3b124925, v52
    v_mul_f32 v56, 0x3b124925, v56
    v_mfma_f32_16x16x32_bf16 v[156:159], v[28:31], v[108:111], v[156:159]
    s_mov_b32 exec_lo, 0x00010001
    s_mov_b32 exec_hi, 0x00010001
    ds_write_b128 v73, v[184:187] offset:128
    ds_write_b128 v74, v[188:191] offset:0
    s_mov_b64 exec, -1
    v_sub_f32 v132, v48, v132
    v_sub_f32 v134, v52, v134
    v_mfma_f32_16x16x32_bf16 v[180:183], v[32:35], v[108:111], v[180:183]
    v_sub_f32 v84, v56, v84
    v_max_f32 v132, 0, v132
    v_max_f32 v134, 0, v134
    v_mfma_f32_16x16x32_bf16 v[136:139], v[88:91], v[28:31], v[136:139]
    v_max_f32 v84, 0, v84
    v_add_f32 v132, 0x3727c5ac, v132
    v_add_f32 v134, 0x3727c5ac, v134
    v_mfma_f32_16x16x32_bf16 v[160:163], v[88:91], v[32:35], v[160:163]
    v_add_f32 v84, 0x3727c5ac, v84
    v_rsq_f32 v132, v132
    v_rsq_f32 v134, v134
    v_mfma_f32_16x16x32_bf16 v[140:143], v[92:95], v[28:31], v[140:143]
    v_rsq_f32 v84, v84
    s_mov_b32 exec_lo, 0x00f0000f
    s_mov_b32 exec_hi, 0xf0000f00
    ds_write2_b32 v75, v132, v133 offset0:128 offset1:144
    ds_write2_b32 v75, v134, v135 offset0:160 offset1:176
    ds_write2_b32 v75, v84, v85 offset0:192 offset1:208
    s_mov_b64 exec, -1
    v_mov_b32_dpp v224, v184 row_newbcast:0 row_mask:0xf bank_mask:0xf
    v_mfma_f32_16x16x32_bf16 v[164:167], v[92:95], v[32:35], v[164:167]
    v_mov_b32_dpp v225, v185 row_newbcast:0 row_mask:0xf bank_mask:0xf
    v_mov_b32_dpp v226, v186 row_newbcast:0 row_mask:0xf bank_mask:0xf
    v_mov_b32_dpp v227, v187 row_newbcast:0 row_mask:0xf bank_mask:0xf
    v_fma_f32 v224, -v224, v85, v184
    v_fma_f32 v225, -v225, v85, v185
    v_fma_f32 v226, -v226, v85, v186
    v_fma_f32 v227, -v227, v85, v187
    s_cmp_eq_u32 s49, 15
    s_cselect_b32 s88, 0xffff0000, -1
    s_mov_b32 s89, -1
    s_mov_b32 s90, -1
    s_cselect_b32 s91, -1, 0xffff
    s_waitcnt lgkmcnt(0)
    s_barrier
    ds_read_b32 v134, v75 offset:640
    ds_read_b32 v84, v75 offset:768
    ds_read_b32 v132, v75 offset:512
    ds_read_b128 v[56:59], v72 offset:128
    ds_read_b128 v[60:63], v72 offset:192
    ds_read_b32 v64, v77 offset:256
    ds_read_b32 v65, v77 offset:320
    ds_read_b128 v[44:47], v76 offset:704
    ds_read_b128 v[40:43], v76 offset:640
    ds_read_b128 v[36:39], v76 offset:576
    ds_read_b128 v[32:35], v76 offset:512
    ds_read_b128 v[48:51], v72 offset:0
    ds_read_b128 v[52:55], v72 offset:64
    s_waitcnt lgkmcnt(9)
    v_pk_fma_f32 v[168:169], v[56:57], v[134:135], v[168:169] op_sel:[0,1,0] op_sel_hi:[1,1,1] neg_lo:[0,1,0] neg_hi:[0,1,0]
    v_pk_fma_f32 v[170:171], v[58:59], v[134:135], v[170:171] op_sel:[0,1,0] op_sel_hi:[1,1,1] neg_lo:[0,1,0] neg_hi:[0,1,0]
    v_pk_mul_f32 v[168:169], v[168:169], v[134:135] op_sel:[0,0] op_sel_hi:[1,0]
    v_pk_mul_f32 v[170:171], v[170:171], v[134:135] op_sel:[0,0] op_sel_hi:[1,0]
    v_cvt_pk_bf16_f32 v104, v168, v169
    v_cvt_pk_bf16_f32 v105, v170, v171
    s_waitcnt lgkmcnt(8)
    v_pk_fma_f32 v[172:173], v[60:61], v[134:135], v[172:173] op_sel:[0,1,0] op_sel_hi:[1,1,1] neg_lo:[0,1,0] neg_hi:[0,1,0]
    v_pk_fma_f32 v[174:175], v[62:63], v[134:135], v[174:175] op_sel:[0,1,0] op_sel_hi:[1,1,1] neg_lo:[0,1,0] neg_hi:[0,1,0]
    v_pk_mul_f32 v[172:173], v[172:173], v[134:135] op_sel:[0,0] op_sel_hi:[1,0]
    v_pk_mul_f32 v[174:175], v[174:175], v[134:135] op_sel:[0,0] op_sel_hi:[1,0]
    v_cvt_pk_bf16_f32 v106, v172, v173
    v_cvt_pk_bf16_f32 v107, v174, v175
    ds_write_b128 v78, v[104:107] offset:4096
    v_pk_mul_f32 v[224:225], v[224:225], v[84:85] op_sel_hi:[1,0]
    v_pk_mul_f32 v[226:227], v[226:227], v[84:85] op_sel_hi:[1,0]
    v_cvt_pk_bf16_f32 v224, v224, v225
    v_cvt_pk_bf16_f32 v226, v226, v227
    ds_write_b16 v80, v224 offset:2048
    ds_write_b16_d16_hi v81, v224 offset:2048
    ds_write_b16 v82, v226 offset:2048
    ds_write_b16_d16_hi v83, v226 offset:2048
    s_waitcnt lgkmcnt(10)
    v_pk_fma_f32 v[176:177], v[44:45], v[64:65], v[176:177] op_sel:[0,0,0] op_sel_hi:[1,0,1] neg_lo:[0,1,0] neg_hi:[0,1,0]
    v_pk_fma_f32 v[178:179], v[46:47], v[64:65], v[178:179] op_sel:[0,0,0] op_sel_hi:[1,0,1] neg_lo:[0,1,0] neg_hi:[0,1,0]
    s_waitcnt lgkmcnt(9)
    v_pk_mul_f32 v[176:177], v[176:177], v[40:41]
    v_pk_mul_f32 v[178:179], v[178:179], v[42:43]
    v_cvt_pk_bf16_f32 v112, v176, v177
    v_cvt_pk_bf16_f32 v113, v178, v179
    v_pk_fma_f32 v[180:181], v[44:45], v[64:65], v[180:181] op_sel:[0,1,0] op_sel_hi:[1,1,1] neg_lo:[0,1,0] neg_hi:[0,1,0]
    v_pk_fma_f32 v[182:183], v[46:47], v[64:65], v[182:183] op_sel:[0,1,0] op_sel_hi:[1,1,1] neg_lo:[0,1,0] neg_hi:[0,1,0]
    v_pk_mul_f32 v[180:181], v[180:181], v[40:41]
    v_pk_mul_f32 v[182:183], v[182:183], v[42:43]
    v_cvt_pk_bf16_f32 v118, v180, v181
    v_cvt_pk_bf16_f32 v119, v182, v183
    ds_write_b64 v78, v[112:113] offset:5120
    ds_write_b64 v78, v[118:119] offset:5128
    v_mul_f32 v68, 0x3e8b97f6, v132
    v_mul_f32 v70, 0x3e8b97f6, v134
    v_cndmask_b32 v69, 0, v68, s[90:91]
    v_cndmask_b32 v68, 0, v68, s[88:89]
    v_cndmask_b32 v71, 0, v70, s[90:91]
    v_cndmask_b32 v70, 0, v70, s[88:89]
    v_pk_fma_f32 v[144:145], v[56:57], v[132:133], v[144:145] op_sel:[0,1,0] op_sel_hi:[1,1,1] neg_lo:[0,1,0] neg_hi:[0,1,0]
    v_pk_fma_f32 v[146:147], v[58:59], v[132:133], v[146:147] op_sel:[0,1,0] op_sel_hi:[1,1,1] neg_lo:[0,1,0] neg_hi:[0,1,0]
    v_pk_mul_f32 v[144:145], v[144:145], v[132:133] op_sel:[0,0] op_sel_hi:[1,0]
    v_pk_mul_f32 v[146:147], v[146:147], v[132:133] op_sel:[0,0] op_sel_hi:[1,0]
    v_cvt_pk_bf16_f32 v100, v144, v145
    v_cvt_pk_bf16_f32 v101, v146, v147
    v_pk_fma_f32 v[148:149], v[60:61], v[132:133], v[148:149] op_sel:[0,1,0] op_sel_hi:[1,1,1] neg_lo:[0,1,0] neg_hi:[0,1,0]
    v_pk_fma_f32 v[150:151], v[62:63], v[132:133], v[150:151] op_sel:[0,1,0] op_sel_hi:[1,1,1] neg_lo:[0,1,0] neg_hi:[0,1,0]
    v_pk_mul_f32 v[148:149], v[148:149], v[132:133] op_sel:[0,0] op_sel_hi:[1,0]
    v_pk_mul_f32 v[150:151], v[150:151], v[132:133] op_sel:[0,0] op_sel_hi:[1,0]
    v_cvt_pk_bf16_f32 v102, v148, v149
    v_cvt_pk_bf16_f32 v103, v150, v151
    s_waitcnt lgkmcnt(0)
    s_barrier
    ds_read_b128 v[96:99], v78 offset:2048
    ds_read_b64 v[108:109], v78 offset:3072
    ds_read_b64 v[114:115], v78 offset:3080
    v_pk_fma_f32 v[160:161], v[48:49], v[134:135], v[160:161] op_sel:[0,1,0] op_sel_hi:[1,1,1] neg_lo:[0,1,0] neg_hi:[0,1,0]
    v_pk_fma_f32 v[162:163], v[50:51], v[134:135], v[162:163] op_sel:[0,1,0] op_sel_hi:[1,1,1] neg_lo:[0,1,0] neg_hi:[0,1,0]
    v_pk_mul_f32 v[160:161], v[160:161], v[70:71] op_sel:[0,0] op_sel_hi:[1,0]
    v_pk_mul_f32 v[162:163], v[162:163], v[70:71] op_sel:[0,0] op_sel_hi:[1,0]
    v_cvt_pk_bf16_f32 v92, v160, v161
    v_cvt_pk_bf16_f32 v93, v162, v163
    v_pk_fma_f32 v[164:165], v[52:53], v[134:135], v[164:165] op_sel:[0,1,0] op_sel_hi:[1,1,1] neg_lo:[0,1,0] neg_hi:[0,1,0]
    v_pk_fma_f32 v[166:167], v[54:55], v[134:135], v[166:167] op_sel:[0,1,0] op_sel_hi:[1,1,1] neg_lo:[0,1,0] neg_hi:[0,1,0]
    v_pk_mul_f32 v[164:165], v[164:165], v[70:71] op_sel:[0,1] op_sel_hi:[1,1]
    v_pk_mul_f32 v[166:167], v[166:167], v[70:71] op_sel:[0,1] op_sel_hi:[1,1]
    v_cvt_pk_bf16_f32 v94, v164, v165
    v_cvt_pk_bf16_f32 v95, v166, v167
    s_nop 1
    v_mfma_f32_16x16x32_bf16 v[24:27], v[100:103], v[92:95], v[240:243]
    v_mfma_f32_16x16x32_bf16 v[28:31], v[104:107], v[92:95], v[244:247]
    v_pk_fma_f32 v[136:137], v[48:49], v[132:133], v[136:137] op_sel:[0,1,0] op_sel_hi:[1,1,1] neg_lo:[0,1,0] neg_hi:[0,1,0]
    v_pk_fma_f32 v[138:139], v[50:51], v[132:133], v[138:139] op_sel:[0,1,0] op_sel_hi:[1,1,1] neg_lo:[0,1,0] neg_hi:[0,1,0]
    v_pk_mul_f32 v[136:137], v[136:137], v[68:69] op_sel:[0,0] op_sel_hi:[1,0]
    v_pk_mul_f32 v[138:139], v[138:139], v[68:69] op_sel:[0,0] op_sel_hi:[1,0]
    v_cvt_pk_bf16_f32 v88, v136, v137
    v_cvt_pk_bf16_f32 v89, v138, v139
    v_pk_fma_f32 v[140:141], v[52:53], v[132:133], v[140:141] op_sel:[0,1,0] op_sel_hi:[1,1,1] neg_lo:[0,1,0] neg_hi:[0,1,0]
    v_pk_fma_f32 v[142:143], v[54:55], v[132:133], v[142:143] op_sel:[0,1,0] op_sel_hi:[1,1,1] neg_lo:[0,1,0] neg_hi:[0,1,0]
    v_pk_mul_f32 v[140:141], v[140:141], v[68:69] op_sel:[0,1] op_sel_hi:[1,1]
    v_pk_mul_f32 v[142:143], v[142:143], v[68:69] op_sel:[0,1] op_sel_hi:[1,1]
    v_cvt_pk_bf16_f32 v90, v140, v141
    v_cvt_pk_bf16_f32 v91, v142, v143
    s_waitcnt lgkmcnt(2)
    s_nop 0
    v_mfma_f32_16x16x32_bf16 v[16:19], v[96:99], v[88:91], v[248:251]
    v_mfma_f32_16x16x32_bf16 v[20:23], v[100:103], v[88:91], v[244:247]
    v_pk_fma_f32 v[152:153], v[36:37], v[64:65], v[152:153] op_sel:[0,0,0] op_sel_hi:[1,0,1] neg_lo:[0,1,0] neg_hi:[0,1,0]
    v_pk_fma_f32 v[154:155], v[38:39], v[64:65], v[154:155] op_sel:[0,0,0] op_sel_hi:[1,0,1] neg_lo:[0,1,0] neg_hi:[0,1,0]
    v_pk_mul_f32 v[152:153], v[152:153], v[32:33]
    v_pk_mul_f32 v[154:155], v[154:155], v[34:35]
    v_cvt_pk_bf16_f32 v110, v152, v153
    v_cvt_pk_bf16_f32 v111, v154, v155
    v_pk_fma_f32 v[156:157], v[36:37], v[64:65], v[156:157] op_sel:[0,1,0] op_sel_hi:[1,1,1] neg_lo:[0,1,0] neg_hi:[0,1,0]
    v_pk_fma_f32 v[158:159], v[38:39], v[64:65], v[158:159] op_sel:[0,1,0] op_sel_hi:[1,1,1] neg_lo:[0,1,0] neg_hi:[0,1,0]
    v_pk_mul_f32 v[156:157], v[156:157], v[32:33]
    v_pk_mul_f32 v[158:159], v[158:159], v[34:35]
    v_cvt_pk_bf16_f32 v116, v156, v157
    v_cvt_pk_bf16_f32 v117, v158, v159
    v_max3_f32 v137, v24, v25, v26
    v_max3_f32 v139, v27, v28, v29
    v_max3_f32 v137, v137, v30, v31
    v_max_f32 v137, v137, v139
    v_max3_f32 v136, v16, v17, v18
    v_max3_f32 v138, v19, v20, v21
    v_max3_f32 v136, v136, v22, v23
    v_max_f32 v136, v136, v138
    v_mov_b32 v138, v136
    v_mov_b32 v139, v137
    s_nop 0
    v_permlane32_swap_b32 v136, v138
    v_permlane32_swap_b32 v137, v139
    v_max_f32 v136, v136, v138
    v_max_f32 v137, v137, v139
    v_mov_b32 v138, v136
    v_mov_b32 v139, v137
    s_nop 0
    v_permlane16_swap_b32 v136, v138
    v_permlane16_swap_b32 v137, v139
    v_max_f32 v136, v136, v138
    v_max_f32 v137, v137, v139
    v_pk_add_f32 v[24:25], v[24:25], v[136:137] op_sel:[0,1] op_sel_hi:[1,1] neg_lo:[0,1] neg_hi:[0,1]
    v_pk_add_f32 v[26:27], v[26:27], v[136:137] op_sel:[0,1] op_sel_hi:[1,1] neg_lo:[0,1] neg_hi:[0,1]
    v_pk_add_f32 v[28:29], v[28:29], v[136:137] op_sel:[0,1] op_sel_hi:[1,1] neg_lo:[0,1] neg_hi:[0,1]
    v_pk_add_f32 v[30:31], v[30:31], v[136:137] op_sel:[0,1] op_sel_hi:[1,1] neg_lo:[0,1] neg_hi:[0,1]
    v_exp_f32 v24, v24
    v_exp_f32 v25, v25
    v_exp_f32 v26, v26
    v_exp_f32 v27, v27
    v_exp_f32 v28, v28
    v_exp_f32 v29, v29
    v_exp_f32 v30, v30
    v_exp_f32 v31, v31
    v_cvt_pk_bf16_f32 v148, v24, v25
    v_cvt_pk_bf16_f32 v149, v26, v27
    v_cvt_pk_bf16_f32 v150, v28, v29
    v_cvt_pk_bf16_f32 v151, v30, v31
    s_nop 1
    v_mfma_f32_16x16x32_bf16 v[160:163], v[110:113], v[148:151], 0
    v_mfma_f32_16x16x32_bf16 v[164:167], v[116:119], v[148:151], 0
    v_pk_add_f32 v[16:17], v[16:17], v[136:137] op_sel:[0,0] op_sel_hi:[1,0] neg_lo:[0,1] neg_hi:[0,1]
    v_pk_add_f32 v[18:19], v[18:19], v[136:137] op_sel:[0,0] op_sel_hi:[1,0] neg_lo:[0,1] neg_hi:[0,1]
    v_pk_add_f32 v[20:21], v[20:21], v[136:137] op_sel:[0,0] op_sel_hi:[1,0] neg_lo:[0,1] neg_hi:[0,1]
    v_pk_add_f32 v[22:23], v[22:23], v[136:137] op_sel:[0,0] op_sel_hi:[1,0] neg_lo:[0,1] neg_hi:[0,1]
    v_exp_f32 v16, v16
    v_exp_f32 v17, v17
    v_exp_f32 v18, v18
    v_exp_f32 v19, v19
    v_exp_f32 v20, v20
    v_exp_f32 v21, v21
    v_exp_f32 v22, v22
    v_exp_f32 v23, v23
    v_cvt_pk_bf16_f32 v144, v16, v17
    v_cvt_pk_bf16_f32 v145, v18, v19
    v_cvt_pk_bf16_f32 v146, v20, v21
    v_cvt_pk_bf16_f32 v147, v22, v23
    s_waitcnt lgkmcnt(1)
    s_nop 0
    v_mfma_f32_16x16x32_bf16 v[152:155], v[108:111], v[144:147], 0
    s_waitcnt lgkmcnt(0)
    v_mfma_f32_16x16x32_bf16 v[156:159], v[114:117], v[144:147], 0
    v_pk_add_f32 v[16:17], v[16:17], v[18:19]
    v_pk_add_f32 v[20:21], v[20:21], v[22:23]
    v_pk_add_f32 v[24:25], v[24:25], v[26:27]
    v_pk_add_f32 v[28:29], v[28:29], v[30:31]
    v_pk_add_f32 v[16:17], v[16:17], v[20:21]
    v_pk_add_f32 v[24:25], v[24:25], v[28:29]
    v_add_f32 v140, v16, v17
    v_add_f32 v142, v24, v25
    v_mov_b32 v138, v140
    v_mov_b32 v139, v142
    s_nop 0
    v_permlane32_swap_b32 v140, v138
    v_permlane32_swap_b32 v142, v139
    v_add_f32 v140, v140, v138
    v_add_f32 v142, v142, v139
    v_mov_b32 v138, v140
    v_mov_b32 v139, v142
    s_nop 0
    v_permlane16_swap_b32 v140, v138
    v_permlane16_swap_b32 v142, v139
    v_add_f32 v140, v140, v138
    v_add_f32 v142, v142, v139
    v_rcp_f32 v140, v140
    v_rcp_f32 v142, v142
    v_cndmask_b32 v141, 0, v140, s[90:91]
    v_cndmask_b32 v140, 0, v140, s[88:89]
    v_cndmask_b32 v143, 0, v142, s[90:91]
    v_cndmask_b32 v142, 0, v142, s[88:89]
    v_pk_mul_f32 v[152:153], v[152:153], v[140:141] op_sel_hi:[1,0]
    v_pk_mul_f32 v[154:155], v[154:155], v[140:141] op_sel_hi:[1,0]
    v_pk_mul_f32 v[156:157], v[156:157], v[140:141] op_sel:[0,1] op_sel_hi:[1,1]
    v_pk_mul_f32 v[158:159], v[158:159], v[140:141] op_sel:[0,1] op_sel_hi:[1,1]
    v_cvt_pk_bf16_f32 v144, v152, v153
    v_cvt_pk_bf16_f32 v145, v154, v155
    v_cvt_pk_bf16_f32 v146, v156, v157
    v_cvt_pk_bf16_f32 v147, v158, v159
    buffer_store_dwordx4 v[144:147], v4, s[40:43], s62 offen sc1
    v_pk_mul_f32 v[160:161], v[160:161], v[142:143] op_sel_hi:[1,0]
    v_pk_mul_f32 v[162:163], v[162:163], v[142:143] op_sel_hi:[1,0]
    v_pk_mul_f32 v[164:165], v[164:165], v[142:143] op_sel:[0,1] op_sel_hi:[1,1]
    v_pk_mul_f32 v[166:167], v[166:167], v[142:143] op_sel:[0,1] op_sel_hi:[1,1]
    v_cvt_pk_bf16_f32 v148, v160, v161
    v_cvt_pk_bf16_f32 v149, v162, v163
    v_cvt_pk_bf16_f32 v150, v164, v165
    v_cvt_pk_bf16_f32 v151, v166, v167
    buffer_store_dwordx4 v[148:151], v4, s[40:43], s63 offen sc1
    s_add_u32 m0, s59, 0
    s_mov_b32 s73, 0
    buffer_load_dwordx4 v208, s[16:19], s73 offen lds
    s_add_u32 m0, s59, 1024
    s_mov_b32 s73, 7168
    buffer_load_dwordx4 v208, s[16:19], s73 offen lds
    s_add_u32 m0, s59, 2048
    s_mov_b32 s73, 14336
    buffer_load_dwordx4 v208, s[16:19], s73 offen lds
    s_add_u32 m0, s59, 3072
    s_mov_b32 s73, 21504
    buffer_load_dwordx4 v208, s[16:19], s73 offen lds
    s_add_u32 m0, s59, 4096
    s_mov_b32 s73, 28672
    buffer_load_dwordx4 v208, s[16:19], s73 offen lds
    s_add_u32 m0, s59, 5120
    s_mov_b32 s73, 35840
    buffer_load_dwordx4 v208, s[16:19], s73 offen lds
    s_add_u32 m0, s59, 6144
    s_mov_b32 s73, 43008
    buffer_load_dwordx4 v208, s[16:19], s73 offen lds
    s_add_u32 m0, s59, 7168
    s_mov_b32 s73, 50176
    buffer_load_dwordx4 v208, s[16:19], s73 offen lds
    s_add_u32 m0, s59, 8192
    s_mov_b32 s73, 57344
    buffer_load_dwordx4 v208, s[16:19], s73 offen lds
    s_add_u32 m0, s59, 9216
    s_mov_b32 s73, 64512
    buffer_load_dwordx4 v208, s[16:19], s73 offen lds
    s_add_u32 m0, s59, 10240
    s_mov_b32 s73, 71680
    buffer_load_dwordx4 v208, s[16:19], s73 offen lds
    s_add_u32 m0, s59, 11264
    s_mov_b32 s73, 78848
    buffer_load_dwordx4 v208, s[16:19], s73 offen lds
    s_add_u32 m0, s59, 12288
    s_mov_b32 s73, 86016
    buffer_load_dwordx4 v208, s[16:19], s73 offen lds
    s_add_u32 m0, s59, 13312
    s_mov_b32 s73, 93184
    buffer_load_dwordx4 v208, s[16:19], s73 offen lds
    s_waitcnt vmcnt(18)
    v_readfirstlane_b32 s4, v6
    s_nop 1
    s_cmp_lg_u32 s4, 0
    s_cbranch_scc1 Lepd_P_2
    s_nop 0
Lepg_P_1:
    s_sub_u32 s6, s6, 1
    s_cbranch_scc1 L_end_P
    buffer_load_dword v6, v7, s[44:47], 0 offen sc1
    s_waitcnt vmcnt(0)
    v_readfirstlane_b32 s4, v6
    s_nop 1
    s_cmp_eq_u32 s4, 0
    s_cbranch_scc1 Lepg_P_1
Lepd_P_2:
    s_waitcnt vmcnt(14)
    v_mov_b32 v8, s4
    s_mov_b64 exec, 1
    buffer_store_dword v8, v9, s[40:43], s80 offen sc1
    s_mov_b64 exec, -1
    s_cmp_lt_u32 s67, 99
    s_cbranch_scc1 Lnotag_P_3
    s_lshr_b32 s68, s2, 3
    s_sub_u32 s68, s68, 28
    s_lshl_b32 s68, s68, 2
    s_add_u32 s68, s68, s3
    s_lshl_b32 s68, s68, 16
    s_and_b32 s69, s2, 7
    s_lshl_b32 s69, s69, 9
    s_add_u32 s68, s68, s69
    v_lshrrev_b32 v16, 2, v1
    v_lshlrev_b32 v16, 12, v16
    v_and_b32 v17, 3, v1
    v_lshl_add_u32 v16, v17, 7, v16
    buffer_load_dword v18, v16, s[24:27], s68 offen
    s_add_u32 s68, s68, 0x100000
    s_waitcnt vmcnt(3)
    buffer_load_dword v19, v16, s[24:27], s68 offen
    s_add_u32 s68, s68, 0x100000
    s_waitcnt vmcnt(3)
    buffer_load_dword v20, v16, s[24:27], s68 offen
    s_add_u32 s68, s68, 0x100000
    s_waitcnt vmcnt(3)
    buffer_load_dword v21, v16, s[24:27], s68 offen
    s_add_u32 s68, s68, 0x100000
    s_waitcnt vmcnt(3)
    buffer_load_dword v22, v16, s[24:27], s68 offen
    s_add_u32 s68, s68, 0x100000
    s_waitcnt vmcnt(3)
    buffer_load_dword v23, v16, s[24:27], s68 offen
    s_add_u32 s68, s68, 0x100000
    s_waitcnt vmcnt(3)
    buffer_load_dword v24, v16, s[24:27], s68 offen
    s_add_u32 s68, s68, 0x100000
    s_waitcnt vmcnt(3)
    s_waitcnt vmcnt(0)
    s_branch L_end_P
Lnotag_P_3:
    v_lshrrev_b32 v221, 5, v1
    v_mul_u32_u24 v221, 3584, v221
    v_and_b32 v222, 31, v1
    v_lshl_add_u32 v221, v222, 1, v221
    s_lshl_b32 s58, s67, 1
    s_lshr_b32 s60, s3, 1
    s_add_u32 s58, s58, s60
    s_mul_i32 s58, s58, 28672
    s_lshl_b32 s60, s66, 7
    s_add_u32 s58, s58, s60
    s_and_b32 s60, s3, 1
    s_lshl_b32 s60, s60, 6
    s_add_u32 s58, s58, s60
    buffer_load_ushort v192, v221, s[8:11], s58 offen offset:0
    buffer_load_ushort v193, v221, s[8:11], s58 offen offset:896
    buffer_load_ushort v194, v221, s[8:11], s58 offen offset:1792
    buffer_load_ushort v195, v221, s[8:11], s58 offen offset:2688
    s_add_u32 s58, s58, 7168
    buffer_load_ushort v196, v221, s[8:11], s58 offen offset:0
    buffer_load_ushort v197, v221, s[8:11], s58 offen offset:896
    buffer_load_ushort v198, v221, s[8:11], s58 offen offset:1792
    buffer_load_ushort v199, v221, s[8:11], s58 offen offset:2688
    s_add_u32 s58, s58, 7168
    buffer_load_ushort v200, v221, s[8:11], s58 offen offset:0
    buffer_load_ushort v201, v221, s[8:11], s58 offen offset:896
    buffer_load_ushort v202, v221, s[8:11], s58 offen offset:1792
    buffer_load_ushort v203, v221, s[8:11], s58 offen offset:2688
    s_add_u32 s58, s58, 7168
    buffer_load_ushort v204, v221, s[8:11], s58 offen offset:0
    buffer_load_ushort v205, v221, s[8:11], s58 offen offset:896
    buffer_load_ushort v206, v221, s[8:11], s58 offen offset:1792
    buffer_load_ushort v207, v221, s[8:11], s58 offen offset:2688
    s_and_b32 s68, s2, 7
    s_cmp_ge_u32 s68, 7
    s_cselect_b32 s48, 7, 0
    s_sub_u32 s68, s68, s48
    s_lshl_b32 s48, s68, 12
    s_add_u32 s68, s68, 1
    s_cmp_ge_u32 s68, 7
    s_cselect_b32 s49, 7, 0
    s_sub_u32 s68, s68, s49
    s_lshl_b32 s49, s68, 12
    s_add_u32 s68, s68, 1
    s_cmp_ge_u32 s68, 7
    s_cselect_b32 s50, 7, 0
    s_sub_u32 s68, s68, s50
    s_lshl_b32 s50, s68, 12
    s_add_u32 s68, s68, 1
    s_cmp_ge_u32 s68, 7
    s_cselect_b32 s51, 7, 0
    s_sub_u32 s68, s68, s51
    s_lshl_b32 s51, s68, 12
    s_add_u32 s68, s68, 1
    s_cmp_ge_u32 s68, 7
    s_cselect_b32 s52, 7, 0
    s_sub_u32 s68, s68, s52
    s_lshl_b32 s52, s68, 12
    s_add_u32 s68, s68, 1
    s_cmp_ge_u32 s68, 7
    s_cselect_b32 s53, 7, 0
    s_sub_u32 s68, s68, s53
    s_lshl_b32 s53, s68, 12
    s_add_u32 s68, s68, 1
    s_cmp_ge_u32 s68, 7
    s_cselect_b32 s54, 7, 0
    s_sub_u32 s68, s68, s54
    s_lshl_b32 s54, s68, 12
    s_waitcnt vmcnt(17)
    s_barrier
    ds_read_b64_tr_b16 a[0:1], v209 offset:0
    ds_read_b64_tr_b16 a[2:3], v209 offset:2048
    ds_read_b64_tr_b16 a[4:5], v209 offset:1024
    ds_read_b64_tr_b16 a[6:7], v209 offset:3072
    ds_read_b64_tr_b16 a[8:9], v209 offset:3584
    ds_read_b64_tr_b16 a[10:11], v209 offset:5632
    ds_read_b64_tr_b16 a[12:13], v209 offset:4608
    ds_read_b64_tr_b16 a[14:15], v209 offset:6656
    ds_read_b64_tr_b16 a[16:17], v209 offset:7168
    ds_read_b64_tr_b16 a[18:19], v209 offset:9216
    ds_read_b64_tr_b16 a[20:21], v209 offset:8192
    ds_read_b64_tr_b16 a[22:23], v209 offset:10240
    ds_read_b64_tr_b16 a[24:25], v209 offset:10752
    ds_read_b64_tr_b16 a[26:27], v209 offset:12800
    ds_read_b64_tr_b16 a[28:29], v209 offset:11776
    ds_read_b64_tr_b16 a[30:31], v209 offset:13824
    ds_read_b64_tr_b16 a[32:33], v209 offset:14336
    ds_read_b64_tr_b16 a[34:35], v209 offset:16384
    ds_read_b64_tr_b16 a[36:37], v209 offset:15360
    ds_read_b64_tr_b16 a[38:39], v209 offset:17408
    ds_read_b64_tr_b16 a[40:41], v209 offset:17920
    ds_read_b64_tr_b16 a[42:43], v209 offset:19968
    ds_read_b64_tr_b16 a[44:45], v209 offset:18944
    ds_read_b64_tr_b16 a[46:47], v209 offset:20992
    ds_read_b64_tr_b16 a[48:49], v209 offset:21504
    ds_read_b64_tr_b16 a[50:51], v209 offset:23552
    ds_read_b64_tr_b16 a[52:53], v209 offset:22528
    ds_read_b64_tr_b16 a[54:55], v209 offset:24576
    ds_read_b64_tr_b16 a[56:57], v209 offset:25088
    ds_read_b64_tr_b16 a[58:59], v209 offset:27136
    ds_read_b64_tr_b16 a[60:61], v209 offset:26112
    ds_read_b64_tr_b16 a[62:63], v209 offset:28160
    ds_read_b64_tr_b16 a[64:65], v209 offset:28672
    ds_read_b64_tr_b16 a[66:67], v209 offset:30720
    ds_read_b64_tr_b16 a[68:69], v209 offset:29696
    ds_read_b64_tr_b16 a[70:71], v209 offset:31744
    ds_read_b64_tr_b16 a[72:73], v209 offset:32256
    ds_read_b64_tr_b16 a[74:75], v209 offset:34304
    ds_read_b64_tr_b16 a[76:77], v209 offset:33280
    ds_read_b64_tr_b16 a[78:79], v209 offset:35328
    ds_read_b64_tr_b16 a[80:81], v209 offset:35840
    ds_read_b64_tr_b16 a[82:83], v209 offset:37888
    ds_read_b64_tr_b16 a[84:85], v209 offset:36864
    ds_read_b64_tr_b16 a[86:87], v209 offset:38912
    ds_read_b64_tr_b16 a[88:89], v209 offset:39424
    ds_read_b64_tr_b16 a[90:91], v209 offset:41472
    ds_read_b64_tr_b16 a[92:93], v209 offset:40448
    ds_read_b64_tr_b16 a[94:95], v209 offset:42496
    ds_read_b64_tr_b16 a[96:97], v209 offset:43008
    ds_read_b64_tr_b16 a[98:99], v209 offset:45056
    ds_read_b64_tr_b16 a[100:101], v209 offset:44032
    ds_read_b64_tr_b16 a[102:103], v209 offset:46080
    ds_read_b64_tr_b16 a[104:105], v209 offset:46592
    ds_read_b64_tr_b16 a[106:107], v209 offset:48640
    ds_read_b64_tr_b16 a[108:109], v209 offset:47616
    ds_read_b64_tr_b16 a[110:111], v209 offset:49664
    ds_read_b64_tr_b16 a[112:113], v209 offset:50176
    ds_read_b64_tr_b16 a[114:115], v209 offset:52224
    ds_read_b64_tr_b16 a[116:117], v209 offset:51200
    ds_read_b64_tr_b16 a[118:119], v209 offset:53248
    ds_read_b64_tr_b16 a[120:121], v209 offset:53248
    ds_read_b64_tr_b16 a[122:123], v209 offset:55296
    ds_read_b64_tr_b16 a[124:125], v209 offset:54272
    ds_read_b64_tr_b16 a[126:127], v209 offset:56320
    s_waitcnt lgkmcnt(0)
    s_barrier
    s_add_u32 m0, s70, 16384
    s_mul_i32 s73, s94, 56
    s_add_u32 s73, s73, 0
    buffer_load_dwordx4 v213, s[20:23], s73 offen lds
    s_add_u32 m0, s70, 17408
    s_mul_i32 s73, s94, 56
    s_add_u32 s73, s73, 28672
    buffer_load_dwordx4 v213, s[20:23], s73 offen lds
    s_add_u32 m0, s70, 18432
    s_mul_i32 s73, s94, 56
    s_add_u32 s73, s73, 57344
    buffer_load_dwordx4 v213, s[20:23], s73 offen lds
    s_add_u32 m0, s70, 19456
    s_mul_i32 s73, s94, 56
    s_add_u32 s73, s73, 86016
    buffer_load_dwordx4 v213, s[20:23], s73 offen lds
    s_add_u32 m0, s70, 20480
    s_mul_i32 s73, s94, 56
    s_add_u32 s73, s73, 114688
    buffer_load_dwordx4 v213, s[20:23], s73 offen lds
    s_add_u32 m0, s70, 21504
    s_mul_i32 s73, s94, 56
    s_add_u32 s73, s73, 143360
    buffer_load_dwordx4 v213, s[20:23], s73 offen lds
    s_add_u32 m0, s70, 22528
    s_mul_i32 s73, s94, 56
    s_add_u32 s73, s73, 172032
    buffer_load_dwordx4 v213, s[20:23], s73 offen lds
    s_add_u32 m0, s70, 23552
    s_mul_i32 s73, s94, 56
    s_add_u32 s73, s73, 200704
    buffer_load_dwordx4 v213, s[20:23], s73 offen lds
    s_add_u32 m0, s70, 24576
    s_mul_i32 s73, s95, 56
    s_add_u32 s73, s73, 0
    buffer_load_dwordx4 v213, s[20:23], s73 offen lds
    s_add_u32 m0, s70, 25600
    s_mul_i32 s73, s95, 56
    s_add_u32 s73, s73, 28672
    buffer_load_dwordx4 v213, s[20:23], s73 offen lds
    s_add_u32 m0, s70, 26624
    s_mul_i32 s73, s95, 56
    s_add_u32 s73, s73, 57344
    buffer_load_dwordx4 v213, s[20:23], s73 offen lds
    s_add_u32 m0, s70, 27648
    s_mul_i32 s73, s95, 56
    s_add_u32 s73, s73, 86016
    buffer_load_dwordx4 v213, s[20:23], s73 offen lds
    s_add_u32 m0, s70, 28672
    s_mul_i32 s73, s95, 56
    s_add_u32 s73, s73, 114688
    buffer_load_dwordx4 v213, s[20:23], s73 offen lds
    s_add_u32 m0, s70, 29696
    s_mul_i32 s73, s95, 56
    s_add_u32 s73, s73, 143360
    buffer_load_dwordx4 v213, s[20:23], s73 offen lds
    s_add_u32 m0, s70, 30720
    s_mul_i32 s73, s95, 56
    s_add_u32 s73, s73, 172032
    buffer_load_dwordx4 v213, s[20:23], s73 offen lds
    s_add_u32 m0, s70, 31744
    s_mul_i32 s73, s95, 56
    s_add_u32 s73, s73, 200704
    buffer_load_dwordx4 v213, s[20:23], s73 offen lds
    s_add_u32 m0, s70, 32768
    s_mul_i32 s73, s96, 56
    s_add_u32 s73, s73, 0
    buffer_load_dwordx4 v213, s[20:23], s73 offen lds
    s_add_u32 m0, s70, 33792
    s_mul_i32 s73, s96, 56
    s_add_u32 s73, s73, 28672
    buffer_load_dwordx4 v213, s[20:23], s73 offen lds
    s_add_u32 m0, s70, 34816
    s_mul_i32 s73, s96, 56
    s_add_u32 s73, s73, 57344
    buffer_load_dwordx4 v213, s[20:23], s73 offen lds
    s_add_u32 m0, s70, 35840
    s_mul_i32 s73, s96, 56
    s_add_u32 s73, s73, 86016
    buffer_load_dwordx4 v213, s[20:23], s73 offen lds
    buffer_load_dword v249, v10, s[40:43], s83 offen sc1
    s_sleep 3
    buffer_load_dword v250, v10, s[40:43], s83 offen sc1
    s_sleep 3
    s_nop 0
Lpoll_P_4:
    s_sub_u32 s6, s6, 1
    s_cbranch_scc1 L_end_P
    buffer_load_dword v251, v10, s[40:43], s83 offen sc1
    s_waitcnt vmcnt(2)
    v_cmp_ne_u32 vcc, s4, v249
    s_nop 1
    s_cbranch_vccz Lpd_P_5
    buffer_load_dword v249, v10, s[40:43], s83 offen sc1
    s_waitcnt vmcnt(2)
    v_cmp_ne_u32 vcc, s4, v250
    s_nop 1
    s_cbranch_vccz Lpd_P_5
    buffer_load_dword v250, v10, s[40:43], s83 offen sc1
    s_waitcnt vmcnt(2)
    v_cmp_ne_u32 vcc, s4, v251
    s_nop 1
    s_cbranch_vccnz Lpoll_P_4
    s_nop 1
Lpd_P_5:
    s_lshl_b32 s58, s67, 16
    s_lshl_b32 s60, s3, 14
    s_add_u32 s58, s58, s60
    s_add_u32 m0, s70, 0
    s_nop 0
    buffer_load_dwordx4 v4, s[40:43], s58 offen offset:0 sc1 lds
    buffer_load_dwordx4 v4, s[40:43], s58 offen offset:1024 sc1 lds
    buffer_load_dwordx4 v4, s[40:43], s58 offen offset:2048 sc1 lds
    buffer_load_dwordx4 v4, s[40:43], s58 offen offset:3072 sc1 lds
    s_add_u32 m0, s70, 4096
    s_add_u32 s58, s58, 4096
    buffer_load_dwordx4 v4, s[40:43], s58 offen offset:0 sc1 lds
    buffer_load_dwordx4 v4, s[40:43], s58 offen offset:1024 sc1 lds
    buffer_load_dwordx4 v4, s[40:43], s58 offen offset:2048 sc1 lds
    buffer_load_dwordx4 v4, s[40:43], s58 offen offset:3072 sc1 lds
    s_add_u32 m0, s70, 8192
    s_add_u32 s58, s58, 4096
    buffer_load_dwordx4 v4, s[40:43], s58 offen offset:0 sc1 lds
    buffer_load_dwordx4 v4, s[40:43], s58 offen offset:1024 sc1 lds
    buffer_load_dwordx4 v4, s[40:43], s58 offen offset:2048 sc1 lds
    buffer_load_dwordx4 v4, s[40:43], s58 offen offset:3072 sc1 lds
    s_add_u32 m0, s70, 12288
    s_add_u32 s58, s58, 4096
    buffer_load_dwordx4 v4, s[40:43], s58 offen offset:0 sc1 lds
    buffer_load_dwordx4 v4, s[40:43], s58 offen offset:1024 sc1 lds
    buffer_load_dwordx4 v4, s[40:43], s58 offen offset:2048 sc1 lds
    buffer_load_dwordx4 v4, s[40:43], s58 offen offset:3072 sc1 lds
    v_and_b32 v64, 1, v3
    v_mul_u32_u24 v64, 36864, v64
    v_lshl_add_u32 v64, v2, 4, v64
    v_lshrrev_b32 v65, 5, v1
    v_lshl_add_u32 v64, v65, 8, v64
    s_lshr_b32 s60, s3, 1
    s_mul_i32 s60, s60, 73728
    s_add_u32 s60, s60, 12288
    v_add_u32 v64, s60, v64
    ds_read_b64_tr_b16 a[128:129], v215 offset:16384
    ds_read_b64_tr_b16 a[130:131], v215 offset:17408
    ds_read_b64_tr_b16 a[132:133], v216 offset:16384
    ds_read_b64_tr_b16 a[134:135], v216 offset:17408
    ds_read_b64_tr_b16 a[136:137], v215 offset:18432
    ds_read_b64_tr_b16 a[138:139], v215 offset:19456
    ds_read_b64_tr_b16 a[140:141], v216 offset:18432
    ds_read_b64_tr_b16 a[142:143], v216 offset:19456
    ds_read_b64_tr_b16 a[144:145], v215 offset:20480
    ds_read_b64_tr_b16 a[146:147], v215 offset:21504
    ds_read_b64_tr_b16 a[148:149], v216 offset:20480
    ds_read_b64_tr_b16 a[150:151], v216 offset:21504
    ds_read_b64_tr_b16 a[152:153], v215 offset:22528
    ds_read_b64_tr_b16 a[154:155], v215 offset:23552
    ds_read_b64_tr_b16 a[156:157], v216 offset:22528
    ds_read_b64_tr_b16 a[158:159], v216 offset:23552
    ds_read_b64_tr_b16 a[160:161], v215 offset:24576
    ds_read_b64_tr_b16 a[162:163], v215 offset:25600
    ds_read_b64_tr_b16 a[164:165], v216 offset:24576
    ds_read_b64_tr_b16 a[166:167], v216 offset:25600
    ds_read_b64_tr_b16 a[168:169], v215 offset:26624
    ds_read_b64_tr_b16 a[170:171], v215 offset:27648
    ds_read_b64_tr_b16 a[172:173], v216 offset:26624
    ds_read_b64_tr_b16 a[174:175], v216 offset:27648
    ds_read_b64_tr_b16 a[176:177], v215 offset:28672
    ds_read_b64_tr_b16 a[178:179], v215 offset:29696
    ds_read_b64_tr_b16 a[180:181], v216 offset:28672
    ds_read_b64_tr_b16 a[182:183], v216 offset:29696
    ds_read_b64_tr_b16 a[184:185], v215 offset:30720
    ds_read_b64_tr_b16 a[186:187], v215 offset:31744
    ds_read_b64_tr_b16 a[188:189], v216 offset:30720
    ds_read_b64_tr_b16 a[190:191], v216 offset:31744
    ds_read_b64_tr_b16 a[192:193], v215 offset:32768
    ds_read_b64_tr_b16 a[194:195], v215 offset:33792
    ds_read_b64_tr_b16 a[196:197], v216 offset:32768
    ds_read_b64_tr_b16 a[198:199], v216 offset:33792
    ds_read_b64_tr_b16 a[200:201], v215 offset:34816
    ds_read_b64_tr_b16 a[202:203], v215 offset:35840
    ds_read_b64_tr_b16 a[204:205], v216 offset:34816
    ds_read_b64_tr_b16 a[206:207], v216 offset:35840
    v_lshlrev_b32 v192, 16, v192
    v_lshlrev_b32 v193, 16, v193
    v_lshlrev_b32 v194, 16, v194
    v_lshlrev_b32 v195, 16, v195
    v_lshlrev_b32 v196, 16, v196
    v_lshlrev_b32 v197, 16, v197
    v_lshlrev_b32 v198, 16, v198
    v_lshlrev_b32 v199, 16, v199
    v_lshlrev_b32 v200, 16, v200
    v_lshlrev_b32 v201, 16, v201
    v_lshlrev_b32 v202, 16, v202
    v_lshlrev_b32 v203, 16, v203
    v_lshlrev_b32 v204, 16, v204
    v_lshlrev_b32 v205, 16, v205
    v_lshlrev_b32 v206, 16, v206
    v_lshlrev_b32 v207, 16, v207
    s_waitcnt vmcnt(8)
    s_barrier
    ds_read_b128 v[32:35], v64 offset:0
    ds_read_b128 v[36:39], v64 offset:512
    ds_read_b128 v[40:43], v64 offset:1024
    ds_read_b128 v[44:47], v64 offset:1536
    ds_read_b128 v[48:51], v64 offset:2048
    ds_read_b128 v[52:55], v64 offset:2560
    s_waitcnt lgkmcnt(5)
    v_mfma_f32_32x32x16_bf16 v[192:207], v[32:35], a[0:3], v[192:207]
    ds_read_b128 v[56:59], v64 offset:3072
    s_add_u32 m0, s70, 16384
    s_mul_i32 s73, s96, 56
    s_add_u32 s73, s73, 114688
    buffer_load_dwordx4 v213, s[20:23], s73 offen lds
    s_waitcnt lgkmcnt(5)
    v_mfma_f32_32x32x16_bf16 v[192:207], v[36:39], a[4:7], v[192:207]
    ds_read_b128 v[60:63], v64 offset:3584
    s_waitcnt lgkmcnt(5)
    v_mfma_f32_32x32x16_bf16 v[192:207], v[40:43], a[8:11], v[192:207]
    ds_read_b128 v[32:35], v64 offset:4096
    s_waitcnt lgkmcnt(5)
    v_mfma_f32_32x32x16_bf16 v[192:207], v[44:47], a[12:15], v[192:207]
    ds_read_b128 v[36:39], v64 offset:4608
    s_add_u32 m0, s70, 17408
    s_mul_i32 s73, s96, 56
    s_add_u32 s73, s73, 143360
    buffer_load_dwordx4 v213, s[20:23], s73 offen lds
    s_waitcnt lgkmcnt(5)
    v_mfma_f32_32x32x16_bf16 v[192:207], v[48:51], a[16:19], v[192:207]
    ds_read_b128 v[40:43], v64 offset:5120
    s_waitcnt lgkmcnt(5)
    v_mfma_f32_32x32x16_bf16 v[192:207], v[52:55], a[20:23], v[192:207]
    ds_read_b128 v[44:47], v64 offset:5632
    s_waitcnt lgkmcnt(5)
    v_mfma_f32_32x32x16_bf16 v[192:207], v[56:59], a[24:27], v[192:207]
    ds_read_b128 v[48:51], v64 offset:6144
    s_add_u32 m0, s70, 18432
    s_mul_i32 s73, s96, 56
    s_add_u32 s73, s73, 172032
    buffer_load_dwordx4 v213, s[20:23], s73 offen lds
    s_waitcnt lgkmcnt(5)
    v_mfma_f32_32x32x16_bf16 v[192:207], v[60:63], a[28:31], v[192:207]
    ds_read_b128 v[52:55], v64 offset:6656
    s_waitcnt lgkmcnt(5)
    v_mfma_f32_32x32x16_bf16 v[192:207], v[32:35], a[32:35], v[192:207]
    ds_read_b128 v[56:59], v64 offset:7168
    s_waitcnt lgkmcnt(5)
    v_mfma_f32_32x32x16_bf16 v[192:207], v[36:39], a[36:39], v[192:207]
    ds_read_b128 v[60:63], v64 offset:7680
    s_add_u32 m0, s70, 19456
    s_mul_i32 s73, s96, 56
    s_add_u32 s73, s73, 200704
    buffer_load_dwordx4 v213, s[20:23], s73 offen lds
    s_waitcnt lgkmcnt(5)
    v_mfma_f32_32x32x16_bf16 v[192:207], v[40:43], a[40:43], v[192:207]
    s_waitcnt lgkmcnt(4)
    v_mfma_f32_32x32x16_bf16 v[192:207], v[44:47], a[44:47], v[192:207]
    s_waitcnt vmcnt(4)
    s_barrier
    ds_read_b128 v[32:35], v64 offset:8192
    ds_read_b128 v[36:39], v64 offset:8704
    s_waitcnt lgkmcnt(5)
    v_mfma_f32_32x32x16_bf16 v[192:207], v[48:51], a[48:51], v[192:207]
    ds_read_b128 v[40:43], v64 offset:9216
    s_add_u32 m0, s70, 20480
    s_mul_i32 s73, s97, 56
    s_add_u32 s73, s73, 0
    buffer_load_dwordx4 v213, s[20:23], s73 offen lds
    s_waitcnt lgkmcnt(5)
    v_mfma_f32_32x32x16_bf16 v[192:207], v[52:55], a[52:55], v[192:207]
    ds_read_b128 v[44:47], v64 offset:9728
    s_waitcnt lgkmcnt(5)
    v_mfma_f32_32x32x16_bf16 v[192:207], v[56:59], a[56:59], v[192:207]
    ds_read_b128 v[48:51], v64 offset:10240
    s_waitcnt lgkmcnt(5)
    v_mfma_f32_32x32x16_bf16 v[192:207], v[60:63], a[60:63], v[192:207]
    ds_read_b128 v[52:55], v64 offset:10752
    s_add_u32 m0, s70, 21504
    s_mul_i32 s73, s97, 56
    s_add_u32 s73, s73, 28672
    buffer_load_dwordx4 v213, s[20:23], s73 offen lds
    s_waitcnt lgkmcnt(5)
    v_mfma_f32_32x32x16_bf16 v[192:207], v[32:35], a[64:67], v[192:207]
    ds_read_b128 v[56:59], v64 offset:11264
    s_waitcnt lgkmcnt(5)
    v_mfma_f32_32x32x16_bf16 v[192:207], v[36:39], a[68:71], v[192:207]
    ds_read_b128 v[60:63], v64 offset:11776
    s_waitcnt lgkmcnt(5)
    v_mfma_f32_32x32x16_bf16 v[192:207], v[40:43], a[72:75], v[192:207]
    ds_read_b128 v[32:35], v64 offset:12288
    s_add_u32 m0, s70, 22528
    s_mul_i32 s73, s97, 56
    s_add_u32 s73, s73, 57344
    buffer_load_dwordx4 v213, s[20:23], s73 offen lds
    s_waitcnt lgkmcnt(5)
    v_mfma_f32_32x32x16_bf16 v[192:207], v[44:47], a[76:79], v[192:207]
    ds_read_b128 v[36:39], v64 offset:12800
    s_waitcnt lgkmcnt(5)
    v_mfma_f32_32x32x16_bf16 v[192:207], v[48:51], a[80:83], v[192:207]
    ds_read_b128 v[40:43], v64 offset:13312
    s_waitcnt lgkmcnt(5)
    v_mfma_f32_32x32x16_bf16 v[192:207], v[52:55], a[84:87], v[192:207]
    ds_read_b128 v[44:47], v64 offset:13824
    s_add_u32 m0, s70, 23552
    s_mul_i32 s73, s97, 56
    s_add_u32 s73, s73, 86016
    buffer_load_dwordx4 v213, s[20:23], s73 offen lds
    s_waitcnt lgkmcnt(5)
    v_mfma_f32_32x32x16_bf16 v[192:207], v[56:59], a[88:91], v[192:207]
    ds_read_b128 v[48:51], v64 offset:14336
    s_waitcnt lgkmcnt(5)
    v_mfma_f32_32x32x16_bf16 v[192:207], v[60:63], a[92:95], v[192:207]
    ds_read_b128 v[52:55], v64 offset:14848
    s_waitcnt lgkmcnt(5)
    v_mfma_f32_32x32x16_bf16 v[192:207], v[32:35], a[96:99], v[192:207]
    ds_read_b128 v[56:59], v64 offset:15360
    s_add_u32 m0, s70, 24576
    s_mul_i32 s73, s97, 56
    s_add_u32 s73, s73, 114688
    buffer_load_dwordx4 v213, s[20:23], s73 offen lds
    s_waitcnt lgkmcnt(5)
    v_mfma_f32_32x32x16_bf16 v[192:207], v[36:39], a[100:103], v[192:207]
    ds_read_b128 v[60:63], v64 offset:15872
    s_waitcnt lgkmcnt(5)
    v_mfma_f32_32x32x16_bf16 v[192:207], v[40:43], a[104:107], v[192:207]
    s_waitcnt lgkmcnt(4)
    v_mfma_f32_32x32x16_bf16 v[192:207], v[44:47], a[108:111], v[192:207]
    s_add_u32 m0, s70, 25600
    s_mul_i32 s73, s97, 56
    s_add_u32 s73, s73, 143360
    buffer_load_dwordx4 v213, s[20:23], s73 offen lds
    s_waitcnt lgkmcnt(3)
    v_mfma_f32_32x32x16_bf16 v[192:207], v[48:51], a[112:115], v[192:207]
    s_waitcnt lgkmcnt(2)
    v_mfma_f32_32x32x16_bf16 v[192:207], v[52:55], a[116:119], v[192:207]
    s_waitcnt lgkmcnt(1)
    v_mfma_f32_32x32x16_bf16 v[192:207], v[56:59], a[120:123], v[192:207]
    s_add_u32 m0, s70, 26624
    s_mul_i32 s73, s97, 56
    s_add_u32 s73, s73, 172032
    buffer_load_dwordx4 v213, s[20:23], s73 offen lds
    s_waitcnt lgkmcnt(0)
    v_mfma_f32_32x32x16_bf16 v[192:207], v[60:63], a[124:127], v[192:207]
    s_nop 11
    v_pk_mul_f32 v[68:69], v[192:193], v[192:193]
    v_pk_mul_f32 v[70:71], v[194:195], v[194:195]
    v_pk_mul_f32 v[72:73], v[196:197], v[196:197]
    v_pk_mul_f32 v[74:75], v[198:199], v[198:199]
    v_pk_mul_f32 v[76:77], v[200:201], v[200:201]
    v_pk_mul_f32 v[78:79], v[202:203], v[202:203]
    v_pk_mul_f32 v[80:81], v[204:205], v[204:205]
    v_pk_mul_f32 v[82:83], v[206:207], v[206:207]
    s_add_u32 m0, s70, 27648
    s_mul_i32 s73, s97, 56
    s_add_u32 s73, s73, 200704
    buffer_load_dwordx4 v213, s[20:23], s73 offen lds
    v_add_f32_dpp v84, v192, v192 row_mirror row_mask:0xf bank_mask:0x3
    v_add_f32_dpp v85, v193, v193 row_mirror row_mask:0xf bank_mask:0x3
    v_add_f32_dpp v86, v196, v196 row_mirror row_mask:0xf bank_mask:0x3
    v_add_f32_dpp v87, v197, v197 row_mirror row_mask:0xf bank_mask:0x3
    v_add_f32_dpp v88, v200, v200 row_mirror row_mask:0xf bank_mask:0x3
    v_add_f32_dpp v89, v201, v201 row_mirror row_mask:0xf bank_mask:0x3
    v_add_f32_dpp v90, v204, v204 row_mirror row_mask:0xf bank_mask:0x3
    v_add_f32_dpp v91, v205, v205 row_mirror row_mask:0xf bank_mask:0x3
    s_add_u32 m0, s70, 28672
    s_mul_i32 s73, s98, 56
    s_add_u32 s73, s73, 0
    buffer_load_dwordx4 v213, s[20:23], s73 offen lds
    v_add_f32_dpp v92, v68, v68 row_mirror row_mask:0xf bank_mask:0x3
    v_add_f32_dpp v93, v69, v69 row_mirror row_mask:0xf bank_mask:0x3
    v_add_f32_dpp v94, v72, v72 row_mirror row_mask:0xf bank_mask:0x3
    v_add_f32_dpp v95, v73, v73 row_mirror row_mask:0xf bank_mask:0x3
    v_add_f32_dpp v96, v76, v76 row_mirror row_mask:0xf bank_mask:0x3
    v_add_f32_dpp v97, v77, v77 row_mirror row_mask:0xf bank_mask:0x3
    v_add_f32_dpp v98, v80, v80 row_mirror row_mask:0xf bank_mask:0x3
    v_add_f32_dpp v99, v81, v81 row_mirror row_mask:0xf bank_mask:0x3
    s_add_u32 m0, s70, 29696
    s_mul_i32 s73, s98, 56
    s_add_u32 s73, s73, 28672
    buffer_load_dwordx4 v213, s[20:23], s73 offen lds
    v_add_f32_dpp v84, v194, v194 row_mirror row_mask:0xf bank_mask:0xc
    v_add_f32_dpp v85, v195, v195 row_mirror row_mask:0xf bank_mask:0xc
    v_add_f32_dpp v86, v198, v198 row_mirror row_mask:0xf bank_mask:0xc
    v_add_f32_dpp v87, v199, v199 row_mirror row_mask:0xf bank_mask:0xc
    v_add_f32_dpp v88, v202, v202 row_mirror row_mask:0xf bank_mask:0xc
    v_add_f32_dpp v89, v203, v203 row_mirror row_mask:0xf bank_mask:0xc
    v_add_f32_dpp v90, v206, v206 row_mirror row_mask:0xf bank_mask:0xc
    v_add_f32_dpp v91, v207, v207 row_mirror row_mask:0xf bank_mask:0xc
    s_add_u32 m0, s70, 30720
    s_mul_i32 s73, s98, 56
    s_add_u32 s73, s73, 57344
    buffer_load_dwordx4 v213, s[20:23], s73 offen lds
    v_add_f32_dpp v92, v70, v70 row_mirror row_mask:0xf bank_mask:0xc
    v_add_f32_dpp v93, v71, v71 row_mirror row_mask:0xf bank_mask:0xc
    v_add_f32_dpp v94, v74, v74 row_mirror row_mask:0xf bank_mask:0xc
    v_add_f32_dpp v95, v75, v75 row_mirror row_mask:0xf bank_mask:0xc
    v_add_f32_dpp v96, v78, v78 row_mirror row_mask:0xf bank_mask:0xc
    v_add_f32_dpp v97, v79, v79 row_mirror row_mask:0xf bank_mask:0xc
    v_add_f32_dpp v98, v82, v82 row_mirror row_mask:0xf bank_mask:0xc
    v_add_f32_dpp v99, v83, v83 row_mirror row_mask:0xf bank_mask:0xc
    s_add_u32 m0, s70, 31744
    s_mul_i32 s73, s98, 56
    s_add_u32 s73, s73, 86016
    buffer_load_dwordx4 v213, s[20:23], s73 offen lds
    v_add_f32_dpp v84, v84, v84 row_half_mirror row_mask:0xf bank_mask:0x5
    v_add_f32_dpp v86, v86, v86 row_half_mirror row_mask:0xf bank_mask:0x5
    v_add_f32_dpp v88, v88, v88 row_half_mirror row_mask:0xf bank_mask:0x5
    v_add_f32_dpp v90, v90, v90 row_half_mirror row_mask:0xf bank_mask:0x5
    v_add_f32_dpp v92, v92, v92 row_half_mirror row_mask:0xf bank_mask:0x5
    v_add_f32_dpp v94, v94, v94 row_half_mirror row_mask:0xf bank_mask:0x5
    v_add_f32_dpp v96, v96, v96 row_half_mirror row_mask:0xf bank_mask:0x5
    v_add_f32_dpp v98, v98, v98 row_half_mirror row_mask:0xf bank_mask:0x5
    v_add_f32_dpp v84, v85, v85 row_half_mirror row_mask:0xf bank_mask:0xa
    v_add_f32_dpp v86, v87, v87 row_half_mirror row_mask:0xf bank_mask:0xa
    v_add_f32_dpp v88, v89, v89 row_half_mirror row_mask:0xf bank_mask:0xa
    v_add_f32_dpp v90, v91, v91 row_half_mirror row_mask:0xf bank_mask:0xa
    v_add_f32_dpp v92, v93, v93 row_half_mirror row_mask:0xf bank_mask:0xa
    v_add_f32_dpp v94, v95, v95 row_half_mirror row_mask:0xf bank_mask:0xa
    v_add_f32_dpp v96, v97, v97 row_half_mirror row_mask:0xf bank_mask:0xa
    v_add_f32_dpp v98, v99, v99 row_half_mirror row_mask:0xf bank_mask:0xa
    v_add_f32_dpp v85, v84, v84 quad_perm:[1,0,3,2] row_mask:0xf bank_mask:0xf
    v_add_f32_dpp v87, v86, v86 quad_perm:[1,0,3,2] row_mask:0xf bank_mask:0xf
    v_add_f32_dpp v89, v88, v88 quad_perm:[1,0,3,2] row_mask:0xf bank_mask:0xf
    v_add_f32_dpp v91, v90, v90 quad_perm:[1,0,3,2] row_mask:0xf bank_mask:0xf
    v_add_f32_dpp v93, v92, v92 quad_perm:[1,0,3,2] row_mask:0xf bank_mask:0xf
    v_add_f32_dpp v95, v94, v94 quad_perm:[1,0,3,2] row_mask:0xf bank_mask:0xf
    v_add_f32_dpp v97, v96, v96 quad_perm:[1,0,3,2] row_mask:0xf bank_mask:0xf
    v_add_f32_dpp v99, v98, v98 quad_perm:[1,0,3,2] row_mask:0xf bank_mask:0xf
    v_add_f32_dpp v68, v85, v85 quad_perm:[2,3,0,1] row_mask:0xf bank_mask:0xf
    v_add_f32_dpp v69, v87, v87 quad_perm:[2,3,0,1] row_mask:0xf bank_mask:0xf
    v_add_f32_dpp v70, v89, v89 quad_perm:[2,3,0,1] row_mask:0xf bank_mask:0xf
    v_add_f32_dpp v71, v91, v91 quad_perm:[2,3,0,1] row_mask:0xf bank_mask:0xf
    v_add_f32_dpp v72, v93, v93 quad_perm:[2,3,0,1] row_mask:0xf bank_mask:0xf
    v_add_f32_dpp v73, v95, v95 quad_perm:[2,3,0,1] row_mask:0xf bank_mask:0xf
    v_add_f32_dpp v74, v97, v97 quad_perm:[2,3,0,1] row_mask:0xf bank_mask:0xf
    v_add_f32_dpp v75, v99, v99 quad_perm:[2,3,0,1] row_mask:0xf bank_mask:0xf
    v_permlane16_swap_b32 v68, v69
    v_permlane16_swap_b32 v70, v71
    v_permlane16_swap_b32 v72, v73
    v_permlane16_swap_b32 v74, v75
    v_add_f32 v84, v68, v69
    v_add_f32 v85, v72, v73
    v_add_f32 v86, v70, v71
    v_add_f32 v87, v74, v75
    v_and_b32 v65, 1, v3
    v_lshlrev_b32 v65, 6, v65
    v_lshrrev_b32 v66, 5, v1
    v_lshl_add_u32 v65, v66, 5, v65
    v_bfe_u32 v67, v1, 2, 2
    v_lshl_add_u32 v65, v67, 3, v65
    s_lshl_b32 s58, s3, 8
    v_add_u32 v65, s58, v65
    ds_write_b64 v65, v[84:85] offset:0
    ds_write_b64 v65, v[86:87] offset:128
    v_and_b32 v67, 31, v1
    v_lshlrev_b32 v65, 9, v66
    v_lshl_add_u32 v65, v67, 4, v65
    v_lshlrev_b32 v66, 8, v66
    v_lshl_add_u32 v66, v67, 3, v66
    s_and_b32 s58, s58, 512
    v_add_u32 v66, s58, v66
    s_lshl_b32 s58, s67, 1
    s_lshr_b32 s60, s3, 1
    s_add_u32 s58, s58, s60
    s_lshl_b32 s58, s58, 12
    s_add_u32 s58, s58, 0x548000
    s_lshl_b32 s60, s66, 9
    s_add_u32 s60, s60, s58
    s_waitcnt lgkmcnt(0)
    s_barrier
    ds_read_b64 v[84:85], v66 offset:0
    v_mov_b32 v89, s4
    v_mov_b32 v91, s4
    s_waitcnt lgkmcnt(0)
    v_mov_b32 v88, v84
    v_mov_b32 v90, v85
    s_nop 0
    v_permlane32_swap_b32 v88, v84
    v_permlane32_swap_b32 v90, v85
    v_add_f32 v88, v88, v84
    v_add_f32 v90, v90, v85
    s_bitcmp0_b32 s3, 0
    s_cselect_b32 exec_lo, -1, 0
    s_mov_b32 exec_hi, 0
    buffer_store_dwordx4 v[88:91], v65, s[40:43], s60 offen sc1
    s_mov_b64 exec, -1
    v_cvt_pk_bf16_f32 v240, v192, v193
    v_cvt_pk_bf16_f32 v241, v194, v195
    v_cvt_pk_bf16_f32 v242, v196, v197
    v_cvt_pk_bf16_f32 v243, v198, v199
    v_cvt_pk_bf16_f32 v244, v200, v201
    v_cvt_pk_bf16_f32 v245, v202, v203
    v_cvt_pk_bf16_f32 v246, v204, v205
    v_cvt_pk_bf16_f32 v247, v206, v207
    s_lshl_b32 s61, s66, 1
    s_and_b32 s60, s3, 1
    s_add_u32 s61, s61, s60
    s_lshl_b32 s61, s61, 7
    s_lshl_b32 s60, s67, 2
    s_add_u32 s61, s61, s60
    s_and_b32 s60, s3, 2
    s_add_u32 s61, s61, s60
    s_lshl_b32 s61, s61, 10
    s_add_u32 s61, s61, 0x200000
    v_lshlrev_b32 v66, 4, v67
    v_cmp_gt_u32 s[86:87], 32, v1
    s_add_u32 m0, s70, 0
    s_mul_i32 s73, s98, 56
    s_add_u32 s73, s73, 114688
    buffer_load_dwordx4 v213, s[20:23], s73 offen lds
    s_add_u32 m0, s70, 1024
    s_mul_i32 s73, s98, 56
    s_add_u32 s73, s73, 143360
    buffer_load_dwordx4 v213, s[20:23], s73 offen lds
    s_add_u32 m0, s70, 2048
    s_mul_i32 s73, s98, 56
    s_add_u32 s73, s73, 172032
    buffer_load_dwordx4 v213, s[20:23], s73 offen lds
    s_add_u32 m0, s70, 3072
    s_mul_i32 s73, s98, 56
    s_add_u32 s73, s73, 200704
    buffer_load_dwordx4 v213, s[20:23], s73 offen lds
    s_add_u32 m0, s70, 4096
    s_mul_i32 s73, s99, 56
    s_add_u32 s73, s73, 0
    buffer_load_dwordx4 v213, s[20:23], s73 offen lds
    s_add_u32 m0, s70, 5120
    s_mul_i32 s73, s99, 56
    s_add_u32 s73, s73, 28672
    buffer_load_dwordx4 v213, s[20:23], s73 offen lds
    s_add_u32 m0, s70, 6144
    s_mul_i32 s73, s99, 56
    s_add_u32 s73, s73, 57344
    buffer_load_dwordx4 v213, s[20:23], s73 offen lds
    s_add_u32 m0, s70, 7168
    s_mul_i32 s73, s99, 56
    s_add_u32 s73, s73, 86016
    buffer_load_dwordx4 v213, s[20:23], s73 offen lds
    s_add_u32 m0, s70, 8192
    s_mul_i32 s73, s99, 56
    s_add_u32 s73, s73, 114688
    buffer_load_dwordx4 v213, s[20:23], s73 offen lds
    s_add_u32 m0, s70, 9216
    s_mul_i32 s73, s99, 56
    s_add_u32 s73, s73, 143360
    buffer_load_dwordx4 v213, s[20:23], s73 offen lds
    s_add_u32 m0, s70, 10240
    s_mul_i32 s73, s99, 56
    s_add_u32 s73, s73, 172032
    buffer_load_dwordx4 v213, s[20:23], s73 offen lds
    s_add_u32 m0, s70, 11264
    s_mul_i32 s73, s99, 56
    s_add_u32 s73, s73, 200704
    buffer_load_dwordx4 v213, s[20:23], s73 offen lds
    s_add_u32 m0, s70, 12288
    s_mul_i32 s73, s100, 56
    s_add_u32 s73, s73, 0
    buffer_load_dwordx4 v213, s[20:23], s73 offen lds
    s_add_u32 m0, s70, 13312
    s_mul_i32 s73, s100, 56
    s_add_u32 s73, s73, 28672
    buffer_load_dwordx4 v213, s[20:23], s73 offen lds
    s_add_u32 m0, s70, 14336
    s_mul_i32 s73, s100, 56
    s_add_u32 s73, s73, 57344
    buffer_load_dwordx4 v213, s[20:23], s73 offen lds
    s_add_u32 m0, s70, 15360
    s_mul_i32 s73, s100, 56
    s_add_u32 s73, s73, 86016
    buffer_load_dwordx4 v213, s[20:23], s73 offen lds
    buffer_load_dwordx4 v[96:99], v65, s[40:43], s58 offen offset:0 sc1
    buffer_load_dwordx4 v[100:103], v65, s[40:43], s58 offen offset:1024 sc1
    buffer_load_dwordx4 v[104:107], v65, s[40:43], s58 offen offset:2048 sc1
    buffer_load_dwordx4 v[108:111], v66, s[40:43], s58 offen offset:3072 sc1
    s_sleep 5
    s_nop 0
Lst_P_6:
    s_sub_u32 s6, s6, 1
    s_cbranch_scc1 L_end_P
    buffer_load_dwordx4 v[112:115], v65, s[40:43], s58 offen offset:0 sc1
    buffer_load_dwordx4 v[116:119], v65, s[40:43], s58 offen offset:1024 sc1
    buffer_load_dwordx4 v[120:123], v65, s[40:43], s58 offen offset:2048 sc1
    buffer_load_dwordx4 v[124:127], v66, s[40:43], s58 offen offset:3072 sc1
    s_waitcnt vmcnt(4)
    v_xor_b32 v97, s4, v97
    v_xor_b32 v99, s4, v99
    v_xor_b32 v101, s4, v101
    v_xor_b32 v103, s4, v103
    v_xor_b32 v105, s4, v105
    v_xor_b32 v107, s4, v107
    v_xor_b32 v109, s4, v109
    v_xor_b32 v111, s4, v111
    v_cndmask_b32 v108, 0, v108, s[86:87]
    v_cndmask_b32 v110, 0, v110, s[86:87]
    v_or3_b32 v97, v97, v99, v101
    v_or3_b32 v103, v103, v105, v107
    v_or3_b32 v97, v97, v109, v111
    v_or_b32 v97, v97, v103
    v_cmp_ne_u32 vcc, 0, v97
    v_add_f32 v128, v96, v100
    v_add_f32 v129, v104, v108
    v_add_f32 v130, v98, v102
    v_add_f32 v131, v106, v110
    s_cbranch_vccz Lstd_P_7
    buffer_load_dwordx4 v[96:99], v65, s[40:43], s58 offen offset:0 sc1
    buffer_load_dwordx4 v[100:103], v65, s[40:43], s58 offen offset:1024 sc1
    buffer_load_dwordx4 v[104:107], v65, s[40:43], s58 offen offset:2048 sc1
    buffer_load_dwordx4 v[108:111], v66, s[40:43], s58 offen offset:3072 sc1
    s_waitcnt vmcnt(4)
    v_xor_b32 v113, s4, v113
    v_xor_b32 v115, s4, v115
    v_xor_b32 v117, s4, v117
    v_xor_b32 v119, s4, v119
    v_xor_b32 v121, s4, v121
    v_xor_b32 v123, s4, v123
    v_xor_b32 v125, s4, v125
    v_xor_b32 v127, s4, v127
    v_cndmask_b32 v124, 0, v124, s[86:87]
    v_cndmask_b32 v126, 0, v126, s[86:87]
    v_or3_b32 v113, v113, v115, v117
    v_or3_b32 v119, v119, v121, v123
    v_or3_b32 v113, v113, v125, v127
    v_or_b32 v113, v113, v119
    v_cmp_ne_u32 vcc, 0, v113
    v_add_f32 v128, v112, v116
    v_add_f32 v129, v120, v124
    v_add_f32 v130, v114, v118
    v_add_f32 v131, v122, v126
    s_cbranch_vccnz Lst_P_6
    s_nop 3
Lstd_P_7:
    v_add_f32 v128, v128, v129
    v_add_f32 v130, v130, v131
    v_mov_b32 v136, v128
    v_mov_b32 v138, v130
    s_nop 0
    v_permlane32_swap_b32 v128, v136
    v_permlane32_swap_b32 v130, v138
    v_add_f32 v128, v128, v136
    v_add_f32 v130, v130, v138
    v_mul_f32 v133, 0x3b124925, v128
    v_mul_f32 v130, 0x3b124925, v130
    v_fma_f32 v130, -v133, v133, v130
    v_max_f32 v130, 0, v130
    v_add_f32 v135, 0x3727c5ac, v130
    v_rsq_f32 v135, v135
    s_nop 0
    v_mul_f32 v130, v130, v135
    v_fmaak_f32 v130, v130, v135, 0x3727c5ac
    v_rsq_f32 v130, v130
    s_nop 0
    v_mul_f32 v135, v135, v130
    s_lshl_b32 s60, s3, 8
    v_lshl_add_u32 v66, v67, 2, s60
    ds_write_b32 v66, v133 offset:1024
    ds_write_b32 v66, v135 offset:1152
    v_lshrrev_b32 v66, 5, v1
    v_lshl_add_u32 v66, v66, 4, s60
    s_waitcnt lgkmcnt(0)
    ds_read_b128 v[140:143], v66 offset:1024
    ds_read_b128 v[156:159], v66 offset:1152
    ds_read_b128 v[144:147], v66 offset:1056
    ds_read_b128 v[160:163], v66 offset:1184
    ds_read_b128 v[148:151], v66 offset:1088
    ds_read_b128 v[164:167], v66 offset:1216
    ds_read_b128 v[152:155], v66 offset:1120
    ds_read_b128 v[168:171], v66 offset:1248
    s_waitcnt lgkmcnt(7)
    v_pk_add_f32 v[192:193], v[192:193], v[140:141] neg_lo:[0,1] neg_hi:[0,1]
    v_pk_add_f32 v[194:195], v[194:195], v[142:143] neg_lo:[0,1] neg_hi:[0,1]
    s_waitcnt lgkmcnt(5)
    v_pk_add_f32 v[196:197], v[196:197], v[144:145] neg_lo:[0,1] neg_hi:[0,1]
    v_pk_add_f32 v[198:199], v[198:199], v[146:147] neg_lo:[0,1] neg_hi:[0,1]
    v_pk_mul_f32 v[192:193], v[192:193], v[156:157]
    v_pk_mul_f32 v[194:195], v[194:195], v[158:159]
    s_waitcnt lgkmcnt(4)
    v_pk_mul_f32 v[196:197], v[196:197], v[160:161]
    v_pk_mul_f32 v[198:199], v[198:199], v[162:163]
    v_cvt_pk_bf16_f32 v84, v192, v193
    v_cvt_pk_bf16_f32 v85, v194, v195
    v_cvt_pk_bf16_f32 v86, v196, v197
    v_cvt_pk_bf16_f32 v87, v198, v199
    buffer_store_dwordx4 v[84:87], v4, s[40:43], s61 offen offset:0 sc1
    s_waitcnt lgkmcnt(3)
    v_pk_add_f32 v[200:201], v[200:201], v[148:149] neg_lo:[0,1] neg_hi:[0,1]
    v_pk_add_f32 v[202:203], v[202:203], v[150:151] neg_lo:[0,1] neg_hi:[0,1]
    s_waitcnt lgkmcnt(1)
    v_pk_add_f32 v[204:205], v[204:205], v[152:153] neg_lo:[0,1] neg_hi:[0,1]
    v_pk_add_f32 v[206:207], v[206:207], v[154:155] neg_lo:[0,1] neg_hi:[0,1]
    v_pk_mul_f32 v[200:201], v[200:201], v[164:165]
    v_pk_mul_f32 v[202:203], v[202:203], v[166:167]
    s_waitcnt lgkmcnt(0)
    v_pk_mul_f32 v[204:205], v[204:205], v[168:169]
    v_pk_mul_f32 v[206:207], v[206:207], v[170:171]
    v_cvt_pk_bf16_f32 v88, v200, v201
    v_cvt_pk_bf16_f32 v89, v202, v203
    v_cvt_pk_bf16_f32 v90, v204, v205
    v_cvt_pk_bf16_f32 v91, v206, v207
    buffer_store_dwordx4 v[88:91], v4, s[40:43], s61 offen offset:1024 sc1
    ds_read_b64_tr_b16 a[208:209], v215 offset:16384
    ds_read_b64_tr_b16 a[210:211], v215 offset:17408
    ds_read_b64_tr_b16 a[212:213], v216 offset:16384
    ds_read_b64_tr_b16 a[214:215], v216 offset:17408
    ds_read_b64_tr_b16 a[216:217], v215 offset:18432
    ds_read_b64_tr_b16 a[218:219], v215 offset:19456
    ds_read_b64_tr_b16 a[220:221], v216 offset:18432
    ds_read_b64_tr_b16 a[222:223], v216 offset:19456
    ds_read_b64_tr_b16 a[224:225], v215 offset:20480
    ds_read_b64_tr_b16 a[226:227], v215 offset:21504
    ds_read_b64_tr_b16 a[228:229], v216 offset:20480
    ds_read_b64_tr_b16 a[230:231], v216 offset:21504
    ds_read_b64_tr_b16 a[232:233], v215 offset:22528
    ds_read_b64_tr_b16 a[234:235], v215 offset:23552
    ds_read_b64_tr_b16 a[236:237], v216 offset:22528
    ds_read_b64_tr_b16 a[238:239], v216 offset:23552
    ds_read_b64_tr_b16 a[240:241], v215 offset:24576
    ds_read_b64_tr_b16 a[242:243], v215 offset:25600
    ds_read_b64_tr_b16 a[244:245], v216 offset:24576
    ds_read_b64_tr_b16 a[246:247], v216 offset:25600
    ds_read_b64_tr_b16 a[248:249], v215 offset:26624
    ds_read_b64_tr_b16 a[250:251], v215 offset:27648
    ds_read_b64_tr_b16 a[252:253], v216 offset:26624
    ds_read_b64_tr_b16 a[254:255], v216 offset:27648
    ds_read_b64_tr_b16 a[0:1], v215 offset:28672
    ds_read_b64_tr_b16 a[2:3], v215 offset:29696
    ds_read_b64_tr_b16 a[4:5], v216 offset:28672
    ds_read_b64_tr_b16 a[6:7], v216 offset:29696
    ds_read_b64_tr_b16 a[8:9], v215 offset:30720
    ds_read_b64_tr_b16 a[10:11], v215 offset:31744
    ds_read_b64_tr_b16 a[12:13], v216 offset:30720
    ds_read_b64_tr_b16 a[14:15], v216 offset:31744
    ds_read_b64_tr_b16 a[16:17], v215 offset:0
    ds_read_b64_tr_b16 a[18:19], v215 offset:1024
    ds_read_b64_tr_b16 a[20:21], v216 offset:0
    ds_read_b64_tr_b16 a[22:23], v216 offset:1024
    ds_read_b64_tr_b16 a[24:25], v215 offset:2048
    ds_read_b64_tr_b16 a[26:27], v215 offset:3072
    ds_read_b64_tr_b16 a[28:29], v216 offset:2048
    ds_read_b64_tr_b16 a[30:31], v216 offset:3072
    ds_read_b64_tr_b16 a[32:33], v215 offset:4096
    ds_read_b64_tr_b16 a[34:35], v215 offset:5120
    ds_read_b64_tr_b16 a[36:37], v216 offset:4096
    ds_read_b64_tr_b16 a[38:39], v216 offset:5120
    ds_read_b64_tr_b16 a[40:41], v215 offset:6144
    ds_read_b64_tr_b16 a[42:43], v215 offset:7168
    ds_read_b64_tr_b16 a[44:45], v216 offset:6144
    ds_read_b64_tr_b16 a[46:47], v216 offset:7168
    ds_read_b64_tr_b16 a[48:49], v215 offset:8192
    ds_read_b64_tr_b16 a[50:51], v215 offset:9216
    ds_read_b64_tr_b16 a[52:53], v216 offset:8192
    ds_read_b64_tr_b16 a[54:55], v216 offset:9216
    ds_read_b64_tr_b16 a[56:57], v215 offset:10240
    ds_read_b64_tr_b16 a[58:59], v215 offset:11264
    ds_read_b64_tr_b16 a[60:61], v216 offset:10240
    ds_read_b64_tr_b16 a[62:63], v216 offset:11264
    ds_read_b64_tr_b16 a[64:65], v215 offset:12288
    ds_read_b64_tr_b16 a[66:67], v215 offset:13312
    ds_read_b64_tr_b16 a[68:69], v216 offset:12288
    ds_read_b64_tr_b16 a[70:71], v216 offset:13312
    ds_read_b64_tr_b16 a[72:73], v215 offset:14336
    ds_read_b64_tr_b16 a[74:75], v215 offset:15360
    ds_read_b64_tr_b16 a[76:77], v216 offset:14336
    ds_read_b64_tr_b16 a[78:79], v216 offset:15360
    s_waitcnt vmcnt(0)
    v_mov_b32 v8, s4
    s_mov_b64 exec, 1
    buffer_store_dword v8, v9, s[40:43], s81 offen sc1
    s_mov_b64 exec, -1
    s_waitcnt lgkmcnt(4)
    s_add_u32 m0, s70, 12288
    s_mul_i32 s73, s100, 56
    s_add_u32 s73, s73, 114688
    buffer_load_dwordx4 v213, s[20:23], s73 offen lds
    s_add_u32 m0, s70, 13312
    s_mul_i32 s73, s100, 56
    s_add_u32 s73, s73, 143360
    buffer_load_dwordx4 v213, s[20:23], s73 offen lds
    s_waitcnt lgkmcnt(0)
    s_add_u32 m0, s70, 14336
    s_mul_i32 s73, s100, 56
    s_add_u32 s73, s73, 172032
    buffer_load_dwordx4 v213, s[20:23], s73 offen lds
    s_add_u32 m0, s70, 15360
    s_mul_i32 s73, s100, 56
    s_add_u32 s73, s73, 200704
    buffer_load_dwordx4 v213, s[20:23], s73 offen lds
    s_add_u32 m0, s70, 16384
    s_mul_i32 s73, s101, 56
    s_add_u32 s73, s73, 0
    buffer_load_dwordx4 v213, s[20:23], s73 offen lds
    s_add_u32 m0, s70, 17408
    s_mul_i32 s73, s101, 56
    s_add_u32 s73, s73, 28672
    buffer_load_dwordx4 v213, s[20:23], s73 offen lds
    s_add_u32 m0, s70, 18432
    s_mul_i32 s73, s101, 56
    s_add_u32 s73, s73, 57344
    buffer_load_dwordx4 v213, s[20:23], s73 offen lds
    s_add_u32 m0, s70, 19456
    s_mul_i32 s73, s101, 56
    s_add_u32 s73, s73, 86016
    buffer_load_dwordx4 v213, s[20:23], s73 offen lds
    s_add_u32 m0, s70, 20480
    s_mul_i32 s73, s101, 56
    s_add_u32 s73, s73, 114688
    buffer_load_dwordx4 v213, s[20:23], s73 offen lds
    s_add_u32 m0, s70, 21504
    s_mul_i32 s73, s101, 56
    s_add_u32 s73, s73, 143360
    buffer_load_dwordx4 v213, s[20:23], s73 offen lds
    s_add_u32 m0, s70, 22528
    s_mul_i32 s73, s101, 56
    s_add_u32 s73, s73, 172032
    buffer_load_dwordx4 v213, s[20:23], s73 offen lds
    s_add_u32 m0, s70, 23552
    s_mul_i32 s73, s101, 56
    s_add_u32 s73, s73, 200704
    buffer_load_dwordx4 v213, s[20:23], s73 offen lds
    s_add_u32 m0, s70, 24576
    s_mul_i32 s73, s48, 64
    s_add_u32 s73, s73, 0
    buffer_load_dwordx4 v214, s[24:27], s73 offen lds
    s_add_u32 m0, s70, 25600
    s_mul_i32 s73, s48, 64
    s_add_u32 s73, s73, 32768
    buffer_load_dwordx4 v214, s[24:27], s73 offen lds
    s_add_u32 m0, s70, 26624
    s_mul_i32 s73, s48, 64
    s_add_u32 s73, s73, 65536
    buffer_load_dwordx4 v214, s[24:27], s73 offen lds
    s_add_u32 m0, s70, 27648
    s_mul_i32 s73, s48, 64
    s_add_u32 s73, s73, 98304
    buffer_load_dwordx4 v214, s[24:27], s73 offen lds
    s_add_u32 m0, s70, 28672
    s_mul_i32 s73, s48, 64
    s_add_u32 s73, s73, 131072
    buffer_load_dwordx4 v214, s[24:27], s73 offen lds
    s_add_u32 m0, s70, 29696
    s_mul_i32 s73, s48, 64
    s_add_u32 s73, s73, 163840
    buffer_load_dwordx4 v214, s[24:27], s73 offen lds
    s_add_u32 m0, s70, 30720
    s_mul_i32 s73, s48, 64
    s_add_u32 s73, s73, 196608
    buffer_load_dwordx4 v214, s[24:27], s73 offen lds
    s_add_u32 m0, s70, 31744
    s_mul_i32 s73, s48, 64
    s_add_u32 s73, s73, 229376
    buffer_load_dwordx4 v214, s[24:27], s73 offen lds
    s_add_u32 m0, s70, 32768
    s_mul_i32 s73, s49, 64
    s_add_u32 s73, s73, 0
    buffer_load_dwordx4 v214, s[24:27], s73 offen lds
    s_add_u32 m0, s70, 33792
    s_mul_i32 s73, s49, 64
    s_add_u32 s73, s73, 32768
    buffer_load_dwordx4 v214, s[24:27], s73 offen lds
    s_add_u32 m0, s70, 34816
    s_mul_i32 s73, s49, 64
    s_add_u32 s73, s73, 65536
    buffer_load_dwordx4 v214, s[24:27], s73 offen lds
    s_add_u32 m0, s70, 35840
    s_mul_i32 s73, s49, 64
    s_add_u32 s73, s73, 98304
    buffer_load_dwordx4 v214, s[24:27], s73 offen lds
    s_lshl_b32 s71, s64, 18
    s_lshl_b32 s86, s3, 15
    s_add_u32 s71, s71, s86
    s_add_u32 s71, s71, 0x200000
    s_add_u32 s72, s71, 0x20000
    s_mul_i32 s58, s66, 229376
    s_add_u32 s58, s58, 0x3c0000
    s_lshl_b32 s86, s65, 2
    s_add_u32 s86, s86, s3
    s_lshl_b32 s86, s86, 10
    s_add_u32 s57, s58, s86
    s_mul_i32 s86, s3, 28672
    s_add_u32 s58, s58, s86
    s_add_u32 s59, s58, 114688
    v_lshrrev_b32 v208, 5, v1
    v_lshlrev_b32 v208, 3, v208
    s_lshl_b32 s86, s65, 7
    s_lshl_b32 s87, s3, 5
    s_add_u32 s86, s86, s87
    buffer_load_dwordx2 v[220:221], v208, s[28:31], s86 offen offset:0
    buffer_load_dwordx2 v[222:223], v208, s[28:31], s86 offen offset:16
    s_lshl_b32 s86, s67, 7
    s_lshr_b32 s87, s3, 1
    s_lshl_b32 s87, s87, 6
    s_add_u32 s86, s86, s87
    buffer_load_dwordx2 v[224:225], v208, s[32:35], s86 offen offset:0
    buffer_load_dwordx2 v[226:227], v208, s[32:35], s86 offen offset:16
    buffer_load_dwordx2 v[228:229], v208, s[32:35], s86 offen offset:32
    buffer_load_dwordx2 v[230:231], v208, s[32:35], s86 offen offset:48
    v_add_u32 v232, s70, v4
    s_xor_b32 s86, s3, 1
    s_mul_i32 s86, s86, 36864
    s_add_u32 s86, s86, 12288
    v_add_u32 v233, s86, v4
    s_xor_b32 s86, s3, 2
    s_mul_i32 s86, s86, 36864
    s_add_u32 s86, s86, 14336
    v_add_u32 v234, s86, v4
    s_xor_b32 s86, s3, 3
    s_mul_i32 s86, s86, 36864
    s_add_u32 s86, s86, 16384
    v_add_u32 v235, s86, v4
    v_lshrrev_b32 v208, 5, v1
    v_lshlrev_b32 v208, 9, v208
    v_and_b32 v209, 31, v1
    v_lshl_add_u32 v208, v209, 2, v208
    s_lshr_b32 s86, s3, 1
    s_lshl_b32 s86, s86, 12
    v_add_u32 v208, s86, v208
    v_xor_b32 v209, 0x1000, v208
    v_add_u32 v236, s70, v208
    v_add_u32 v237, s70, v209
    s_lshl_b32 s86, s3, 11
    s_add_u32 s86, s86, 12288
    v_add_u32 v238, s86, v4
    v_add_u32 v239, 73728, v238
    v_lshrrev_b32 v208, 3, v1
    v_mul_u32_u24 v212, 896, v208
    v_and_b32 v208, 7, v1
    v_lshl_add_u32 v212, v208, 3, v212
    s_lshl_b32 s68, s67, 2
    s_add_u32 s68, s68, s3
    s_mul_i32 s68, s68, 14336
    s_lshl_b32 s86, s66, 7
    s_add_u32 s68, s68, s86
    s_add_u32 s69, s68, 7168
    s_mov_b32 s88, 0xc0135761
    s_mov_b32 s89, 0xc0135761
    s_mov_b32 s90, 0xbdd2d3e8
    s_mov_b32 s91, 0xffff0000
    buffer_load_dword v249, v11, s[40:43], s84 offen sc1
    s_sleep 3
    buffer_load_dword v250, v11, s[40:43], s84 offen sc1
    s_sleep 3
    s_nop 0
Lpoll_P_8:
    s_sub_u32 s6, s6, 1
    s_cbranch_scc1 L_end_P
    buffer_load_dword v251, v11, s[40:43], s84 offen sc1
    s_waitcnt vmcnt(2)
    v_cmp_ne_u32 vcc, s4, v249
    s_nop 1
    s_cbranch_vccz Lpd_P_9
    buffer_load_dword v249, v11, s[40:43], s84 offen sc1
    s_waitcnt vmcnt(2)
    v_cmp_ne_u32 vcc, s4, v250
    s_nop 1
    s_cbranch_vccz Lpd_P_9
    buffer_load_dword v250, v11, s[40:43], s84 offen sc1
    s_waitcnt vmcnt(2)
    v_cmp_ne_u32 vcc, s4, v251
    s_nop 1
    s_cbranch_vccnz Lpoll_P_8
    s_nop 1
Lpd_P_9:
    s_add_u32 s56, s71, s94
    buffer_load_dwordx4 v[80:83], v5, s[40:43], s56 offen offset:0 sc1
    buffer_load_dwordx4 v[84:87], v5, s[40:43], s56 offen offset:1024 sc1
    buffer_load_dwordx4 v[88:91], v5, s[40:43], s56 offen offset:2048 sc1
    buffer_load_dwordx4 v[92:95], v5, s[40:43], s56 offen offset:3072 sc1
    s_add_u32 s56, s71, s95
    buffer_load_dwordx4 v[96:99], v5, s[40:43], s56 offen offset:0 sc1
    buffer_load_dwordx4 v[100:103], v5, s[40:43], s56 offen offset:1024 sc1
    buffer_load_dwordx4 v[104:107], v5, s[40:43], s56 offen offset:2048 sc1
    buffer_load_dwordx4 v[108:111], v5, s[40:43], s56 offen offset:3072 sc1
    v_lshlrev_b32 v16, 16, v220
    v_and_b32 v17, s91, v220
    v_lshlrev_b32 v18, 16, v221
    v_and_b32 v19, s91, v221
    v_lshlrev_b32 v20, 16, v222
    v_and_b32 v21, s91, v222
    v_lshlrev_b32 v22, 16, v223
    v_and_b32 v23, s91, v223
    v_mov_b64 v[24:25], 0
    v_mov_b64 v[26:27], 0
    v_mov_b64 v[28:29], 0
    v_mov_b64 v[30:31], 0
    ds_read_b64_tr_b16 a[80:81], v215 offset:12288
    ds_read_b64_tr_b16 a[82:83], v215 offset:13312
    ds_read_b64_tr_b16 a[84:85], v216 offset:12288
    ds_read_b64_tr_b16 a[86:87], v216 offset:13312
    ds_read_b64_tr_b16 a[88:89], v215 offset:14336
    ds_read_b64_tr_b16 a[90:91], v215 offset:15360
    ds_read_b64_tr_b16 a[92:93], v216 offset:14336
    ds_read_b64_tr_b16 a[94:95], v216 offset:15360
    ds_read_b64_tr_b16 a[96:97], v215 offset:16384
    ds_read_b64_tr_b16 a[98:99], v215 offset:17408
    ds_read_b64_tr_b16 a[100:101], v216 offset:16384
    ds_read_b64_tr_b16 a[102:103], v216 offset:17408
    ds_read_b64_tr_b16 a[104:105], v215 offset:18432
    ds_read_b64_tr_b16 a[106:107], v215 offset:19456
    ds_read_b64_tr_b16 a[108:109], v216 offset:18432
    ds_read_b64_tr_b16 a[110:111], v216 offset:19456
    ds_read_b64_tr_b16 a[112:113], v215 offset:20480
    ds_read_b64_tr_b16 a[114:115], v215 offset:21504
    ds_read_b64_tr_b16 a[116:117], v216 offset:20480
    ds_read_b64_tr_b16 a[118:119], v216 offset:21504
    ds_read_b64_tr_b16 a[120:121], v215 offset:22528
    ds_read_b64_tr_b16 a[122:123], v215 offset:23552
    ds_read_b64_tr_b16 a[124:125], v216 offset:22528
    ds_read_b64_tr_b16 a[126:127], v216 offset:23552
    v_mov_b32 v9, v5
    s_add_u32 s56, s71, s96
    buffer_load_dwordx4 v[112:115], v5, s[40:43], s56 offen offset:0 sc1
    buffer_load_dwordx4 v[116:119], v5, s[40:43], s56 offen offset:1024 sc1
    s_waitcnt vmcnt(9)
    v_mfma_f32_32x32x16_bf16 v[16:31], a[128:131], v[80:83], v[16:31]
    v_mfma_f32_32x32x16_bf16 v[32:47], a[132:135], v[80:83], 0
    buffer_load_dwordx4 v[120:123], v5, s[40:43], s56 offen offset:2048 sc1
    s_waitcnt vmcnt(9)
    v_mfma_f32_32x32x16_bf16 v[16:31], a[136:139], v[84:87], v[16:31]
    v_mfma_f32_32x32x16_bf16 v[32:47], a[140:143], v[84:87], v[32:47]
    buffer_load_dwordx4 v[124:127], v5, s[40:43], s56 offen offset:3072 sc1
    s_waitcnt vmcnt(9)
    v_mfma_f32_32x32x16_bf16 v[16:31], a[144:147], v[88:91], v[16:31]
    v_mfma_f32_32x32x16_bf16 v[32:47], a[148:151], v[88:91], v[32:47]
    s_add_u32 s56, s71, s97
    buffer_load_dwordx4 v[128:131], v5, s[40:43], s56 offen offset:0 sc1
    s_waitcnt vmcnt(9)
    v_mfma_f32_32x32x16_bf16 v[16:31], a[152:155], v[92:95], v[16:31]
    v_mfma_f32_32x32x16_bf16 v[32:47], a[156:159], v[92:95], v[32:47]
    buffer_load_dwordx4 v[132:135], v5, s[40:43], s56 offen offset:1024 sc1
    s_waitcnt vmcnt(9)
    v_mfma_f32_32x32x16_bf16 v[16:31], a[160:163], v[96:99], v[16:31]
    v_mfma_f32_32x32x16_bf16 v[32:47], a[164:167], v[96:99], v[32:47]
    buffer_load_dwordx4 v[136:139], v5, s[40:43], s56 offen offset:2048 sc1
    s_waitcnt vmcnt(9)
    v_mfma_f32_32x32x16_bf16 v[16:31], a[168:171], v[100:103], v[16:31]
    v_mfma_f32_32x32x16_bf16 v[32:47], a[172:175], v[100:103], v[32:47]
    buffer_load_dwordx4 v[140:143], v5, s[40:43], s56 offen offset:3072 sc1
    s_waitcnt vmcnt(9)
    v_mfma_f32_32x32x16_bf16 v[16:31], a[176:179], v[104:107], v[16:31]
    v_mfma_f32_32x32x16_bf16 v[32:47], a[180:183], v[104:107], v[32:47]
    s_add_u32 s56, s71, s98
    buffer_load_dwordx4 v[144:147], v5, s[40:43], s56 offen offset:0 sc1
    s_waitcnt vmcnt(9)
    v_mfma_f32_32x32x16_bf16 v[16:31], a[184:187], v[108:111], v[16:31]
    v_mfma_f32_32x32x16_bf16 v[32:47], a[188:191], v[108:111], v[32:47]
    buffer_load_dwordx4 v[148:151], v5, s[40:43], s56 offen offset:1024 sc1
    s_waitcnt vmcnt(9)
    v_mfma_f32_32x32x16_bf16 v[16:31], a[192:195], v[112:115], v[16:31]
    v_mfma_f32_32x32x16_bf16 v[32:47], a[196:199], v[112:115], v[32:47]
    buffer_load_dwordx4 v[152:155], v5, s[40:43], s56 offen offset:2048 sc1
    s_waitcnt vmcnt(9)
    v_mfma_f32_32x32x16_bf16 v[16:31], a[200:203], v[116:119], v[16:31]
    v_mfma_f32_32x32x16_bf16 v[32:47], a[204:207], v[116:119], v[32:47]
    buffer_load_dwordx4 v[156:159], v5, s[40:43], s56 offen offset:3072 sc1
    s_waitcnt vmcnt(9)
    v_mfma_f32_32x32x16_bf16 v[16:31], a[208:211], v[120:123], v[16:31]
    v_mfma_f32_32x32x16_bf16 v[32:47], a[212:215], v[120:123], v[32:47]
    s_add_u32 s56, s71, s99
    buffer_load_dwordx4 v[160:163], v5, s[40:43], s56 offen offset:0 sc1
    s_waitcnt vmcnt(9)
    v_mfma_f32_32x32x16_bf16 v[16:31], a[216:219], v[124:127], v[16:31]
    v_mfma_f32_32x32x16_bf16 v[32:47], a[220:223], v[124:127], v[32:47]
    buffer_load_dwordx4 v[164:167], v5, s[40:43], s56 offen offset:1024 sc1
    s_waitcnt vmcnt(9)
    v_mfma_f32_32x32x16_bf16 v[16:31], a[224:227], v[128:131], v[16:31]
    v_mfma_f32_32x32x16_bf16 v[32:47], a[228:231], v[128:131], v[32:47]
    buffer_load_dwordx4 v[168:171], v5, s[40:43], s56 offen offset:2048 sc1
    s_waitcnt vmcnt(9)
    v_mfma_f32_32x32x16_bf16 v[16:31], a[232:235], v[132:135], v[16:31]
    v_mfma_f32_32x32x16_bf16 v[32:47], a[236:239], v[132:135], v[32:47]
    buffer_load_dwordx4 v[172:175], v5, s[40:43], s56 offen offset:3072 sc1
    s_waitcnt vmcnt(9)
    v_mfma_f32_32x32x16_bf16 v[16:31], a[240:243], v[136:139], v[16:31]
    v_mfma_f32_32x32x16_bf16 v[32:47], a[244:247], v[136:139], v[32:47]
    s_add_u32 s56, s71, s100
    buffer_load_dwordx4 v[176:179], v5, s[40:43], s56 offen offset:0 sc1
    s_waitcnt vmcnt(9)
    v_mfma_f32_32x32x16_bf16 v[16:31], a[248:251], v[140:143], v[16:31]
    v_mfma_f32_32x32x16_bf16 v[32:47], a[252:255], v[140:143], v[32:47]
    buffer_load_dwordx4 v[180:183], v5, s[40:43], s56 offen offset:1024 sc1
    s_waitcnt vmcnt(9)
    v_mfma_f32_32x32x16_bf16 v[16:31], a[0:3], v[144:147], v[16:31]
    v_mfma_f32_32x32x16_bf16 v[32:47], a[4:7], v[144:147], v[32:47]
    s_barrier
    buffer_load_dwordx4 v[184:187], v5, s[40:43], s56 offen offset:2048 sc1
    s_waitcnt vmcnt(9)
    v_mfma_f32_32x32x16_bf16 v[16:31], a[8:11], v[148:151], v[16:31]
    v_mfma_f32_32x32x16_bf16 v[32:47], a[12:15], v[148:151], v[32:47]
    buffer_load_dwordx4 v[188:191], v5, s[40:43], s56 offen offset:3072 sc1
    s_waitcnt vmcnt(9)
    v_mfma_f32_32x32x16_bf16 v[16:31], a[16:19], v[152:155], v[16:31]
    v_mfma_f32_32x32x16_bf16 v[32:47], a[20:23], v[152:155], v[32:47]
    s_add_u32 s56, s71, s101
    buffer_load_dwordx4 v[192:195], v5, s[40:43], s56 offen offset:0 sc1
    s_waitcnt vmcnt(9)
    v_mfma_f32_32x32x16_bf16 v[16:31], a[24:27], v[156:159], v[16:31]
    v_mfma_f32_32x32x16_bf16 v[32:47], a[28:31], v[156:159], v[32:47]
    buffer_load_dwordx4 v[196:199], v5, s[40:43], s56 offen offset:1024 sc1
    s_waitcnt vmcnt(9)
    v_mfma_f32_32x32x16_bf16 v[16:31], a[32:35], v[160:163], v[16:31]
    v_mfma_f32_32x32x16_bf16 v[32:47], a[36:39], v[160:163], v[32:47]
    v_lshlrev_b32 v48, 16, v220
    v_and_b32 v49, s91, v220
    v_lshlrev_b32 v50, 16, v221
    v_and_b32 v51, s91, v221
    buffer_load_dwordx4 v[200:203], v5, s[40:43], s56 offen offset:2048 sc1
    s_waitcnt vmcnt(9)
    v_mfma_f32_32x32x16_bf16 v[16:31], a[40:43], v[164:167], v[16:31]
    v_mfma_f32_32x32x16_bf16 v[32:47], a[44:47], v[164:167], v[32:47]
    v_lshlrev_b32 v52, 16, v222
    v_and_b32 v53, s91, v222
    v_lshlrev_b32 v54, 16, v223
    v_and_b32 v55, s91, v223
    buffer_load_dwordx4 v[204:207], v5, s[40:43], s56 offen offset:3072 sc1
    s_waitcnt vmcnt(9)
    v_mfma_f32_32x32x16_bf16 v[16:31], a[48:51], v[168:171], v[16:31]
    v_mfma_f32_32x32x16_bf16 v[32:47], a[52:55], v[168:171], v[32:47]
    v_mov_b64 v[56:57], 0
    v_mov_b64 v[58:59], 0
    v_mov_b64 v[60:61], 0
    v_mov_b64 v[62:63], 0
    s_add_u32 s56, s72, s94
    buffer_load_dwordx4 v[80:83], v5, s[40:43], s56 offen offset:0 sc1
    s_waitcnt vmcnt(9)
    v_mfma_f32_32x32x16_bf16 v[16:31], a[56:59], v[172:175], v[16:31]
    v_mfma_f32_32x32x16_bf16 v[32:47], a[60:63], v[172:175], v[32:47]
    buffer_load_dwordx4 v[84:87], v5, s[40:43], s56 offen offset:1024 sc1
    s_waitcnt vmcnt(9)
    v_mfma_f32_32x32x16_bf16 v[16:31], a[64:67], v[176:179], v[16:31]
    v_mfma_f32_32x32x16_bf16 v[32:47], a[68:71], v[176:179], v[32:47]
    s_waitcnt lgkmcnt(15)
    s_add_u32 m0, s70, 12288
    s_mul_i32 s73, s49, 64
    s_add_u32 s73, s73, 131072
    buffer_load_dwordx4 v214, s[24:27], s73 offen lds
    s_add_u32 m0, s70, 13312
    s_mul_i32 s73, s49, 64
    s_add_u32 s73, s73, 163840
    buffer_load_dwordx4 v214, s[24:27], s73 offen lds
    buffer_load_dwordx4 v[88:91], v5, s[40:43], s56 offen offset:2048 sc1
    s_waitcnt vmcnt(11)
    v_mfma_f32_32x32x16_bf16 v[16:31], a[72:75], v[180:183], v[16:31]
    v_mfma_f32_32x32x16_bf16 v[32:47], a[76:79], v[180:183], v[32:47]
    s_add_u32 m0, s70, 14336
    s_mul_i32 s73, s49, 64
    s_add_u32 s73, s73, 196608
    buffer_load_dwordx4 v214, s[24:27], s73 offen lds
    s_add_u32 m0, s70, 15360
    s_mul_i32 s73, s49, 64
    s_add_u32 s73, s73, 229376
    buffer_load_dwordx4 v214, s[24:27], s73 offen lds
    buffer_load_dwordx4 v[92:95], v5, s[40:43], s56 offen offset:3072 sc1
    s_waitcnt vmcnt(13)
    v_mfma_f32_32x32x16_bf16 v[16:31], a[80:83], v[184:187], v[16:31]
    v_mfma_f32_32x32x16_bf16 v[32:47], a[84:87], v[184:187], v[32:47]
    s_waitcnt lgkmcnt(12)
    s_add_u32 m0, s70, 16384
    s_mul_i32 s73, s50, 64
    s_add_u32 s73, s73, 0
    buffer_load_dwordx4 v214, s[24:27], s73 offen lds
    s_add_u32 m0, s70, 17408
    s_mul_i32 s73, s50, 64
    s_add_u32 s73, s73, 32768
    buffer_load_dwordx4 v214, s[24:27], s73 offen lds
    s_add_u32 s56, s72, s95
    buffer_load_dwordx4 v[96:99], v5, s[40:43], s56 offen offset:0 sc1
    s_waitcnt vmcnt(15)
    v_mfma_f32_32x32x16_bf16 v[16:31], a[88:91], v[188:191], v[16:31]
    v_mfma_f32_32x32x16_bf16 v[32:47], a[92:95], v[188:191], v[32:47]
    s_waitcnt lgkmcnt(8)
    s_add_u32 m0, s70, 18432
    s_mul_i32 s73, s50, 64
    s_add_u32 s73, s73, 65536
    buffer_load_dwordx4 v214, s[24:27], s73 offen lds
    s_add_u32 m0, s70, 19456
    s_mul_i32 s73, s50, 64
    s_add_u32 s73, s73, 98304
    buffer_load_dwordx4 v214, s[24:27], s73 offen lds
    buffer_load_dwordx4 v[100:103], v5, s[40:43], s56 offen offset:1024 sc1
    s_waitcnt vmcnt(17)
    v_mfma_f32_32x32x16_bf16 v[16:31], a[96:99], v[192:195], v[16:31]
    v_mfma_f32_32x32x16_bf16 v[32:47], a[100:103], v[192:195], v[32:47]
    s_waitcnt lgkmcnt(4)
    s_add_u32 m0, s70, 20480
    s_mul_i32 s73, s50, 64
    s_add_u32 s73, s73, 131072
    buffer_load_dwordx4 v214, s[24:27], s73 offen lds
    s_add_u32 m0, s70, 21504
    s_mul_i32 s73, s50, 64
    s_add_u32 s73, s73, 163840
    buffer_load_dwordx4 v214, s[24:27], s73 offen lds
    buffer_load_dwordx4 v[104:107], v5, s[40:43], s56 offen offset:2048 sc1
    s_waitcnt vmcnt(19)
    v_mfma_f32_32x32x16_bf16 v[16:31], a[104:107], v[196:199], v[16:31]
    v_mfma_f32_32x32x16_bf16 v[32:47], a[108:111], v[196:199], v[32:47]
    s_waitcnt lgkmcnt(0)
    s_add_u32 m0, s70, 22528
    s_mul_i32 s73, s50, 64
    s_add_u32 s73, s73, 196608
    buffer_load_dwordx4 v214, s[24:27], s73 offen lds
    s_add_u32 m0, s70, 23552
    s_mul_i32 s73, s50, 64
    s_add_u32 s73, s73, 229376
    buffer_load_dwordx4 v214, s[24:27], s73 offen lds
    buffer_load_dwordx4 v[108:111], v5, s[40:43], s56 offen offset:3072 sc1
    s_waitcnt vmcnt(21)
    v_mfma_f32_32x32x16_bf16 v[16:31], a[112:115], v[200:203], v[16:31]
    v_mfma_f32_32x32x16_bf16 v[32:47], a[116:119], v[200:203], v[32:47]
    s_add_u32 s56, s72, s96
    buffer_load_dwordx4 v[112:115], v5, s[40:43], s56 offen offset:0 sc1
    s_waitcnt vmcnt(21)
    v_mfma_f32_32x32x16_bf16 v[16:31], a[120:123], v[204:207], v[16:31]
    v_mfma_f32_32x32x16_bf16 v[32:47], a[124:127], v[204:207], v[32:47]
    buffer_load_dwordx4 v[116:119], v5, s[40:43], s56 offen offset:1024 sc1
    s_waitcnt vmcnt(21)
    v_mfma_f32_32x32x16_bf16 v[48:63], a[128:131], v[80:83], v[48:63]
    v_mfma_f32_32x32x16_bf16 v[64:79], a[132:135], v[80:83], 0
    s_nop 7
    ds_write_b128 v235, v[40:43] offset:0
    ds_write_b128 v235, v[44:47] offset:1024
    ds_write_b128 v234, v[32:35] offset:0
    buffer_load_dwordx4 v[120:123], v5, s[40:43], s56 offen offset:2048 sc1
    s_waitcnt vmcnt(21)
    v_mfma_f32_32x32x16_bf16 v[48:63], a[136:139], v[84:87], v[48:63]
    v_mfma_f32_32x32x16_bf16 v[64:79], a[140:143], v[84:87], v[64:79]
    ds_write_b128 v234, v[36:39] offset:1024
    ds_write_b128 v233, v[24:27] offset:0
    ds_write_b128 v233, v[28:31] offset:1024
    buffer_load_dwordx4 v[124:127], v5, s[40:43], s56 offen offset:3072 sc1
    s_waitcnt vmcnt(19)
    v_mfma_f32_32x32x16_bf16 v[48:63], a[144:147], v[88:91], v[48:63]
    v_mfma_f32_32x32x16_bf16 v[64:79], a[148:151], v[88:91], v[64:79]
    s_waitcnt lgkmcnt(0)
    s_barrier
    ds_read_b128 v[24:27], v232 offset:0
    ds_read_b128 v[32:35], v232 offset:2048
    ds_read_b128 v[40:43], v232 offset:4096
    ds_read_b128 v[28:31], v232 offset:1024
    ds_read_b128 v[36:39], v232 offset:3072
    ds_read_b128 v[44:47], v232 offset:5120
    s_add_u32 s56, s72, s97
    buffer_load_dwordx4 v[128:131], v5, s[40:43], s56 offen offset:0 sc1
    s_waitcnt vmcnt(17)
    v_mfma_f32_32x32x16_bf16 v[48:63], a[152:155], v[92:95], v[48:63]
    v_mfma_f32_32x32x16_bf16 v[64:79], a[156:159], v[92:95], v[64:79]
    buffer_load_dwordx4 v[132:135], v5, s[40:43], s56 offen offset:1024 sc1
    s_waitcnt vmcnt(15)
    v_mfma_f32_32x32x16_bf16 v[48:63], a[160:163], v[96:99], v[48:63]
    v_mfma_f32_32x32x16_bf16 v[64:79], a[164:167], v[96:99], v[64:79]
    v_mov_b32 v211, s88
    s_waitcnt lgkmcnt(4)
    v_add_f32 v24, v24, v32
    s_waitcnt lgkmcnt(3)
    v_add_f32 v16, v16, v40
    v_add_f32 v25, v25, v33
    v_add_f32 v17, v17, v41
    v_add_f32 v26, v26, v34
    v_add_f32 v18, v18, v42
    v_add_f32 v27, v27, v35
    v_add_f32 v19, v19, v43
    s_waitcnt lgkmcnt(1)
    v_add_f32 v28, v28, v36
    s_waitcnt lgkmcnt(0)
    v_add_f32 v20, v20, v44
    v_add_f32 v29, v29, v37
    v_add_f32 v21, v21, v45
    v_add_f32 v30, v30, v38
    v_add_f32 v22, v22, v46
    v_add_f32 v31, v31, v39
    buffer_load_dwordx4 v[136:139], v5, s[40:43], s56 offen offset:2048 sc1
    s_waitcnt vmcnt(13)
    v_mfma_f32_32x32x16_bf16 v[48:63], a[168:171], v[100:103], v[48:63]
    v_mfma_f32_32x32x16_bf16 v[64:79], a[172:175], v[100:103], v[64:79]
    v_add_f32 v23, v23, v47
    v_add_f32 v16, v16, v24
    v_add_f32 v17, v17, v25
    v_add_f32 v18, v18, v26
    v_add_f32 v19, v19, v27
    v_add_f32 v20, v20, v28
    v_add_f32 v21, v21, v29
    v_add_f32 v22, v22, v30
    v_add_f32 v23, v23, v31
    v_mul_f32 v24, v16, v16
    v_mul_f32 v25, v17, v17
    v_mul_f32 v26, v18, v18
    v_mul_f32 v27, v19, v19
    v_mul_f32 v28, v20, v20
    v_mul_f32 v29, v21, v21
    v_mul_f32 v30, v22, v22
    buffer_load_dwordx4 v[140:143], v5, s[40:43], s56 offen offset:3072 sc1
    s_waitcnt vmcnt(11)
    v_mfma_f32_32x32x16_bf16 v[48:63], a[176:179], v[104:107], v[48:63]
    v_mfma_f32_32x32x16_bf16 v[64:79], a[180:183], v[104:107], v[64:79]
    v_mul_f32 v31, v23, v23
    v_fma_f32 v24, v24, s90, v211
    v_fma_f32 v25, v25, s90, v211
    v_fma_f32 v26, v26, s90, v211
    v_fma_f32 v27, v27, s90, v211
    v_fma_f32 v28, v28, s90, v211
    v_fma_f32 v29, v29, s90, v211
    v_fma_f32 v30, v30, s90, v211
    v_fma_f32 v31, v31, s90, v211
    v_mul_f32 v24, v24, v16
    v_mul_f32 v25, v25, v17
    v_mul_f32 v26, v26, v18
    v_mul_f32 v27, v27, v19
    v_mul_f32 v28, v28, v20
    v_mul_f32 v29, v29, v21
    v_mul_f32 v30, v30, v22
    s_add_u32 s56, s72, s98
    buffer_load_dwordx4 v[144:147], v5, s[40:43], s56 offen offset:0 sc1
    s_waitcnt vmcnt(9)
    v_mfma_f32_32x32x16_bf16 v[48:63], a[184:187], v[108:111], v[48:63]
    v_mfma_f32_32x32x16_bf16 v[64:79], a[188:191], v[108:111], v[64:79]
    v_mul_f32 v31, v31, v23
    v_exp_f32 v24, v24
    v_exp_f32 v25, v25
    v_exp_f32 v26, v26
    v_exp_f32 v27, v27
    v_exp_f32 v28, v28
    v_exp_f32 v29, v29
    v_exp_f32 v30, v30
    v_exp_f32 v31, v31
    v_add_f32 v24, 1.0, v24
    v_add_f32 v25, 1.0, v25
    v_add_f32 v26, 1.0, v26
    v_add_f32 v27, 1.0, v27
    v_add_f32 v28, 1.0, v28
    v_add_f32 v29, 1.0, v29
    v_add_f32 v30, 1.0, v30
    ds_read_b64_tr_b16 a[128:129], v217 offset:24576
    ds_read_b64_tr_b16 a[130:131], v217 offset:25600
    ds_read_b64_tr_b16 a[132:133], v218 offset:24576
    ds_read_b64_tr_b16 a[134:135], v218 offset:25600
    ds_read_b64_tr_b16 a[136:137], v217 offset:26624
    ds_read_b64_tr_b16 a[138:139], v217 offset:27648
    ds_read_b64_tr_b16 a[140:141], v218 offset:26624
    ds_read_b64_tr_b16 a[142:143], v218 offset:27648
    buffer_load_dwordx4 v[148:151], v5, s[40:43], s56 offen offset:1024 sc1
    s_waitcnt vmcnt(9)
    v_mfma_f32_32x32x16_bf16 v[48:63], a[192:195], v[112:115], v[48:63]
    v_mfma_f32_32x32x16_bf16 v[64:79], a[196:199], v[112:115], v[64:79]
    v_add_f32 v31, 1.0, v31
    v_rcp_f32 v24, v24
    v_rcp_f32 v25, v25
    v_rcp_f32 v26, v26
    v_rcp_f32 v27, v27
    v_rcp_f32 v28, v28
    v_rcp_f32 v29, v29
    v_rcp_f32 v30, v30
    v_rcp_f32 v31, v31
    v_mul_f32 v24, v24, v16
    v_mul_f32 v25, v25, v17
    v_mul_f32 v26, v26, v18
    v_mul_f32 v27, v27, v19
    v_mul_f32 v28, v28, v20
    v_mul_f32 v29, v29, v21
    v_mul_f32 v30, v30, v22
    ds_read_b64_tr_b16 a[144:145], v217 offset:28672
    ds_read_b64_tr_b16 a[146:147], v217 offset:29696
    ds_read_b64_tr_b16 a[148:149], v218 offset:28672
    ds_read_b64_tr_b16 a[150:151], v218 offset:29696
    ds_read_b64_tr_b16 a[152:153], v217 offset:30720
    ds_read_b64_tr_b16 a[154:155], v217 offset:31744
    ds_read_b64_tr_b16 a[156:157], v218 offset:30720
    ds_read_b64_tr_b16 a[158:159], v218 offset:31744
    buffer_load_dwordx4 v[152:155], v5, s[40:43], s56 offen offset:2048 sc1
    s_waitcnt vmcnt(9)
    v_mfma_f32_32x32x16_bf16 v[48:63], a[200:203], v[116:119], v[48:63]
    v_mfma_f32_32x32x16_bf16 v[64:79], a[204:207], v[116:119], v[64:79]
    v_mul_f32 v31, v31, v23
    v_cvt_pk_bf16_f32 v32, v24, v25
    v_cvt_pk_bf16_f32 v33, v26, v27
    v_cvt_pk_bf16_f32 v34, v28, v29
    v_cvt_pk_bf16_f32 v35, v30, v31
    buffer_store_dwordx4 v[32:35], v5, s[40:43], s57 offen sc1
    ds_read_b64_tr_b16 a[160:161], v217 offset:32768
    ds_read_b64_tr_b16 a[162:163], v217 offset:33792
    ds_read_b64_tr_b16 a[164:165], v218 offset:32768
    ds_read_b64_tr_b16 a[166:167], v218 offset:33792
    ds_read_b64_tr_b16 a[168:169], v217 offset:34816
    ds_read_b64_tr_b16 a[170:171], v217 offset:35840
    ds_read_b64_tr_b16 a[172:173], v218 offset:34816
    ds_read_b64_tr_b16 a[174:175], v218 offset:35840
    buffer_load_dwordx4 v[156:159], v5, s[40:43], s56 offen offset:3072 sc1
    s_waitcnt vmcnt(10)
    v_mfma_f32_32x32x16_bf16 v[48:63], a[208:211], v[120:123], v[48:63]
    v_mfma_f32_32x32x16_bf16 v[64:79], a[212:215], v[120:123], v[64:79]
    ds_read_b64_tr_b16 a[176:177], v217 offset:12288
    ds_read_b64_tr_b16 a[178:179], v217 offset:13312
    ds_read_b64_tr_b16 a[180:181], v218 offset:12288
    ds_read_b64_tr_b16 a[182:183], v218 offset:13312
    ds_read_b64_tr_b16 a[184:185], v217 offset:14336
    ds_read_b64_tr_b16 a[186:187], v217 offset:15360
    ds_read_b64_tr_b16 a[188:189], v218 offset:14336
    ds_read_b64_tr_b16 a[190:191], v218 offset:15360
    s_and_b32 s60, s3, 1
    s_cmp_eq_u32 s60, 0
    s_cselect_b32 s60, 1.0, 0
    v_lshlrev_b32 v16, 16, v224
    v_and_b32 v17, s91, v224
    v_lshlrev_b32 v208, 16, v240
    v_and_b32 v209, s91, v240
    v_add_f32 v16, v16, v208
    s_add_u32 s56, s72, s99
    buffer_load_dwordx4 v[160:163], v5, s[40:43], s56 offen offset:0 sc1
    s_waitcnt vmcnt(10)
    v_mfma_f32_32x32x16_bf16 v[48:63], a[216:219], v[124:127], v[48:63]
    v_mfma_f32_32x32x16_bf16 v[64:79], a[220:223], v[124:127], v[64:79]
    ds_read_b64_tr_b16 a[192:193], v217 offset:16384
    ds_read_b64_tr_b16 a[194:195], v217 offset:17408
    ds_read_b64_tr_b16 a[196:197], v218 offset:16384
    ds_read_b64_tr_b16 a[198:199], v218 offset:17408
    ds_read_b64_tr_b16 a[200:201], v217 offset:18432
    ds_read_b64_tr_b16 a[202:203], v217 offset:19456
    ds_read_b64_tr_b16 a[204:205], v218 offset:18432
    ds_read_b64_tr_b16 a[206:207], v218 offset:19456
    v_add_f32 v17, v17, v209
    v_mul_f32 v16, s60, v16
    v_mul_f32 v17, s60, v17
    v_lshlrev_b32 v18, 16, v225
    v_and_b32 v19, s91, v225
    v_lshlrev_b32 v210, 16, v241
    buffer_load_dwordx4 v[164:167], v5, s[40:43], s56 offen offset:1024 sc1
    s_waitcnt vmcnt(10)
    v_mfma_f32_32x32x16_bf16 v[48:63], a[224:227], v[128:131], v[48:63]
    v_mfma_f32_32x32x16_bf16 v[64:79], a[228:231], v[128:131], v[64:79]
    ds_read_b64_tr_b16 a[208:209], v217 offset:20480
    ds_read_b64_tr_b16 a[210:211], v217 offset:21504
    ds_read_b64_tr_b16 a[212:213], v218 offset:20480
    ds_read_b64_tr_b16 a[214:215], v218 offset:21504
    ds_read_b64_tr_b16 a[216:217], v217 offset:22528
    ds_read_b64_tr_b16 a[218:219], v217 offset:23552
    ds_read_b64_tr_b16 a[220:221], v218 offset:22528
    ds_read_b64_tr_b16 a[222:223], v218 offset:23552
    s_waitcnt lgkmcnt(15)
    s_add_u32 m0, s70, 24576
    s_mul_i32 s73, s51, 64
    s_add_u32 s73, s73, 0
    buffer_load_dwordx4 v214, s[24:27], s73 offen lds
    s_add_u32 m0, s70, 25600
    s_mul_i32 s73, s51, 64
    s_add_u32 s73, s73, 32768
    buffer_load_dwordx4 v214, s[24:27], s73 offen lds
    v_and_b32 v211, s91, v241
    v_add_f32 v18, v18, v210
    v_add_f32 v19, v19, v211
    v_mul_f32 v18, s60, v18
    v_mul_f32 v19, s60, v19
    v_lshlrev_b32 v20, 16, v226
    buffer_load_dwordx4 v[168:171], v5, s[40:43], s56 offen offset:2048 sc1
    s_waitcnt vmcnt(12)
    v_mfma_f32_32x32x16_bf16 v[48:63], a[232:235], v[132:135], v[48:63]
    v_mfma_f32_32x32x16_bf16 v[64:79], a[236:239], v[132:135], v[64:79]
    s_waitcnt vmcnt(6)
    v_mov_b32 v8, s4
    s_mov_b64 exec, 1
    buffer_store_dword v8, v9, s[40:43], s82 offen sc1
    s_mov_b64 exec, -1
    s_add_u32 m0, s70, 26624
    s_mul_i32 s73, s51, 64
    s_add_u32 s73, s73, 65536
    buffer_load_dwordx4 v214, s[24:27], s73 offen lds
    s_add_u32 m0, s70, 27648
    s_mul_i32 s73, s51, 64
    s_add_u32 s73, s73, 98304
    buffer_load_dwordx4 v214, s[24:27], s73 offen lds
    v_and_b32 v21, s91, v226
    v_lshlrev_b32 v208, 16, v242
    v_and_b32 v209, s91, v242
    v_add_f32 v20, v20, v208
    v_add_f32 v21, v21, v209
    v_mul_f32 v20, s60, v20
    buffer_load_dwordx4 v[172:175], v5, s[40:43], s56 offen offset:3072 sc1
    v_mfma_f32_32x32x16_bf16 v[48:63], a[240:243], v[136:139], v[48:63]
    v_mfma_f32_32x32x16_bf16 v[64:79], a[244:247], v[136:139], v[64:79]
    s_add_u32 m0, s70, 28672
    s_mul_i32 s73, s51, 64
    s_add_u32 s73, s73, 131072
    buffer_load_dwordx4 v214, s[24:27], s73 offen lds
    s_add_u32 m0, s70, 29696
    s_mul_i32 s73, s51, 64
    s_add_u32 s73, s73, 163840
    buffer_load_dwordx4 v214, s[24:27], s73 offen lds
    v_mul_f32 v21, s60, v21
    v_lshlrev_b32 v22, 16, v227
    v_and_b32 v23, s91, v227
    v_lshlrev_b32 v210, 16, v243
    v_and_b32 v211, s91, v243
    v_add_f32 v22, v22, v210
    s_add_u32 s56, s72, s100
    buffer_load_dwordx4 v[176:179], v5, s[40:43], s56 offen offset:0 sc1
    v_mfma_f32_32x32x16_bf16 v[48:63], a[248:251], v[140:143], v[48:63]
    v_mfma_f32_32x32x16_bf16 v[64:79], a[252:255], v[140:143], v[64:79]
    s_add_u32 m0, s70, 30720
    s_mul_i32 s73, s51, 64
    s_add_u32 s73, s73, 196608
    buffer_load_dwordx4 v214, s[24:27], s73 offen lds
    s_add_u32 m0, s70, 31744
    s_mul_i32 s73, s51, 64
    s_add_u32 s73, s73, 229376
    buffer_load_dwordx4 v214, s[24:27], s73 offen lds
    v_add_f32 v23, v23, v211
    v_mul_f32 v22, s60, v22
    v_mul_f32 v23, s60, v23
    v_lshlrev_b32 v24, 16, v228
    v_and_b32 v25, s91, v228
    v_lshlrev_b32 v208, 16, v244
    buffer_load_dwordx4 v[180:183], v5, s[40:43], s56 offen offset:1024 sc1
    v_mfma_f32_32x32x16_bf16 v[48:63], a[0:3], v[144:147], v[48:63]
    v_mfma_f32_32x32x16_bf16 v[64:79], a[4:7], v[144:147], v[64:79]
    s_add_u32 m0, s70, 32768
    s_mul_i32 s73, s52, 64
    s_add_u32 s73, s73, 0
    buffer_load_dwordx4 v214, s[24:27], s73 offen lds
    s_add_u32 m0, s70, 33792
    s_mul_i32 s73, s52, 64
    s_add_u32 s73, s73, 32768
    buffer_load_dwordx4 v214, s[24:27], s73 offen lds
    v_and_b32 v209, s91, v244
    v_add_f32 v24, v24, v208
    v_add_f32 v25, v25, v209
    v_mul_f32 v24, s60, v24
    v_mul_f32 v25, s60, v25
    v_lshlrev_b32 v26, 16, v229
    buffer_load_dwordx4 v[184:187], v5, s[40:43], s56 offen offset:2048 sc1
    v_mfma_f32_32x32x16_bf16 v[48:63], a[8:11], v[148:151], v[48:63]
    v_mfma_f32_32x32x16_bf16 v[64:79], a[12:15], v[148:151], v[64:79]
    s_add_u32 m0, s70, 34816
    s_mul_i32 s73, s52, 64
    s_add_u32 s73, s73, 65536
    buffer_load_dwordx4 v214, s[24:27], s73 offen lds
    s_add_u32 m0, s70, 35840
    s_mul_i32 s73, s52, 64
    s_add_u32 s73, s73, 98304
    buffer_load_dwordx4 v214, s[24:27], s73 offen lds
    v_and_b32 v27, s91, v229
    v_lshlrev_b32 v210, 16, v245
    v_and_b32 v211, s91, v245
    v_add_f32 v26, v26, v210
    v_add_f32 v27, v27, v211
    v_mul_f32 v26, s60, v26
    buffer_load_dwordx4 v[188:191], v5, s[40:43], s56 offen offset:3072 sc1
    v_mfma_f32_32x32x16_bf16 v[48:63], a[16:19], v[152:155], v[48:63]
    v_mfma_f32_32x32x16_bf16 v[64:79], a[20:23], v[152:155], v[64:79]
    s_add_u32 m0, s70, 12288
    s_mul_i32 s73, s52, 64
    s_add_u32 s73, s73, 131072
    buffer_load_dwordx4 v214, s[24:27], s73 offen lds
    s_add_u32 m0, s70, 13312
    s_mul_i32 s73, s52, 64
    s_add_u32 s73, s73, 163840
    buffer_load_dwordx4 v214, s[24:27], s73 offen lds
    v_mul_f32 v27, s60, v27
    v_lshlrev_b32 v28, 16, v230
    v_and_b32 v29, s91, v230
    v_lshlrev_b32 v208, 16, v246
    v_and_b32 v209, s91, v246
    v_add_f32 v28, v28, v208
    buffer_load_dword v248, v12, s[40:43], s85 offen offset:0 sc1
    s_add_u32 s56, s72, s101
    buffer_load_dwordx4 v[192:195], v5, s[40:43], s56 offen offset:0 sc1
    s_waitcnt vmcnt(25)
    v_mfma_f32_32x32x16_bf16 v[48:63], a[24:27], v[156:159], v[48:63]
    v_mfma_f32_32x32x16_bf16 v[64:79], a[28:31], v[156:159], v[64:79]
    s_add_u32 m0, s70, 14336
    s_mul_i32 s73, s52, 64
    s_add_u32 s73, s73, 196608
    buffer_load_dwordx4 v214, s[24:27], s73 offen lds
    s_add_u32 m0, s70, 15360
    s_mul_i32 s73, s52, 64
    s_add_u32 s73, s73, 229376
    buffer_load_dwordx4 v214, s[24:27], s73 offen lds
    v_add_f32 v29, v29, v209
    v_mul_f32 v28, s60, v28
    v_mul_f32 v29, s60, v29
    v_lshlrev_b32 v30, 16, v231
    v_and_b32 v31, s91, v231
    v_lshlrev_b32 v210, 16, v247
    buffer_load_dwordx4 v[196:199], v5, s[40:43], s56 offen offset:1024 sc1
    s_waitcnt vmcnt(27)
    v_mfma_f32_32x32x16_bf16 v[48:63], a[32:35], v[160:163], v[48:63]
    v_mfma_f32_32x32x16_bf16 v[64:79], a[36:39], v[160:163], v[64:79]
    s_waitcnt vmcnt(24)
    ds_read_b64_tr_b16 a[224:225], v217 offset:24576
    ds_read_b64_tr_b16 a[226:227], v217 offset:25600
    ds_read_b64_tr_b16 a[228:229], v218 offset:24576
    ds_read_b64_tr_b16 a[230:231], v218 offset:25600
    v_and_b32 v211, s91, v247
    v_add_f32 v30, v30, v210
    v_add_f32 v31, v31, v211
    v_mul_f32 v30, s60, v30
    v_mul_f32 v31, s60, v31
    buffer_load_dwordx4 v[200:203], v5, s[40:43], s56 offen offset:2048 sc1
    v_mfma_f32_32x32x16_bf16 v[48:63], a[40:43], v[164:167], v[48:63]
    v_mfma_f32_32x32x16_bf16 v[64:79], a[44:47], v[164:167], v[64:79]
    s_waitcnt vmcnt(21)
    ds_read_b64_tr_b16 a[232:233], v217 offset:26624
    ds_read_b64_tr_b16 a[234:235], v217 offset:27648
    ds_read_b64_tr_b16 a[236:237], v218 offset:26624
    ds_read_b64_tr_b16 a[238:239], v218 offset:27648
    buffer_load_dwordx4 v[204:207], v5, s[40:43], s56 offen offset:3072 sc1
    v_mfma_f32_32x32x16_bf16 v[48:63], a[48:51], v[168:171], v[48:63]
    v_mfma_f32_32x32x16_bf16 v[64:79], a[52:55], v[168:171], v[64:79]
    s_waitcnt vmcnt(19)
    ds_read_b64_tr_b16 a[240:241], v217 offset:28672
    ds_read_b64_tr_b16 a[242:243], v217 offset:29696
    ds_read_b64_tr_b16 a[244:245], v218 offset:28672
    ds_read_b64_tr_b16 a[246:247], v218 offset:29696
    s_waitcnt vmcnt(6)
    v_cmp_ne_u32 vcc, s4, v248
    s_nop 1
    s_cbranch_vccz Lpcd_P_11
    s_nop 1
Lpc_P_10:
    s_sub_u32 s6, s6, 1
    s_cbranch_scc1 L_end_P
    buffer_load_dword v248, v12, s[40:43], s85 offen offset:0 sc1
    s_waitcnt vmcnt(0)
    v_cmp_ne_u32 vcc, s4, v248
    s_nop 1
    s_cbranch_vccnz Lpc_P_10
Lpcd_P_11:
    s_add_u32 s56, s58, s48
    buffer_load_dwordx4 v[80:83], v4, s[40:43], s56 offen offset:0 sc1
    v_mfma_f32_32x32x16_bf16 v[48:63], a[56:59], v[172:175], v[48:63]
    v_mfma_f32_32x32x16_bf16 v[64:79], a[60:63], v[172:175], v[64:79]
    ds_read_b64_tr_b16 a[248:249], v217 offset:30720
    ds_read_b64_tr_b16 a[250:251], v217 offset:31744
    ds_read_b64_tr_b16 a[252:253], v218 offset:30720
    ds_read_b64_tr_b16 a[254:255], v218 offset:31744
    buffer_load_dwordx4 v[84:87], v4, s[40:43], s56 offen offset:1024 sc1
    v_mfma_f32_32x32x16_bf16 v[48:63], a[64:67], v[176:179], v[48:63]
    v_mfma_f32_32x32x16_bf16 v[64:79], a[68:71], v[176:179], v[64:79]
    ds_read_b64_tr_b16 a[0:1], v217 offset:32768
    ds_read_b64_tr_b16 a[2:3], v217 offset:33792
    ds_read_b64_tr_b16 a[4:5], v218 offset:32768
    ds_read_b64_tr_b16 a[6:7], v218 offset:33792
    buffer_load_dwordx4 v[88:91], v4, s[40:43], s56 offen offset:2048 sc1
    v_mfma_f32_32x32x16_bf16 v[48:63], a[72:75], v[180:183], v[48:63]
    v_mfma_f32_32x32x16_bf16 v[64:79], a[76:79], v[180:183], v[64:79]
    ds_read_b64_tr_b16 a[8:9], v217 offset:34816
    ds_read_b64_tr_b16 a[10:11], v217 offset:35840
    ds_read_b64_tr_b16 a[12:13], v218 offset:34816
    ds_read_b64_tr_b16 a[14:15], v218 offset:35840
    buffer_load_dwordx4 v[92:95], v4, s[40:43], s56 offen offset:3072 sc1
    v_mfma_f32_32x32x16_bf16 v[48:63], a[80:83], v[184:187], v[48:63]
    v_mfma_f32_32x32x16_bf16 v[64:79], a[84:87], v[184:187], v[64:79]
    ds_read_b64_tr_b16 a[16:17], v217 offset:12288
    ds_read_b64_tr_b16 a[18:19], v217 offset:13312
    ds_read_b64_tr_b16 a[20:21], v218 offset:12288
    ds_read_b64_tr_b16 a[22:23], v218 offset:13312
    s_add_u32 s56, s58, s49
    buffer_load_dwordx4 v[96:99], v4, s[40:43], s56 offen offset:0 sc1
    v_mfma_f32_32x32x16_bf16 v[48:63], a[88:91], v[188:191], v[48:63]
    v_mfma_f32_32x32x16_bf16 v[64:79], a[92:95], v[188:191], v[64:79]
    s_waitcnt vmcnt(8)
    ds_read_b64_tr_b16 a[24:25], v217 offset:14336
    ds_read_b64_tr_b16 a[26:27], v217 offset:15360
    ds_read_b64_tr_b16 a[28:29], v218 offset:14336
    ds_read_b64_tr_b16 a[30:31], v218 offset:15360
    buffer_load_dwordx4 v[100:103], v4, s[40:43], s56 offen offset:1024 sc1
    buffer_load_dwordx4 v[104:107], v4, s[40:43], s56 offen offset:2048 sc1
    buffer_load_dwordx4 v[108:111], v4, s[40:43], s56 offen offset:3072 sc1
    s_add_u32 s56, s58, s50
    buffer_load_dwordx4 v[112:115], v4, s[40:43], s56 offen offset:0 sc1
    v_mfma_f32_32x32x16_bf16 v[64:79], a[100:103], v[192:195], v[64:79]
    s_waitcnt vmcnt(11)
    v_mfma_f32_32x32x16_bf16 v[64:79], a[108:111], v[196:199], v[64:79]
    s_waitcnt vmcnt(10)
    v_mfma_f32_32x32x16_bf16 v[64:79], a[116:119], v[200:203], v[64:79]
    s_waitcnt vmcnt(9)
    v_mfma_f32_32x32x16_bf16 v[64:79], a[124:127], v[204:207], v[64:79]
    v_mfma_f32_32x32x16_bf16 v[48:63], a[96:99], v[192:195], v[48:63]
    v_mfma_f32_32x32x16_bf16 v[48:63], a[104:107], v[196:199], v[48:63]
    s_nop 9
    ds_write_b128 v235, v[72:75] offset:6144
    ds_write_b128 v235, v[76:79] offset:7168
    v_mfma_f32_32x32x16_bf16 v[48:63], a[112:115], v[200:203], v[48:63]
    ds_write_b128 v234, v[64:67] offset:6144
    ds_write_b128 v234, v[68:71] offset:7168
    v_mfma_f32_32x32x16_bf16 v[48:63], a[120:123], v[204:207], v[48:63]
    s_nop 11
    ds_write_b128 v233, v[56:59] offset:6144
    ds_write_b128 v233, v[60:63] offset:7168
    s_waitcnt lgkmcnt(0)
    s_barrier
    ds_read_b128 v[56:59], v232 offset:6144
    ds_read_b128 v[64:67], v232 offset:8192
    ds_read_b128 v[72:75], v232 offset:10240
    ds_read_b128 v[60:63], v232 offset:7168
    ds_read_b128 v[68:71], v232 offset:9216
    ds_read_b128 v[76:79], v232 offset:11264
    v_mov_b32 v211, s88
    s_waitcnt lgkmcnt(4)
    v_pk_add_f32 v[56:57], v[56:57], v[64:65]
    s_waitcnt lgkmcnt(3)
    v_pk_add_f32 v[48:49], v[48:49], v[72:73]
    v_pk_add_f32 v[58:59], v[58:59], v[66:67]
    v_pk_add_f32 v[50:51], v[50:51], v[74:75]
    s_waitcnt lgkmcnt(1)
    v_pk_add_f32 v[60:61], v[60:61], v[68:69]
    s_waitcnt lgkmcnt(0)
    v_pk_add_f32 v[52:53], v[52:53], v[76:77]
    v_pk_add_f32 v[62:63], v[62:63], v[70:71]
    v_pk_add_f32 v[54:55], v[54:55], v[78:79]
    v_pk_add_f32 v[48:49], v[48:49], v[56:57]
    v_pk_add_f32 v[50:51], v[50:51], v[58:59]
    v_pk_add_f32 v[52:53], v[52:53], v[60:61]
    v_pk_add_f32 v[54:55], v[54:55], v[62:63]
    v_pk_mul_f32 v[56:57], v[48:49], v[48:49]
    v_pk_mul_f32 v[58:59], v[50:51], v[50:51]
    v_pk_mul_f32 v[60:61], v[52:53], v[52:53]
    v_pk_mul_f32 v[62:63], v[54:55], v[54:55]
    v_fma_f32 v56, v56, s90, v211
    v_fma_f32 v57, v57, s90, v211
    v_fma_f32 v58, v58, s90, v211
    v_fma_f32 v59, v59, s90, v211
    v_fma_f32 v60, v60, s90, v211
    v_fma_f32 v61, v61, s90, v211
    v_fma_f32 v62, v62, s90, v211
    v_fma_f32 v63, v63, s90, v211
    v_pk_mul_f32 v[56:57], v[56:57], v[48:49]
    v_pk_mul_f32 v[58:59], v[58:59], v[50:51]
    v_pk_mul_f32 v[60:61], v[60:61], v[52:53]
    v_pk_mul_f32 v[62:63], v[62:63], v[54:55]
    v_exp_f32 v56, v56
    v_exp_f32 v57, v57
    v_exp_f32 v58, v58
    v_exp_f32 v59, v59
    v_exp_f32 v60, v60
    v_exp_f32 v61, v61
    v_exp_f32 v62, v62
    v_exp_f32 v63, v63
    v_add_f32 v56, 1.0, v56
    v_add_f32 v57, 1.0, v57
    v_add_f32 v58, 1.0, v58
    v_add_f32 v59, 1.0, v59
    v_add_f32 v60, 1.0, v60
    v_add_f32 v61, 1.0, v61
    v_add_f32 v62, 1.0, v62
    v_add_f32 v63, 1.0, v63
    v_rcp_f32 v56, v56
    v_rcp_f32 v57, v57
    v_rcp_f32 v58, v58
    v_rcp_f32 v59, v59
    v_rcp_f32 v60, v60
    v_rcp_f32 v61, v61
    v_rcp_f32 v62, v62
    v_rcp_f32 v63, v63
    v_mul_f32 v56, v56, v48
    v_mul_f32 v57, v57, v49
    v_mul_f32 v58, v58, v50
    v_mul_f32 v59, v59, v51
    v_mul_f32 v60, v60, v52
    v_mul_f32 v61, v61, v53
    v_mul_f32 v62, v62, v54
    v_mul_f32 v63, v63, v55
    v_cvt_pk_bf16_f32 v64, v56, v57
    v_cvt_pk_bf16_f32 v65, v58, v59
    v_cvt_pk_bf16_f32 v66, v60, v61
    v_cvt_pk_bf16_f32 v67, v62, v63
    s_add_u32 s57, s57, 114688
    buffer_store_dwordx4 v[64:67], v5, s[40:43], s57 offen sc1
    s_add_u32 s82, s82, 4096
    s_add_u32 s85, s85, 4096
    buffer_load_dwordx4 v[116:119], v4, s[40:43], s56 offen offset:1024 sc1
    s_waitcnt vmcnt(10)
    v_mfma_f32_32x32x16_bf16 v[16:31], a[128:131], v[80:83], v[16:31]
    v_mfma_f32_32x32x16_bf16 v[32:47], a[132:135], v[80:83], 0
    s_add_u32 m0, s70, 16384
    s_mul_i32 s73, s53, 64
    s_add_u32 s73, s73, 0
    buffer_load_dwordx4 v214, s[24:27], s73 offen lds
    s_add_u32 m0, s70, 17408
    s_mul_i32 s73, s53, 64
    s_add_u32 s73, s73, 32768
    buffer_load_dwordx4 v214, s[24:27], s73 offen lds
    buffer_load_dwordx4 v[120:123], v4, s[40:43], s56 offen offset:2048 sc1
    s_waitcnt vmcnt(12)
    v_mfma_f32_32x32x16_bf16 v[16:31], a[136:139], v[84:87], v[16:31]
    v_mfma_f32_32x32x16_bf16 v[32:47], a[140:143], v[84:87], v[32:47]
    s_add_u32 m0, s70, 18432
    s_mul_i32 s73, s53, 64
    s_add_u32 s73, s73, 65536
    buffer_load_dwordx4 v214, s[24:27], s73 offen lds
    s_add_u32 m0, s70, 19456
    s_mul_i32 s73, s53, 64
    s_add_u32 s73, s73, 98304
    buffer_load_dwordx4 v214, s[24:27], s73 offen lds
    buffer_load_dwordx4 v[124:127], v4, s[40:43], s56 offen offset:3072 sc1
    s_waitcnt vmcnt(14)
    v_mfma_f32_32x32x16_bf16 v[16:31], a[144:147], v[88:91], v[16:31]
    v_mfma_f32_32x32x16_bf16 v[32:47], a[148:151], v[88:91], v[32:47]
    s_add_u32 m0, s70, 20480
    s_mul_i32 s73, s53, 64
    s_add_u32 s73, s73, 131072
    buffer_load_dwordx4 v214, s[24:27], s73 offen lds
    s_add_u32 m0, s70, 21504
    s_mul_i32 s73, s53, 64
    s_add_u32 s73, s73, 163840
    buffer_load_dwordx4 v214, s[24:27], s73 offen lds
    s_add_u32 s56, s58, s51
    buffer_load_dwordx4 v[128:131], v4, s[40:43], s56 offen offset:0 sc1
    s_waitcnt vmcnt(16)
    v_mfma_f32_32x32x16_bf16 v[16:31], a[152:155], v[92:95], v[16:31]
    v_mfma_f32_32x32x16_bf16 v[32:47], a[156:159], v[92:95], v[32:47]
    s_add_u32 m0, s70, 22528
    s_mul_i32 s73, s53, 64
    s_add_u32 s73, s73, 196608
    buffer_load_dwordx4 v214, s[24:27], s73 offen lds
    s_add_u32 m0, s70, 23552
    s_mul_i32 s73, s53, 64
    s_add_u32 s73, s73, 229376
    buffer_load_dwordx4 v214, s[24:27], s73 offen lds
    buffer_load_dwordx4 v[132:135], v4, s[40:43], s56 offen offset:1024 sc1
    s_waitcnt vmcnt(18)
    v_mfma_f32_32x32x16_bf16 v[16:31], a[160:163], v[96:99], v[16:31]
    v_mfma_f32_32x32x16_bf16 v[32:47], a[164:167], v[96:99], v[32:47]
    s_add_u32 m0, s70, 24576
    s_mul_i32 s73, s54, 64
    s_add_u32 s73, s73, 0
    buffer_load_dwordx4 v214, s[24:27], s73 offen lds
    s_add_u32 m0, s70, 25600
    s_mul_i32 s73, s54, 64
    s_add_u32 s73, s73, 32768
    buffer_load_dwordx4 v214, s[24:27], s73 offen lds
    s_waitcnt vmcnt(15)
    v_mov_b32 v8, s4
    s_mov_b64 exec, 1
    buffer_store_dword v8, v9, s[40:43], s82 offen sc1
    s_mov_b64 exec, -1
    buffer_load_dwordx4 v[136:139], v4, s[40:43], s56 offen offset:2048 sc1
    v_mfma_f32_32x32x16_bf16 v[16:31], a[168:171], v[100:103], v[16:31]
    v_mfma_f32_32x32x16_bf16 v[32:47], a[172:175], v[100:103], v[32:47]
    s_add_u32 m0, s70, 26624
    s_mul_i32 s73, s54, 64
    s_add_u32 s73, s73, 65536
    buffer_load_dwordx4 v214, s[24:27], s73 offen lds
    s_add_u32 m0, s70, 27648
    s_mul_i32 s73, s54, 64
    s_add_u32 s73, s73, 98304
    buffer_load_dwordx4 v214, s[24:27], s73 offen lds
    buffer_load_dwordx4 v[140:143], v4, s[40:43], s56 offen offset:3072 sc1
    v_mfma_f32_32x32x16_bf16 v[16:31], a[176:179], v[104:107], v[16:31]
    v_mfma_f32_32x32x16_bf16 v[32:47], a[180:183], v[104:107], v[32:47]
    s_add_u32 m0, s70, 28672
    s_mul_i32 s73, s54, 64
    s_add_u32 s73, s73, 131072
    buffer_load_dwordx4 v214, s[24:27], s73 offen lds
    s_add_u32 m0, s70, 29696
    s_mul_i32 s73, s54, 64
    s_add_u32 s73, s73, 163840
    buffer_load_dwordx4 v214, s[24:27], s73 offen lds
    s_and_b32 s60, s3, 1
    s_cmp_eq_u32 s60, 1
    s_cselect_b32 s60, 1.0, 0
    v_lshlrev_b32 v48, 16, v224
    v_and_b32 v49, s91, v224
    v_lshlrev_b32 v208, 16, v240
    v_and_b32 v209, s91, v240
    v_add_f32 v48, v48, v208
    s_add_u32 s56, s58, s52
    buffer_load_dwordx4 v[144:147], v4, s[40:43], s56 offen offset:0 sc1
    v_mfma_f32_32x32x16_bf16 v[16:31], a[184:187], v[108:111], v[16:31]
    v_mfma_f32_32x32x16_bf16 v[32:47], a[188:191], v[108:111], v[32:47]
    s_add_u32 m0, s70, 30720
    s_mul_i32 s73, s54, 64
    s_add_u32 s73, s73, 196608
    buffer_load_dwordx4 v214, s[24:27], s73 offen lds
    s_add_u32 m0, s70, 31744
    s_mul_i32 s73, s54, 64
    s_add_u32 s73, s73, 229376
    buffer_load_dwordx4 v214, s[24:27], s73 offen lds
    v_add_f32 v49, v49, v209
    v_mul_f32 v48, s60, v48
    v_mul_f32 v49, s60, v49
    v_lshlrev_b32 v50, 16, v225
    v_and_b32 v51, s91, v225
    v_lshlrev_b32 v210, 16, v241
    buffer_load_dwordx4 v[148:151], v4, s[40:43], s56 offen offset:1024 sc1
    v_mfma_f32_32x32x16_bf16 v[16:31], a[192:195], v[112:115], v[16:31]
    v_mfma_f32_32x32x16_bf16 v[32:47], a[196:199], v[112:115], v[32:47]
    s_waitcnt vmcnt(23)
    ds_read_b64_tr_b16 a[32:33], v217 offset:16384
    ds_read_b64_tr_b16 a[34:35], v217 offset:17408
    ds_read_b64_tr_b16 a[36:37], v218 offset:16384
    ds_read_b64_tr_b16 a[38:39], v218 offset:17408
    v_and_b32 v211, s91, v241
    v_add_f32 v50, v50, v210
    v_add_f32 v51, v51, v211
    v_mul_f32 v50, s60, v50
    v_mul_f32 v51, s60, v51
    v_lshlrev_b32 v52, 16, v226
    buffer_load_dwordx4 v[152:155], v4, s[40:43], s56 offen offset:2048 sc1
    v_mfma_f32_32x32x16_bf16 v[16:31], a[200:203], v[116:119], v[16:31]
    v_mfma_f32_32x32x16_bf16 v[32:47], a[204:207], v[116:119], v[32:47]
    s_waitcnt vmcnt(21)
    ds_read_b64_tr_b16 a[40:41], v217 offset:18432
    ds_read_b64_tr_b16 a[42:43], v217 offset:19456
    ds_read_b64_tr_b16 a[44:45], v218 offset:18432
    ds_read_b64_tr_b16 a[46:47], v218 offset:19456
    v_and_b32 v53, s91, v226
    v_lshlrev_b32 v208, 16, v242
    v_and_b32 v209, s91, v242
    v_add_f32 v52, v52, v208
    v_add_f32 v53, v53, v209
    v_mul_f32 v52, s60, v52
    buffer_load_dwordx4 v[156:159], v4, s[40:43], s56 offen offset:3072 sc1
    v_mfma_f32_32x32x16_bf16 v[16:31], a[208:211], v[120:123], v[16:31]
    v_mfma_f32_32x32x16_bf16 v[32:47], a[212:215], v[120:123], v[32:47]
    s_waitcnt vmcnt(19)
    ds_read_b64_tr_b16 a[48:49], v217 offset:20480
    ds_read_b64_tr_b16 a[50:51], v217 offset:21504
    ds_read_b64_tr_b16 a[52:53], v218 offset:20480
    ds_read_b64_tr_b16 a[54:55], v218 offset:21504
    v_mul_f32 v53, s60, v53
    v_lshlrev_b32 v54, 16, v227
    v_and_b32 v55, s91, v227
    v_lshlrev_b32 v210, 16, v243
    v_and_b32 v211, s91, v243
    v_add_f32 v54, v54, v210
    s_add_u32 s56, s58, s53
    buffer_load_dwordx4 v[160:163], v4, s[40:43], s56 offen offset:0 sc1
    v_mfma_f32_32x32x16_bf16 v[16:31], a[216:219], v[124:127], v[16:31]
    v_mfma_f32_32x32x16_bf16 v[32:47], a[220:223], v[124:127], v[32:47]
    s_waitcnt vmcnt(17)
    ds_read_b64_tr_b16 a[56:57], v217 offset:22528
    ds_read_b64_tr_b16 a[58:59], v217 offset:23552
    ds_read_b64_tr_b16 a[60:61], v218 offset:22528
    ds_read_b64_tr_b16 a[62:63], v218 offset:23552
    v_add_f32 v55, v55, v211
    v_mul_f32 v54, s60, v54
    v_mul_f32 v55, s60, v55
    v_lshlrev_b32 v56, 16, v228
    v_and_b32 v57, s91, v228
    v_lshlrev_b32 v208, 16, v244
    buffer_load_dwordx4 v[164:167], v4, s[40:43], s56 offen offset:1024 sc1
    v_mfma_f32_32x32x16_bf16 v[16:31], a[224:227], v[128:131], v[16:31]
    v_mfma_f32_32x32x16_bf16 v[32:47], a[228:231], v[128:131], v[32:47]
    s_waitcnt vmcnt(15)
    ds_read_b64_tr_b16 a[64:65], v217 offset:24576
    ds_read_b64_tr_b16 a[66:67], v217 offset:25600
    ds_read_b64_tr_b16 a[68:69], v218 offset:24576
    ds_read_b64_tr_b16 a[70:71], v218 offset:25600
    v_and_b32 v209, s91, v244
    v_add_f32 v56, v56, v208
    v_add_f32 v57, v57, v209
    v_mul_f32 v56, s60, v56
    v_mul_f32 v57, s60, v57
    v_lshlrev_b32 v58, 16, v229
    buffer_load_dwordx4 v[168:171], v4, s[40:43], s56 offen offset:2048 sc1
    v_mfma_f32_32x32x16_bf16 v[16:31], a[232:235], v[132:135], v[16:31]
    v_mfma_f32_32x32x16_bf16 v[32:47], a[236:239], v[132:135], v[32:47]
    s_waitcnt vmcnt(12)
    ds_read_b64_tr_b16 a[72:73], v217 offset:26624
    ds_read_b64_tr_b16 a[74:75], v217 offset:27648
    ds_read_b64_tr_b16 a[76:77], v218 offset:26624
    ds_read_b64_tr_b16 a[78:79], v218 offset:27648
    v_and_b32 v59, s91, v229
    v_lshlrev_b32 v210, 16, v245
    v_and_b32 v211, s91, v245
    v_add_f32 v58, v58, v210
    v_add_f32 v59, v59, v211
    v_mul_f32 v58, s60, v58
    buffer_load_dwordx4 v[172:175], v4, s[40:43], s56 offen offset:3072 sc1
    v_mfma_f32_32x32x16_bf16 v[16:31], a[240:243], v[136:139], v[16:31]
    v_mfma_f32_32x32x16_bf16 v[32:47], a[244:247], v[136:139], v[32:47]
    s_waitcnt vmcnt(10)
    ds_read_b64_tr_b16 a[80:81], v217 offset:28672
    ds_read_b64_tr_b16 a[82:83], v217 offset:29696
    ds_read_b64_tr_b16 a[84:85], v218 offset:28672
    ds_read_b64_tr_b16 a[86:87], v218 offset:29696
    v_mul_f32 v59, s60, v59
    v_lshlrev_b32 v60, 16, v230
    v_and_b32 v61, s91, v230
    v_lshlrev_b32 v208, 16, v246
    v_and_b32 v209, s91, v246
    v_add_f32 v60, v60, v208
    s_add_u32 s56, s58, s54
    buffer_load_dwordx4 v[176:179], v4, s[40:43], s56 offen offset:0 sc1
    v_mfma_f32_32x32x16_bf16 v[16:31], a[248:251], v[140:143], v[16:31]
    v_mfma_f32_32x32x16_bf16 v[32:47], a[252:255], v[140:143], v[32:47]
    s_waitcnt vmcnt(8)
    ds_read_b64_tr_b16 a[88:89], v217 offset:30720
    ds_read_b64_tr_b16 a[90:91], v217 offset:31744
    ds_read_b64_tr_b16 a[92:93], v218 offset:30720
    ds_read_b64_tr_b16 a[94:95], v218 offset:31744
    v_add_f32 v61, v61, v209
    v_mul_f32 v60, s60, v60
    v_mul_f32 v61, s60, v61
    v_lshlrev_b32 v62, 16, v231
    v_and_b32 v63, s91, v231
    v_lshlrev_b32 v210, 16, v247
    buffer_load_dwordx4 v[180:183], v4, s[40:43], s56 offen offset:1024 sc1
    v_mfma_f32_32x32x16_bf16 v[16:31], a[0:3], v[144:147], v[16:31]
    v_mfma_f32_32x32x16_bf16 v[32:47], a[4:7], v[144:147], v[32:47]
    v_and_b32 v211, s91, v247
    v_add_f32 v62, v62, v210
    v_add_f32 v63, v63, v211
    v_mul_f32 v62, s60, v62
    v_mul_f32 v63, s60, v63
    buffer_load_dword v248, v12, s[40:43], s85 offen offset:0 sc1
    buffer_load_dwordx4 v[184:187], v4, s[40:43], s56 offen offset:2048 sc1
    s_waitcnt vmcnt(10)
    v_mfma_f32_32x32x16_bf16 v[16:31], a[8:11], v[148:151], v[16:31]
    v_mfma_f32_32x32x16_bf16 v[32:47], a[12:15], v[148:151], v[32:47]
    buffer_load_dwordx4 v[188:191], v4, s[40:43], s56 offen offset:3072 sc1
    s_waitcnt vmcnt(10)
    v_mfma_f32_32x32x16_bf16 v[16:31], a[16:19], v[152:155], v[16:31]
    v_mfma_f32_32x32x16_bf16 v[32:47], a[20:23], v[152:155], v[32:47]
    s_waitcnt vmcnt(9)
    v_mfma_f32_32x32x16_bf16 v[16:31], a[24:27], v[156:159], v[16:31]
    v_mfma_f32_32x32x16_bf16 v[32:47], a[28:31], v[156:159], v[32:47]
    s_waitcnt vmcnt(8) lgkmcnt(15)
    v_mfma_f32_32x32x16_bf16 v[16:31], a[32:35], v[160:163], v[16:31]
    v_mfma_f32_32x32x16_bf16 v[32:47], a[36:39], v[160:163], v[32:47]
    s_waitcnt vmcnt(2)
    v_cmp_ne_u32 vcc, s4, v248
    s_nop 1
    s_cbranch_vccz Lpcd_P_13
    s_nop 6
Lpc_P_12:
    s_sub_u32 s6, s6, 1
    s_cbranch_scc1 L_end_P
    buffer_load_dword v248, v12, s[40:43], s85 offen offset:0 sc1
    s_waitcnt vmcnt(0)
    v_cmp_ne_u32 vcc, s4, v248
    s_nop 1
    s_cbranch_vccnz Lpc_P_12
Lpcd_P_13:
    s_add_u32 s56, s59, s48
    buffer_load_dwordx4 v[192:195], v4, s[40:43], s56 offen offset:0 sc1
    buffer_load_dwordx4 v[196:199], v4, s[40:43], s56 offen offset:1024 sc1
    v_mfma_f32_32x32x16_bf16 v[16:31], a[40:43], v[164:167], v[16:31]
    v_mfma_f32_32x32x16_bf16 v[32:47], a[44:47], v[164:167], v[32:47]
    buffer_load_dwordx4 v[200:203], v4, s[40:43], s56 offen offset:2048 sc1
    buffer_load_dwordx4 v[204:207], v4, s[40:43], s56 offen offset:3072 sc1
    v_mfma_f32_32x32x16_bf16 v[16:31], a[48:51], v[168:171], v[16:31]
    v_mfma_f32_32x32x16_bf16 v[32:47], a[52:55], v[168:171], v[32:47]
    s_add_u32 s56, s59, s49
    buffer_load_dwordx4 v[80:83], v4, s[40:43], s56 offen offset:0 sc1
    v_mfma_f32_32x32x16_bf16 v[16:31], a[56:59], v[172:175], v[16:31]
    v_mfma_f32_32x32x16_bf16 v[32:47], a[60:63], v[172:175], v[32:47]
    buffer_load_dwordx4 v[84:87], v4, s[40:43], s56 offen offset:1024 sc1
    s_waitcnt lgkmcnt(14)
    v_mfma_f32_32x32x16_bf16 v[16:31], a[64:67], v[176:179], v[16:31]
    s_waitcnt lgkmcnt(12)
    v_mfma_f32_32x32x16_bf16 v[32:47], a[68:71], v[176:179], v[32:47]
    buffer_load_dwordx4 v[88:91], v4, s[40:43], s56 offen offset:2048 sc1
    s_waitcnt lgkmcnt(10)
    v_mfma_f32_32x32x16_bf16 v[16:31], a[72:75], v[180:183], v[16:31]
    s_waitcnt lgkmcnt(8)
    v_mfma_f32_32x32x16_bf16 v[32:47], a[76:79], v[180:183], v[32:47]
    buffer_load_dwordx4 v[92:95], v4, s[40:43], s56 offen offset:3072 sc1
    s_waitcnt vmcnt(9) lgkmcnt(6)
    v_mfma_f32_32x32x16_bf16 v[16:31], a[80:83], v[184:187], v[16:31]
    s_waitcnt lgkmcnt(4)
    v_mfma_f32_32x32x16_bf16 v[32:47], a[84:87], v[184:187], v[32:47]
    s_add_u32 s56, s59, s50
    buffer_load_dwordx4 v[96:99], v4, s[40:43], s56 offen offset:0 sc1
    s_waitcnt vmcnt(9) lgkmcnt(2)
    v_mfma_f32_32x32x16_bf16 v[16:31], a[88:91], v[188:191], v[16:31]
    s_waitcnt lgkmcnt(0)
    v_mfma_f32_32x32x16_bf16 v[32:47], a[92:95], v[188:191], v[32:47]
    buffer_load_dwordx4 v[100:103], v4, s[40:43], s56 offen offset:1024 sc1
    s_waitcnt vmcnt(9)
    v_mfma_f32_32x32x16_bf16 v[48:63], a[128:131], v[192:195], v[48:63]
    v_mfma_f32_32x32x16_bf16 v[64:79], a[132:135], v[192:195], 0
    s_nop 7
    ds_write_b32 v237, v32 offset:0
    ds_write_b32 v237, v34 offset:256
    ds_write_b32 v237, v33 offset:128
    ds_write_b32 v237, v35 offset:384
    ds_write_b32 v237, v36 offset:1024
    ds_write_b32 v237, v38 offset:1280
    buffer_load_dwordx4 v[104:107], v4, s[40:43], s56 offen offset:2048 sc1
    s_waitcnt vmcnt(9)
    v_mfma_f32_32x32x16_bf16 v[48:63], a[136:139], v[196:199], v[48:63]
    v_mfma_f32_32x32x16_bf16 v[64:79], a[140:143], v[196:199], v[64:79]
    ds_write_b32 v237, v37 offset:1152
    ds_write_b32 v237, v39 offset:1408
    ds_write_b32 v237, v40 offset:2048
    ds_write_b32 v237, v42 offset:2304
    ds_write_b32 v237, v41 offset:2176
    ds_write_b32 v237, v43 offset:2432
    buffer_load_dwordx4 v[108:111], v4, s[40:43], s56 offen offset:3072 sc1
    s_waitcnt vmcnt(9)
    v_mfma_f32_32x32x16_bf16 v[48:63], a[144:147], v[200:203], v[48:63]
    v_mfma_f32_32x32x16_bf16 v[64:79], a[148:151], v[200:203], v[64:79]
    ds_write_b32 v237, v44 offset:3072
    ds_write_b32 v237, v46 offset:3328
    ds_write_b32 v237, v45 offset:3200
    ds_write_b32 v237, v47 offset:3456
    ds_write_b32 v236, v16 offset:0
    ds_write_b32 v236, v18 offset:256
    s_add_u32 s56, s59, s51
    buffer_load_dwordx4 v[112:115], v4, s[40:43], s56 offen offset:0 sc1
    s_waitcnt vmcnt(9)
    v_mfma_f32_32x32x16_bf16 v[48:63], a[152:155], v[204:207], v[48:63]
    v_mfma_f32_32x32x16_bf16 v[64:79], a[156:159], v[204:207], v[64:79]
    ds_write_b32 v236, v17 offset:128
    ds_write_b32 v236, v19 offset:384
    ds_write_b32 v236, v20 offset:1024
    ds_write_b32 v236, v22 offset:1280
    ds_write_b32 v236, v21 offset:1152
    ds_write_b32 v236, v23 offset:1408
    buffer_load_dwordx4 v[116:119], v4, s[40:43], s56 offen offset:1024 sc1
    s_waitcnt vmcnt(9)
    v_mfma_f32_32x32x16_bf16 v[48:63], a[160:163], v[80:83], v[48:63]
    v_mfma_f32_32x32x16_bf16 v[64:79], a[164:167], v[80:83], v[64:79]
    ds_write_b32 v236, v24 offset:2048
    ds_write_b32 v236, v26 offset:2304
    ds_write_b32 v236, v25 offset:2176
    ds_write_b32 v236, v27 offset:2432
    ds_write_b32 v236, v28 offset:3072
    ds_write_b32 v236, v30 offset:3328
    buffer_load_dwordx4 v[120:123], v4, s[40:43], s56 offen offset:2048 sc1
    s_waitcnt vmcnt(9)
    v_mfma_f32_32x32x16_bf16 v[48:63], a[168:171], v[84:87], v[48:63]
    v_mfma_f32_32x32x16_bf16 v[64:79], a[172:175], v[84:87], v[64:79]
    ds_write_b32 v236, v29 offset:3200
    ds_write_b32 v236, v31 offset:3456
    buffer_load_dwordx4 v[124:127], v4, s[40:43], s56 offen offset:3072 sc1
    s_waitcnt vmcnt(9)
    v_mfma_f32_32x32x16_bf16 v[48:63], a[176:179], v[88:91], v[48:63]
    v_mfma_f32_32x32x16_bf16 v[64:79], a[180:183], v[88:91], v[64:79]
    s_add_u32 s56, s59, s52
    buffer_load_dwordx4 v[128:131], v4, s[40:43], s56 offen offset:0 sc1
    s_waitcnt vmcnt(9)
    v_mfma_f32_32x32x16_bf16 v[48:63], a[184:187], v[92:95], v[48:63]
    v_mfma_f32_32x32x16_bf16 v[64:79], a[188:191], v[92:95], v[64:79]
    s_waitcnt lgkmcnt(0)
    s_barrier
    ds_read_b128 v[16:19], v238 offset:0
    ds_read_b128 v[20:23], v238 offset:36864
    ds_read_b128 v[24:27], v239 offset:0
    ds_read_b128 v[28:31], v239 offset:36864
    ds_read_b128 v[32:35], v238 offset:1024
    ds_read_b128 v[36:39], v238 offset:37888
    ds_read_b128 v[40:43], v239 offset:1024
    ds_read_b128 v[44:47], v239 offset:37888
    buffer_load_dwordx4 v[132:135], v4, s[40:43], s56 offen offset:1024 sc1
    s_waitcnt vmcnt(9)
    v_mfma_f32_32x32x16_bf16 v[48:63], a[192:195], v[96:99], v[48:63]
    v_mfma_f32_32x32x16_bf16 v[64:79], a[196:199], v[96:99], v[64:79]
    buffer_load_dwordx4 v[136:139], v4, s[40:43], s56 offen offset:2048 sc1
    s_waitcnt vmcnt(9)
    v_mfma_f32_32x32x16_bf16 v[48:63], a[200:203], v[100:103], v[48:63]
    v_mfma_f32_32x32x16_bf16 v[64:79], a[204:207], v[100:103], v[64:79]
    s_waitcnt lgkmcnt(6)
    v_add_f32 v16, v16, v20
    s_waitcnt lgkmcnt(4)
    v_add_f32 v24, v24, v28
    v_add_f32 v17, v17, v21
    v_add_f32 v25, v25, v29
    v_add_f32 v18, v18, v22
    v_add_f32 v26, v26, v30
    buffer_load_dwordx4 v[140:143], v4, s[40:43], s56 offen offset:3072 sc1
    s_waitcnt vmcnt(9)
    v_mfma_f32_32x32x16_bf16 v[48:63], a[208:211], v[104:107], v[48:63]
    v_mfma_f32_32x32x16_bf16 v[64:79], a[212:215], v[104:107], v[64:79]
    v_add_f32 v19, v19, v23
    v_add_f32 v27, v27, v31
    v_add_f32 v16, v16, v24
    v_add_f32 v17, v17, v25
    v_add_f32 v18, v18, v26
    v_add_f32 v19, v19, v27
    s_add_u32 s56, s59, s53
    buffer_load_dwordx4 v[144:147], v4, s[40:43], s56 offen offset:0 sc1
    s_waitcnt vmcnt(9)
    v_mfma_f32_32x32x16_bf16 v[48:63], a[216:219], v[108:111], v[48:63]
    v_mfma_f32_32x32x16_bf16 v[64:79], a[220:223], v[108:111], v[64:79]
    v_cvt_pk_bf16_f32 v20, v16, v17
    v_cvt_pk_bf16_f32 v21, v18, v19
    buffer_store_dwordx2 v[20:21], v212, s[36:39], s68 offen offset:0
    s_waitcnt lgkmcnt(2)
    v_add_f32 v32, v32, v36
    s_waitcnt lgkmcnt(0)
    v_add_f32 v40, v40, v44
    v_add_f32 v33, v33, v37
    buffer_load_dwordx4 v[148:151], v4, s[40:43], s56 offen offset:1024 sc1
    s_waitcnt vmcnt(10)
    v_mfma_f32_32x32x16_bf16 v[48:63], a[224:227], v[112:115], v[48:63]
    v_mfma_f32_32x32x16_bf16 v[64:79], a[228:231], v[112:115], v[64:79]
    v_add_f32 v41, v41, v45
    v_add_f32 v34, v34, v38
    v_add_f32 v42, v42, v46
    v_add_f32 v35, v35, v39
    v_add_f32 v43, v43, v47
    v_add_f32 v32, v32, v40
    buffer_load_dwordx4 v[152:155], v4, s[40:43], s56 offen offset:2048 sc1
    s_waitcnt vmcnt(10)
    v_mfma_f32_32x32x16_bf16 v[48:63], a[232:235], v[116:119], v[48:63]
    v_mfma_f32_32x32x16_bf16 v[64:79], a[236:239], v[116:119], v[64:79]
    v_add_f32 v33, v33, v41
    v_add_f32 v34, v34, v42
    v_add_f32 v35, v35, v43
    v_cvt_pk_bf16_f32 v36, v32, v33
    v_cvt_pk_bf16_f32 v37, v34, v35
    buffer_store_dwordx2 v[36:37], v212, s[36:39], s69 offen offset:0
    buffer_load_dwordx4 v[156:159], v4, s[40:43], s56 offen offset:3072 sc1
    s_waitcnt vmcnt(11)
    v_mfma_f32_32x32x16_bf16 v[48:63], a[240:243], v[120:123], v[48:63]
    v_mfma_f32_32x32x16_bf16 v[64:79], a[244:247], v[120:123], v[64:79]
    s_add_u32 s56, s59, s54
    buffer_load_dwordx4 v[160:163], v4, s[40:43], s56 offen offset:0 sc1
    s_waitcnt vmcnt(11)
    v_mfma_f32_32x32x16_bf16 v[48:63], a[248:251], v[124:127], v[48:63]
    v_mfma_f32_32x32x16_bf16 v[64:79], a[252:255], v[124:127], v[64:79]
    buffer_load_dwordx4 v[164:167], v4, s[40:43], s56 offen offset:1024 sc1
    s_waitcnt vmcnt(11)
    v_mfma_f32_32x32x16_bf16 v[48:63], a[0:3], v[128:131], v[48:63]
    v_mfma_f32_32x32x16_bf16 v[64:79], a[4:7], v[128:131], v[64:79]
    buffer_load_dwordx4 v[168:171], v4, s[40:43], s56 offen offset:2048 sc1
    s_waitcnt vmcnt(11)
    v_mfma_f32_32x32x16_bf16 v[48:63], a[8:11], v[132:135], v[48:63]
    v_mfma_f32_32x32x16_bf16 v[64:79], a[12:15], v[132:135], v[64:79]
    buffer_load_dwordx4 v[172:175], v4, s[40:43], s56 offen offset:3072 sc1
    s_waitcnt vmcnt(11)
    v_mfma_f32_32x32x16_bf16 v[48:63], a[16:19], v[136:139], v[48:63]
    v_mfma_f32_32x32x16_bf16 v[64:79], a[20:23], v[136:139], v[64:79]
    s_waitcnt vmcnt(10)
    v_mfma_f32_32x32x16_bf16 v[48:63], a[24:27], v[140:143], v[48:63]
    v_mfma_f32_32x32x16_bf16 v[64:79], a[28:31], v[140:143], v[64:79]
    s_waitcnt vmcnt(9)
    v_mfma_f32_32x32x16_bf16 v[48:63], a[32:35], v[144:147], v[48:63]
    v_mfma_f32_32x32x16_bf16 v[64:79], a[36:39], v[144:147], v[64:79]
    s_waitcnt vmcnt(7)
    v_mfma_f32_32x32x16_bf16 v[48:63], a[40:43], v[148:151], v[48:63]
    v_mfma_f32_32x32x16_bf16 v[64:79], a[44:47], v[148:151], v[64:79]
    s_waitcnt vmcnt(6)
    v_mfma_f32_32x32x16_bf16 v[48:63], a[48:51], v[152:155], v[48:63]
    v_mfma_f32_32x32x16_bf16 v[64:79], a[52:55], v[152:155], v[64:79]
    s_waitcnt vmcnt(4)
    v_mfma_f32_32x32x16_bf16 v[48:63], a[56:59], v[156:159], v[48:63]
    v_mfma_f32_32x32x16_bf16 v[64:79], a[60:63], v[156:159], v[64:79]
    s_waitcnt vmcnt(3)
    v_mfma_f32_32x32x16_bf16 v[64:79], a[68:71], v[160:163], v[64:79]
    s_waitcnt vmcnt(2)
    v_mfma_f32_32x32x16_bf16 v[64:79], a[76:79], v[164:167], v[64:79]
    s_waitcnt vmcnt(1)
    v_mfma_f32_32x32x16_bf16 v[64:79], a[84:87], v[168:171], v[64:79]
    s_waitcnt vmcnt(0)
    v_mfma_f32_32x32x16_bf16 v[64:79], a[92:95], v[172:175], v[64:79]
    v_mfma_f32_32x32x16_bf16 v[48:63], a[64:67], v[160:163], v[48:63]
    v_mfma_f32_32x32x16_bf16 v[48:63], a[72:75], v[164:167], v[48:63]
    s_nop 9
    ds_write_b32 v237, v64 offset:8192
    ds_write_b32 v237, v66 offset:8448
    ds_write_b32 v237, v65 offset:8320
    ds_write_b32 v237, v67 offset:8576
    ds_write_b32 v237, v68 offset:9216
    ds_write_b32 v237, v70 offset:9472
    v_mfma_f32_32x32x16_bf16 v[48:63], a[80:83], v[168:171], v[48:63]
    ds_write_b32 v237, v69 offset:9344
    ds_write_b32 v237, v71 offset:9600
    ds_write_b32 v237, v72 offset:10240
    ds_write_b32 v237, v74 offset:10496
    ds_write_b32 v237, v73 offset:10368
    ds_write_b32 v237, v75 offset:10624
    v_mfma_f32_32x32x16_bf16 v[48:63], a[88:91], v[172:175], v[48:63]
    ds_write_b32 v237, v76 offset:11264
    ds_write_b32 v237, v78 offset:11520
    ds_write_b32 v237, v77 offset:11392
    ds_write_b32 v237, v79 offset:11648
    s_nop 7
    ds_write_b32 v236, v48 offset:8192
    ds_write_b32 v236, v50 offset:8448
    ds_write_b32 v236, v49 offset:8320
    ds_write_b32 v236, v51 offset:8576
    ds_write_b32 v236, v52 offset:9216
    ds_write_b32 v236, v54 offset:9472
    ds_write_b32 v236, v53 offset:9344
    ds_write_b32 v236, v55 offset:9600
    ds_write_b32 v236, v56 offset:10240
    ds_write_b32 v236, v58 offset:10496
    ds_write_b32 v236, v57 offset:10368
    ds_write_b32 v236, v59 offset:10624
    ds_write_b32 v236, v60 offset:11264
    ds_write_b32 v236, v62 offset:11520
    ds_write_b32 v236, v61 offset:11392
    ds_write_b32 v236, v63 offset:11648
    s_waitcnt lgkmcnt(0)
    s_barrier
    ds_read_b128 v[48:51], v238 offset:8192
    ds_read_b128 v[52:55], v238 offset:45056
    ds_read_b128 v[56:59], v239 offset:8192
    ds_read_b128 v[60:63], v239 offset:45056
    ds_read_b128 v[64:67], v238 offset:9216
    ds_read_b128 v[68:71], v238 offset:46080
    ds_read_b128 v[72:75], v239 offset:9216
    ds_read_b128 v[76:79], v239 offset:46080
    s_waitcnt lgkmcnt(6)
    v_pk_add_f32 v[48:49], v[48:49], v[52:53]
    s_waitcnt lgkmcnt(4)
    v_pk_add_f32 v[56:57], v[56:57], v[60:61]
    v_pk_add_f32 v[50:51], v[50:51], v[54:55]
    v_pk_add_f32 v[58:59], v[58:59], v[62:63]
    v_pk_add_f32 v[48:49], v[48:49], v[56:57]
    v_pk_add_f32 v[50:51], v[50:51], v[58:59]
    v_cvt_pk_bf16_f32 v52, v48, v49
    v_cvt_pk_bf16_f32 v53, v50, v51
    buffer_store_dwordx2 v[52:53], v212, s[36:39], s68 offen offset:64
    s_waitcnt lgkmcnt(2)
    v_pk_add_f32 v[64:65], v[64:65], v[68:69]
    s_waitcnt lgkmcnt(0)
    v_pk_add_f32 v[72:73], v[72:73], v[76:77]
    v_pk_add_f32 v[66:67], v[66:67], v[70:71]
    v_pk_add_f32 v[74:75], v[74:75], v[78:79]
    v_pk_add_f32 v[64:65], v[64:65], v[72:73]
    v_pk_add_f32 v[66:67], v[66:67], v[74:75]
    v_cvt_pk_bf16_f32 v68, v64, v65
    v_cvt_pk_bf16_f32 v69, v66, v67
    buffer_store_dwordx2 v[68:69], v212, s[36:39], s69 offen offset:64
L_end_P:
    s_endpgm

.section .rodata,"a"
.p2align 6
.amdhsa_kernel sequential_preLN__sliding_local_dilated__mixer_token_mlp__prompt_kernel
  .amdhsa_next_free_vgpr 508
  .amdhsa_next_free_sgpr 102
  .amdhsa_accum_offset 252
  .amdhsa_group_segment_fixed_size 0
  .amdhsa_kernarg_size 88
  .amdhsa_user_sgpr_count 2
  .amdhsa_user_sgpr_kernarg_segment_ptr 1
  .amdhsa_system_sgpr_workgroup_id_x 1
.end_amdhsa_kernel
```

```asm
; @launch grid=(256,1,1) block=(256,1,1) lds=163840
.amdgcn_target "amdgcn-amd-amdhsa--gfx950"
.text
.globl sequential_preLN__sliding_local_dilated__mixer_token_mlp__prompt_kernel
.p2align 8
.type sequential_preLN__sliding_local_dilated__mixer_token_mlp__prompt_kernel,@function
sequential_preLN__sliding_local_dilated__mixer_token_mlp__prompt_kernel:
    s_cmp_ge_u32 s2, 256
    s_cbranch_scc1 L_end_P
    s_load_dwordx2 s[8:9], s[0:1], 0
    s_load_dwordx2 s[12:13], s[0:1], 8
    s_load_dwordx2 s[44:45], s[0:1], 72
    s_load_dwordx2 s[40:41], s[0:1], 80
    s_load_dwordx2 s[16:17], s[0:1], 16
    s_load_dwordx2 s[20:21], s[0:1], 32
    s_load_dwordx2 s[24:25], s[0:1], 48
    s_load_dwordx2 s[28:29], s[0:1], 40
    s_load_dwordx2 s[32:33], s[0:1], 56
    s_load_dwordx2 s[36:37], s[0:1], 64
    v_lshrrev_b32 v1, 6, v0
    s_nop 0
    v_readfirstlane_b32 s3, v1
    v_and_b32 v1, 63, v0
    v_and_b32 v2, 15, v0
    v_lshrrev_b32 v3, 4, v1
    v_lshlrev_b32 v4, 4, v1
    s_mov_b32 s10, 0x1c0000
    s_mov_b32 s11, 0x00020000
    s_mov_b32 s14, 0x126000
    s_mov_b32 s15, 0x00020000
    s_mov_b32 s46, 0x100
    s_mov_b32 s47, 0x00020000
    s_mov_b32 s42, 0x5c0000
    s_mov_b32 s43, 0x00020000
    s_mov_b32 s18, 0x62000
    s_mov_b32 s19, 0x00020000
    s_mov_b32 s22, 0x700000
    s_mov_b32 s23, 0x00020000
    s_mov_b32 s26, 0x700000
    s_mov_b32 s27, 0x00020000
    s_mov_b32 s30, 0xe00
    s_mov_b32 s31, 0x00020000
    s_mov_b32 s34, 0x1000
    s_mov_b32 s35, 0x00020000
    s_mov_b32 s38, 0x1c0000
    s_mov_b32 s39, 0x00020000
    s_mov_b32 s5, 0x3f803f80
    s_mov_b32 s6, 0x200000
    s_bfe_u32 s48, s2, 0x20001
    s_lshl_b32 s48, s48, 2
    s_lshr_b32 s53, s2, 6
    s_add_u32 s48, s48, s53
    s_bfe_u32 s49, s2, 0x30003
    s_and_b32 s53, s2, 1
    s_lshl_b32 s53, s53, 3
    s_add_u32 s49, s49, s53
    v_lshrrev_b32 v237, 2, v1
    v_mul_u32_u24 v123, 2688, v237
    v_lshrrev_b32 v237, 5, v1
    v_lshlrev_b32 v237, 1, v237
    v_and_b32 v238, 3, v1
    v_xor_b32 v237, v237, v238
    v_lshl_add_u32 v123, v237, 4, v123
    s_mul_i32 s53, s49, 56
    s_min_u32 s53, s53, 832
    s_mul_i32 s51, s3, 43008
    s_add_u32 s53, s53, s51
    v_add_u32 v123, s53, v123
    s_lshr_b32 s53, s3, 1
    s_mul_i32 s51, s53, 6144
    s_and_b32 s53, s3, 1
    s_lshl_b32 s53, s53, 10
    s_add_u32 s51, s51, s53
    v_lshrrev_b32 v237, 3, v1
    v_mul_u32_u24 v122, 896, v237
    v_and_b32 v237, 7, v1
    v_xor_b32 v237, v237, v3
    v_lshl_add_u32 v120, v237, 4, v122
    s_lshl_b32 s50, s48, 7
    s_lshl_b32 s53, s3, 5
    s_add_u32 s53, s53, s50
    s_mul_i32 s53, s53, 896
    v_xor_b32 v121, 64, v120
    v_add_u32 v120, s53, v120
    s_add_u32 s53, s53, 7168
    v_add_u32 v121, s53, v121
    s_lshl_b32 s53, s3, 1
    v_xor_b32 v237, s53, v237
    v_lshl_add_u32 v122, v237, 4, v122
    s_lshl_b32 s53, s3, 2
    s_add_u32 s53, s53, s50
    s_sub_u32 s53, s53, 16
    s_mul_i32 s53, s53, 896
    s_cmp_eq_u32 s48, 0
    s_cselect_b32 s53, 0x40000000, s53
    v_add_u32 v122, s53, v122
    s_lshl_b32 s52, s3, 12
    s_add_u32 s52, s52, 63488
    s_lshl_b32 s7, s3, 9
    s_cmp_eq_u32 s3, 0
    s_cselect_b32 s54, 0xffffff00, -1
    s_mov_b32 s55, 0
    s_memrealtime s[86:87]
    v_mov_b32 v7, 0
    s_waitcnt lgkmcnt(0)
    s_or_b32 s86, s86, 1
    v_mov_b32 v6, s86
    s_or_b32 s86, s2, s3
    s_cmp_eq_u32 s86, 0
    s_cselect_b64 exec, 1, 0
    buffer_store_dword v6, v7, s[44:47], 0 offen sc1
    s_mov_b64 exec, -1
    s_add_u32 m0, s51, 12288
    s_mov_b32 s73, 0
    buffer_load_dwordx4 v123, s[12:15], s73 offen lds
    s_add_u32 m0, s51, 14336
    s_mov_b32 s73, 896
    buffer_load_dwordx4 v123, s[12:15], s73 offen lds
    s_add_u32 m0, s51, 16384
    s_mov_b32 s73, 1792
    buffer_load_dwordx4 v123, s[12:15], s73 offen lds
    s_add_u32 m0, s52, 36864
    s_mov_b32 s73, 0
    buffer_load_dwordx4 v120, s[8:11], s73 offen lds
    s_add_u32 m0, s52, 37888
    s_mov_b32 s73, 0
    buffer_load_dwordx4 v121, s[8:11], s73 offen lds
    s_add_u32 m0, s52, 38912
    s_mov_b32 s73, 14336
    buffer_load_dwordx4 v120, s[8:11], s73 offen lds
    s_add_u32 m0, s52, 39936
    s_mov_b32 s73, 14336
    buffer_load_dwordx4 v121, s[8:11], s73 offen lds
    s_add_u32 m0, s7, 98304
    s_mov_b32 s73, 0
    s_mov_b64 exec, s[54:55]
    buffer_load_dwordx4 v122, s[8:11], s73 offen lds
    s_mov_b64 exec, -1
    s_bfe_u32 s53, s2, 0x30003
    s_add_u32 s86, s53, 1
    s_lshr_b32 s86, s86, 1
    s_lshr_b32 s87, s2, 6
    s_mul_i32 s87, s87, 5
    s_add_u32 s86, s86, s87
    s_lshl_b32 s86, s86, 2
    s_add_u32 s53, s86, s3
    s_mov_b32 s56, s53
    s_mov_b32 s86, 0x2a54
    s_bitcmp1_b32 s86, s49
    s_cselect_b32 s57, 0x40000000, 0
    s_mul_i32 s86, s53, 48
    v_add_u32 v237, s86, v1
    v_mul_u32_u24 v238, 43691, v237
    v_lshrrev_b32 v238, 19, v238
    v_mul_u32_u24 v239, 12, v238
    v_sub_u32 v239, v237, v239
    v_lshrrev_b32 v239, 2, v239
    v_mul_u32_u24 v239, 896, v239
    v_mul_u32_u24 v238, 2688, v238
    v_and_b32 v237, 3, v237
    v_lshlrev_b32 v237, 7, v237
    v_add3_u32 v237, v237, v238, v239
    v_add_u32 v237, s57, v237
    s_and_b32 s86, s2, 1
    s_mul_i32 s86, s86, 384
    s_add_u32 s86, s86, 344064
    s_mov_b32 exec_hi, 0xffff
    buffer_load_dword v232, v237, s[12:15], s86 offen
    v_lshlrev_b32 v237, 7, v1
    v_add_u32 v238, s57, v237
    s_mul_i32 s86, s53, 6016
    s_bfe_u32 s87, s2, 0x20001
    s_mul_i32 s87, s87, 458752
    s_add_u32 s86, s86, s87
    s_max_u32 s86, s86, 14336
    s_sub_u32 s86, s86, 14336
    s_mov_b32 exec_hi, 0x7fff
    buffer_load_dword v233, v238, s[8:11], s86 offen
    s_getpc_b64 s[86:87]
Lpc_P:
    s_mul_i32 s53, s53, 384
    v_add_u32 v237, s53, v237
    v_min_u32 v237, L_end_P-Lpc_P, v237
    s_mov_b64 exec, 7
    global_load_dword v236, v237, s[86:87]
    s_mov_b64 exec, -1
    v_mul_u32_u24 v237, 18432, v3
    v_lshl_add_u32 v237, v2, 3, v237
    v_mov_b32 v238, s5
    v_add_u32 v237, 61440, v237
    ds_write2_b32 v237, v238, v238 offset0:0 offset1:1
    s_lshr_b32 s68, s2, 3
    s_mul_i32 s69, s68, 37
    s_lshr_b32 s69, s69, 8
    s_mul_i32 s64, s69, 7
    s_sub_u32 s64, s68, s64
    s_mov_b32 s66, s64
    s_and_b32 s68, s2, 7
    s_lshl_b32 s67, s68, 2
    s_add_u32 s67, s67, s69
    s_cmp_ge_u32 s69, 4
    s_cselect_b32 s67, 99, s67
    s_mul_i32 s71, s68, 3
    s_add_u32 s71, s71, 4
    s_lshl_b32 s72, s68, 2
    s_cmp_lt_u32 s68, 4
    s_cselect_b32 s65, s72, s71
    s_cselect_b32 s71, 4, 3
    s_add_u32 s65, s65, s69
    s_cmp_ge_u32 s69, s71
    s_cselect_b32 s65, 99, s65
    v_lshrrev_b32 v219, 3, v1
    v_mul_u32_u24 v208, 896, v219
    v_and_b32 v219, 1, v3
    v_lshlrev_b32 v219, 2, v219
    v_and_b32 v220, 7, v1
    v_xor_b32 v219, v219, v220
    v_lshl_add_u32 v208, v219, 4, v208
    s_lshl_b32 s58, s66, 7
    s_mul_i32 s60, s3, 100352
    s_add_u32 s58, s58, s60
    v_add_u32 v208, s58, v208
    s_mul_i32 s59, s3, 14336
    s_add_u32 s59, s59, 106496
    v_lshrrev_b32 v219, 5, v1
    v_lshlrev_b32 v209, 9, v219
    v_bfe_u32 v219, v1, 2, 2
    v_lshl_add_u32 v209, v219, 7, v209
    v_lshrrev_b32 v219, 1, v219
    s_and_b32 s58, s3, 1
    v_xor_b32 v219, s58, v219
    v_lshl_add_u32 v209, v219, 6, v209
    v_and_b32 v219, 1, v3
    v_lshl_add_u32 v209, v219, 5, v209
    v_and_b32 v219, 3, v1
    v_lshl_add_u32 v209, v219, 3, v209
    v_add_u32 v209, 106496, v209
    v_lshrrev_b32 v219, 5, v1
    v_lshlrev_b32 v219, 10, v219
    v_sub_u32 v210, v209, v219
    s_mul_i32 s70, s3, 36864
    s_add_u32 s70, s70, 12288
    v_lshrrev_b32 v219, 3, v1
    v_mul_u32_u24 v213, 3584, v219
    v_and_b32 v219, 1, v3
    v_lshlrev_b32 v219, 2, v219
    v_and_b32 v220, 7, v1
    v_xor_b32 v219, v219, v220
    v_lshl_add_u32 v213, v219, 4, v213
    s_mul_i32 s68, s3, 1835008
    s_lshl_b32 s69, s65, 7
    s_add_u32 s68, s68, s69
    s_cmp_ge_u32 s65, 99
    s_cselect_b32 s68, 0x40000000, s68
    v_add_u32 v213, s68, v213
    s_cselect_b32 s68, 0x40000000, 0
    v_add_u32 v5, s68, v4
    v_lshrrev_b32 v219, 5, v1
    v_lshlrev_b32 v215, 9, v219
    v_bfe_u32 v219, v1, 2, 2
    v_lshl_add_u32 v215, v219, 7, v215
    v_lshrrev_b32 v219, 1, v219
    s_lshr_b32 s68, s3, 1
    v_xor_b32 v219, s68, v219
    v_lshl_add_u32 v215, v219, 6, v215
    v_and_b32 v219, 1, v3
    v_lshl_add_u32 v215, v219, 5, v215
    v_and_b32 v219, 3, v1
    v_lshl_add_u32 v215, v219, 3, v215
    s_and_b32 s68, s3, 1
    s_lshl_b32 s68, s68, 5
    v_xor_b32 v215, s68, v215
    v_add_u32 v215, s70, v215
    v_xor_b32 v216, 64, v215
    s_mul_i32 s70, s3, 36864
    s_add_u32 s70, s70, 12288
    v_lshrrev_b32 v219, 3, v1
    v_mul_u32_u24 v214, 4096, v219
    v_and_b32 v219, 1, v3
    v_lshlrev_b32 v219, 2, v219
    v_and_b32 v220, 7, v1
    v_xor_b32 v219, v219, v220
    v_lshl_add_u32 v214, v219, 4, v214
    s_mul_i32 s68, s3, 1835008
    s_lshl_b32 s69, s67, 7
    s_add_u32 s68, s68, s69
    s_cmp_ge_u32 s67, 99
    s_cselect_b32 s68, 0x40000000, s68
    v_add_u32 v214, s68, v214
    v_lshrrev_b32 v219, 5, v1
    v_lshlrev_b32 v217, 9, v219
    v_bfe_u32 v219, v1, 2, 2
    v_lshl_add_u32 v217, v219, 7, v217
    v_lshrrev_b32 v219, 1, v219
    s_lshr_b32 s68, s3, 1
    v_xor_b32 v219, s68, v219
    v_lshl_add_u32 v217, v219, 6, v217
    v_and_b32 v219, 1, v3
    v_lshl_add_u32 v217, v219, 5, v217
    v_and_b32 v219, 3, v1
    v_lshl_add_u32 v217, v219, 3, v217
    v_add_u32 v217, s70, v217
    v_xor_b32 v218, 64, v217
    s_and_b32 s68, s2, 7
    s_cmp_ge_u32 s68, 8
    s_cselect_b32 s94, 8, 0
    s_sub_u32 s68, s68, s94
    s_lshl_b32 s94, s68, 12
    s_add_u32 s68, s68, 1
    s_cmp_ge_u32 s68, 8
    s_cselect_b32 s95, 8, 0
    s_sub_u32 s68, s68, s95
    s_lshl_b32 s95, s68, 12
    s_add_u32 s68, s68, 1
    s_cmp_ge_u32 s68, 8
    s_cselect_b32 s96, 8, 0
    s_sub_u32 s68, s68, s96
    s_lshl_b32 s96, s68, 12
    s_add_u32 s68, s68, 1
    s_cmp_ge_u32 s68, 8
    s_cselect_b32 s97, 8, 0
    s_sub_u32 s68, s68, s97
    s_lshl_b32 s97, s68, 12
    s_add_u32 s68, s68, 1
    s_cmp_ge_u32 s68, 8
    s_cselect_b32 s98, 8, 0
    s_sub_u32 s68, s68, s98
    s_lshl_b32 s98, s68, 12
    s_add_u32 s68, s68, 1
    s_cmp_ge_u32 s68, 8
    s_cselect_b32 s99, 8, 0
    s_sub_u32 s68, s68, s99
    s_lshl_b32 s99, s68, 12
    s_add_u32 s68, s68, 1
    s_cmp_ge_u32 s68, 8
    s_cselect_b32 s100, 8, 0
    s_sub_u32 s68, s68, s100
    s_lshl_b32 s100, s68, 12
    s_add_u32 s68, s68, 1
    s_cmp_ge_u32 s68, 8
    s_cselect_b32 s101, 8, 0
    s_sub_u32 s68, s68, s101
    s_lshl_b32 s101, s68, 12
    s_lshl_b32 s80, s48, 2
    s_add_u32 s80, s80, s3
    s_lshl_b32 s80, s80, 11
    s_lshr_b32 s93, s49, 2
    s_lshl_b32 s93, s93, 7
    s_add_u32 s80, s80, s93
    s_and_b32 s93, s49, 3
    s_lshl_b32 s93, s93, 2
    s_add_u32 s80, s80, s93
    s_add_u32 s80, s80, 0x588000
    s_lshl_b32 s83, s67, 1
    s_lshr_b32 s93, s3, 1
    s_add_u32 s83, s83, s93
    s_lshl_b32 s83, s83, 11
    s_add_u32 s83, s83, 0x588000
    v_lshrrev_b32 v10, 2, v2
    v_lshlrev_b32 v10, 7, v10
    v_and_b32 v219, 3, v2
    v_lshl_add_u32 v10, v219, 2, v10
    s_lshl_b32 s84, s64, 12
    s_lshl_b32 s85, s84, 1
    s_add_u32 s85, s85, 0x5b0000
    s_add_u32 s84, s84, 0x5a8000
    s_lshl_b32 s81, s67, 5
    s_add_u32 s81, s81, s3
    s_lshl_b32 s81, s81, 2
    s_add_u32 s81, s81, s84
    s_lshl_b32 s93, s3, 10
    s_add_u32 s84, s84, s93
    v_bfe_u32 v11, v1, 2, 3
    v_min_u32 v12, 6, v11
    v_and_b32 v219, 3, v1
    v_lshlrev_b32 v219, 2, v219
    v_lshl_add_u32 v11, v11, 7, v219
    v_lshl_add_u32 v12, v12, 7, v219
    s_lshl_b32 s82, s65, 5
    s_add_u32 s82, s82, s3
    s_lshl_b32 s82, s82, 2
    s_add_u32 s82, s82, s85
    s_mul_i32 s93, s3, 896
    s_add_u32 s85, s85, s93
    v_mov_b32 v9, 0
    v_lshlrev_b32 v124, 9, v3
    v_bfe_u32 v237, v1, 2, 2
    v_lshl_add_u32 v124, v237, 6, v124
    v_and_b32 v237, 3, v1
    v_lshl_add_u32 v124, v237, 3, v124
    v_and_b32 v237, 1, v3
    v_lshlrev_b32 v237, 5, v237
    v_add_u32 v124, v124, v237
    v_add_u32 v124, 12288, v124
    v_xor_b32 v125, 32, v124
    s_and_b32 s53, s3, 1
    s_lshl_b32 s53, s53, 5
    v_xor_b32 v127, s53, v124
    s_lshr_b32 s53, s3, 1
    s_lshl_b32 s53, s53, 11
    s_add_u32 s53, s53, 2048
    v_add_u32 v126, s53, v127
    v_lshrrev_b32 v237, 1, v2
    v_xor_b32 v237, v237, v3
    v_lshlrev_b32 v237, 4, v237
    v_lshl_add_u32 v237, v2, 7, v237
    v_add_u32 v130, 61440, v237
    v_xor_b32 v131, 64, v130
    v_add_u32 v128, s52, v237
    v_xor_b32 v129, 64, v128
    v_lshlrev_b32 v237, 2, v3
    v_sub_u32 v237, v2, v237
    v_mov_b32 v239, 0xf149f2ca
    v_add_u32 v238, 16, v237
    v_and_b32 v238, 0xfffffff1, v238
    v_cmp_eq_u32 vcc, 0, v238
    s_nop 1
    v_cndmask_b32 v240, v239, 0, vcc
    v_add_u32 v238, 15, v237
    v_and_b32 v238, 0xfffffff1, v238
    v_cmp_eq_u32 vcc, 0, v238
    s_nop 1
    v_cndmask_b32 v241, v239, 0, vcc
    v_add_u32 v238, 14, v237
    v_and_b32 v238, 0xfffffff1, v238
    v_cmp_eq_u32 vcc, 0, v238
    s_nop 1
    v_cndmask_b32 v242, v239, 0, vcc
    v_add_u32 v238, 13, v237
    v_and_b32 v238, 0xfffffff1, v238
    v_cmp_eq_u32 vcc, 0, v238
    s_nop 1
    v_cndmask_b32 v243, v239, 0, vcc
    v_add_u32 v238, 0, v237
    v_and_b32 v238, 0xfffffff1, v238
    v_cmp_eq_u32 vcc, 0, v238
    s_nop 1
    v_cndmask_b32 v244, v239, 0, vcc
    v_add_u32 v238, -1, v237
    v_and_b32 v238, 0xfffffff1, v238
    v_cmp_eq_u32 vcc, 0, v238
    s_nop 1
    v_cndmask_b32 v245, v239, 0, vcc
    v_add_u32 v238, -2, v237
    v_and_b32 v238, 0xfffffff1, v238
    v_cmp_eq_u32 vcc, 0, v238
    s_nop 1
    v_cndmask_b32 v246, v239, 0, vcc
    v_add_u32 v238, -3, v237
    v_and_b32 v238, 0xfffffff1, v238
    v_cmp_eq_u32 vcc, 0, v238
    s_nop 1
    v_cndmask_b32 v247, v239, 0, vcc
    s_or_b32 s53, s48, s3
    s_cmp_eq_u32 s53, 0
    s_cselect_b64 vcc, -1, 0
    v_cndmask_b32 v248, v240, v239, vcc
    v_cndmask_b32 v249, v241, v239, vcc
    v_cndmask_b32 v250, v242, v239, vcc
    v_cndmask_b32 v251, v243, v239, vcc
    v_mov_b32 v40, s5
    v_mov_b32 v41, s5
    v_mov_b32 v42, s5
    v_mov_b32 v43, s5
    s_mov_b32 s88, 0x22222222
    s_mov_b32 s89, 0x22222222
    s_mov_b32 s90, 0x44444444
    s_mov_b32 s91, 0x44444444
    s_mov_b32 s92, 0x88888888
    s_mov_b32 s93, 0x88888888
    v_lshlrev_b32 v72, 4, v3
    s_lshl_b32 s53, s3, 6
    v_add_u32 v73, s53, v72
    s_and_b32 s53, s53, 64
    v_add_u32 v74, s53, v72
    s_mul_i32 s53, s3, 384
    v_lshl_add_u32 v75, v2, 2, s53
    v_add_u32 v76, s53, v72
    s_and_b32 s53, s3, 1
    s_lshl_b32 s53, s53, 3
    v_add_u32 v80, s53, v4
    v_lshrrev_b32 v81, 2, v2
    v_lshlrev_b32 v81, 8, v81
    v_lshl_add_u32 v81, v3, 6, v81
    v_and_b32 v82, 3, v2
    v_lshl_add_u32 v81, v82, 1, v81
    v_add_u32 v81, s53, v81
    v_add_u32 v81, 1024, v81
    s_cmp_lt_u32 s3, 2
    s_cselect_b64 vcc, -1, 0
    s_cselect_b32 s53, 2, 16
    v_cndmask_b32 v80, v81, v80, vcc
    v_add_u32 v81, s53, v80
    v_add_u32 v82, s53, v81
    v_add_u32 v83, s53, v82
    v_lshlrev_b32 v77, 2, v2
    s_lshl_b32 s53, s3, 11
    v_add_u32 v78, s53, v4
    s_lshl_b32 s62, s48, 3
    s_lshl_b32 s63, s3, 1
    s_add_u32 s62, s62, s63
    s_lshl_b32 s62, s62, 4
    s_add_u32 s62, s62, s49
    s_lshl_b32 s62, s62, 10
    s_add_u32 s63, s62, 16384
    s_add_u32 m0, s51, 24576
    s_mov_b32 s73, 172032
    buffer_load_dwordx4 v123, s[12:15], s73 offen lds
    s_add_u32 m0, s51, 26624
    s_mov_b32 s73, 172928
    buffer_load_dwordx4 v123, s[12:15], s73 offen lds
    s_add_u32 m0, s51, 28672
    s_mov_b32 s73, 173824
    buffer_load_dwordx4 v123, s[12:15], s73 offen lds
    s_add_u32 m0, s52, 18432
    s_mov_b32 s73, 128
    buffer_load_dwordx4 v120, s[8:11], s73 offen lds
    s_add_u32 m0, s52, 19456
    s_mov_b32 s73, 128
    buffer_load_dwordx4 v121, s[8:11], s73 offen lds
    s_add_u32 m0, s52, 20480
    s_mov_b32 s73, 14464
    buffer_load_dwordx4 v120, s[8:11], s73 offen lds
    s_add_u32 m0, s52, 21504
    s_mov_b32 s73, 14464
    buffer_load_dwordx4 v121, s[8:11], s73 offen lds
    s_add_u32 m0, s7, 79872
    s_mov_b32 s73, 128
    s_mov_b64 exec, s[54:55]
    buffer_load_dwordx4 v122, s[8:11], s73 offen lds
    s_mov_b64 exec, -1
    s_waitcnt vmcnt(11)
    s_waitcnt lgkmcnt(0)
    s_barrier
    ds_read_b128 v[16:19], v128 offset:36864
    ds_read_b128 v[20:23], v128 offset:38912
    ds_read_b128 v[24:27], v130 offset:36864
    ds_read_b64_tr_b16 v[88:89], v124 offset:0
    ds_read_b64_tr_b16 v[90:91], v124 offset:256
    ds_read_b64_tr_b16 v[92:93], v125 offset:0
    ds_read_b64_tr_b16 v[94:95], v125 offset:256
    ds_read_b64_tr_b16 v[96:97], v124 offset:2048
    ds_read_b64_tr_b16 v[98:99], v124 offset:2304
    ds_read_b64_tr_b16 v[100:101], v125 offset:2048
    ds_read_b64_tr_b16 v[102:103], v125 offset:2304
    ds_read_b64_tr_b16 v[104:105], v124 offset:4096
    ds_read_b64_tr_b16 v[106:107], v124 offset:4352
    ds_read_b64_tr_b16 v[108:109], v125 offset:4096
    ds_read_b64_tr_b16 v[110:111], v125 offset:4352
    ds_read_b64_tr_b16 v[112:113], v126 offset:0
    ds_read_b64_tr_b16 v[114:115], v126 offset:256
    ds_read_b64_tr_b16 v[116:117], v127 offset:0
    ds_read_b64_tr_b16 v[118:119], v127 offset:256
    s_waitcnt lgkmcnt(8)
    v_mfma_f32_16x16x32_bf16 v[136:139], v[88:91], v[16:19], 0
    ds_read_b128 v[28:31], v129 offset:36864
    v_mfma_f32_16x16x32_bf16 v[160:163], v[88:91], v[20:23], 0
    ds_read_b128 v[32:35], v129 offset:38912
    v_mfma_f32_16x16x32_bf16 v[140:143], v[92:95], v[16:19], 0
    ds_read_b128 v[36:39], v131 offset:36864
    v_mfma_f32_16x16x32_bf16 v[164:167], v[92:95], v[20:23], 0
    ds_read_b64_tr_b16 v[88:89], v124 offset:6144
    v_mfma_f32_16x16x32_bf16 v[144:147], v[96:99], v[16:19], 0
    ds_read_b64_tr_b16 v[90:91], v124 offset:6400
    s_add_u32 m0, s51, 36864
    s_mov_b32 s73, 344064
    buffer_load_dwordx4 v123, s[12:15], s73 offen lds
    v_mfma_f32_16x16x32_bf16 v[168:171], v[96:99], v[20:23], 0
    ds_read_b64_tr_b16 v[92:93], v125 offset:6144
    v_mfma_f32_16x16x32_bf16 v[148:151], v[100:103], v[16:19], 0
    ds_read_b64_tr_b16 v[94:95], v125 offset:6400
    v_mfma_f32_16x16x32_bf16 v[172:175], v[100:103], v[20:23], 0
    ds_read_b64_tr_b16 v[96:97], v124 offset:8192
    s_waitcnt lgkmcnt(8)
    v_mfma_f32_16x16x32_bf16 v[152:155], v[16:19], v[104:107], 0
    ds_read_b64_tr_b16 v[98:99], v124 offset:8448
    v_mfma_f32_16x16x32_bf16 v[176:179], v[20:23], v[104:107], 0
    ds_read_b64_tr_b16 v[100:101], v125 offset:8192
    s_add_u32 m0, s51, 38912
    s_mov_b32 s73, 344960
    buffer_load_dwordx4 v123, s[12:15], s73 offen lds
    v_mfma_f32_16x16x32_bf16 v[156:159], v[16:19], v[108:111], 0
    ds_read_b64_tr_b16 v[102:103], v125 offset:8448
    v_mfma_f32_16x16x32_bf16 v[180:183], v[20:23], v[108:111], 0
    ds_read_b64_tr_b16 v[104:105], v124 offset:10240
    v_mfma_f32_16x16x32_bf16 v[184:187], v[112:115], v[24:27], 0
    ds_read_b64_tr_b16 v[106:107], v124 offset:10496
    v_mfma_f32_16x16x32_bf16 v[188:191], v[116:119], v[24:27], 0
    ds_read_b64_tr_b16 v[108:109], v125 offset:10240
    v_mfma_f32_16x16x32_bf16 v[48:51], v[16:19], v[16:19], 0
    ds_read_b64_tr_b16 v[110:111], v125 offset:10496
    s_add_u32 m0, s51, 40960
    s_mov_b32 s73, 345856
    buffer_load_dwordx4 v123, s[12:15], s73 offen lds
    v_mfma_f32_16x16x32_bf16 v[52:55], v[20:23], v[20:23], 0
    ds_read_b64_tr_b16 v[112:113], v126 offset:6144
    v_mfma_f32_16x16x32_bf16 v[56:59], v[24:27], v[24:27], 0
    ds_read_b64_tr_b16 v[114:115], v126 offset:6400
    v_mfma_f32_16x16x32_bf16 v[60:63], v[40:43], v[16:19], 0
    ds_read_b64_tr_b16 v[116:117], v127 offset:6144
    v_mfma_f32_16x16x32_bf16 v[64:67], v[40:43], v[20:23], 0
    ds_read_b64_tr_b16 v[118:119], v127 offset:6400
    v_mfma_f32_16x16x32_bf16 v[68:71], v[40:43], v[24:27], 0
    s_add_u32 m0, s52, 0
    s_mov_b32 s73, 256
    buffer_load_dwordx4 v120, s[8:11], s73 offen lds
    s_add_u32 m0, s52, 1024
    s_mov_b32 s73, 256
    buffer_load_dwordx4 v121, s[8:11], s73 offen lds
    s_add_u32 m0, s52, 2048
    s_mov_b32 s73, 14592
    buffer_load_dwordx4 v120, s[8:11], s73 offen lds
    s_add_u32 m0, s52, 3072
    s_mov_b32 s73, 14592
    buffer_load_dwordx4 v121, s[8:11], s73 offen lds
    s_add_u32 m0, s7, 61440
    s_mov_b32 s73, 256
    s_mov_b64 exec, s[54:55]
    buffer_load_dwordx4 v122, s[8:11], s73 offen lds
    s_mov_b64 exec, -1
    s_waitcnt vmcnt(8)
    s_barrier
    s_waitcnt lgkmcnt(8)
    v_mfma_f32_16x16x32_bf16 v[136:139], v[88:91], v[28:31], v[136:139]
    ds_read_b128 v[16:19], v128 offset:18432
    v_mfma_f32_16x16x32_bf16 v[160:163], v[88:91], v[32:35], v[160:163]
    ds_read_b128 v[20:23], v128 offset:20480
    v_mfma_f32_16x16x32_bf16 v[140:143], v[92:95], v[28:31], v[140:143]
    ds_read_b128 v[24:27], v130 offset:18432
    v_mfma_f32_16x16x32_bf16 v[164:167], v[92:95], v[32:35], v[164:167]
    ds_read_b64_tr_b16 v[88:89], v124 offset:12288
    v_mfma_f32_16x16x32_bf16 v[144:147], v[96:99], v[28:31], v[144:147]
    ds_read_b64_tr_b16 v[90:91], v124 offset:12544
    s_add_u32 m0, s51, 49152
    s_mov_b32 s73, 516096
    buffer_load_dwordx4 v123, s[12:15], s73 offen lds
    v_mfma_f32_16x16x32_bf16 v[168:171], v[96:99], v[32:35], v[168:171]
    ds_read_b64_tr_b16 v[92:93], v125 offset:12288
    v_mfma_f32_16x16x32_bf16 v[148:151], v[100:103], v[28:31], v[148:151]
    ds_read_b64_tr_b16 v[94:95], v125 offset:12544
    v_mfma_f32_16x16x32_bf16 v[172:175], v[100:103], v[32:35], v[172:175]
    ds_read_b64_tr_b16 v[96:97], v124 offset:14336
    s_waitcnt lgkmcnt(8)
    v_mfma_f32_16x16x32_bf16 v[152:155], v[28:31], v[104:107], v[152:155]
    ds_read_b64_tr_b16 v[98:99], v124 offset:14592
    v_mfma_f32_16x16x32_bf16 v[176:179], v[32:35], v[104:107], v[176:179]
    ds_read_b64_tr_b16 v[100:101], v125 offset:14336
    s_add_u32 m0, s51, 51200
    s_mov_b32 s73, 516992
    buffer_load_dwordx4 v123, s[12:15], s73 offen lds
    v_mfma_f32_16x16x32_bf16 v[156:159], v[28:31], v[108:111], v[156:159]
    ds_read_b64_tr_b16 v[102:103], v125 offset:14592
    v_mfma_f32_16x16x32_bf16 v[180:183], v[32:35], v[108:111], v[180:183]
    ds_read_b64_tr_b16 v[104:105], v124 offset:16384
    v_mfma_f32_16x16x32_bf16 v[184:187], v[112:115], v[36:39], v[184:187]
    ds_read_b64_tr_b16 v[106:107], v124 offset:16640
    v_mfma_f32_16x16x32_bf16 v[188:191], v[116:119], v[36:39], v[188:191]
    ds_read_b64_tr_b16 v[108:109], v125 offset:16384
    v_mfma_f32_16x16x32_bf16 v[48:51], v[28:31], v[28:31], v[48:51]
    ds_read_b64_tr_b16 v[110:111], v125 offset:16640
    s_add_u32 m0, s51, 53248
    s_mov_b32 s73, 517888
    buffer_load_dwordx4 v123, s[12:15], s73 offen lds
    v_mfma_f32_16x16x32_bf16 v[52:55], v[32:35], v[32:35], v[52:55]
    ds_read_b64_tr_b16 v[112:113], v126 offset:12288
    v_mfma_f32_16x16x32_bf16 v[56:59], v[36:39], v[36:39], v[56:59]
    ds_read_b64_tr_b16 v[114:115], v126 offset:12544
    v_mfma_f32_16x16x32_bf16 v[60:63], v[40:43], v[28:31], v[60:63]
    ds_read_b64_tr_b16 v[116:117], v127 offset:12288
    v_mfma_f32_16x16x32_bf16 v[64:67], v[40:43], v[32:35], v[64:67]
    ds_read_b64_tr_b16 v[118:119], v127 offset:12544
    v_mfma_f32_16x16x32_bf16 v[68:71], v[40:43], v[36:39], v[68:71]
    s_add_u32 m0, s52, 55296
    s_mov_b32 s73, 384
    buffer_load_dwordx4 v120, s[8:11], s73 offen lds
    s_waitcnt lgkmcnt(8)
    v_mfma_f32_16x16x32_bf16 v[136:139], v[88:91], v[16:19], v[136:139]
    ds_read_b128 v[28:31], v129 offset:18432
    v_mfma_f32_16x16x32_bf16 v[160:163], v[88:91], v[20:23], v[160:163]
    ds_read_b128 v[32:35], v129 offset:20480
    v_mfma_f32_16x16x32_bf16 v[140:143], v[92:95], v[16:19], v[140:143]
    ds_read_b128 v[36:39], v131 offset:18432
    v_mfma_f32_16x16x32_bf16 v[164:167], v[92:95], v[20:23], v[164:167]
    ds_read_b64_tr_b16 v[88:89], v124 offset:18432
    v_mfma_f32_16x16x32_bf16 v[144:147], v[96:99], v[16:19], v[144:147]
    ds_read_b64_tr_b16 v[90:91], v124 offset:18688
    s_add_u32 m0, s52, 56320
    s_mov_b32 s73, 384
    buffer_load_dwordx4 v121, s[8:11], s73 offen lds
    v_mfma_f32_16x16x32_bf16 v[168:171], v[96:99], v[20:23], v[168:171]
    ds_read_b64_tr_b16 v[92:93], v125 offset:18432
    v_mfma_f32_16x16x32_bf16 v[148:151], v[100:103], v[16:19], v[148:151]
    ds_read_b64_tr_b16 v[94:95], v125 offset:18688
    v_mfma_f32_16x16x32_bf16 v[172:175], v[100:103], v[20:23], v[172:175]
    ds_read_b64_tr_b16 v[96:97], v124 offset:20480
    s_waitcnt lgkmcnt(8)
    v_mfma_f32_16x16x32_bf16 v[152:155], v[16:19], v[104:107], v[152:155]
    ds_read_b64_tr_b16 v[98:99], v124 offset:20736
    v_mfma_f32_16x16x32_bf16 v[176:179], v[20:23], v[104:107], v[176:179]
    ds_read_b64_tr_b16 v[100:101], v125 offset:20480
    s_add_u32 m0, s52, 57344
    s_mov_b32 s73, 14720
    buffer_load_dwordx4 v120, s[8:11], s73 offen lds
    v_mfma_f32_16x16x32_bf16 v[156:159], v[16:19], v[108:111], v[156:159]
    ds_read_b64_tr_b16 v[102:103], v125 offset:20736
    v_mfma_f32_16x16x32_bf16 v[180:183], v[20:23], v[108:111], v[180:183]
    ds_read_b64_tr_b16 v[104:105], v124 offset:22528
    v_mfma_f32_16x16x32_bf16 v[184:187], v[112:115], v[24:27], v[184:187]
    ds_read_b64_tr_b16 v[106:107], v124 offset:22784
    v_mfma_f32_16x16x32_bf16 v[188:191], v[116:119], v[24:27], v[188:191]
    ds_read_b64_tr_b16 v[108:109], v125 offset:22528
    v_mfma_f32_16x16x32_bf16 v[48:51], v[16:19], v[16:19], v[48:51]
    ds_read_b64_tr_b16 v[110:111], v125 offset:22784
    s_add_u32 m0, s52, 58368
    s_mov_b32 s73, 14720
    buffer_load_dwordx4 v121, s[8:11], s73 offen lds
    v_mfma_f32_16x16x32_bf16 v[52:55], v[20:23], v[20:23], v[52:55]
    ds_read_b64_tr_b16 v[112:113], v126 offset:18432
    v_mfma_f32_16x16x32_bf16 v[56:59], v[24:27], v[24:27], v[56:59]
    ds_read_b64_tr_b16 v[114:115], v126 offset:18688
    v_mfma_f32_16x16x32_bf16 v[60:63], v[40:43], v[16:19], v[60:63]
    ds_read_b64_tr_b16 v[116:117], v127 offset:18432
    v_mfma_f32_16x16x32_bf16 v[64:67], v[40:43], v[20:23], v[64:67]
    ds_read_b64_tr_b16 v[118:119], v127 offset:18688
    v_mfma_f32_16x16x32_bf16 v[68:71], v[40:43], v[24:27], v[68:71]
    s_add_u32 m0, s7, 116736
    s_mov_b32 s73, 384
    s_mov_b64 exec, s[54:55]
    buffer_load_dwordx4 v122, s[8:11], s73 offen lds
    s_mov_b64 exec, -1
    s_waitcnt vmcnt(8)
    s_barrier
    s_waitcnt lgkmcnt(8)
    v_mfma_f32_16x16x32_bf16 v[136:139], v[88:91], v[28:31], v[136:139]
    ds_read_b128 v[16:19], v128 offset:0
    v_mfma_f32_16x16x32_bf16 v[160:163], v[88:91], v[32:35], v[160:163]
    ds_read_b128 v[20:23], v128 offset:2048
    v_mfma_f32_16x16x32_bf16 v[140:143], v[92:95], v[28:31], v[140:143]
    ds_read_b128 v[24:27], v130 offset:0
    v_mfma_f32_16x16x32_bf16 v[164:167], v[92:95], v[32:35], v[164:167]
    ds_read_b64_tr_b16 v[88:89], v124 offset:24576
    v_mfma_f32_16x16x32_bf16 v[144:147], v[96:99], v[28:31], v[144:147]
    ds_read_b64_tr_b16 v[90:91], v124 offset:24832
    s_add_u32 m0, s51, 12288
    s_mov_b32 s73, 688128
    buffer_load_dwordx4 v123, s[12:15], s73 offen lds
    v_mfma_f32_16x16x32_bf16 v[168:171], v[96:99], v[32:35], v[168:171]
    ds_read_b64_tr_b16 v[92:93], v125 offset:24576
    v_mfma_f32_16x16x32_bf16 v[148:151], v[100:103], v[28:31], v[148:151]
    ds_read_b64_tr_b16 v[94:95], v125 offset:24832
    v_mfma_f32_16x16x32_bf16 v[172:175], v[100:103], v[32:35], v[172:175]
    ds_read_b64_tr_b16 v[96:97], v124 offset:26624
    s_waitcnt lgkmcnt(8)
    v_mfma_f32_16x16x32_bf16 v[152:155], v[28:31], v[104:107], v[152:155]
    ds_read_b64_tr_b16 v[98:99], v124 offset:26880
    v_mfma_f32_16x16x32_bf16 v[176:179], v[32:35], v[104:107], v[176:179]
    ds_read_b64_tr_b16 v[100:101], v125 offset:26624
    s_add_u32 m0, s51, 14336
    s_mov_b32 s73, 689024
    buffer_load_dwordx4 v123, s[12:15], s73 offen lds
    v_mfma_f32_16x16x32_bf16 v[156:159], v[28:31], v[108:111], v[156:159]
    ds_read_b64_tr_b16 v[102:103], v125 offset:26880
    v_mfma_f32_16x16x32_bf16 v[180:183], v[32:35], v[108:111], v[180:183]
    ds_read_b64_tr_b16 v[104:105], v124 offset:28672
    v_mfma_f32_16x16x32_bf16 v[184:187], v[112:115], v[36:39], v[184:187]
    ds_read_b64_tr_b16 v[106:107], v124 offset:28928
    v_mfma_f32_16x16x32_bf16 v[188:191], v[116:119], v[36:39], v[188:191]
    ds_read_b64_tr_b16 v[108:109], v125 offset:28672
    v_mfma_f32_16x16x32_bf16 v[48:51], v[28:31], v[28:31], v[48:51]
    ds_read_b64_tr_b16 v[110:111], v125 offset:28928
    s_add_u32 m0, s51, 16384
    s_mov_b32 s73, 689920
    buffer_load_dwordx4 v123, s[12:15], s73 offen lds
    v_mfma_f32_16x16x32_bf16 v[52:55], v[32:35], v[32:35], v[52:55]
    ds_read_b64_tr_b16 v[112:113], v126 offset:24576
    v_mfma_f32_16x16x32_bf16 v[56:59], v[36:39], v[36:39], v[56:59]
    ds_read_b64_tr_b16 v[114:115], v126 offset:24832
    v_mfma_f32_16x16x32_bf16 v[60:63], v[40:43], v[28:31], v[60:63]
    ds_read_b64_tr_b16 v[116:117], v127 offset:24576
    v_mfma_f32_16x16x32_bf16 v[64:67], v[40:43], v[32:35], v[64:67]
    ds_read_b64_tr_b16 v[118:119], v127 offset:24832
    v_mfma_f32_16x16x32_bf16 v[68:71], v[40:43], v[36:39], v[68:71]
    s_add_u32 m0, s52, 36864
    s_mov_b32 s73, 512
    buffer_load_dwordx4 v120, s[8:11], s73 offen lds
    s_waitcnt lgkmcnt(8)
    v_mfma_f32_16x16x32_bf16 v[136:139], v[88:91], v[16:19], v[136:139]
    ds_read_b128 v[28:31], v129 offset:0
    v_mfma_f32_16x16x32_bf16 v[160:163], v[88:91], v[20:23], v[160:163]
    ds_read_b128 v[32:35], v129 offset:2048
    v_mfma_f32_16x16x32_bf16 v[140:143], v[92:95], v[16:19], v[140:143]
    ds_read_b128 v[36:39], v131 offset:0
    v_mfma_f32_16x16x32_bf16 v[164:167], v[92:95], v[20:23], v[164:167]
    ds_read_b64_tr_b16 v[88:89], v124 offset:30720
    v_mfma_f32_16x16x32_bf16 v[144:147], v[96:99], v[16:19], v[144:147]
    ds_read_b64_tr_b16 v[90:91], v124 offset:30976
    s_add_u32 m0, s52, 37888
    s_mov_b32 s73, 512
    buffer_load_dwordx4 v121, s[8:11], s73 offen lds
    v_mfma_f32_16x16x32_bf16 v[168:171], v[96:99], v[20:23], v[168:171]
    ds_read_b64_tr_b16 v[92:93], v125 offset:30720
    v_mfma_f32_16x16x32_bf16 v[148:151], v[100:103], v[16:19], v[148:151]
    ds_read_b64_tr_b16 v[94:95], v125 offset:30976
    v_mfma_f32_16x16x32_bf16 v[172:175], v[100:103], v[20:23], v[172:175]
    ds_read_b64_tr_b16 v[96:97], v124 offset:32768
    s_waitcnt lgkmcnt(8)
    v_mfma_f32_16x16x32_bf16 v[152:155], v[16:19], v[104:107], v[152:155]
    ds_read_b64_tr_b16 v[98:99], v124 offset:33024
    v_mfma_f32_16x16x32_bf16 v[176:179], v[20:23], v[104:107], v[176:179]
    ds_read_b64_tr_b16 v[100:101], v125 offset:32768
    s_add_u32 m0, s52, 38912
    s_mov_b32 s73, 14848
    buffer_load_dwordx4 v120, s[8:11], s73 offen lds
    v_mfma_f32_16x16x32_bf16 v[156:159], v[16:19], v[108:111], v[156:159]
    ds_read_b64_tr_b16 v[102:103], v125 offset:33024
    v_mfma_f32_16x16x32_bf16 v[180:183], v[20:23], v[108:111], v[180:183]
    ds_read_b64_tr_b16 v[104:105], v124 offset:34816
    v_mfma_f32_16x16x32_bf16 v[184:187], v[112:115], v[24:27], v[184:187]
    ds_read_b64_tr_b16 v[106:107], v124 offset:35072
    v_mfma_f32_16x16x32_bf16 v[188:191], v[116:119], v[24:27], v[188:191]
    ds_read_b64_tr_b16 v[108:109], v125 offset:34816
    v_mfma_f32_16x16x32_bf16 v[48:51], v[16:19], v[16:19], v[48:51]
    ds_read_b64_tr_b16 v[110:111], v125 offset:35072
    s_add_u32 m0, s52, 39936
    s_mov_b32 s73, 14848
    buffer_load_dwordx4 v121, s[8:11], s73 offen lds
    v_mfma_f32_16x16x32_bf16 v[52:55], v[20:23], v[20:23], v[52:55]
    ds_read_b64_tr_b16 v[112:113], v126 offset:30720
    v_mfma_f32_16x16x32_bf16 v[56:59], v[24:27], v[24:27], v[56:59]
    ds_read_b64_tr_b16 v[114:115], v126 offset:30976
    v_mfma_f32_16x16x32_bf16 v[60:63], v[40:43], v[16:19], v[60:63]
    ds_read_b64_tr_b16 v[116:117], v127 offset:30720
    v_mfma_f32_16x16x32_bf16 v[64:67], v[40:43], v[20:23], v[64:67]
    ds_read_b64_tr_b16 v[118:119], v127 offset:30976
    v_mfma_f32_16x16x32_bf16 v[68:71], v[40:43], v[24:27], v[68:71]
    s_add_u32 m0, s7, 98304
    s_mov_b32 s73, 512
    s_mov_b64 exec, s[54:55]
    buffer_load_dwordx4 v122, s[8:11], s73 offen lds
    s_mov_b64 exec, -1
    s_waitcnt vmcnt(8)
    s_barrier
    s_waitcnt lgkmcnt(8)
    v_mfma_f32_16x16x32_bf16 v[136:139], v[88:91], v[28:31], v[136:139]
    ds_read_b128 v[16:19], v128 offset:55296
    v_mfma_f32_16x16x32_bf16 v[160:163], v[88:91], v[32:35], v[160:163]
    ds_read_b128 v[20:23], v128 offset:57344
    v_mfma_f32_16x16x32_bf16 v[140:143], v[92:95], v[28:31], v[140:143]
    ds_read_b128 v[24:27], v130 offset:55296
    v_mfma_f32_16x16x32_bf16 v[164:167], v[92:95], v[32:35], v[164:167]
    ds_read_b64_tr_b16 v[88:89], v124 offset:36864
    v_mfma_f32_16x16x32_bf16 v[144:147], v[96:99], v[28:31], v[144:147]
    ds_read_b64_tr_b16 v[90:91], v124 offset:37120
    s_add_u32 m0, s51, 24576
    s_mov_b32 s73, 860160
    buffer_load_dwordx4 v123, s[12:15], s73 offen lds
    v_mfma_f32_16x16x32_bf16 v[168:171], v[96:99], v[32:35], v[168:171]
    ds_read_b64_tr_b16 v[92:93], v125 offset:36864
    v_mfma_f32_16x16x32_bf16 v[148:151], v[100:103], v[28:31], v[148:151]
    ds_read_b64_tr_b16 v[94:95], v125 offset:37120
    v_mfma_f32_16x16x32_bf16 v[172:175], v[100:103], v[32:35], v[172:175]
    ds_read_b64_tr_b16 v[96:97], v124 offset:38912
    s_waitcnt lgkmcnt(8)
    v_mfma_f32_16x16x32_bf16 v[152:155], v[28:31], v[104:107], v[152:155]
    ds_read_b64_tr_b16 v[98:99], v124 offset:39168
    v_mfma_f32_16x16x32_bf16 v[176:179], v[32:35], v[104:107], v[176:179]
    ds_read_b64_tr_b16 v[100:101], v125 offset:38912
    s_add_u32 m0, s51, 26624
    s_mov_b32 s73, 861056
    buffer_load_dwordx4 v123, s[12:15], s73 offen lds
    v_mfma_f32_16x16x32_bf16 v[156:159], v[28:31], v[108:111], v[156:159]
    ds_read_b64_tr_b16 v[102:103], v125 offset:39168
    v_mfma_f32_16x16x32_bf16 v[180:183], v[32:35], v[108:111], v[180:183]
    ds_read_b64_tr_b16 v[104:105], v124 offset:40960
    v_mfma_f32_16x16x32_bf16 v[184:187], v[112:115], v[36:39], v[184:187]
    ds_read_b64_tr_b16 v[106:107], v124 offset:41216
    v_mfma_f32_16x16x32_bf16 v[188:191], v[116:119], v[36:39], v[188:191]
    ds_read_b64_tr_b16 v[108:109], v125 offset:40960
    v_mfma_f32_16x16x32_bf16 v[48:51], v[28:31], v[28:31], v[48:51]
    ds_read_b64_tr_b16 v[110:111], v125 offset:41216
    s_add_u32 m0, s51, 28672
    s_mov_b32 s73, 861952
    buffer_load_dwordx4 v123, s[12:15], s73 offen lds
    v_mfma_f32_16x16x32_bf16 v[52:55], v[32:35], v[32:35], v[52:55]
    ds_read_b64_tr_b16 v[112:113], v126 offset:36864
    v_mfma_f32_16x16x32_bf16 v[56:59], v[36:39], v[36:39], v[56:59]
    ds_read_b64_tr_b16 v[114:115], v126 offset:37120
    v_mfma_f32_16x16x32_bf16 v[60:63], v[40:43], v[28:31], v[60:63]
    ds_read_b64_tr_b16 v[116:117], v127 offset:36864
    v_mfma_f32_16x16x32_bf16 v[64:67], v[40:43], v[32:35], v[64:67]
    ds_read_b64_tr_b16 v[118:119], v127 offset:37120
    v_mfma_f32_16x16x32_bf16 v[68:71], v[40:43], v[36:39], v[68:71]
    s_add_u32 m0, s52, 18432
    s_mov_b32 s73, 640
    buffer_load_dwordx4 v120, s[8:11], s73 offen lds
    s_waitcnt lgkmcnt(8)
    v_mfma_f32_16x16x32_bf16 v[136:139], v[88:91], v[16:19], v[136:139]
    ds_read_b128 v[28:31], v129 offset:55296
    v_mfma_f32_16x16x32_bf16 v[160:163], v[88:91], v[20:23], v[160:163]
    ds_read_b128 v[32:35], v129 offset:57344
    v_mfma_f32_16x16x32_bf16 v[140:143], v[92:95], v[16:19], v[140:143]
    ds_read_b128 v[36:39], v131 offset:55296
    v_mfma_f32_16x16x32_bf16 v[164:167], v[92:95], v[20:23], v[164:167]
    ds_read_b64_tr_b16 v[88:89], v124 offset:43008
    v_mfma_f32_16x16x32_bf16 v[144:147], v[96:99], v[16:19], v[144:147]
    ds_read_b64_tr_b16 v[90:91], v124 offset:43264
    s_add_u32 m0, s52, 19456
    s_mov_b32 s73, 640
    buffer_load_dwordx4 v121, s[8:11], s73 offen lds
    v_mfma_f32_16x16x32_bf16 v[168:171], v[96:99], v[20:23], v[168:171]
    ds_read_b64_tr_b16 v[92:93], v125 offset:43008
    v_mfma_f32_16x16x32_bf16 v[148:151], v[100:103], v[16:19], v[148:151]
    ds_read_b64_tr_b16 v[94:95], v125 offset:43264
    v_mfma_f32_16x16x32_bf16 v[172:175], v[100:103], v[20:23], v[172:175]
    ds_read_b64_tr_b16 v[96:97], v124 offset:45056
    s_waitcnt lgkmcnt(8)
    v_mfma_f32_16x16x32_bf16 v[152:155], v[16:19], v[104:107], v[152:155]
    ds_read_b64_tr_b16 v[98:99], v124 offset:45312
    v_mfma_f32_16x16x32_bf16 v[176:179], v[20:23], v[104:107], v[176:179]
    ds_read_b64_tr_b16 v[100:101], v125 offset:45056
    s_add_u32 m0, s52, 20480
    s_mov_b32 s73, 14976
    buffer_load_dwordx4 v120, s[8:11], s73 offen lds
    v_mfma_f32_16x16x32_bf16 v[156:159], v[16:19], v[108:111], v[156:159]
    ds_read_b64_tr_b16 v[102:103], v125 offset:45312
    v_mfma_f32_16x16x32_bf16 v[180:183], v[20:23], v[108:111], v[180:183]
    ds_read_b64_tr_b16 v[104:105], v124 offset:47104
    v_mfma_f32_16x16x32_bf16 v[184:187], v[112:115], v[24:27], v[184:187]
    ds_read_b64_tr_b16 v[106:107], v124 offset:47360
    v_mfma_f32_16x16x32_bf16 v[188:191], v[116:119], v[24:27], v[188:191]
    ds_read_b64_tr_b16 v[108:109], v125 offset:47104
    v_mfma_f32_16x16x32_bf16 v[48:51], v[16:19], v[16:19], v[48:51]
    ds_read_b64_tr_b16 v[110:111], v125 offset:47360
    s_add_u32 m0, s52, 21504
    s_mov_b32 s73, 14976
    buffer_load_dwordx4 v121, s[8:11], s73 offen lds
    v_mfma_f32_16x16x32_bf16 v[52:55], v[20:23], v[20:23], v[52:55]
    ds_read_b64_tr_b16 v[112:113], v126 offset:43008
    v_mfma_f32_16x16x32_bf16 v[56:59], v[24:27], v[24:27], v[56:59]
    ds_read_b64_tr_b16 v[114:115], v126 offset:43264
    v_mfma_f32_16x16x32_bf16 v[60:63], v[40:43], v[16:19], v[60:63]
    ds_read_b64_tr_b16 v[116:117], v127 offset:43008
    v_mfma_f32_16x16x32_bf16 v[64:67], v[40:43], v[20:23], v[64:67]
    ds_read_b64_tr_b16 v[118:119], v127 offset:43264
    v_mfma_f32_16x16x32_bf16 v[68:71], v[40:43], v[24:27], v[68:71]
    s_add_u32 m0, s7, 79872
    s_mov_b32 s73, 640
    s_mov_b64 exec, s[54:55]
    buffer_load_dwordx4 v122, s[8:11], s73 offen lds
    s_mov_b64 exec, -1
    s_waitcnt vmcnt(8)
    s_barrier
    s_waitcnt lgkmcnt(8)
    v_mfma_f32_16x16x32_bf16 v[136:139], v[88:91], v[28:31], v[136:139]
    ds_read_b128 v[16:19], v128 offset:36864
    v_mfma_f32_16x16x32_bf16 v[160:163], v[88:91], v[32:35], v[160:163]
    ds_read_b128 v[20:23], v128 offset:38912
    v_mfma_f32_16x16x32_bf16 v[140:143], v[92:95], v[28:31], v[140:143]
    ds_read_b128 v[24:27], v130 offset:36864
    v_mfma_f32_16x16x32_bf16 v[164:167], v[92:95], v[32:35], v[164:167]
    ds_read_b64_tr_b16 v[88:89], v124 offset:0
    v_mfma_f32_16x16x32_bf16 v[144:147], v[96:99], v[28:31], v[144:147]
    ds_read_b64_tr_b16 v[90:91], v124 offset:256
    s_add_u32 m0, s51, 36864
    s_mov_b32 s73, 1032192
    buffer_load_dwordx4 v123, s[12:15], s73 offen lds
    v_mfma_f32_16x16x32_bf16 v[168:171], v[96:99], v[32:35], v[168:171]
    ds_read_b64_tr_b16 v[92:93], v125 offset:0
    v_mfma_f32_16x16x32_bf16 v[148:151], v[100:103], v[28:31], v[148:151]
    ds_read_b64_tr_b16 v[94:95], v125 offset:256
    v_mfma_f32_16x16x32_bf16 v[172:175], v[100:103], v[32:35], v[172:175]
    ds_read_b64_tr_b16 v[96:97], v124 offset:2048
    s_waitcnt lgkmcnt(8)
    v_mfma_f32_16x16x32_bf16 v[152:155], v[28:31], v[104:107], v[152:155]
    ds_read_b64_tr_b16 v[98:99], v124 offset:2304
    v_mfma_f32_16x16x32_bf16 v[176:179], v[32:35], v[104:107], v[176:179]
    ds_read_b64_tr_b16 v[100:101], v125 offset:2048
    s_add_u32 m0, s51, 38912
    s_mov_b32 s73, 1033088
    buffer_load_dwordx4 v123, s[12:15], s73 offen lds
    v_mfma_f32_16x16x32_bf16 v[156:159], v[28:31], v[108:111], v[156:159]
    ds_read_b64_tr_b16 v[102:103], v125 offset:2304
    v_mfma_f32_16x16x32_bf16 v[180:183], v[32:35], v[108:111], v[180:183]
    ds_read_b64_tr_b16 v[104:105], v124 offset:4096
    v_mfma_f32_16x16x32_bf16 v[184:187], v[112:115], v[36:39], v[184:187]
    ds_read_b64_tr_b16 v[106:107], v124 offset:4352
    v_mfma_f32_16x16x32_bf16 v[188:191], v[116:119], v[36:39], v[188:191]
    ds_read_b64_tr_b16 v[108:109], v125 offset:4096
    v_mfma_f32_16x16x32_bf16 v[48:51], v[28:31], v[28:31], v[48:51]
    ds_read_b64_tr_b16 v[110:111], v125 offset:4352
    s_add_u32 m0, s51, 40960
    s_mov_b32 s73, 1033984
    buffer_load_dwordx4 v123, s[12:15], s73 offen lds
    v_mfma_f32_16x16x32_bf16 v[52:55], v[32:35], v[32:35], v[52:55]
    ds_read_b64_tr_b16 v[112:113], v126 offset:0
    v_mfma_f32_16x16x32_bf16 v[56:59], v[36:39], v[36:39], v[56:59]
    ds_read_b64_tr_b16 v[114:115], v126 offset:256
    v_mfma_f32_16x16x32_bf16 v[60:63], v[40:43], v[28:31], v[60:63]
    ds_read_b64_tr_b16 v[116:117], v127 offset:0
    v_mfma_f32_16x16x32_bf16 v[64:67], v[40:43], v[32:35], v[64:67]
    ds_read_b64_tr_b16 v[118:119], v127 offset:256
    v_mfma_f32_16x16x32_bf16 v[68:71], v[40:43], v[36:39], v[68:71]
    s_add_u32 m0, s52, 0
    s_mov_b32 s73, 768
    buffer_load_dwordx4 v120, s[8:11], s73 offen lds
    s_waitcnt lgkmcnt(8)
    v_mfma_f32_16x16x32_bf16 v[136:139], v[88:91], v[16:19], v[136:139]
    ds_read_b128 v[28:31], v129 offset:36864
    v_mfma_f32_16x16x32_bf16 v[160:163], v[88:91], v[20:23], v[160:163]
    ds_read_b128 v[32:35], v129 offset:38912
    v_mfma_f32_16x16x32_bf16 v[140:143], v[92:95], v[16:19], v[140:143]
    ds_read_b128 v[36:39], v131 offset:36864
    v_mfma_f32_16x16x32_bf16 v[164:167], v[92:95], v[20:23], v[164:167]
    ds_read_b64_tr_b16 v[88:89], v124 offset:6144
    v_mfma_f32_16x16x32_bf16 v[144:147], v[96:99], v[16:19], v[144:147]
    ds_read_b64_tr_b16 v[90:91], v124 offset:6400
    s_add_u32 m0, s52, 1024
    s_mov_b32 s73, 768
    buffer_load_dwordx4 v121, s[8:11], s73 offen lds
    v_mfma_f32_16x16x32_bf16 v[168:171], v[96:99], v[20:23], v[168:171]
    ds_read_b64_tr_b16 v[92:93], v125 offset:6144
    v_mfma_f32_16x16x32_bf16 v[148:151], v[100:103], v[16:19], v[148:151]
    ds_read_b64_tr_b16 v[94:95], v125 offset:6400
    v_mfma_f32_16x16x32_bf16 v[172:175], v[100:103], v[20:23], v[172:175]
    ds_read_b64_tr_b16 v[96:97], v124 offset:8192
    s_waitcnt lgkmcnt(8)
    v_mfma_f32_16x16x32_bf16 v[152:155], v[16:19], v[104:107], v[152:155]
    ds_read_b64_tr_b16 v[98:99], v124 offset:8448
    v_mfma_f32_16x16x32_bf16 v[176:179], v[20:23], v[104:107], v[176:179]
    ds_read_b64_tr_b16 v[100:101], v125 offset:8192
    s_add_u32 m0, s52, 2048
    s_mov_b32 s73, 15104
    buffer_load_dwordx4 v120, s[8:11], s73 offen lds
    v_mfma_f32_16x16x32_bf16 v[156:159], v[16:19], v[108:111], v[156:159]
    ds_read_b64_tr_b16 v[102:103], v125 offset:8448
    v_mfma_f32_16x16x32_bf16 v[180:183], v[20:23], v[108:111], v[180:183]
    ds_read_b64_tr_b16 v[104:105], v124 offset:10240
    v_mfma_f32_16x16x32_bf16 v[184:187], v[112:115], v[24:27], v[184:187]
    ds_read_b64_tr_b16 v[106:107], v124 offset:10496
    v_mfma_f32_16x16x32_bf16 v[188:191], v[116:119], v[24:27], v[188:191]
    ds_read_b64_tr_b16 v[108:109], v125 offset:10240
    v_mfma_f32_16x16x32_bf16 v[48:51], v[16:19], v[16:19], v[48:51]
    ds_read_b64_tr_b16 v[110:111], v125 offset:10496
    s_add_u32 m0, s52, 3072
    s_mov_b32 s73, 15104
    buffer_load_dwordx4 v121, s[8:11], s73 offen lds
    v_mfma_f32_16x16x32_bf16 v[52:55], v[20:23], v[20:23], v[52:55]
    ds_read_b64_tr_b16 v[112:113], v126 offset:6144
    v_mfma_f32_16x16x32_bf16 v[56:59], v[24:27], v[24:27], v[56:59]
    ds_read_b64_tr_b16 v[114:115], v126 offset:6400
    v_mfma_f32_16x16x32_bf16 v[60:63], v[40:43], v[16:19], v[60:63]
    ds_read_b64_tr_b16 v[116:117], v127 offset:6144
    v_mfma_f32_16x16x32_bf16 v[64:67], v[40:43], v[20:23], v[64:67]
    ds_read_b64_tr_b16 v[118:119], v127 offset:6400
    v_mfma_f32_16x16x32_bf16 v[68:71], v[40:43], v[24:27], v[68:71]
    s_add_u32 m0, s7, 61440
    s_mov_b32 s73, 768
    s_mov_b64 exec, s[54:55]
    buffer_load_dwordx4 v122, s[8:11], s73 offen lds
    s_mov_b64 exec, -1
    v_mov_b32 v7, 0
    buffer_load_dword v6, v7, s[44:47], 0 offen sc1
    s_lshr_b32 s68, s2, 3
    s_lshl_b32 s68, s68, 2
    s_add_u32 s68, s68, s3
    v_lshlrev_b32 v219, 7, v1
    s_mul_i32 s86, s68, 3200
    s_mov_b64 exec, 0x1ffffff
    buffer_load_dword v234, v219, s[16:19], s86 offen
    s_mov_b64 exec, -1
    v_lshrrev_b32 v219, 2, v1
    v_mul_u32_u24 v219, 3584, v219
    v_and_b32 v220, 3, v1
    v_lshl_add_u32 v219, v220, 7, v219
    s_mul_i32 s68, s68, 57344
    s_and_b32 s69, s2, 7
    s_mul_i32 s86, s69, 3
    s_add_u32 s86, s86, 4
    s_lshl_b32 s87, s69, 2
    s_min_u32 s86, s86, s87
    s_lshl_b32 s86, s86, 7
    s_add_u32 s86, s86, s68
    s_cmp_lt_u32 s69, 4
    s_cselect_b32 exec_lo, -1, 0x77777777
    s_cselect_b32 exec_hi, -1, 0x77777777
    buffer_load_dword v235, v219, s[20:23], s86 offen
    s_mov_b64 exec, -1
    s_waitcnt vmcnt(11)
    s_barrier
    s_waitcnt lgkmcnt(8)
    v_mfma_f32_16x16x32_bf16 v[136:139], v[88:91], v[28:31], v[136:139]
    ds_read_b128 v[16:19], v128 offset:18432
    v_mfma_f32_16x16x32_bf16 v[160:163], v[88:91], v[32:35], v[160:163]
    ds_read_b128 v[20:23], v128 offset:20480
    v_mfma_f32_16x16x32_bf16 v[140:143], v[92:95], v[28:31], v[140:143]
    ds_read_b128 v[24:27], v130 offset:18432
    v_mfma_f32_16x16x32_bf16 v[164:167], v[92:95], v[32:35], v[164:167]
    ds_read_b64_tr_b16 v[88:89], v124 offset:12288
    v_mfma_f32_16x16x32_bf16 v[144:147], v[96:99], v[28:31], v[144:147]
    ds_read_b64_tr_b16 v[90:91], v124 offset:12544
    v_mfma_f32_16x16x32_bf16 v[168:171], v[96:99], v[32:35], v[168:171]
    ds_read_b64_tr_b16 v[92:93], v125 offset:12288
    v_mfma_f32_16x16x32_bf16 v[148:151], v[100:103], v[28:31], v[148:151]
    ds_read_b64_tr_b16 v[94:95], v125 offset:12544
    v_mfma_f32_16x16x32_bf16 v[172:175], v[100:103], v[32:35], v[172:175]
    ds_read_b64_tr_b16 v[96:97], v124 offset:14336
    s_waitcnt lgkmcnt(8)
    v_mfma_f32_16x16x32_bf16 v[152:155], v[28:31], v[104:107], v[152:155]
    ds_read_b64_tr_b16 v[98:99], v124 offset:14592
    v_mfma_f32_16x16x32_bf16 v[176:179], v[32:35], v[104:107], v[176:179]
    ds_read_b64_tr_b16 v[100:101], v125 offset:14336
    v_mfma_f32_16x16x32_bf16 v[156:159], v[28:31], v[108:111], v[156:159]
    ds_read_b64_tr_b16 v[102:103], v125 offset:14592
    v_mfma_f32_16x16x32_bf16 v[180:183], v[32:35], v[108:111], v[180:183]
    ds_read_b64_tr_b16 v[104:105], v124 offset:16384
    v_mfma_f32_16x16x32_bf16 v[184:187], v[112:115], v[36:39], v[184:187]
    ds_read_b64_tr_b16 v[106:107], v124 offset:16640
    v_mfma_f32_16x16x32_bf16 v[188:191], v[116:119], v[36:39], v[188:191]
    ds_read_b64_tr_b16 v[108:109], v125 offset:16384
    v_mfma_f32_16x16x32_bf16 v[48:51], v[28:31], v[28:31], v[48:51]
    ds_read_b64_tr_b16 v[110:111], v125 offset:16640
    v_mfma_f32_16x16x32_bf16 v[52:55], v[32:35], v[32:35], v[52:55]
    ds_read_b64_tr_b16 v[112:113], v126 offset:12288
    v_mfma_f32_16x16x32_bf16 v[56:59], v[36:39], v[36:39], v[56:59]
    ds_read_b64_tr_b16 v[114:115], v126 offset:12544
    v_mfma_f32_16x16x32_bf16 v[60:63], v[40:43], v[28:31], v[60:63]
    ds_read_b64_tr_b16 v[116:117], v127 offset:12288
    v_mfma_f32_16x16x32_bf16 v[64:67], v[40:43], v[32:35], v[64:67]
    ds_read_b64_tr_b16 v[118:119], v127 offset:12544
    v_mfma_f32_16x16x32_bf16 v[68:71], v[40:43], v[36:39], v[68:71]
    s_waitcnt lgkmcnt(8)
    v_mfma_f32_16x16x32_bf16 v[136:139], v[88:91], v[16:19], v[136:139]
    ds_read_b128 v[28:31], v129 offset:18432
    v_mfma_f32_16x16x32_bf16 v[160:163], v[88:91], v[20:23], v[160:163]
    ds_read_b128 v[32:35], v129 offset:20480
    v_mfma_f32_16x16x32_bf16 v[140:143], v[92:95], v[16:19], v[140:143]
    ds_read_b128 v[36:39], v131 offset:18432
    v_mfma_f32_16x16x32_bf16 v[164:167], v[92:95], v[20:23], v[164:167]
    ds_read_b64_tr_b16 v[88:89], v124 offset:18432
    v_mfma_f32_16x16x32_bf16 v[144:147], v[96:99], v[16:19], v[144:147]
    ds_read_b64_tr_b16 v[90:91], v124 offset:18688
    v_mfma_f32_16x16x32_bf16 v[168:171], v[96:99], v[20:23], v[168:171]
    ds_read_b64_tr_b16 v[92:93], v125 offset:18432
    v_mfma_f32_16x16x32_bf16 v[148:151], v[100:103], v[16:19], v[148:151]
    ds_read_b64_tr_b16 v[94:95], v125 offset:18688
    v_mfma_f32_16x16x32_bf16 v[172:175], v[100:103], v[20:23], v[172:175]
    ds_read_b64_tr_b16 v[96:97], v124 offset:20480
    s_waitcnt lgkmcnt(8)
    v_mfma_f32_16x16x32_bf16 v[152:155], v[16:19], v[104:107], v[152:155]
    ds_read_b64_tr_b16 v[98:99], v124 offset:20736
    v_mfma_f32_16x16x32_bf16 v[176:179], v[20:23], v[104:107], v[176:179]
    ds_read_b64_tr_b16 v[100:101], v125 offset:20480
    v_mfma_f32_16x16x32_bf16 v[156:159], v[16:19], v[108:111], v[156:159]
    ds_read_b64_tr_b16 v[102:103], v125 offset:20736
    v_mfma_f32_16x16x32_bf16 v[180:183], v[20:23], v[108:111], v[180:183]
    ds_read_b64_tr_b16 v[104:105], v124 offset:22528
    v_mfma_f32_16x16x32_bf16 v[184:187], v[112:115], v[24:27], v[184:187]
    ds_read_b64_tr_b16 v[106:107], v124 offset:22784
    v_mfma_f32_16x16x32_bf16 v[188:191], v[116:119], v[24:27], v[188:191]
    ds_read_b64_tr_b16 v[108:109], v125 offset:22528
    v_mfma_f32_16x16x32_bf16 v[48:51], v[16:19], v[16:19], v[48:51]
    ds_read_b64_tr_b16 v[110:111], v125 offset:22784
    v_mfma_f32_16x16x32_bf16 v[52:55], v[20:23], v[20:23], v[52:55]
    ds_read_b64_tr_b16 v[112:113], v126 offset:18432
    v_mfma_f32_16x16x32_bf16 v[56:59], v[24:27], v[24:27], v[56:59]
    ds_read_b64_tr_b16 v[114:115], v126 offset:18688
    v_mfma_f32_16x16x32_bf16 v[60:63], v[40:43], v[16:19], v[60:63]
    ds_read_b64_tr_b16 v[116:117], v127 offset:18432
    v_mfma_f32_16x16x32_bf16 v[64:67], v[40:43], v[20:23], v[64:67]
    ds_read_b64_tr_b16 v[118:119], v127 offset:18688
    v_mfma_f32_16x16x32_bf16 v[68:71], v[40:43], v[24:27], v[68:71]
    s_waitcnt vmcnt(3)
    s_barrier
    s_waitcnt lgkmcnt(8)
    v_mfma_f32_16x16x32_bf16 v[136:139], v[88:91], v[28:31], v[136:139]
    ds_read_b128 v[16:19], v128 offset:0
    v_mfma_f32_16x16x32_bf16 v[160:163], v[88:91], v[32:35], v[160:163]
    ds_read_b128 v[20:23], v128 offset:2048
    v_mfma_f32_16x16x32_bf16 v[140:143], v[92:95], v[28:31], v[140:143]
    ds_read_b128 v[24:27], v130 offset:0
    v_mfma_f32_16x16x32_bf16 v[164:167], v[92:95], v[32:35], v[164:167]
    ds_read_b64_tr_b16 v[88:89], v124 offset:24576
    v_mfma_f32_16x16x32_bf16 v[144:147], v[96:99], v[28:31], v[144:147]
    ds_read_b64_tr_b16 v[90:91], v124 offset:24832
    v_mfma_f32_16x16x32_bf16 v[168:171], v[96:99], v[32:35], v[168:171]
    ds_read_b64_tr_b16 v[92:93], v125 offset:24576
    v_mfma_f32_16x16x32_bf16 v[148:151], v[100:103], v[28:31], v[148:151]
    ds_read_b64_tr_b16 v[94:95], v125 offset:24832
    v_mfma_f32_16x16x32_bf16 v[172:175], v[100:103], v[32:35], v[172:175]
    ds_read_b64_tr_b16 v[96:97], v124 offset:26624
    s_waitcnt lgkmcnt(8)
    v_mfma_f32_16x16x32_bf16 v[152:155], v[28:31], v[104:107], v[152:155]
    ds_read_b64_tr_b16 v[98:99], v124 offset:26880
    v_mfma_f32_16x16x32_bf16 v[176:179], v[32:35], v[104:107], v[176:179]
    ds_read_b64_tr_b16 v[100:101], v125 offset:26624
    v_mfma_f32_16x16x32_bf16 v[156:159], v[28:31], v[108:111], v[156:159]
    ds_read_b64_tr_b16 v[102:103], v125 offset:26880
    v_mfma_f32_16x16x32_bf16 v[180:183], v[32:35], v[108:111], v[180:183]
    ds_read_b64_tr_b16 v[104:105], v124 offset:28672
    v_mfma_f32_16x16x32_bf16 v[184:187], v[112:115], v[36:39], v[184:187]
    ds_read_b64_tr_b16 v[106:107], v124 offset:28928
    v_mfma_f32_16x16x32_bf16 v[188:191], v[116:119], v[36:39], v[188:191]
    ds_read_b64_tr_b16 v[108:109], v125 offset:28672
    v_mfma_f32_16x16x32_bf16 v[48:51], v[28:31], v[28:31], v[48:51]
    ds_read_b64_tr_b16 v[110:111], v125 offset:28928
    v_mfma_f32_16x16x32_bf16 v[52:55], v[32:35], v[32:35], v[52:55]
    ds_read_b64_tr_b16 v[112:113], v126 offset:24576
    v_mfma_f32_16x16x32_bf16 v[56:59], v[36:39], v[36:39], v[56:59]
    ds_read_b64_tr_b16 v[114:115], v126 offset:24832
    v_mfma_f32_16x16x32_bf16 v[60:63], v[40:43], v[28:31], v[60:63]
    ds_read_b64_tr_b16 v[116:117], v127 offset:24576
    v_mfma_f32_16x16x32_bf16 v[64:67], v[40:43], v[32:35], v[64:67]
    ds_read_b64_tr_b16 v[118:119], v127 offset:24832
    v_mfma_f32_16x16x32_bf16 v[68:71], v[40:43], v[36:39], v[68:71]
    s_waitcnt lgkmcnt(8)
    v_mfma_f32_16x16x32_bf16 v[136:139], v[88:91], v[16:19], v[136:139]
    ds_read_b128 v[28:31], v129 offset:0
    v_mfma_f32_16x16x32_bf16 v[160:163], v[88:91], v[20:23], v[160:163]
    ds_read_b128 v[32:35], v129 offset:2048
    v_mfma_f32_16x16x32_bf16 v[140:143], v[92:95], v[16:19], v[140:143]
    ds_read_b128 v[36:39], v131 offset:0
    v_mfma_f32_16x16x32_bf16 v[164:167], v[92:95], v[20:23], v[164:167]
    ds_read_b64_tr_b16 v[88:89], v124 offset:30720
    v_mfma_f32_16x16x32_bf16 v[144:147], v[96:99], v[16:19], v[144:147]
    ds_read_b64_tr_b16 v[90:91], v124 offset:30976
    v_mfma_f32_16x16x32_bf16 v[168:171], v[96:99], v[20:23], v[168:171]
    ds_read_b64_tr_b16 v[92:93], v125 offset:30720
    v_mfma_f32_16x16x32_bf16 v[148:151], v[100:103], v[16:19], v[148:151]
    ds_read_b64_tr_b16 v[94:95], v125 offset:30976
    v_mfma_f32_16x16x32_bf16 v[172:175], v[100:103], v[20:23], v[172:175]
    ds_read_b64_tr_b16 v[96:97], v124 offset:32768
    s_waitcnt lgkmcnt(8)
    v_mfma_f32_16x16x32_bf16 v[152:155], v[16:19], v[104:107], v[152:155]
    ds_read_b64_tr_b16 v[98:99], v124 offset:33024
    v_mfma_f32_16x16x32_bf16 v[176:179], v[20:23], v[104:107], v[176:179]
    ds_read_b64_tr_b16 v[100:101], v125 offset:32768
    v_mfma_f32_16x16x32_bf16 v[156:159], v[16:19], v[108:111], v[156:159]
    ds_read_b64_tr_b16 v[102:103], v125 offset:33024
    v_mfma_f32_16x16x32_bf16 v[180:183], v[20:23], v[108:111], v[180:183]
    ds_read_b64_tr_b16 v[104:105], v124 offset:34816
    v_mfma_f32_16x16x32_bf16 v[184:187], v[112:115], v[24:27], v[184:187]
    ds_read_b64_tr_b16 v[106:107], v124 offset:35072
    v_mfma_f32_16x16x32_bf16 v[188:191], v[116:119], v[24:27], v[188:191]
    ds_read_b64_tr_b16 v[108:109], v125 offset:34816
    v_mfma_f32_16x16x32_bf16 v[48:51], v[16:19], v[16:19], v[48:51]
    ds_read_b64_tr_b16 v[110:111], v125 offset:35072
    v_mfma_f32_16x16x32_bf16 v[52:55], v[20:23], v[20:23], v[52:55]
    ds_read_b64_tr_b16 v[112:113], v126 offset:30720
    v_mfma_f32_16x16x32_bf16 v[56:59], v[24:27], v[24:27], v[56:59]
    ds_read_b64_tr_b16 v[114:115], v126 offset:30976
    v_mfma_f32_16x16x32_bf16 v[60:63], v[40:43], v[16:19], v[60:63]
    ds_read_b64_tr_b16 v[116:117], v127 offset:30720
    v_mfma_f32_16x16x32_bf16 v[64:67], v[40:43], v[20:23], v[64:67]
    ds_read_b64_tr_b16 v[118:119], v127 offset:30976
    v_mfma_f32_16x16x32_bf16 v[68:71], v[40:43], v[24:27], v[68:71]
    s_waitcnt lgkmcnt(9)
    v_mfma_f32_16x16x32_bf16 v[48:51], v[28:31], v[28:31], v[48:51]
    v_mfma_f32_16x16x32_bf16 v[52:55], v[32:35], v[32:35], v[52:55]
    v_mfma_f32_16x16x32_bf16 v[56:59], v[36:39], v[36:39], v[56:59]
    v_mfma_f32_16x16x32_bf16 v[60:63], v[40:43], v[28:31], v[60:63]
    v_mfma_f32_16x16x32_bf16 v[64:67], v[40:43], v[32:35], v[64:67]
    v_mfma_f32_16x16x32_bf16 v[68:71], v[40:43], v[36:39], v[68:71]
    s_waitcnt lgkmcnt(2)
    v_mfma_f32_16x16x32_bf16 v[184:187], v[112:115], v[36:39], v[184:187]
    s_waitcnt lgkmcnt(0)
    v_mfma_f32_16x16x32_bf16 v[188:191], v[116:119], v[36:39], v[188:191]
    v_mfma_f32_16x16x32_bf16 v[144:147], v[96:99], v[28:31], v[144:147]
    v_cndmask_b32 v48, v48, v49, s[88:89]
    v_cndmask_b32 v52, v52, v53, s[88:89]
    v_cndmask_b32 v56, v56, v57, s[88:89]
    v_mfma_f32_16x16x32_bf16 v[168:171], v[96:99], v[32:35], v[168:171]
    v_cndmask_b32 v48, v48, v50, s[90:91]
    v_cndmask_b32 v52, v52, v54, s[90:91]
    v_cndmask_b32 v56, v56, v58, s[90:91]
    v_mfma_f32_16x16x32_bf16 v[148:151], v[100:103], v[28:31], v[148:151]
    v_cndmask_b32 v48, v48, v51, s[92:93]
    v_cndmask_b32 v52, v52, v55, s[92:93]
    v_cndmask_b32 v56, v56, v59, s[92:93]
    v_mfma_f32_16x16x32_bf16 v[172:175], v[100:103], v[32:35], v[172:175]
    v_mul_f32 v133, 0x3b124925, v60
    v_mul_f32 v135, 0x3b124925, v64
    v_mul_f32 v85, 0x3b124925, v68
    v_mfma_f32_16x16x32_bf16 v[152:155], v[28:31], v[104:107], v[152:155]
    v_mul_f32 v132, v133, v133
    v_mul_f32 v134, v135, v135
    v_mul_f32 v84, v85, v85
    v_mfma_f32_16x16x32_bf16 v[176:179], v[32:35], v[104:107], v[176:179]
    v_mul_f32 v48, 0x3b124925, v48
    v_mul_f32 v52, 0x3b124925, v52
    v_mul_f32 v56, 0x3b124925, v56
    v_mfma_f32_16x16x32_bf16 v[156:159], v[28:31], v[108:111], v[156:159]
    s_mov_b32 exec_lo, 0x00010001
    s_mov_b32 exec_hi, 0x00010001
    ds_write_b128 v73, v[184:187] offset:128
    ds_write_b128 v74, v[188:191] offset:0
    s_mov_b64 exec, -1
    v_sub_f32 v132, v48, v132
    v_sub_f32 v134, v52, v134
    v_mfma_f32_16x16x32_bf16 v[180:183], v[32:35], v[108:111], v[180:183]
    v_sub_f32 v84, v56, v84
    v_max_f32 v132, 0, v132
    v_max_f32 v134, 0, v134
    v_mfma_f32_16x16x32_bf16 v[136:139], v[88:91], v[28:31], v[136:139]
    v_max_f32 v84, 0, v84
    v_add_f32 v132, 0x3727c5ac, v132
    v_add_f32 v134, 0x3727c5ac, v134
    v_mfma_f32_16x16x32_bf16 v[160:163], v[88:91], v[32:35], v[160:163]
    v_add_f32 v84, 0x3727c5ac, v84
    v_rsq_f32 v132, v132
    v_rsq_f32 v134, v134
    v_mfma_f32_16x16x32_bf16 v[140:143], v[92:95], v[28:31], v[140:143]
    v_rsq_f32 v84, v84
    s_mov_b32 exec_lo, 0x00f0000f
    s_mov_b32 exec_hi, 0xf0000f00
    ds_write2_b32 v75, v132, v133 offset0:128 offset1:144
    ds_write2_b32 v75, v134, v135 offset0:160 offset1:176
    ds_write2_b32 v75, v84, v85 offset0:192 offset1:208
    s_mov_b64 exec, -1
    v_mov_b32_dpp v224, v184 row_newbcast:0 row_mask:0xf bank_mask:0xf
    v_mfma_f32_16x16x32_bf16 v[164:167], v[92:95], v[32:35], v[164:167]
    v_mov_b32_dpp v225, v185 row_newbcast:0 row_mask:0xf bank_mask:0xf
    v_mov_b32_dpp v226, v186 row_newbcast:0 row_mask:0xf bank_mask:0xf
    v_mov_b32_dpp v227, v187 row_newbcast:0 row_mask:0xf bank_mask:0xf
    v_fma_f32 v224, -v224, v85, v184
    v_fma_f32 v225, -v225, v85, v185
    v_fma_f32 v226, -v226, v85, v186
    v_fma_f32 v227, -v227, v85, v187
    s_cmp_eq_u32 s49, 15
    s_cselect_b32 s88, 0xffff0000, -1
    s_mov_b32 s89, -1
    s_mov_b32 s90, -1
    s_cselect_b32 s91, -1, 0xffff
    s_waitcnt lgkmcnt(0)
    s_barrier
    ds_read_b32 v134, v75 offset:640
    ds_read_b32 v84, v75 offset:768
    ds_read_b32 v132, v75 offset:512
    ds_read_b128 v[56:59], v72 offset:128
    ds_read_b128 v[60:63], v72 offset:192
    ds_read_b32 v64, v77 offset:256
    ds_read_b32 v65, v77 offset:320
    ds_read_b128 v[44:47], v76 offset:704
    ds_read_b128 v[40:43], v76 offset:640
    ds_read_b128 v[36:39], v76 offset:576
    ds_read_b128 v[32:35], v76 offset:512
    ds_read_b128 v[48:51], v72 offset:0
    ds_read_b128 v[52:55], v72 offset:64
    s_waitcnt lgkmcnt(9)
    v_pk_fma_f32 v[168:169], v[56:57], v[134:135], v[168:169] op_sel:[0,1,0] op_sel_hi:[1,1,1] neg_lo:[0,1,0] neg_hi:[0,1,0]
    v_pk_fma_f32 v[170:171], v[58:59], v[134:135], v[170:171] op_sel:[0,1,0] op_sel_hi:[1,1,1] neg_lo:[0,1,0] neg_hi:[0,1,0]
    v_pk_mul_f32 v[168:169], v[168:169], v[134:135] op_sel:[0,0] op_sel_hi:[1,0]
    v_pk_mul_f32 v[170:171], v[170:171], v[134:135] op_sel:[0,0] op_sel_hi:[1,0]
    v_cvt_pk_bf16_f32 v104, v168, v169
    v_cvt_pk_bf16_f32 v105, v170, v171
    s_waitcnt lgkmcnt(8)
    v_pk_fma_f32 v[172:173], v[60:61], v[134:135], v[172:173] op_sel:[0,1,0] op_sel_hi:[1,1,1] neg_lo:[0,1,0] neg_hi:[0,1,0]
    v_pk_fma_f32 v[174:175], v[62:63], v[134:135], v[174:175] op_sel:[0,1,0] op_sel_hi:[1,1,1] neg_lo:[0,1,0] neg_hi:[0,1,0]
    v_pk_mul_f32 v[172:173], v[172:173], v[134:135] op_sel:[0,0] op_sel_hi:[1,0]
    v_pk_mul_f32 v[174:175], v[174:175], v[134:135] op_sel:[0,0] op_sel_hi:[1,0]
    v_cvt_pk_bf16_f32 v106, v172, v173
    v_cvt_pk_bf16_f32 v107, v174, v175
    ds_write_b128 v78, v[104:107] offset:4096
    v_pk_mul_f32 v[224:225], v[224:225], v[84:85] op_sel_hi:[1,0]
    v_pk_mul_f32 v[226:227], v[226:227], v[84:85] op_sel_hi:[1,0]
    v_cvt_pk_bf16_f32 v224, v224, v225
    v_cvt_pk_bf16_f32 v226, v226, v227
    ds_write_b16 v80, v224 offset:2048
    ds_write_b16_d16_hi v81, v224 offset:2048
    ds_write_b16 v82, v226 offset:2048
    ds_write_b16_d16_hi v83, v226 offset:2048
    s_waitcnt lgkmcnt(10)
    v_pk_fma_f32 v[176:177], v[44:45], v[64:65], v[176:177] op_sel:[0,0,0] op_sel_hi:[1,0,1] neg_lo:[0,1,0] neg_hi:[0,1,0]
    v_pk_fma_f32 v[178:179], v[46:47], v[64:65], v[178:179] op_sel:[0,0,0] op_sel_hi:[1,0,1] neg_lo:[0,1,0] neg_hi:[0,1,0]
    s_waitcnt lgkmcnt(9)
    v_pk_mul_f32 v[176:177], v[176:177], v[40:41]
    v_pk_mul_f32 v[178:179], v[178:179], v[42:43]
    v_cvt_pk_bf16_f32 v112, v176, v177
    v_cvt_pk_bf16_f32 v113, v178, v179
    v_pk_fma_f32 v[180:181], v[44:45], v[64:65], v[180:181] op_sel:[0,1,0] op_sel_hi:[1,1,1] neg_lo:[0,1,0] neg_hi:[0,1,0]
    v_pk_fma_f32 v[182:183], v[46:47], v[64:65], v[182:183] op_sel:[0,1,0] op_sel_hi:[1,1,1] neg_lo:[0,1,0] neg_hi:[0,1,0]
    v_pk_mul_f32 v[180:181], v[180:181], v[40:41]
    v_pk_mul_f32 v[182:183], v[182:183], v[42:43]
    v_cvt_pk_bf16_f32 v118, v180, v181
    v_cvt_pk_bf16_f32 v119, v182, v183
    ds_write_b64 v78, v[112:113] offset:5120
    ds_write_b64 v78, v[118:119] offset:5128
    v_mul_f32 v68, 0x3e8b97f6, v132
    v_mul_f32 v70, 0x3e8b97f6, v134
    v_cndmask_b32 v69, 0, v68, s[90:91]
    v_cndmask_b32 v68, 0, v68, s[88:89]
    v_cndmask_b32 v71, 0, v70, s[90:91]
    v_cndmask_b32 v70, 0, v70, s[88:89]
    v_pk_fma_f32 v[144:145], v[56:57], v[132:133], v[144:145] op_sel:[0,1,0] op_sel_hi:[1,1,1] neg_lo:[0,1,0] neg_hi:[0,1,0]
    v_pk_fma_f32 v[146:147], v[58:59], v[132:133], v[146:147] op_sel:[0,1,0] op_sel_hi:[1,1,1] neg_lo:[0,1,0] neg_hi:[0,1,0]
    v_pk_mul_f32 v[144:145], v[144:145], v[132:133] op_sel:[0,0] op_sel_hi:[1,0]
    v_pk_mul_f32 v[146:147], v[146:147], v[132:133] op_sel:[0,0] op_sel_hi:[1,0]
    v_cvt_pk_bf16_f32 v100, v144, v145
    v_cvt_pk_bf16_f32 v101, v146, v147
    v_pk_fma_f32 v[148:149], v[60:61], v[132:133], v[148:149] op_sel:[0,1,0] op_sel_hi:[1,1,1] neg_lo:[0,1,0] neg_hi:[0,1,0]
    v_pk_fma_f32 v[150:151], v[62:63], v[132:133], v[150:151] op_sel:[0,1,0] op_sel_hi:[1,1,1] neg_lo:[0,1,0] neg_hi:[0,1,0]
    v_pk_mul_f32 v[148:149], v[148:149], v[132:133] op_sel:[0,0] op_sel_hi:[1,0]
    v_pk_mul_f32 v[150:151], v[150:151], v[132:133] op_sel:[0,0] op_sel_hi:[1,0]
    v_cvt_pk_bf16_f32 v102, v148, v149
    v_cvt_pk_bf16_f32 v103, v150, v151
    s_waitcnt lgkmcnt(0)
    s_barrier
    ds_read_b128 v[96:99], v78 offset:2048
    ds_read_b64 v[108:109], v78 offset:3072
    ds_read_b64 v[114:115], v78 offset:3080
    v_pk_fma_f32 v[160:161], v[48:49], v[134:135], v[160:161] op_sel:[0,1,0] op_sel_hi:[1,1,1] neg_lo:[0,1,0] neg_hi:[0,1,0]
    v_pk_fma_f32 v[162:163], v[50:51], v[134:135], v[162:163] op_sel:[0,1,0] op_sel_hi:[1,1,1] neg_lo:[0,1,0] neg_hi:[0,1,0]
    v_pk_mul_f32 v[160:161], v[160:161], v[70:71] op_sel:[0,0] op_sel_hi:[1,0]
    v_pk_mul_f32 v[162:163], v[162:163], v[70:71] op_sel:[0,0] op_sel_hi:[1,0]
    v_cvt_pk_bf16_f32 v92, v160, v161
    v_cvt_pk_bf16_f32 v93, v162, v163
    v_pk_fma_f32 v[164:165], v[52:53], v[134:135], v[164:165] op_sel:[0,1,0] op_sel_hi:[1,1,1] neg_lo:[0,1,0] neg_hi:[0,1,0]
    v_pk_fma_f32 v[166:167], v[54:55], v[134:135], v[166:167] op_sel:[0,1,0] op_sel_hi:[1,1,1] neg_lo:[0,1,0] neg_hi:[0,1,0]
    v_pk_mul_f32 v[164:165], v[164:165], v[70:71] op_sel:[0,1] op_sel_hi:[1,1]
    v_pk_mul_f32 v[166:167], v[166:167], v[70:71] op_sel:[0,1] op_sel_hi:[1,1]
    v_cvt_pk_bf16_f32 v94, v164, v165
    v_cvt_pk_bf16_f32 v95, v166, v167
    s_nop 1
    v_mfma_f32_16x16x32_bf16 v[24:27], v[100:103], v[92:95], v[240:243]
    v_mfma_f32_16x16x32_bf16 v[28:31], v[104:107], v[92:95], v[244:247]
    v_pk_fma_f32 v[136:137], v[48:49], v[132:133], v[136:137] op_sel:[0,1,0] op_sel_hi:[1,1,1] neg_lo:[0,1,0] neg_hi:[0,1,0]
    v_pk_fma_f32 v[138:139], v[50:51], v[132:133], v[138:139] op_sel:[0,1,0] op_sel_hi:[1,1,1] neg_lo:[0,1,0] neg_hi:[0,1,0]
    v_pk_mul_f32 v[136:137], v[136:137], v[68:69] op_sel:[0,0] op_sel_hi:[1,0]
    v_pk_mul_f32 v[138:139], v[138:139], v[68:69] op_sel:[0,0] op_sel_hi:[1,0]
    v_cvt_pk_bf16_f32 v88, v136, v137
    v_cvt_pk_bf16_f32 v89, v138, v139
    v_pk_fma_f32 v[140:141], v[52:53], v[132:133], v[140:141] op_sel:[0,1,0] op_sel_hi:[1,1,1] neg_lo:[0,1,0] neg_hi:[0,1,0]
    v_pk_fma_f32 v[142:143], v[54:55], v[132:133], v[142:143] op_sel:[0,1,0] op_sel_hi:[1,1,1] neg_lo:[0,1,0] neg_hi:[0,1,0]
    v_pk_mul_f32 v[140:141], v[140:141], v[68:69] op_sel:[0,1] op_sel_hi:[1,1]
    v_pk_mul_f32 v[142:143], v[142:143], v[68:69] op_sel:[0,1] op_sel_hi:[1,1]
    v_cvt_pk_bf16_f32 v90, v140, v141
    v_cvt_pk_bf16_f32 v91, v142, v143
    s_waitcnt lgkmcnt(2)
    s_nop 0
    v_mfma_f32_16x16x32_bf16 v[16:19], v[96:99], v[88:91], v[248:251]
    v_mfma_f32_16x16x32_bf16 v[20:23], v[100:103], v[88:91], v[244:247]
    v_pk_fma_f32 v[152:153], v[36:37], v[64:65], v[152:153] op_sel:[0,0,0] op_sel_hi:[1,0,1] neg_lo:[0,1,0] neg_hi:[0,1,0]
    v_pk_fma_f32 v[154:155], v[38:39], v[64:65], v[154:155] op_sel:[0,0,0] op_sel_hi:[1,0,1] neg_lo:[0,1,0] neg_hi:[0,1,0]
    v_pk_mul_f32 v[152:153], v[152:153], v[32:33]
    v_pk_mul_f32 v[154:155], v[154:155], v[34:35]
    v_cvt_pk_bf16_f32 v110, v152, v153
    v_cvt_pk_bf16_f32 v111, v154, v155
    v_pk_fma_f32 v[156:157], v[36:37], v[64:65], v[156:157] op_sel:[0,1,0] op_sel_hi:[1,1,1] neg_lo:[0,1,0] neg_hi:[0,1,0]
    v_pk_fma_f32 v[158:159], v[38:39], v[64:65], v[158:159] op_sel:[0,1,0] op_sel_hi:[1,1,1] neg_lo:[0,1,0] neg_hi:[0,1,0]
    v_pk_mul_f32 v[156:157], v[156:157], v[32:33]
    v_pk_mul_f32 v[158:159], v[158:159], v[34:35]
    v_cvt_pk_bf16_f32 v116, v156, v157
    v_cvt_pk_bf16_f32 v117, v158, v159
    v_max3_f32 v137, v24, v25, v26
    v_max3_f32 v139, v27, v28, v29
    v_max3_f32 v137, v137, v30, v31
    v_max_f32 v137, v137, v139
    v_max3_f32 v136, v16, v17, v18
    v_max3_f32 v138, v19, v20, v21
    v_max3_f32 v136, v136, v22, v23
    v_max_f32 v136, v136, v138
    v_mov_b32 v138, v136
    v_mov_b32 v139, v137
    s_nop 0
    v_permlane32_swap_b32 v136, v138
    v_permlane32_swap_b32 v137, v139
    v_max_f32 v136, v136, v138
    v_max_f32 v137, v137, v139
    v_mov_b32 v138, v136
    v_mov_b32 v139, v137
    s_nop 0
    v_permlane16_swap_b32 v136, v138
    v_permlane16_swap_b32 v137, v139
    v_max_f32 v136, v136, v138
    v_max_f32 v137, v137, v139
    v_pk_add_f32 v[24:25], v[24:25], v[136:137] op_sel:[0,1] op_sel_hi:[1,1] neg_lo:[0,1] neg_hi:[0,1]
    v_pk_add_f32 v[26:27], v[26:27], v[136:137] op_sel:[0,1] op_sel_hi:[1,1] neg_lo:[0,1] neg_hi:[0,1]
    v_pk_add_f32 v[28:29], v[28:29], v[136:137] op_sel:[0,1] op_sel_hi:[1,1] neg_lo:[0,1] neg_hi:[0,1]
    v_pk_add_f32 v[30:31], v[30:31], v[136:137] op_sel:[0,1] op_sel_hi:[1,1] neg_lo:[0,1] neg_hi:[0,1]
    v_exp_f32 v24, v24
    v_exp_f32 v25, v25
    v_exp_f32 v26, v26
    v_exp_f32 v27, v27
    v_exp_f32 v28, v28
    v_exp_f32 v29, v29
    v_exp_f32 v30, v30
    v_exp_f32 v31, v31
    v_cvt_pk_bf16_f32 v148, v24, v25
    v_cvt_pk_bf16_f32 v149, v26, v27
    v_cvt_pk_bf16_f32 v150, v28, v29
    v_cvt_pk_bf16_f32 v151, v30, v31
    s_nop 1
    v_mfma_f32_16x16x32_bf16 v[160:163], v[110:113], v[148:151], 0
    v_mfma_f32_16x16x32_bf16 v[164:167], v[116:119], v[148:151], 0
    v_pk_add_f32 v[16:17], v[16:17], v[136:137] op_sel:[0,0] op_sel_hi:[1,0] neg_lo:[0,1] neg_hi:[0,1]
    v_pk_add_f32 v[18:19], v[18:19], v[136:137] op_sel:[0,0] op_sel_hi:[1,0] neg_lo:[0,1] neg_hi:[0,1]
    v_pk_add_f32 v[20:21], v[20:21], v[136:137] op_sel:[0,0] op_sel_hi:[1,0] neg_lo:[0,1] neg_hi:[0,1]
    v_pk_add_f32 v[22:23], v[22:23], v[136:137] op_sel:[0,0] op_sel_hi:[1,0] neg_lo:[0,1] neg_hi:[0,1]
    v_exp_f32 v16, v16
    v_exp_f32 v17, v17
    v_exp_f32 v18, v18
    v_exp_f32 v19, v19
    v_exp_f32 v20, v20
    v_exp_f32 v21, v21
    v_exp_f32 v22, v22
    v_exp_f32 v23, v23
    v_cvt_pk_bf16_f32 v144, v16, v17
    v_cvt_pk_bf16_f32 v145, v18, v19
    v_cvt_pk_bf16_f32 v146, v20, v21
    v_cvt_pk_bf16_f32 v147, v22, v23
    s_waitcnt lgkmcnt(1)
    s_nop 0
    v_mfma_f32_16x16x32_bf16 v[152:155], v[108:111], v[144:147], 0
    s_waitcnt lgkmcnt(0)
    v_mfma_f32_16x16x32_bf16 v[156:159], v[114:117], v[144:147], 0
    v_pk_add_f32 v[16:17], v[16:17], v[18:19]
    v_pk_add_f32 v[20:21], v[20:21], v[22:23]
    v_pk_add_f32 v[24:25], v[24:25], v[26:27]
    v_pk_add_f32 v[28:29], v[28:29], v[30:31]
    v_pk_add_f32 v[16:17], v[16:17], v[20:21]
    v_pk_add_f32 v[24:25], v[24:25], v[28:29]
    v_add_f32 v140, v16, v17
    v_add_f32 v142, v24, v25
    v_mov_b32 v138, v140
    v_mov_b32 v139, v142
    s_nop 0
    v_permlane32_swap_b32 v140, v138
    v_permlane32_swap_b32 v142, v139
    v_add_f32 v140, v140, v138
    v_add_f32 v142, v142, v139
    v_mov_b32 v138, v140
    v_mov_b32 v139, v142
    s_nop 0
    v_permlane16_swap_b32 v140, v138
    v_permlane16_swap_b32 v142, v139
    v_add_f32 v140, v140, v138
    v_add_f32 v142, v142, v139
    v_rcp_f32 v140, v140
    v_rcp_f32 v142, v142
    v_cndmask_b32 v141, 0, v140, s[90:91]
    v_cndmask_b32 v140, 0, v140, s[88:89]
    v_cndmask_b32 v143, 0, v142, s[90:91]
    v_cndmask_b32 v142, 0, v142, s[88:89]
    v_pk_mul_f32 v[152:153], v[152:153], v[140:141] op_sel_hi:[1,0]
    v_pk_mul_f32 v[154:155], v[154:155], v[140:141] op_sel_hi:[1,0]
    v_pk_mul_f32 v[156:157], v[156:157], v[140:141] op_sel:[0,1] op_sel_hi:[1,1]
    v_pk_mul_f32 v[158:159], v[158:159], v[140:141] op_sel:[0,1] op_sel_hi:[1,1]
    v_cvt_pk_bf16_f32 v144, v152, v153
    v_cvt_pk_bf16_f32 v145, v154, v155
    v_cvt_pk_bf16_f32 v146, v156, v157
    v_cvt_pk_bf16_f32 v147, v158, v159
    buffer_store_dwordx4 v[144:147], v4, s[40:43], s62 offen sc1
    v_pk_mul_f32 v[160:161], v[160:161], v[142:143] op_sel_hi:[1,0]
    v_pk_mul_f32 v[162:163], v[162:163], v[142:143] op_sel_hi:[1,0]
    v_pk_mul_f32 v[164:165], v[164:165], v[142:143] op_sel:[0,1] op_sel_hi:[1,1]
    v_pk_mul_f32 v[166:167], v[166:167], v[142:143] op_sel:[0,1] op_sel_hi:[1,1]
    v_cvt_pk_bf16_f32 v148, v160, v161
    v_cvt_pk_bf16_f32 v149, v162, v163
    v_cvt_pk_bf16_f32 v150, v164, v165
    v_cvt_pk_bf16_f32 v151, v166, v167
    buffer_store_dwordx4 v[148:151], v4, s[40:43], s63 offen sc1
    s_add_u32 m0, s59, 0
    s_mov_b32 s73, 0
    buffer_load_dwordx4 v208, s[16:19], s73 offen lds
    s_add_u32 m0, s59, 1024
    s_mov_b32 s73, 7168
    buffer_load_dwordx4 v208, s[16:19], s73 offen lds
    s_add_u32 m0, s59, 2048
    s_mov_b32 s73, 14336
    buffer_load_dwordx4 v208, s[16:19], s73 offen lds
    s_add_u32 m0, s59, 3072
    s_mov_b32 s73, 21504
    buffer_load_dwordx4 v208, s[16:19], s73 offen lds
    s_add_u32 m0, s59, 4096
    s_mov_b32 s73, 28672
    buffer_load_dwordx4 v208, s[16:19], s73 offen lds
    s_add_u32 m0, s59, 5120
    s_mov_b32 s73, 35840
    buffer_load_dwordx4 v208, s[16:19], s73 offen lds
    s_add_u32 m0, s59, 6144
    s_mov_b32 s73, 43008
    buffer_load_dwordx4 v208, s[16:19], s73 offen lds
    s_add_u32 m0, s59, 7168
    s_mov_b32 s73, 50176
    buffer_load_dwordx4 v208, s[16:19], s73 offen lds
    s_add_u32 m0, s59, 8192
    s_mov_b32 s73, 57344
    buffer_load_dwordx4 v208, s[16:19], s73 offen lds
    s_add_u32 m0, s59, 9216
    s_mov_b32 s73, 64512
    buffer_load_dwordx4 v208, s[16:19], s73 offen lds
    s_add_u32 m0, s59, 10240
    s_mov_b32 s73, 71680
    buffer_load_dwordx4 v208, s[16:19], s73 offen lds
    s_add_u32 m0, s59, 11264
    s_mov_b32 s73, 78848
    buffer_load_dwordx4 v208, s[16:19], s73 offen lds
    s_add_u32 m0, s59, 12288
    s_mov_b32 s73, 86016
    buffer_load_dwordx4 v208, s[16:19], s73 offen lds
    s_add_u32 m0, s59, 13312
    s_mov_b32 s73, 93184
    buffer_load_dwordx4 v208, s[16:19], s73 offen lds
    s_waitcnt vmcnt(18)
    v_readfirstlane_b32 s4, v6
    s_nop 1
    s_cmp_lg_u32 s4, 0
    s_cbranch_scc1 Lepd_P_2
    s_nop 0
Lepg_P_1:
    s_sub_u32 s6, s6, 1
    s_cbranch_scc1 L_end_P
    buffer_load_dword v6, v7, s[44:47], 0 offen sc1
    s_waitcnt vmcnt(0)
    v_readfirstlane_b32 s4, v6
    s_nop 1
    s_cmp_eq_u32 s4, 0
    s_cbranch_scc1 Lepg_P_1
Lepd_P_2:
    s_waitcnt vmcnt(14)
    v_mov_b32 v8, s4
    s_mov_b64 exec, 1
    buffer_store_dword v8, v9, s[40:43], s80 offen sc1
    s_mov_b64 exec, -1
    s_cmp_lt_u32 s67, 99
    s_cbranch_scc1 Lnotag_P_3
    s_lshr_b32 s68, s2, 3
    s_sub_u32 s68, s68, 28
    s_lshl_b32 s68, s68, 2
    s_add_u32 s68, s68, s3
    s_lshl_b32 s68, s68, 16
    s_and_b32 s69, s2, 7
    s_lshl_b32 s69, s69, 9
    s_add_u32 s68, s68, s69
    v_lshrrev_b32 v16, 2, v1
    v_lshlrev_b32 v16, 12, v16
    v_and_b32 v17, 3, v1
    v_lshl_add_u32 v16, v17, 7, v16
    buffer_load_dword v18, v16, s[24:27], s68 offen
    s_add_u32 s68, s68, 0x100000
    s_waitcnt vmcnt(3)
    buffer_load_dword v19, v16, s[24:27], s68 offen
    s_add_u32 s68, s68, 0x100000
    s_waitcnt vmcnt(3)
    buffer_load_dword v20, v16, s[24:27], s68 offen
    s_add_u32 s68, s68, 0x100000
    s_waitcnt vmcnt(3)
    buffer_load_dword v21, v16, s[24:27], s68 offen
    s_add_u32 s68, s68, 0x100000
    s_waitcnt vmcnt(3)
    buffer_load_dword v22, v16, s[24:27], s68 offen
    s_add_u32 s68, s68, 0x100000
    s_waitcnt vmcnt(3)
    buffer_load_dword v23, v16, s[24:27], s68 offen
    s_add_u32 s68, s68, 0x100000
    s_waitcnt vmcnt(3)
    buffer_load_dword v24, v16, s[24:27], s68 offen
    s_add_u32 s68, s68, 0x100000
    s_waitcnt vmcnt(3)
    s_waitcnt vmcnt(0)
    s_branch L_end_P
Lnotag_P_3:
    v_lshrrev_b32 v221, 5, v1
    v_mul_u32_u24 v221, 3584, v221
    v_and_b32 v222, 31, v1
    v_lshl_add_u32 v221, v222, 1, v221
    s_lshl_b32 s58, s67, 1
    s_lshr_b32 s60, s3, 1
    s_add_u32 s58, s58, s60
    s_mul_i32 s58, s58, 28672
    s_lshl_b32 s60, s66, 7
    s_add_u32 s58, s58, s60
    s_and_b32 s60, s3, 1
    s_lshl_b32 s60, s60, 6
    s_add_u32 s58, s58, s60
    buffer_load_ushort v192, v221, s[8:11], s58 offen offset:0
    buffer_load_ushort v193, v221, s[8:11], s58 offen offset:896
    buffer_load_ushort v194, v221, s[8:11], s58 offen offset:1792
    buffer_load_ushort v195, v221, s[8:11], s58 offen offset:2688
    s_add_u32 s58, s58, 7168
    buffer_load_ushort v196, v221, s[8:11], s58 offen offset:0
    buffer_load_ushort v197, v221, s[8:11], s58 offen offset:896
    buffer_load_ushort v198, v221, s[8:11], s58 offen offset:1792
    buffer_load_ushort v199, v221, s[8:11], s58 offen offset:2688
    s_add_u32 s58, s58, 7168
    buffer_load_ushort v200, v221, s[8:11], s58 offen offset:0
    buffer_load_ushort v201, v221, s[8:11], s58 offen offset:896
    buffer_load_ushort v202, v221, s[8:11], s58 offen offset:1792
    buffer_load_ushort v203, v221, s[8:11], s58 offen offset:2688
    s_add_u32 s58, s58, 7168
    buffer_load_ushort v204, v221, s[8:11], s58 offen offset:0
    buffer_load_ushort v205, v221, s[8:11], s58 offen offset:896
    buffer_load_ushort v206, v221, s[8:11], s58 offen offset:1792
    buffer_load_ushort v207, v221, s[8:11], s58 offen offset:2688
    s_and_b32 s68, s2, 7
    s_cmp_ge_u32 s68, 7
    s_cselect_b32 s48, 7, 0
    s_sub_u32 s68, s68, s48
    s_lshl_b32 s48, s68, 12
    s_add_u32 s68, s68, 1
    s_cmp_ge_u32 s68, 7
    s_cselect_b32 s49, 7, 0
    s_sub_u32 s68, s68, s49
    s_lshl_b32 s49, s68, 12
    s_add_u32 s68, s68, 1
    s_cmp_ge_u32 s68, 7
    s_cselect_b32 s50, 7, 0
    s_sub_u32 s68, s68, s50
    s_lshl_b32 s50, s68, 12
    s_add_u32 s68, s68, 1
    s_cmp_ge_u32 s68, 7
    s_cselect_b32 s51, 7, 0
    s_sub_u32 s68, s68, s51
    s_lshl_b32 s51, s68, 12
    s_add_u32 s68, s68, 1
    s_cmp_ge_u32 s68, 7
    s_cselect_b32 s52, 7, 0
    s_sub_u32 s68, s68, s52
    s_lshl_b32 s52, s68, 12
    s_add_u32 s68, s68, 1
    s_cmp_ge_u32 s68, 7
    s_cselect_b32 s53, 7, 0
    s_sub_u32 s68, s68, s53
    s_lshl_b32 s53, s68, 12
    s_add_u32 s68, s68, 1
    s_cmp_ge_u32 s68, 7
    s_cselect_b32 s54, 7, 0
    s_sub_u32 s68, s68, s54
    s_lshl_b32 s54, s68, 12
    s_waitcnt vmcnt(17)
    s_barrier
    ds_read_b64_tr_b16 a[0:1], v209 offset:0
    ds_read_b64_tr_b16 a[2:3], v209 offset:2048
    ds_read_b64_tr_b16 a[4:5], v209 offset:1024
    ds_read_b64_tr_b16 a[6:7], v209 offset:3072
    ds_read_b64_tr_b16 a[8:9], v209 offset:3584
    ds_read_b64_tr_b16 a[10:11], v209 offset:5632
    ds_read_b64_tr_b16 a[12:13], v209 offset:4608
    ds_read_b64_tr_b16 a[14:15], v209 offset:6656
    ds_read_b64_tr_b16 a[16:17], v209 offset:7168
    ds_read_b64_tr_b16 a[18:19], v209 offset:9216
    ds_read_b64_tr_b16 a[20:21], v209 offset:8192
    ds_read_b64_tr_b16 a[22:23], v209 offset:10240
    ds_read_b64_tr_b16 a[24:25], v209 offset:10752
    ds_read_b64_tr_b16 a[26:27], v209 offset:12800
    ds_read_b64_tr_b16 a[28:29], v209 offset:11776
    ds_read_b64_tr_b16 a[30:31], v209 offset:13824
    ds_read_b64_tr_b16 a[32:33], v209 offset:14336
    ds_read_b64_tr_b16 a[34:35], v209 offset:16384
    ds_read_b64_tr_b16 a[36:37], v209 offset:15360
    ds_read_b64_tr_b16 a[38:39], v209 offset:17408
    ds_read_b64_tr_b16 a[40:41], v209 offset:17920
    ds_read_b64_tr_b16 a[42:43], v209 offset:19968
    ds_read_b64_tr_b16 a[44:45], v209 offset:18944
    ds_read_b64_tr_b16 a[46:47], v209 offset:20992
    ds_read_b64_tr_b16 a[48:49], v209 offset:21504
    ds_read_b64_tr_b16 a[50:51], v209 offset:23552
    ds_read_b64_tr_b16 a[52:53], v209 offset:22528
    ds_read_b64_tr_b16 a[54:55], v209 offset:24576
    ds_read_b64_tr_b16 a[56:57], v209 offset:25088
    ds_read_b64_tr_b16 a[58:59], v209 offset:27136
    ds_read_b64_tr_b16 a[60:61], v209 offset:26112
    ds_read_b64_tr_b16 a[62:63], v209 offset:28160
    ds_read_b64_tr_b16 a[64:65], v209 offset:28672
    ds_read_b64_tr_b16 a[66:67], v209 offset:30720
    ds_read_b64_tr_b16 a[68:69], v209 offset:29696
    ds_read_b64_tr_b16 a[70:71], v209 offset:31744
    ds_read_b64_tr_b16 a[72:73], v209 offset:32256
    ds_read_b64_tr_b16 a[74:75], v209 offset:34304
    ds_read_b64_tr_b16 a[76:77], v209 offset:33280
    ds_read_b64_tr_b16 a[78:79], v209 offset:35328
    ds_read_b64_tr_b16 a[80:81], v209 offset:35840
    ds_read_b64_tr_b16 a[82:83], v209 offset:37888
    ds_read_b64_tr_b16 a[84:85], v209 offset:36864
    ds_read_b64_tr_b16 a[86:87], v209 offset:38912
    ds_read_b64_tr_b16 a[88:89], v209 offset:39424
    ds_read_b64_tr_b16 a[90:91], v209 offset:41472
    ds_read_b64_tr_b16 a[92:93], v209 offset:40448
    ds_read_b64_tr_b16 a[94:95], v209 offset:42496
    ds_read_b64_tr_b16 a[96:97], v209 offset:43008
    ds_read_b64_tr_b16 a[98:99], v209 offset:45056
    ds_read_b64_tr_b16 a[100:101], v209 offset:44032
    ds_read_b64_tr_b16 a[102:103], v209 offset:46080
    ds_read_b64_tr_b16 a[104:105], v209 offset:46592
    ds_read_b64_tr_b16 a[106:107], v209 offset:48640
    ds_read_b64_tr_b16 a[108:109], v209 offset:47616
    ds_read_b64_tr_b16 a[110:111], v209 offset:49664
    ds_read_b64_tr_b16 a[112:113], v209 offset:50176
    ds_read_b64_tr_b16 a[114:115], v209 offset:52224
    ds_read_b64_tr_b16 a[116:117], v209 offset:51200
    ds_read_b64_tr_b16 a[118:119], v209 offset:53248
    ds_read_b64_tr_b16 a[120:121], v209 offset:53248
    ds_read_b64_tr_b16 a[122:123], v209 offset:55296
    ds_read_b64_tr_b16 a[124:125], v209 offset:54272
    ds_read_b64_tr_b16 a[126:127], v209 offset:56320
    s_waitcnt lgkmcnt(0)
    s_barrier
    s_add_u32 m0, s70, 16384
    s_mul_i32 s73, s94, 56
    s_add_u32 s73, s73, 0
    buffer_load_dwordx4 v213, s[20:23], s73 offen lds
    s_add_u32 m0, s70, 17408
    s_mul_i32 s73, s94, 56
    s_add_u32 s73, s73, 28672
    buffer_load_dwordx4 v213, s[20:23], s73 offen lds
    s_add_u32 m0, s70, 18432
    s_mul_i32 s73, s94, 56
    s_add_u32 s73, s73, 57344
    buffer_load_dwordx4 v213, s[20:23], s73 offen lds
    s_add_u32 m0, s70, 19456
    s_mul_i32 s73, s94, 56
    s_add_u32 s73, s73, 86016
    buffer_load_dwordx4 v213, s[20:23], s73 offen lds
    s_add_u32 m0, s70, 20480
    s_mul_i32 s73, s94, 56
    s_add_u32 s73, s73, 114688
    buffer_load_dwordx4 v213, s[20:23], s73 offen lds
    s_add_u32 m0, s70, 21504
    s_mul_i32 s73, s94, 56
    s_add_u32 s73, s73, 143360
    buffer_load_dwordx4 v213, s[20:23], s73 offen lds
    s_add_u32 m0, s70, 22528
    s_mul_i32 s73, s94, 56
    s_add_u32 s73, s73, 172032
    buffer_load_dwordx4 v213, s[20:23], s73 offen lds
    s_add_u32 m0, s70, 23552
    s_mul_i32 s73, s94, 56
    s_add_u32 s73, s73, 200704
    buffer_load_dwordx4 v213, s[20:23], s73 offen lds
    s_add_u32 m0, s70, 24576
    s_mul_i32 s73, s95, 56
    s_add_u32 s73, s73, 0
    buffer_load_dwordx4 v213, s[20:23], s73 offen lds
    s_add_u32 m0, s70, 25600
    s_mul_i32 s73, s95, 56
    s_add_u32 s73, s73, 28672
    buffer_load_dwordx4 v213, s[20:23], s73 offen lds
    s_add_u32 m0, s70, 26624
    s_mul_i32 s73, s95, 56
    s_add_u32 s73, s73, 57344
    buffer_load_dwordx4 v213, s[20:23], s73 offen lds
    s_add_u32 m0, s70, 27648
    s_mul_i32 s73, s95, 56
    s_add_u32 s73, s73, 86016
    buffer_load_dwordx4 v213, s[20:23], s73 offen lds
    s_add_u32 m0, s70, 28672
    s_mul_i32 s73, s95, 56
    s_add_u32 s73, s73, 114688
    buffer_load_dwordx4 v213, s[20:23], s73 offen lds
    s_add_u32 m0, s70, 29696
    s_mul_i32 s73, s95, 56
    s_add_u32 s73, s73, 143360
    buffer_load_dwordx4 v213, s[20:23], s73 offen lds
    s_add_u32 m0, s70, 30720
    s_mul_i32 s73, s95, 56
    s_add_u32 s73, s73, 172032
    buffer_load_dwordx4 v213, s[20:23], s73 offen lds
    s_add_u32 m0, s70, 31744
    s_mul_i32 s73, s95, 56
    s_add_u32 s73, s73, 200704
    buffer_load_dwordx4 v213, s[20:23], s73 offen lds
    s_add_u32 m0, s70, 32768
    s_mul_i32 s73, s96, 56
    s_add_u32 s73, s73, 0
    buffer_load_dwordx4 v213, s[20:23], s73 offen lds
    s_add_u32 m0, s70, 33792
    s_mul_i32 s73, s96, 56
    s_add_u32 s73, s73, 28672
    buffer_load_dwordx4 v213, s[20:23], s73 offen lds
    s_add_u32 m0, s70, 34816
    s_mul_i32 s73, s96, 56
    s_add_u32 s73, s73, 57344
    buffer_load_dwordx4 v213, s[20:23], s73 offen lds
    s_add_u32 m0, s70, 35840
    s_mul_i32 s73, s96, 56
    s_add_u32 s73, s73, 86016
    buffer_load_dwordx4 v213, s[20:23], s73 offen lds
    buffer_load_dword v249, v10, s[40:43], s83 offen sc1
    s_sleep 3
    buffer_load_dword v250, v10, s[40:43], s83 offen sc1
    s_sleep 3
    s_nop 0
Lpoll_P_4:
    s_sub_u32 s6, s6, 1
    s_cbranch_scc1 L_end_P
    buffer_load_dword v251, v10, s[40:43], s83 offen sc1
    s_waitcnt vmcnt(2)
    v_cmp_ne_u32 vcc, s4, v249
    s_nop 1
    s_cbranch_vccz Lpd_P_5
    buffer_load_dword v249, v10, s[40:43], s83 offen sc1
    s_waitcnt vmcnt(2)
    v_cmp_ne_u32 vcc, s4, v250
    s_nop 1
    s_cbranch_vccz Lpd_P_5
    buffer_load_dword v250, v10, s[40:43], s83 offen sc1
    s_waitcnt vmcnt(2)
    v_cmp_ne_u32 vcc, s4, v251
    s_nop 1
    s_cbranch_vccnz Lpoll_P_4
    s_nop 1
Lpd_P_5:
    s_lshl_b32 s58, s67, 16
    s_lshl_b32 s60, s3, 14
    s_add_u32 s58, s58, s60
    s_add_u32 m0, s70, 0
    s_nop 0
    buffer_load_dwordx4 v4, s[40:43], s58 offen offset:0 sc1 lds
    buffer_load_dwordx4 v4, s[40:43], s58 offen offset:1024 sc1 lds
    buffer_load_dwordx4 v4, s[40:43], s58 offen offset:2048 sc1 lds
    buffer_load_dwordx4 v4, s[40:43], s58 offen offset:3072 sc1 lds
    s_add_u32 m0, s70, 4096
    s_add_u32 s58, s58, 4096
    buffer_load_dwordx4 v4, s[40:43], s58 offen offset:0 sc1 lds
    buffer_load_dwordx4 v4, s[40:43], s58 offen offset:1024 sc1 lds
    buffer_load_dwordx4 v4, s[40:43], s58 offen offset:2048 sc1 lds
    buffer_load_dwordx4 v4, s[40:43], s58 offen offset:3072 sc1 lds
    s_add_u32 m0, s70, 8192
    s_add_u32 s58, s58, 4096
    buffer_load_dwordx4 v4, s[40:43], s58 offen offset:0 sc1 lds
    buffer_load_dwordx4 v4, s[40:43], s58 offen offset:1024 sc1 lds
    buffer_load_dwordx4 v4, s[40:43], s58 offen offset:2048 sc1 lds
    buffer_load_dwordx4 v4, s[40:43], s58 offen offset:3072 sc1 lds
    s_add_u32 m0, s70, 12288
    s_add_u32 s58, s58, 4096
    buffer_load_dwordx4 v4, s[40:43], s58 offen offset:0 sc1 lds
    buffer_load_dwordx4 v4, s[40:43], s58 offen offset:1024 sc1 lds
    buffer_load_dwordx4 v4, s[40:43], s58 offen offset:2048 sc1 lds
    buffer_load_dwordx4 v4, s[40:43], s58 offen offset:3072 sc1 lds
    v_and_b32 v64, 1, v3
    v_mul_u32_u24 v64, 36864, v64
    v_lshl_add_u32 v64, v2, 4, v64
    v_lshrrev_b32 v65, 5, v1
    v_lshl_add_u32 v64, v65, 8, v64
    s_lshr_b32 s60, s3, 1
    s_mul_i32 s60, s60, 73728
    s_add_u32 s60, s60, 12288
    v_add_u32 v64, s60, v64
    ds_read_b64_tr_b16 a[128:129], v215 offset:16384
    ds_read_b64_tr_b16 a[130:131], v215 offset:17408
    ds_read_b64_tr_b16 a[132:133], v216 offset:16384
    ds_read_b64_tr_b16 a[134:135], v216 offset:17408
    ds_read_b64_tr_b16 a[136:137], v215 offset:18432
    ds_read_b64_tr_b16 a[138:139], v215 offset:19456
    ds_read_b64_tr_b16 a[140:141], v216 offset:18432
    ds_read_b64_tr_b16 a[142:143], v216 offset:19456
    ds_read_b64_tr_b16 a[144:145], v215 offset:20480
    ds_read_b64_tr_b16 a[146:147], v215 offset:21504
    ds_read_b64_tr_b16 a[148:149], v216 offset:20480
    ds_read_b64_tr_b16 a[150:151], v216 offset:21504
    ds_read_b64_tr_b16 a[152:153], v215 offset:22528
    ds_read_b64_tr_b16 a[154:155], v215 offset:23552
    ds_read_b64_tr_b16 a[156:157], v216 offset:22528
    ds_read_b64_tr_b16 a[158:159], v216 offset:23552
    ds_read_b64_tr_b16 a[160:161], v215 offset:24576
    ds_read_b64_tr_b16 a[162:163], v215 offset:25600
    ds_read_b64_tr_b16 a[164:165], v216 offset:24576
    ds_read_b64_tr_b16 a[166:167], v216 offset:25600
    ds_read_b64_tr_b16 a[168:169], v215 offset:26624
    ds_read_b64_tr_b16 a[170:171], v215 offset:27648
    ds_read_b64_tr_b16 a[172:173], v216 offset:26624
    ds_read_b64_tr_b16 a[174:175], v216 offset:27648
    ds_read_b64_tr_b16 a[176:177], v215 offset:28672
    ds_read_b64_tr_b16 a[178:179], v215 offset:29696
    ds_read_b64_tr_b16 a[180:181], v216 offset:28672
    ds_read_b64_tr_b16 a[182:183], v216 offset:29696
    ds_read_b64_tr_b16 a[184:185], v215 offset:30720
    ds_read_b64_tr_b16 a[186:187], v215 offset:31744
    ds_read_b64_tr_b16 a[188:189], v216 offset:30720
    ds_read_b64_tr_b16 a[190:191], v216 offset:31744
    ds_read_b64_tr_b16 a[192:193], v215 offset:32768
    ds_read_b64_tr_b16 a[194:195], v215 offset:33792
    ds_read_b64_tr_b16 a[196:197], v216 offset:32768
    ds_read_b64_tr_b16 a[198:199], v216 offset:33792
    ds_read_b64_tr_b16 a[200:201], v215 offset:34816
    ds_read_b64_tr_b16 a[202:203], v215 offset:35840
    ds_read_b64_tr_b16 a[204:205], v216 offset:34816
    ds_read_b64_tr_b16 a[206:207], v216 offset:35840
    v_lshlrev_b32 v192, 16, v192
    v_lshlrev_b32 v193, 16, v193
    v_lshlrev_b32 v194, 16, v194
    v_lshlrev_b32 v195, 16, v195
    v_lshlrev_b32 v196, 16, v196
    v_lshlrev_b32 v197, 16, v197
    v_lshlrev_b32 v198, 16, v198
    v_lshlrev_b32 v199, 16, v199
    v_lshlrev_b32 v200, 16, v200
    v_lshlrev_b32 v201, 16, v201
    v_lshlrev_b32 v202, 16, v202
    v_lshlrev_b32 v203, 16, v203
    v_lshlrev_b32 v204, 16, v204
    v_lshlrev_b32 v205, 16, v205
    v_lshlrev_b32 v206, 16, v206
    v_lshlrev_b32 v207, 16, v207
    s_waitcnt vmcnt(8)
    s_barrier
    ds_read_b128 v[32:35], v64 offset:0
    ds_read_b128 v[36:39], v64 offset:512
    ds_read_b128 v[40:43], v64 offset:1024
    ds_read_b128 v[44:47], v64 offset:1536
    ds_read_b128 v[48:51], v64 offset:2048
    ds_read_b128 v[52:55], v64 offset:2560
    s_waitcnt lgkmcnt(5)
    v_mfma_f32_32x32x16_bf16 v[192:207], v[32:35], a[0:3], v[192:207]
    ds_read_b128 v[56:59], v64 offset:3072
    s_add_u32 m0, s70, 16384
    s_mul_i32 s73, s96, 56
    s_add_u32 s73, s73, 114688
    buffer_load_dwordx4 v213, s[20:23], s73 offen lds
    s_waitcnt lgkmcnt(5)
    v_mfma_f32_32x32x16_bf16 v[192:207], v[36:39], a[4:7], v[192:207]
    ds_read_b128 v[60:63], v64 offset:3584
    s_waitcnt lgkmcnt(5)
    v_mfma_f32_32x32x16_bf16 v[192:207], v[40:43], a[8:11], v[192:207]
    ds_read_b128 v[32:35], v64 offset:4096
    s_waitcnt lgkmcnt(5)
    v_mfma_f32_32x32x16_bf16 v[192:207], v[44:47], a[12:15], v[192:207]
    ds_read_b128 v[36:39], v64 offset:4608
    s_add_u32 m0, s70, 17408
    s_mul_i32 s73, s96, 56
    s_add_u32 s73, s73, 143360
    buffer_load_dwordx4 v213, s[20:23], s73 offen lds
    s_waitcnt lgkmcnt(5)
    v_mfma_f32_32x32x16_bf16 v[192:207], v[48:51], a[16:19], v[192:207]
    ds_read_b128 v[40:43], v64 offset:5120
    s_waitcnt lgkmcnt(5)
    v_mfma_f32_32x32x16_bf16 v[192:207], v[52:55], a[20:23], v[192:207]
    ds_read_b128 v[44:47], v64 offset:5632
    s_waitcnt lgkmcnt(5)
    v_mfma_f32_32x32x16_bf16 v[192:207], v[56:59], a[24:27], v[192:207]
    ds_read_b128 v[48:51], v64 offset:6144
    s_add_u32 m0, s70, 18432
    s_mul_i32 s73, s96, 56
    s_add_u32 s73, s73, 172032
    buffer_load_dwordx4 v213, s[20:23], s73 offen lds
    s_waitcnt lgkmcnt(5)
    v_mfma_f32_32x32x16_bf16 v[192:207], v[60:63], a[28:31], v[192:207]
    ds_read_b128 v[52:55], v64 offset:6656
    s_waitcnt lgkmcnt(5)
    v_mfma_f32_32x32x16_bf16 v[192:207], v[32:35], a[32:35], v[192:207]
    ds_read_b128 v[56:59], v64 offset:7168
    s_waitcnt lgkmcnt(5)
    v_mfma_f32_32x32x16_bf16 v[192:207], v[36:39], a[36:39], v[192:207]
    ds_read_b128 v[60:63], v64 offset:7680
    s_add_u32 m0, s70, 19456
    s_mul_i32 s73, s96, 56
    s_add_u32 s73, s73, 200704
    buffer_load_dwordx4 v213, s[20:23], s73 offen lds
    s_waitcnt lgkmcnt(5)
    v_mfma_f32_32x32x16_bf16 v[192:207], v[40:43], a[40:43], v[192:207]
    s_waitcnt lgkmcnt(4)
    v_mfma_f32_32x32x16_bf16 v[192:207], v[44:47], a[44:47], v[192:207]
    s_waitcnt vmcnt(4)
    s_barrier
    ds_read_b128 v[32:35], v64 offset:8192
    ds_read_b128 v[36:39], v64 offset:8704
    s_waitcnt lgkmcnt(5)
    v_mfma_f32_32x32x16_bf16 v[192:207], v[48:51], a[48:51], v[192:207]
    ds_read_b128 v[40:43], v64 offset:9216
    s_add_u32 m0, s70, 20480
    s_mul_i32 s73, s97, 56
    s_add_u32 s73, s73, 0
    buffer_load_dwordx4 v213, s[20:23], s73 offen lds
    s_waitcnt lgkmcnt(5)
    v_mfma_f32_32x32x16_bf16 v[192:207], v[52:55], a[52:55], v[192:207]
    ds_read_b128 v[44:47], v64 offset:9728
    s_waitcnt lgkmcnt(5)
    v_mfma_f32_32x32x16_bf16 v[192:207], v[56:59], a[56:59], v[192:207]
    ds_read_b128 v[48:51], v64 offset:10240
    s_waitcnt lgkmcnt(5)
    v_mfma_f32_32x32x16_bf16 v[192:207], v[60:63], a[60:63], v[192:207]
    ds_read_b128 v[52:55], v64 offset:10752
    s_add_u32 m0, s70, 21504
    s_mul_i32 s73, s97, 56
    s_add_u32 s73, s73, 28672
    buffer_load_dwordx4 v213, s[20:23], s73 offen lds
    s_waitcnt lgkmcnt(5)
    v_mfma_f32_32x32x16_bf16 v[192:207], v[32:35], a[64:67], v[192:207]
    ds_read_b128 v[56:59], v64 offset:11264
    s_waitcnt lgkmcnt(5)
    v_mfma_f32_32x32x16_bf16 v[192:207], v[36:39], a[68:71], v[192:207]
    ds_read_b128 v[60:63], v64 offset:11776
    s_waitcnt lgkmcnt(5)
    v_mfma_f32_32x32x16_bf16 v[192:207], v[40:43], a[72:75], v[192:207]
    ds_read_b128 v[32:35], v64 offset:12288
    s_add_u32 m0, s70, 22528
    s_mul_i32 s73, s97, 56
    s_add_u32 s73, s73, 57344
    buffer_load_dwordx4 v213, s[20:23], s73 offen lds
    s_waitcnt lgkmcnt(5)
    v_mfma_f32_32x32x16_bf16 v[192:207], v[44:47], a[76:79], v[192:207]
    ds_read_b128 v[36:39], v64 offset:12800
    s_waitcnt lgkmcnt(5)
    v_mfma_f32_32x32x16_bf16 v[192:207], v[48:51], a[80:83], v[192:207]
    ds_read_b128 v[40:43], v64 offset:13312
    s_waitcnt lgkmcnt(5)
    v_mfma_f32_32x32x16_bf16 v[192:207], v[52:55], a[84:87], v[192:207]
    ds_read_b128 v[44:47], v64 offset:13824
    s_add_u32 m0, s70, 23552
    s_mul_i32 s73, s97, 56
    s_add_u32 s73, s73, 86016
    buffer_load_dwordx4 v213, s[20:23], s73 offen lds
    s_waitcnt lgkmcnt(5)
    v_mfma_f32_32x32x16_bf16 v[192:207], v[56:59], a[88:91], v[192:207]
    ds_read_b128 v[48:51], v64 offset:14336
    s_waitcnt lgkmcnt(5)
    v_mfma_f32_32x32x16_bf16 v[192:207], v[60:63], a[92:95], v[192:207]
    ds_read_b128 v[52:55], v64 offset:14848
    s_waitcnt lgkmcnt(5)
    v_mfma_f32_32x32x16_bf16 v[192:207], v[32:35], a[96:99], v[192:207]
    ds_read_b128 v[56:59], v64 offset:15360
    s_add_u32 m0, s70, 24576
    s_mul_i32 s73, s97, 56
    s_add_u32 s73, s73, 114688
    buffer_load_dwordx4 v213, s[20:23], s73 offen lds
    s_waitcnt lgkmcnt(5)
    v_mfma_f32_32x32x16_bf16 v[192:207], v[36:39], a[100:103], v[192:207]
    ds_read_b128 v[60:63], v64 offset:15872
    s_waitcnt lgkmcnt(5)
    v_mfma_f32_32x32x16_bf16 v[192:207], v[40:43], a[104:107], v[192:207]
    s_waitcnt lgkmcnt(4)
    v_mfma_f32_32x32x16_bf16 v[192:207], v[44:47], a[108:111], v[192:207]
    s_add_u32 m0, s70, 25600
    s_mul_i32 s73, s97, 56
    s_add_u32 s73, s73, 143360
    buffer_load_dwordx4 v213, s[20:23], s73 offen lds
    s_waitcnt lgkmcnt(3)
    v_mfma_f32_32x32x16_bf16 v[192:207], v[48:51], a[112:115], v[192:207]
    s_waitcnt lgkmcnt(2)
    v_mfma_f32_32x32x16_bf16 v[192:207], v[52:55], a[116:119], v[192:207]
    s_waitcnt lgkmcnt(1)
    v_mfma_f32_32x32x16_bf16 v[192:207], v[56:59], a[120:123], v[192:207]
    s_add_u32 m0, s70, 26624
    s_mul_i32 s73, s97, 56
    s_add_u32 s73, s73, 172032
    buffer_load_dwordx4 v213, s[20:23], s73 offen lds
    s_waitcnt lgkmcnt(0)
    v_mfma_f32_32x32x16_bf16 v[192:207], v[60:63], a[124:127], v[192:207]
    s_nop 11
    v_pk_mul_f32 v[68:69], v[192:193], v[192:193]
    v_pk_mul_f32 v[70:71], v[194:195], v[194:195]
    v_pk_mul_f32 v[72:73], v[196:197], v[196:197]
    v_pk_mul_f32 v[74:75], v[198:199], v[198:199]
    v_pk_mul_f32 v[76:77], v[200:201], v[200:201]
    v_pk_mul_f32 v[78:79], v[202:203], v[202:203]
    v_pk_mul_f32 v[80:81], v[204:205], v[204:205]
    v_pk_mul_f32 v[82:83], v[206:207], v[206:207]
    s_add_u32 m0, s70, 27648
    s_mul_i32 s73, s97, 56
    s_add_u32 s73, s73, 200704
    buffer_load_dwordx4 v213, s[20:23], s73 offen lds
    v_add_f32_dpp v84, v192, v192 row_mirror row_mask:0xf bank_mask:0x3
    v_add_f32_dpp v85, v193, v193 row_mirror row_mask:0xf bank_mask:0x3
    v_add_f32_dpp v86, v196, v196 row_mirror row_mask:0xf bank_mask:0x3
    v_add_f32_dpp v87, v197, v197 row_mirror row_mask:0xf bank_mask:0x3
    v_add_f32_dpp v88, v200, v200 row_mirror row_mask:0xf bank_mask:0x3
    v_add_f32_dpp v89, v201, v201 row_mirror row_mask:0xf bank_mask:0x3
    v_add_f32_dpp v90, v204, v204 row_mirror row_mask:0xf bank_mask:0x3
    v_add_f32_dpp v91, v205, v205 row_mirror row_mask:0xf bank_mask:0x3
    s_add_u32 m0, s70, 28672
    s_mul_i32 s73, s98, 56
    s_add_u32 s73, s73, 0
    buffer_load_dwordx4 v213, s[20:23], s73 offen lds
    v_add_f32_dpp v92, v68, v68 row_mirror row_mask:0xf bank_mask:0x3
    v_add_f32_dpp v93, v69, v69 row_mirror row_mask:0xf bank_mask:0x3
    v_add_f32_dpp v94, v72, v72 row_mirror row_mask:0xf bank_mask:0x3
    v_add_f32_dpp v95, v73, v73 row_mirror row_mask:0xf bank_mask:0x3
    v_add_f32_dpp v96, v76, v76 row_mirror row_mask:0xf bank_mask:0x3
    v_add_f32_dpp v97, v77, v77 row_mirror row_mask:0xf bank_mask:0x3
    v_add_f32_dpp v98, v80, v80 row_mirror row_mask:0xf bank_mask:0x3
    v_add_f32_dpp v99, v81, v81 row_mirror row_mask:0xf bank_mask:0x3
    s_add_u32 m0, s70, 29696
    s_mul_i32 s73, s98, 56
    s_add_u32 s73, s73, 28672
    buffer_load_dwordx4 v213, s[20:23], s73 offen lds
    v_add_f32_dpp v84, v194, v194 row_mirror row_mask:0xf bank_mask:0xc
    v_add_f32_dpp v85, v195, v195 row_mirror row_mask:0xf bank_mask:0xc
    v_add_f32_dpp v86, v198, v198 row_mirror row_mask:0xf bank_mask:0xc
    v_add_f32_dpp v87, v199, v199 row_mirror row_mask:0xf bank_mask:0xc
    v_add_f32_dpp v88, v202, v202 row_mirror row_mask:0xf bank_mask:0xc
    v_add_f32_dpp v89, v203, v203 row_mirror row_mask:0xf bank_mask:0xc
    v_add_f32_dpp v90, v206, v206 row_mirror row_mask:0xf bank_mask:0xc
    v_add_f32_dpp v91, v207, v207 row_mirror row_mask:0xf bank_mask:0xc
    s_add_u32 m0, s70, 30720
    s_mul_i32 s73, s98, 56
    s_add_u32 s73, s73, 57344
    buffer_load_dwordx4 v213, s[20:23], s73 offen lds
    v_add_f32_dpp v92, v70, v70 row_mirror row_mask:0xf bank_mask:0xc
    v_add_f32_dpp v93, v71, v71 row_mirror row_mask:0xf bank_mask:0xc
    v_add_f32_dpp v94, v74, v74 row_mirror row_mask:0xf bank_mask:0xc
    v_add_f32_dpp v95, v75, v75 row_mirror row_mask:0xf bank_mask:0xc
    v_add_f32_dpp v96, v78, v78 row_mirror row_mask:0xf bank_mask:0xc
    v_add_f32_dpp v97, v79, v79 row_mirror row_mask:0xf bank_mask:0xc
    v_add_f32_dpp v98, v82, v82 row_mirror row_mask:0xf bank_mask:0xc
    v_add_f32_dpp v99, v83, v83 row_mirror row_mask:0xf bank_mask:0xc
    s_add_u32 m0, s70, 31744
    s_mul_i32 s73, s98, 56
    s_add_u32 s73, s73, 86016
    buffer_load_dwordx4 v213, s[20:23], s73 offen lds
    v_add_f32_dpp v84, v84, v84 row_half_mirror row_mask:0xf bank_mask:0x5
    v_add_f32_dpp v86, v86, v86 row_half_mirror row_mask:0xf bank_mask:0x5
    v_add_f32_dpp v88, v88, v88 row_half_mirror row_mask:0xf bank_mask:0x5
    v_add_f32_dpp v90, v90, v90 row_half_mirror row_mask:0xf bank_mask:0x5
    v_add_f32_dpp v92, v92, v92 row_half_mirror row_mask:0xf bank_mask:0x5
    v_add_f32_dpp v94, v94, v94 row_half_mirror row_mask:0xf bank_mask:0x5
    v_add_f32_dpp v96, v96, v96 row_half_mirror row_mask:0xf bank_mask:0x5
    v_add_f32_dpp v98, v98, v98 row_half_mirror row_mask:0xf bank_mask:0x5
    v_add_f32_dpp v84, v85, v85 row_half_mirror row_mask:0xf bank_mask:0xa
    v_add_f32_dpp v86, v87, v87 row_half_mirror row_mask:0xf bank_mask:0xa
    v_add_f32_dpp v88, v89, v89 row_half_mirror row_mask:0xf bank_mask:0xa
    v_add_f32_dpp v90, v91, v91 row_half_mirror row_mask:0xf bank_mask:0xa
    v_add_f32_dpp v92, v93, v93 row_half_mirror row_mask:0xf bank_mask:0xa
    v_add_f32_dpp v94, v95, v95 row_half_mirror row_mask:0xf bank_mask:0xa
    v_add_f32_dpp v96, v97, v97 row_half_mirror row_mask:0xf bank_mask:0xa
    v_add_f32_dpp v98, v99, v99 row_half_mirror row_mask:0xf bank_mask:0xa
    v_add_f32_dpp v85, v84, v84 quad_perm:[1,0,3,2] row_mask:0xf bank_mask:0xf
    v_add_f32_dpp v87, v86, v86 quad_perm:[1,0,3,2] row_mask:0xf bank_mask:0xf
    v_add_f32_dpp v89, v88, v88 quad_perm:[1,0,3,2] row_mask:0xf bank_mask:0xf
    v_add_f32_dpp v91, v90, v90 quad_perm:[1,0,3,2] row_mask:0xf bank_mask:0xf
    v_add_f32_dpp v93, v92, v92 quad_perm:[1,0,3,2] row_mask:0xf bank_mask:0xf
    v_add_f32_dpp v95, v94, v94 quad_perm:[1,0,3,2] row_mask:0xf bank_mask:0xf
    v_add_f32_dpp v97, v96, v96 quad_perm:[1,0,3,2] row_mask:0xf bank_mask:0xf
    v_add_f32_dpp v99, v98, v98 quad_perm:[1,0,3,2] row_mask:0xf bank_mask:0xf
    v_add_f32_dpp v68, v85, v85 quad_perm:[2,3,0,1] row_mask:0xf bank_mask:0xf
    v_add_f32_dpp v69, v87, v87 quad_perm:[2,3,0,1] row_mask:0xf bank_mask:0xf
    v_add_f32_dpp v70, v89, v89 quad_perm:[2,3,0,1] row_mask:0xf bank_mask:0xf
    v_add_f32_dpp v71, v91, v91 quad_perm:[2,3,0,1] row_mask:0xf bank_mask:0xf
    v_add_f32_dpp v72, v93, v93 quad_perm:[2,3,0,1] row_mask:0xf bank_mask:0xf
    v_add_f32_dpp v73, v95, v95 quad_perm:[2,3,0,1] row_mask:0xf bank_mask:0xf
    v_add_f32_dpp v74, v97, v97 quad_perm:[2,3,0,1] row_mask:0xf bank_mask:0xf
    v_add_f32_dpp v75, v99, v99 quad_perm:[2,3,0,1] row_mask:0xf bank_mask:0xf
    v_permlane16_swap_b32 v68, v69
    v_permlane16_swap_b32 v70, v71
    v_permlane16_swap_b32 v72, v73
    v_permlane16_swap_b32 v74, v75
    v_add_f32 v84, v68, v69
    v_add_f32 v85, v72, v73
    v_add_f32 v86, v70, v71
    v_add_f32 v87, v74, v75
    v_and_b32 v65, 1, v3
    v_lshlrev_b32 v65, 6, v65
    v_lshrrev_b32 v66, 5, v1
    v_lshl_add_u32 v65, v66, 5, v65
    v_bfe_u32 v67, v1, 2, 2
    v_lshl_add_u32 v65, v67, 3, v65
    s_lshl_b32 s58, s3, 8
    v_add_u32 v65, s58, v65
    ds_write_b64 v65, v[84:85] offset:0
    ds_write_b64 v65, v[86:87] offset:128
    v_and_b32 v67, 31, v1
    v_lshlrev_b32 v65, 9, v66
    v_lshl_add_u32 v65, v67, 4, v65
    v_lshlrev_b32 v66, 8, v66
    v_lshl_add_u32 v66, v67, 3, v66
    s_and_b32 s58, s58, 512
    v_add_u32 v66, s58, v66
    s_lshl_b32 s58, s67, 1
    s_lshr_b32 s60, s3, 1
    s_add_u32 s58, s58, s60
    s_lshl_b32 s58, s58, 12
    s_add_u32 s58, s58, 0x548000
    s_lshl_b32 s60, s66, 9
    s_add_u32 s60, s60, s58
    s_waitcnt lgkmcnt(0)
    s_barrier
    ds_read_b64 v[84:85], v66 offset:0
    v_mov_b32 v89, s4
    v_mov_b32 v91, s4
    s_waitcnt lgkmcnt(0)
    v_mov_b32 v88, v84
    v_mov_b32 v90, v85
    s_nop 0
    v_permlane32_swap_b32 v88, v84
    v_permlane32_swap_b32 v90, v85
    v_add_f32 v88, v88, v84
    v_add_f32 v90, v90, v85
    s_bitcmp0_b32 s3, 0
    s_cselect_b32 exec_lo, -1, 0
    s_mov_b32 exec_hi, 0
    buffer_store_dwordx4 v[88:91], v65, s[40:43], s60 offen sc1
    s_mov_b64 exec, -1
    v_cvt_pk_bf16_f32 v240, v192, v193
    v_cvt_pk_bf16_f32 v241, v194, v195
    v_cvt_pk_bf16_f32 v242, v196, v197
    v_cvt_pk_bf16_f32 v243, v198, v199
    v_cvt_pk_bf16_f32 v244, v200, v201
    v_cvt_pk_bf16_f32 v245, v202, v203
    v_cvt_pk_bf16_f32 v246, v204, v205
    v_cvt_pk_bf16_f32 v247, v206, v207
    s_lshl_b32 s61, s66, 1
    s_and_b32 s60, s3, 1
    s_add_u32 s61, s61, s60
    s_lshl_b32 s61, s61, 7
    s_lshl_b32 s60, s67, 2
    s_add_u32 s61, s61, s60
    s_and_b32 s60, s3, 2
    s_add_u32 s61, s61, s60
    s_lshl_b32 s61, s61, 10
    s_add_u32 s61, s61, 0x200000
    v_lshlrev_b32 v66, 4, v67
    v_cmp_gt_u32 s[86:87], 32, v1
    s_add_u32 m0, s70, 0
    s_mul_i32 s73, s98, 56
    s_add_u32 s73, s73, 114688
    buffer_load_dwordx4 v213, s[20:23], s73 offen lds
    s_add_u32 m0, s70, 1024
    s_mul_i32 s73, s98, 56
    s_add_u32 s73, s73, 143360
    buffer_load_dwordx4 v213, s[20:23], s73 offen lds
    s_add_u32 m0, s70, 2048
    s_mul_i32 s73, s98, 56
    s_add_u32 s73, s73, 172032
    buffer_load_dwordx4 v213, s[20:23], s73 offen lds
    s_add_u32 m0, s70, 3072
    s_mul_i32 s73, s98, 56
    s_add_u32 s73, s73, 200704
    buffer_load_dwordx4 v213, s[20:23], s73 offen lds
    s_add_u32 m0, s70, 4096
    s_mul_i32 s73, s99, 56
    s_add_u32 s73, s73, 0
    buffer_load_dwordx4 v213, s[20:23], s73 offen lds
    s_add_u32 m0, s70, 5120
    s_mul_i32 s73, s99, 56
    s_add_u32 s73, s73, 28672
    buffer_load_dwordx4 v213, s[20:23], s73 offen lds
    s_add_u32 m0, s70, 6144
    s_mul_i32 s73, s99, 56
    s_add_u32 s73, s73, 57344
    buffer_load_dwordx4 v213, s[20:23], s73 offen lds
    s_add_u32 m0, s70, 7168
    s_mul_i32 s73, s99, 56
    s_add_u32 s73, s73, 86016
    buffer_load_dwordx4 v213, s[20:23], s73 offen lds
    s_add_u32 m0, s70, 8192
    s_mul_i32 s73, s99, 56
    s_add_u32 s73, s73, 114688
    buffer_load_dwordx4 v213, s[20:23], s73 offen lds
    s_add_u32 m0, s70, 9216
    s_mul_i32 s73, s99, 56
    s_add_u32 s73, s73, 143360
    buffer_load_dwordx4 v213, s[20:23], s73 offen lds
    s_add_u32 m0, s70, 10240
    s_mul_i32 s73, s99, 56
    s_add_u32 s73, s73, 172032
    buffer_load_dwordx4 v213, s[20:23], s73 offen lds
    s_add_u32 m0, s70, 11264
    s_mul_i32 s73, s99, 56
    s_add_u32 s73, s73, 200704
    buffer_load_dwordx4 v213, s[20:23], s73 offen lds
    s_add_u32 m0, s70, 12288
    s_mul_i32 s73, s100, 56
    s_add_u32 s73, s73, 0
    buffer_load_dwordx4 v213, s[20:23], s73 offen lds
    s_add_u32 m0, s70, 13312
    s_mul_i32 s73, s100, 56
    s_add_u32 s73, s73, 28672
    buffer_load_dwordx4 v213, s[20:23], s73 offen lds
    s_add_u32 m0, s70, 14336
    s_mul_i32 s73, s100, 56
    s_add_u32 s73, s73, 57344
    buffer_load_dwordx4 v213, s[20:23], s73 offen lds
    s_add_u32 m0, s70, 15360
    s_mul_i32 s73, s100, 56
    s_add_u32 s73, s73, 86016
    buffer_load_dwordx4 v213, s[20:23], s73 offen lds
    buffer_load_dwordx4 v[96:99], v65, s[40:43], s58 offen offset:0 sc1
    buffer_load_dwordx4 v[100:103], v65, s[40:43], s58 offen offset:1024 sc1
    buffer_load_dwordx4 v[104:107], v65, s[40:43], s58 offen offset:2048 sc1
    buffer_load_dwordx4 v[108:111], v66, s[40:43], s58 offen offset:3072 sc1
    s_sleep 5
    s_nop 0
Lst_P_6:
    s_sub_u32 s6, s6, 1
    s_cbranch_scc1 L_end_P
    buffer_load_dwordx4 v[112:115], v65, s[40:43], s58 offen offset:0 sc1
    buffer_load_dwordx4 v[116:119], v65, s[40:43], s58 offen offset:1024 sc1
    buffer_load_dwordx4 v[120:123], v65, s[40:43], s58 offen offset:2048 sc1
    buffer_load_dwordx4 v[124:127], v66, s[40:43], s58 offen offset:3072 sc1
    s_waitcnt vmcnt(4)
    v_xor_b32 v97, s4, v97
    v_xor_b32 v99, s4, v99
    v_xor_b32 v101, s4, v101
    v_xor_b32 v103, s4, v103
    v_xor_b32 v105, s4, v105
    v_xor_b32 v107, s4, v107
    v_xor_b32 v109, s4, v109
    v_xor_b32 v111, s4, v111
    v_cndmask_b32 v108, 0, v108, s[86:87]
    v_cndmask_b32 v110, 0, v110, s[86:87]
    v_or3_b32 v97, v97, v99, v101
    v_or3_b32 v103, v103, v105, v107
    v_or3_b32 v97, v97, v109, v111
    v_or_b32 v97, v97, v103
    v_cmp_ne_u32 vcc, 0, v97
    v_add_f32 v128, v96, v100
    v_add_f32 v129, v104, v108
    v_add_f32 v130, v98, v102
    v_add_f32 v131, v106, v110
    s_cbranch_vccz Lstd_P_7
    buffer_load_dwordx4 v[96:99], v65, s[40:43], s58 offen offset:0 sc1
    buffer_load_dwordx4 v[100:103], v65, s[40:43], s58 offen offset:1024 sc1
    buffer_load_dwordx4 v[104:107], v65, s[40:43], s58 offen offset:2048 sc1
    buffer_load_dwordx4 v[108:111], v66, s[40:43], s58 offen offset:3072 sc1
    s_waitcnt vmcnt(4)
    v_xor_b32 v113, s4, v113
    v_xor_b32 v115, s4, v115
    v_xor_b32 v117, s4, v117
    v_xor_b32 v119, s4, v119
    v_xor_b32 v121, s4, v121
    v_xor_b32 v123, s4, v123
    v_xor_b32 v125, s4, v125
    v_xor_b32 v127, s4, v127
    v_cndmask_b32 v124, 0, v124, s[86:87]
    v_cndmask_b32 v126, 0, v126, s[86:87]
    v_or3_b32 v113, v113, v115, v117
    v_or3_b32 v119, v119, v121, v123
    v_or3_b32 v113, v113, v125, v127
    v_or_b32 v113, v113, v119
    v_cmp_ne_u32 vcc, 0, v113
    v_add_f32 v128, v112, v116
    v_add_f32 v129, v120, v124
    v_add_f32 v130, v114, v118
    v_add_f32 v131, v122, v126
    s_cbranch_vccnz Lst_P_6
    s_nop 3
Lstd_P_7:
    v_add_f32 v128, v128, v129
    v_add_f32 v130, v130, v131
    v_mov_b32 v136, v128
    v_mov_b32 v138, v130
    s_nop 0
    v_permlane32_swap_b32 v128, v136
    v_permlane32_swap_b32 v130, v138
    v_add_f32 v128, v128, v136
    v_add_f32 v130, v130, v138
    v_mul_f32 v133, 0x3b124925, v128
    v_mul_f32 v130, 0x3b124925, v130
    v_fma_f32 v130, -v133, v133, v130
    v_max_f32 v130, 0, v130
    v_add_f32 v135, 0x3727c5ac, v130
    v_rsq_f32 v135, v135
    s_nop 0
    v_mul_f32 v130, v130, v135
    v_fmaak_f32 v130, v130, v135, 0x3727c5ac
    v_rsq_f32 v130, v130
    s_nop 0
    v_mul_f32 v135, v135, v130
    s_lshl_b32 s60, s3, 8
    v_lshl_add_u32 v66, v67, 2, s60
    ds_write_b32 v66, v133 offset:1024
    ds_write_b32 v66, v135 offset:1152
    v_lshrrev_b32 v66, 5, v1
    v_lshl_add_u32 v66, v66, 4, s60
    s_waitcnt lgkmcnt(0)
    ds_read_b128 v[140:143], v66 offset:1024
    ds_read_b128 v[156:159], v66 offset:1152
    ds_read_b128 v[144:147], v66 offset:1056
    ds_read_b128 v[160:163], v66 offset:1184
    ds_read_b128 v[148:151], v66 offset:1088
    ds_read_b128 v[164:167], v66 offset:1216
    ds_read_b128 v[152:155], v66 offset:1120
    ds_read_b128 v[168:171], v66 offset:1248
    s_waitcnt lgkmcnt(7)
    v_pk_add_f32 v[192:193], v[192:193], v[140:141] neg_lo:[0,1] neg_hi:[0,1]
    v_pk_add_f32 v[194:195], v[194:195], v[142:143] neg_lo:[0,1] neg_hi:[0,1]
    s_waitcnt lgkmcnt(5)
    v_pk_add_f32 v[196:197], v[196:197], v[144:145] neg_lo:[0,1] neg_hi:[0,1]
    v_pk_add_f32 v[198:199], v[198:199], v[146:147] neg_lo:[0,1] neg_hi:[0,1]
    v_pk_mul_f32 v[192:193], v[192:193], v[156:157]
    v_pk_mul_f32 v[194:195], v[194:195], v[158:159]
    s_waitcnt lgkmcnt(4)
    v_pk_mul_f32 v[196:197], v[196:197], v[160:161]
    v_pk_mul_f32 v[198:199], v[198:199], v[162:163]
    v_cvt_pk_bf16_f32 v84, v192, v193
    v_cvt_pk_bf16_f32 v85, v194, v195
    v_cvt_pk_bf16_f32 v86, v196, v197
    v_cvt_pk_bf16_f32 v87, v198, v199
    buffer_store_dwordx4 v[84:87], v4, s[40:43], s61 offen offset:0 sc1
    s_waitcnt lgkmcnt(3)
    v_pk_add_f32 v[200:201], v[200:201], v[148:149] neg_lo:[0,1] neg_hi:[0,1]
    v_pk_add_f32 v[202:203], v[202:203], v[150:151] neg_lo:[0,1] neg_hi:[0,1]
    s_waitcnt lgkmcnt(1)
    v_pk_add_f32 v[204:205], v[204:205], v[152:153] neg_lo:[0,1] neg_hi:[0,1]
    v_pk_add_f32 v[206:207], v[206:207], v[154:155] neg_lo:[0,1] neg_hi:[0,1]
    v_pk_mul_f32 v[200:201], v[200:201], v[164:165]
    v_pk_mul_f32 v[202:203], v[202:203], v[166:167]
    s_waitcnt lgkmcnt(0)
    v_pk_mul_f32 v[204:205], v[204:205], v[168:169]
    v_pk_mul_f32 v[206:207], v[206:207], v[170:171]
    v_cvt_pk_bf16_f32 v88, v200, v201
    v_cvt_pk_bf16_f32 v89, v202, v203
    v_cvt_pk_bf16_f32 v90, v204, v205
    v_cvt_pk_bf16_f32 v91, v206, v207
    buffer_store_dwordx4 v[88:91], v4, s[40:43], s61 offen offset:1024 sc1
    ds_read_b64_tr_b16 a[208:209], v215 offset:16384
    ds_read_b64_tr_b16 a[210:211], v215 offset:17408
    ds_read_b64_tr_b16 a[212:213], v216 offset:16384
    ds_read_b64_tr_b16 a[214:215], v216 offset:17408
    ds_read_b64_tr_b16 a[216:217], v215 offset:18432
    ds_read_b64_tr_b16 a[218:219], v215 offset:19456
    ds_read_b64_tr_b16 a[220:221], v216 offset:18432
    ds_read_b64_tr_b16 a[222:223], v216 offset:19456
    ds_read_b64_tr_b16 a[224:225], v215 offset:20480
    ds_read_b64_tr_b16 a[226:227], v215 offset:21504
    ds_read_b64_tr_b16 a[228:229], v216 offset:20480
    ds_read_b64_tr_b16 a[230:231], v216 offset:21504
    ds_read_b64_tr_b16 a[232:233], v215 offset:22528
    ds_read_b64_tr_b16 a[234:235], v215 offset:23552
    ds_read_b64_tr_b16 a[236:237], v216 offset:22528
    ds_read_b64_tr_b16 a[238:239], v216 offset:23552
    ds_read_b64_tr_b16 a[240:241], v215 offset:24576
    ds_read_b64_tr_b16 a[242:243], v215 offset:25600
    ds_read_b64_tr_b16 a[244:245], v216 offset:24576
    ds_read_b64_tr_b16 a[246:247], v216 offset:25600
    ds_read_b64_tr_b16 a[248:249], v215 offset:26624
    ds_read_b64_tr_b16 a[250:251], v215 offset:27648
    ds_read_b64_tr_b16 a[252:253], v216 offset:26624
    ds_read_b64_tr_b16 a[254:255], v216 offset:27648
    ds_read_b64_tr_b16 a[0:1], v215 offset:28672
    ds_read_b64_tr_b16 a[2:3], v215 offset:29696
    ds_read_b64_tr_b16 a[4:5], v216 offset:28672
    ds_read_b64_tr_b16 a[6:7], v216 offset:29696
    ds_read_b64_tr_b16 a[8:9], v215 offset:30720
    ds_read_b64_tr_b16 a[10:11], v215 offset:31744
    ds_read_b64_tr_b16 a[12:13], v216 offset:30720
    ds_read_b64_tr_b16 a[14:15], v216 offset:31744
    ds_read_b64_tr_b16 a[16:17], v215 offset:0
    ds_read_b64_tr_b16 a[18:19], v215 offset:1024
    ds_read_b64_tr_b16 a[20:21], v216 offset:0
    ds_read_b64_tr_b16 a[22:23], v216 offset:1024
    ds_read_b64_tr_b16 a[24:25], v215 offset:2048
    ds_read_b64_tr_b16 a[26:27], v215 offset:3072
    ds_read_b64_tr_b16 a[28:29], v216 offset:2048
    ds_read_b64_tr_b16 a[30:31], v216 offset:3072
    ds_read_b64_tr_b16 a[32:33], v215 offset:4096
    ds_read_b64_tr_b16 a[34:35], v215 offset:5120
    ds_read_b64_tr_b16 a[36:37], v216 offset:4096
    ds_read_b64_tr_b16 a[38:39], v216 offset:5120
    ds_read_b64_tr_b16 a[40:41], v215 offset:6144
    ds_read_b64_tr_b16 a[42:43], v215 offset:7168
    ds_read_b64_tr_b16 a[44:45], v216 offset:6144
    ds_read_b64_tr_b16 a[46:47], v216 offset:7168
    ds_read_b64_tr_b16 a[48:49], v215 offset:8192
    ds_read_b64_tr_b16 a[50:51], v215 offset:9216
    ds_read_b64_tr_b16 a[52:53], v216 offset:8192
    ds_read_b64_tr_b16 a[54:55], v216 offset:9216
    ds_read_b64_tr_b16 a[56:57], v215 offset:10240
    ds_read_b64_tr_b16 a[58:59], v215 offset:11264
    ds_read_b64_tr_b16 a[60:61], v216 offset:10240
    ds_read_b64_tr_b16 a[62:63], v216 offset:11264
    ds_read_b64_tr_b16 a[64:65], v215 offset:12288
    ds_read_b64_tr_b16 a[66:67], v215 offset:13312
    ds_read_b64_tr_b16 a[68:69], v216 offset:12288
    ds_read_b64_tr_b16 a[70:71], v216 offset:13312
    ds_read_b64_tr_b16 a[72:73], v215 offset:14336
    ds_read_b64_tr_b16 a[74:75], v215 offset:15360
    ds_read_b64_tr_b16 a[76:77], v216 offset:14336
    ds_read_b64_tr_b16 a[78:79], v216 offset:15360
    s_waitcnt vmcnt(0)
    v_mov_b32 v8, s4
    s_mov_b64 exec, 1
    buffer_store_dword v8, v9, s[40:43], s81 offen sc1
    s_mov_b64 exec, -1
    s_waitcnt lgkmcnt(4)
    s_add_u32 m0, s70, 12288
    s_mul_i32 s73, s100, 56
    s_add_u32 s73, s73, 114688
    buffer_load_dwordx4 v213, s[20:23], s73 offen lds
    s_add_u32 m0, s70, 13312
    s_mul_i32 s73, s100, 56
    s_add_u32 s73, s73, 143360
    buffer_load_dwordx4 v213, s[20:23], s73 offen lds
    s_waitcnt lgkmcnt(0)
    s_add_u32 m0, s70, 14336
    s_mul_i32 s73, s100, 56
    s_add_u32 s73, s73, 172032
    buffer_load_dwordx4 v213, s[20:23], s73 offen lds
    s_add_u32 m0, s70, 15360
    s_mul_i32 s73, s100, 56
    s_add_u32 s73, s73, 200704
    buffer_load_dwordx4 v213, s[20:23], s73 offen lds
    s_add_u32 m0, s70, 16384
    s_mul_i32 s73, s101, 56
    s_add_u32 s73, s73, 0
    buffer_load_dwordx4 v213, s[20:23], s73 offen lds
    s_add_u32 m0, s70, 17408
    s_mul_i32 s73, s101, 56
    s_add_u32 s73, s73, 28672
    buffer_load_dwordx4 v213, s[20:23], s73 offen lds
    s_add_u32 m0, s70, 18432
    s_mul_i32 s73, s101, 56
    s_add_u32 s73, s73, 57344
    buffer_load_dwordx4 v213, s[20:23], s73 offen lds
    s_add_u32 m0, s70, 19456
    s_mul_i32 s73, s101, 56
    s_add_u32 s73, s73, 86016
    buffer_load_dwordx4 v213, s[20:23], s73 offen lds
    s_add_u32 m0, s70, 20480
    s_mul_i32 s73, s101, 56
    s_add_u32 s73, s73, 114688
    buffer_load_dwordx4 v213, s[20:23], s73 offen lds
    s_add_u32 m0, s70, 21504
    s_mul_i32 s73, s101, 56
    s_add_u32 s73, s73, 143360
    buffer_load_dwordx4 v213, s[20:23], s73 offen lds
    s_add_u32 m0, s70, 22528
    s_mul_i32 s73, s101, 56
    s_add_u32 s73, s73, 172032
    buffer_load_dwordx4 v213, s[20:23], s73 offen lds
    s_add_u32 m0, s70, 23552
    s_mul_i32 s73, s101, 56
    s_add_u32 s73, s73, 200704
    buffer_load_dwordx4 v213, s[20:23], s73 offen lds
    s_add_u32 m0, s70, 24576
    s_mul_i32 s73, s48, 64
    s_add_u32 s73, s73, 0
    buffer_load_dwordx4 v214, s[24:27], s73 offen lds
    s_add_u32 m0, s70, 25600
    s_mul_i32 s73, s48, 64
    s_add_u32 s73, s73, 32768
    buffer_load_dwordx4 v214, s[24:27], s73 offen lds
    s_add_u32 m0, s70, 26624
    s_mul_i32 s73, s48, 64
    s_add_u32 s73, s73, 65536
    buffer_load_dwordx4 v214, s[24:27], s73 offen lds
    s_add_u32 m0, s70, 27648
    s_mul_i32 s73, s48, 64
    s_add_u32 s73, s73, 98304
    buffer_load_dwordx4 v214, s[24:27], s73 offen lds
    s_add_u32 m0, s70, 28672
    s_mul_i32 s73, s48, 64
    s_add_u32 s73, s73, 131072
    buffer_load_dwordx4 v214, s[24:27], s73 offen lds
    s_add_u32 m0, s70, 29696
    s_mul_i32 s73, s48, 64
    s_add_u32 s73, s73, 163840
    buffer_load_dwordx4 v214, s[24:27], s73 offen lds
    s_add_u32 m0, s70, 30720
    s_mul_i32 s73, s48, 64
    s_add_u32 s73, s73, 196608
    buffer_load_dwordx4 v214, s[24:27], s73 offen lds
    s_add_u32 m0, s70, 31744
    s_mul_i32 s73, s48, 64
    s_add_u32 s73, s73, 229376
    buffer_load_dwordx4 v214, s[24:27], s73 offen lds
    s_add_u32 m0, s70, 32768
    s_mul_i32 s73, s49, 64
    s_add_u32 s73, s73, 0
    buffer_load_dwordx4 v214, s[24:27], s73 offen lds
    s_add_u32 m0, s70, 33792
    s_mul_i32 s73, s49, 64
    s_add_u32 s73, s73, 32768
    buffer_load_dwordx4 v214, s[24:27], s73 offen lds
    s_add_u32 m0, s70, 34816
    s_mul_i32 s73, s49, 64
    s_add_u32 s73, s73, 65536
    buffer_load_dwordx4 v214, s[24:27], s73 offen lds
    s_add_u32 m0, s70, 35840
    s_mul_i32 s73, s49, 64
    s_add_u32 s73, s73, 98304
    buffer_load_dwordx4 v214, s[24:27], s73 offen lds
    s_lshl_b32 s71, s64, 18
    s_lshl_b32 s86, s3, 15
    s_add_u32 s71, s71, s86
    s_add_u32 s71, s71, 0x200000
    s_add_u32 s72, s71, 0x20000
    s_mul_i32 s58, s66, 229376
    s_add_u32 s58, s58, 0x3c0000
    s_lshl_b32 s86, s65, 2
    s_add_u32 s86, s86, s3
    s_lshl_b32 s86, s86, 10
    s_add_u32 s57, s58, s86
    s_mul_i32 s86, s3, 28672
    s_add_u32 s58, s58, s86
    s_add_u32 s59, s58, 114688
    v_lshrrev_b32 v208, 5, v1
    v_lshlrev_b32 v208, 3, v208
    s_lshl_b32 s86, s65, 7
    s_lshl_b32 s87, s3, 5
    s_add_u32 s86, s86, s87
    buffer_load_dwordx2 v[220:221], v208, s[28:31], s86 offen offset:0
    buffer_load_dwordx2 v[222:223], v208, s[28:31], s86 offen offset:16
    s_lshl_b32 s86, s67, 7
    s_lshr_b32 s87, s3, 1
    s_lshl_b32 s87, s87, 6
    s_add_u32 s86, s86, s87
    buffer_load_dwordx2 v[224:225], v208, s[32:35], s86 offen offset:0
    buffer_load_dwordx2 v[226:227], v208, s[32:35], s86 offen offset:16
    buffer_load_dwordx2 v[228:229], v208, s[32:35], s86 offen offset:32
    buffer_load_dwordx2 v[230:231], v208, s[32:35], s86 offen offset:48
    v_add_u32 v232, s70, v4
    s_xor_b32 s86, s3, 1
    s_mul_i32 s86, s86, 36864
    s_add_u32 s86, s86, 12288
    v_add_u32 v233, s86, v4
    s_xor_b32 s86, s3, 2
    s_mul_i32 s86, s86, 36864
    s_add_u32 s86, s86, 14336
    v_add_u32 v234, s86, v4
    s_xor_b32 s86, s3, 3
    s_mul_i32 s86, s86, 36864
    s_add_u32 s86, s86, 16384
    v_add_u32 v235, s86, v4
    v_lshrrev_b32 v208, 5, v1
    v_lshlrev_b32 v208, 9, v208
    v_and_b32 v209, 31, v1
    v_lshl_add_u32 v208, v209, 2, v208
    s_lshr_b32 s86, s3, 1
    s_lshl_b32 s86, s86, 12
    v_add_u32 v208, s86, v208
    v_xor_b32 v209, 0x1000, v208
    v_add_u32 v236, s70, v208
    v_add_u32 v237, s70, v209
    s_lshl_b32 s86, s3, 11
    s_add_u32 s86, s86, 12288
    v_add_u32 v238, s86, v4
    v_add_u32 v239, 73728, v238
    v_lshrrev_b32 v208, 3, v1
    v_mul_u32_u24 v212, 896, v208
    v_and_b32 v208, 7, v1
    v_lshl_add_u32 v212, v208, 3, v212
    s_lshl_b32 s68, s67, 2
    s_add_u32 s68, s68, s3
    s_mul_i32 s68, s68, 14336
    s_lshl_b32 s86, s66, 7
    s_add_u32 s68, s68, s86
    s_add_u32 s69, s68, 7168
    s_mov_b32 s88, 0xc0135761
    s_mov_b32 s89, 0xc0135761
    s_mov_b32 s90, 0xbdd2d3e8
    s_mov_b32 s91, 0xffff0000
    buffer_load_dword v249, v11, s[40:43], s84 offen sc1
    s_sleep 3
    buffer_load_dword v250, v11, s[40:43], s84 offen sc1
    s_sleep 3
    s_nop 0
Lpoll_P_8:
    s_sub_u32 s6, s6, 1
    s_cbranch_scc1 L_end_P
    buffer_load_dword v251, v11, s[40:43], s84 offen sc1
    s_waitcnt vmcnt(2)
    v_cmp_ne_u32 vcc, s4, v249
    s_nop 1
    s_cbranch_vccz Lpd_P_9
    buffer_load_dword v249, v11, s[40:43], s84 offen sc1
    s_waitcnt vmcnt(2)
    v_cmp_ne_u32 vcc, s4, v250
    s_nop 1
    s_cbranch_vccz Lpd_P_9
    buffer_load_dword v250, v11, s[40:43], s84 offen sc1
    s_waitcnt vmcnt(2)
    v_cmp_ne_u32 vcc, s4, v251
    s_nop 1
    s_cbranch_vccnz Lpoll_P_8
    s_nop 1
Lpd_P_9:
    s_add_u32 s56, s71, s94
    buffer_load_dwordx4 v[80:83], v5, s[40:43], s56 offen offset:0 sc1
    buffer_load_dwordx4 v[84:87], v5, s[40:43], s56 offen offset:1024 sc1
    buffer_load_dwordx4 v[88:91], v5, s[40:43], s56 offen offset:2048 sc1
    buffer_load_dwordx4 v[92:95], v5, s[40:43], s56 offen offset:3072 sc1
    s_add_u32 s56, s71, s95
    buffer_load_dwordx4 v[96:99], v5, s[40:43], s56 offen offset:0 sc1
    buffer_load_dwordx4 v[100:103], v5, s[40:43], s56 offen offset:1024 sc1
    buffer_load_dwordx4 v[104:107], v5, s[40:43], s56 offen offset:2048 sc1
    buffer_load_dwordx4 v[108:111], v5, s[40:43], s56 offen offset:3072 sc1
    v_lshlrev_b32 v16, 16, v220
    v_and_b32 v17, s91, v220
    v_lshlrev_b32 v18, 16, v221
    v_and_b32 v19, s91, v221
    v_lshlrev_b32 v20, 16, v222
    v_and_b32 v21, s91, v222
    v_lshlrev_b32 v22, 16, v223
    v_and_b32 v23, s91, v223
    v_mov_b64 v[24:25], 0
    v_mov_b64 v[26:27], 0
    v_mov_b64 v[28:29], 0
    v_mov_b64 v[30:31], 0
    ds_read_b64_tr_b16 a[80:81], v215 offset:12288
    ds_read_b64_tr_b16 a[82:83], v215 offset:13312
    ds_read_b64_tr_b16 a[84:85], v216 offset:12288
    ds_read_b64_tr_b16 a[86:87], v216 offset:13312
    ds_read_b64_tr_b16 a[88:89], v215 offset:14336
    ds_read_b64_tr_b16 a[90:91], v215 offset:15360
    ds_read_b64_tr_b16 a[92:93], v216 offset:14336
    ds_read_b64_tr_b16 a[94:95], v216 offset:15360
    ds_read_b64_tr_b16 a[96:97], v215 offset:16384
    ds_read_b64_tr_b16 a[98:99], v215 offset:17408
    ds_read_b64_tr_b16 a[100:101], v216 offset:16384
    ds_read_b64_tr_b16 a[102:103], v216 offset:17408
    ds_read_b64_tr_b16 a[104:105], v215 offset:18432
    ds_read_b64_tr_b16 a[106:107], v215 offset:19456
    ds_read_b64_tr_b16 a[108:109], v216 offset:18432
    ds_read_b64_tr_b16 a[110:111], v216 offset:19456
    ds_read_b64_tr_b16 a[112:113], v215 offset:20480
    ds_read_b64_tr_b16 a[114:115], v215 offset:21504
    ds_read_b64_tr_b16 a[116:117], v216 offset:20480
    ds_read_b64_tr_b16 a[118:119], v216 offset:21504
    ds_read_b64_tr_b16 a[120:121], v215 offset:22528
    ds_read_b64_tr_b16 a[122:123], v215 offset:23552
    ds_read_b64_tr_b16 a[124:125], v216 offset:22528
    ds_read_b64_tr_b16 a[126:127], v216 offset:23552
    v_mov_b32 v9, v5
    s_add_u32 s56, s71, s96
    buffer_load_dwordx4 v[112:115], v5, s[40:43], s56 offen offset:0 sc1
    buffer_load_dwordx4 v[116:119], v5, s[40:43], s56 offen offset:1024 sc1
    s_waitcnt vmcnt(9)
    v_mfma_f32_32x32x16_bf16 v[16:31], a[128:131], v[80:83], v[16:31]
    v_mfma_f32_32x32x16_bf16 v[32:47], a[132:135], v[80:83], 0
    buffer_load_dwordx4 v[120:123], v5, s[40:43], s56 offen offset:2048 sc1
    s_waitcnt vmcnt(9)
    v_mfma_f32_32x32x16_bf16 v[16:31], a[136:139], v[84:87], v[16:31]
    v_mfma_f32_32x32x16_bf16 v[32:47], a[140:143], v[84:87], v[32:47]
    buffer_load_dwordx4 v[124:127], v5, s[40:43], s56 offen offset:3072 sc1
    s_waitcnt vmcnt(9)
    v_mfma_f32_32x32x16_bf16 v[16:31], a[144:147], v[88:91], v[16:31]
    v_mfma_f32_32x32x16_bf16 v[32:47], a[148:151], v[88:91], v[32:47]
    s_add_u32 s56, s71, s97
    buffer_load_dwordx4 v[128:131], v5, s[40:43], s56 offen offset:0 sc1
    s_waitcnt vmcnt(9)
    v_mfma_f32_32x32x16_bf16 v[16:31], a[152:155], v[92:95], v[16:31]
    v_mfma_f32_32x32x16_bf16 v[32:47], a[156:159], v[92:95], v[32:47]
    buffer_load_dwordx4 v[132:135], v5, s[40:43], s56 offen offset:1024 sc1
    s_waitcnt vmcnt(9)
    v_mfma_f32_32x32x16_bf16 v[16:31], a[160:163], v[96:99], v[16:31]
    v_mfma_f32_32x32x16_bf16 v[32:47], a[164:167], v[96:99], v[32:47]
    buffer_load_dwordx4 v[136:139], v5, s[40:43], s56 offen offset:2048 sc1
    s_waitcnt vmcnt(9)
    v_mfma_f32_32x32x16_bf16 v[16:31], a[168:171], v[100:103], v[16:31]
    v_mfma_f32_32x32x16_bf16 v[32:47], a[172:175], v[100:103], v[32:47]
    buffer_load_dwordx4 v[140:143], v5, s[40:43], s56 offen offset:3072 sc1
    s_waitcnt vmcnt(9)
    v_mfma_f32_32x32x16_bf16 v[16:31], a[176:179], v[104:107], v[16:31]
    v_mfma_f32_32x32x16_bf16 v[32:47], a[180:183], v[104:107], v[32:47]
    s_add_u32 s56, s71, s98
    buffer_load_dwordx4 v[144:147], v5, s[40:43], s56 offen offset:0 sc1
    s_waitcnt vmcnt(9)
    v_mfma_f32_32x32x16_bf16 v[16:31], a[184:187], v[108:111], v[16:31]
    v_mfma_f32_32x32x16_bf16 v[32:47], a[188:191], v[108:111], v[32:47]
    buffer_load_dwordx4 v[148:151], v5, s[40:43], s56 offen offset:1024 sc1
    s_waitcnt vmcnt(9)
    v_mfma_f32_32x32x16_bf16 v[16:31], a[192:195], v[112:115], v[16:31]
    v_mfma_f32_32x32x16_bf16 v[32:47], a[196:199], v[112:115], v[32:47]
    buffer_load_dwordx4 v[152:155], v5, s[40:43], s56 offen offset:2048 sc1
    s_waitcnt vmcnt(9)
    v_mfma_f32_32x32x16_bf16 v[16:31], a[200:203], v[116:119], v[16:31]
    v_mfma_f32_32x32x16_bf16 v[32:47], a[204:207], v[116:119], v[32:47]
    buffer_load_dwordx4 v[156:159], v5, s[40:43], s56 offen offset:3072 sc1
    s_waitcnt vmcnt(9)
    v_mfma_f32_32x32x16_bf16 v[16:31], a[208:211], v[120:123], v[16:31]
    v_mfma_f32_32x32x16_bf16 v[32:47], a[212:215], v[120:123], v[32:47]
    s_add_u32 s56, s71, s99
    buffer_load_dwordx4 v[160:163], v5, s[40:43], s56 offen offset:0 sc1
    s_waitcnt vmcnt(9)
    v_mfma_f32_32x32x16_bf16 v[16:31], a[216:219], v[124:127], v[16:31]
    v_mfma_f32_32x32x16_bf16 v[32:47], a[220:223], v[124:127], v[32:47]
    buffer_load_dwordx4 v[164:167], v5, s[40:43], s56 offen offset:1024 sc1
    s_waitcnt vmcnt(9)
    v_mfma_f32_32x32x16_bf16 v[16:31], a[224:227], v[128:131], v[16:31]
    v_mfma_f32_32x32x16_bf16 v[32:47], a[228:231], v[128:131], v[32:47]
    buffer_load_dwordx4 v[168:171], v5, s[40:43], s56 offen offset:2048 sc1
    s_waitcnt vmcnt(9)
    v_mfma_f32_32x32x16_bf16 v[16:31], a[232:235], v[132:135], v[16:31]
    v_mfma_f32_32x32x16_bf16 v[32:47], a[236:239], v[132:135], v[32:47]
    buffer_load_dwordx4 v[172:175], v5, s[40:43], s56 offen offset:3072 sc1
    s_waitcnt vmcnt(9)
    v_mfma_f32_32x32x16_bf16 v[16:31], a[240:243], v[136:139], v[16:31]
    v_mfma_f32_32x32x16_bf16 v[32:47], a[244:247], v[136:139], v[32:47]
    s_add_u32 s56, s71, s100
    buffer_load_dwordx4 v[176:179], v5, s[40:43], s56 offen offset:0 sc1
    s_waitcnt vmcnt(9)
    v_mfma_f32_32x32x16_bf16 v[16:31], a[248:251], v[140:143], v[16:31]
    v_mfma_f32_32x32x16_bf16 v[32:47], a[252:255], v[140:143], v[32:47]
    buffer_load_dwordx4 v[180:183], v5, s[40:43], s56 offen offset:1024 sc1
    s_waitcnt vmcnt(9)
    v_mfma_f32_32x32x16_bf16 v[16:31], a[0:3], v[144:147], v[16:31]
    v_mfma_f32_32x32x16_bf16 v[32:47], a[4:7], v[144:147], v[32:47]
    s_barrier
    buffer_load_dwordx4 v[184:187], v5, s[40:43], s56 offen offset:2048 sc1
    s_waitcnt vmcnt(9)
    v_mfma_f32_32x32x16_bf16 v[16:31], a[8:11], v[148:151], v[16:31]
    v_mfma_f32_32x32x16_bf16 v[32:47], a[12:15], v[148:151], v[32:47]
    buffer_load_dwordx4 v[188:191], v5, s[40:43], s56 offen offset:3072 sc1
    s_waitcnt vmcnt(9)
    v_mfma_f32_32x32x16_bf16 v[16:31], a[16:19], v[152:155], v[16:31]
    v_mfma_f32_32x32x16_bf16 v[32:47], a[20:23], v[152:155], v[32:47]
    s_add_u32 s56, s71, s101
    buffer_load_dwordx4 v[192:195], v5, s[40:43], s56 offen offset:0 sc1
    s_waitcnt vmcnt(9)
    v_mfma_f32_32x32x16_bf16 v[16:31], a[24:27], v[156:159], v[16:31]
    v_mfma_f32_32x32x16_bf16 v[32:47], a[28:31], v[156:159], v[32:47]
    buffer_load_dwordx4 v[196:199], v5, s[40:43], s56 offen offset:1024 sc1
    s_waitcnt vmcnt(9)
    v_mfma_f32_32x32x16_bf16 v[16:31], a[32:35], v[160:163], v[16:31]
    v_mfma_f32_32x32x16_bf16 v[32:47], a[36:39], v[160:163], v[32:47]
    v_lshlrev_b32 v48, 16, v220
    v_and_b32 v49, s91, v220
    v_lshlrev_b32 v50, 16, v221
    v_and_b32 v51, s91, v221
    buffer_load_dwordx4 v[200:203], v5, s[40:43], s56 offen offset:2048 sc1
    s_waitcnt vmcnt(9)
    v_mfma_f32_32x32x16_bf16 v[16:31], a[40:43], v[164:167], v[16:31]
    v_mfma_f32_32x32x16_bf16 v[32:47], a[44:47], v[164:167], v[32:47]
    v_lshlrev_b32 v52, 16, v222
    v_and_b32 v53, s91, v222
    v_lshlrev_b32 v54, 16, v223
    v_and_b32 v55, s91, v223
    buffer_load_dwordx4 v[204:207], v5, s[40:43], s56 offen offset:3072 sc1
    s_waitcnt vmcnt(9)
    v_mfma_f32_32x32x16_bf16 v[16:31], a[48:51], v[168:171], v[16:31]
    v_mfma_f32_32x32x16_bf16 v[32:47], a[52:55], v[168:171], v[32:47]
    v_mov_b64 v[56:57], 0
    v_mov_b64 v[58:59], 0
    v_mov_b64 v[60:61], 0
    v_mov_b64 v[62:63], 0
    s_add_u32 s56, s72, s94
    buffer_load_dwordx4 v[80:83], v5, s[40:43], s56 offen offset:0 sc1
    s_waitcnt vmcnt(9)
    v_mfma_f32_32x32x16_bf16 v[16:31], a[56:59], v[172:175], v[16:31]
    v_mfma_f32_32x32x16_bf16 v[32:47], a[60:63], v[172:175], v[32:47]
    buffer_load_dwordx4 v[84:87], v5, s[40:43], s56 offen offset:1024 sc1
    s_waitcnt vmcnt(9)
    v_mfma_f32_32x32x16_bf16 v[16:31], a[64:67], v[176:179], v[16:31]
    v_mfma_f32_32x32x16_bf16 v[32:47], a[68:71], v[176:179], v[32:47]
    s_waitcnt lgkmcnt(15)
    s_add_u32 m0, s70, 12288
    s_mul_i32 s73, s49, 64
    s_add_u32 s73, s73, 131072
    buffer_load_dwordx4 v214, s[24:27], s73 offen lds
    s_add_u32 m0, s70, 13312
    s_mul_i32 s73, s49, 64
    s_add_u32 s73, s73, 163840
    buffer_load_dwordx4 v214, s[24:27], s73 offen lds
    buffer_load_dwordx4 v[88:91], v5, s[40:43], s56 offen offset:2048 sc1
    s_waitcnt vmcnt(11)
    v_mfma_f32_32x32x16_bf16 v[16:31], a[72:75], v[180:183], v[16:31]
    v_mfma_f32_32x32x16_bf16 v[32:47], a[76:79], v[180:183], v[32:47]
    s_add_u32 m0, s70, 14336
    s_mul_i32 s73, s49, 64
    s_add_u32 s73, s73, 196608
    buffer_load_dwordx4 v214, s[24:27], s73 offen lds
    s_add_u32 m0, s70, 15360
    s_mul_i32 s73, s49, 64
    s_add_u32 s73, s73, 229376
    buffer_load_dwordx4 v214, s[24:27], s73 offen lds
    buffer_load_dwordx4 v[92:95], v5, s[40:43], s56 offen offset:3072 sc1
    s_waitcnt vmcnt(13)
    v_mfma_f32_32x32x16_bf16 v[16:31], a[80:83], v[184:187], v[16:31]
    v_mfma_f32_32x32x16_bf16 v[32:47], a[84:87], v[184:187], v[32:47]
    s_waitcnt lgkmcnt(12)
    s_add_u32 m0, s70, 16384
    s_mul_i32 s73, s50, 64
    s_add_u32 s73, s73, 0
    buffer_load_dwordx4 v214, s[24:27], s73 offen lds
    s_add_u32 m0, s70, 17408
    s_mul_i32 s73, s50, 64
    s_add_u32 s73, s73, 32768
    buffer_load_dwordx4 v214, s[24:27], s73 offen lds
    s_add_u32 s56, s72, s95
    buffer_load_dwordx4 v[96:99], v5, s[40:43], s56 offen offset:0 sc1
    s_waitcnt vmcnt(15)
    v_mfma_f32_32x32x16_bf16 v[16:31], a[88:91], v[188:191], v[16:31]
    v_mfma_f32_32x32x16_bf16 v[32:47], a[92:95], v[188:191], v[32:47]
    s_waitcnt lgkmcnt(8)
    s_add_u32 m0, s70, 18432
    s_mul_i32 s73, s50, 64
    s_add_u32 s73, s73, 65536
    buffer_load_dwordx4 v214, s[24:27], s73 offen lds
    s_add_u32 m0, s70, 19456
    s_mul_i32 s73, s50, 64
    s_add_u32 s73, s73, 98304
    buffer_load_dwordx4 v214, s[24:27], s73 offen lds
    buffer_load_dwordx4 v[100:103], v5, s[40:43], s56 offen offset:1024 sc1
    s_waitcnt vmcnt(17)
    v_mfma_f32_32x32x16_bf16 v[16:31], a[96:99], v[192:195], v[16:31]
    v_mfma_f32_32x32x16_bf16 v[32:47], a[100:103], v[192:195], v[32:47]
    s_waitcnt lgkmcnt(4)
    s_add_u32 m0, s70, 20480
    s_mul_i32 s73, s50, 64
    s_add_u32 s73, s73, 131072
    buffer_load_dwordx4 v214, s[24:27], s73 offen lds
    s_add_u32 m0, s70, 21504
    s_mul_i32 s73, s50, 64
    s_add_u32 s73, s73, 163840
    buffer_load_dwordx4 v214, s[24:27], s73 offen lds
    buffer_load_dwordx4 v[104:107], v5, s[40:43], s56 offen offset:2048 sc1
    s_waitcnt vmcnt(19)
    v_mfma_f32_32x32x16_bf16 v[16:31], a[104:107], v[196:199], v[16:31]
    v_mfma_f32_32x32x16_bf16 v[32:47], a[108:111], v[196:199], v[32:47]
    s_waitcnt lgkmcnt(0)
    s_add_u32 m0, s70, 22528
    s_mul_i32 s73, s50, 64
    s_add_u32 s73, s73, 196608
    buffer_load_dwordx4 v214, s[24:27], s73 offen lds
    s_add_u32 m0, s70, 23552
    s_mul_i32 s73, s50, 64
    s_add_u32 s73, s73, 229376
    buffer_load_dwordx4 v214, s[24:27], s73 offen lds
    buffer_load_dwordx4 v[108:111], v5, s[40:43], s56 offen offset:3072 sc1
    s_waitcnt vmcnt(21)
    v_mfma_f32_32x32x16_bf16 v[16:31], a[112:115], v[200:203], v[16:31]
    v_mfma_f32_32x32x16_bf16 v[32:47], a[116:119], v[200:203], v[32:47]
    s_add_u32 s56, s72, s96
    buffer_load_dwordx4 v[112:115], v5, s[40:43], s56 offen offset:0 sc1
    s_waitcnt vmcnt(21)
    v_mfma_f32_32x32x16_bf16 v[16:31], a[120:123], v[204:207], v[16:31]
    v_mfma_f32_32x32x16_bf16 v[32:47], a[124:127], v[204:207], v[32:47]
    buffer_load_dwordx4 v[116:119], v5, s[40:43], s56 offen offset:1024 sc1
    s_waitcnt vmcnt(21)
    v_mfma_f32_32x32x16_bf16 v[48:63], a[128:131], v[80:83], v[48:63]
    v_mfma_f32_32x32x16_bf16 v[64:79], a[132:135], v[80:83], 0
    s_nop 7
    ds_write_b128 v235, v[40:43] offset:0
    ds_write_b128 v235, v[44:47] offset:1024
    ds_write_b128 v234, v[32:35] offset:0
    buffer_load_dwordx4 v[120:123], v5, s[40:43], s56 offen offset:2048 sc1
    s_waitcnt vmcnt(21)
    v_mfma_f32_32x32x16_bf16 v[48:63], a[136:139], v[84:87], v[48:63]
    v_mfma_f32_32x32x16_bf16 v[64:79], a[140:143], v[84:87], v[64:79]
    ds_write_b128 v234, v[36:39] offset:1024
    ds_write_b128 v233, v[24:27] offset:0
    ds_write_b128 v233, v[28:31] offset:1024
    buffer_load_dwordx4 v[124:127], v5, s[40:43], s56 offen offset:3072 sc1
    s_waitcnt vmcnt(19)
    v_mfma_f32_32x32x16_bf16 v[48:63], a[144:147], v[88:91], v[48:63]
    v_mfma_f32_32x32x16_bf16 v[64:79], a[148:151], v[88:91], v[64:79]
    s_waitcnt lgkmcnt(0)
    s_barrier
    ds_read_b128 v[24:27], v232 offset:0
    ds_read_b128 v[32:35], v232 offset:2048
    ds_read_b128 v[40:43], v232 offset:4096
    ds_read_b128 v[28:31], v232 offset:1024
    ds_read_b128 v[36:39], v232 offset:3072
    ds_read_b128 v[44:47], v232 offset:5120
    s_add_u32 s56, s72, s97
    buffer_load_dwordx4 v[128:131], v5, s[40:43], s56 offen offset:0 sc1
    s_waitcnt vmcnt(17)
    v_mfma_f32_32x32x16_bf16 v[48:63], a[152:155], v[92:95], v[48:63]
    v_mfma_f32_32x32x16_bf16 v[64:79], a[156:159], v[92:95], v[64:79]
    buffer_load_dwordx4 v[132:135], v5, s[40:43], s56 offen offset:1024 sc1
    s_waitcnt vmcnt(15)
    v_mfma_f32_32x32x16_bf16 v[48:63], a[160:163], v[96:99], v[48:63]
    v_mfma_f32_32x32x16_bf16 v[64:79], a[164:167], v[96:99], v[64:79]
    v_mov_b32 v211, s88
    s_waitcnt lgkmcnt(4)
    v_add_f32 v24, v24, v32
    s_waitcnt lgkmcnt(3)
    v_add_f32 v16, v16, v40
    v_add_f32 v25, v25, v33
    v_add_f32 v17, v17, v41
    v_add_f32 v26, v26, v34
    v_add_f32 v18, v18, v42
    v_add_f32 v27, v27, v35
    v_add_f32 v19, v19, v43
    s_waitcnt lgkmcnt(1)
    v_add_f32 v28, v28, v36
    s_waitcnt lgkmcnt(0)
    v_add_f32 v20, v20, v44
    v_add_f32 v29, v29, v37
    v_add_f32 v21, v21, v45
    v_add_f32 v30, v30, v38
    v_add_f32 v22, v22, v46
    v_add_f32 v31, v31, v39
    buffer_load_dwordx4 v[136:139], v5, s[40:43], s56 offen offset:2048 sc1
    s_waitcnt vmcnt(13)
    v_mfma_f32_32x32x16_bf16 v[48:63], a[168:171], v[100:103], v[48:63]
    v_mfma_f32_32x32x16_bf16 v[64:79], a[172:175], v[100:103], v[64:79]
    v_add_f32 v23, v23, v47
    v_add_f32 v16, v16, v24
    v_add_f32 v17, v17, v25
    v_add_f32 v18, v18, v26
    v_add_f32 v19, v19, v27
    v_add_f32 v20, v20, v28
    v_add_f32 v21, v21, v29
    v_add_f32 v22, v22, v30
    v_add_f32 v23, v23, v31
    v_mul_f32 v24, v16, v16
    v_mul_f32 v25, v17, v17
    v_mul_f32 v26, v18, v18
    v_mul_f32 v27, v19, v19
    v_mul_f32 v28, v20, v20
    v_mul_f32 v29, v21, v21
    v_mul_f32 v30, v22, v22
    buffer_load_dwordx4 v[140:143], v5, s[40:43], s56 offen offset:3072 sc1
    s_waitcnt vmcnt(11)
    v_mfma_f32_32x32x16_bf16 v[48:63], a[176:179], v[104:107], v[48:63]
    v_mfma_f32_32x32x16_bf16 v[64:79], a[180:183], v[104:107], v[64:79]
    v_mul_f32 v31, v23, v23
    v_fma_f32 v24, v24, s90, v211
    v_fma_f32 v25, v25, s90, v211
    v_fma_f32 v26, v26, s90, v211
    v_fma_f32 v27, v27, s90, v211
    v_fma_f32 v28, v28, s90, v211
    v_fma_f32 v29, v29, s90, v211
    v_fma_f32 v30, v30, s90, v211
    v_fma_f32 v31, v31, s90, v211
    v_mul_f32 v24, v24, v16
    v_mul_f32 v25, v25, v17
    v_mul_f32 v26, v26, v18
    v_mul_f32 v27, v27, v19
    v_mul_f32 v28, v28, v20
    v_mul_f32 v29, v29, v21
    v_mul_f32 v30, v30, v22
    s_add_u32 s56, s72, s98
    buffer_load_dwordx4 v[144:147], v5, s[40:43], s56 offen offset:0 sc1
    s_waitcnt vmcnt(9)
    v_mfma_f32_32x32x16_bf16 v[48:63], a[184:187], v[108:111], v[48:63]
    v_mfma_f32_32x32x16_bf16 v[64:79], a[188:191], v[108:111], v[64:79]
    v_mul_f32 v31, v31, v23
    v_exp_f32 v24, v24
    v_exp_f32 v25, v25
    v_exp_f32 v26, v26
    v_exp_f32 v27, v27
    v_exp_f32 v28, v28
    v_exp_f32 v29, v29
    v_exp_f32 v30, v30
    v_exp_f32 v31, v31
    v_add_f32 v24, 1.0, v24
    v_add_f32 v25, 1.0, v25
    v_add_f32 v26, 1.0, v26
    v_add_f32 v27, 1.0, v27
    v_add_f32 v28, 1.0, v28
    v_add_f32 v29, 1.0, v29
    v_add_f32 v30, 1.0, v30
    ds_read_b64_tr_b16 a[128:129], v217 offset:24576
    ds_read_b64_tr_b16 a[130:131], v217 offset:25600
    ds_read_b64_tr_b16 a[132:133], v218 offset:24576
    ds_read_b64_tr_b16 a[134:135], v218 offset:25600
    ds_read_b64_tr_b16 a[136:137], v217 offset:26624
    ds_read_b64_tr_b16 a[138:139], v217 offset:27648
    ds_read_b64_tr_b16 a[140:141], v218 offset:26624
    ds_read_b64_tr_b16 a[142:143], v218 offset:27648
    buffer_load_dwordx4 v[148:151], v5, s[40:43], s56 offen offset:1024 sc1
    s_waitcnt vmcnt(9)
    v_mfma_f32_32x32x16_bf16 v[48:63], a[192:195], v[112:115], v[48:63]
    v_mfma_f32_32x32x16_bf16 v[64:79], a[196:199], v[112:115], v[64:79]
    v_add_f32 v31, 1.0, v31
    v_rcp_f32 v24, v24
    v_rcp_f32 v25, v25
    v_rcp_f32 v26, v26
    v_rcp_f32 v27, v27
    v_rcp_f32 v28, v28
    v_rcp_f32 v29, v29
    v_rcp_f32 v30, v30
    v_rcp_f32 v31, v31
    v_mul_f32 v24, v24, v16
    v_mul_f32 v25, v25, v17
    v_mul_f32 v26, v26, v18
    v_mul_f32 v27, v27, v19
    v_mul_f32 v28, v28, v20
    v_mul_f32 v29, v29, v21
    v_mul_f32 v30, v30, v22
    ds_read_b64_tr_b16 a[144:145], v217 offset:28672
    ds_read_b64_tr_b16 a[146:147], v217 offset:29696
    ds_read_b64_tr_b16 a[148:149], v218 offset:28672
    ds_read_b64_tr_b16 a[150:151], v218 offset:29696
    ds_read_b64_tr_b16 a[152:153], v217 offset:30720
    ds_read_b64_tr_b16 a[154:155], v217 offset:31744
    ds_read_b64_tr_b16 a[156:157], v218 offset:30720
    ds_read_b64_tr_b16 a[158:159], v218 offset:31744
    buffer_load_dwordx4 v[152:155], v5, s[40:43], s56 offen offset:2048 sc1
    s_waitcnt vmcnt(9)
    v_mfma_f32_32x32x16_bf16 v[48:63], a[200:203], v[116:119], v[48:63]
    v_mfma_f32_32x32x16_bf16 v[64:79], a[204:207], v[116:119], v[64:79]
    v_mul_f32 v31, v31, v23
    v_cvt_pk_bf16_f32 v32, v24, v25
    v_cvt_pk_bf16_f32 v33, v26, v27
    v_cvt_pk_bf16_f32 v34, v28, v29
    v_cvt_pk_bf16_f32 v35, v30, v31
    buffer_store_dwordx4 v[32:35], v5, s[40:43], s57 offen sc1
    ds_read_b64_tr_b16 a[160:161], v217 offset:32768
    ds_read_b64_tr_b16 a[162:163], v217 offset:33792
    ds_read_b64_tr_b16 a[164:165], v218 offset:32768
    ds_read_b64_tr_b16 a[166:167], v218 offset:33792
    ds_read_b64_tr_b16 a[168:169], v217 offset:34816
    ds_read_b64_tr_b16 a[170:171], v217 offset:35840
    ds_read_b64_tr_b16 a[172:173], v218 offset:34816
    ds_read_b64_tr_b16 a[174:175], v218 offset:35840
    buffer_load_dwordx4 v[156:159], v5, s[40:43], s56 offen offset:3072 sc1
    s_waitcnt vmcnt(10)
    v_mfma_f32_32x32x16_bf16 v[48:63], a[208:211], v[120:123], v[48:63]
    v_mfma_f32_32x32x16_bf16 v[64:79], a[212:215], v[120:123], v[64:79]
    ds_read_b64_tr_b16 a[176:177], v217 offset:12288
    ds_read_b64_tr_b16 a[178:179], v217 offset:13312
    ds_read_b64_tr_b16 a[180:181], v218 offset:12288
    ds_read_b64_tr_b16 a[182:183], v218 offset:13312
    ds_read_b64_tr_b16 a[184:185], v217 offset:14336
    ds_read_b64_tr_b16 a[186:187], v217 offset:15360
    ds_read_b64_tr_b16 a[188:189], v218 offset:14336
    ds_read_b64_tr_b16 a[190:191], v218 offset:15360
    s_and_b32 s60, s3, 1
    s_cmp_eq_u32 s60, 0
    s_cselect_b32 s60, 1.0, 0
    v_lshlrev_b32 v16, 16, v224
    v_and_b32 v17, s91, v224
    v_lshlrev_b32 v208, 16, v240
    v_and_b32 v209, s91, v240
    v_add_f32 v16, v16, v208
    s_add_u32 s56, s72, s99
    buffer_load_dwordx4 v[160:163], v5, s[40:43], s56 offen offset:0 sc1
    s_waitcnt vmcnt(10)
    v_mfma_f32_32x32x16_bf16 v[48:63], a[216:219], v[124:127], v[48:63]
    v_mfma_f32_32x32x16_bf16 v[64:79], a[220:223], v[124:127], v[64:79]
    ds_read_b64_tr_b16 a[192:193], v217 offset:16384
    ds_read_b64_tr_b16 a[194:195], v217 offset:17408
    ds_read_b64_tr_b16 a[196:197], v218 offset:16384
    ds_read_b64_tr_b16 a[198:199], v218 offset:17408
    ds_read_b64_tr_b16 a[200:201], v217 offset:18432
    ds_read_b64_tr_b16 a[202:203], v217 offset:19456
    ds_read_b64_tr_b16 a[204:205], v218 offset:18432
    ds_read_b64_tr_b16 a[206:207], v218 offset:19456
    v_add_f32 v17, v17, v209
    v_mul_f32 v16, s60, v16
    v_mul_f32 v17, s60, v17
    v_lshlrev_b32 v18, 16, v225
    v_and_b32 v19, s91, v225
    v_lshlrev_b32 v210, 16, v241
    buffer_load_dwordx4 v[164:167], v5, s[40:43], s56 offen offset:1024 sc1
    s_waitcnt vmcnt(10)
    v_mfma_f32_32x32x16_bf16 v[48:63], a[224:227], v[128:131], v[48:63]
    v_mfma_f32_32x32x16_bf16 v[64:79], a[228:231], v[128:131], v[64:79]
    ds_read_b64_tr_b16 a[208:209], v217 offset:20480
    ds_read_b64_tr_b16 a[210:211], v217 offset:21504
    ds_read_b64_tr_b16 a[212:213], v218 offset:20480
    ds_read_b64_tr_b16 a[214:215], v218 offset:21504
    ds_read_b64_tr_b16 a[216:217], v217 offset:22528
    ds_read_b64_tr_b16 a[218:219], v217 offset:23552
    ds_read_b64_tr_b16 a[220:221], v218 offset:22528
    ds_read_b64_tr_b16 a[222:223], v218 offset:23552
    s_waitcnt lgkmcnt(15)
    s_add_u32 m0, s70, 24576
    s_mul_i32 s73, s51, 64
    s_add_u32 s73, s73, 0
    buffer_load_dwordx4 v214, s[24:27], s73 offen lds
    s_add_u32 m0, s70, 25600
    s_mul_i32 s73, s51, 64
    s_add_u32 s73, s73, 32768
    buffer_load_dwordx4 v214, s[24:27], s73 offen lds
    v_and_b32 v211, s91, v241
    v_add_f32 v18, v18, v210
    v_add_f32 v19, v19, v211
    v_mul_f32 v18, s60, v18
    v_mul_f32 v19, s60, v19
    v_lshlrev_b32 v20, 16, v226
    buffer_load_dwordx4 v[168:171], v5, s[40:43], s56 offen offset:2048 sc1
    s_waitcnt vmcnt(12)
    v_mfma_f32_32x32x16_bf16 v[48:63], a[232:235], v[132:135], v[48:63]
    v_mfma_f32_32x32x16_bf16 v[64:79], a[236:239], v[132:135], v[64:79]
    s_waitcnt vmcnt(6)
    v_mov_b32 v8, s4
    s_mov_b64 exec, 1
    buffer_store_dword v8, v9, s[40:43], s82 offen sc1
    s_mov_b64 exec, -1
    s_add_u32 m0, s70, 26624
    s_mul_i32 s73, s51, 64
    s_add_u32 s73, s73, 65536
    buffer_load_dwordx4 v214, s[24:27], s73 offen lds
    s_add_u32 m0, s70, 27648
    s_mul_i32 s73, s51, 64
    s_add_u32 s73, s73, 98304
    buffer_load_dwordx4 v214, s[24:27], s73 offen lds
    v_and_b32 v21, s91, v226
    v_lshlrev_b32 v208, 16, v242
    v_and_b32 v209, s91, v242
    v_add_f32 v20, v20, v208
    v_add_f32 v21, v21, v209
    v_mul_f32 v20, s60, v20
    buffer_load_dwordx4 v[172:175], v5, s[40:43], s56 offen offset:3072 sc1
    v_mfma_f32_32x32x16_bf16 v[48:63], a[240:243], v[136:139], v[48:63]
    v_mfma_f32_32x32x16_bf16 v[64:79], a[244:247], v[136:139], v[64:79]
    s_add_u32 m0, s70, 28672
    s_mul_i32 s73, s51, 64
    s_add_u32 s73, s73, 131072
    buffer_load_dwordx4 v214, s[24:27], s73 offen lds
    s_add_u32 m0, s70, 29696
    s_mul_i32 s73, s51, 64
    s_add_u32 s73, s73, 163840
    buffer_load_dwordx4 v214, s[24:27], s73 offen lds
    v_mul_f32 v21, s60, v21
    v_lshlrev_b32 v22, 16, v227
    v_and_b32 v23, s91, v227
    v_lshlrev_b32 v210, 16, v243
    v_and_b32 v211, s91, v243
    v_add_f32 v22, v22, v210
    s_add_u32 s56, s72, s100
    buffer_load_dwordx4 v[176:179], v5, s[40:43], s56 offen offset:0 sc1
    v_mfma_f32_32x32x16_bf16 v[48:63], a[248:251], v[140:143], v[48:63]
    v_mfma_f32_32x32x16_bf16 v[64:79], a[252:255], v[140:143], v[64:79]
    s_add_u32 m0, s70, 30720
    s_mul_i32 s73, s51, 64
    s_add_u32 s73, s73, 196608
    buffer_load_dwordx4 v214, s[24:27], s73 offen lds
    s_add_u32 m0, s70, 31744
    s_mul_i32 s73, s51, 64
    s_add_u32 s73, s73, 229376
    buffer_load_dwordx4 v214, s[24:27], s73 offen lds
    v_add_f32 v23, v23, v211
    v_mul_f32 v22, s60, v22
    v_mul_f32 v23, s60, v23
    v_lshlrev_b32 v24, 16, v228
    v_and_b32 v25, s91, v228
    v_lshlrev_b32 v208, 16, v244
    buffer_load_dwordx4 v[180:183], v5, s[40:43], s56 offen offset:1024 sc1
    v_mfma_f32_32x32x16_bf16 v[48:63], a[0:3], v[144:147], v[48:63]
    v_mfma_f32_32x32x16_bf16 v[64:79], a[4:7], v[144:147], v[64:79]
    s_add_u32 m0, s70, 32768
    s_mul_i32 s73, s52, 64
    s_add_u32 s73, s73, 0
    buffer_load_dwordx4 v214, s[24:27], s73 offen lds
    s_add_u32 m0, s70, 33792
    s_mul_i32 s73, s52, 64
    s_add_u32 s73, s73, 32768
    buffer_load_dwordx4 v214, s[24:27], s73 offen lds
    v_and_b32 v209, s91, v244
    v_add_f32 v24, v24, v208
    v_add_f32 v25, v25, v209
    v_mul_f32 v24, s60, v24
    v_mul_f32 v25, s60, v25
    v_lshlrev_b32 v26, 16, v229
    buffer_load_dwordx4 v[184:187], v5, s[40:43], s56 offen offset:2048 sc1
    v_mfma_f32_32x32x16_bf16 v[48:63], a[8:11], v[148:151], v[48:63]
    v_mfma_f32_32x32x16_bf16 v[64:79], a[12:15], v[148:151], v[64:79]
    s_add_u32 m0, s70, 34816
    s_mul_i32 s73, s52, 64
    s_add_u32 s73, s73, 65536
    buffer_load_dwordx4 v214, s[24:27], s73 offen lds
    s_add_u32 m0, s70, 35840
    s_mul_i32 s73, s52, 64
    s_add_u32 s73, s73, 98304
    buffer_load_dwordx4 v214, s[24:27], s73 offen lds
    v_and_b32 v27, s91, v229
    v_lshlrev_b32 v210, 16, v245
    v_and_b32 v211, s91, v245
    v_add_f32 v26, v26, v210
    v_add_f32 v27, v27, v211
    v_mul_f32 v26, s60, v26
    buffer_load_dwordx4 v[188:191], v5, s[40:43], s56 offen offset:3072 sc1
    v_mfma_f32_32x32x16_bf16 v[48:63], a[16:19], v[152:155], v[48:63]
    v_mfma_f32_32x32x16_bf16 v[64:79], a[20:23], v[152:155], v[64:79]
    s_add_u32 m0, s70, 12288
    s_mul_i32 s73, s52, 64
    s_add_u32 s73, s73, 131072
    buffer_load_dwordx4 v214, s[24:27], s73 offen lds
    s_add_u32 m0, s70, 13312
    s_mul_i32 s73, s52, 64
    s_add_u32 s73, s73, 163840
    buffer_load_dwordx4 v214, s[24:27], s73 offen lds
    v_mul_f32 v27, s60, v27
    v_lshlrev_b32 v28, 16, v230
    v_and_b32 v29, s91, v230
    v_lshlrev_b32 v208, 16, v246
    v_and_b32 v209, s91, v246
    v_add_f32 v28, v28, v208
    buffer_load_dword v248, v12, s[40:43], s85 offen offset:0 sc1
    s_add_u32 s56, s72, s101
    buffer_load_dwordx4 v[192:195], v5, s[40:43], s56 offen offset:0 sc1
    s_waitcnt vmcnt(25)
    v_mfma_f32_32x32x16_bf16 v[48:63], a[24:27], v[156:159], v[48:63]
    v_mfma_f32_32x32x16_bf16 v[64:79], a[28:31], v[156:159], v[64:79]
    s_add_u32 m0, s70, 14336
    s_mul_i32 s73, s52, 64
    s_add_u32 s73, s73, 196608
    buffer_load_dwordx4 v214, s[24:27], s73 offen lds
    s_add_u32 m0, s70, 15360
    s_mul_i32 s73, s52, 64
    s_add_u32 s73, s73, 229376
    buffer_load_dwordx4 v214, s[24:27], s73 offen lds
    v_add_f32 v29, v29, v209
    v_mul_f32 v28, s60, v28
    v_mul_f32 v29, s60, v29
    v_lshlrev_b32 v30, 16, v231
    v_and_b32 v31, s91, v231
    v_lshlrev_b32 v210, 16, v247
    buffer_load_dwordx4 v[196:199], v5, s[40:43], s56 offen offset:1024 sc1
    s_waitcnt vmcnt(27)
    v_mfma_f32_32x32x16_bf16 v[48:63], a[32:35], v[160:163], v[48:63]
    v_mfma_f32_32x32x16_bf16 v[64:79], a[36:39], v[160:163], v[64:79]
    s_waitcnt vmcnt(24)
    ds_read_b64_tr_b16 a[224:225], v217 offset:24576
    ds_read_b64_tr_b16 a[226:227], v217 offset:25600
    ds_read_b64_tr_b16 a[228:229], v218 offset:24576
    ds_read_b64_tr_b16 a[230:231], v218 offset:25600
    v_and_b32 v211, s91, v247
    v_add_f32 v30, v30, v210
    v_add_f32 v31, v31, v211
    v_mul_f32 v30, s60, v30
    v_mul_f32 v31, s60, v31
    buffer_load_dwordx4 v[200:203], v5, s[40:43], s56 offen offset:2048 sc1
    v_mfma_f32_32x32x16_bf16 v[48:63], a[40:43], v[164:167], v[48:63]
    v_mfma_f32_32x32x16_bf16 v[64:79], a[44:47], v[164:167], v[64:79]
    s_waitcnt vmcnt(21)
    ds_read_b64_tr_b16 a[232:233], v217 offset:26624
    ds_read_b64_tr_b16 a[234:235], v217 offset:27648
    ds_read_b64_tr_b16 a[236:237], v218 offset:26624
    ds_read_b64_tr_b16 a[238:239], v218 offset:27648
    buffer_load_dwordx4 v[204:207], v5, s[40:43], s56 offen offset:3072 sc1
    v_mfma_f32_32x32x16_bf16 v[48:63], a[48:51], v[168:171], v[48:63]
    v_mfma_f32_32x32x16_bf16 v[64:79], a[52:55], v[168:171], v[64:79]
    s_waitcnt vmcnt(19)
    ds_read_b64_tr_b16 a[240:241], v217 offset:28672
    ds_read_b64_tr_b16 a[242:243], v217 offset:29696
    ds_read_b64_tr_b16 a[244:245], v218 offset:28672
    ds_read_b64_tr_b16 a[246:247], v218 offset:29696
    s_waitcnt vmcnt(6)
    v_cmp_ne_u32 vcc, s4, v248
    s_nop 1
    s_cbranch_vccz Lpcd_P_11
    s_nop 1
Lpc_P_10:
    s_sub_u32 s6, s6, 1
    s_cbranch_scc1 L_end_P
    buffer_load_dword v248, v12, s[40:43], s85 offen offset:0 sc1
    s_waitcnt vmcnt(0)
    v_cmp_ne_u32 vcc, s4, v248
    s_nop 1
    s_cbranch_vccnz Lpc_P_10
Lpcd_P_11:
    s_add_u32 s56, s58, s48
    buffer_load_dwordx4 v[80:83], v4, s[40:43], s56 offen offset:0 sc1
    v_mfma_f32_32x32x16_bf16 v[48:63], a[56:59], v[172:175], v[48:63]
    v_mfma_f32_32x32x16_bf16 v[64:79], a[60:63], v[172:175], v[64:79]
    ds_read_b64_tr_b16 a[248:249], v217 offset:30720
    ds_read_b64_tr_b16 a[250:251], v217 offset:31744
    ds_read_b64_tr_b16 a[252:253], v218 offset:30720
    ds_read_b64_tr_b16 a[254:255], v218 offset:31744
    buffer_load_dwordx4 v[84:87], v4, s[40:43], s56 offen offset:1024 sc1
    v_mfma_f32_32x32x16_bf16 v[48:63], a[64:67], v[176:179], v[48:63]
    v_mfma_f32_32x32x16_bf16 v[64:79], a[68:71], v[176:179], v[64:79]
    ds_read_b64_tr_b16 a[0:1], v217 offset:32768
    ds_read_b64_tr_b16 a[2:3], v217 offset:33792
    ds_read_b64_tr_b16 a[4:5], v218 offset:32768
    ds_read_b64_tr_b16 a[6:7], v218 offset:33792
    buffer_load_dwordx4 v[88:91], v4, s[40:43], s56 offen offset:2048 sc1
    v_mfma_f32_32x32x16_bf16 v[48:63], a[72:75], v[180:183], v[48:63]
    v_mfma_f32_32x32x16_bf16 v[64:79], a[76:79], v[180:183], v[64:79]
    ds_read_b64_tr_b16 a[8:9], v217 offset:34816
    ds_read_b64_tr_b16 a[10:11], v217 offset:35840
    ds_read_b64_tr_b16 a[12:13], v218 offset:34816
    ds_read_b64_tr_b16 a[14:15], v218 offset:35840
    buffer_load_dwordx4 v[92:95], v4, s[40:43], s56 offen offset:3072 sc1
    v_mfma_f32_32x32x16_bf16 v[48:63], a[80:83], v[184:187], v[48:63]
    v_mfma_f32_32x32x16_bf16 v[64:79], a[84:87], v[184:187], v[64:79]
    ds_read_b64_tr_b16 a[16:17], v217 offset:12288
    ds_read_b64_tr_b16 a[18:19], v217 offset:13312
    ds_read_b64_tr_b16 a[20:21], v218 offset:12288
    ds_read_b64_tr_b16 a[22:23], v218 offset:13312
    s_add_u32 s56, s58, s49
    buffer_load_dwordx4 v[96:99], v4, s[40:43], s56 offen offset:0 sc1
    v_mfma_f32_32x32x16_bf16 v[48:63], a[88:91], v[188:191], v[48:63]
    v_mfma_f32_32x32x16_bf16 v[64:79], a[92:95], v[188:191], v[64:79]
    s_waitcnt vmcnt(8)
    ds_read_b64_tr_b16 a[24:25], v217 offset:14336
    ds_read_b64_tr_b16 a[26:27], v217 offset:15360
    ds_read_b64_tr_b16 a[28:29], v218 offset:14336
    ds_read_b64_tr_b16 a[30:31], v218 offset:15360
    buffer_load_dwordx4 v[100:103], v4, s[40:43], s56 offen offset:1024 sc1
    buffer_load_dwordx4 v[104:107], v4, s[40:43], s56 offen offset:2048 sc1
    buffer_load_dwordx4 v[108:111], v4, s[40:43], s56 offen offset:3072 sc1
    s_add_u32 s56, s58, s50
    buffer_load_dwordx4 v[112:115], v4, s[40:43], s56 offen offset:0 sc1
    v_mfma_f32_32x32x16_bf16 v[64:79], a[100:103], v[192:195], v[64:79]
    s_waitcnt vmcnt(11)
    v_mfma_f32_32x32x16_bf16 v[64:79], a[108:111], v[196:199], v[64:79]
    s_waitcnt vmcnt(10)
    v_mfma_f32_32x32x16_bf16 v[64:79], a[116:119], v[200:203], v[64:79]
    s_waitcnt vmcnt(9)
    v_mfma_f32_32x32x16_bf16 v[64:79], a[124:127], v[204:207], v[64:79]
    v_mfma_f32_32x32x16_bf16 v[48:63], a[96:99], v[192:195], v[48:63]
    v_mfma_f32_32x32x16_bf16 v[48:63], a[104:107], v[196:199], v[48:63]
    s_nop 9
    ds_write_b128 v235, v[72:75] offset:6144
    ds_write_b128 v235, v[76:79] offset:7168
    v_mfma_f32_32x32x16_bf16 v[48:63], a[112:115], v[200:203], v[48:63]
    ds_write_b128 v234, v[64:67] offset:6144
    ds_write_b128 v234, v[68:71] offset:7168
    v_mfma_f32_32x32x16_bf16 v[48:63], a[120:123], v[204:207], v[48:63]
    s_nop 11
    ds_write_b128 v233, v[56:59] offset:6144
    ds_write_b128 v233, v[60:63] offset:7168
    s_waitcnt lgkmcnt(0)
    s_barrier
    ds_read_b128 v[56:59], v232 offset:6144
    ds_read_b128 v[64:67], v232 offset:8192
    ds_read_b128 v[72:75], v232 offset:10240
    ds_read_b128 v[60:63], v232 offset:7168
    ds_read_b128 v[68:71], v232 offset:9216
    ds_read_b128 v[76:79], v232 offset:11264
    v_mov_b32 v211, s88
    s_waitcnt lgkmcnt(4)
    v_pk_add_f32 v[56:57], v[56:57], v[64:65]
    s_waitcnt lgkmcnt(3)
    v_pk_add_f32 v[48:49], v[48:49], v[72:73]
    v_pk_add_f32 v[58:59], v[58:59], v[66:67]
    v_pk_add_f32 v[50:51], v[50:51], v[74:75]
    s_waitcnt lgkmcnt(1)
    v_pk_add_f32 v[60:61], v[60:61], v[68:69]
    s_waitcnt lgkmcnt(0)
    v_pk_add_f32 v[52:53], v[52:53], v[76:77]
    v_pk_add_f32 v[62:63], v[62:63], v[70:71]
    v_pk_add_f32 v[54:55], v[54:55], v[78:79]
    v_pk_add_f32 v[48:49], v[48:49], v[56:57]
    v_pk_add_f32 v[50:51], v[50:51], v[58:59]
    v_pk_add_f32 v[52:53], v[52:53], v[60:61]
    v_pk_add_f32 v[54:55], v[54:55], v[62:63]
    v_pk_mul_f32 v[56:57], v[48:49], v[48:49]
    v_pk_mul_f32 v[58:59], v[50:51], v[50:51]
    v_pk_mul_f32 v[60:61], v[52:53], v[52:53]
    v_pk_mul_f32 v[62:63], v[54:55], v[54:55]
    v_fma_f32 v56, v56, s90, v211
    v_fma_f32 v57, v57, s90, v211
    v_fma_f32 v58, v58, s90, v211
    v_fma_f32 v59, v59, s90, v211
    v_fma_f32 v60, v60, s90, v211
    v_fma_f32 v61, v61, s90, v211
    v_fma_f32 v62, v62, s90, v211
    v_fma_f32 v63, v63, s90, v211
    v_pk_mul_f32 v[56:57], v[56:57], v[48:49]
    v_pk_mul_f32 v[58:59], v[58:59], v[50:51]
    v_pk_mul_f32 v[60:61], v[60:61], v[52:53]
    v_pk_mul_f32 v[62:63], v[62:63], v[54:55]
    v_exp_f32 v56, v56
    v_exp_f32 v57, v57
    v_exp_f32 v58, v58
    v_exp_f32 v59, v59
    v_exp_f32 v60, v60
    v_exp_f32 v61, v61
    v_exp_f32 v62, v62
    v_exp_f32 v63, v63
    v_add_f32 v56, 1.0, v56
    v_add_f32 v57, 1.0, v57
    v_add_f32 v58, 1.0, v58
    v_add_f32 v59, 1.0, v59
    v_add_f32 v60, 1.0, v60
    v_add_f32 v61, 1.0, v61
    v_add_f32 v62, 1.0, v62
    v_add_f32 v63, 1.0, v63
    v_rcp_f32 v56, v56
    v_rcp_f32 v57, v57
    v_rcp_f32 v58, v58
    v_rcp_f32 v59, v59
    v_rcp_f32 v60, v60
    v_rcp_f32 v61, v61
    v_rcp_f32 v62, v62
    v_rcp_f32 v63, v63
    v_mul_f32 v56, v56, v48
    v_mul_f32 v57, v57, v49
    v_mul_f32 v58, v58, v50
    v_mul_f32 v59, v59, v51
    v_mul_f32 v60, v60, v52
    v_mul_f32 v61, v61, v53
    v_mul_f32 v62, v62, v54
    v_mul_f32 v63, v63, v55
    v_cvt_pk_bf16_f32 v64, v56, v57
    v_cvt_pk_bf16_f32 v65, v58, v59
    v_cvt_pk_bf16_f32 v66, v60, v61
    v_cvt_pk_bf16_f32 v67, v62, v63
    s_add_u32 s57, s57, 114688
    buffer_store_dwordx4 v[64:67], v5, s[40:43], s57 offen sc1
    s_add_u32 s82, s82, 4096
    s_add_u32 s85, s85, 4096
    buffer_load_dwordx4 v[116:119], v4, s[40:43], s56 offen offset:1024 sc1
    s_waitcnt vmcnt(10)
    v_mfma_f32_32x32x16_bf16 v[16:31], a[128:131], v[80:83], v[16:31]
    v_mfma_f32_32x32x16_bf16 v[32:47], a[132:135], v[80:83], 0
    s_add_u32 m0, s70, 16384
    s_mul_i32 s73, s53, 64
    s_add_u32 s73, s73, 0
    buffer_load_dwordx4 v214, s[24:27], s73 offen lds
    s_add_u32 m0, s70, 17408
    s_mul_i32 s73, s53, 64
    s_add_u32 s73, s73, 32768
    buffer_load_dwordx4 v214, s[24:27], s73 offen lds
    buffer_load_dwordx4 v[120:123], v4, s[40:43], s56 offen offset:2048 sc1
    s_waitcnt vmcnt(12)
    v_mfma_f32_32x32x16_bf16 v[16:31], a[136:139], v[84:87], v[16:31]
    v_mfma_f32_32x32x16_bf16 v[32:47], a[140:143], v[84:87], v[32:47]
    s_add_u32 m0, s70, 18432
    s_mul_i32 s73, s53, 64
    s_add_u32 s73, s73, 65536
    buffer_load_dwordx4 v214, s[24:27], s73 offen lds
    s_add_u32 m0, s70, 19456
    s_mul_i32 s73, s53, 64
    s_add_u32 s73, s73, 98304
    buffer_load_dwordx4 v214, s[24:27], s73 offen lds
    buffer_load_dwordx4 v[124:127], v4, s[40:43], s56 offen offset:3072 sc1
    s_waitcnt vmcnt(14)
    v_mfma_f32_32x32x16_bf16 v[16:31], a[144:147], v[88:91], v[16:31]
    v_mfma_f32_32x32x16_bf16 v[32:47], a[148:151], v[88:91], v[32:47]
    s_add_u32 m0, s70, 20480
    s_mul_i32 s73, s53, 64
    s_add_u32 s73, s73, 131072
    buffer_load_dwordx4 v214, s[24:27], s73 offen lds
    s_add_u32 m0, s70, 21504
    s_mul_i32 s73, s53, 64
    s_add_u32 s73, s73, 163840
    buffer_load_dwordx4 v214, s[24:27], s73 offen lds
    s_add_u32 s56, s58, s51
    buffer_load_dwordx4 v[128:131], v4, s[40:43], s56 offen offset:0 sc1
    s_waitcnt vmcnt(16)
    v_mfma_f32_32x32x16_bf16 v[16:31], a[152:155], v[92:95], v[16:31]
    v_mfma_f32_32x32x16_bf16 v[32:47], a[156:159], v[92:95], v[32:47]
    s_add_u32 m0, s70, 22528
    s_mul_i32 s73, s53, 64
    s_add_u32 s73, s73, 196608
    buffer_load_dwordx4 v214, s[24:27], s73 offen lds
    s_add_u32 m0, s70, 23552
    s_mul_i32 s73, s53, 64
    s_add_u32 s73, s73, 229376
    buffer_load_dwordx4 v214, s[24:27], s73 offen lds
    buffer_load_dwordx4 v[132:135], v4, s[40:43], s56 offen offset:1024 sc1
    s_waitcnt vmcnt(18)
    v_mfma_f32_32x32x16_bf16 v[16:31], a[160:163], v[96:99], v[16:31]
    v_mfma_f32_32x32x16_bf16 v[32:47], a[164:167], v[96:99], v[32:47]
    s_add_u32 m0, s70, 24576
    s_mul_i32 s73, s54, 64
    s_add_u32 s73, s73, 0
    buffer_load_dwordx4 v214, s[24:27], s73 offen lds
    s_add_u32 m0, s70, 25600
    s_mul_i32 s73, s54, 64
    s_add_u32 s73, s73, 32768
    buffer_load_dwordx4 v214, s[24:27], s73 offen lds
    s_waitcnt vmcnt(15)
    v_mov_b32 v8, s4
    s_mov_b64 exec, 1
    buffer_store_dword v8, v9, s[40:43], s82 offen sc1
    s_mov_b64 exec, -1
    buffer_load_dwordx4 v[136:139], v4, s[40:43], s56 offen offset:2048 sc1
    v_mfma_f32_32x32x16_bf16 v[16:31], a[168:171], v[100:103], v[16:31]
    v_mfma_f32_32x32x16_bf16 v[32:47], a[172:175], v[100:103], v[32:47]
    s_add_u32 m0, s70, 26624
    s_mul_i32 s73, s54, 64
    s_add_u32 s73, s73, 65536
    buffer_load_dwordx4 v214, s[24:27], s73 offen lds
    s_add_u32 m0, s70, 27648
    s_mul_i32 s73, s54, 64
    s_add_u32 s73, s73, 98304
    buffer_load_dwordx4 v214, s[24:27], s73 offen lds
    buffer_load_dwordx4 v[140:143], v4, s[40:43], s56 offen offset:3072 sc1
    v_mfma_f32_32x32x16_bf16 v[16:31], a[176:179], v[104:107], v[16:31]
    v_mfma_f32_32x32x16_bf16 v[32:47], a[180:183], v[104:107], v[32:47]
    s_add_u32 m0, s70, 28672
    s_mul_i32 s73, s54, 64
    s_add_u32 s73, s73, 131072
    buffer_load_dwordx4 v214, s[24:27], s73 offen lds
    s_add_u32 m0, s70, 29696
    s_mul_i32 s73, s54, 64
    s_add_u32 s73, s73, 163840
    buffer_load_dwordx4 v214, s[24:27], s73 offen lds
    s_and_b32 s60, s3, 1
    s_cmp_eq_u32 s60, 1
    s_cselect_b32 s60, 1.0, 0
    v_lshlrev_b32 v48, 16, v224
    v_and_b32 v49, s91, v224
    v_lshlrev_b32 v208, 16, v240
    v_and_b32 v209, s91, v240
    v_add_f32 v48, v48, v208
    s_add_u32 s56, s58, s52
    buffer_load_dwordx4 v[144:147], v4, s[40:43], s56 offen offset:0 sc1
    v_mfma_f32_32x32x16_bf16 v[16:31], a[184:187], v[108:111], v[16:31]
    v_mfma_f32_32x32x16_bf16 v[32:47], a[188:191], v[108:111], v[32:47]
    s_add_u32 m0, s70, 30720
    s_mul_i32 s73, s54, 64
    s_add_u32 s73, s73, 196608
    buffer_load_dwordx4 v214, s[24:27], s73 offen lds
    s_add_u32 m0, s70, 31744
    s_mul_i32 s73, s54, 64
    s_add_u32 s73, s73, 229376
    buffer_load_dwordx4 v214, s[24:27], s73 offen lds
    v_add_f32 v49, v49, v209
    v_mul_f32 v48, s60, v48
    v_mul_f32 v49, s60, v49
    v_lshlrev_b32 v50, 16, v225
    v_and_b32 v51, s91, v225
    v_lshlrev_b32 v210, 16, v241
    buffer_load_dwordx4 v[148:151], v4, s[40:43], s56 offen offset:1024 sc1
    v_mfma_f32_32x32x16_bf16 v[16:31], a[192:195], v[112:115], v[16:31]
    v_mfma_f32_32x32x16_bf16 v[32:47], a[196:199], v[112:115], v[32:47]
    s_waitcnt vmcnt(23)
    ds_read_b64_tr_b16 a[32:33], v217 offset:16384
    ds_read_b64_tr_b16 a[34:35], v217 offset:17408
    ds_read_b64_tr_b16 a[36:37], v218 offset:16384
    ds_read_b64_tr_b16 a[38:39], v218 offset:17408
    v_and_b32 v211, s91, v241
    v_add_f32 v50, v50, v210
    v_add_f32 v51, v51, v211
    v_mul_f32 v50, s60, v50
    v_mul_f32 v51, s60, v51
    v_lshlrev_b32 v52, 16, v226
    buffer_load_dwordx4 v[152:155], v4, s[40:43], s56 offen offset:2048 sc1
    v_mfma_f32_32x32x16_bf16 v[16:31], a[200:203], v[116:119], v[16:31]
    v_mfma_f32_32x32x16_bf16 v[32:47], a[204:207], v[116:119], v[32:47]
    s_waitcnt vmcnt(21)
    ds_read_b64_tr_b16 a[40:41], v217 offset:18432
    ds_read_b64_tr_b16 a[42:43], v217 offset:19456
    ds_read_b64_tr_b16 a[44:45], v218 offset:18432
    ds_read_b64_tr_b16 a[46:47], v218 offset:19456
    v_and_b32 v53, s91, v226
    v_lshlrev_b32 v208, 16, v242
    v_and_b32 v209, s91, v242
    v_add_f32 v52, v52, v208
    v_add_f32 v53, v53, v209
    v_mul_f32 v52, s60, v52
    buffer_load_dwordx4 v[156:159], v4, s[40:43], s56 offen offset:3072 sc1
    v_mfma_f32_32x32x16_bf16 v[16:31], a[208:211], v[120:123], v[16:31]
    v_mfma_f32_32x32x16_bf16 v[32:47], a[212:215], v[120:123], v[32:47]
    s_waitcnt vmcnt(19)
    ds_read_b64_tr_b16 a[48:49], v217 offset:20480
    ds_read_b64_tr_b16 a[50:51], v217 offset:21504
    ds_read_b64_tr_b16 a[52:53], v218 offset:20480
    ds_read_b64_tr_b16 a[54:55], v218 offset:21504
    v_mul_f32 v53, s60, v53
    v_lshlrev_b32 v54, 16, v227
    v_and_b32 v55, s91, v227
    v_lshlrev_b32 v210, 16, v243
    v_and_b32 v211, s91, v243
    v_add_f32 v54, v54, v210
    s_add_u32 s56, s58, s53
    buffer_load_dwordx4 v[160:163], v4, s[40:43], s56 offen offset:0 sc1
    v_mfma_f32_32x32x16_bf16 v[16:31], a[216:219], v[124:127], v[16:31]
    v_mfma_f32_32x32x16_bf16 v[32:47], a[220:223], v[124:127], v[32:47]
    s_waitcnt vmcnt(17)
    ds_read_b64_tr_b16 a[56:57], v217 offset:22528
    ds_read_b64_tr_b16 a[58:59], v217 offset:23552
    ds_read_b64_tr_b16 a[60:61], v218 offset:22528
    ds_read_b64_tr_b16 a[62:63], v218 offset:23552
    v_add_f32 v55, v55, v211
    v_mul_f32 v54, s60, v54
    v_mul_f32 v55, s60, v55
    v_lshlrev_b32 v56, 16, v228
    v_and_b32 v57, s91, v228
    v_lshlrev_b32 v208, 16, v244
    buffer_load_dwordx4 v[164:167], v4, s[40:43], s56 offen offset:1024 sc1
    v_mfma_f32_32x32x16_bf16 v[16:31], a[224:227], v[128:131], v[16:31]
    v_mfma_f32_32x32x16_bf16 v[32:47], a[228:231], v[128:131], v[32:47]
    s_waitcnt vmcnt(15)
    ds_read_b64_tr_b16 a[64:65], v217 offset:24576
    ds_read_b64_tr_b16 a[66:67], v217 offset:25600
    ds_read_b64_tr_b16 a[68:69], v218 offset:24576
    ds_read_b64_tr_b16 a[70:71], v218 offset:25600
    v_and_b32 v209, s91, v244
    v_add_f32 v56, v56, v208
    v_add_f32 v57, v57, v209
    v_mul_f32 v56, s60, v56
    v_mul_f32 v57, s60, v57
    v_lshlrev_b32 v58, 16, v229
    buffer_load_dwordx4 v[168:171], v4, s[40:43], s56 offen offset:2048 sc1
    v_mfma_f32_32x32x16_bf16 v[16:31], a[232:235], v[132:135], v[16:31]
    v_mfma_f32_32x32x16_bf16 v[32:47], a[236:239], v[132:135], v[32:47]
    s_waitcnt vmcnt(12)
    ds_read_b64_tr_b16 a[72:73], v217 offset:26624
    ds_read_b64_tr_b16 a[74:75], v217 offset:27648
    ds_read_b64_tr_b16 a[76:77], v218 offset:26624
    ds_read_b64_tr_b16 a[78:79], v218 offset:27648
    v_and_b32 v59, s91, v229
    v_lshlrev_b32 v210, 16, v245
    v_and_b32 v211, s91, v245
    v_add_f32 v58, v58, v210
    v_add_f32 v59, v59, v211
    v_mul_f32 v58, s60, v58
    buffer_load_dwordx4 v[172:175], v4, s[40:43], s56 offen offset:3072 sc1
    v_mfma_f32_32x32x16_bf16 v[16:31], a[240:243], v[136:139], v[16:31]
    v_mfma_f32_32x32x16_bf16 v[32:47], a[244:247], v[136:139], v[32:47]
    s_waitcnt vmcnt(10)
    ds_read_b64_tr_b16 a[80:81], v217 offset:28672
    ds_read_b64_tr_b16 a[82:83], v217 offset:29696
    ds_read_b64_tr_b16 a[84:85], v218 offset:28672
    ds_read_b64_tr_b16 a[86:87], v218 offset:29696
    v_mul_f32 v59, s60, v59
    v_lshlrev_b32 v60, 16, v230
    v_and_b32 v61, s91, v230
    v_lshlrev_b32 v208, 16, v246
    v_and_b32 v209, s91, v246
    v_add_f32 v60, v60, v208
    s_add_u32 s56, s58, s54
    buffer_load_dwordx4 v[176:179], v4, s[40:43], s56 offen offset:0 sc1
    v_mfma_f32_32x32x16_bf16 v[16:31], a[248:251], v[140:143], v[16:31]
    v_mfma_f32_32x32x16_bf16 v[32:47], a[252:255], v[140:143], v[32:47]
    s_waitcnt vmcnt(8)
    ds_read_b64_tr_b16 a[88:89], v217 offset:30720
    ds_read_b64_tr_b16 a[90:91], v217 offset:31744
    ds_read_b64_tr_b16 a[92:93], v218 offset:30720
    ds_read_b64_tr_b16 a[94:95], v218 offset:31744
    v_add_f32 v61, v61, v209
    v_mul_f32 v60, s60, v60
    v_mul_f32 v61, s60, v61
    v_lshlrev_b32 v62, 16, v231
    v_and_b32 v63, s91, v231
    v_lshlrev_b32 v210, 16, v247
    buffer_load_dwordx4 v[180:183], v4, s[40:43], s56 offen offset:1024 sc1
    v_mfma_f32_32x32x16_bf16 v[16:31], a[0:3], v[144:147], v[16:31]
    v_mfma_f32_32x32x16_bf16 v[32:47], a[4:7], v[144:147], v[32:47]
    v_and_b32 v211, s91, v247
    v_add_f32 v62, v62, v210
    v_add_f32 v63, v63, v211
    v_mul_f32 v62, s60, v62
    v_mul_f32 v63, s60, v63
    buffer_load_dword v248, v12, s[40:43], s85 offen offset:0 sc1
    buffer_load_dwordx4 v[184:187], v4, s[40:43], s56 offen offset:2048 sc1
    s_waitcnt vmcnt(10)
    v_mfma_f32_32x32x16_bf16 v[16:31], a[8:11], v[148:151], v[16:31]
    v_mfma_f32_32x32x16_bf16 v[32:47], a[12:15], v[148:151], v[32:47]
    buffer_load_dwordx4 v[188:191], v4, s[40:43], s56 offen offset:3072 sc1
    s_waitcnt vmcnt(10)
    v_mfma_f32_32x32x16_bf16 v[16:31], a[16:19], v[152:155], v[16:31]
    v_mfma_f32_32x32x16_bf16 v[32:47], a[20:23], v[152:155], v[32:47]
    s_waitcnt vmcnt(9)
    v_mfma_f32_32x32x16_bf16 v[16:31], a[24:27], v[156:159], v[16:31]
    v_mfma_f32_32x32x16_bf16 v[32:47], a[28:31], v[156:159], v[32:47]
    s_waitcnt vmcnt(8) lgkmcnt(15)
    v_mfma_f32_32x32x16_bf16 v[16:31], a[32:35], v[160:163], v[16:31]
    v_mfma_f32_32x32x16_bf16 v[32:47], a[36:39], v[160:163], v[32:47]
    s_waitcnt vmcnt(2)
    v_cmp_ne_u32 vcc, s4, v248
    s_nop 1
    s_cbranch_vccz Lpcd_P_13
    s_nop 6
Lpc_P_12:
    s_sub_u32 s6, s6, 1
    s_cbranch_scc1 L_end_P
    buffer_load_dword v248, v12, s[40:43], s85 offen offset:0 sc1
    s_waitcnt vmcnt(0)
    v_cmp_ne_u32 vcc, s4, v248
    s_nop 1
    s_cbranch_vccnz Lpc_P_12
Lpcd_P_13:
    s_add_u32 s56, s59, s48
    buffer_load_dwordx4 v[192:195], v4, s[40:43], s56 offen offset:0 sc1
    buffer_load_dwordx4 v[196:199], v4, s[40:43], s56 offen offset:1024 sc1
    v_mfma_f32_32x32x16_bf16 v[16:31], a[40:43], v[164:167], v[16:31]
    v_mfma_f32_32x32x16_bf16 v[32:47], a[44:47], v[164:167], v[32:47]
    buffer_load_dwordx4 v[200:203], v4, s[40:43], s56 offen offset:2048 sc1
    buffer_load_dwordx4 v[204:207], v4, s[40:43], s56 offen offset:3072 sc1
    v_mfma_f32_32x32x16_bf16 v[16:31], a[48:51], v[168:171], v[16:31]
    v_mfma_f32_32x32x16_bf16 v[32:47], a[52:55], v[168:171], v[32:47]
    s_add_u32 s56, s59, s49
    buffer_load_dwordx4 v[80:83], v4, s[40:43], s56 offen offset:0 sc1
    v_mfma_f32_32x32x16_bf16 v[16:31], a[56:59], v[172:175], v[16:31]
    v_mfma_f32_32x32x16_bf16 v[32:47], a[60:63], v[172:175], v[32:47]
    buffer_load_dwordx4 v[84:87], v4, s[40:43], s56 offen offset:1024 sc1
    s_waitcnt lgkmcnt(14)
    v_mfma_f32_32x32x16_bf16 v[16:31], a[64:67], v[176:179], v[16:31]
    s_waitcnt lgkmcnt(12)
    v_mfma_f32_32x32x16_bf16 v[32:47], a[68:71], v[176:179], v[32:47]
    buffer_load_dwordx4 v[88:91], v4, s[40:43], s56 offen offset:2048 sc1
    s_waitcnt lgkmcnt(10)
    v_mfma_f32_32x32x16_bf16 v[16:31], a[72:75], v[180:183], v[16:31]
    s_waitcnt lgkmcnt(8)
    v_mfma_f32_32x32x16_bf16 v[32:47], a[76:79], v[180:183], v[32:47]
    buffer_load_dwordx4 v[92:95], v4, s[40:43], s56 offen offset:3072 sc1
    s_waitcnt vmcnt(9) lgkmcnt(6)
    v_mfma_f32_32x32x16_bf16 v[16:31], a[80:83], v[184:187], v[16:31]
    s_waitcnt lgkmcnt(4)
    v_mfma_f32_32x32x16_bf16 v[32:47], a[84:87], v[184:187], v[32:47]
    s_add_u32 s56, s59, s50
    buffer_load_dwordx4 v[96:99], v4, s[40:43], s56 offen offset:0 sc1
    s_waitcnt vmcnt(9) lgkmcnt(2)
    v_mfma_f32_32x32x16_bf16 v[16:31], a[88:91], v[188:191], v[16:31]
    s_waitcnt lgkmcnt(0)
    v_mfma_f32_32x32x16_bf16 v[32:47], a[92:95], v[188:191], v[32:47]
    buffer_load_dwordx4 v[100:103], v4, s[40:43], s56 offen offset:1024 sc1
    s_waitcnt vmcnt(9)
    v_mfma_f32_32x32x16_bf16 v[48:63], a[128:131], v[192:195], v[48:63]
    v_mfma_f32_32x32x16_bf16 v[64:79], a[132:135], v[192:195], 0
    s_nop 7
    ds_write_b32 v237, v32 offset:0
    ds_write_b32 v237, v34 offset:256
    ds_write_b32 v237, v33 offset:128
    ds_write_b32 v237, v35 offset:384
    ds_write_b32 v237, v36 offset:1024
    ds_write_b32 v237, v38 offset:1280
    buffer_load_dwordx4 v[104:107], v4, s[40:43], s56 offen offset:2048 sc1
    s_waitcnt vmcnt(9)
    v_mfma_f32_32x32x16_bf16 v[48:63], a[136:139], v[196:199], v[48:63]
    v_mfma_f32_32x32x16_bf16 v[64:79], a[140:143], v[196:199], v[64:79]
    ds_write_b32 v237, v37 offset:1152
    ds_write_b32 v237, v39 offset:1408
    ds_write_b32 v237, v40 offset:2048
    ds_write_b32 v237, v42 offset:2304
    ds_write_b32 v237, v41 offset:2176
    ds_write_b32 v237, v43 offset:2432
    buffer_load_dwordx4 v[108:111], v4, s[40:43], s56 offen offset:3072 sc1
    s_waitcnt vmcnt(9)
    v_mfma_f32_32x32x16_bf16 v[48:63], a[144:147], v[200:203], v[48:63]
    v_mfma_f32_32x32x16_bf16 v[64:79], a[148:151], v[200:203], v[64:79]
    ds_write_b32 v237, v44 offset:3072
    ds_write_b32 v237, v46 offset:3328
    ds_write_b32 v237, v45 offset:3200
    ds_write_b32 v237, v47 offset:3456
    ds_write_b32 v236, v16 offset:0
    ds_write_b32 v236, v18 offset:256
    s_add_u32 s56, s59, s51
    buffer_load_dwordx4 v[112:115], v4, s[40:43], s56 offen offset:0 sc1
    s_waitcnt vmcnt(9)
    v_mfma_f32_32x32x16_bf16 v[48:63], a[152:155], v[204:207], v[48:63]
    v_mfma_f32_32x32x16_bf16 v[64:79], a[156:159], v[204:207], v[64:79]
    ds_write_b32 v236, v17 offset:128
    ds_write_b32 v236, v19 offset:384
    ds_write_b32 v236, v20 offset:1024
    ds_write_b32 v236, v22 offset:1280
    ds_write_b32 v236, v21 offset:1152
    ds_write_b32 v236, v23 offset:1408
    buffer_load_dwordx4 v[116:119], v4, s[40:43], s56 offen offset:1024 sc1
    s_waitcnt vmcnt(9)
    v_mfma_f32_32x32x16_bf16 v[48:63], a[160:163], v[80:83], v[48:63]
    v_mfma_f32_32x32x16_bf16 v[64:79], a[164:167], v[80:83], v[64:79]
    ds_write_b32 v236, v24 offset:2048
    ds_write_b32 v236, v26 offset:2304
    ds_write_b32 v236, v25 offset:2176
    ds_write_b32 v236, v27 offset:2432
    ds_write_b32 v236, v28 offset:3072
    ds_write_b32 v236, v30 offset:3328
    buffer_load_dwordx4 v[120:123], v4, s[40:43], s56 offen offset:2048 sc1
    s_waitcnt vmcnt(9)
    v_mfma_f32_32x32x16_bf16 v[48:63], a[168:171], v[84:87], v[48:63]
    v_mfma_f32_32x32x16_bf16 v[64:79], a[172:175], v[84:87], v[64:79]
    ds_write_b32 v236, v29 offset:3200
    ds_write_b32 v236, v31 offset:3456
    buffer_load_dwordx4 v[124:127], v4, s[40:43], s56 offen offset:3072 sc1
    s_waitcnt vmcnt(9)
    v_mfma_f32_32x32x16_bf16 v[48:63], a[176:179], v[88:91], v[48:63]
    v_mfma_f32_32x32x16_bf16 v[64:79], a[180:183], v[88:91], v[64:79]
    s_add_u32 s56, s59, s52
    buffer_load_dwordx4 v[128:131], v4, s[40:43], s56 offen offset:0 sc1
    s_waitcnt vmcnt(9)
    v_mfma_f32_32x32x16_bf16 v[48:63], a[184:187], v[92:95], v[48:63]
    v_mfma_f32_32x32x16_bf16 v[64:79], a[188:191], v[92:95], v[64:79]
    s_waitcnt lgkmcnt(0)
    s_barrier
    ds_read_b128 v[16:19], v238 offset:0
    ds_read_b128 v[20:23], v238 offset:36864
    ds_read_b128 v[24:27], v239 offset:0
    ds_read_b128 v[28:31], v239 offset:36864
    ds_read_b128 v[32:35], v238 offset:1024
    ds_read_b128 v[36:39], v238 offset:37888
    ds_read_b128 v[40:43], v239 offset:1024
    ds_read_b128 v[44:47], v239 offset:37888
    buffer_load_dwordx4 v[132:135], v4, s[40:43], s56 offen offset:1024 sc1
    s_waitcnt vmcnt(9)
    v_mfma_f32_32x32x16_bf16 v[48:63], a[192:195], v[96:99], v[48:63]
    v_mfma_f32_32x32x16_bf16 v[64:79], a[196:199], v[96:99], v[64:79]
    buffer_load_dwordx4 v[136:139], v4, s[40:43], s56 offen offset:2048 sc1
    s_waitcnt vmcnt(9)
    v_mfma_f32_32x32x16_bf16 v[48:63], a[200:203], v[100:103], v[48:63]
    v_mfma_f32_32x32x16_bf16 v[64:79], a[204:207], v[100:103], v[64:79]
    s_waitcnt lgkmcnt(6)
    v_add_f32 v16, v16, v20
    s_waitcnt lgkmcnt(4)
    v_add_f32 v24, v24, v28
    v_add_f32 v17, v17, v21
    v_add_f32 v25, v25, v29
    v_add_f32 v18, v18, v22
    v_add_f32 v26, v26, v30
    buffer_load_dwordx4 v[140:143], v4, s[40:43], s56 offen offset:3072 sc1
    s_waitcnt vmcnt(9)
    v_mfma_f32_32x32x16_bf16 v[48:63], a[208:211], v[104:107], v[48:63]
    v_mfma_f32_32x32x16_bf16 v[64:79], a[212:215], v[104:107], v[64:79]
    v_add_f32 v19, v19, v23
    v_add_f32 v27, v27, v31
    v_add_f32 v16, v16, v24
    v_add_f32 v17, v17, v25
    v_add_f32 v18, v18, v26
    v_add_f32 v19, v19, v27
    s_add_u32 s56, s59, s53
    buffer_load_dwordx4 v[144:147], v4, s[40:43], s56 offen offset:0 sc1
    s_waitcnt vmcnt(9)
    v_mfma_f32_32x32x16_bf16 v[48:63], a[216:219], v[108:111], v[48:63]
    v_mfma_f32_32x32x16_bf16 v[64:79], a[220:223], v[108:111], v[64:79]
    v_cvt_pk_bf16_f32 v20, v16, v17
    v_cvt_pk_bf16_f32 v21, v18, v19
    buffer_store_dwordx2 v[20:21], v212, s[36:39], s68 offen offset:0
    s_waitcnt lgkmcnt(2)
    v_add_f32 v32, v32, v36
    s_waitcnt lgkmcnt(0)
    v_add_f32 v40, v40, v44
    v_add_f32 v33, v33, v37
    buffer_load_dwordx4 v[148:151], v4, s[40:43], s56 offen offset:1024 sc1
    s_waitcnt vmcnt(10)
    v_mfma_f32_32x32x16_bf16 v[48:63], a[224:227], v[112:115], v[48:63]
    v_mfma_f32_32x32x16_bf16 v[64:79], a[228:231], v[112:115], v[64:79]
    v_add_f32 v41, v41, v45
    v_add_f32 v34, v34, v38
    v_add_f32 v42, v42, v46
    v_add_f32 v35, v35, v39
    v_add_f32 v43, v43, v47
    v_add_f32 v32, v32, v40
    buffer_load_dwordx4 v[152:155], v4, s[40:43], s56 offen offset:2048 sc1
    s_waitcnt vmcnt(10)
    v_mfma_f32_32x32x16_bf16 v[48:63], a[232:235], v[116:119], v[48:63]
    v_mfma_f32_32x32x16_bf16 v[64:79], a[236:239], v[116:119], v[64:79]
    v_add_f32 v33, v33, v41
    v_add_f32 v34, v34, v42
    v_add_f32 v35, v35, v43
    v_cvt_pk_bf16_f32 v36, v32, v33
    v_cvt_pk_bf16_f32 v37, v34, v35
    buffer_store_dwordx2 v[36:37], v212, s[36:39], s69 offen offset:0
    buffer_load_dwordx4 v[156:159], v4, s[40:43], s56 offen offset:3072 sc1
    s_waitcnt vmcnt(11)
    v_mfma_f32_32x32x16_bf16 v[48:63], a[240:243], v[120:123], v[48:63]
    v_mfma_f32_32x32x16_bf16 v[64:79], a[244:247], v[120:123], v[64:79]
    s_add_u32 s56, s59, s54
    buffer_load_dwordx4 v[160:163], v4, s[40:43], s56 offen offset:0 sc1
    s_waitcnt vmcnt(11)
    v_mfma_f32_32x32x16_bf16 v[48:63], a[248:251], v[124:127], v[48:63]
    v_mfma_f32_32x32x16_bf16 v[64:79], a[252:255], v[124:127], v[64:79]
    buffer_load_dwordx4 v[164:167], v4, s[40:43], s56 offen offset:1024 sc1
    s_waitcnt vmcnt(11)
    v_mfma_f32_32x32x16_bf16 v[48:63], a[0:3], v[128:131], v[48:63]
    v_mfma_f32_32x32x16_bf16 v[64:79], a[4:7], v[128:131], v[64:79]
    buffer_load_dwordx4 v[168:171], v4, s[40:43], s56 offen offset:2048 sc1
    s_waitcnt vmcnt(11)
    v_mfma_f32_32x32x16_bf16 v[48:63], a[8:11], v[132:135], v[48:63]
    v_mfma_f32_32x32x16_bf16 v[64:79], a[12:15], v[132:135], v[64:79]
    buffer_load_dwordx4 v[172:175], v4, s[40:43], s56 offen offset:3072 sc1
    s_waitcnt vmcnt(11)
    v_mfma_f32_32x32x16_bf16 v[48:63], a[16:19], v[136:139], v[48:63]
    v_mfma_f32_32x32x16_bf16 v[64:79], a[20:23], v[136:139], v[64:79]
    s_waitcnt vmcnt(10)
    v_mfma_f32_32x32x16_bf16 v[48:63], a[24:27], v[140:143], v[48:63]
    v_mfma_f32_32x32x16_bf16 v[64:79], a[28:31], v[140:143], v[64:79]
    s_waitcnt vmcnt(9)
    v_mfma_f32_32x32x16_bf16 v[48:63], a[32:35], v[144:147], v[48:63]
    v_mfma_f32_32x32x16_bf16 v[64:79], a[36:39], v[144:147], v[64:79]
    s_waitcnt vmcnt(7)
    v_mfma_f32_32x32x16_bf16 v[48:63], a[40:43], v[148:151], v[48:63]
    v_mfma_f32_32x32x16_bf16 v[64:79], a[44:47], v[148:151], v[64:79]
    s_waitcnt vmcnt(6)
    v_mfma_f32_32x32x16_bf16 v[48:63], a[48:51], v[152:155], v[48:63]
    v_mfma_f32_32x32x16_bf16 v[64:79], a[52:55], v[152:155], v[64:79]
    s_waitcnt vmcnt(4)
    v_mfma_f32_32x32x16_bf16 v[48:63], a[56:59], v[156:159], v[48:63]
    v_mfma_f32_32x32x16_bf16 v[64:79], a[60:63], v[156:159], v[64:79]
    s_waitcnt vmcnt(3)
    v_mfma_f32_32x32x16_bf16 v[64:79], a[68:71], v[160:163], v[64:79]
    s_waitcnt vmcnt(2)
    v_mfma_f32_32x32x16_bf16 v[64:79], a[76:79], v[164:167], v[64:79]
    s_waitcnt vmcnt(1)
    v_mfma_f32_32x32x16_bf16 v[64:79], a[84:87], v[168:171], v[64:79]
    s_waitcnt vmcnt(0)
    v_mfma_f32_32x32x16_bf16 v[64:79], a[92:95], v[172:175], v[64:79]
    v_mfma_f32_32x32x16_bf16 v[48:63], a[64:67], v[160:163], v[48:63]
    v_mfma_f32_32x32x16_bf16 v[48:63], a[72:75], v[164:167], v[48:63]
    s_nop 9
    ds_write_b32 v237, v64 offset:8192
    ds_write_b32 v237, v66 offset:8448
    ds_write_b32 v237, v65 offset:8320
    ds_write_b32 v237, v67 offset:8576
    ds_write_b32 v237, v68 offset:9216
    ds_write_b32 v237, v70 offset:9472
    v_mfma_f32_32x32x16_bf16 v[48:63], a[80:83], v[168:171], v[48:63]
    ds_write_b32 v237, v69 offset:9344
    ds_write_b32 v237, v71 offset:9600
    ds_write_b32 v237, v72 offset:10240
    ds_write_b32 v237, v74 offset:10496
    ds_write_b32 v237, v73 offset:10368
    ds_write_b32 v237, v75 offset:10624
    v_mfma_f32_32x32x16_bf16 v[48:63], a[88:91], v[172:175], v[48:63]
    ds_write_b32 v237, v76 offset:11264
    ds_write_b32 v237, v78 offset:11520
    ds_write_b32 v237, v77 offset:11392
    ds_write_b32 v237, v79 offset:11648
    s_nop 7
    ds_write_b32 v236, v48 offset:8192
    ds_write_b32 v236, v50 offset:8448
    ds_write_b32 v236, v49 offset:8320
    ds_write_b32 v236, v51 offset:8576
    ds_write_b32 v236, v52 offset:9216
    ds_write_b32 v236, v54 offset:9472
    ds_write_b32 v236, v53 offset:9344
    ds_write_b32 v236, v55 offset:9600
    ds_write_b32 v236, v56 offset:10240
    ds_write_b32 v236, v58 offset:10496
    ds_write_b32 v236, v57 offset:10368
    ds_write_b32 v236, v59 offset:10624
    ds_write_b32 v236, v60 offset:11264
    ds_write_b32 v236, v62 offset:11520
    ds_write_b32 v236, v61 offset:11392
    ds_write_b32 v236, v63 offset:11648
    s_waitcnt lgkmcnt(0)
    s_barrier
    ds_read_b128 v[48:51], v238 offset:8192
    ds_read_b128 v[52:55], v238 offset:45056
    ds_read_b128 v[56:59], v239 offset:8192
    ds_read_b128 v[60:63], v239 offset:45056
    ds_read_b128 v[64:67], v238 offset:9216
    ds_read_b128 v[68:71], v238 offset:46080
    ds_read_b128 v[72:75], v239 offset:9216
    ds_read_b128 v[76:79], v239 offset:46080
    s_waitcnt lgkmcnt(6)
    v_pk_add_f32 v[48:49], v[48:49], v[52:53]
    s_waitcnt lgkmcnt(4)
    v_pk_add_f32 v[56:57], v[56:57], v[60:61]
    v_pk_add_f32 v[50:51], v[50:51], v[54:55]
    v_pk_add_f32 v[58:59], v[58:59], v[62:63]
    v_pk_add_f32 v[48:49], v[48:49], v[56:57]
    v_pk_add_f32 v[50:51], v[50:51], v[58:59]
    v_cvt_pk_bf16_f32 v52, v48, v49
    v_cvt_pk_bf16_f32 v53, v50, v51
    buffer_store_dwordx2 v[52:53], v212, s[36:39], s68 offen offset:64
    s_waitcnt lgkmcnt(2)
    v_pk_add_f32 v[64:65], v[64:65], v[68:69]
    s_waitcnt lgkmcnt(0)
    v_pk_add_f32 v[72:73], v[72:73], v[76:77]
    v_pk_add_f32 v[66:67], v[66:67], v[70:71]
    v_pk_add_f32 v[74:75], v[74:75], v[78:79]
    v_pk_add_f32 v[64:65], v[64:65], v[72:73]
    v_pk_add_f32 v[66:67], v[66:67], v[74:75]
    v_cvt_pk_bf16_f32 v68, v64, v65
    v_cvt_pk_bf16_f32 v69, v66, v67
    buffer_store_dwordx2 v[68:69], v212, s[36:39], s69 offen offset:64
L_end_P:
    s_endpgm

.section .rodata,"a"
.p2align 6
.amdhsa_kernel sequential_preLN__sliding_local_dilated__mixer_token_mlp__prompt_kernel
  .amdhsa_next_free_vgpr 508
  .amdhsa_next_free_sgpr 102
  .amdhsa_accum_offset 252
  .amdhsa_group_segment_fixed_size 0
  .amdhsa_kernarg_size 88
  .amdhsa_user_sgpr_count 2
  .amdhsa_user_sgpr_kernarg_segment_ptr 1
  .amdhsa_system_sgpr_workgroup_id_x 1
.end_amdhsa_kernel
```

```asm
; @launch grid=(256,1,1) block=(256,1,1) lds=163840
.amdgcn_target "amdgcn-amd-amdhsa--gfx950"
.text
.globl sequential_preLN__sliding_local_dilated__mixer_token_mlp__prompt_kernel
.p2align 8
.type sequential_preLN__sliding_local_dilated__mixer_token_mlp__prompt_kernel,@function
sequential_preLN__sliding_local_dilated__mixer_token_mlp__prompt_kernel:
    s_cmp_ge_u32 s2, 256
    s_cbranch_scc1 L_end_P
    s_load_dwordx2 s[8:9], s[0:1], 0
    s_load_dwordx2 s[12:13], s[0:1], 8
    s_load_dwordx2 s[44:45], s[0:1], 72
    s_load_dwordx2 s[40:41], s[0:1], 80
    s_load_dwordx2 s[16:17], s[0:1], 16
    s_load_dwordx2 s[20:21], s[0:1], 32
    s_load_dwordx2 s[24:25], s[0:1], 48
    s_load_dwordx2 s[28:29], s[0:1], 40
    s_load_dwordx2 s[32:33], s[0:1], 56
    s_load_dwordx2 s[36:37], s[0:1], 64
    v_lshrrev_b32 v1, 6, v0
    s_nop 0
    v_readfirstlane_b32 s3, v1
    v_and_b32 v1, 63, v0
    v_and_b32 v2, 15, v0
    v_lshrrev_b32 v3, 4, v1
    v_lshlrev_b32 v4, 4, v1
    s_mov_b32 s10, 0x1c0000
    s_mov_b32 s11, 0x00020000
    s_mov_b32 s14, 0x126000
    s_mov_b32 s15, 0x00020000
    s_mov_b32 s46, 0x100
    s_mov_b32 s47, 0x00020000
    s_mov_b32 s42, 0x5c0000
    s_mov_b32 s43, 0x00020000
    s_mov_b32 s18, 0x62000
    s_mov_b32 s19, 0x00020000
    s_mov_b32 s22, 0x700000
    s_mov_b32 s23, 0x00020000
    s_mov_b32 s26, 0x700000
    s_mov_b32 s27, 0x00020000
    s_mov_b32 s30, 0xe00
    s_mov_b32 s31, 0x00020000
    s_mov_b32 s34, 0x1000
    s_mov_b32 s35, 0x00020000
    s_mov_b32 s38, 0x1c0000
    s_mov_b32 s39, 0x00020000
    s_mov_b32 s5, 0x3f803f80
    s_mov_b32 s6, 0x200000
    s_bfe_u32 s48, s2, 0x20001
    s_lshl_b32 s48, s48, 2
    s_lshr_b32 s53, s2, 6
    s_add_u32 s48, s48, s53
    s_bfe_u32 s49, s2, 0x30003
    s_and_b32 s53, s2, 1
    s_lshl_b32 s53, s53, 3
    s_add_u32 s49, s49, s53
    v_lshrrev_b32 v237, 2, v1
    v_mul_u32_u24 v123, 2688, v237
    v_lshrrev_b32 v237, 5, v1
    v_lshlrev_b32 v237, 1, v237
    v_and_b32 v238, 3, v1
    v_xor_b32 v237, v237, v238
    v_lshl_add_u32 v123, v237, 4, v123
    s_mul_i32 s53, s49, 56
    s_min_u32 s53, s53, 832
    s_mul_i32 s51, s3, 43008
    s_add_u32 s53, s53, s51
    v_add_u32 v123, s53, v123
    s_lshr_b32 s53, s3, 1
    s_mul_i32 s51, s53, 6144
    s_and_b32 s53, s3, 1
    s_lshl_b32 s53, s53, 10
    s_add_u32 s51, s51, s53
    v_lshrrev_b32 v237, 3, v1
    v_mul_u32_u24 v122, 896, v237
    v_and_b32 v237, 7, v1
    v_xor_b32 v237, v237, v3
    v_lshl_add_u32 v120, v237, 4, v122
    s_lshl_b32 s50, s48, 7
    s_lshl_b32 s53, s3, 5
    s_add_u32 s53, s53, s50
    s_mul_i32 s53, s53, 896
    v_xor_b32 v121, 64, v120
    v_add_u32 v120, s53, v120
    s_add_u32 s53, s53, 7168
    v_add_u32 v121, s53, v121
    s_lshl_b32 s53, s3, 1
    v_xor_b32 v237, s53, v237
    v_lshl_add_u32 v122, v237, 4, v122
    s_lshl_b32 s53, s3, 2
    s_add_u32 s53, s53, s50
    s_sub_u32 s53, s53, 16
    s_mul_i32 s53, s53, 896
    s_cmp_eq_u32 s48, 0
    s_cselect_b32 s53, 0x40000000, s53
    v_add_u32 v122, s53, v122
    s_lshl_b32 s52, s3, 12
    s_add_u32 s52, s52, 63488
    s_lshl_b32 s7, s3, 9
    s_cmp_eq_u32 s3, 0
    s_cselect_b32 s54, 0xffffff00, -1
    s_mov_b32 s55, 0
    s_memrealtime s[86:87]
    v_mov_b32 v7, 0
    s_waitcnt lgkmcnt(0)
    s_or_b32 s86, s86, 1
    v_mov_b32 v6, s86
    s_or_b32 s86, s2, s3
    s_cmp_eq_u32 s86, 0
    s_cselect_b64 exec, 1, 0
    buffer_store_dword v6, v7, s[44:47], 0 offen sc1
    s_mov_b64 exec, -1
    s_add_u32 m0, s51, 12288
    s_mov_b32 s73, 0
    buffer_load_dwordx4 v123, s[12:15], s73 offen lds
    s_add_u32 m0, s51, 14336
    s_mov_b32 s73, 896
    buffer_load_dwordx4 v123, s[12:15], s73 offen lds
    s_add_u32 m0, s51, 16384
    s_mov_b32 s73, 1792
    buffer_load_dwordx4 v123, s[12:15], s73 offen lds
    s_add_u32 m0, s52, 36864
    s_mov_b32 s73, 0
    buffer_load_dwordx4 v120, s[8:11], s73 offen lds
    s_add_u32 m0, s52, 37888
    s_mov_b32 s73, 0
    buffer_load_dwordx4 v121, s[8:11], s73 offen lds
    s_add_u32 m0, s52, 38912
    s_mov_b32 s73, 14336
    buffer_load_dwordx4 v120, s[8:11], s73 offen lds
    s_add_u32 m0, s52, 39936
    s_mov_b32 s73, 14336
    buffer_load_dwordx4 v121, s[8:11], s73 offen lds
    s_add_u32 m0, s7, 98304
    s_mov_b32 s73, 0
    s_mov_b64 exec, s[54:55]
    buffer_load_dwordx4 v122, s[8:11], s73 offen lds
    s_mov_b64 exec, -1
    s_bfe_u32 s53, s2, 0x30003
    s_add_u32 s86, s53, 1
    s_lshr_b32 s86, s86, 1
    s_lshr_b32 s87, s2, 6
    s_mul_i32 s87, s87, 5
    s_add_u32 s86, s86, s87
    s_lshl_b32 s86, s86, 2
    s_add_u32 s53, s86, s3
    s_mov_b32 s56, s53
    s_mov_b32 s86, 0x2a54
    s_bitcmp1_b32 s86, s49
    s_cselect_b32 s57, 0x40000000, 0
    s_mul_i32 s86, s53, 58
    v_add_u32 v237, s86, v1
    v_mul_u32_u24 v238, 43691, v237
    v_lshrrev_b32 v238, 19, v238
    v_mul_u32_u24 v239, 12, v238
    v_sub_u32 v239, v237, v239
    v_lshrrev_b32 v239, 2, v239
    v_mul_u32_u24 v239, 896, v239
    v_mul_u32_u24 v238, 2688, v238
    v_and_b32 v237, 3, v237
    v_lshlrev_b32 v237, 7, v237
    v_add3_u32 v237, v237, v238, v239
    v_add_u32 v237, s57, v237
    s_and_b32 s87, s2, 1
    s_mul_i32 s87, s87, 384
    s_add_u32 s87, s87, 172032
    s_mov_b32 exec_lo, 0xffffffff
    s_mov_b32 exec_hi, 0x3ffffff
    buffer_load_dword v232, v237, s[12:15], s87 offen
    s_mov_b64 exec, -1
    v_lshlrev_b32 v237, 7, v1
    v_add_u32 v238, s57, v237
    s_mul_i32 s86, s53, 6016
    s_bfe_u32 s87, s2, 0x20001
    s_mul_i32 s87, s87, 458752
    s_add_u32 s86, s86, s87
    s_max_u32 s86, s86, 14336
    s_sub_u32 s86, s86, 14336
    s_mov_b32 exec_hi, 0x7fff
    buffer_load_dword v233, v238, s[8:11], s86 offen
    s_getpc_b64 s[86:87]
Lpc_P:
    s_mul_i32 s53, s53, 384
    v_add_u32 v237, s53, v237
    v_min_u32 v237, L_end_P-Lpc_P, v237
    s_mov_b64 exec, 7
    global_load_dword v236, v237, s[86:87]
    s_mov_b64 exec, -1
    v_mul_u32_u24 v237, 18432, v3
    v_lshl_add_u32 v237, v2, 3, v237
    v_mov_b32 v238, s5
    v_add_u32 v237, 61440, v237
    ds_write2_b32 v237, v238, v238 offset0:0 offset1:1
    s_lshr_b32 s68, s2, 3
    s_mul_i32 s69, s68, 37
    s_lshr_b32 s69, s69, 8
    s_mul_i32 s64, s69, 7
    s_sub_u32 s64, s68, s64
    s_mov_b32 s66, s64
    s_and_b32 s68, s2, 7
    s_lshl_b32 s67, s68, 2
    s_add_u32 s67, s67, s69
    s_cmp_ge_u32 s69, 4
    s_cselect_b32 s67, 99, s67
    s_mul_i32 s71, s68, 3
    s_add_u32 s71, s71, 4
    s_lshl_b32 s72, s68, 2
    s_cmp_lt_u32 s68, 4
    s_cselect_b32 s65, s72, s71
    s_cselect_b32 s71, 4, 3
    s_add_u32 s65, s65, s69
    s_cmp_ge_u32 s69, s71
    s_cselect_b32 s65, 99, s65
    v_lshrrev_b32 v219, 3, v1
    v_mul_u32_u24 v208, 896, v219
    v_and_b32 v219, 1, v3
    v_lshlrev_b32 v219, 2, v219
    v_and_b32 v220, 7, v1
    v_xor_b32 v219, v219, v220
    v_lshl_add_u32 v208, v219, 4, v208
    s_lshl_b32 s58, s66, 7
    s_mul_i32 s60, s3, 100352
    s_add_u32 s58, s58, s60
    v_add_u32 v208, s58, v208
    s_mul_i32 s59, s3, 36864
    s_add_u32 s59, s59, 12288
    v_lshrrev_b32 v219, 5, v1
    v_lshlrev_b32 v209, 9, v219
    v_bfe_u32 v219, v1, 2, 2
    v_lshl_add_u32 v209, v219, 7, v209
    v_lshrrev_b32 v219, 1, v219
    s_and_b32 s58, s3, 1
    v_xor_b32 v219, s58, v219
    v_lshl_add_u32 v209, v219, 6, v209
    v_and_b32 v219, 1, v3
    v_lshl_add_u32 v209, v219, 5, v209
    v_and_b32 v219, 3, v1
    v_lshl_add_u32 v209, v219, 3, v209
    v_add_u32 v209, 12288, v209
    v_lshrrev_b32 v219, 5, v1
    v_lshlrev_b32 v219, 10, v219
    v_sub_u32 v210, v209, v219
    s_mul_i32 s70, s3, 36864
    s_add_u32 s70, s70, 12288
    v_lshrrev_b32 v219, 3, v1
    v_mul_u32_u24 v213, 3584, v219
    v_and_b32 v219, 1, v3
    v_lshlrev_b32 v219, 2, v219
    v_and_b32 v220, 7, v1
    v_xor_b32 v219, v219, v220
    v_lshl_add_u32 v213, v219, 4, v213
    s_mul_i32 s68, s3, 1835008
    s_lshl_b32 s69, s65, 7
    s_add_u32 s68, s68, s69
    s_cmp_ge_u32 s65, 99
    s_cselect_b32 s68, 0x40000000, s68
    v_add_u32 v213, s68, v213
    s_cselect_b32 s68, 0x40000000, 0
    v_add_u32 v5, s68, v4
    v_lshrrev_b32 v219, 5, v1
    v_lshlrev_b32 v215, 9, v219
    v_bfe_u32 v219, v1, 2, 2
    v_lshl_add_u32 v215, v219, 7, v215
    v_lshrrev_b32 v219, 1, v219
    s_lshr_b32 s68, s3, 1
    v_xor_b32 v219, s68, v219
    v_lshl_add_u32 v215, v219, 6, v215
    v_and_b32 v219, 1, v3
    v_lshl_add_u32 v215, v219, 5, v215
    v_and_b32 v219, 3, v1
    v_lshl_add_u32 v215, v219, 3, v215
    s_and_b32 s68, s3, 1
    s_lshl_b32 s68, s68, 5
    v_xor_b32 v215, s68, v215
    v_add_u32 v215, s70, v215
    v_xor_b32 v216, 64, v215
    s_mul_i32 s70, s3, 36864
    s_add_u32 s70, s70, 12288
    v_lshrrev_b32 v219, 3, v1
    v_mul_u32_u24 v214, 4096, v219
    v_and_b32 v219, 1, v3
    v_lshlrev_b32 v219, 2, v219
    v_and_b32 v220, 7, v1
    v_xor_b32 v219, v219, v220
    v_lshl_add_u32 v214, v219, 4, v214
    s_mul_i32 s68, s3, 1835008
    s_lshl_b32 s69, s67, 7
    s_add_u32 s68, s68, s69
    s_cmp_ge_u32 s67, 99
    s_cselect_b32 s68, 0x40000000, s68
    v_add_u32 v214, s68, v214
    v_lshrrev_b32 v219, 5, v1
    v_lshlrev_b32 v217, 9, v219
    v_bfe_u32 v219, v1, 2, 2
    v_lshl_add_u32 v217, v219, 7, v217
    v_lshrrev_b32 v219, 1, v219
    s_lshr_b32 s68, s3, 1
    v_xor_b32 v219, s68, v219
    v_lshl_add_u32 v217, v219, 6, v217
    v_and_b32 v219, 1, v3
    v_lshl_add_u32 v217, v219, 5, v217
    v_and_b32 v219, 3, v1
    v_lshl_add_u32 v217, v219, 3, v217
    v_add_u32 v217, s70, v217
    v_xor_b32 v218, 64, v217
    s_and_b32 s68, s2, 7
    s_cmp_ge_u32 s68, 8
    s_cselect_b32 s94, 8, 0
    s_sub_u32 s68, s68, s94
    s_lshl_b32 s94, s68, 12
    s_add_u32 s68, s68, 1
    s_cmp_ge_u32 s68, 8
    s_cselect_b32 s95, 8, 0
    s_sub_u32 s68, s68, s95
    s_lshl_b32 s95, s68, 12
    s_add_u32 s68, s68, 1
    s_cmp_ge_u32 s68, 8
    s_cselect_b32 s96, 8, 0
    s_sub_u32 s68, s68, s96
    s_lshl_b32 s96, s68, 12
    s_add_u32 s68, s68, 1
    s_cmp_ge_u32 s68, 8
    s_cselect_b32 s97, 8, 0
    s_sub_u32 s68, s68, s97
    s_lshl_b32 s97, s68, 12
    s_add_u32 s68, s68, 1
    s_cmp_ge_u32 s68, 8
    s_cselect_b32 s98, 8, 0
    s_sub_u32 s68, s68, s98
    s_lshl_b32 s98, s68, 12
    s_add_u32 s68, s68, 1
    s_cmp_ge_u32 s68, 8
    s_cselect_b32 s99, 8, 0
    s_sub_u32 s68, s68, s99
    s_lshl_b32 s99, s68, 12
    s_add_u32 s68, s68, 1
    s_cmp_ge_u32 s68, 8
    s_cselect_b32 s100, 8, 0
    s_sub_u32 s68, s68, s100
    s_lshl_b32 s100, s68, 12
    s_add_u32 s68, s68, 1
    s_cmp_ge_u32 s68, 8
    s_cselect_b32 s101, 8, 0
    s_sub_u32 s68, s68, s101
    s_lshl_b32 s101, s68, 12
    s_lshl_b32 s80, s48, 2
    s_add_u32 s80, s80, s3
    s_lshl_b32 s80, s80, 11
    s_lshr_b32 s93, s49, 2
    s_lshl_b32 s93, s93, 7
    s_add_u32 s80, s80, s93
    s_and_b32 s93, s49, 3
    s_lshl_b32 s93, s93, 2
    s_add_u32 s80, s80, s93
    s_add_u32 s80, s80, 0x588000
    s_lshl_b32 s83, s67, 1
    s_lshr_b32 s93, s3, 1
    s_add_u32 s83, s83, s93
    s_lshl_b32 s83, s83, 11
    s_add_u32 s83, s83, 0x588000
    v_lshrrev_b32 v10, 2, v2
    v_lshlrev_b32 v10, 7, v10
    v_and_b32 v219, 3, v2
    v_lshl_add_u32 v10, v219, 2, v10
    s_lshl_b32 s84, s64, 12
    s_lshl_b32 s85, s84, 1
    s_add_u32 s85, s85, 0x5b0000
    s_add_u32 s84, s84, 0x5a8000
    s_lshl_b32 s81, s67, 5
    s_add_u32 s81, s81, s3
    s_lshl_b32 s81, s81, 2
    s_add_u32 s81, s81, s84
    s_lshl_b32 s93, s3, 10
    s_add_u32 s84, s84, s93
    v_bfe_u32 v11, v1, 2, 3
    v_min_u32 v12, 6, v11
    v_and_b32 v219, 3, v1
    v_lshlrev_b32 v219, 2, v219
    v_lshl_add_u32 v11, v11, 7, v219
    v_lshl_add_u32 v12, v12, 7, v219
    s_lshl_b32 s82, s65, 5
    s_add_u32 s82, s82, s3
    s_lshl_b32 s82, s82, 2
    s_add_u32 s82, s82, s85
    s_mul_i32 s93, s3, 896
    s_add_u32 s85, s85, s93
    v_mov_b32 v9, 0
    v_lshlrev_b32 v124, 9, v3
    v_bfe_u32 v237, v1, 2, 2
    v_lshl_add_u32 v124, v237, 6, v124
    v_and_b32 v237, 3, v1
    v_lshl_add_u32 v124, v237, 3, v124
    v_and_b32 v237, 1, v3
    v_lshlrev_b32 v237, 5, v237
    v_add_u32 v124, v124, v237
    v_add_u32 v124, 12288, v124
    v_xor_b32 v125, 32, v124
    s_and_b32 s53, s3, 1
    s_lshl_b32 s53, s53, 5
    v_xor_b32 v127, s53, v124
    s_lshr_b32 s53, s3, 1
    s_lshl_b32 s53, s53, 11
    s_add_u32 s53, s53, 2048
    v_add_u32 v126, s53, v127
    v_lshrrev_b32 v237, 1, v2
    v_xor_b32 v237, v237, v3
    v_lshlrev_b32 v237, 4, v237
    v_lshl_add_u32 v237, v2, 7, v237
    v_add_u32 v130, 61440, v237
    v_xor_b32 v131, 64, v130
    v_add_u32 v128, s52, v237
    v_xor_b32 v129, 64, v128
    v_lshlrev_b32 v237, 2, v3
    v_sub_u32 v237, v2, v237
    v_mov_b32 v239, 0xf149f2ca
    v_add_u32 v238, 16, v237
    v_and_b32 v238, 0xfffffff1, v238
    v_cmp_eq_u32 vcc, 0, v238
    s_nop 1
    v_cndmask_b32 v240, v239, 0, vcc
    v_add_u32 v238, 15, v237
    v_and_b32 v238, 0xfffffff1, v238
    v_cmp_eq_u32 vcc, 0, v238
    s_nop 1
    v_cndmask_b32 v241, v239, 0, vcc
    v_add_u32 v238, 14, v237
    v_and_b32 v238, 0xfffffff1, v238
    v_cmp_eq_u32 vcc, 0, v238
    s_nop 1
    v_cndmask_b32 v242, v239, 0, vcc
    v_add_u32 v238, 13, v237
    v_and_b32 v238, 0xfffffff1, v238
    v_cmp_eq_u32 vcc, 0, v238
    s_nop 1
    v_cndmask_b32 v243, v239, 0, vcc
    v_add_u32 v238, 0, v237
    v_and_b32 v238, 0xfffffff1, v238
    v_cmp_eq_u32 vcc, 0, v238
    s_nop 1
    v_cndmask_b32 v244, v239, 0, vcc
    v_add_u32 v238, -1, v237
    v_and_b32 v238, 0xfffffff1, v238
    v_cmp_eq_u32 vcc, 0, v238
    s_nop 1
    v_cndmask_b32 v245, v239, 0, vcc
    v_add_u32 v238, -2, v237
    v_and_b32 v238, 0xfffffff1, v238
    v_cmp_eq_u32 vcc, 0, v238
    s_nop 1
    v_cndmask_b32 v246, v239, 0, vcc
    v_add_u32 v238, -3, v237
    v_and_b32 v238, 0xfffffff1, v238
    v_cmp_eq_u32 vcc, 0, v238
    s_nop 1
    v_cndmask_b32 v247, v239, 0, vcc
    s_or_b32 s53, s48, s3
    s_cmp_eq_u32 s53, 0
    s_cselect_b64 vcc, -1, 0
    v_cndmask_b32 v248, v240, v239, vcc
    v_cndmask_b32 v249, v241, v239, vcc
    v_cndmask_b32 v250, v242, v239, vcc
    v_cndmask_b32 v251, v243, v239, vcc
    v_mov_b32 v40, s5
    v_mov_b32 v41, s5
    v_mov_b32 v42, s5
    v_mov_b32 v43, s5
    s_mov_b32 s88, 0x22222222
    s_mov_b32 s89, 0x22222222
    s_mov_b32 s90, 0x44444444
    s_mov_b32 s91, 0x44444444
    s_mov_b32 s92, 0x88888888
    s_mov_b32 s93, 0x88888888
    v_lshlrev_b32 v72, 4, v3
    s_lshl_b32 s53, s3, 6
    v_add_u32 v73, s53, v72
    s_and_b32 s53, s53, 64
    v_add_u32 v74, s53, v72
    s_mul_i32 s53, s3, 384
    v_lshl_add_u32 v75, v2, 2, s53
    v_add_u32 v76, s53, v72
    s_and_b32 s53, s3, 1
    s_lshl_b32 s53, s53, 3
    v_add_u32 v80, s53, v4
    v_lshrrev_b32 v81, 2, v2
    v_lshlrev_b32 v81, 8, v81
    v_lshl_add_u32 v81, v3, 6, v81
    v_and_b32 v82, 3, v2
    v_lshl_add_u32 v81, v82, 1, v81
    v_add_u32 v81, s53, v81
    v_add_u32 v81, 1024, v81
    s_cmp_lt_u32 s3, 2
    s_cselect_b64 vcc, -1, 0
    s_cselect_b32 s53, 2, 16
    v_cndmask_b32 v80, v81, v80, vcc
    v_add_u32 v81, s53, v80
    v_add_u32 v82, s53, v81
    v_add_u32 v83, s53, v82
    v_lshlrev_b32 v77, 2, v2
    s_lshl_b32 s53, s3, 11
    v_add_u32 v78, s53, v4
    s_lshl_b32 s62, s48, 3
    s_lshl_b32 s63, s3, 1
    s_add_u32 s62, s62, s63
    s_lshl_b32 s62, s62, 4
    s_add_u32 s62, s62, s49
    s_lshl_b32 s62, s62, 10
    s_add_u32 s63, s62, 16384
    s_add_u32 m0, s51, 24576
    s_mov_b32 s73, 172032
    buffer_load_dwordx4 v123, s[12:15], s73 offen lds
    s_add_u32 m0, s51, 26624
    s_mov_b32 s73, 172928
    buffer_load_dwordx4 v123, s[12:15], s73 offen lds
    s_add_u32 m0, s51, 28672
    s_mov_b32 s73, 173824
    buffer_load_dwordx4 v123, s[12:15], s73 offen lds
    s_add_u32 m0, s52, 18432
    s_mov_b32 s73, 128
    buffer_load_dwordx4 v120, s[8:11], s73 offen lds
    s_add_u32 m0, s52, 19456
    s_mov_b32 s73, 128
    buffer_load_dwordx4 v121, s[8:11], s73 offen lds
    s_add_u32 m0, s52, 20480
    s_mov_b32 s73, 14464
    buffer_load_dwordx4 v120, s[8:11], s73 offen lds
    s_add_u32 m0, s52, 21504
    s_mov_b32 s73, 14464
    buffer_load_dwordx4 v121, s[8:11], s73 offen lds
    s_add_u32 m0, s7, 79872
    s_mov_b32 s73, 128
    s_mov_b64 exec, s[54:55]
    buffer_load_dwordx4 v122, s[8:11], s73 offen lds
    s_mov_b64 exec, -1
    s_waitcnt vmcnt(11)
    s_waitcnt lgkmcnt(0)
    s_barrier
    ds_read_b128 v[16:19], v128 offset:36864
    ds_read_b128 v[20:23], v128 offset:38912
    ds_read_b128 v[24:27], v130 offset:36864
    ds_read_b64_tr_b16 v[88:89], v124 offset:0
    ds_read_b64_tr_b16 v[90:91], v124 offset:256
    ds_read_b64_tr_b16 v[92:93], v125 offset:0
    ds_read_b64_tr_b16 v[94:95], v125 offset:256
    ds_read_b64_tr_b16 v[96:97], v124 offset:2048
    ds_read_b64_tr_b16 v[98:99], v124 offset:2304
    ds_read_b64_tr_b16 v[100:101], v125 offset:2048
    ds_read_b64_tr_b16 v[102:103], v125 offset:2304
    ds_read_b64_tr_b16 v[104:105], v124 offset:4096
    ds_read_b64_tr_b16 v[106:107], v124 offset:4352
    ds_read_b64_tr_b16 v[108:109], v125 offset:4096
    ds_read_b64_tr_b16 v[110:111], v125 offset:4352
    ds_read_b64_tr_b16 v[112:113], v126 offset:0
    ds_read_b64_tr_b16 v[114:115], v126 offset:256
    ds_read_b64_tr_b16 v[116:117], v127 offset:0
    ds_read_b64_tr_b16 v[118:119], v127 offset:256
    s_waitcnt lgkmcnt(8)
    v_mfma_f32_16x16x32_bf16 v[136:139], v[88:91], v[16:19], 0
    ds_read_b128 v[28:31], v129 offset:36864
    v_mfma_f32_16x16x32_bf16 v[160:163], v[88:91], v[20:23], 0
    ds_read_b128 v[32:35], v129 offset:38912
    v_mfma_f32_16x16x32_bf16 v[140:143], v[92:95], v[16:19], 0
    ds_read_b128 v[36:39], v131 offset:36864
    v_mfma_f32_16x16x32_bf16 v[164:167], v[92:95], v[20:23], 0
    ds_read_b64_tr_b16 v[88:89], v124 offset:6144
    v_mfma_f32_16x16x32_bf16 v[144:147], v[96:99], v[16:19], 0
    ds_read_b64_tr_b16 v[90:91], v124 offset:6400
    s_add_u32 m0, s51, 36864
    s_mov_b32 s73, 344064
    buffer_load_dwordx4 v123, s[12:15], s73 offen lds
    v_mfma_f32_16x16x32_bf16 v[168:171], v[96:99], v[20:23], 0
    ds_read_b64_tr_b16 v[92:93], v125 offset:6144
    v_mfma_f32_16x16x32_bf16 v[148:151], v[100:103], v[16:19], 0
    ds_read_b64_tr_b16 v[94:95], v125 offset:6400
    v_mfma_f32_16x16x32_bf16 v[172:175], v[100:103], v[20:23], 0
    ds_read_b64_tr_b16 v[96:97], v124 offset:8192
    s_waitcnt lgkmcnt(8)
    v_mfma_f32_16x16x32_bf16 v[152:155], v[16:19], v[104:107], 0
    ds_read_b64_tr_b16 v[98:99], v124 offset:8448
    v_mfma_f32_16x16x32_bf16 v[176:179], v[20:23], v[104:107], 0
    ds_read_b64_tr_b16 v[100:101], v125 offset:8192
    s_add_u32 m0, s51, 38912
    s_mov_b32 s73, 344960
    buffer_load_dwordx4 v123, s[12:15], s73 offen lds
    v_mfma_f32_16x16x32_bf16 v[156:159], v[16:19], v[108:111], 0
    ds_read_b64_tr_b16 v[102:103], v125 offset:8448
    v_mfma_f32_16x16x32_bf16 v[180:183], v[20:23], v[108:111], 0
    ds_read_b64_tr_b16 v[104:105], v124 offset:10240
    v_mfma_f32_16x16x32_bf16 v[184:187], v[112:115], v[24:27], 0
    ds_read_b64_tr_b16 v[106:107], v124 offset:10496
    v_mfma_f32_16x16x32_bf16 v[188:191], v[116:119], v[24:27], 0
    ds_read_b64_tr_b16 v[108:109], v125 offset:10240
    v_mfma_f32_16x16x32_bf16 v[48:51], v[16:19], v[16:19], 0
    ds_read_b64_tr_b16 v[110:111], v125 offset:10496
    s_add_u32 m0, s51, 40960
    s_mov_b32 s73, 345856
    buffer_load_dwordx4 v123, s[12:15], s73 offen lds
    v_mfma_f32_16x16x32_bf16 v[52:55], v[20:23], v[20:23], 0
    ds_read_b64_tr_b16 v[112:113], v126 offset:6144
    v_mfma_f32_16x16x32_bf16 v[56:59], v[24:27], v[24:27], 0
    ds_read_b64_tr_b16 v[114:115], v126 offset:6400
    v_mfma_f32_16x16x32_bf16 v[60:63], v[40:43], v[16:19], 0
    ds_read_b64_tr_b16 v[116:117], v127 offset:6144
    v_mfma_f32_16x16x32_bf16 v[64:67], v[40:43], v[20:23], 0
    ds_read_b64_tr_b16 v[118:119], v127 offset:6400
    v_mfma_f32_16x16x32_bf16 v[68:71], v[40:43], v[24:27], 0
    s_add_u32 m0, s52, 0
    s_mov_b32 s73, 256
    buffer_load_dwordx4 v120, s[8:11], s73 offen lds
    s_add_u32 m0, s52, 1024
    s_mov_b32 s73, 256
    buffer_load_dwordx4 v121, s[8:11], s73 offen lds
    s_add_u32 m0, s52, 2048
    s_mov_b32 s73, 14592
    buffer_load_dwordx4 v120, s[8:11], s73 offen lds
    s_add_u32 m0, s52, 3072
    s_mov_b32 s73, 14592
    buffer_load_dwordx4 v121, s[8:11], s73 offen lds
    s_add_u32 m0, s7, 61440
    s_mov_b32 s73, 256
    s_mov_b64 exec, s[54:55]
    buffer_load_dwordx4 v122, s[8:11], s73 offen lds
    s_mov_b64 exec, -1
    s_waitcnt vmcnt(8)
    s_barrier
    s_waitcnt lgkmcnt(8)
    v_mfma_f32_16x16x32_bf16 v[136:139], v[88:91], v[28:31], v[136:139]
    ds_read_b128 v[16:19], v128 offset:18432
    v_mfma_f32_16x16x32_bf16 v[160:163], v[88:91], v[32:35], v[160:163]
    ds_read_b128 v[20:23], v128 offset:20480
    v_mfma_f32_16x16x32_bf16 v[140:143], v[92:95], v[28:31], v[140:143]
    ds_read_b128 v[24:27], v130 offset:18432
    v_mfma_f32_16x16x32_bf16 v[164:167], v[92:95], v[32:35], v[164:167]
    ds_read_b64_tr_b16 v[88:89], v124 offset:12288
    v_mfma_f32_16x16x32_bf16 v[144:147], v[96:99], v[28:31], v[144:147]
    ds_read_b64_tr_b16 v[90:91], v124 offset:12544
    s_add_u32 m0, s51, 49152
    s_mov_b32 s73, 516096
    buffer_load_dwordx4 v123, s[12:15], s73 offen lds
    v_mfma_f32_16x16x32_bf16 v[168:171], v[96:99], v[32:35], v[168:171]
    ds_read_b64_tr_b16 v[92:93], v125 offset:12288
    v_mfma_f32_16x16x32_bf16 v[148:151], v[100:103], v[28:31], v[148:151]
    ds_read_b64_tr_b16 v[94:95], v125 offset:12544
    v_mfma_f32_16x16x32_bf16 v[172:175], v[100:103], v[32:35], v[172:175]
    ds_read_b64_tr_b16 v[96:97], v124 offset:14336
    s_waitcnt lgkmcnt(8)
    v_mfma_f32_16x16x32_bf16 v[152:155], v[28:31], v[104:107], v[152:155]
    ds_read_b64_tr_b16 v[98:99], v124 offset:14592
    v_mfma_f32_16x16x32_bf16 v[176:179], v[32:35], v[104:107], v[176:179]
    ds_read_b64_tr_b16 v[100:101], v125 offset:14336
    s_add_u32 m0, s51, 51200
    s_mov_b32 s73, 516992
    buffer_load_dwordx4 v123, s[12:15], s73 offen lds
    v_mfma_f32_16x16x32_bf16 v[156:159], v[28:31], v[108:111], v[156:159]
    ds_read_b64_tr_b16 v[102:103], v125 offset:14592
    v_mfma_f32_16x16x32_bf16 v[180:183], v[32:35], v[108:111], v[180:183]
    ds_read_b64_tr_b16 v[104:105], v124 offset:16384
    v_mfma_f32_16x16x32_bf16 v[184:187], v[112:115], v[36:39], v[184:187]
    ds_read_b64_tr_b16 v[106:107], v124 offset:16640
    v_mfma_f32_16x16x32_bf16 v[188:191], v[116:119], v[36:39], v[188:191]
    ds_read_b64_tr_b16 v[108:109], v125 offset:16384
    v_mfma_f32_16x16x32_bf16 v[48:51], v[28:31], v[28:31], v[48:51]
    ds_read_b64_tr_b16 v[110:111], v125 offset:16640
    s_add_u32 m0, s51, 53248
    s_mov_b32 s73, 517888
    buffer_load_dwordx4 v123, s[12:15], s73 offen lds
    v_mfma_f32_16x16x32_bf16 v[52:55], v[32:35], v[32:35], v[52:55]
    ds_read_b64_tr_b16 v[112:113], v126 offset:12288
    v_mfma_f32_16x16x32_bf16 v[56:59], v[36:39], v[36:39], v[56:59]
    ds_read_b64_tr_b16 v[114:115], v126 offset:12544
    v_mfma_f32_16x16x32_bf16 v[60:63], v[40:43], v[28:31], v[60:63]
    ds_read_b64_tr_b16 v[116:117], v127 offset:12288
    v_mfma_f32_16x16x32_bf16 v[64:67], v[40:43], v[32:35], v[64:67]
    ds_read_b64_tr_b16 v[118:119], v127 offset:12544
    v_mfma_f32_16x16x32_bf16 v[68:71], v[40:43], v[36:39], v[68:71]
    s_add_u32 m0, s52, 55296
    s_mov_b32 s73, 384
    buffer_load_dwordx4 v120, s[8:11], s73 offen lds
    s_waitcnt lgkmcnt(8)
    v_mfma_f32_16x16x32_bf16 v[136:139], v[88:91], v[16:19], v[136:139]
    ds_read_b128 v[28:31], v129 offset:18432
    v_mfma_f32_16x16x32_bf16 v[160:163], v[88:91], v[20:23], v[160:163]
    ds_read_b128 v[32:35], v129 offset:20480
    v_mfma_f32_16x16x32_bf16 v[140:143], v[92:95], v[16:19], v[140:143]
    ds_read_b128 v[36:39], v131 offset:18432
    v_mfma_f32_16x16x32_bf16 v[164:167], v[92:95], v[20:23], v[164:167]
    ds_read_b64_tr_b16 v[88:89], v124 offset:18432
    v_mfma_f32_16x16x32_bf16 v[144:147], v[96:99], v[16:19], v[144:147]
    ds_read_b64_tr_b16 v[90:91], v124 offset:18688
    s_add_u32 m0, s52, 56320
    s_mov_b32 s73, 384
    buffer_load_dwordx4 v121, s[8:11], s73 offen lds
    v_mfma_f32_16x16x32_bf16 v[168:171], v[96:99], v[20:23], v[168:171]
    ds_read_b64_tr_b16 v[92:93], v125 offset:18432
    v_mfma_f32_16x16x32_bf16 v[148:151], v[100:103], v[16:19], v[148:151]
    ds_read_b64_tr_b16 v[94:95], v125 offset:18688
    v_mfma_f32_16x16x32_bf16 v[172:175], v[100:103], v[20:23], v[172:175]
    ds_read_b64_tr_b16 v[96:97], v124 offset:20480
    s_waitcnt lgkmcnt(8)
    v_mfma_f32_16x16x32_bf16 v[152:155], v[16:19], v[104:107], v[152:155]
    ds_read_b64_tr_b16 v[98:99], v124 offset:20736
    v_mfma_f32_16x16x32_bf16 v[176:179], v[20:23], v[104:107], v[176:179]
    ds_read_b64_tr_b16 v[100:101], v125 offset:20480
    s_add_u32 m0, s52, 57344
    s_mov_b32 s73, 14720
    buffer_load_dwordx4 v120, s[8:11], s73 offen lds
    v_mfma_f32_16x16x32_bf16 v[156:159], v[16:19], v[108:111], v[156:159]
    ds_read_b64_tr_b16 v[102:103], v125 offset:20736
    v_mfma_f32_16x16x32_bf16 v[180:183], v[20:23], v[108:111], v[180:183]
    ds_read_b64_tr_b16 v[104:105], v124 offset:22528
    v_mfma_f32_16x16x32_bf16 v[184:187], v[112:115], v[24:27], v[184:187]
    ds_read_b64_tr_b16 v[106:107], v124 offset:22784
    v_mfma_f32_16x16x32_bf16 v[188:191], v[116:119], v[24:27], v[188:191]
    ds_read_b64_tr_b16 v[108:109], v125 offset:22528
    v_mfma_f32_16x16x32_bf16 v[48:51], v[16:19], v[16:19], v[48:51]
    ds_read_b64_tr_b16 v[110:111], v125 offset:22784
    s_add_u32 m0, s52, 58368
    s_mov_b32 s73, 14720
    buffer_load_dwordx4 v121, s[8:11], s73 offen lds
    v_mfma_f32_16x16x32_bf16 v[52:55], v[20:23], v[20:23], v[52:55]
    ds_read_b64_tr_b16 v[112:113], v126 offset:18432
    v_mfma_f32_16x16x32_bf16 v[56:59], v[24:27], v[24:27], v[56:59]
    ds_read_b64_tr_b16 v[114:115], v126 offset:18688
    v_mfma_f32_16x16x32_bf16 v[60:63], v[40:43], v[16:19], v[60:63]
    ds_read_b64_tr_b16 v[116:117], v127 offset:18432
    v_mfma_f32_16x16x32_bf16 v[64:67], v[40:43], v[20:23], v[64:67]
    ds_read_b64_tr_b16 v[118:119], v127 offset:18688
    v_mfma_f32_16x16x32_bf16 v[68:71], v[40:43], v[24:27], v[68:71]
    s_add_u32 m0, s7, 116736
    s_mov_b32 s73, 384
    s_mov_b64 exec, s[54:55]
    buffer_load_dwordx4 v122, s[8:11], s73 offen lds
    s_mov_b64 exec, -1
    s_waitcnt vmcnt(8)
    s_barrier
    s_waitcnt lgkmcnt(8)
    v_mfma_f32_16x16x32_bf16 v[136:139], v[88:91], v[28:31], v[136:139]
    ds_read_b128 v[16:19], v128 offset:0
    v_mfma_f32_16x16x32_bf16 v[160:163], v[88:91], v[32:35], v[160:163]
    ds_read_b128 v[20:23], v128 offset:2048
    v_mfma_f32_16x16x32_bf16 v[140:143], v[92:95], v[28:31], v[140:143]
    ds_read_b128 v[24:27], v130 offset:0
    v_mfma_f32_16x16x32_bf16 v[164:167], v[92:95], v[32:35], v[164:167]
    ds_read_b64_tr_b16 v[88:89], v124 offset:24576
    v_mfma_f32_16x16x32_bf16 v[144:147], v[96:99], v[28:31], v[144:147]
    ds_read_b64_tr_b16 v[90:91], v124 offset:24832
    s_add_u32 m0, s51, 12288
    s_mov_b32 s73, 688128
    buffer_load_dwordx4 v123, s[12:15], s73 offen lds
    v_mfma_f32_16x16x32_bf16 v[168:171], v[96:99], v[32:35], v[168:171]
    ds_read_b64_tr_b16 v[92:93], v125 offset:24576
    v_mfma_f32_16x16x32_bf16 v[148:151], v[100:103], v[28:31], v[148:151]
    ds_read_b64_tr_b16 v[94:95], v125 offset:24832
    v_mfma_f32_16x16x32_bf16 v[172:175], v[100:103], v[32:35], v[172:175]
    ds_read_b64_tr_b16 v[96:97], v124 offset:26624
    s_waitcnt lgkmcnt(8)
    v_mfma_f32_16x16x32_bf16 v[152:155], v[28:31], v[104:107], v[152:155]
    ds_read_b64_tr_b16 v[98:99], v124 offset:26880
    v_mfma_f32_16x16x32_bf16 v[176:179], v[32:35], v[104:107], v[176:179]
    ds_read_b64_tr_b16 v[100:101], v125 offset:26624
    s_add_u32 m0, s51, 14336
    s_mov_b32 s73, 689024
    buffer_load_dwordx4 v123, s[12:15], s73 offen lds
    v_mfma_f32_16x16x32_bf16 v[156:159], v[28:31], v[108:111], v[156:159]
    ds_read_b64_tr_b16 v[102:103], v125 offset:26880
    v_mfma_f32_16x16x32_bf16 v[180:183], v[32:35], v[108:111], v[180:183]
    ds_read_b64_tr_b16 v[104:105], v124 offset:28672
    v_mfma_f32_16x16x32_bf16 v[184:187], v[112:115], v[36:39], v[184:187]
    ds_read_b64_tr_b16 v[106:107], v124 offset:28928
    v_mfma_f32_16x16x32_bf16 v[188:191], v[116:119], v[36:39], v[188:191]
    ds_read_b64_tr_b16 v[108:109], v125 offset:28672
    v_mfma_f32_16x16x32_bf16 v[48:51], v[28:31], v[28:31], v[48:51]
    ds_read_b64_tr_b16 v[110:111], v125 offset:28928
    s_add_u32 m0, s51, 16384
    s_mov_b32 s73, 689920
    buffer_load_dwordx4 v123, s[12:15], s73 offen lds
    v_mfma_f32_16x16x32_bf16 v[52:55], v[32:35], v[32:35], v[52:55]
    ds_read_b64_tr_b16 v[112:113], v126 offset:24576
    v_mfma_f32_16x16x32_bf16 v[56:59], v[36:39], v[36:39], v[56:59]
    ds_read_b64_tr_b16 v[114:115], v126 offset:24832
    v_mfma_f32_16x16x32_bf16 v[60:63], v[40:43], v[28:31], v[60:63]
    ds_read_b64_tr_b16 v[116:117], v127 offset:24576
    v_mfma_f32_16x16x32_bf16 v[64:67], v[40:43], v[32:35], v[64:67]
    ds_read_b64_tr_b16 v[118:119], v127 offset:24832
    v_mfma_f32_16x16x32_bf16 v[68:71], v[40:43], v[36:39], v[68:71]
    s_add_u32 m0, s52, 36864
    s_mov_b32 s73, 512
    buffer_load_dwordx4 v120, s[8:11], s73 offen lds
    s_waitcnt lgkmcnt(8)
    v_mfma_f32_16x16x32_bf16 v[136:139], v[88:91], v[16:19], v[136:139]
    ds_read_b128 v[28:31], v129 offset:0
    v_mfma_f32_16x16x32_bf16 v[160:163], v[88:91], v[20:23], v[160:163]
    ds_read_b128 v[32:35], v129 offset:2048
    v_mfma_f32_16x16x32_bf16 v[140:143], v[92:95], v[16:19], v[140:143]
    ds_read_b128 v[36:39], v131 offset:0
    v_mfma_f32_16x16x32_bf16 v[164:167], v[92:95], v[20:23], v[164:167]
    ds_read_b64_tr_b16 v[88:89], v124 offset:30720
    v_mfma_f32_16x16x32_bf16 v[144:147], v[96:99], v[16:19], v[144:147]
    ds_read_b64_tr_b16 v[90:91], v124 offset:30976
    s_add_u32 m0, s52, 37888
    s_mov_b32 s73, 512
    buffer_load_dwordx4 v121, s[8:11], s73 offen lds
    v_mfma_f32_16x16x32_bf16 v[168:171], v[96:99], v[20:23], v[168:171]
    ds_read_b64_tr_b16 v[92:93], v125 offset:30720
    v_mfma_f32_16x16x32_bf16 v[148:151], v[100:103], v[16:19], v[148:151]
    ds_read_b64_tr_b16 v[94:95], v125 offset:30976
    v_mfma_f32_16x16x32_bf16 v[172:175], v[100:103], v[20:23], v[172:175]
    ds_read_b64_tr_b16 v[96:97], v124 offset:32768
    s_waitcnt lgkmcnt(8)
    v_mfma_f32_16x16x32_bf16 v[152:155], v[16:19], v[104:107], v[152:155]
    ds_read_b64_tr_b16 v[98:99], v124 offset:33024
    v_mfma_f32_16x16x32_bf16 v[176:179], v[20:23], v[104:107], v[176:179]
    ds_read_b64_tr_b16 v[100:101], v125 offset:32768
    s_add_u32 m0, s52, 38912
    s_mov_b32 s73, 14848
    buffer_load_dwordx4 v120, s[8:11], s73 offen lds
    v_mfma_f32_16x16x32_bf16 v[156:159], v[16:19], v[108:111], v[156:159]
    ds_read_b64_tr_b16 v[102:103], v125 offset:33024
    v_mfma_f32_16x16x32_bf16 v[180:183], v[20:23], v[108:111], v[180:183]
    ds_read_b64_tr_b16 v[104:105], v124 offset:34816
    v_mfma_f32_16x16x32_bf16 v[184:187], v[112:115], v[24:27], v[184:187]
    ds_read_b64_tr_b16 v[106:107], v124 offset:35072
    v_mfma_f32_16x16x32_bf16 v[188:191], v[116:119], v[24:27], v[188:191]
    ds_read_b64_tr_b16 v[108:109], v125 offset:34816
    v_mfma_f32_16x16x32_bf16 v[48:51], v[16:19], v[16:19], v[48:51]
    ds_read_b64_tr_b16 v[110:111], v125 offset:35072
    s_add_u32 m0, s52, 39936
    s_mov_b32 s73, 14848
    buffer_load_dwordx4 v121, s[8:11], s73 offen lds
    v_mfma_f32_16x16x32_bf16 v[52:55], v[20:23], v[20:23], v[52:55]
    ds_read_b64_tr_b16 v[112:113], v126 offset:30720
    v_mfma_f32_16x16x32_bf16 v[56:59], v[24:27], v[24:27], v[56:59]
    ds_read_b64_tr_b16 v[114:115], v126 offset:30976
    v_mfma_f32_16x16x32_bf16 v[60:63], v[40:43], v[16:19], v[60:63]
    ds_read_b64_tr_b16 v[116:117], v127 offset:30720
    v_mfma_f32_16x16x32_bf16 v[64:67], v[40:43], v[20:23], v[64:67]
    ds_read_b64_tr_b16 v[118:119], v127 offset:30976
    v_mfma_f32_16x16x32_bf16 v[68:71], v[40:43], v[24:27], v[68:71]
    s_add_u32 m0, s7, 98304
    s_mov_b32 s73, 512
    s_mov_b64 exec, s[54:55]
    buffer_load_dwordx4 v122, s[8:11], s73 offen lds
    s_mov_b64 exec, -1
    s_waitcnt vmcnt(8)
    s_barrier
    s_waitcnt lgkmcnt(8)
    v_mfma_f32_16x16x32_bf16 v[136:139], v[88:91], v[28:31], v[136:139]
    ds_read_b128 v[16:19], v128 offset:55296
    v_mfma_f32_16x16x32_bf16 v[160:163], v[88:91], v[32:35], v[160:163]
    ds_read_b128 v[20:23], v128 offset:57344
    v_mfma_f32_16x16x32_bf16 v[140:143], v[92:95], v[28:31], v[140:143]
    ds_read_b128 v[24:27], v130 offset:55296
    v_mfma_f32_16x16x32_bf16 v[164:167], v[92:95], v[32:35], v[164:167]
    ds_read_b64_tr_b16 v[88:89], v124 offset:36864
    v_mfma_f32_16x16x32_bf16 v[144:147], v[96:99], v[28:31], v[144:147]
    ds_read_b64_tr_b16 v[90:91], v124 offset:37120
    s_add_u32 m0, s51, 24576
    s_mov_b32 s73, 860160
    buffer_load_dwordx4 v123, s[12:15], s73 offen lds
    v_mfma_f32_16x16x32_bf16 v[168:171], v[96:99], v[32:35], v[168:171]
    ds_read_b64_tr_b16 v[92:93], v125 offset:36864
    v_mfma_f32_16x16x32_bf16 v[148:151], v[100:103], v[28:31], v[148:151]
    ds_read_b64_tr_b16 v[94:95], v125 offset:37120
    v_mfma_f32_16x16x32_bf16 v[172:175], v[100:103], v[32:35], v[172:175]
    ds_read_b64_tr_b16 v[96:97], v124 offset:38912
    s_waitcnt lgkmcnt(8)
    v_mfma_f32_16x16x32_bf16 v[152:155], v[28:31], v[104:107], v[152:155]
    ds_read_b64_tr_b16 v[98:99], v124 offset:39168
    v_mfma_f32_16x16x32_bf16 v[176:179], v[32:35], v[104:107], v[176:179]
    ds_read_b64_tr_b16 v[100:101], v125 offset:38912
    s_add_u32 m0, s51, 26624
    s_mov_b32 s73, 861056
    buffer_load_dwordx4 v123, s[12:15], s73 offen lds
    v_mfma_f32_16x16x32_bf16 v[156:159], v[28:31], v[108:111], v[156:159]
    ds_read_b64_tr_b16 v[102:103], v125 offset:39168
    v_mfma_f32_16x16x32_bf16 v[180:183], v[32:35], v[108:111], v[180:183]
    ds_read_b64_tr_b16 v[104:105], v124 offset:40960
    v_mfma_f32_16x16x32_bf16 v[184:187], v[112:115], v[36:39], v[184:187]
    ds_read_b64_tr_b16 v[106:107], v124 offset:41216
    v_mfma_f32_16x16x32_bf16 v[188:191], v[116:119], v[36:39], v[188:191]
    ds_read_b64_tr_b16 v[108:109], v125 offset:40960
    v_mfma_f32_16x16x32_bf16 v[48:51], v[28:31], v[28:31], v[48:51]
    ds_read_b64_tr_b16 v[110:111], v125 offset:41216
    s_add_u32 m0, s51, 28672
    s_mov_b32 s73, 861952
    buffer_load_dwordx4 v123, s[12:15], s73 offen lds
    v_mfma_f32_16x16x32_bf16 v[52:55], v[32:35], v[32:35], v[52:55]
    ds_read_b64_tr_b16 v[112:113], v126 offset:36864
    v_mfma_f32_16x16x32_bf16 v[56:59], v[36:39], v[36:39], v[56:59]
    ds_read_b64_tr_b16 v[114:115], v126 offset:37120
    v_mfma_f32_16x16x32_bf16 v[60:63], v[40:43], v[28:31], v[60:63]
    ds_read_b64_tr_b16 v[116:117], v127 offset:36864
    v_mfma_f32_16x16x32_bf16 v[64:67], v[40:43], v[32:35], v[64:67]
    ds_read_b64_tr_b16 v[118:119], v127 offset:37120
    v_mfma_f32_16x16x32_bf16 v[68:71], v[40:43], v[36:39], v[68:71]
    s_add_u32 m0, s52, 18432
    s_mov_b32 s73, 640
    buffer_load_dwordx4 v120, s[8:11], s73 offen lds
    s_waitcnt lgkmcnt(8)
    v_mfma_f32_16x16x32_bf16 v[136:139], v[88:91], v[16:19], v[136:139]
    ds_read_b128 v[28:31], v129 offset:55296
    v_mfma_f32_16x16x32_bf16 v[160:163], v[88:91], v[20:23], v[160:163]
    ds_read_b128 v[32:35], v129 offset:57344
    v_mfma_f32_16x16x32_bf16 v[140:143], v[92:95], v[16:19], v[140:143]
    ds_read_b128 v[36:39], v131 offset:55296
    v_mfma_f32_16x16x32_bf16 v[164:167], v[92:95], v[20:23], v[164:167]
    ds_read_b64_tr_b16 v[88:89], v124 offset:43008
    v_mfma_f32_16x16x32_bf16 v[144:147], v[96:99], v[16:19], v[144:147]
    ds_read_b64_tr_b16 v[90:91], v124 offset:43264
    s_add_u32 m0, s52, 19456
    s_mov_b32 s73, 640
    buffer_load_dwordx4 v121, s[8:11], s73 offen lds
    v_mfma_f32_16x16x32_bf16 v[168:171], v[96:99], v[20:23], v[168:171]
    ds_read_b64_tr_b16 v[92:93], v125 offset:43008
    v_mfma_f32_16x16x32_bf16 v[148:151], v[100:103], v[16:19], v[148:151]
    ds_read_b64_tr_b16 v[94:95], v125 offset:43264
    v_mfma_f32_16x16x32_bf16 v[172:175], v[100:103], v[20:23], v[172:175]
    ds_read_b64_tr_b16 v[96:97], v124 offset:45056
    s_waitcnt lgkmcnt(8)
    v_mfma_f32_16x16x32_bf16 v[152:155], v[16:19], v[104:107], v[152:155]
    ds_read_b64_tr_b16 v[98:99], v124 offset:45312
    v_mfma_f32_16x16x32_bf16 v[176:179], v[20:23], v[104:107], v[176:179]
    ds_read_b64_tr_b16 v[100:101], v125 offset:45056
    s_add_u32 m0, s52, 20480
    s_mov_b32 s73, 14976
    buffer_load_dwordx4 v120, s[8:11], s73 offen lds
    v_mfma_f32_16x16x32_bf16 v[156:159], v[16:19], v[108:111], v[156:159]
    ds_read_b64_tr_b16 v[102:103], v125 offset:45312
    v_mfma_f32_16x16x32_bf16 v[180:183], v[20:23], v[108:111], v[180:183]
    ds_read_b64_tr_b16 v[104:105], v124 offset:47104
    v_mfma_f32_16x16x32_bf16 v[184:187], v[112:115], v[24:27], v[184:187]
    ds_read_b64_tr_b16 v[106:107], v124 offset:47360
    v_mfma_f32_16x16x32_bf16 v[188:191], v[116:119], v[24:27], v[188:191]
    ds_read_b64_tr_b16 v[108:109], v125 offset:47104
    v_mfma_f32_16x16x32_bf16 v[48:51], v[16:19], v[16:19], v[48:51]
    ds_read_b64_tr_b16 v[110:111], v125 offset:47360
    s_add_u32 m0, s52, 21504
    s_mov_b32 s73, 14976
    buffer_load_dwordx4 v121, s[8:11], s73 offen lds
    v_mfma_f32_16x16x32_bf16 v[52:55], v[20:23], v[20:23], v[52:55]
    ds_read_b64_tr_b16 v[112:113], v126 offset:43008
    v_mfma_f32_16x16x32_bf16 v[56:59], v[24:27], v[24:27], v[56:59]
    ds_read_b64_tr_b16 v[114:115], v126 offset:43264
    v_mfma_f32_16x16x32_bf16 v[60:63], v[40:43], v[16:19], v[60:63]
    ds_read_b64_tr_b16 v[116:117], v127 offset:43008
    v_mfma_f32_16x16x32_bf16 v[64:67], v[40:43], v[20:23], v[64:67]
    ds_read_b64_tr_b16 v[118:119], v127 offset:43264
    v_mfma_f32_16x16x32_bf16 v[68:71], v[40:43], v[24:27], v[68:71]
    s_add_u32 m0, s7, 79872
    s_mov_b32 s73, 640
    s_mov_b64 exec, s[54:55]
    buffer_load_dwordx4 v122, s[8:11], s73 offen lds
    s_mov_b64 exec, -1
    s_waitcnt vmcnt(8)
    s_barrier
    s_waitcnt lgkmcnt(8)
    v_mfma_f32_16x16x32_bf16 v[136:139], v[88:91], v[28:31], v[136:139]
    ds_read_b128 v[16:19], v128 offset:36864
    v_mfma_f32_16x16x32_bf16 v[160:163], v[88:91], v[32:35], v[160:163]
    ds_read_b128 v[20:23], v128 offset:38912
    v_mfma_f32_16x16x32_bf16 v[140:143], v[92:95], v[28:31], v[140:143]
    ds_read_b128 v[24:27], v130 offset:36864
    v_mfma_f32_16x16x32_bf16 v[164:167], v[92:95], v[32:35], v[164:167]
    ds_read_b64_tr_b16 v[88:89], v124 offset:0
    v_mfma_f32_16x16x32_bf16 v[144:147], v[96:99], v[28:31], v[144:147]
    ds_read_b64_tr_b16 v[90:91], v124 offset:256
    s_add_u32 m0, s51, 36864
    s_mov_b32 s73, 1032192
    buffer_load_dwordx4 v123, s[12:15], s73 offen lds
    v_mfma_f32_16x16x32_bf16 v[168:171], v[96:99], v[32:35], v[168:171]
    ds_read_b64_tr_b16 v[92:93], v125 offset:0
    v_mfma_f32_16x16x32_bf16 v[148:151], v[100:103], v[28:31], v[148:151]
    ds_read_b64_tr_b16 v[94:95], v125 offset:256
    v_mfma_f32_16x16x32_bf16 v[172:175], v[100:103], v[32:35], v[172:175]
    ds_read_b64_tr_b16 v[96:97], v124 offset:2048
    s_waitcnt lgkmcnt(8)
    v_mfma_f32_16x16x32_bf16 v[152:155], v[28:31], v[104:107], v[152:155]
    ds_read_b64_tr_b16 v[98:99], v124 offset:2304
    v_mfma_f32_16x16x32_bf16 v[176:179], v[32:35], v[104:107], v[176:179]
    ds_read_b64_tr_b16 v[100:101], v125 offset:2048
    s_add_u32 m0, s51, 38912
    s_mov_b32 s73, 1033088
    buffer_load_dwordx4 v123, s[12:15], s73 offen lds
    v_mfma_f32_16x16x32_bf16 v[156:159], v[28:31], v[108:111], v[156:159]
    ds_read_b64_tr_b16 v[102:103], v125 offset:2304
    v_mfma_f32_16x16x32_bf16 v[180:183], v[32:35], v[108:111], v[180:183]
    ds_read_b64_tr_b16 v[104:105], v124 offset:4096
    v_mfma_f32_16x16x32_bf16 v[184:187], v[112:115], v[36:39], v[184:187]
    ds_read_b64_tr_b16 v[106:107], v124 offset:4352
    v_mfma_f32_16x16x32_bf16 v[188:191], v[116:119], v[36:39], v[188:191]
    ds_read_b64_tr_b16 v[108:109], v125 offset:4096
    v_mfma_f32_16x16x32_bf16 v[48:51], v[28:31], v[28:31], v[48:51]
    ds_read_b64_tr_b16 v[110:111], v125 offset:4352
    s_add_u32 m0, s51, 40960
    s_mov_b32 s73, 1033984
    buffer_load_dwordx4 v123, s[12:15], s73 offen lds
    v_mfma_f32_16x16x32_bf16 v[52:55], v[32:35], v[32:35], v[52:55]
    ds_read_b64_tr_b16 v[112:113], v126 offset:0
    v_mfma_f32_16x16x32_bf16 v[56:59], v[36:39], v[36:39], v[56:59]
    ds_read_b64_tr_b16 v[114:115], v126 offset:256
    v_mfma_f32_16x16x32_bf16 v[60:63], v[40:43], v[28:31], v[60:63]
    ds_read_b64_tr_b16 v[116:117], v127 offset:0
    v_mfma_f32_16x16x32_bf16 v[64:67], v[40:43], v[32:35], v[64:67]
    ds_read_b64_tr_b16 v[118:119], v127 offset:256
    v_mfma_f32_16x16x32_bf16 v[68:71], v[40:43], v[36:39], v[68:71]
    s_add_u32 m0, s52, 0
    s_mov_b32 s73, 768
    buffer_load_dwordx4 v120, s[8:11], s73 offen lds
    s_waitcnt lgkmcnt(8)
    v_mfma_f32_16x16x32_bf16 v[136:139], v[88:91], v[16:19], v[136:139]
    ds_read_b128 v[28:31], v129 offset:36864
    v_mfma_f32_16x16x32_bf16 v[160:163], v[88:91], v[20:23], v[160:163]
    ds_read_b128 v[32:35], v129 offset:38912
    v_mfma_f32_16x16x32_bf16 v[140:143], v[92:95], v[16:19], v[140:143]
    ds_read_b128 v[36:39], v131 offset:36864
    v_mfma_f32_16x16x32_bf16 v[164:167], v[92:95], v[20:23], v[164:167]
    ds_read_b64_tr_b16 v[88:89], v124 offset:6144
    v_mfma_f32_16x16x32_bf16 v[144:147], v[96:99], v[16:19], v[144:147]
    ds_read_b64_tr_b16 v[90:91], v124 offset:6400
    s_add_u32 m0, s52, 1024
    s_mov_b32 s73, 768
    buffer_load_dwordx4 v121, s[8:11], s73 offen lds
    v_mfma_f32_16x16x32_bf16 v[168:171], v[96:99], v[20:23], v[168:171]
    ds_read_b64_tr_b16 v[92:93], v125 offset:6144
    v_mfma_f32_16x16x32_bf16 v[148:151], v[100:103], v[16:19], v[148:151]
    ds_read_b64_tr_b16 v[94:95], v125 offset:6400
    v_mfma_f32_16x16x32_bf16 v[172:175], v[100:103], v[20:23], v[172:175]
    ds_read_b64_tr_b16 v[96:97], v124 offset:8192
    s_waitcnt lgkmcnt(8)
    v_mfma_f32_16x16x32_bf16 v[152:155], v[16:19], v[104:107], v[152:155]
    ds_read_b64_tr_b16 v[98:99], v124 offset:8448
    v_mfma_f32_16x16x32_bf16 v[176:179], v[20:23], v[104:107], v[176:179]
    ds_read_b64_tr_b16 v[100:101], v125 offset:8192
    s_add_u32 m0, s52, 2048
    s_mov_b32 s73, 15104
    buffer_load_dwordx4 v120, s[8:11], s73 offen lds
    v_mfma_f32_16x16x32_bf16 v[156:159], v[16:19], v[108:111], v[156:159]
    ds_read_b64_tr_b16 v[102:103], v125 offset:8448
    v_mfma_f32_16x16x32_bf16 v[180:183], v[20:23], v[108:111], v[180:183]
    ds_read_b64_tr_b16 v[104:105], v124 offset:10240
    v_mfma_f32_16x16x32_bf16 v[184:187], v[112:115], v[24:27], v[184:187]
    ds_read_b64_tr_b16 v[106:107], v124 offset:10496
    v_mfma_f32_16x16x32_bf16 v[188:191], v[116:119], v[24:27], v[188:191]
    ds_read_b64_tr_b16 v[108:109], v125 offset:10240
    v_mfma_f32_16x16x32_bf16 v[48:51], v[16:19], v[16:19], v[48:51]
    ds_read_b64_tr_b16 v[110:111], v125 offset:10496
    s_add_u32 m0, s52, 3072
    s_mov_b32 s73, 15104
    buffer_load_dwordx4 v121, s[8:11], s73 offen lds
    v_mfma_f32_16x16x32_bf16 v[52:55], v[20:23], v[20:23], v[52:55]
    ds_read_b64_tr_b16 v[112:113], v126 offset:6144
    v_mfma_f32_16x16x32_bf16 v[56:59], v[24:27], v[24:27], v[56:59]
    ds_read_b64_tr_b16 v[114:115], v126 offset:6400
    v_mfma_f32_16x16x32_bf16 v[60:63], v[40:43], v[16:19], v[60:63]
    ds_read_b64_tr_b16 v[116:117], v127 offset:6144
    v_mfma_f32_16x16x32_bf16 v[64:67], v[40:43], v[20:23], v[64:67]
    ds_read_b64_tr_b16 v[118:119], v127 offset:6400
    v_mfma_f32_16x16x32_bf16 v[68:71], v[40:43], v[24:27], v[68:71]
    s_add_u32 m0, s7, 61440
    s_mov_b32 s73, 768
    s_mov_b64 exec, s[54:55]
    buffer_load_dwordx4 v122, s[8:11], s73 offen lds
    s_mov_b64 exec, -1
    v_mov_b32 v7, 0
    buffer_load_dword v6, v7, s[44:47], 0 offen sc1
    s_lshr_b32 s68, s2, 3
    s_lshl_b32 s68, s68, 2
    s_add_u32 s68, s68, s3
    v_lshlrev_b32 v219, 7, v1
    s_mul_i32 s86, s68, 3200
    s_mov_b64 exec, 0x1ffffff
    buffer_load_dword v234, v219, s[16:19], s86 offen
    s_mov_b64 exec, -1
    v_lshrrev_b32 v219, 2, v1
    v_mul_u32_u24 v219, 3584, v219
    v_and_b32 v220, 3, v1
    v_lshl_add_u32 v219, v220, 7, v219
    s_mul_i32 s68, s68, 57344
    s_and_b32 s69, s2, 7
    s_mul_i32 s86, s69, 3
    s_add_u32 s86, s86, 4
    s_lshl_b32 s87, s69, 2
    s_min_u32 s86, s86, s87
    s_lshl_b32 s86, s86, 7
    s_add_u32 s86, s86, s68
    s_cmp_lt_u32 s69, 4
    s_cselect_b32 exec_lo, -1, 0x77777777
    s_cselect_b32 exec_hi, -1, 0x77777777
    buffer_load_dword v235, v219, s[20:23], s86 offen
    s_mov_b64 exec, -1
    s_waitcnt vmcnt(11)
    s_barrier
    s_waitcnt lgkmcnt(8)
    v_mfma_f32_16x16x32_bf16 v[136:139], v[88:91], v[28:31], v[136:139]
    ds_read_b128 v[16:19], v128 offset:18432
    v_mfma_f32_16x16x32_bf16 v[160:163], v[88:91], v[32:35], v[160:163]
    ds_read_b128 v[20:23], v128 offset:20480
    v_mfma_f32_16x16x32_bf16 v[140:143], v[92:95], v[28:31], v[140:143]
    ds_read_b128 v[24:27], v130 offset:18432
    v_mfma_f32_16x16x32_bf16 v[164:167], v[92:95], v[32:35], v[164:167]
    ds_read_b64_tr_b16 v[88:89], v124 offset:12288
    v_mfma_f32_16x16x32_bf16 v[144:147], v[96:99], v[28:31], v[144:147]
    ds_read_b64_tr_b16 v[90:91], v124 offset:12544
    v_mfma_f32_16x16x32_bf16 v[168:171], v[96:99], v[32:35], v[168:171]
    ds_read_b64_tr_b16 v[92:93], v125 offset:12288
    v_mfma_f32_16x16x32_bf16 v[148:151], v[100:103], v[28:31], v[148:151]
    ds_read_b64_tr_b16 v[94:95], v125 offset:12544
    v_mfma_f32_16x16x32_bf16 v[172:175], v[100:103], v[32:35], v[172:175]
    ds_read_b64_tr_b16 v[96:97], v124 offset:14336
    s_waitcnt lgkmcnt(8)
    v_mfma_f32_16x16x32_bf16 v[152:155], v[28:31], v[104:107], v[152:155]
    ds_read_b64_tr_b16 v[98:99], v124 offset:14592
    v_mfma_f32_16x16x32_bf16 v[176:179], v[32:35], v[104:107], v[176:179]
    ds_read_b64_tr_b16 v[100:101], v125 offset:14336
    v_mfma_f32_16x16x32_bf16 v[156:159], v[28:31], v[108:111], v[156:159]
    ds_read_b64_tr_b16 v[102:103], v125 offset:14592
    v_mfma_f32_16x16x32_bf16 v[180:183], v[32:35], v[108:111], v[180:183]
    ds_read_b64_tr_b16 v[104:105], v124 offset:16384
    v_mfma_f32_16x16x32_bf16 v[184:187], v[112:115], v[36:39], v[184:187]
    ds_read_b64_tr_b16 v[106:107], v124 offset:16640
    v_mfma_f32_16x16x32_bf16 v[188:191], v[116:119], v[36:39], v[188:191]
    ds_read_b64_tr_b16 v[108:109], v125 offset:16384
    v_mfma_f32_16x16x32_bf16 v[48:51], v[28:31], v[28:31], v[48:51]
    ds_read_b64_tr_b16 v[110:111], v125 offset:16640
    v_mfma_f32_16x16x32_bf16 v[52:55], v[32:35], v[32:35], v[52:55]
    ds_read_b64_tr_b16 v[112:113], v126 offset:12288
    v_mfma_f32_16x16x32_bf16 v[56:59], v[36:39], v[36:39], v[56:59]
    ds_read_b64_tr_b16 v[114:115], v126 offset:12544
    v_mfma_f32_16x16x32_bf16 v[60:63], v[40:43], v[28:31], v[60:63]
    ds_read_b64_tr_b16 v[116:117], v127 offset:12288
    v_mfma_f32_16x16x32_bf16 v[64:67], v[40:43], v[32:35], v[64:67]
    ds_read_b64_tr_b16 v[118:119], v127 offset:12544
    v_mfma_f32_16x16x32_bf16 v[68:71], v[40:43], v[36:39], v[68:71]
    s_waitcnt lgkmcnt(8)
    v_mfma_f32_16x16x32_bf16 v[136:139], v[88:91], v[16:19], v[136:139]
    ds_read_b128 v[28:31], v129 offset:18432
    v_mfma_f32_16x16x32_bf16 v[160:163], v[88:91], v[20:23], v[160:163]
    ds_read_b128 v[32:35], v129 offset:20480
    v_mfma_f32_16x16x32_bf16 v[140:143], v[92:95], v[16:19], v[140:143]
    ds_read_b128 v[36:39], v131 offset:18432
    v_mfma_f32_16x16x32_bf16 v[164:167], v[92:95], v[20:23], v[164:167]
    ds_read_b64_tr_b16 v[88:89], v124 offset:18432
    v_mfma_f32_16x16x32_bf16 v[144:147], v[96:99], v[16:19], v[144:147]
    ds_read_b64_tr_b16 v[90:91], v124 offset:18688
    v_mfma_f32_16x16x32_bf16 v[168:171], v[96:99], v[20:23], v[168:171]
    ds_read_b64_tr_b16 v[92:93], v125 offset:18432
    v_mfma_f32_16x16x32_bf16 v[148:151], v[100:103], v[16:19], v[148:151]
    ds_read_b64_tr_b16 v[94:95], v125 offset:18688
    v_mfma_f32_16x16x32_bf16 v[172:175], v[100:103], v[20:23], v[172:175]
    ds_read_b64_tr_b16 v[96:97], v124 offset:20480
    s_waitcnt lgkmcnt(8)
    v_mfma_f32_16x16x32_bf16 v[152:155], v[16:19], v[104:107], v[152:155]
    ds_read_b64_tr_b16 v[98:99], v124 offset:20736
    v_mfma_f32_16x16x32_bf16 v[176:179], v[20:23], v[104:107], v[176:179]
    ds_read_b64_tr_b16 v[100:101], v125 offset:20480
    v_mfma_f32_16x16x32_bf16 v[156:159], v[16:19], v[108:111], v[156:159]
    ds_read_b64_tr_b16 v[102:103], v125 offset:20736
    v_mfma_f32_16x16x32_bf16 v[180:183], v[20:23], v[108:111], v[180:183]
    ds_read_b64_tr_b16 v[104:105], v124 offset:22528
    v_mfma_f32_16x16x32_bf16 v[184:187], v[112:115], v[24:27], v[184:187]
    ds_read_b64_tr_b16 v[106:107], v124 offset:22784
    v_mfma_f32_16x16x32_bf16 v[188:191], v[116:119], v[24:27], v[188:191]
    ds_read_b64_tr_b16 v[108:109], v125 offset:22528
    v_mfma_f32_16x16x32_bf16 v[48:51], v[16:19], v[16:19], v[48:51]
    ds_read_b64_tr_b16 v[110:111], v125 offset:22784
    v_mfma_f32_16x16x32_bf16 v[52:55], v[20:23], v[20:23], v[52:55]
    ds_read_b64_tr_b16 v[112:113], v126 offset:18432
    v_mfma_f32_16x16x32_bf16 v[56:59], v[24:27], v[24:27], v[56:59]
    ds_read_b64_tr_b16 v[114:115], v126 offset:18688
    v_mfma_f32_16x16x32_bf16 v[60:63], v[40:43], v[16:19], v[60:63]
    ds_read_b64_tr_b16 v[116:117], v127 offset:18432
    v_mfma_f32_16x16x32_bf16 v[64:67], v[40:43], v[20:23], v[64:67]
    ds_read_b64_tr_b16 v[118:119], v127 offset:18688
    v_mfma_f32_16x16x32_bf16 v[68:71], v[40:43], v[24:27], v[68:71]
    s_waitcnt vmcnt(3)
    s_barrier
    s_waitcnt lgkmcnt(8)
    v_mfma_f32_16x16x32_bf16 v[136:139], v[88:91], v[28:31], v[136:139]
    ds_read_b128 v[16:19], v128 offset:0
    v_mfma_f32_16x16x32_bf16 v[160:163], v[88:91], v[32:35], v[160:163]
    ds_read_b128 v[20:23], v128 offset:2048
    v_mfma_f32_16x16x32_bf16 v[140:143], v[92:95], v[28:31], v[140:143]
    ds_read_b128 v[24:27], v130 offset:0
    v_mfma_f32_16x16x32_bf16 v[164:167], v[92:95], v[32:35], v[164:167]
    ds_read_b64_tr_b16 v[88:89], v124 offset:24576
    v_mfma_f32_16x16x32_bf16 v[144:147], v[96:99], v[28:31], v[144:147]
    ds_read_b64_tr_b16 v[90:91], v124 offset:24832
    v_mfma_f32_16x16x32_bf16 v[168:171], v[96:99], v[32:35], v[168:171]
    ds_read_b64_tr_b16 v[92:93], v125 offset:24576
    v_mfma_f32_16x16x32_bf16 v[148:151], v[100:103], v[28:31], v[148:151]
    ds_read_b64_tr_b16 v[94:95], v125 offset:24832
    v_mfma_f32_16x16x32_bf16 v[172:175], v[100:103], v[32:35], v[172:175]
    ds_read_b64_tr_b16 v[96:97], v124 offset:26624
    s_waitcnt lgkmcnt(8)
    v_mfma_f32_16x16x32_bf16 v[152:155], v[28:31], v[104:107], v[152:155]
    ds_read_b64_tr_b16 v[98:99], v124 offset:26880
    v_mfma_f32_16x16x32_bf16 v[176:179], v[32:35], v[104:107], v[176:179]
    ds_read_b64_tr_b16 v[100:101], v125 offset:26624
    v_mfma_f32_16x16x32_bf16 v[156:159], v[28:31], v[108:111], v[156:159]
    ds_read_b64_tr_b16 v[102:103], v125 offset:26880
    v_mfma_f32_16x16x32_bf16 v[180:183], v[32:35], v[108:111], v[180:183]
    ds_read_b64_tr_b16 v[104:105], v124 offset:28672
    v_mfma_f32_16x16x32_bf16 v[184:187], v[112:115], v[36:39], v[184:187]
    ds_read_b64_tr_b16 v[106:107], v124 offset:28928
    v_mfma_f32_16x16x32_bf16 v[188:191], v[116:119], v[36:39], v[188:191]
    ds_read_b64_tr_b16 v[108:109], v125 offset:28672
    v_mfma_f32_16x16x32_bf16 v[48:51], v[28:31], v[28:31], v[48:51]
    ds_read_b64_tr_b16 v[110:111], v125 offset:28928
    v_mfma_f32_16x16x32_bf16 v[52:55], v[32:35], v[32:35], v[52:55]
    ds_read_b64_tr_b16 v[112:113], v126 offset:24576
    v_mfma_f32_16x16x32_bf16 v[56:59], v[36:39], v[36:39], v[56:59]
    ds_read_b64_tr_b16 v[114:115], v126 offset:24832
    v_mfma_f32_16x16x32_bf16 v[60:63], v[40:43], v[28:31], v[60:63]
    ds_read_b64_tr_b16 v[116:117], v127 offset:24576
    v_mfma_f32_16x16x32_bf16 v[64:67], v[40:43], v[32:35], v[64:67]
    ds_read_b64_tr_b16 v[118:119], v127 offset:24832
    v_mfma_f32_16x16x32_bf16 v[68:71], v[40:43], v[36:39], v[68:71]
    s_waitcnt lgkmcnt(8)
    v_mfma_f32_16x16x32_bf16 v[136:139], v[88:91], v[16:19], v[136:139]
    ds_read_b128 v[28:31], v129 offset:0
    v_mfma_f32_16x16x32_bf16 v[160:163], v[88:91], v[20:23], v[160:163]
    ds_read_b128 v[32:35], v129 offset:2048
    v_mfma_f32_16x16x32_bf16 v[140:143], v[92:95], v[16:19], v[140:143]
    ds_read_b128 v[36:39], v131 offset:0
    v_mfma_f32_16x16x32_bf16 v[164:167], v[92:95], v[20:23], v[164:167]
    ds_read_b64_tr_b16 v[88:89], v124 offset:30720
    v_mfma_f32_16x16x32_bf16 v[144:147], v[96:99], v[16:19], v[144:147]
    ds_read_b64_tr_b16 v[90:91], v124 offset:30976
    v_mfma_f32_16x16x32_bf16 v[168:171], v[96:99], v[20:23], v[168:171]
    ds_read_b64_tr_b16 v[92:93], v125 offset:30720
    v_mfma_f32_16x16x32_bf16 v[148:151], v[100:103], v[16:19], v[148:151]
    ds_read_b64_tr_b16 v[94:95], v125 offset:30976
    v_mfma_f32_16x16x32_bf16 v[172:175], v[100:103], v[20:23], v[172:175]
    ds_read_b64_tr_b16 v[96:97], v124 offset:32768
    s_waitcnt lgkmcnt(8)
    v_mfma_f32_16x16x32_bf16 v[152:155], v[16:19], v[104:107], v[152:155]
    ds_read_b64_tr_b16 v[98:99], v124 offset:33024
    v_mfma_f32_16x16x32_bf16 v[176:179], v[20:23], v[104:107], v[176:179]
    ds_read_b64_tr_b16 v[100:101], v125 offset:32768
    v_mfma_f32_16x16x32_bf16 v[156:159], v[16:19], v[108:111], v[156:159]
    ds_read_b64_tr_b16 v[102:103], v125 offset:33024
    v_mfma_f32_16x16x32_bf16 v[180:183], v[20:23], v[108:111], v[180:183]
    ds_read_b64_tr_b16 v[104:105], v124 offset:34816
    v_mfma_f32_16x16x32_bf16 v[184:187], v[112:115], v[24:27], v[184:187]
    ds_read_b64_tr_b16 v[106:107], v124 offset:35072
    v_mfma_f32_16x16x32_bf16 v[188:191], v[116:119], v[24:27], v[188:191]
    ds_read_b64_tr_b16 v[108:109], v125 offset:34816
    v_mfma_f32_16x16x32_bf16 v[48:51], v[16:19], v[16:19], v[48:51]
    ds_read_b64_tr_b16 v[110:111], v125 offset:35072
    v_mfma_f32_16x16x32_bf16 v[52:55], v[20:23], v[20:23], v[52:55]
    ds_read_b64_tr_b16 v[112:113], v126 offset:30720
    v_mfma_f32_16x16x32_bf16 v[56:59], v[24:27], v[24:27], v[56:59]
    ds_read_b64_tr_b16 v[114:115], v126 offset:30976
    v_mfma_f32_16x16x32_bf16 v[60:63], v[40:43], v[16:19], v[60:63]
    ds_read_b64_tr_b16 v[116:117], v127 offset:30720
    v_mfma_f32_16x16x32_bf16 v[64:67], v[40:43], v[20:23], v[64:67]
    ds_read_b64_tr_b16 v[118:119], v127 offset:30976
    v_mfma_f32_16x16x32_bf16 v[68:71], v[40:43], v[24:27], v[68:71]
    s_waitcnt lgkmcnt(9)
    v_mfma_f32_16x16x32_bf16 v[48:51], v[28:31], v[28:31], v[48:51]
    v_mfma_f32_16x16x32_bf16 v[52:55], v[32:35], v[32:35], v[52:55]
    v_mfma_f32_16x16x32_bf16 v[56:59], v[36:39], v[36:39], v[56:59]
    v_mfma_f32_16x16x32_bf16 v[60:63], v[40:43], v[28:31], v[60:63]
    v_mfma_f32_16x16x32_bf16 v[64:67], v[40:43], v[32:35], v[64:67]
    v_mfma_f32_16x16x32_bf16 v[68:71], v[40:43], v[36:39], v[68:71]
    s_waitcnt lgkmcnt(2)
    v_mfma_f32_16x16x32_bf16 v[184:187], v[112:115], v[36:39], v[184:187]
    s_waitcnt lgkmcnt(0)
    v_mfma_f32_16x16x32_bf16 v[188:191], v[116:119], v[36:39], v[188:191]
    v_mfma_f32_16x16x32_bf16 v[144:147], v[96:99], v[28:31], v[144:147]
    v_cndmask_b32 v48, v48, v49, s[88:89]
    v_cndmask_b32 v52, v52, v53, s[88:89]
    v_cndmask_b32 v56, v56, v57, s[88:89]
    v_mfma_f32_16x16x32_bf16 v[168:171], v[96:99], v[32:35], v[168:171]
    v_cndmask_b32 v48, v48, v50, s[90:91]
    v_cndmask_b32 v52, v52, v54, s[90:91]
    v_cndmask_b32 v56, v56, v58, s[90:91]
    v_mfma_f32_16x16x32_bf16 v[148:151], v[100:103], v[28:31], v[148:151]
    v_cndmask_b32 v48, v48, v51, s[92:93]
    v_cndmask_b32 v52, v52, v55, s[92:93]
    v_cndmask_b32 v56, v56, v59, s[92:93]
    v_mfma_f32_16x16x32_bf16 v[172:175], v[100:103], v[32:35], v[172:175]
    v_mul_f32 v133, 0x3b124925, v60
    v_mul_f32 v135, 0x3b124925, v64
    v_mul_f32 v85, 0x3b124925, v68
    v_mfma_f32_16x16x32_bf16 v[152:155], v[28:31], v[104:107], v[152:155]
    v_mul_f32 v132, v133, v133
    v_mul_f32 v134, v135, v135
    v_mul_f32 v84, v85, v85
    v_mfma_f32_16x16x32_bf16 v[176:179], v[32:35], v[104:107], v[176:179]
    v_mul_f32 v48, 0x3b124925, v48
    v_mul_f32 v52, 0x3b124925, v52
    v_mul_f32 v56, 0x3b124925, v56
    v_mfma_f32_16x16x32_bf16 v[156:159], v[28:31], v[108:111], v[156:159]
    s_mov_b32 exec_lo, 0x00010001
    s_mov_b32 exec_hi, 0x00010001
    ds_write_b128 v73, v[184:187] offset:128
    ds_write_b128 v74, v[188:191] offset:0
    s_mov_b64 exec, -1
    v_sub_f32 v132, v48, v132
    v_sub_f32 v134, v52, v134
    v_mfma_f32_16x16x32_bf16 v[180:183], v[32:35], v[108:111], v[180:183]
    v_sub_f32 v84, v56, v84
    v_max_f32 v132, 0, v132
    v_max_f32 v134, 0, v134
    v_mfma_f32_16x16x32_bf16 v[136:139], v[88:91], v[28:31], v[136:139]
    v_max_f32 v84, 0, v84
    v_add_f32 v132, 0x3727c5ac, v132
    v_add_f32 v134, 0x3727c5ac, v134
    v_mfma_f32_16x16x32_bf16 v[160:163], v[88:91], v[32:35], v[160:163]
    v_add_f32 v84, 0x3727c5ac, v84
    v_rsq_f32 v132, v132
    v_rsq_f32 v134, v134
    v_mfma_f32_16x16x32_bf16 v[140:143], v[92:95], v[28:31], v[140:143]
    v_rsq_f32 v84, v84
    s_mov_b32 exec_lo, 0x00f0000f
    s_mov_b32 exec_hi, 0xf0000f00
    ds_write2_b32 v75, v132, v133 offset0:128 offset1:144
    ds_write2_b32 v75, v134, v135 offset0:160 offset1:176
    ds_write2_b32 v75, v84, v85 offset0:192 offset1:208
    s_mov_b64 exec, -1
    v_mov_b32_dpp v224, v184 row_newbcast:0 row_mask:0xf bank_mask:0xf
    v_mfma_f32_16x16x32_bf16 v[164:167], v[92:95], v[32:35], v[164:167]
    v_mov_b32_dpp v225, v185 row_newbcast:0 row_mask:0xf bank_mask:0xf
    v_mov_b32_dpp v226, v186 row_newbcast:0 row_mask:0xf bank_mask:0xf
    v_mov_b32_dpp v227, v187 row_newbcast:0 row_mask:0xf bank_mask:0xf
    v_fma_f32 v224, -v224, v85, v184
    v_fma_f32 v225, -v225, v85, v185
    v_fma_f32 v226, -v226, v85, v186
    v_fma_f32 v227, -v227, v85, v187
    s_cmp_eq_u32 s49, 15
    s_cselect_b32 s88, 0xffff0000, -1
    s_mov_b32 s89, -1
    s_mov_b32 s90, -1
    s_cselect_b32 s91, -1, 0xffff
    s_waitcnt lgkmcnt(0)
    s_barrier
    ds_read_b32 v134, v75 offset:640
    ds_read_b32 v84, v75 offset:768
    ds_read_b32 v132, v75 offset:512
    ds_read_b128 v[56:59], v72 offset:128
    ds_read_b128 v[60:63], v72 offset:192
    ds_read_b32 v64, v77 offset:256
    ds_read_b32 v65, v77 offset:320
    ds_read_b128 v[44:47], v76 offset:704
    ds_read_b128 v[40:43], v76 offset:640
    ds_read_b128 v[36:39], v76 offset:576
    ds_read_b128 v[32:35], v76 offset:512
    ds_read_b128 v[48:51], v72 offset:0
    ds_read_b128 v[52:55], v72 offset:64
    s_waitcnt lgkmcnt(9)
    v_pk_fma_f32 v[168:169], v[56:57], v[134:135], v[168:169] op_sel:[0,1,0] op_sel_hi:[1,1,1] neg_lo:[0,1,0] neg_hi:[0,1,0]
    v_pk_fma_f32 v[170:171], v[58:59], v[134:135], v[170:171] op_sel:[0,1,0] op_sel_hi:[1,1,1] neg_lo:[0,1,0] neg_hi:[0,1,0]
    v_pk_mul_f32 v[168:169], v[168:169], v[134:135] op_sel:[0,0] op_sel_hi:[1,0]
    v_pk_mul_f32 v[170:171], v[170:171], v[134:135] op_sel:[0,0] op_sel_hi:[1,0]
    v_cvt_pk_bf16_f32 v104, v168, v169
    v_cvt_pk_bf16_f32 v105, v170, v171
    s_waitcnt lgkmcnt(8)
    v_pk_fma_f32 v[172:173], v[60:61], v[134:135], v[172:173] op_sel:[0,1,0] op_sel_hi:[1,1,1] neg_lo:[0,1,0] neg_hi:[0,1,0]
    v_pk_fma_f32 v[174:175], v[62:63], v[134:135], v[174:175] op_sel:[0,1,0] op_sel_hi:[1,1,1] neg_lo:[0,1,0] neg_hi:[0,1,0]
    v_pk_mul_f32 v[172:173], v[172:173], v[134:135] op_sel:[0,0] op_sel_hi:[1,0]
    v_pk_mul_f32 v[174:175], v[174:175], v[134:135] op_sel:[0,0] op_sel_hi:[1,0]
    v_cvt_pk_bf16_f32 v106, v172, v173
    v_cvt_pk_bf16_f32 v107, v174, v175
    ds_write_b128 v78, v[104:107] offset:4096
    v_pk_mul_f32 v[224:225], v[224:225], v[84:85] op_sel_hi:[1,0]
    v_pk_mul_f32 v[226:227], v[226:227], v[84:85] op_sel_hi:[1,0]
    v_cvt_pk_bf16_f32 v224, v224, v225
    v_cvt_pk_bf16_f32 v226, v226, v227
    ds_write_b16 v80, v224 offset:2048
    ds_write_b16_d16_hi v81, v224 offset:2048
    ds_write_b16 v82, v226 offset:2048
    ds_write_b16_d16_hi v83, v226 offset:2048
    s_waitcnt lgkmcnt(10)
    v_pk_fma_f32 v[176:177], v[44:45], v[64:65], v[176:177] op_sel:[0,0,0] op_sel_hi:[1,0,1] neg_lo:[0,1,0] neg_hi:[0,1,0]
    v_pk_fma_f32 v[178:179], v[46:47], v[64:65], v[178:179] op_sel:[0,0,0] op_sel_hi:[1,0,1] neg_lo:[0,1,0] neg_hi:[0,1,0]
    s_waitcnt lgkmcnt(9)
    v_pk_mul_f32 v[176:177], v[176:177], v[40:41]
    v_pk_mul_f32 v[178:179], v[178:179], v[42:43]
    v_cvt_pk_bf16_f32 v112, v176, v177
    v_cvt_pk_bf16_f32 v113, v178, v179
    v_pk_fma_f32 v[180:181], v[44:45], v[64:65], v[180:181] op_sel:[0,1,0] op_sel_hi:[1,1,1] neg_lo:[0,1,0] neg_hi:[0,1,0]
    v_pk_fma_f32 v[182:183], v[46:47], v[64:65], v[182:183] op_sel:[0,1,0] op_sel_hi:[1,1,1] neg_lo:[0,1,0] neg_hi:[0,1,0]
    v_pk_mul_f32 v[180:181], v[180:181], v[40:41]
    v_pk_mul_f32 v[182:183], v[182:183], v[42:43]
    v_cvt_pk_bf16_f32 v118, v180, v181
    v_cvt_pk_bf16_f32 v119, v182, v183
    ds_write_b64 v78, v[112:113] offset:5120
    ds_write_b64 v78, v[118:119] offset:5128
    v_mul_f32 v68, 0x3e8b97f6, v132
    v_mul_f32 v70, 0x3e8b97f6, v134
    v_cndmask_b32 v69, 0, v68, s[90:91]
    v_cndmask_b32 v68, 0, v68, s[88:89]
    v_cndmask_b32 v71, 0, v70, s[90:91]
    v_cndmask_b32 v70, 0, v70, s[88:89]
    v_pk_fma_f32 v[144:145], v[56:57], v[132:133], v[144:145] op_sel:[0,1,0] op_sel_hi:[1,1,1] neg_lo:[0,1,0] neg_hi:[0,1,0]
    v_pk_fma_f32 v[146:147], v[58:59], v[132:133], v[146:147] op_sel:[0,1,0] op_sel_hi:[1,1,1] neg_lo:[0,1,0] neg_hi:[0,1,0]
    v_pk_mul_f32 v[144:145], v[144:145], v[132:133] op_sel:[0,0] op_sel_hi:[1,0]
    v_pk_mul_f32 v[146:147], v[146:147], v[132:133] op_sel:[0,0] op_sel_hi:[1,0]
    v_cvt_pk_bf16_f32 v100, v144, v145
    v_cvt_pk_bf16_f32 v101, v146, v147
    v_pk_fma_f32 v[148:149], v[60:61], v[132:133], v[148:149] op_sel:[0,1,0] op_sel_hi:[1,1,1] neg_lo:[0,1,0] neg_hi:[0,1,0]
    v_pk_fma_f32 v[150:151], v[62:63], v[132:133], v[150:151] op_sel:[0,1,0] op_sel_hi:[1,1,1] neg_lo:[0,1,0] neg_hi:[0,1,0]
    v_pk_mul_f32 v[148:149], v[148:149], v[132:133] op_sel:[0,0] op_sel_hi:[1,0]
    v_pk_mul_f32 v[150:151], v[150:151], v[132:133] op_sel:[0,0] op_sel_hi:[1,0]
    v_cvt_pk_bf16_f32 v102, v148, v149
    v_cvt_pk_bf16_f32 v103, v150, v151
    s_waitcnt lgkmcnt(0)
    s_barrier
    ds_read_b128 v[96:99], v78 offset:2048
    ds_read_b64 v[108:109], v78 offset:3072
    ds_read_b64 v[114:115], v78 offset:3080
    v_pk_fma_f32 v[160:161], v[48:49], v[134:135], v[160:161] op_sel:[0,1,0] op_sel_hi:[1,1,1] neg_lo:[0,1,0] neg_hi:[0,1,0]
    v_pk_fma_f32 v[162:163], v[50:51], v[134:135], v[162:163] op_sel:[0,1,0] op_sel_hi:[1,1,1] neg_lo:[0,1,0] neg_hi:[0,1,0]
    v_pk_mul_f32 v[160:161], v[160:161], v[70:71] op_sel:[0,0] op_sel_hi:[1,0]
    v_pk_mul_f32 v[162:163], v[162:163], v[70:71] op_sel:[0,0] op_sel_hi:[1,0]
    v_cvt_pk_bf16_f32 v92, v160, v161
    v_cvt_pk_bf16_f32 v93, v162, v163
    v_pk_fma_f32 v[164:165], v[52:53], v[134:135], v[164:165] op_sel:[0,1,0] op_sel_hi:[1,1,1] neg_lo:[0,1,0] neg_hi:[0,1,0]
    v_pk_fma_f32 v[166:167], v[54:55], v[134:135], v[166:167] op_sel:[0,1,0] op_sel_hi:[1,1,1] neg_lo:[0,1,0] neg_hi:[0,1,0]
    v_pk_mul_f32 v[164:165], v[164:165], v[70:71] op_sel:[0,1] op_sel_hi:[1,1]
    v_pk_mul_f32 v[166:167], v[166:167], v[70:71] op_sel:[0,1] op_sel_hi:[1,1]
    v_cvt_pk_bf16_f32 v94, v164, v165
    v_cvt_pk_bf16_f32 v95, v166, v167
    s_nop 1
    v_mfma_f32_16x16x32_bf16 v[24:27], v[100:103], v[92:95], v[240:243]
    v_mfma_f32_16x16x32_bf16 v[28:31], v[104:107], v[92:95], v[244:247]
    v_pk_fma_f32 v[136:137], v[48:49], v[132:133], v[136:137] op_sel:[0,1,0] op_sel_hi:[1,1,1] neg_lo:[0,1,0] neg_hi:[0,1,0]
    v_pk_fma_f32 v[138:139], v[50:51], v[132:133], v[138:139] op_sel:[0,1,0] op_sel_hi:[1,1,1] neg_lo:[0,1,0] neg_hi:[0,1,0]
    v_pk_mul_f32 v[136:137], v[136:137], v[68:69] op_sel:[0,0] op_sel_hi:[1,0]
    v_pk_mul_f32 v[138:139], v[138:139], v[68:69] op_sel:[0,0] op_sel_hi:[1,0]
    v_cvt_pk_bf16_f32 v88, v136, v137
    v_cvt_pk_bf16_f32 v89, v138, v139
    v_pk_fma_f32 v[140:141], v[52:53], v[132:133], v[140:141] op_sel:[0,1,0] op_sel_hi:[1,1,1] neg_lo:[0,1,0] neg_hi:[0,1,0]
    v_pk_fma_f32 v[142:143], v[54:55], v[132:133], v[142:143] op_sel:[0,1,0] op_sel_hi:[1,1,1] neg_lo:[0,1,0] neg_hi:[0,1,0]
    v_pk_mul_f32 v[140:141], v[140:141], v[68:69] op_sel:[0,1] op_sel_hi:[1,1]
    v_pk_mul_f32 v[142:143], v[142:143], v[68:69] op_sel:[0,1] op_sel_hi:[1,1]
    v_cvt_pk_bf16_f32 v90, v140, v141
    v_cvt_pk_bf16_f32 v91, v142, v143
    s_waitcnt lgkmcnt(2)
    s_nop 0
    v_mfma_f32_16x16x32_bf16 v[16:19], v[96:99], v[88:91], v[248:251]
    v_mfma_f32_16x16x32_bf16 v[20:23], v[100:103], v[88:91], v[244:247]
    v_pk_fma_f32 v[152:153], v[36:37], v[64:65], v[152:153] op_sel:[0,0,0] op_sel_hi:[1,0,1] neg_lo:[0,1,0] neg_hi:[0,1,0]
    v_pk_fma_f32 v[154:155], v[38:39], v[64:65], v[154:155] op_sel:[0,0,0] op_sel_hi:[1,0,1] neg_lo:[0,1,0] neg_hi:[0,1,0]
    v_pk_mul_f32 v[152:153], v[152:153], v[32:33]
    v_pk_mul_f32 v[154:155], v[154:155], v[34:35]
    v_cvt_pk_bf16_f32 v110, v152, v153
    v_cvt_pk_bf16_f32 v111, v154, v155
    v_pk_fma_f32 v[156:157], v[36:37], v[64:65], v[156:157] op_sel:[0,1,0] op_sel_hi:[1,1,1] neg_lo:[0,1,0] neg_hi:[0,1,0]
    v_pk_fma_f32 v[158:159], v[38:39], v[64:65], v[158:159] op_sel:[0,1,0] op_sel_hi:[1,1,1] neg_lo:[0,1,0] neg_hi:[0,1,0]
    v_pk_mul_f32 v[156:157], v[156:157], v[32:33]
    v_pk_mul_f32 v[158:159], v[158:159], v[34:35]
    v_cvt_pk_bf16_f32 v116, v156, v157
    v_cvt_pk_bf16_f32 v117, v158, v159
    v_max3_f32 v137, v24, v25, v26
    v_max3_f32 v139, v27, v28, v29
    v_max3_f32 v137, v137, v30, v31
    v_max_f32 v137, v137, v139
    v_max3_f32 v136, v16, v17, v18
    v_max3_f32 v138, v19, v20, v21
    v_max3_f32 v136, v136, v22, v23
    v_max_f32 v136, v136, v138
    v_mov_b32 v138, v136
    v_mov_b32 v139, v137
    s_nop 0
    v_permlane32_swap_b32 v136, v138
    v_permlane32_swap_b32 v137, v139
    v_max_f32 v136, v136, v138
    v_max_f32 v137, v137, v139
    v_mov_b32 v138, v136
    v_mov_b32 v139, v137
    s_nop 0
    v_permlane16_swap_b32 v136, v138
    v_permlane16_swap_b32 v137, v139
    v_max_f32 v136, v136, v138
    v_max_f32 v137, v137, v139
    v_pk_add_f32 v[24:25], v[24:25], v[136:137] op_sel:[0,1] op_sel_hi:[1,1] neg_lo:[0,1] neg_hi:[0,1]
    v_pk_add_f32 v[26:27], v[26:27], v[136:137] op_sel:[0,1] op_sel_hi:[1,1] neg_lo:[0,1] neg_hi:[0,1]
    v_pk_add_f32 v[28:29], v[28:29], v[136:137] op_sel:[0,1] op_sel_hi:[1,1] neg_lo:[0,1] neg_hi:[0,1]
    v_pk_add_f32 v[30:31], v[30:31], v[136:137] op_sel:[0,1] op_sel_hi:[1,1] neg_lo:[0,1] neg_hi:[0,1]
    v_exp_f32 v24, v24
    v_exp_f32 v25, v25
    v_exp_f32 v26, v26
    v_exp_f32 v27, v27
    v_exp_f32 v28, v28
    v_exp_f32 v29, v29
    v_exp_f32 v30, v30
    v_exp_f32 v31, v31
    v_cvt_pk_bf16_f32 v148, v24, v25
    v_cvt_pk_bf16_f32 v149, v26, v27
    v_cvt_pk_bf16_f32 v150, v28, v29
    v_cvt_pk_bf16_f32 v151, v30, v31
    s_nop 1
    v_mfma_f32_16x16x32_bf16 v[160:163], v[110:113], v[148:151], 0
    v_mfma_f32_16x16x32_bf16 v[164:167], v[116:119], v[148:151], 0
    v_pk_add_f32 v[16:17], v[16:17], v[136:137] op_sel:[0,0] op_sel_hi:[1,0] neg_lo:[0,1] neg_hi:[0,1]
    v_pk_add_f32 v[18:19], v[18:19], v[136:137] op_sel:[0,0] op_sel_hi:[1,0] neg_lo:[0,1] neg_hi:[0,1]
    v_pk_add_f32 v[20:21], v[20:21], v[136:137] op_sel:[0,0] op_sel_hi:[1,0] neg_lo:[0,1] neg_hi:[0,1]
    v_pk_add_f32 v[22:23], v[22:23], v[136:137] op_sel:[0,0] op_sel_hi:[1,0] neg_lo:[0,1] neg_hi:[0,1]
    v_exp_f32 v16, v16
    v_exp_f32 v17, v17
    v_exp_f32 v18, v18
    v_exp_f32 v19, v19
    v_exp_f32 v20, v20
    v_exp_f32 v21, v21
    v_exp_f32 v22, v22
    v_exp_f32 v23, v23
    v_cvt_pk_bf16_f32 v144, v16, v17
    v_cvt_pk_bf16_f32 v145, v18, v19
    v_cvt_pk_bf16_f32 v146, v20, v21
    v_cvt_pk_bf16_f32 v147, v22, v23
    s_waitcnt lgkmcnt(1)
    s_nop 0
    v_mfma_f32_16x16x32_bf16 v[152:155], v[108:111], v[144:147], 0
    s_waitcnt lgkmcnt(0)
    v_mfma_f32_16x16x32_bf16 v[156:159], v[114:117], v[144:147], 0
    v_pk_add_f32 v[16:17], v[16:17], v[18:19]
    v_pk_add_f32 v[20:21], v[20:21], v[22:23]
    v_pk_add_f32 v[24:25], v[24:25], v[26:27]
    v_pk_add_f32 v[28:29], v[28:29], v[30:31]
    v_pk_add_f32 v[16:17], v[16:17], v[20:21]
    v_pk_add_f32 v[24:25], v[24:25], v[28:29]
    v_add_f32 v140, v16, v17
    v_add_f32 v142, v24, v25
    v_mov_b32 v138, v140
    v_mov_b32 v139, v142
    s_nop 0
    v_permlane32_swap_b32 v140, v138
    v_permlane32_swap_b32 v142, v139
    v_add_f32 v140, v140, v138
    v_add_f32 v142, v142, v139
    v_mov_b32 v138, v140
    v_mov_b32 v139, v142
    s_nop 0
    v_permlane16_swap_b32 v140, v138
    v_permlane16_swap_b32 v142, v139
    v_add_f32 v140, v140, v138
    v_add_f32 v142, v142, v139
    v_rcp_f32 v140, v140
    v_rcp_f32 v142, v142
    v_cndmask_b32 v141, 0, v140, s[90:91]
    v_cndmask_b32 v140, 0, v140, s[88:89]
    v_cndmask_b32 v143, 0, v142, s[90:91]
    v_cndmask_b32 v142, 0, v142, s[88:89]
    v_pk_mul_f32 v[152:153], v[152:153], v[140:141] op_sel_hi:[1,0]
    v_pk_mul_f32 v[154:155], v[154:155], v[140:141] op_sel_hi:[1,0]
    v_pk_mul_f32 v[156:157], v[156:157], v[140:141] op_sel:[0,1] op_sel_hi:[1,1]
    v_pk_mul_f32 v[158:159], v[158:159], v[140:141] op_sel:[0,1] op_sel_hi:[1,1]
    v_cvt_pk_bf16_f32 v144, v152, v153
    v_cvt_pk_bf16_f32 v145, v154, v155
    v_cvt_pk_bf16_f32 v146, v156, v157
    v_cvt_pk_bf16_f32 v147, v158, v159
    buffer_store_dwordx4 v[144:147], v4, s[40:43], s62 offen sc1
    v_pk_mul_f32 v[160:161], v[160:161], v[142:143] op_sel_hi:[1,0]
    v_pk_mul_f32 v[162:163], v[162:163], v[142:143] op_sel_hi:[1,0]
    v_pk_mul_f32 v[164:165], v[164:165], v[142:143] op_sel:[0,1] op_sel_hi:[1,1]
    v_pk_mul_f32 v[166:167], v[166:167], v[142:143] op_sel:[0,1] op_sel_hi:[1,1]
    v_cvt_pk_bf16_f32 v148, v160, v161
    v_cvt_pk_bf16_f32 v149, v162, v163
    v_cvt_pk_bf16_f32 v150, v164, v165
    v_cvt_pk_bf16_f32 v151, v166, v167
    buffer_store_dwordx4 v[148:151], v4, s[40:43], s63 offen sc1
    s_add_u32 m0, s59, 0
    s_mov_b32 s73, 0
    buffer_load_dwordx4 v208, s[16:19], s73 offen lds
    s_add_u32 m0, s59, 1024
    s_mov_b32 s73, 7168
    buffer_load_dwordx4 v208, s[16:19], s73 offen lds
    s_add_u32 m0, s59, 2048
    s_mov_b32 s73, 14336
    buffer_load_dwordx4 v208, s[16:19], s73 offen lds
    s_add_u32 m0, s59, 3072
    s_mov_b32 s73, 21504
    buffer_load_dwordx4 v208, s[16:19], s73 offen lds
    s_add_u32 m0, s59, 4096
    s_mov_b32 s73, 28672
    buffer_load_dwordx4 v208, s[16:19], s73 offen lds
    s_add_u32 m0, s59, 5120
    s_mov_b32 s73, 35840
    buffer_load_dwordx4 v208, s[16:19], s73 offen lds
    s_add_u32 m0, s59, 6144
    s_mov_b32 s73, 43008
    buffer_load_dwordx4 v208, s[16:19], s73 offen lds
    s_add_u32 m0, s59, 7168
    s_mov_b32 s73, 50176
    buffer_load_dwordx4 v208, s[16:19], s73 offen lds
    s_add_u32 m0, s59, 8192
    s_mov_b32 s73, 57344
    buffer_load_dwordx4 v208, s[16:19], s73 offen lds
    s_add_u32 m0, s59, 9216
    s_mov_b32 s73, 64512
    buffer_load_dwordx4 v208, s[16:19], s73 offen lds
    s_add_u32 m0, s59, 10240
    s_mov_b32 s73, 71680
    buffer_load_dwordx4 v208, s[16:19], s73 offen lds
    s_add_u32 m0, s59, 11264
    s_mov_b32 s73, 78848
    buffer_load_dwordx4 v208, s[16:19], s73 offen lds
    s_add_u32 m0, s59, 12288
    s_mov_b32 s73, 86016
    buffer_load_dwordx4 v208, s[16:19], s73 offen lds
    s_add_u32 m0, s59, 13312
    s_mov_b32 s73, 93184
    buffer_load_dwordx4 v208, s[16:19], s73 offen lds
    s_waitcnt vmcnt(18)
    v_readfirstlane_b32 s4, v6
    s_nop 1
    s_cmp_lg_u32 s4, 0
    s_cbranch_scc1 Lepd_P_2
    s_nop 0
Lepg_P_1:
    s_sub_u32 s6, s6, 1
    s_cbranch_scc1 L_end_P
    buffer_load_dword v6, v7, s[44:47], 0 offen sc1
    s_waitcnt vmcnt(0)
    v_readfirstlane_b32 s4, v6
    s_nop 1
    s_cmp_eq_u32 s4, 0
    s_cbranch_scc1 Lepg_P_1
Lepd_P_2:
    s_waitcnt vmcnt(14)
    v_mov_b32 v8, s4
    s_mov_b64 exec, 1
    buffer_store_dword v8, v9, s[40:43], s80 offen sc1
    s_mov_b64 exec, -1
    s_cmp_lt_u32 s67, 99
    s_cbranch_scc1 Lnotag_P_3
    s_lshr_b32 s68, s2, 3
    s_sub_u32 s68, s68, 28
    s_lshl_b32 s68, s68, 2
    s_add_u32 s68, s68, s3
    s_lshl_b32 s68, s68, 16
    s_and_b32 s69, s2, 7
    s_lshl_b32 s69, s69, 9
    s_add_u32 s68, s68, s69
    v_lshrrev_b32 v16, 2, v1
    v_lshlrev_b32 v16, 12, v16
    v_and_b32 v17, 3, v1
    v_lshl_add_u32 v16, v17, 7, v16
    buffer_load_dword v18, v16, s[24:27], s68 offen
    s_add_u32 s68, s68, 0x100000
    s_waitcnt vmcnt(3)
    buffer_load_dword v19, v16, s[24:27], s68 offen
    s_add_u32 s68, s68, 0x100000
    s_waitcnt vmcnt(3)
    buffer_load_dword v20, v16, s[24:27], s68 offen
    s_add_u32 s68, s68, 0x100000
    s_waitcnt vmcnt(3)
    buffer_load_dword v21, v16, s[24:27], s68 offen
    s_add_u32 s68, s68, 0x100000
    s_waitcnt vmcnt(3)
    buffer_load_dword v22, v16, s[24:27], s68 offen
    s_add_u32 s68, s68, 0x100000
    s_waitcnt vmcnt(3)
    buffer_load_dword v23, v16, s[24:27], s68 offen
    s_add_u32 s68, s68, 0x100000
    s_waitcnt vmcnt(3)
    buffer_load_dword v24, v16, s[24:27], s68 offen
    s_add_u32 s68, s68, 0x100000
    s_waitcnt vmcnt(3)
    s_waitcnt vmcnt(0)
    s_branch L_end_P
Lnotag_P_3:
    v_lshrrev_b32 v221, 5, v1
    v_mul_u32_u24 v221, 3584, v221
    v_and_b32 v222, 31, v1
    v_lshl_add_u32 v221, v222, 1, v221
    s_lshl_b32 s58, s67, 1
    s_lshr_b32 s60, s3, 1
    s_add_u32 s58, s58, s60
    s_mul_i32 s58, s58, 28672
    s_lshl_b32 s60, s66, 7
    s_add_u32 s58, s58, s60
    s_and_b32 s60, s3, 1
    s_lshl_b32 s60, s60, 6
    s_add_u32 s58, s58, s60
    buffer_load_ushort v192, v221, s[8:11], s58 offen offset:0
    buffer_load_ushort v193, v221, s[8:11], s58 offen offset:896
    buffer_load_ushort v194, v221, s[8:11], s58 offen offset:1792
    buffer_load_ushort v195, v221, s[8:11], s58 offen offset:2688
    s_add_u32 s58, s58, 7168
    buffer_load_ushort v196, v221, s[8:11], s58 offen offset:0
    buffer_load_ushort v197, v221, s[8:11], s58 offen offset:896
    buffer_load_ushort v198, v221, s[8:11], s58 offen offset:1792
    buffer_load_ushort v199, v221, s[8:11], s58 offen offset:2688
    s_add_u32 s58, s58, 7168
    buffer_load_ushort v200, v221, s[8:11], s58 offen offset:0
    buffer_load_ushort v201, v221, s[8:11], s58 offen offset:896
    buffer_load_ushort v202, v221, s[8:11], s58 offen offset:1792
    buffer_load_ushort v203, v221, s[8:11], s58 offen offset:2688
    s_add_u32 s58, s58, 7168
    buffer_load_ushort v204, v221, s[8:11], s58 offen offset:0
    buffer_load_ushort v205, v221, s[8:11], s58 offen offset:896
    buffer_load_ushort v206, v221, s[8:11], s58 offen offset:1792
    buffer_load_ushort v207, v221, s[8:11], s58 offen offset:2688
    s_and_b32 s68, s2, 7
    s_cmp_ge_u32 s68, 7
    s_cselect_b32 s48, 7, 0
    s_sub_u32 s68, s68, s48
    s_lshl_b32 s48, s68, 12
    s_add_u32 s68, s68, 1
    s_cmp_ge_u32 s68, 7
    s_cselect_b32 s49, 7, 0
    s_sub_u32 s68, s68, s49
    s_lshl_b32 s49, s68, 12
    s_add_u32 s68, s68, 1
    s_cmp_ge_u32 s68, 7
    s_cselect_b32 s50, 7, 0
    s_sub_u32 s68, s68, s50
    s_lshl_b32 s50, s68, 12
    s_add_u32 s68, s68, 1
    s_cmp_ge_u32 s68, 7
    s_cselect_b32 s51, 7, 0
    s_sub_u32 s68, s68, s51
    s_lshl_b32 s51, s68, 12
    s_add_u32 s68, s68, 1
    s_cmp_ge_u32 s68, 7
    s_cselect_b32 s52, 7, 0
    s_sub_u32 s68, s68, s52
    s_lshl_b32 s52, s68, 12
    s_add_u32 s68, s68, 1
    s_cmp_ge_u32 s68, 7
    s_cselect_b32 s53, 7, 0
    s_sub_u32 s68, s68, s53
    s_lshl_b32 s53, s68, 12
    s_add_u32 s68, s68, 1
    s_cmp_ge_u32 s68, 7
    s_cselect_b32 s54, 7, 0
    s_sub_u32 s68, s68, s54
    s_lshl_b32 s54, s68, 12
    s_add_u32 m0, s70, 16384
    s_mul_i32 s73, s94, 56
    s_add_u32 s73, s73, 0
    buffer_load_dwordx4 v213, s[20:23], s73 offen lds
    s_add_u32 m0, s70, 17408
    s_mul_i32 s73, s94, 56
    s_add_u32 s73, s73, 28672
    buffer_load_dwordx4 v213, s[20:23], s73 offen lds
    s_add_u32 m0, s70, 18432
    s_mul_i32 s73, s94, 56
    s_add_u32 s73, s73, 57344
    buffer_load_dwordx4 v213, s[20:23], s73 offen lds
    s_add_u32 m0, s70, 19456
    s_mul_i32 s73, s94, 56
    s_add_u32 s73, s73, 86016
    buffer_load_dwordx4 v213, s[20:23], s73 offen lds
    s_add_u32 m0, s70, 20480
    s_mul_i32 s73, s94, 56
    s_add_u32 s73, s73, 114688
    buffer_load_dwordx4 v213, s[20:23], s73 offen lds
    s_add_u32 m0, s70, 21504
    s_mul_i32 s73, s94, 56
    s_add_u32 s73, s73, 143360
    buffer_load_dwordx4 v213, s[20:23], s73 offen lds
    s_add_u32 m0, s70, 22528
    s_mul_i32 s73, s94, 56
    s_add_u32 s73, s73, 172032
    buffer_load_dwordx4 v213, s[20:23], s73 offen lds
    s_add_u32 m0, s70, 23552
    s_mul_i32 s73, s94, 56
    s_add_u32 s73, s73, 200704
    buffer_load_dwordx4 v213, s[20:23], s73 offen lds
    s_waitcnt vmcnt(25)
    s_barrier
    ds_read_b64_tr_b16 a[0:1], v209 offset:0
    ds_read_b64_tr_b16 a[2:3], v209 offset:2048
    s_add_u32 m0, s70, 24576
    s_mul_i32 s73, s95, 56
    s_add_u32 s73, s73, 0
    buffer_load_dwordx4 v213, s[20:23], s73 offen lds
    ds_read_b64_tr_b16 a[4:5], v209 offset:1024
    ds_read_b64_tr_b16 a[6:7], v209 offset:3072
    s_add_u32 m0, s70, 25600
    s_mul_i32 s73, s95, 56
    s_add_u32 s73, s73, 28672
    buffer_load_dwordx4 v213, s[20:23], s73 offen lds
    ds_read_b64_tr_b16 a[8:9], v209 offset:3584
    ds_read_b64_tr_b16 a[10:11], v209 offset:5632
    ds_read_b64_tr_b16 a[12:13], v209 offset:4608
    ds_read_b64_tr_b16 a[14:15], v209 offset:6656
    s_add_u32 m0, s70, 26624
    s_mul_i32 s73, s95, 56
    s_add_u32 s73, s73, 57344
    buffer_load_dwordx4 v213, s[20:23], s73 offen lds
    ds_read_b64_tr_b16 a[16:17], v209 offset:7168
    ds_read_b64_tr_b16 a[18:19], v209 offset:9216
    s_add_u32 m0, s70, 27648
    s_mul_i32 s73, s95, 56
    s_add_u32 s73, s73, 86016
    buffer_load_dwordx4 v213, s[20:23], s73 offen lds
    ds_read_b64_tr_b16 a[20:21], v209 offset:8192
    ds_read_b64_tr_b16 a[22:23], v209 offset:10240
    ds_read_b64_tr_b16 a[24:25], v209 offset:10752
    ds_read_b64_tr_b16 a[26:27], v209 offset:12800
    s_add_u32 m0, s70, 28672
    s_mul_i32 s73, s95, 56
    s_add_u32 s73, s73, 114688
    buffer_load_dwordx4 v213, s[20:23], s73 offen lds
    ds_read_b64_tr_b16 a[28:29], v209 offset:11776
    ds_read_b64_tr_b16 a[30:31], v210 offset:13824
    s_add_u32 m0, s70, 29696
    s_mul_i32 s73, s95, 56
    s_add_u32 s73, s73, 143360
    buffer_load_dwordx4 v213, s[20:23], s73 offen lds
    ds_read_b64_tr_b16 a[32:33], v209 offset:36864
    ds_read_b64_tr_b16 a[34:35], v209 offset:38912
    ds_read_b64_tr_b16 a[36:37], v209 offset:37888
    ds_read_b64_tr_b16 a[38:39], v209 offset:39936
    s_add_u32 m0, s70, 30720
    s_mul_i32 s73, s95, 56
    s_add_u32 s73, s73, 172032
    buffer_load_dwordx4 v213, s[20:23], s73 offen lds
    ds_read_b64_tr_b16 a[40:41], v209 offset:40448
    ds_read_b64_tr_b16 a[42:43], v209 offset:42496
    s_add_u32 m0, s70, 31744
    s_mul_i32 s73, s95, 56
    s_add_u32 s73, s73, 200704
    buffer_load_dwordx4 v213, s[20:23], s73 offen lds
    ds_read_b64_tr_b16 a[44:45], v209 offset:41472
    ds_read_b64_tr_b16 a[46:47], v209 offset:43520
    ds_read_b64_tr_b16 a[48:49], v209 offset:44032
    ds_read_b64_tr_b16 a[50:51], v209 offset:46080
    s_add_u32 m0, s70, 32768
    s_mul_i32 s73, s96, 56
    s_add_u32 s73, s73, 0
    buffer_load_dwordx4 v213, s[20:23], s73 offen lds
    ds_read_b64_tr_b16 a[52:53], v209 offset:45056
    ds_read_b64_tr_b16 a[54:55], v209 offset:47104
    s_add_u32 m0, s70, 33792
    s_mul_i32 s73, s96, 56
    s_add_u32 s73, s73, 28672
    buffer_load_dwordx4 v213, s[20:23], s73 offen lds
    ds_read_b64_tr_b16 a[56:57], v209 offset:47616
    ds_read_b64_tr_b16 a[58:59], v209 offset:49664
    ds_read_b64_tr_b16 a[60:61], v209 offset:48640
    ds_read_b64_tr_b16 a[62:63], v210 offset:50688
    s_add_u32 m0, s70, 34816
    s_mul_i32 s73, s96, 56
    s_add_u32 s73, s73, 57344
    buffer_load_dwordx4 v213, s[20:23], s73 offen lds
    v_add_u32 v209, 73728, v209
    v_add_u32 v210, 73728, v210
    ds_read_b64_tr_b16 a[64:65], v209 offset:0
    ds_read_b64_tr_b16 a[66:67], v209 offset:2048
    s_add_u32 m0, s70, 35840
    s_mul_i32 s73, s96, 56
    s_add_u32 s73, s73, 86016
    buffer_load_dwordx4 v213, s[20:23], s73 offen lds
    ds_read_b64_tr_b16 a[68:69], v209 offset:1024
    ds_read_b64_tr_b16 a[70:71], v209 offset:3072
    ds_read_b64_tr_b16 a[72:73], v209 offset:3584
    ds_read_b64_tr_b16 a[74:75], v209 offset:5632
    ds_read_b64_tr_b16 a[76:77], v209 offset:4608
    ds_read_b64_tr_b16 a[78:79], v209 offset:6656
    ds_read_b64_tr_b16 a[80:81], v209 offset:7168
    ds_read_b64_tr_b16 a[82:83], v209 offset:9216
    ds_read_b64_tr_b16 a[84:85], v209 offset:8192
    ds_read_b64_tr_b16 a[86:87], v209 offset:10240
    ds_read_b64_tr_b16 a[88:89], v209 offset:10752
    ds_read_b64_tr_b16 a[90:91], v209 offset:12800
    ds_read_b64_tr_b16 a[92:93], v209 offset:11776
    ds_read_b64_tr_b16 a[94:95], v210 offset:13824
    ds_read_b64_tr_b16 a[96:97], v209 offset:36864
    ds_read_b64_tr_b16 a[98:99], v209 offset:38912
    ds_read_b64_tr_b16 a[100:101], v209 offset:37888
    ds_read_b64_tr_b16 a[102:103], v209 offset:39936
    ds_read_b64_tr_b16 a[104:105], v209 offset:40448
    ds_read_b64_tr_b16 a[106:107], v209 offset:42496
    ds_read_b64_tr_b16 a[108:109], v209 offset:41472
    ds_read_b64_tr_b16 a[110:111], v209 offset:43520
    ds_read_b64_tr_b16 a[112:113], v209 offset:44032
    ds_read_b64_tr_b16 a[114:115], v209 offset:46080
    ds_read_b64_tr_b16 a[116:117], v209 offset:45056
    ds_read_b64_tr_b16 a[118:119], v209 offset:47104
    ds_read_b64_tr_b16 a[120:121], v209 offset:47104
    ds_read_b64_tr_b16 a[122:123], v209 offset:49152
    ds_read_b64_tr_b16 a[124:125], v209 offset:48128
    ds_read_b64_tr_b16 a[126:127], v209 offset:50176
    s_waitcnt lgkmcnt(0)
    s_barrier
    buffer_load_dword v249, v10, s[40:43], s83 offen sc1
    s_sleep 3
    buffer_load_dword v250, v10, s[40:43], s83 offen sc1
    s_sleep 3
    s_nop 0
Lpoll_P_4:
    s_sub_u32 s6, s6, 1
    s_cbranch_scc1 L_end_P
    buffer_load_dword v251, v10, s[40:43], s83 offen sc1
    s_waitcnt vmcnt(2)
    v_cmp_ne_u32 vcc, s4, v249
    s_nop 1
    s_cbranch_vccz Lpd_P_5
    buffer_load_dword v249, v10, s[40:43], s83 offen sc1
    s_waitcnt vmcnt(2)
    v_cmp_ne_u32 vcc, s4, v250
    s_nop 1
    s_cbranch_vccz Lpd_P_5
    buffer_load_dword v250, v10, s[40:43], s83 offen sc1
    s_waitcnt vmcnt(2)
    v_cmp_ne_u32 vcc, s4, v251
    s_nop 1
    s_cbranch_vccnz Lpoll_P_4
    s_nop 1
Lpd_P_5:
    s_lshl_b32 s58, s67, 16
    s_lshl_b32 s60, s3, 14
    s_add_u32 s58, s58, s60
    s_add_u32 m0, s70, 0
    s_nop 0
    buffer_load_dwordx4 v4, s[40:43], s58 offen offset:0 sc1 lds
    buffer_load_dwordx4 v4, s[40:43], s58 offen offset:1024 sc1 lds
    buffer_load_dwordx4 v4, s[40:43], s58 offen offset:2048 sc1 lds
    buffer_load_dwordx4 v4, s[40:43], s58 offen offset:3072 sc1 lds
    s_add_u32 m0, s70, 4096
    s_add_u32 s58, s58, 4096
    buffer_load_dwordx4 v4, s[40:43], s58 offen offset:0 sc1 lds
    buffer_load_dwordx4 v4, s[40:43], s58 offen offset:1024 sc1 lds
    buffer_load_dwordx4 v4, s[40:43], s58 offen offset:2048 sc1 lds
    buffer_load_dwordx4 v4, s[40:43], s58 offen offset:3072 sc1 lds
    s_add_u32 m0, s70, 8192
    s_add_u32 s58, s58, 4096
    buffer_load_dwordx4 v4, s[40:43], s58 offen offset:0 sc1 lds
    buffer_load_dwordx4 v4, s[40:43], s58 offen offset:1024 sc1 lds
    buffer_load_dwordx4 v4, s[40:43], s58 offen offset:2048 sc1 lds
    buffer_load_dwordx4 v4, s[40:43], s58 offen offset:3072 sc1 lds
    s_add_u32 m0, s70, 12288
    s_add_u32 s58, s58, 4096
    buffer_load_dwordx4 v4, s[40:43], s58 offen offset:0 sc1 lds
    buffer_load_dwordx4 v4, s[40:43], s58 offen offset:1024 sc1 lds
    buffer_load_dwordx4 v4, s[40:43], s58 offen offset:2048 sc1 lds
    buffer_load_dwordx4 v4, s[40:43], s58 offen offset:3072 sc1 lds
    v_and_b32 v64, 1, v3
    v_mul_u32_u24 v64, 36864, v64
    v_lshl_add_u32 v64, v2, 4, v64
    v_lshrrev_b32 v65, 5, v1
    v_lshl_add_u32 v64, v65, 8, v64
    s_lshr_b32 s60, s3, 1
    s_mul_i32 s60, s60, 73728
    s_add_u32 s60, s60, 12288
    v_add_u32 v64, s60, v64
    ds_read_b64_tr_b16 a[128:129], v215 offset:16384
    ds_read_b64_tr_b16 a[130:131], v215 offset:17408
    ds_read_b64_tr_b16 a[132:133], v216 offset:16384
    ds_read_b64_tr_b16 a[134:135], v216 offset:17408
    ds_read_b64_tr_b16 a[136:137], v215 offset:18432
    ds_read_b64_tr_b16 a[138:139], v215 offset:19456
    ds_read_b64_tr_b16 a[140:141], v216 offset:18432
    ds_read_b64_tr_b16 a[142:143], v216 offset:19456
    ds_read_b64_tr_b16 a[144:145], v215 offset:20480
    ds_read_b64_tr_b16 a[146:147], v215 offset:21504
    ds_read_b64_tr_b16 a[148:149], v216 offset:20480
    ds_read_b64_tr_b16 a[150:151], v216 offset:21504
    ds_read_b64_tr_b16 a[152:153], v215 offset:22528
    ds_read_b64_tr_b16 a[154:155], v215 offset:23552
    ds_read_b64_tr_b16 a[156:157], v216 offset:22528
    ds_read_b64_tr_b16 a[158:159], v216 offset:23552
    ds_read_b64_tr_b16 a[160:161], v215 offset:24576
    ds_read_b64_tr_b16 a[162:163], v215 offset:25600
    ds_read_b64_tr_b16 a[164:165], v216 offset:24576
    ds_read_b64_tr_b16 a[166:167], v216 offset:25600
    ds_read_b64_tr_b16 a[168:169], v215 offset:26624
    ds_read_b64_tr_b16 a[170:171], v215 offset:27648
    ds_read_b64_tr_b16 a[172:173], v216 offset:26624
    ds_read_b64_tr_b16 a[174:175], v216 offset:27648
    ds_read_b64_tr_b16 a[176:177], v215 offset:28672
    ds_read_b64_tr_b16 a[178:179], v215 offset:29696
    ds_read_b64_tr_b16 a[180:181], v216 offset:28672
    ds_read_b64_tr_b16 a[182:183], v216 offset:29696
    ds_read_b64_tr_b16 a[184:185], v215 offset:30720
    ds_read_b64_tr_b16 a[186:187], v215 offset:31744
    ds_read_b64_tr_b16 a[188:189], v216 offset:30720
    ds_read_b64_tr_b16 a[190:191], v216 offset:31744
    ds_read_b64_tr_b16 a[192:193], v215 offset:32768
    ds_read_b64_tr_b16 a[194:195], v215 offset:33792
    ds_read_b64_tr_b16 a[196:197], v216 offset:32768
    ds_read_b64_tr_b16 a[198:199], v216 offset:33792
    ds_read_b64_tr_b16 a[200:201], v215 offset:34816
    ds_read_b64_tr_b16 a[202:203], v215 offset:35840
    ds_read_b64_tr_b16 a[204:205], v216 offset:34816
    ds_read_b64_tr_b16 a[206:207], v216 offset:35840
    v_lshlrev_b32 v192, 16, v192
    v_lshlrev_b32 v193, 16, v193
    v_lshlrev_b32 v194, 16, v194
    v_lshlrev_b32 v195, 16, v195
    v_lshlrev_b32 v196, 16, v196
    v_lshlrev_b32 v197, 16, v197
    v_lshlrev_b32 v198, 16, v198
    v_lshlrev_b32 v199, 16, v199
    v_lshlrev_b32 v200, 16, v200
    v_lshlrev_b32 v201, 16, v201
    v_lshlrev_b32 v202, 16, v202
    v_lshlrev_b32 v203, 16, v203
    v_lshlrev_b32 v204, 16, v204
    v_lshlrev_b32 v205, 16, v205
    v_lshlrev_b32 v206, 16, v206
    v_lshlrev_b32 v207, 16, v207
    s_waitcnt vmcnt(8)
    s_barrier
    ds_read_b128 v[32:35], v64 offset:0
    ds_read_b128 v[36:39], v64 offset:512
    ds_read_b128 v[40:43], v64 offset:1024
    ds_read_b128 v[44:47], v64 offset:1536
    ds_read_b128 v[48:51], v64 offset:2048
    ds_read_b128 v[52:55], v64 offset:2560
    s_waitcnt lgkmcnt(5)
    v_mfma_f32_32x32x16_bf16 v[192:207], v[32:35], a[0:3], v[192:207]
    ds_read_b128 v[56:59], v64 offset:3072
    s_add_u32 m0, s70, 16384
    s_mul_i32 s73, s96, 56
    s_add_u32 s73, s73, 114688
    buffer_load_dwordx4 v213, s[20:23], s73 offen lds
    s_waitcnt lgkmcnt(5)
    v_mfma_f32_32x32x16_bf16 v[192:207], v[36:39], a[4:7], v[192:207]
    ds_read_b128 v[60:63], v64 offset:3584
    s_waitcnt lgkmcnt(5)
    v_mfma_f32_32x32x16_bf16 v[192:207], v[40:43], a[8:11], v[192:207]
    ds_read_b128 v[32:35], v64 offset:4096
    s_waitcnt lgkmcnt(5)
    v_mfma_f32_32x32x16_bf16 v[192:207], v[44:47], a[12:15], v[192:207]
    ds_read_b128 v[36:39], v64 offset:4608
    s_add_u32 m0, s70, 17408
    s_mul_i32 s73, s96, 56
    s_add_u32 s73, s73, 143360
    buffer_load_dwordx4 v213, s[20:23], s73 offen lds
    s_waitcnt lgkmcnt(5)
    v_mfma_f32_32x32x16_bf16 v[192:207], v[48:51], a[16:19], v[192:207]
    ds_read_b128 v[40:43], v64 offset:5120
    s_waitcnt lgkmcnt(5)
    v_mfma_f32_32x32x16_bf16 v[192:207], v[52:55], a[20:23], v[192:207]
    ds_read_b128 v[44:47], v64 offset:5632
    s_waitcnt lgkmcnt(5)
    v_mfma_f32_32x32x16_bf16 v[192:207], v[56:59], a[24:27], v[192:207]
    ds_read_b128 v[48:51], v64 offset:6144
    s_add_u32 m0, s70, 18432
    s_mul_i32 s73, s96, 56
    s_add_u32 s73, s73, 172032
    buffer_load_dwordx4 v213, s[20:23], s73 offen lds
    s_waitcnt lgkmcnt(5)
    v_mfma_f32_32x32x16_bf16 v[192:207], v[60:63], a[28:31], v[192:207]
    ds_read_b128 v[52:55], v64 offset:6656
    s_waitcnt lgkmcnt(5)
    v_mfma_f32_32x32x16_bf16 v[192:207], v[32:35], a[32:35], v[192:207]
    ds_read_b128 v[56:59], v64 offset:7168
    s_waitcnt lgkmcnt(5)
    v_mfma_f32_32x32x16_bf16 v[192:207], v[36:39], a[36:39], v[192:207]
    ds_read_b128 v[60:63], v64 offset:7680
    s_add_u32 m0, s70, 19456
    s_mul_i32 s73, s96, 56
    s_add_u32 s73, s73, 200704
    buffer_load_dwordx4 v213, s[20:23], s73 offen lds
    s_waitcnt lgkmcnt(5)
    v_mfma_f32_32x32x16_bf16 v[192:207], v[40:43], a[40:43], v[192:207]
    s_waitcnt lgkmcnt(4)
    v_mfma_f32_32x32x16_bf16 v[192:207], v[44:47], a[44:47], v[192:207]
    s_waitcnt vmcnt(4)
    s_barrier
    ds_read_b128 v[32:35], v64 offset:8192
    ds_read_b128 v[36:39], v64 offset:8704
    s_waitcnt lgkmcnt(5)
    v_mfma_f32_32x32x16_bf16 v[192:207], v[48:51], a[48:51], v[192:207]
    ds_read_b128 v[40:43], v64 offset:9216
    s_add_u32 m0, s70, 20480
    s_mul_i32 s73, s97, 56
    s_add_u32 s73, s73, 0
    buffer_load_dwordx4 v213, s[20:23], s73 offen lds
    s_waitcnt lgkmcnt(5)
    v_mfma_f32_32x32x16_bf16 v[192:207], v[52:55], a[52:55], v[192:207]
    ds_read_b128 v[44:47], v64 offset:9728
    s_waitcnt lgkmcnt(5)
    v_mfma_f32_32x32x16_bf16 v[192:207], v[56:59], a[56:59], v[192:207]
    ds_read_b128 v[48:51], v64 offset:10240
    s_waitcnt lgkmcnt(5)
    v_mfma_f32_32x32x16_bf16 v[192:207], v[60:63], a[60:63], v[192:207]
    ds_read_b128 v[52:55], v64 offset:10752
    s_add_u32 m0, s70, 21504
    s_mul_i32 s73, s97, 56
    s_add_u32 s73, s73, 28672
    buffer_load_dwordx4 v213, s[20:23], s73 offen lds
    s_waitcnt lgkmcnt(5)
    v_mfma_f32_32x32x16_bf16 v[192:207], v[32:35], a[64:67], v[192:207]
    ds_read_b128 v[56:59], v64 offset:11264
    s_waitcnt lgkmcnt(5)
    v_mfma_f32_32x32x16_bf16 v[192:207], v[36:39], a[68:71], v[192:207]
    ds_read_b128 v[60:63], v64 offset:11776
    s_waitcnt lgkmcnt(5)
    v_mfma_f32_32x32x16_bf16 v[192:207], v[40:43], a[72:75], v[192:207]
    ds_read_b128 v[32:35], v64 offset:12288
    s_add_u32 m0, s70, 22528
    s_mul_i32 s73, s97, 56
    s_add_u32 s73, s73, 57344
    buffer_load_dwordx4 v213, s[20:23], s73 offen lds
    s_waitcnt lgkmcnt(5)
    v_mfma_f32_32x32x16_bf16 v[192:207], v[44:47], a[76:79], v[192:207]
    ds_read_b128 v[36:39], v64 offset:12800
    s_waitcnt lgkmcnt(5)
    v_mfma_f32_32x32x16_bf16 v[192:207], v[48:51], a[80:83], v[192:207]
    ds_read_b128 v[40:43], v64 offset:13312
    s_waitcnt lgkmcnt(5)
    v_mfma_f32_32x32x16_bf16 v[192:207], v[52:55], a[84:87], v[192:207]
    ds_read_b128 v[44:47], v64 offset:13824
    s_add_u32 m0, s70, 23552
    s_mul_i32 s73, s97, 56
    s_add_u32 s73, s73, 86016
    buffer_load_dwordx4 v213, s[20:23], s73 offen lds
    s_waitcnt lgkmcnt(5)
    v_mfma_f32_32x32x16_bf16 v[192:207], v[56:59], a[88:91], v[192:207]
    ds_read_b128 v[48:51], v64 offset:14336
    s_waitcnt lgkmcnt(5)
    v_mfma_f32_32x32x16_bf16 v[192:207], v[60:63], a[92:95], v[192:207]
    ds_read_b128 v[52:55], v64 offset:14848
    s_waitcnt lgkmcnt(5)
    v_mfma_f32_32x32x16_bf16 v[192:207], v[32:35], a[96:99], v[192:207]
    ds_read_b128 v[56:59], v64 offset:15360
    s_add_u32 m0, s70, 24576
    s_mul_i32 s73, s97, 56
    s_add_u32 s73, s73, 114688
    buffer_load_dwordx4 v213, s[20:23], s73 offen lds
    s_waitcnt lgkmcnt(5)
    v_mfma_f32_32x32x16_bf16 v[192:207], v[36:39], a[100:103], v[192:207]
    ds_read_b128 v[60:63], v64 offset:15872
    s_waitcnt lgkmcnt(5)
    v_mfma_f32_32x32x16_bf16 v[192:207], v[40:43], a[104:107], v[192:207]
    s_waitcnt lgkmcnt(4)
    v_mfma_f32_32x32x16_bf16 v[192:207], v[44:47], a[108:111], v[192:207]
    s_add_u32 m0, s70, 25600
    s_mul_i32 s73, s97, 56
    s_add_u32 s73, s73, 143360
    buffer_load_dwordx4 v213, s[20:23], s73 offen lds
    s_waitcnt lgkmcnt(3)
    v_mfma_f32_32x32x16_bf16 v[192:207], v[48:51], a[112:115], v[192:207]
    s_waitcnt lgkmcnt(2)
    v_mfma_f32_32x32x16_bf16 v[192:207], v[52:55], a[116:119], v[192:207]
    s_waitcnt lgkmcnt(1)
    v_mfma_f32_32x32x16_bf16 v[192:207], v[56:59], a[120:123], v[192:207]
    s_add_u32 m0, s70, 26624
    s_mul_i32 s73, s97, 56
    s_add_u32 s73, s73, 172032
    buffer_load_dwordx4 v213, s[20:23], s73 offen lds
    s_waitcnt lgkmcnt(0)
    v_mfma_f32_32x32x16_bf16 v[192:207], v[60:63], a[124:127], v[192:207]
    s_nop 11
    v_pk_mul_f32 v[68:69], v[192:193], v[192:193]
    v_pk_mul_f32 v[70:71], v[194:195], v[194:195]
    v_pk_mul_f32 v[72:73], v[196:197], v[196:197]
    v_pk_mul_f32 v[74:75], v[198:199], v[198:199]
    v_pk_mul_f32 v[76:77], v[200:201], v[200:201]
    v_pk_mul_f32 v[78:79], v[202:203], v[202:203]
    v_pk_mul_f32 v[80:81], v[204:205], v[204:205]
    v_pk_mul_f32 v[82:83], v[206:207], v[206:207]
    s_add_u32 m0, s70, 27648
    s_mul_i32 s73, s97, 56
    s_add_u32 s73, s73, 200704
    buffer_load_dwordx4 v213, s[20:23], s73 offen lds
    v_add_f32_dpp v84, v192, v192 row_mirror row_mask:0xf bank_mask:0x3
    v_add_f32_dpp v85, v193, v193 row_mirror row_mask:0xf bank_mask:0x3
    v_add_f32_dpp v86, v196, v196 row_mirror row_mask:0xf bank_mask:0x3
    v_add_f32_dpp v87, v197, v197 row_mirror row_mask:0xf bank_mask:0x3
    v_add_f32_dpp v88, v200, v200 row_mirror row_mask:0xf bank_mask:0x3
    v_add_f32_dpp v89, v201, v201 row_mirror row_mask:0xf bank_mask:0x3
    v_add_f32_dpp v90, v204, v204 row_mirror row_mask:0xf bank_mask:0x3
    v_add_f32_dpp v91, v205, v205 row_mirror row_mask:0xf bank_mask:0x3
    s_add_u32 m0, s70, 28672
    s_mul_i32 s73, s98, 56
    s_add_u32 s73, s73, 0
    buffer_load_dwordx4 v213, s[20:23], s73 offen lds
    v_add_f32_dpp v92, v68, v68 row_mirror row_mask:0xf bank_mask:0x3
    v_add_f32_dpp v93, v69, v69 row_mirror row_mask:0xf bank_mask:0x3
    v_add_f32_dpp v94, v72, v72 row_mirror row_mask:0xf bank_mask:0x3
    v_add_f32_dpp v95, v73, v73 row_mirror row_mask:0xf bank_mask:0x3
    v_add_f32_dpp v96, v76, v76 row_mirror row_mask:0xf bank_mask:0x3
    v_add_f32_dpp v97, v77, v77 row_mirror row_mask:0xf bank_mask:0x3
    v_add_f32_dpp v98, v80, v80 row_mirror row_mask:0xf bank_mask:0x3
    v_add_f32_dpp v99, v81, v81 row_mirror row_mask:0xf bank_mask:0x3
    s_add_u32 m0, s70, 29696
    s_mul_i32 s73, s98, 56
    s_add_u32 s73, s73, 28672
    buffer_load_dwordx4 v213, s[20:23], s73 offen lds
    v_add_f32_dpp v84, v194, v194 row_mirror row_mask:0xf bank_mask:0xc
    v_add_f32_dpp v85, v195, v195 row_mirror row_mask:0xf bank_mask:0xc
    v_add_f32_dpp v86, v198, v198 row_mirror row_mask:0xf bank_mask:0xc
    v_add_f32_dpp v87, v199, v199 row_mirror row_mask:0xf bank_mask:0xc
    v_add_f32_dpp v88, v202, v202 row_mirror row_mask:0xf bank_mask:0xc
    v_add_f32_dpp v89, v203, v203 row_mirror row_mask:0xf bank_mask:0xc
    v_add_f32_dpp v90, v206, v206 row_mirror row_mask:0xf bank_mask:0xc
    v_add_f32_dpp v91, v207, v207 row_mirror row_mask:0xf bank_mask:0xc
    s_add_u32 m0, s70, 30720
    s_mul_i32 s73, s98, 56
    s_add_u32 s73, s73, 57344
    buffer_load_dwordx4 v213, s[20:23], s73 offen lds
    v_add_f32_dpp v92, v70, v70 row_mirror row_mask:0xf bank_mask:0xc
    v_add_f32_dpp v93, v71, v71 row_mirror row_mask:0xf bank_mask:0xc
    v_add_f32_dpp v94, v74, v74 row_mirror row_mask:0xf bank_mask:0xc
    v_add_f32_dpp v95, v75, v75 row_mirror row_mask:0xf bank_mask:0xc
    v_add_f32_dpp v96, v78, v78 row_mirror row_mask:0xf bank_mask:0xc
    v_add_f32_dpp v97, v79, v79 row_mirror row_mask:0xf bank_mask:0xc
    v_add_f32_dpp v98, v82, v82 row_mirror row_mask:0xf bank_mask:0xc
    v_add_f32_dpp v99, v83, v83 row_mirror row_mask:0xf bank_mask:0xc
    s_add_u32 m0, s70, 31744
    s_mul_i32 s73, s98, 56
    s_add_u32 s73, s73, 86016
    buffer_load_dwordx4 v213, s[20:23], s73 offen lds
    v_add_f32_dpp v84, v84, v84 row_half_mirror row_mask:0xf bank_mask:0x5
    v_add_f32_dpp v86, v86, v86 row_half_mirror row_mask:0xf bank_mask:0x5
    v_add_f32_dpp v88, v88, v88 row_half_mirror row_mask:0xf bank_mask:0x5
    v_add_f32_dpp v90, v90, v90 row_half_mirror row_mask:0xf bank_mask:0x5
    v_add_f32_dpp v92, v92, v92 row_half_mirror row_mask:0xf bank_mask:0x5
    v_add_f32_dpp v94, v94, v94 row_half_mirror row_mask:0xf bank_mask:0x5
    v_add_f32_dpp v96, v96, v96 row_half_mirror row_mask:0xf bank_mask:0x5
    v_add_f32_dpp v98, v98, v98 row_half_mirror row_mask:0xf bank_mask:0x5
    v_add_f32_dpp v84, v85, v85 row_half_mirror row_mask:0xf bank_mask:0xa
    v_add_f32_dpp v86, v87, v87 row_half_mirror row_mask:0xf bank_mask:0xa
    v_add_f32_dpp v88, v89, v89 row_half_mirror row_mask:0xf bank_mask:0xa
    v_add_f32_dpp v90, v91, v91 row_half_mirror row_mask:0xf bank_mask:0xa
    v_add_f32_dpp v92, v93, v93 row_half_mirror row_mask:0xf bank_mask:0xa
    v_add_f32_dpp v94, v95, v95 row_half_mirror row_mask:0xf bank_mask:0xa
    v_add_f32_dpp v96, v97, v97 row_half_mirror row_mask:0xf bank_mask:0xa
    v_add_f32_dpp v98, v99, v99 row_half_mirror row_mask:0xf bank_mask:0xa
    v_add_f32_dpp v85, v84, v84 quad_perm:[1,0,3,2] row_mask:0xf bank_mask:0xf
    v_add_f32_dpp v87, v86, v86 quad_perm:[1,0,3,2] row_mask:0xf bank_mask:0xf
    v_add_f32_dpp v89, v88, v88 quad_perm:[1,0,3,2] row_mask:0xf bank_mask:0xf
    v_add_f32_dpp v91, v90, v90 quad_perm:[1,0,3,2] row_mask:0xf bank_mask:0xf
    v_add_f32_dpp v93, v92, v92 quad_perm:[1,0,3,2] row_mask:0xf bank_mask:0xf
    v_add_f32_dpp v95, v94, v94 quad_perm:[1,0,3,2] row_mask:0xf bank_mask:0xf
    v_add_f32_dpp v97, v96, v96 quad_perm:[1,0,3,2] row_mask:0xf bank_mask:0xf
    v_add_f32_dpp v99, v98, v98 quad_perm:[1,0,3,2] row_mask:0xf bank_mask:0xf
    v_add_f32_dpp v68, v85, v85 quad_perm:[2,3,0,1] row_mask:0xf bank_mask:0xf
    v_add_f32_dpp v69, v87, v87 quad_perm:[2,3,0,1] row_mask:0xf bank_mask:0xf
    v_add_f32_dpp v70, v89, v89 quad_perm:[2,3,0,1] row_mask:0xf bank_mask:0xf
    v_add_f32_dpp v71, v91, v91 quad_perm:[2,3,0,1] row_mask:0xf bank_mask:0xf
    v_add_f32_dpp v72, v93, v93 quad_perm:[2,3,0,1] row_mask:0xf bank_mask:0xf
    v_add_f32_dpp v73, v95, v95 quad_perm:[2,3,0,1] row_mask:0xf bank_mask:0xf
    v_add_f32_dpp v74, v97, v97 quad_perm:[2,3,0,1] row_mask:0xf bank_mask:0xf
    v_add_f32_dpp v75, v99, v99 quad_perm:[2,3,0,1] row_mask:0xf bank_mask:0xf
    v_permlane16_swap_b32 v68, v69
    v_permlane16_swap_b32 v70, v71
    v_permlane16_swap_b32 v72, v73
    v_permlane16_swap_b32 v74, v75
    v_add_f32 v84, v68, v69
    v_add_f32 v85, v72, v73
    v_add_f32 v86, v70, v71
    v_add_f32 v87, v74, v75
    v_and_b32 v65, 1, v3
    v_lshlrev_b32 v65, 6, v65
    v_lshrrev_b32 v66, 5, v1
    v_lshl_add_u32 v65, v66, 5, v65
    v_bfe_u32 v67, v1, 2, 2
    v_lshl_add_u32 v65, v67, 3, v65
    s_lshl_b32 s58, s3, 8
    v_add_u32 v65, s58, v65
    ds_write_b64 v65, v[84:85] offset:0
    ds_write_b64 v65, v[86:87] offset:128
    v_and_b32 v67, 31, v1
    v_lshlrev_b32 v65, 9, v66
    v_lshl_add_u32 v65, v67, 4, v65
    v_lshlrev_b32 v66, 8, v66
    v_lshl_add_u32 v66, v67, 3, v66
    s_and_b32 s58, s58, 512
    v_add_u32 v66, s58, v66
    s_lshl_b32 s58, s67, 1
    s_lshr_b32 s60, s3, 1
    s_add_u32 s58, s58, s60
    s_lshl_b32 s58, s58, 12
    s_add_u32 s58, s58, 0x548000
    s_lshl_b32 s60, s66, 9
    s_add_u32 s60, s60, s58
    s_waitcnt lgkmcnt(0)
    s_barrier
    ds_read_b64 v[84:85], v66 offset:0
    v_mov_b32 v89, s4
    v_mov_b32 v91, s4
    s_waitcnt lgkmcnt(0)
    v_mov_b32 v88, v84
    v_mov_b32 v90, v85
    s_nop 0
    v_permlane32_swap_b32 v88, v84
    v_permlane32_swap_b32 v90, v85
    v_add_f32 v88, v88, v84
    v_add_f32 v90, v90, v85
    s_bitcmp0_b32 s3, 0
    s_cselect_b32 exec_lo, -1, 0
    s_mov_b32 exec_hi, 0
    buffer_store_dwordx4 v[88:91], v65, s[40:43], s60 offen sc1
    s_mov_b64 exec, -1
    v_cvt_pk_bf16_f32 v240, v192, v193
    v_cvt_pk_bf16_f32 v241, v194, v195
    v_cvt_pk_bf16_f32 v242, v196, v197
    v_cvt_pk_bf16_f32 v243, v198, v199
    v_cvt_pk_bf16_f32 v244, v200, v201
    v_cvt_pk_bf16_f32 v245, v202, v203
    v_cvt_pk_bf16_f32 v246, v204, v205
    v_cvt_pk_bf16_f32 v247, v206, v207
    s_lshl_b32 s61, s66, 1
    s_and_b32 s60, s3, 1
    s_add_u32 s61, s61, s60
    s_lshl_b32 s61, s61, 7
    s_lshl_b32 s60, s67, 2
    s_add_u32 s61, s61, s60
    s_and_b32 s60, s3, 2
    s_add_u32 s61, s61, s60
    s_lshl_b32 s61, s61, 10
    s_add_u32 s61, s61, 0x200000
    v_lshlrev_b32 v66, 4, v67
    v_cmp_gt_u32 s[86:87], 32, v1
    s_add_u32 m0, s70, 0
    s_mul_i32 s73, s98, 56
    s_add_u32 s73, s73, 114688
    buffer_load_dwordx4 v213, s[20:23], s73 offen lds
    s_add_u32 m0, s70, 1024
    s_mul_i32 s73, s98, 56
    s_add_u32 s73, s73, 143360
    buffer_load_dwordx4 v213, s[20:23], s73 offen lds
    s_add_u32 m0, s70, 2048
    s_mul_i32 s73, s98, 56
    s_add_u32 s73, s73, 172032
    buffer_load_dwordx4 v213, s[20:23], s73 offen lds
    s_add_u32 m0, s70, 3072
    s_mul_i32 s73, s98, 56
    s_add_u32 s73, s73, 200704
    buffer_load_dwordx4 v213, s[20:23], s73 offen lds
    s_add_u32 m0, s70, 4096
    s_mul_i32 s73, s99, 56
    s_add_u32 s73, s73, 0
    buffer_load_dwordx4 v213, s[20:23], s73 offen lds
    s_add_u32 m0, s70, 5120
    s_mul_i32 s73, s99, 56
    s_add_u32 s73, s73, 28672
    buffer_load_dwordx4 v213, s[20:23], s73 offen lds
    s_add_u32 m0, s70, 6144
    s_mul_i32 s73, s99, 56
    s_add_u32 s73, s73, 57344
    buffer_load_dwordx4 v213, s[20:23], s73 offen lds
    s_add_u32 m0, s70, 7168
    s_mul_i32 s73, s99, 56
    s_add_u32 s73, s73, 86016
    buffer_load_dwordx4 v213, s[20:23], s73 offen lds
    s_add_u32 m0, s70, 8192
    s_mul_i32 s73, s99, 56
    s_add_u32 s73, s73, 114688
    buffer_load_dwordx4 v213, s[20:23], s73 offen lds
    s_add_u32 m0, s70, 9216
    s_mul_i32 s73, s99, 56
    s_add_u32 s73, s73, 143360
    buffer_load_dwordx4 v213, s[20:23], s73 offen lds
    s_add_u32 m0, s70, 10240
    s_mul_i32 s73, s99, 56
    s_add_u32 s73, s73, 172032
    buffer_load_dwordx4 v213, s[20:23], s73 offen lds
    s_add_u32 m0, s70, 11264
    s_mul_i32 s73, s99, 56
    s_add_u32 s73, s73, 200704
    buffer_load_dwordx4 v213, s[20:23], s73 offen lds
    s_add_u32 m0, s70, 12288
    s_mul_i32 s73, s100, 56
    s_add_u32 s73, s73, 0
    buffer_load_dwordx4 v213, s[20:23], s73 offen lds
    s_add_u32 m0, s70, 13312
    s_mul_i32 s73, s100, 56
    s_add_u32 s73, s73, 28672
    buffer_load_dwordx4 v213, s[20:23], s73 offen lds
    s_add_u32 m0, s70, 14336
    s_mul_i32 s73, s100, 56
    s_add_u32 s73, s73, 57344
    buffer_load_dwordx4 v213, s[20:23], s73 offen lds
    s_add_u32 m0, s70, 15360
    s_mul_i32 s73, s100, 56
    s_add_u32 s73, s73, 86016
    buffer_load_dwordx4 v213, s[20:23], s73 offen lds
    buffer_load_dwordx4 v[96:99], v65, s[40:43], s58 offen offset:0 sc1
    buffer_load_dwordx4 v[100:103], v65, s[40:43], s58 offen offset:1024 sc1
    buffer_load_dwordx4 v[104:107], v65, s[40:43], s58 offen offset:2048 sc1
    buffer_load_dwordx4 v[108:111], v66, s[40:43], s58 offen offset:3072 sc1
    s_sleep 5
    s_nop 0
Lst_P_6:
    s_sub_u32 s6, s6, 1
    s_cbranch_scc1 L_end_P
    buffer_load_dwordx4 v[112:115], v65, s[40:43], s58 offen offset:0 sc1
    buffer_load_dwordx4 v[116:119], v65, s[40:43], s58 offen offset:1024 sc1
    buffer_load_dwordx4 v[120:123], v65, s[40:43], s58 offen offset:2048 sc1
    buffer_load_dwordx4 v[124:127], v66, s[40:43], s58 offen offset:3072 sc1
    s_waitcnt vmcnt(4)
    v_xor_b32 v97, s4, v97
    v_xor_b32 v99, s4, v99
    v_xor_b32 v101, s4, v101
    v_xor_b32 v103, s4, v103
    v_xor_b32 v105, s4, v105
    v_xor_b32 v107, s4, v107
    v_xor_b32 v109, s4, v109
    v_xor_b32 v111, s4, v111
    v_cndmask_b32 v108, 0, v108, s[86:87]
    v_cndmask_b32 v110, 0, v110, s[86:87]
    v_or3_b32 v97, v97, v99, v101
    v_or3_b32 v103, v103, v105, v107
    v_or3_b32 v97, v97, v109, v111
    v_or_b32 v97, v97, v103
    v_cmp_ne_u32 vcc, 0, v97
    v_add_f32 v128, v96, v100
    v_add_f32 v129, v104, v108
    v_add_f32 v130, v98, v102
    v_add_f32 v131, v106, v110
    s_cbranch_vccz Lstd_P_7
    buffer_load_dwordx4 v[96:99], v65, s[40:43], s58 offen offset:0 sc1
    buffer_load_dwordx4 v[100:103], v65, s[40:43], s58 offen offset:1024 sc1
    buffer_load_dwordx4 v[104:107], v65, s[40:43], s58 offen offset:2048 sc1
    buffer_load_dwordx4 v[108:111], v66, s[40:43], s58 offen offset:3072 sc1
    s_waitcnt vmcnt(4)
    v_xor_b32 v113, s4, v113
    v_xor_b32 v115, s4, v115
    v_xor_b32 v117, s4, v117
    v_xor_b32 v119, s4, v119
    v_xor_b32 v121, s4, v121
    v_xor_b32 v123, s4, v123
    v_xor_b32 v125, s4, v125
    v_xor_b32 v127, s4, v127
    v_cndmask_b32 v124, 0, v124, s[86:87]
    v_cndmask_b32 v126, 0, v126, s[86:87]
    v_or3_b32 v113, v113, v115, v117
    v_or3_b32 v119, v119, v121, v123
    v_or3_b32 v113, v113, v125, v127
    v_or_b32 v113, v113, v119
    v_cmp_ne_u32 vcc, 0, v113
    v_add_f32 v128, v112, v116
    v_add_f32 v129, v120, v124
    v_add_f32 v130, v114, v118
    v_add_f32 v131, v122, v126
    s_cbranch_vccnz Lst_P_6
    s_nop 3
Lstd_P_7:
    v_add_f32 v128, v128, v129
    v_add_f32 v130, v130, v131
    v_mov_b32 v136, v128
    v_mov_b32 v138, v130
    s_nop 0
    v_permlane32_swap_b32 v128, v136
    v_permlane32_swap_b32 v130, v138
    v_add_f32 v128, v128, v136
    v_add_f32 v130, v130, v138
    v_mul_f32 v133, 0x3b124925, v128
    v_mul_f32 v130, 0x3b124925, v130
    v_fma_f32 v130, -v133, v133, v130
    v_max_f32 v130, 0, v130
    v_add_f32 v135, 0x3727c5ac, v130
    v_rsq_f32 v135, v135
    s_nop 0
    v_mul_f32 v130, v130, v135
    v_fmaak_f32 v130, v130, v135, 0x3727c5ac
    v_rsq_f32 v130, v130
    s_nop 0
    v_mul_f32 v135, v135, v130
    s_lshl_b32 s60, s3, 8
    v_lshl_add_u32 v66, v67, 2, s60
    ds_write_b32 v66, v133 offset:1024
    ds_write_b32 v66, v135 offset:1152
    v_lshrrev_b32 v66, 5, v1
    v_lshl_add_u32 v66, v66, 4, s60
    s_waitcnt lgkmcnt(0)
    ds_read_b128 v[140:143], v66 offset:1024
    ds_read_b128 v[156:159], v66 offset:1152
    ds_read_b128 v[144:147], v66 offset:1056
    ds_read_b128 v[160:163], v66 offset:1184
    ds_read_b128 v[148:151], v66 offset:1088
    ds_read_b128 v[164:167], v66 offset:1216
    ds_read_b128 v[152:155], v66 offset:1120
    ds_read_b128 v[168:171], v66 offset:1248
    s_waitcnt lgkmcnt(7)
    v_pk_add_f32 v[192:193], v[192:193], v[140:141] neg_lo:[0,1] neg_hi:[0,1]
    v_pk_add_f32 v[194:195], v[194:195], v[142:143] neg_lo:[0,1] neg_hi:[0,1]
    s_waitcnt lgkmcnt(5)
    v_pk_add_f32 v[196:197], v[196:197], v[144:145] neg_lo:[0,1] neg_hi:[0,1]
    v_pk_add_f32 v[198:199], v[198:199], v[146:147] neg_lo:[0,1] neg_hi:[0,1]
    v_pk_mul_f32 v[192:193], v[192:193], v[156:157]
    v_pk_mul_f32 v[194:195], v[194:195], v[158:159]
    s_waitcnt lgkmcnt(4)
    v_pk_mul_f32 v[196:197], v[196:197], v[160:161]
    v_pk_mul_f32 v[198:199], v[198:199], v[162:163]
    v_cvt_pk_bf16_f32 v84, v192, v193
    v_cvt_pk_bf16_f32 v85, v194, v195
    v_cvt_pk_bf16_f32 v86, v196, v197
    v_cvt_pk_bf16_f32 v87, v198, v199
    buffer_store_dwordx4 v[84:87], v4, s[40:43], s61 offen offset:0 sc1
    s_waitcnt lgkmcnt(3)
    v_pk_add_f32 v[200:201], v[200:201], v[148:149] neg_lo:[0,1] neg_hi:[0,1]
    v_pk_add_f32 v[202:203], v[202:203], v[150:151] neg_lo:[0,1] neg_hi:[0,1]
    s_waitcnt lgkmcnt(1)
    v_pk_add_f32 v[204:205], v[204:205], v[152:153] neg_lo:[0,1] neg_hi:[0,1]
    v_pk_add_f32 v[206:207], v[206:207], v[154:155] neg_lo:[0,1] neg_hi:[0,1]
    v_pk_mul_f32 v[200:201], v[200:201], v[164:165]
    v_pk_mul_f32 v[202:203], v[202:203], v[166:167]
    s_waitcnt lgkmcnt(0)
    v_pk_mul_f32 v[204:205], v[204:205], v[168:169]
    v_pk_mul_f32 v[206:207], v[206:207], v[170:171]
    v_cvt_pk_bf16_f32 v88, v200, v201
    v_cvt_pk_bf16_f32 v89, v202, v203
    v_cvt_pk_bf16_f32 v90, v204, v205
    v_cvt_pk_bf16_f32 v91, v206, v207
    buffer_store_dwordx4 v[88:91], v4, s[40:43], s61 offen offset:1024 sc1
    ds_read_b64_tr_b16 a[208:209], v215 offset:16384
    ds_read_b64_tr_b16 a[210:211], v215 offset:17408
    ds_read_b64_tr_b16 a[212:213], v216 offset:16384
    ds_read_b64_tr_b16 a[214:215], v216 offset:17408
    ds_read_b64_tr_b16 a[216:217], v215 offset:18432
    ds_read_b64_tr_b16 a[218:219], v215 offset:19456
    ds_read_b64_tr_b16 a[220:221], v216 offset:18432
    ds_read_b64_tr_b16 a[222:223], v216 offset:19456
    ds_read_b64_tr_b16 a[224:225], v215 offset:20480
    ds_read_b64_tr_b16 a[226:227], v215 offset:21504
    ds_read_b64_tr_b16 a[228:229], v216 offset:20480
    ds_read_b64_tr_b16 a[230:231], v216 offset:21504
    ds_read_b64_tr_b16 a[232:233], v215 offset:22528
    ds_read_b64_tr_b16 a[234:235], v215 offset:23552
    ds_read_b64_tr_b16 a[236:237], v216 offset:22528
    ds_read_b64_tr_b16 a[238:239], v216 offset:23552
    ds_read_b64_tr_b16 a[240:241], v215 offset:24576
    ds_read_b64_tr_b16 a[242:243], v215 offset:25600
    ds_read_b64_tr_b16 a[244:245], v216 offset:24576
    ds_read_b64_tr_b16 a[246:247], v216 offset:25600
    ds_read_b64_tr_b16 a[248:249], v215 offset:26624
    ds_read_b64_tr_b16 a[250:251], v215 offset:27648
    ds_read_b64_tr_b16 a[252:253], v216 offset:26624
    ds_read_b64_tr_b16 a[254:255], v216 offset:27648
    ds_read_b64_tr_b16 a[0:1], v215 offset:28672
    ds_read_b64_tr_b16 a[2:3], v215 offset:29696
    ds_read_b64_tr_b16 a[4:5], v216 offset:28672
    ds_read_b64_tr_b16 a[6:7], v216 offset:29696
    ds_read_b64_tr_b16 a[8:9], v215 offset:30720
    ds_read_b64_tr_b16 a[10:11], v215 offset:31744
    ds_read_b64_tr_b16 a[12:13], v216 offset:30720
    ds_read_b64_tr_b16 a[14:15], v216 offset:31744
    ds_read_b64_tr_b16 a[16:17], v215 offset:0
    ds_read_b64_tr_b16 a[18:19], v215 offset:1024
    ds_read_b64_tr_b16 a[20:21], v216 offset:0
    ds_read_b64_tr_b16 a[22:23], v216 offset:1024
    ds_read_b64_tr_b16 a[24:25], v215 offset:2048
    ds_read_b64_tr_b16 a[26:27], v215 offset:3072
    ds_read_b64_tr_b16 a[28:29], v216 offset:2048
    ds_read_b64_tr_b16 a[30:31], v216 offset:3072
    ds_read_b64_tr_b16 a[32:33], v215 offset:4096
    ds_read_b64_tr_b16 a[34:35], v215 offset:5120
    ds_read_b64_tr_b16 a[36:37], v216 offset:4096
    ds_read_b64_tr_b16 a[38:39], v216 offset:5120
    ds_read_b64_tr_b16 a[40:41], v215 offset:6144
    ds_read_b64_tr_b16 a[42:43], v215 offset:7168
    ds_read_b64_tr_b16 a[44:45], v216 offset:6144
    ds_read_b64_tr_b16 a[46:47], v216 offset:7168
    ds_read_b64_tr_b16 a[48:49], v215 offset:8192
    ds_read_b64_tr_b16 a[50:51], v215 offset:9216
    ds_read_b64_tr_b16 a[52:53], v216 offset:8192
    ds_read_b64_tr_b16 a[54:55], v216 offset:9216
    ds_read_b64_tr_b16 a[56:57], v215 offset:10240
    ds_read_b64_tr_b16 a[58:59], v215 offset:11264
    ds_read_b64_tr_b16 a[60:61], v216 offset:10240
    ds_read_b64_tr_b16 a[62:63], v216 offset:11264
    ds_read_b64_tr_b16 a[64:65], v215 offset:12288
    ds_read_b64_tr_b16 a[66:67], v215 offset:13312
    ds_read_b64_tr_b16 a[68:69], v216 offset:12288
    ds_read_b64_tr_b16 a[70:71], v216 offset:13312
    ds_read_b64_tr_b16 a[72:73], v215 offset:14336
    ds_read_b64_tr_b16 a[74:75], v215 offset:15360
    ds_read_b64_tr_b16 a[76:77], v216 offset:14336
    ds_read_b64_tr_b16 a[78:79], v216 offset:15360
    s_waitcnt vmcnt(0)
    v_mov_b32 v8, s4
    s_mov_b64 exec, 1
    buffer_store_dword v8, v9, s[40:43], s81 offen sc1
    s_mov_b64 exec, -1
    s_waitcnt lgkmcnt(4)
    s_add_u32 m0, s70, 12288
    s_mul_i32 s73, s100, 56
    s_add_u32 s73, s73, 114688
    buffer_load_dwordx4 v213, s[20:23], s73 offen lds
    s_add_u32 m0, s70, 13312
    s_mul_i32 s73, s100, 56
    s_add_u32 s73, s73, 143360
    buffer_load_dwordx4 v213, s[20:23], s73 offen lds
    s_waitcnt lgkmcnt(0)
    s_add_u32 m0, s70, 14336
    s_mul_i32 s73, s100, 56
    s_add_u32 s73, s73, 172032
    buffer_load_dwordx4 v213, s[20:23], s73 offen lds
    s_add_u32 m0, s70, 15360
    s_mul_i32 s73, s100, 56
    s_add_u32 s73, s73, 200704
    buffer_load_dwordx4 v213, s[20:23], s73 offen lds
    s_add_u32 m0, s70, 16384
    s_mul_i32 s73, s101, 56
    s_add_u32 s73, s73, 0
    buffer_load_dwordx4 v213, s[20:23], s73 offen lds
    s_add_u32 m0, s70, 17408
    s_mul_i32 s73, s101, 56
    s_add_u32 s73, s73, 28672
    buffer_load_dwordx4 v213, s[20:23], s73 offen lds
    s_add_u32 m0, s70, 18432
    s_mul_i32 s73, s101, 56
    s_add_u32 s73, s73, 57344
    buffer_load_dwordx4 v213, s[20:23], s73 offen lds
    s_add_u32 m0, s70, 19456
    s_mul_i32 s73, s101, 56
    s_add_u32 s73, s73, 86016
    buffer_load_dwordx4 v213, s[20:23], s73 offen lds
    s_add_u32 m0, s70, 20480
    s_mul_i32 s73, s101, 56
    s_add_u32 s73, s73, 114688
    buffer_load_dwordx4 v213, s[20:23], s73 offen lds
    s_add_u32 m0, s70, 21504
    s_mul_i32 s73, s101, 56
    s_add_u32 s73, s73, 143360
    buffer_load_dwordx4 v213, s[20:23], s73 offen lds
    s_add_u32 m0, s70, 22528
    s_mul_i32 s73, s101, 56
    s_add_u32 s73, s73, 172032
    buffer_load_dwordx4 v213, s[20:23], s73 offen lds
    s_add_u32 m0, s70, 23552
    s_mul_i32 s73, s101, 56
    s_add_u32 s73, s73, 200704
    buffer_load_dwordx4 v213, s[20:23], s73 offen lds
    s_add_u32 m0, s70, 24576
    s_mul_i32 s73, s48, 64
    s_add_u32 s73, s73, 0
    buffer_load_dwordx4 v214, s[24:27], s73 offen lds
    s_add_u32 m0, s70, 25600
    s_mul_i32 s73, s48, 64
    s_add_u32 s73, s73, 32768
    buffer_load_dwordx4 v214, s[24:27], s73 offen lds
    s_add_u32 m0, s70, 26624
    s_mul_i32 s73, s48, 64
    s_add_u32 s73, s73, 65536
    buffer_load_dwordx4 v214, s[24:27], s73 offen lds
    s_add_u32 m0, s70, 27648
    s_mul_i32 s73, s48, 64
    s_add_u32 s73, s73, 98304
    buffer_load_dwordx4 v214, s[24:27], s73 offen lds
    s_add_u32 m0, s70, 28672
    s_mul_i32 s73, s48, 64
    s_add_u32 s73, s73, 131072
    buffer_load_dwordx4 v214, s[24:27], s73 offen lds
    s_add_u32 m0, s70, 29696
    s_mul_i32 s73, s48, 64
    s_add_u32 s73, s73, 163840
    buffer_load_dwordx4 v214, s[24:27], s73 offen lds
    s_add_u32 m0, s70, 30720
    s_mul_i32 s73, s48, 64
    s_add_u32 s73, s73, 196608
    buffer_load_dwordx4 v214, s[24:27], s73 offen lds
    s_add_u32 m0, s70, 31744
    s_mul_i32 s73, s48, 64
    s_add_u32 s73, s73, 229376
    buffer_load_dwordx4 v214, s[24:27], s73 offen lds
    s_add_u32 m0, s70, 32768
    s_mul_i32 s73, s49, 64
    s_add_u32 s73, s73, 0
    buffer_load_dwordx4 v214, s[24:27], s73 offen lds
    s_add_u32 m0, s70, 33792
    s_mul_i32 s73, s49, 64
    s_add_u32 s73, s73, 32768
    buffer_load_dwordx4 v214, s[24:27], s73 offen lds
    s_add_u32 m0, s70, 34816
    s_mul_i32 s73, s49, 64
    s_add_u32 s73, s73, 65536
    buffer_load_dwordx4 v214, s[24:27], s73 offen lds
    s_add_u32 m0, s70, 35840
    s_mul_i32 s73, s49, 64
    s_add_u32 s73, s73, 98304
    buffer_load_dwordx4 v214, s[24:27], s73 offen lds
    s_lshl_b32 s71, s64, 18
    s_lshl_b32 s86, s3, 15
    s_add_u32 s71, s71, s86
    s_add_u32 s71, s71, 0x200000
    s_add_u32 s72, s71, 0x20000
    s_mul_i32 s58, s66, 229376
    s_add_u32 s58, s58, 0x3c0000
    s_lshl_b32 s86, s65, 2
    s_add_u32 s86, s86, s3
    s_lshl_b32 s86, s86, 10
    s_add_u32 s57, s58, s86
    s_mul_i32 s86, s3, 28672
    s_add_u32 s58, s58, s86
    s_add_u32 s59, s58, 114688
    v_lshrrev_b32 v208, 5, v1
    v_lshlrev_b32 v208, 3, v208
    s_lshl_b32 s86, s65, 7
    s_lshl_b32 s87, s3, 5
    s_add_u32 s86, s86, s87
    buffer_load_dwordx2 v[220:221], v208, s[28:31], s86 offen offset:0
    buffer_load_dwordx2 v[222:223], v208, s[28:31], s86 offen offset:16
    s_lshl_b32 s86, s67, 7
    s_lshr_b32 s87, s3, 1
    s_lshl_b32 s87, s87, 6
    s_add_u32 s86, s86, s87
    buffer_load_dwordx2 v[224:225], v208, s[32:35], s86 offen offset:0
    buffer_load_dwordx2 v[226:227], v208, s[32:35], s86 offen offset:16
    buffer_load_dwordx2 v[228:229], v208, s[32:35], s86 offen offset:32
    buffer_load_dwordx2 v[230:231], v208, s[32:35], s86 offen offset:48
    v_add_u32 v232, s70, v4
    s_xor_b32 s86, s3, 1
    s_mul_i32 s86, s86, 36864
    s_add_u32 s86, s86, 12288
    v_add_u32 v233, s86, v4
    s_xor_b32 s86, s3, 2
    s_mul_i32 s86, s86, 36864
    s_add_u32 s86, s86, 14336
    v_add_u32 v234, s86, v4
    s_xor_b32 s86, s3, 3
    s_mul_i32 s86, s86, 36864
    s_add_u32 s86, s86, 16384
    v_add_u32 v235, s86, v4
    v_lshrrev_b32 v208, 5, v1
    v_lshlrev_b32 v208, 9, v208
    v_and_b32 v209, 31, v1
    v_lshl_add_u32 v208, v209, 2, v208
    s_lshr_b32 s86, s3, 1
    s_lshl_b32 s86, s86, 12
    v_add_u32 v208, s86, v208
    v_xor_b32 v209, 0x1000, v208
    v_add_u32 v236, s70, v208
    v_add_u32 v237, s70, v209
    s_lshl_b32 s86, s3, 11
    s_add_u32 s86, s86, 12288
    v_add_u32 v238, s86, v4
    v_add_u32 v239, 73728, v238
    v_lshrrev_b32 v208, 3, v1
    v_mul_u32_u24 v212, 896, v208
    v_and_b32 v208, 7, v1
    v_lshl_add_u32 v212, v208, 3, v212
    s_lshl_b32 s68, s67, 2
    s_add_u32 s68, s68, s3
    s_mul_i32 s68, s68, 14336
    s_lshl_b32 s86, s66, 7
    s_add_u32 s68, s68, s86
    s_add_u32 s69, s68, 7168
    s_mov_b32 s88, 0xc0135761
    s_mov_b32 s89, 0xc0135761
    s_mov_b32 s90, 0xbdd2d3e8
    s_mov_b32 s91, 0xffff0000
    buffer_load_dword v249, v11, s[40:43], s84 offen sc1
    s_sleep 3
    buffer_load_dword v250, v11, s[40:43], s84 offen sc1
    s_sleep 3
    s_nop 0
Lpoll_P_8:
    s_sub_u32 s6, s6, 1
    s_cbranch_scc1 L_end_P
    buffer_load_dword v251, v11, s[40:43], s84 offen sc1
    s_waitcnt vmcnt(2)
    v_cmp_ne_u32 vcc, s4, v249
    s_nop 1
    s_cbranch_vccz Lpd_P_9
    buffer_load_dword v249, v11, s[40:43], s84 offen sc1
    s_waitcnt vmcnt(2)
    v_cmp_ne_u32 vcc, s4, v250
    s_nop 1
    s_cbranch_vccz Lpd_P_9
    buffer_load_dword v250, v11, s[40:43], s84 offen sc1
    s_waitcnt vmcnt(2)
    v_cmp_ne_u32 vcc, s4, v251
    s_nop 1
    s_cbranch_vccnz Lpoll_P_8
    s_nop 1
Lpd_P_9:
    s_add_u32 s56, s71, s94
    buffer_load_dwordx4 v[80:83], v5, s[40:43], s56 offen offset:0 sc1
    buffer_load_dwordx4 v[84:87], v5, s[40:43], s56 offen offset:1024 sc1
    buffer_load_dwordx4 v[88:91], v5, s[40:43], s56 offen offset:2048 sc1
    buffer_load_dwordx4 v[92:95], v5, s[40:43], s56 offen offset:3072 sc1
    s_add_u32 s56, s71, s95
    buffer_load_dwordx4 v[96:99], v5, s[40:43], s56 offen offset:0 sc1
    buffer_load_dwordx4 v[100:103], v5, s[40:43], s56 offen offset:1024 sc1
    buffer_load_dwordx4 v[104:107], v5, s[40:43], s56 offen offset:2048 sc1
    buffer_load_dwordx4 v[108:111], v5, s[40:43], s56 offen offset:3072 sc1
    v_lshlrev_b32 v16, 16, v220
    v_and_b32 v17, s91, v220
    v_lshlrev_b32 v18, 16, v221
    v_and_b32 v19, s91, v221
    v_lshlrev_b32 v20, 16, v222
    v_and_b32 v21, s91, v222
    v_lshlrev_b32 v22, 16, v223
    v_and_b32 v23, s91, v223
    v_mov_b64 v[24:25], 0
    v_mov_b64 v[26:27], 0
    v_mov_b64 v[28:29], 0
    v_mov_b64 v[30:31], 0
    ds_read_b64_tr_b16 a[80:81], v215 offset:12288
    ds_read_b64_tr_b16 a[82:83], v215 offset:13312
    ds_read_b64_tr_b16 a[84:85], v216 offset:12288
    ds_read_b64_tr_b16 a[86:87], v216 offset:13312
    ds_read_b64_tr_b16 a[88:89], v215 offset:14336
    ds_read_b64_tr_b16 a[90:91], v215 offset:15360
    ds_read_b64_tr_b16 a[92:93], v216 offset:14336
    ds_read_b64_tr_b16 a[94:95], v216 offset:15360
    ds_read_b64_tr_b16 a[96:97], v215 offset:16384
    ds_read_b64_tr_b16 a[98:99], v215 offset:17408
    ds_read_b64_tr_b16 a[100:101], v216 offset:16384
    ds_read_b64_tr_b16 a[102:103], v216 offset:17408
    ds_read_b64_tr_b16 a[104:105], v215 offset:18432
    ds_read_b64_tr_b16 a[106:107], v215 offset:19456
    ds_read_b64_tr_b16 a[108:109], v216 offset:18432
    ds_read_b64_tr_b16 a[110:111], v216 offset:19456
    ds_read_b64_tr_b16 a[112:113], v215 offset:20480
    ds_read_b64_tr_b16 a[114:115], v215 offset:21504
    ds_read_b64_tr_b16 a[116:117], v216 offset:20480
    ds_read_b64_tr_b16 a[118:119], v216 offset:21504
    ds_read_b64_tr_b16 a[120:121], v215 offset:22528
    ds_read_b64_tr_b16 a[122:123], v215 offset:23552
    ds_read_b64_tr_b16 a[124:125], v216 offset:22528
    ds_read_b64_tr_b16 a[126:127], v216 offset:23552
    v_mov_b32 v9, v5
    s_add_u32 s56, s71, s96
    buffer_load_dwordx4 v[112:115], v5, s[40:43], s56 offen offset:0 sc1
    buffer_load_dwordx4 v[116:119], v5, s[40:43], s56 offen offset:1024 sc1
    s_waitcnt vmcnt(9)
    v_mfma_f32_32x32x16_bf16 v[16:31], a[128:131], v[80:83], v[16:31]
    v_mfma_f32_32x32x16_bf16 v[32:47], a[132:135], v[80:83], 0
    buffer_load_dwordx4 v[120:123], v5, s[40:43], s56 offen offset:2048 sc1
    s_waitcnt vmcnt(9)
    v_mfma_f32_32x32x16_bf16 v[16:31], a[136:139], v[84:87], v[16:31]
    v_mfma_f32_32x32x16_bf16 v[32:47], a[140:143], v[84:87], v[32:47]
    buffer_load_dwordx4 v[124:127], v5, s[40:43], s56 offen offset:3072 sc1
    s_waitcnt vmcnt(9)
    v_mfma_f32_32x32x16_bf16 v[16:31], a[144:147], v[88:91], v[16:31]
    v_mfma_f32_32x32x16_bf16 v[32:47], a[148:151], v[88:91], v[32:47]
    s_add_u32 s56, s71, s97
    buffer_load_dwordx4 v[128:131], v5, s[40:43], s56 offen offset:0 sc1
    s_waitcnt vmcnt(9)
    v_mfma_f32_32x32x16_bf16 v[16:31], a[152:155], v[92:95], v[16:31]
    v_mfma_f32_32x32x16_bf16 v[32:47], a[156:159], v[92:95], v[32:47]
    buffer_load_dwordx4 v[132:135], v5, s[40:43], s56 offen offset:1024 sc1
    s_waitcnt vmcnt(9)
    v_mfma_f32_32x32x16_bf16 v[16:31], a[160:163], v[96:99], v[16:31]
    v_mfma_f32_32x32x16_bf16 v[32:47], a[164:167], v[96:99], v[32:47]
    buffer_load_dwordx4 v[136:139], v5, s[40:43], s56 offen offset:2048 sc1
    s_waitcnt vmcnt(9)
    v_mfma_f32_32x32x16_bf16 v[16:31], a[168:171], v[100:103], v[16:31]
    v_mfma_f32_32x32x16_bf16 v[32:47], a[172:175], v[100:103], v[32:47]
    buffer_load_dwordx4 v[140:143], v5, s[40:43], s56 offen offset:3072 sc1
    s_waitcnt vmcnt(9)
    v_mfma_f32_32x32x16_bf16 v[16:31], a[176:179], v[104:107], v[16:31]
    v_mfma_f32_32x32x16_bf16 v[32:47], a[180:183], v[104:107], v[32:47]
    s_add_u32 s56, s71, s98
    buffer_load_dwordx4 v[144:147], v5, s[40:43], s56 offen offset:0 sc1
    s_waitcnt vmcnt(9)
    v_mfma_f32_32x32x16_bf16 v[16:31], a[184:187], v[108:111], v[16:31]
    v_mfma_f32_32x32x16_bf16 v[32:47], a[188:191], v[108:111], v[32:47]
    buffer_load_dwordx4 v[148:151], v5, s[40:43], s56 offen offset:1024 sc1
    s_waitcnt vmcnt(9)
    v_mfma_f32_32x32x16_bf16 v[16:31], a[192:195], v[112:115], v[16:31]
    v_mfma_f32_32x32x16_bf16 v[32:47], a[196:199], v[112:115], v[32:47]
    buffer_load_dwordx4 v[152:155], v5, s[40:43], s56 offen offset:2048 sc1
    s_waitcnt vmcnt(9)
    v_mfma_f32_32x32x16_bf16 v[16:31], a[200:203], v[116:119], v[16:31]
    v_mfma_f32_32x32x16_bf16 v[32:47], a[204:207], v[116:119], v[32:47]
    buffer_load_dwordx4 v[156:159], v5, s[40:43], s56 offen offset:3072 sc1
    s_waitcnt vmcnt(9)
    v_mfma_f32_32x32x16_bf16 v[16:31], a[208:211], v[120:123], v[16:31]
    v_mfma_f32_32x32x16_bf16 v[32:47], a[212:215], v[120:123], v[32:47]
    s_add_u32 s56, s71, s99
    buffer_load_dwordx4 v[160:163], v5, s[40:43], s56 offen offset:0 sc1
    s_waitcnt vmcnt(9)
    v_mfma_f32_32x32x16_bf16 v[16:31], a[216:219], v[124:127], v[16:31]
    v_mfma_f32_32x32x16_bf16 v[32:47], a[220:223], v[124:127], v[32:47]
    buffer_load_dwordx4 v[164:167], v5, s[40:43], s56 offen offset:1024 sc1
    s_waitcnt vmcnt(9)
    v_mfma_f32_32x32x16_bf16 v[16:31], a[224:227], v[128:131], v[16:31]
    v_mfma_f32_32x32x16_bf16 v[32:47], a[228:231], v[128:131], v[32:47]
    buffer_load_dwordx4 v[168:171], v5, s[40:43], s56 offen offset:2048 sc1
    s_waitcnt vmcnt(9)
    v_mfma_f32_32x32x16_bf16 v[16:31], a[232:235], v[132:135], v[16:31]
    v_mfma_f32_32x32x16_bf16 v[32:47], a[236:239], v[132:135], v[32:47]
    buffer_load_dwordx4 v[172:175], v5, s[40:43], s56 offen offset:3072 sc1
    s_waitcnt vmcnt(9)
    v_mfma_f32_32x32x16_bf16 v[16:31], a[240:243], v[136:139], v[16:31]
    v_mfma_f32_32x32x16_bf16 v[32:47], a[244:247], v[136:139], v[32:47]
    s_add_u32 s56, s71, s100
    buffer_load_dwordx4 v[176:179], v5, s[40:43], s56 offen offset:0 sc1
    s_waitcnt vmcnt(9)
    v_mfma_f32_32x32x16_bf16 v[16:31], a[248:251], v[140:143], v[16:31]
    v_mfma_f32_32x32x16_bf16 v[32:47], a[252:255], v[140:143], v[32:47]
    buffer_load_dwordx4 v[180:183], v5, s[40:43], s56 offen offset:1024 sc1
    s_waitcnt vmcnt(9)
    v_mfma_f32_32x32x16_bf16 v[16:31], a[0:3], v[144:147], v[16:31]
    v_mfma_f32_32x32x16_bf16 v[32:47], a[4:7], v[144:147], v[32:47]
    s_barrier
    buffer_load_dwordx4 v[184:187], v5, s[40:43], s56 offen offset:2048 sc1
    s_waitcnt vmcnt(9)
    v_mfma_f32_32x32x16_bf16 v[16:31], a[8:11], v[148:151], v[16:31]
    v_mfma_f32_32x32x16_bf16 v[32:47], a[12:15], v[148:151], v[32:47]
    buffer_load_dwordx4 v[188:191], v5, s[40:43], s56 offen offset:3072 sc1
    s_waitcnt vmcnt(9)
    v_mfma_f32_32x32x16_bf16 v[16:31], a[16:19], v[152:155], v[16:31]
    v_mfma_f32_32x32x16_bf16 v[32:47], a[20:23], v[152:155], v[32:47]
    s_add_u32 s56, s71, s101
    buffer_load_dwordx4 v[192:195], v5, s[40:43], s56 offen offset:0 sc1
    s_waitcnt vmcnt(9)
    v_mfma_f32_32x32x16_bf16 v[16:31], a[24:27], v[156:159], v[16:31]
    v_mfma_f32_32x32x16_bf16 v[32:47], a[28:31], v[156:159], v[32:47]
    buffer_load_dwordx4 v[196:199], v5, s[40:43], s56 offen offset:1024 sc1
    s_waitcnt vmcnt(9)
    v_mfma_f32_32x32x16_bf16 v[16:31], a[32:35], v[160:163], v[16:31]
    v_mfma_f32_32x32x16_bf16 v[32:47], a[36:39], v[160:163], v[32:47]
    v_lshlrev_b32 v48, 16, v220
    v_and_b32 v49, s91, v220
    v_lshlrev_b32 v50, 16, v221
    v_and_b32 v51, s91, v221
    buffer_load_dwordx4 v[200:203], v5, s[40:43], s56 offen offset:2048 sc1
    s_waitcnt vmcnt(9)
    v_mfma_f32_32x32x16_bf16 v[16:31], a[40:43], v[164:167], v[16:31]
    v_mfma_f32_32x32x16_bf16 v[32:47], a[44:47], v[164:167], v[32:47]
    v_lshlrev_b32 v52, 16, v222
    v_and_b32 v53, s91, v222
    v_lshlrev_b32 v54, 16, v223
    v_and_b32 v55, s91, v223
    buffer_load_dwordx4 v[204:207], v5, s[40:43], s56 offen offset:3072 sc1
    s_waitcnt vmcnt(9)
    v_mfma_f32_32x32x16_bf16 v[16:31], a[48:51], v[168:171], v[16:31]
    v_mfma_f32_32x32x16_bf16 v[32:47], a[52:55], v[168:171], v[32:47]
    v_mov_b64 v[56:57], 0
    v_mov_b64 v[58:59], 0
    v_mov_b64 v[60:61], 0
    v_mov_b64 v[62:63], 0
    s_add_u32 s56, s72, s94
    buffer_load_dwordx4 v[80:83], v5, s[40:43], s56 offen offset:0 sc1
    s_waitcnt vmcnt(9)
    v_mfma_f32_32x32x16_bf16 v[16:31], a[56:59], v[172:175], v[16:31]
    v_mfma_f32_32x32x16_bf16 v[32:47], a[60:63], v[172:175], v[32:47]
    buffer_load_dwordx4 v[84:87], v5, s[40:43], s56 offen offset:1024 sc1
    s_waitcnt vmcnt(9)
    v_mfma_f32_32x32x16_bf16 v[16:31], a[64:67], v[176:179], v[16:31]
    v_mfma_f32_32x32x16_bf16 v[32:47], a[68:71], v[176:179], v[32:47]
    s_waitcnt lgkmcnt(15)
    s_add_u32 m0, s70, 12288
    s_mul_i32 s73, s49, 64
    s_add_u32 s73, s73, 131072
    buffer_load_dwordx4 v214, s[24:27], s73 offen lds
    s_add_u32 m0, s70, 13312
    s_mul_i32 s73, s49, 64
    s_add_u32 s73, s73, 163840
    buffer_load_dwordx4 v214, s[24:27], s73 offen lds
    buffer_load_dwordx4 v[88:91], v5, s[40:43], s56 offen offset:2048 sc1
    s_waitcnt vmcnt(11)
    v_mfma_f32_32x32x16_bf16 v[16:31], a[72:75], v[180:183], v[16:31]
    v_mfma_f32_32x32x16_bf16 v[32:47], a[76:79], v[180:183], v[32:47]
    s_add_u32 m0, s70, 14336
    s_mul_i32 s73, s49, 64
    s_add_u32 s73, s73, 196608
    buffer_load_dwordx4 v214, s[24:27], s73 offen lds
    s_add_u32 m0, s70, 15360
    s_mul_i32 s73, s49, 64
    s_add_u32 s73, s73, 229376
    buffer_load_dwordx4 v214, s[24:27], s73 offen lds
    buffer_load_dwordx4 v[92:95], v5, s[40:43], s56 offen offset:3072 sc1
    s_waitcnt vmcnt(13)
    v_mfma_f32_32x32x16_bf16 v[16:31], a[80:83], v[184:187], v[16:31]
    v_mfma_f32_32x32x16_bf16 v[32:47], a[84:87], v[184:187], v[32:47]
    s_waitcnt lgkmcnt(12)
    s_add_u32 m0, s70, 16384
    s_mul_i32 s73, s50, 64
    s_add_u32 s73, s73, 0
    buffer_load_dwordx4 v214, s[24:27], s73 offen lds
    s_add_u32 m0, s70, 17408
    s_mul_i32 s73, s50, 64
    s_add_u32 s73, s73, 32768
    buffer_load_dwordx4 v214, s[24:27], s73 offen lds
    s_add_u32 s56, s72, s95
    buffer_load_dwordx4 v[96:99], v5, s[40:43], s56 offen offset:0 sc1
    s_waitcnt vmcnt(15)
    v_mfma_f32_32x32x16_bf16 v[16:31], a[88:91], v[188:191], v[16:31]
    v_mfma_f32_32x32x16_bf16 v[32:47], a[92:95], v[188:191], v[32:47]
    s_waitcnt lgkmcnt(8)
    s_add_u32 m0, s70, 18432
    s_mul_i32 s73, s50, 64
    s_add_u32 s73, s73, 65536
    buffer_load_dwordx4 v214, s[24:27], s73 offen lds
    s_add_u32 m0, s70, 19456
    s_mul_i32 s73, s50, 64
    s_add_u32 s73, s73, 98304
    buffer_load_dwordx4 v214, s[24:27], s73 offen lds
    buffer_load_dwordx4 v[100:103], v5, s[40:43], s56 offen offset:1024 sc1
    s_waitcnt vmcnt(17)
    v_mfma_f32_32x32x16_bf16 v[16:31], a[96:99], v[192:195], v[16:31]
    v_mfma_f32_32x32x16_bf16 v[32:47], a[100:103], v[192:195], v[32:47]
    s_waitcnt lgkmcnt(4)
    s_add_u32 m0, s70, 20480
    s_mul_i32 s73, s50, 64
    s_add_u32 s73, s73, 131072
    buffer_load_dwordx4 v214, s[24:27], s73 offen lds
    s_add_u32 m0, s70, 21504
    s_mul_i32 s73, s50, 64
    s_add_u32 s73, s73, 163840
    buffer_load_dwordx4 v214, s[24:27], s73 offen lds
    buffer_load_dwordx4 v[104:107], v5, s[40:43], s56 offen offset:2048 sc1
    s_waitcnt vmcnt(19)
    v_mfma_f32_32x32x16_bf16 v[16:31], a[104:107], v[196:199], v[16:31]
    v_mfma_f32_32x32x16_bf16 v[32:47], a[108:111], v[196:199], v[32:47]
    s_waitcnt lgkmcnt(0)
    s_add_u32 m0, s70, 22528
    s_mul_i32 s73, s50, 64
    s_add_u32 s73, s73, 196608
    buffer_load_dwordx4 v214, s[24:27], s73 offen lds
    s_add_u32 m0, s70, 23552
    s_mul_i32 s73, s50, 64
    s_add_u32 s73, s73, 229376
    buffer_load_dwordx4 v214, s[24:27], s73 offen lds
    buffer_load_dwordx4 v[108:111], v5, s[40:43], s56 offen offset:3072 sc1
    s_waitcnt vmcnt(21)
    v_mfma_f32_32x32x16_bf16 v[16:31], a[112:115], v[200:203], v[16:31]
    v_mfma_f32_32x32x16_bf16 v[32:47], a[116:119], v[200:203], v[32:47]
    s_add_u32 s56, s72, s96
    buffer_load_dwordx4 v[112:115], v5, s[40:43], s56 offen offset:0 sc1
    s_waitcnt vmcnt(21)
    v_mfma_f32_32x32x16_bf16 v[16:31], a[120:123], v[204:207], v[16:31]
    v_mfma_f32_32x32x16_bf16 v[32:47], a[124:127], v[204:207], v[32:47]
    buffer_load_dwordx4 v[116:119], v5, s[40:43], s56 offen offset:1024 sc1
    s_waitcnt vmcnt(21)
    v_mfma_f32_32x32x16_bf16 v[48:63], a[128:131], v[80:83], v[48:63]
    v_mfma_f32_32x32x16_bf16 v[64:79], a[132:135], v[80:83], 0
    s_nop 7
    ds_write_b128 v235, v[40:43] offset:0
    ds_write_b128 v235, v[44:47] offset:1024
    ds_write_b128 v234, v[32:35] offset:0
    buffer_load_dwordx4 v[120:123], v5, s[40:43], s56 offen offset:2048 sc1
    s_waitcnt vmcnt(21)
    v_mfma_f32_32x32x16_bf16 v[48:63], a[136:139], v[84:87], v[48:63]
    v_mfma_f32_32x32x16_bf16 v[64:79], a[140:143], v[84:87], v[64:79]
    ds_write_b128 v234, v[36:39] offset:1024
    ds_write_b128 v233, v[24:27] offset:0
    ds_write_b128 v233, v[28:31] offset:1024
    buffer_load_dwordx4 v[124:127], v5, s[40:43], s56 offen offset:3072 sc1
    s_waitcnt vmcnt(19)
    v_mfma_f32_32x32x16_bf16 v[48:63], a[144:147], v[88:91], v[48:63]
    v_mfma_f32_32x32x16_bf16 v[64:79], a[148:151], v[88:91], v[64:79]
    s_waitcnt lgkmcnt(0)
    s_barrier
    ds_read_b128 v[24:27], v232 offset:0
    ds_read_b128 v[32:35], v232 offset:2048
    ds_read_b128 v[40:43], v232 offset:4096
    ds_read_b128 v[28:31], v232 offset:1024
    ds_read_b128 v[36:39], v232 offset:3072
    ds_read_b128 v[44:47], v232 offset:5120
    s_add_u32 s56, s72, s97
    buffer_load_dwordx4 v[128:131], v5, s[40:43], s56 offen offset:0 sc1
    s_waitcnt vmcnt(17)
    v_mfma_f32_32x32x16_bf16 v[48:63], a[152:155], v[92:95], v[48:63]
    v_mfma_f32_32x32x16_bf16 v[64:79], a[156:159], v[92:95], v[64:79]
    buffer_load_dwordx4 v[132:135], v5, s[40:43], s56 offen offset:1024 sc1
    s_waitcnt vmcnt(15)
    v_mfma_f32_32x32x16_bf16 v[48:63], a[160:163], v[96:99], v[48:63]
    v_mfma_f32_32x32x16_bf16 v[64:79], a[164:167], v[96:99], v[64:79]
    v_mov_b32 v211, s88
    s_waitcnt lgkmcnt(4)
    v_add_f32 v24, v24, v32
    s_waitcnt lgkmcnt(3)
    v_add_f32 v16, v16, v40
    v_add_f32 v25, v25, v33
    v_add_f32 v17, v17, v41
    v_add_f32 v26, v26, v34
    v_add_f32 v18, v18, v42
    v_add_f32 v27, v27, v35
    v_add_f32 v19, v19, v43
    s_waitcnt lgkmcnt(1)
    v_add_f32 v28, v28, v36
    s_waitcnt lgkmcnt(0)
    v_add_f32 v20, v20, v44
    v_add_f32 v29, v29, v37
    v_add_f32 v21, v21, v45
    v_add_f32 v30, v30, v38
    v_add_f32 v22, v22, v46
    v_add_f32 v31, v31, v39
    buffer_load_dwordx4 v[136:139], v5, s[40:43], s56 offen offset:2048 sc1
    s_waitcnt vmcnt(13)
    v_mfma_f32_32x32x16_bf16 v[48:63], a[168:171], v[100:103], v[48:63]
    v_mfma_f32_32x32x16_bf16 v[64:79], a[172:175], v[100:103], v[64:79]
    v_add_f32 v23, v23, v47
    v_add_f32 v16, v16, v24
    v_add_f32 v17, v17, v25
    v_add_f32 v18, v18, v26
    v_add_f32 v19, v19, v27
    v_add_f32 v20, v20, v28
    v_add_f32 v21, v21, v29
    v_add_f32 v22, v22, v30
    v_add_f32 v23, v23, v31
    v_mul_f32 v24, v16, v16
    v_mul_f32 v25, v17, v17
    v_mul_f32 v26, v18, v18
    v_mul_f32 v27, v19, v19
    v_mul_f32 v28, v20, v20
    v_mul_f32 v29, v21, v21
    v_mul_f32 v30, v22, v22
    buffer_load_dwordx4 v[140:143], v5, s[40:43], s56 offen offset:3072 sc1
    s_waitcnt vmcnt(11)
    v_mfma_f32_32x32x16_bf16 v[48:63], a[176:179], v[104:107], v[48:63]
    v_mfma_f32_32x32x16_bf16 v[64:79], a[180:183], v[104:107], v[64:79]
    v_mul_f32 v31, v23, v23
    v_fma_f32 v24, v24, s90, v211
    v_fma_f32 v25, v25, s90, v211
    v_fma_f32 v26, v26, s90, v211
    v_fma_f32 v27, v27, s90, v211
    v_fma_f32 v28, v28, s90, v211
    v_fma_f32 v29, v29, s90, v211
    v_fma_f32 v30, v30, s90, v211
    v_fma_f32 v31, v31, s90, v211
    v_mul_f32 v24, v24, v16
    v_mul_f32 v25, v25, v17
    v_mul_f32 v26, v26, v18
    v_mul_f32 v27, v27, v19
    v_mul_f32 v28, v28, v20
    v_mul_f32 v29, v29, v21
    v_mul_f32 v30, v30, v22
    s_add_u32 s56, s72, s98
    buffer_load_dwordx4 v[144:147], v5, s[40:43], s56 offen offset:0 sc1
    s_waitcnt vmcnt(9)
    v_mfma_f32_32x32x16_bf16 v[48:63], a[184:187], v[108:111], v[48:63]
    v_mfma_f32_32x32x16_bf16 v[64:79], a[188:191], v[108:111], v[64:79]
    v_mul_f32 v31, v31, v23
    v_exp_f32 v24, v24
    v_exp_f32 v25, v25
    v_exp_f32 v26, v26
    v_exp_f32 v27, v27
    v_exp_f32 v28, v28
    v_exp_f32 v29, v29
    v_exp_f32 v30, v30
    v_exp_f32 v31, v31
    v_add_f32 v24, 1.0, v24
    v_add_f32 v25, 1.0, v25
    v_add_f32 v26, 1.0, v26
    v_add_f32 v27, 1.0, v27
    v_add_f32 v28, 1.0, v28
    v_add_f32 v29, 1.0, v29
    v_add_f32 v30, 1.0, v30
    ds_read_b64_tr_b16 a[128:129], v217 offset:24576
    ds_read_b64_tr_b16 a[130:131], v217 offset:25600
    ds_read_b64_tr_b16 a[132:133], v218 offset:24576
    ds_read_b64_tr_b16 a[134:135], v218 offset:25600
    ds_read_b64_tr_b16 a[136:137], v217 offset:26624
    ds_read_b64_tr_b16 a[138:139], v217 offset:27648
    ds_read_b64_tr_b16 a[140:141], v218 offset:26624
    ds_read_b64_tr_b16 a[142:143], v218 offset:27648
    buffer_load_dwordx4 v[148:151], v5, s[40:43], s56 offen offset:1024 sc1
    s_waitcnt vmcnt(9)
    v_mfma_f32_32x32x16_bf16 v[48:63], a[192:195], v[112:115], v[48:63]
    v_mfma_f32_32x32x16_bf16 v[64:79], a[196:199], v[112:115], v[64:79]
    v_add_f32 v31, 1.0, v31
    v_rcp_f32 v24, v24
    v_rcp_f32 v25, v25
    v_rcp_f32 v26, v26
    v_rcp_f32 v27, v27
    v_rcp_f32 v28, v28
    v_rcp_f32 v29, v29
    v_rcp_f32 v30, v30
    v_rcp_f32 v31, v31
    v_mul_f32 v24, v24, v16
    v_mul_f32 v25, v25, v17
    v_mul_f32 v26, v26, v18
    v_mul_f32 v27, v27, v19
    v_mul_f32 v28, v28, v20
    v_mul_f32 v29, v29, v21
    v_mul_f32 v30, v30, v22
    ds_read_b64_tr_b16 a[144:145], v217 offset:28672
    ds_read_b64_tr_b16 a[146:147], v217 offset:29696
    ds_read_b64_tr_b16 a[148:149], v218 offset:28672
    ds_read_b64_tr_b16 a[150:151], v218 offset:29696
    ds_read_b64_tr_b16 a[152:153], v217 offset:30720
    ds_read_b64_tr_b16 a[154:155], v217 offset:31744
    ds_read_b64_tr_b16 a[156:157], v218 offset:30720
    ds_read_b64_tr_b16 a[158:159], v218 offset:31744
    buffer_load_dwordx4 v[152:155], v5, s[40:43], s56 offen offset:2048 sc1
    s_waitcnt vmcnt(9)
    v_mfma_f32_32x32x16_bf16 v[48:63], a[200:203], v[116:119], v[48:63]
    v_mfma_f32_32x32x16_bf16 v[64:79], a[204:207], v[116:119], v[64:79]
    v_mul_f32 v31, v31, v23
    v_cvt_pk_bf16_f32 v32, v24, v25
    v_cvt_pk_bf16_f32 v33, v26, v27
    v_cvt_pk_bf16_f32 v34, v28, v29
    v_cvt_pk_bf16_f32 v35, v30, v31
    buffer_store_dwordx4 v[32:35], v5, s[40:43], s57 offen sc1
    ds_read_b64_tr_b16 a[160:161], v217 offset:32768
    ds_read_b64_tr_b16 a[162:163], v217 offset:33792
    ds_read_b64_tr_b16 a[164:165], v218 offset:32768
    ds_read_b64_tr_b16 a[166:167], v218 offset:33792
    ds_read_b64_tr_b16 a[168:169], v217 offset:34816
    ds_read_b64_tr_b16 a[170:171], v217 offset:35840
    ds_read_b64_tr_b16 a[172:173], v218 offset:34816
    ds_read_b64_tr_b16 a[174:175], v218 offset:35840
    buffer_load_dwordx4 v[156:159], v5, s[40:43], s56 offen offset:3072 sc1
    s_waitcnt vmcnt(10)
    v_mfma_f32_32x32x16_bf16 v[48:63], a[208:211], v[120:123], v[48:63]
    v_mfma_f32_32x32x16_bf16 v[64:79], a[212:215], v[120:123], v[64:79]
    ds_read_b64_tr_b16 a[176:177], v217 offset:12288
    ds_read_b64_tr_b16 a[178:179], v217 offset:13312
    ds_read_b64_tr_b16 a[180:181], v218 offset:12288
    ds_read_b64_tr_b16 a[182:183], v218 offset:13312
    ds_read_b64_tr_b16 a[184:185], v217 offset:14336
    ds_read_b64_tr_b16 a[186:187], v217 offset:15360
    ds_read_b64_tr_b16 a[188:189], v218 offset:14336
    ds_read_b64_tr_b16 a[190:191], v218 offset:15360
    s_and_b32 s60, s3, 1
    s_cmp_eq_u32 s60, 0
    s_cselect_b32 s60, 1.0, 0
    v_lshlrev_b32 v16, 16, v224
    v_and_b32 v17, s91, v224
    v_lshlrev_b32 v208, 16, v240
    v_and_b32 v209, s91, v240
    v_add_f32 v16, v16, v208
    s_add_u32 s56, s72, s99
    buffer_load_dwordx4 v[160:163], v5, s[40:43], s56 offen offset:0 sc1
    s_waitcnt vmcnt(10)
    v_mfma_f32_32x32x16_bf16 v[48:63], a[216:219], v[124:127], v[48:63]
    v_mfma_f32_32x32x16_bf16 v[64:79], a[220:223], v[124:127], v[64:79]
    ds_read_b64_tr_b16 a[192:193], v217 offset:16384
    ds_read_b64_tr_b16 a[194:195], v217 offset:17408
    ds_read_b64_tr_b16 a[196:197], v218 offset:16384
    ds_read_b64_tr_b16 a[198:199], v218 offset:17408
    ds_read_b64_tr_b16 a[200:201], v217 offset:18432
    ds_read_b64_tr_b16 a[202:203], v217 offset:19456
    ds_read_b64_tr_b16 a[204:205], v218 offset:18432
    ds_read_b64_tr_b16 a[206:207], v218 offset:19456
    v_add_f32 v17, v17, v209
    v_mul_f32 v16, s60, v16
    v_mul_f32 v17, s60, v17
    v_lshlrev_b32 v18, 16, v225
    v_and_b32 v19, s91, v225
    v_lshlrev_b32 v210, 16, v241
    buffer_load_dwordx4 v[164:167], v5, s[40:43], s56 offen offset:1024 sc1
    s_waitcnt vmcnt(10)
    v_mfma_f32_32x32x16_bf16 v[48:63], a[224:227], v[128:131], v[48:63]
    v_mfma_f32_32x32x16_bf16 v[64:79], a[228:231], v[128:131], v[64:79]
    ds_read_b64_tr_b16 a[208:209], v217 offset:20480
    ds_read_b64_tr_b16 a[210:211], v217 offset:21504
    ds_read_b64_tr_b16 a[212:213], v218 offset:20480
    ds_read_b64_tr_b16 a[214:215], v218 offset:21504
    ds_read_b64_tr_b16 a[216:217], v217 offset:22528
    ds_read_b64_tr_b16 a[218:219], v217 offset:23552
    ds_read_b64_tr_b16 a[220:221], v218 offset:22528
    ds_read_b64_tr_b16 a[222:223], v218 offset:23552
    s_waitcnt lgkmcnt(15)
    s_add_u32 m0, s70, 24576
    s_mul_i32 s73, s51, 64
    s_add_u32 s73, s73, 0
    buffer_load_dwordx4 v214, s[24:27], s73 offen lds
    s_add_u32 m0, s70, 25600
    s_mul_i32 s73, s51, 64
    s_add_u32 s73, s73, 32768
    buffer_load_dwordx4 v214, s[24:27], s73 offen lds
    v_and_b32 v211, s91, v241
    v_add_f32 v18, v18, v210
    v_add_f32 v19, v19, v211
    v_mul_f32 v18, s60, v18
    v_mul_f32 v19, s60, v19
    v_lshlrev_b32 v20, 16, v226
    buffer_load_dwordx4 v[168:171], v5, s[40:43], s56 offen offset:2048 sc1
    s_waitcnt vmcnt(12)
    v_mfma_f32_32x32x16_bf16 v[48:63], a[232:235], v[132:135], v[48:63]
    v_mfma_f32_32x32x16_bf16 v[64:79], a[236:239], v[132:135], v[64:79]
    s_waitcnt vmcnt(6)
    v_mov_b32 v8, s4
    s_mov_b64 exec, 1
    buffer_store_dword v8, v9, s[40:43], s82 offen sc1
    s_mov_b64 exec, -1
    s_add_u32 m0, s70, 26624
    s_mul_i32 s73, s51, 64
    s_add_u32 s73, s73, 65536
    buffer_load_dwordx4 v214, s[24:27], s73 offen lds
    s_add_u32 m0, s70, 27648
    s_mul_i32 s73, s51, 64
    s_add_u32 s73, s73, 98304
    buffer_load_dwordx4 v214, s[24:27], s73 offen lds
    v_and_b32 v21, s91, v226
    v_lshlrev_b32 v208, 16, v242
    v_and_b32 v209, s91, v242
    v_add_f32 v20, v20, v208
    v_add_f32 v21, v21, v209
    v_mul_f32 v20, s60, v20
    buffer_load_dwordx4 v[172:175], v5, s[40:43], s56 offen offset:3072 sc1
    v_mfma_f32_32x32x16_bf16 v[48:63], a[240:243], v[136:139], v[48:63]
    v_mfma_f32_32x32x16_bf16 v[64:79], a[244:247], v[136:139], v[64:79]
    s_add_u32 m0, s70, 28672
    s_mul_i32 s73, s51, 64
    s_add_u32 s73, s73, 131072
    buffer_load_dwordx4 v214, s[24:27], s73 offen lds
    s_add_u32 m0, s70, 29696
    s_mul_i32 s73, s51, 64
    s_add_u32 s73, s73, 163840
    buffer_load_dwordx4 v214, s[24:27], s73 offen lds
    v_mul_f32 v21, s60, v21
    v_lshlrev_b32 v22, 16, v227
    v_and_b32 v23, s91, v227
    v_lshlrev_b32 v210, 16, v243
    v_and_b32 v211, s91, v243
    v_add_f32 v22, v22, v210
    s_add_u32 s56, s72, s100
    buffer_load_dwordx4 v[176:179], v5, s[40:43], s56 offen offset:0 sc1
    v_mfma_f32_32x32x16_bf16 v[48:63], a[248:251], v[140:143], v[48:63]
    v_mfma_f32_32x32x16_bf16 v[64:79], a[252:255], v[140:143], v[64:79]
    s_add_u32 m0, s70, 30720
    s_mul_i32 s73, s51, 64
    s_add_u32 s73, s73, 196608
    buffer_load_dwordx4 v214, s[24:27], s73 offen lds
    s_add_u32 m0, s70, 31744
    s_mul_i32 s73, s51, 64
    s_add_u32 s73, s73, 229376
    buffer_load_dwordx4 v214, s[24:27], s73 offen lds
    v_add_f32 v23, v23, v211
    v_mul_f32 v22, s60, v22
    v_mul_f32 v23, s60, v23
    v_lshlrev_b32 v24, 16, v228
    v_and_b32 v25, s91, v228
    v_lshlrev_b32 v208, 16, v244
    buffer_load_dwordx4 v[180:183], v5, s[40:43], s56 offen offset:1024 sc1
    v_mfma_f32_32x32x16_bf16 v[48:63], a[0:3], v[144:147], v[48:63]
    v_mfma_f32_32x32x16_bf16 v[64:79], a[4:7], v[144:147], v[64:79]
    s_add_u32 m0, s70, 32768
    s_mul_i32 s73, s52, 64
    s_add_u32 s73, s73, 0
    buffer_load_dwordx4 v214, s[24:27], s73 offen lds
    s_add_u32 m0, s70, 33792
    s_mul_i32 s73, s52, 64
    s_add_u32 s73, s73, 32768
    buffer_load_dwordx4 v214, s[24:27], s73 offen lds
    v_and_b32 v209, s91, v244
    v_add_f32 v24, v24, v208
    v_add_f32 v25, v25, v209
    v_mul_f32 v24, s60, v24
    v_mul_f32 v25, s60, v25
    v_lshlrev_b32 v26, 16, v229
    buffer_load_dwordx4 v[184:187], v5, s[40:43], s56 offen offset:2048 sc1
    v_mfma_f32_32x32x16_bf16 v[48:63], a[8:11], v[148:151], v[48:63]
    v_mfma_f32_32x32x16_bf16 v[64:79], a[12:15], v[148:151], v[64:79]
    s_add_u32 m0, s70, 34816
    s_mul_i32 s73, s52, 64
    s_add_u32 s73, s73, 65536
    buffer_load_dwordx4 v214, s[24:27], s73 offen lds
    s_add_u32 m0, s70, 35840
    s_mul_i32 s73, s52, 64
    s_add_u32 s73, s73, 98304
    buffer_load_dwordx4 v214, s[24:27], s73 offen lds
    v_and_b32 v27, s91, v229
    v_lshlrev_b32 v210, 16, v245
    v_and_b32 v211, s91, v245
    v_add_f32 v26, v26, v210
    v_add_f32 v27, v27, v211
    v_mul_f32 v26, s60, v26
    buffer_load_dwordx4 v[188:191], v5, s[40:43], s56 offen offset:3072 sc1
    v_mfma_f32_32x32x16_bf16 v[48:63], a[16:19], v[152:155], v[48:63]
    v_mfma_f32_32x32x16_bf16 v[64:79], a[20:23], v[152:155], v[64:79]
    s_add_u32 m0, s70, 12288
    s_mul_i32 s73, s52, 64
    s_add_u32 s73, s73, 131072
    buffer_load_dwordx4 v214, s[24:27], s73 offen lds
    s_add_u32 m0, s70, 13312
    s_mul_i32 s73, s52, 64
    s_add_u32 s73, s73, 163840
    buffer_load_dwordx4 v214, s[24:27], s73 offen lds
    v_mul_f32 v27, s60, v27
    v_lshlrev_b32 v28, 16, v230
    v_and_b32 v29, s91, v230
    v_lshlrev_b32 v208, 16, v246
    v_and_b32 v209, s91, v246
    v_add_f32 v28, v28, v208
    buffer_load_dword v248, v12, s[40:43], s85 offen offset:0 sc1
    s_add_u32 s56, s72, s101
    buffer_load_dwordx4 v[192:195], v5, s[40:43], s56 offen offset:0 sc1
    s_waitcnt vmcnt(25)
    v_mfma_f32_32x32x16_bf16 v[48:63], a[24:27], v[156:159], v[48:63]
    v_mfma_f32_32x32x16_bf16 v[64:79], a[28:31], v[156:159], v[64:79]
    s_add_u32 m0, s70, 14336
    s_mul_i32 s73, s52, 64
    s_add_u32 s73, s73, 196608
    buffer_load_dwordx4 v214, s[24:27], s73 offen lds
    s_add_u32 m0, s70, 15360
    s_mul_i32 s73, s52, 64
    s_add_u32 s73, s73, 229376
    buffer_load_dwordx4 v214, s[24:27], s73 offen lds
    v_add_f32 v29, v29, v209
    v_mul_f32 v28, s60, v28
    v_mul_f32 v29, s60, v29
    v_lshlrev_b32 v30, 16, v231
    v_and_b32 v31, s91, v231
    v_lshlrev_b32 v210, 16, v247
    buffer_load_dwordx4 v[196:199], v5, s[40:43], s56 offen offset:1024 sc1
    s_waitcnt vmcnt(27)
    v_mfma_f32_32x32x16_bf16 v[48:63], a[32:35], v[160:163], v[48:63]
    v_mfma_f32_32x32x16_bf16 v[64:79], a[36:39], v[160:163], v[64:79]
    s_waitcnt vmcnt(24)
    ds_read_b64_tr_b16 a[224:225], v217 offset:24576
    ds_read_b64_tr_b16 a[226:227], v217 offset:25600
    ds_read_b64_tr_b16 a[228:229], v218 offset:24576
    ds_read_b64_tr_b16 a[230:231], v218 offset:25600
    v_and_b32 v211, s91, v247
    v_add_f32 v30, v30, v210
    v_add_f32 v31, v31, v211
    v_mul_f32 v30, s60, v30
    v_mul_f32 v31, s60, v31
    buffer_load_dwordx4 v[200:203], v5, s[40:43], s56 offen offset:2048 sc1
    v_mfma_f32_32x32x16_bf16 v[48:63], a[40:43], v[164:167], v[48:63]
    v_mfma_f32_32x32x16_bf16 v[64:79], a[44:47], v[164:167], v[64:79]
    s_waitcnt vmcnt(21)
    ds_read_b64_tr_b16 a[232:233], v217 offset:26624
    ds_read_b64_tr_b16 a[234:235], v217 offset:27648
    ds_read_b64_tr_b16 a[236:237], v218 offset:26624
    ds_read_b64_tr_b16 a[238:239], v218 offset:27648
    buffer_load_dwordx4 v[204:207], v5, s[40:43], s56 offen offset:3072 sc1
    v_mfma_f32_32x32x16_bf16 v[48:63], a[48:51], v[168:171], v[48:63]
    v_mfma_f32_32x32x16_bf16 v[64:79], a[52:55], v[168:171], v[64:79]
    s_waitcnt vmcnt(19)
    ds_read_b64_tr_b16 a[240:241], v217 offset:28672
    ds_read_b64_tr_b16 a[242:243], v217 offset:29696
    ds_read_b64_tr_b16 a[244:245], v218 offset:28672
    ds_read_b64_tr_b16 a[246:247], v218 offset:29696
    s_waitcnt vmcnt(6)
    v_cmp_ne_u32 vcc, s4, v248
    s_nop 1
    s_cbranch_vccz Lpcd_P_11
    s_nop 1
Lpc_P_10:
    s_sub_u32 s6, s6, 1
    s_cbranch_scc1 L_end_P
    buffer_load_dword v248, v12, s[40:43], s85 offen offset:0 sc1
    s_waitcnt vmcnt(0)
    v_cmp_ne_u32 vcc, s4, v248
    s_nop 1
    s_cbranch_vccnz Lpc_P_10
Lpcd_P_11:
    s_add_u32 s56, s58, s48
    buffer_load_dwordx4 v[80:83], v4, s[40:43], s56 offen offset:0 sc1
    v_mfma_f32_32x32x16_bf16 v[48:63], a[56:59], v[172:175], v[48:63]
    v_mfma_f32_32x32x16_bf16 v[64:79], a[60:63], v[172:175], v[64:79]
    ds_read_b64_tr_b16 a[248:249], v217 offset:30720
    ds_read_b64_tr_b16 a[250:251], v217 offset:31744
    ds_read_b64_tr_b16 a[252:253], v218 offset:30720
    ds_read_b64_tr_b16 a[254:255], v218 offset:31744
    buffer_load_dwordx4 v[84:87], v4, s[40:43], s56 offen offset:1024 sc1
    v_mfma_f32_32x32x16_bf16 v[48:63], a[64:67], v[176:179], v[48:63]
    v_mfma_f32_32x32x16_bf16 v[64:79], a[68:71], v[176:179], v[64:79]
    ds_read_b64_tr_b16 a[0:1], v217 offset:32768
    ds_read_b64_tr_b16 a[2:3], v217 offset:33792
    ds_read_b64_tr_b16 a[4:5], v218 offset:32768
    ds_read_b64_tr_b16 a[6:7], v218 offset:33792
    buffer_load_dwordx4 v[88:91], v4, s[40:43], s56 offen offset:2048 sc1
    v_mfma_f32_32x32x16_bf16 v[48:63], a[72:75], v[180:183], v[48:63]
    v_mfma_f32_32x32x16_bf16 v[64:79], a[76:79], v[180:183], v[64:79]
    ds_read_b64_tr_b16 a[8:9], v217 offset:34816
    ds_read_b64_tr_b16 a[10:11], v217 offset:35840
    ds_read_b64_tr_b16 a[12:13], v218 offset:34816
    ds_read_b64_tr_b16 a[14:15], v218 offset:35840
    buffer_load_dwordx4 v[92:95], v4, s[40:43], s56 offen offset:3072 sc1
    v_mfma_f32_32x32x16_bf16 v[48:63], a[80:83], v[184:187], v[48:63]
    v_mfma_f32_32x32x16_bf16 v[64:79], a[84:87], v[184:187], v[64:79]
    ds_read_b64_tr_b16 a[16:17], v217 offset:12288
    ds_read_b64_tr_b16 a[18:19], v217 offset:13312
    ds_read_b64_tr_b16 a[20:21], v218 offset:12288
    ds_read_b64_tr_b16 a[22:23], v218 offset:13312
    s_add_u32 s56, s58, s49
    buffer_load_dwordx4 v[96:99], v4, s[40:43], s56 offen offset:0 sc1
    v_mfma_f32_32x32x16_bf16 v[48:63], a[88:91], v[188:191], v[48:63]
    v_mfma_f32_32x32x16_bf16 v[64:79], a[92:95], v[188:191], v[64:79]
    s_waitcnt vmcnt(8)
    ds_read_b64_tr_b16 a[24:25], v217 offset:14336
    ds_read_b64_tr_b16 a[26:27], v217 offset:15360
    ds_read_b64_tr_b16 a[28:29], v218 offset:14336
    ds_read_b64_tr_b16 a[30:31], v218 offset:15360
    buffer_load_dwordx4 v[100:103], v4, s[40:43], s56 offen offset:1024 sc1
    buffer_load_dwordx4 v[104:107], v4, s[40:43], s56 offen offset:2048 sc1
    buffer_load_dwordx4 v[108:111], v4, s[40:43], s56 offen offset:3072 sc1
    s_add_u32 s56, s58, s50
    buffer_load_dwordx4 v[112:115], v4, s[40:43], s56 offen offset:0 sc1
    v_mfma_f32_32x32x16_bf16 v[64:79], a[100:103], v[192:195], v[64:79]
    s_waitcnt vmcnt(11)
    v_mfma_f32_32x32x16_bf16 v[64:79], a[108:111], v[196:199], v[64:79]
    s_waitcnt vmcnt(10)
    v_mfma_f32_32x32x16_bf16 v[64:79], a[116:119], v[200:203], v[64:79]
    s_waitcnt vmcnt(9)
    v_mfma_f32_32x32x16_bf16 v[64:79], a[124:127], v[204:207], v[64:79]
    v_mfma_f32_32x32x16_bf16 v[48:63], a[96:99], v[192:195], v[48:63]
    v_mfma_f32_32x32x16_bf16 v[48:63], a[104:107], v[196:199], v[48:63]
    s_nop 9
    ds_write_b128 v235, v[72:75] offset:6144
    ds_write_b128 v235, v[76:79] offset:7168
    v_mfma_f32_32x32x16_bf16 v[48:63], a[112:115], v[200:203], v[48:63]
    ds_write_b128 v234, v[64:67] offset:6144
    ds_write_b128 v234, v[68:71] offset:7168
    v_mfma_f32_32x32x16_bf16 v[48:63], a[120:123], v[204:207], v[48:63]
    s_nop 11
    ds_write_b128 v233, v[56:59] offset:6144
    ds_write_b128 v233, v[60:63] offset:7168
    s_waitcnt lgkmcnt(0)
    s_barrier
    ds_read_b128 v[56:59], v232 offset:6144
    ds_read_b128 v[64:67], v232 offset:8192
    ds_read_b128 v[72:75], v232 offset:10240
    ds_read_b128 v[60:63], v232 offset:7168
    ds_read_b128 v[68:71], v232 offset:9216
    ds_read_b128 v[76:79], v232 offset:11264
    v_mov_b32 v211, s88
    s_waitcnt lgkmcnt(4)
    v_pk_add_f32 v[56:57], v[56:57], v[64:65]
    s_waitcnt lgkmcnt(3)
    v_pk_add_f32 v[48:49], v[48:49], v[72:73]
    v_pk_add_f32 v[58:59], v[58:59], v[66:67]
    v_pk_add_f32 v[50:51], v[50:51], v[74:75]
    s_waitcnt lgkmcnt(1)
    v_pk_add_f32 v[60:61], v[60:61], v[68:69]
    s_waitcnt lgkmcnt(0)
    v_pk_add_f32 v[52:53], v[52:53], v[76:77]
    v_pk_add_f32 v[62:63], v[62:63], v[70:71]
    v_pk_add_f32 v[54:55], v[54:55], v[78:79]
    v_pk_add_f32 v[48:49], v[48:49], v[56:57]
    v_pk_add_f32 v[50:51], v[50:51], v[58:59]
    v_pk_add_f32 v[52:53], v[52:53], v[60:61]
    v_pk_add_f32 v[54:55], v[54:55], v[62:63]
    v_pk_mul_f32 v[56:57], v[48:49], v[48:49]
    v_pk_mul_f32 v[58:59], v[50:51], v[50:51]
    v_pk_mul_f32 v[60:61], v[52:53], v[52:53]
    v_pk_mul_f32 v[62:63], v[54:55], v[54:55]
    v_fma_f32 v56, v56, s90, v211
    v_fma_f32 v57, v57, s90, v211
    v_fma_f32 v58, v58, s90, v211
    v_fma_f32 v59, v59, s90, v211
    v_fma_f32 v60, v60, s90, v211
    v_fma_f32 v61, v61, s90, v211
    v_fma_f32 v62, v62, s90, v211
    v_fma_f32 v63, v63, s90, v211
    v_pk_mul_f32 v[56:57], v[56:57], v[48:49]
    v_pk_mul_f32 v[58:59], v[58:59], v[50:51]
    v_pk_mul_f32 v[60:61], v[60:61], v[52:53]
    v_pk_mul_f32 v[62:63], v[62:63], v[54:55]
    v_exp_f32 v56, v56
    v_exp_f32 v57, v57
    v_exp_f32 v58, v58
    v_exp_f32 v59, v59
    v_exp_f32 v60, v60
    v_exp_f32 v61, v61
    v_exp_f32 v62, v62
    v_exp_f32 v63, v63
    v_add_f32 v56, 1.0, v56
    v_add_f32 v57, 1.0, v57
    v_add_f32 v58, 1.0, v58
    v_add_f32 v59, 1.0, v59
    v_add_f32 v60, 1.0, v60
    v_add_f32 v61, 1.0, v61
    v_add_f32 v62, 1.0, v62
    v_add_f32 v63, 1.0, v63
    v_rcp_f32 v56, v56
    v_rcp_f32 v57, v57
    v_rcp_f32 v58, v58
    v_rcp_f32 v59, v59
    v_rcp_f32 v60, v60
    v_rcp_f32 v61, v61
    v_rcp_f32 v62, v62
    v_rcp_f32 v63, v63
    v_mul_f32 v56, v56, v48
    v_mul_f32 v57, v57, v49
    v_mul_f32 v58, v58, v50
    v_mul_f32 v59, v59, v51
    v_mul_f32 v60, v60, v52
    v_mul_f32 v61, v61, v53
    v_mul_f32 v62, v62, v54
    v_mul_f32 v63, v63, v55
    v_cvt_pk_bf16_f32 v64, v56, v57
    v_cvt_pk_bf16_f32 v65, v58, v59
    v_cvt_pk_bf16_f32 v66, v60, v61
    v_cvt_pk_bf16_f32 v67, v62, v63
    s_add_u32 s57, s57, 114688
    buffer_store_dwordx4 v[64:67], v5, s[40:43], s57 offen sc1
    s_add_u32 s82, s82, 4096
    s_add_u32 s85, s85, 4096
    buffer_load_dwordx4 v[116:119], v4, s[40:43], s56 offen offset:1024 sc1
    s_waitcnt vmcnt(10)
    v_mfma_f32_32x32x16_bf16 v[16:31], a[128:131], v[80:83], v[16:31]
    v_mfma_f32_32x32x16_bf16 v[32:47], a[132:135], v[80:83], 0
    s_add_u32 m0, s70, 16384
    s_mul_i32 s73, s53, 64
    s_add_u32 s73, s73, 0
    buffer_load_dwordx4 v214, s[24:27], s73 offen lds
    s_add_u32 m0, s70, 17408
    s_mul_i32 s73, s53, 64
    s_add_u32 s73, s73, 32768
    buffer_load_dwordx4 v214, s[24:27], s73 offen lds
    buffer_load_dwordx4 v[120:123], v4, s[40:43], s56 offen offset:2048 sc1
    s_waitcnt vmcnt(12)
    v_mfma_f32_32x32x16_bf16 v[16:31], a[136:139], v[84:87], v[16:31]
    v_mfma_f32_32x32x16_bf16 v[32:47], a[140:143], v[84:87], v[32:47]
    s_add_u32 m0, s70, 18432
    s_mul_i32 s73, s53, 64
    s_add_u32 s73, s73, 65536
    buffer_load_dwordx4 v214, s[24:27], s73 offen lds
    s_add_u32 m0, s70, 19456
    s_mul_i32 s73, s53, 64
    s_add_u32 s73, s73, 98304
    buffer_load_dwordx4 v214, s[24:27], s73 offen lds
    buffer_load_dwordx4 v[124:127], v4, s[40:43], s56 offen offset:3072 sc1
    s_waitcnt vmcnt(14)
    v_mfma_f32_32x32x16_bf16 v[16:31], a[144:147], v[88:91], v[16:31]
    v_mfma_f32_32x32x16_bf16 v[32:47], a[148:151], v[88:91], v[32:47]
    s_add_u32 m0, s70, 20480
    s_mul_i32 s73, s53, 64
    s_add_u32 s73, s73, 131072
    buffer_load_dwordx4 v214, s[24:27], s73 offen lds
    s_add_u32 m0, s70, 21504
    s_mul_i32 s73, s53, 64
    s_add_u32 s73, s73, 163840
    buffer_load_dwordx4 v214, s[24:27], s73 offen lds
    s_add_u32 s56, s58, s51
    buffer_load_dwordx4 v[128:131], v4, s[40:43], s56 offen offset:0 sc1
    s_waitcnt vmcnt(16)
    v_mfma_f32_32x32x16_bf16 v[16:31], a[152:155], v[92:95], v[16:31]
    v_mfma_f32_32x32x16_bf16 v[32:47], a[156:159], v[92:95], v[32:47]
    s_add_u32 m0, s70, 22528
    s_mul_i32 s73, s53, 64
    s_add_u32 s73, s73, 196608
    buffer_load_dwordx4 v214, s[24:27], s73 offen lds
    s_add_u32 m0, s70, 23552
    s_mul_i32 s73, s53, 64
    s_add_u32 s73, s73, 229376
    buffer_load_dwordx4 v214, s[24:27], s73 offen lds
    buffer_load_dwordx4 v[132:135], v4, s[40:43], s56 offen offset:1024 sc1
    s_waitcnt vmcnt(18)
    v_mfma_f32_32x32x16_bf16 v[16:31], a[160:163], v[96:99], v[16:31]
    v_mfma_f32_32x32x16_bf16 v[32:47], a[164:167], v[96:99], v[32:47]
    s_add_u32 m0, s70, 24576
    s_mul_i32 s73, s54, 64
    s_add_u32 s73, s73, 0
    buffer_load_dwordx4 v214, s[24:27], s73 offen lds
    s_add_u32 m0, s70, 25600
    s_mul_i32 s73, s54, 64
    s_add_u32 s73, s73, 32768
    buffer_load_dwordx4 v214, s[24:27], s73 offen lds
    s_waitcnt vmcnt(15)
    v_mov_b32 v8, s4
    s_mov_b64 exec, 1
    buffer_store_dword v8, v9, s[40:43], s82 offen sc1
    s_mov_b64 exec, -1
    buffer_load_dwordx4 v[136:139], v4, s[40:43], s56 offen offset:2048 sc1
    v_mfma_f32_32x32x16_bf16 v[16:31], a[168:171], v[100:103], v[16:31]
    v_mfma_f32_32x32x16_bf16 v[32:47], a[172:175], v[100:103], v[32:47]
    s_add_u32 m0, s70, 26624
    s_mul_i32 s73, s54, 64
    s_add_u32 s73, s73, 65536
    buffer_load_dwordx4 v214, s[24:27], s73 offen lds
    s_add_u32 m0, s70, 27648
    s_mul_i32 s73, s54, 64
    s_add_u32 s73, s73, 98304
    buffer_load_dwordx4 v214, s[24:27], s73 offen lds
    buffer_load_dwordx4 v[140:143], v4, s[40:43], s56 offen offset:3072 sc1
    v_mfma_f32_32x32x16_bf16 v[16:31], a[176:179], v[104:107], v[16:31]
    v_mfma_f32_32x32x16_bf16 v[32:47], a[180:183], v[104:107], v[32:47]
    s_add_u32 m0, s70, 28672
    s_mul_i32 s73, s54, 64
    s_add_u32 s73, s73, 131072
    buffer_load_dwordx4 v214, s[24:27], s73 offen lds
    s_add_u32 m0, s70, 29696
    s_mul_i32 s73, s54, 64
    s_add_u32 s73, s73, 163840
    buffer_load_dwordx4 v214, s[24:27], s73 offen lds
    s_and_b32 s60, s3, 1
    s_cmp_eq_u32 s60, 1
    s_cselect_b32 s60, 1.0, 0
    v_lshlrev_b32 v48, 16, v224
    v_and_b32 v49, s91, v224
    v_lshlrev_b32 v208, 16, v240
    v_and_b32 v209, s91, v240
    v_add_f32 v48, v48, v208
    s_add_u32 s56, s58, s52
    buffer_load_dwordx4 v[144:147], v4, s[40:43], s56 offen offset:0 sc1
    v_mfma_f32_32x32x16_bf16 v[16:31], a[184:187], v[108:111], v[16:31]
    v_mfma_f32_32x32x16_bf16 v[32:47], a[188:191], v[108:111], v[32:47]
    s_add_u32 m0, s70, 30720
    s_mul_i32 s73, s54, 64
    s_add_u32 s73, s73, 196608
    buffer_load_dwordx4 v214, s[24:27], s73 offen lds
    s_add_u32 m0, s70, 31744
    s_mul_i32 s73, s54, 64
    s_add_u32 s73, s73, 229376
    buffer_load_dwordx4 v214, s[24:27], s73 offen lds
    v_add_f32 v49, v49, v209
    v_mul_f32 v48, s60, v48
    v_mul_f32 v49, s60, v49
    v_lshlrev_b32 v50, 16, v225
    v_and_b32 v51, s91, v225
    v_lshlrev_b32 v210, 16, v241
    buffer_load_dwordx4 v[148:151], v4, s[40:43], s56 offen offset:1024 sc1
    v_mfma_f32_32x32x16_bf16 v[16:31], a[192:195], v[112:115], v[16:31]
    v_mfma_f32_32x32x16_bf16 v[32:47], a[196:199], v[112:115], v[32:47]
    s_waitcnt vmcnt(23)
    ds_read_b64_tr_b16 a[32:33], v217 offset:16384
    ds_read_b64_tr_b16 a[34:35], v217 offset:17408
    ds_read_b64_tr_b16 a[36:37], v218 offset:16384
    ds_read_b64_tr_b16 a[38:39], v218 offset:17408
    v_and_b32 v211, s91, v241
    v_add_f32 v50, v50, v210
    v_add_f32 v51, v51, v211
    v_mul_f32 v50, s60, v50
    v_mul_f32 v51, s60, v51
    v_lshlrev_b32 v52, 16, v226
    buffer_load_dwordx4 v[152:155], v4, s[40:43], s56 offen offset:2048 sc1
    v_mfma_f32_32x32x16_bf16 v[16:31], a[200:203], v[116:119], v[16:31]
    v_mfma_f32_32x32x16_bf16 v[32:47], a[204:207], v[116:119], v[32:47]
    s_waitcnt vmcnt(21)
    ds_read_b64_tr_b16 a[40:41], v217 offset:18432
    ds_read_b64_tr_b16 a[42:43], v217 offset:19456
    ds_read_b64_tr_b16 a[44:45], v218 offset:18432
    ds_read_b64_tr_b16 a[46:47], v218 offset:19456
    v_and_b32 v53, s91, v226
    v_lshlrev_b32 v208, 16, v242
    v_and_b32 v209, s91, v242
    v_add_f32 v52, v52, v208
    v_add_f32 v53, v53, v209
    v_mul_f32 v52, s60, v52
    buffer_load_dwordx4 v[156:159], v4, s[40:43], s56 offen offset:3072 sc1
    v_mfma_f32_32x32x16_bf16 v[16:31], a[208:211], v[120:123], v[16:31]
    v_mfma_f32_32x32x16_bf16 v[32:47], a[212:215], v[120:123], v[32:47]
    s_waitcnt vmcnt(19)
    ds_read_b64_tr_b16 a[48:49], v217 offset:20480
    ds_read_b64_tr_b16 a[50:51], v217 offset:21504
    ds_read_b64_tr_b16 a[52:53], v218 offset:20480
    ds_read_b64_tr_b16 a[54:55], v218 offset:21504
    v_mul_f32 v53, s60, v53
    v_lshlrev_b32 v54, 16, v227
    v_and_b32 v55, s91, v227
    v_lshlrev_b32 v210, 16, v243
    v_and_b32 v211, s91, v243
    v_add_f32 v54, v54, v210
    s_add_u32 s56, s58, s53
    buffer_load_dwordx4 v[160:163], v4, s[40:43], s56 offen offset:0 sc1
    v_mfma_f32_32x32x16_bf16 v[16:31], a[216:219], v[124:127], v[16:31]
    v_mfma_f32_32x32x16_bf16 v[32:47], a[220:223], v[124:127], v[32:47]
    s_waitcnt vmcnt(17)
    ds_read_b64_tr_b16 a[56:57], v217 offset:22528
    ds_read_b64_tr_b16 a[58:59], v217 offset:23552
    ds_read_b64_tr_b16 a[60:61], v218 offset:22528
    ds_read_b64_tr_b16 a[62:63], v218 offset:23552
    v_add_f32 v55, v55, v211
    v_mul_f32 v54, s60, v54
    v_mul_f32 v55, s60, v55
    v_lshlrev_b32 v56, 16, v228
    v_and_b32 v57, s91, v228
    v_lshlrev_b32 v208, 16, v244
    buffer_load_dwordx4 v[164:167], v4, s[40:43], s56 offen offset:1024 sc1
    v_mfma_f32_32x32x16_bf16 v[16:31], a[224:227], v[128:131], v[16:31]
    v_mfma_f32_32x32x16_bf16 v[32:47], a[228:231], v[128:131], v[32:47]
    s_waitcnt vmcnt(15)
    ds_read_b64_tr_b16 a[64:65], v217 offset:24576
    ds_read_b64_tr_b16 a[66:67], v217 offset:25600
    ds_read_b64_tr_b16 a[68:69], v218 offset:24576
    ds_read_b64_tr_b16 a[70:71], v218 offset:25600
    v_and_b32 v209, s91, v244
    v_add_f32 v56, v56, v208
    v_add_f32 v57, v57, v209
    v_mul_f32 v56, s60, v56
    v_mul_f32 v57, s60, v57
    v_lshlrev_b32 v58, 16, v229
    buffer_load_dwordx4 v[168:171], v4, s[40:43], s56 offen offset:2048 sc1
    v_mfma_f32_32x32x16_bf16 v[16:31], a[232:235], v[132:135], v[16:31]
    v_mfma_f32_32x32x16_bf16 v[32:47], a[236:239], v[132:135], v[32:47]
    s_waitcnt vmcnt(12)
    ds_read_b64_tr_b16 a[72:73], v217 offset:26624
    ds_read_b64_tr_b16 a[74:75], v217 offset:27648
    ds_read_b64_tr_b16 a[76:77], v218 offset:26624
    ds_read_b64_tr_b16 a[78:79], v218 offset:27648
    v_and_b32 v59, s91, v229
    v_lshlrev_b32 v210, 16, v245
    v_and_b32 v211, s91, v245
    v_add_f32 v58, v58, v210
    v_add_f32 v59, v59, v211
    v_mul_f32 v58, s60, v58
    buffer_load_dwordx4 v[172:175], v4, s[40:43], s56 offen offset:3072 sc1
    v_mfma_f32_32x32x16_bf16 v[16:31], a[240:243], v[136:139], v[16:31]
    v_mfma_f32_32x32x16_bf16 v[32:47], a[244:247], v[136:139], v[32:47]
    s_waitcnt vmcnt(10)
    ds_read_b64_tr_b16 a[80:81], v217 offset:28672
    ds_read_b64_tr_b16 a[82:83], v217 offset:29696
    ds_read_b64_tr_b16 a[84:85], v218 offset:28672
    ds_read_b64_tr_b16 a[86:87], v218 offset:29696
    v_mul_f32 v59, s60, v59
    v_lshlrev_b32 v60, 16, v230
    v_and_b32 v61, s91, v230
    v_lshlrev_b32 v208, 16, v246
    v_and_b32 v209, s91, v246
    v_add_f32 v60, v60, v208
    s_add_u32 s56, s58, s54
    buffer_load_dwordx4 v[176:179], v4, s[40:43], s56 offen offset:0 sc1
    v_mfma_f32_32x32x16_bf16 v[16:31], a[248:251], v[140:143], v[16:31]
    v_mfma_f32_32x32x16_bf16 v[32:47], a[252:255], v[140:143], v[32:47]
    s_waitcnt vmcnt(8)
    ds_read_b64_tr_b16 a[88:89], v217 offset:30720
    ds_read_b64_tr_b16 a[90:91], v217 offset:31744
    ds_read_b64_tr_b16 a[92:93], v218 offset:30720
    ds_read_b64_tr_b16 a[94:95], v218 offset:31744
    v_add_f32 v61, v61, v209
    v_mul_f32 v60, s60, v60
    v_mul_f32 v61, s60, v61
    v_lshlrev_b32 v62, 16, v231
    v_and_b32 v63, s91, v231
    v_lshlrev_b32 v210, 16, v247
    buffer_load_dwordx4 v[180:183], v4, s[40:43], s56 offen offset:1024 sc1
    v_mfma_f32_32x32x16_bf16 v[16:31], a[0:3], v[144:147], v[16:31]
    v_mfma_f32_32x32x16_bf16 v[32:47], a[4:7], v[144:147], v[32:47]
    v_and_b32 v211, s91, v247
    v_add_f32 v62, v62, v210
    v_add_f32 v63, v63, v211
    v_mul_f32 v62, s60, v62
    v_mul_f32 v63, s60, v63
    buffer_load_dword v248, v12, s[40:43], s85 offen offset:0 sc1
    buffer_load_dwordx4 v[184:187], v4, s[40:43], s56 offen offset:2048 sc1
    s_waitcnt vmcnt(10)
    v_mfma_f32_32x32x16_bf16 v[16:31], a[8:11], v[148:151], v[16:31]
    v_mfma_f32_32x32x16_bf16 v[32:47], a[12:15], v[148:151], v[32:47]
    buffer_load_dwordx4 v[188:191], v4, s[40:43], s56 offen offset:3072 sc1
    s_waitcnt vmcnt(10)
    v_mfma_f32_32x32x16_bf16 v[16:31], a[16:19], v[152:155], v[16:31]
    v_mfma_f32_32x32x16_bf16 v[32:47], a[20:23], v[152:155], v[32:47]
    s_waitcnt vmcnt(9)
    v_mfma_f32_32x32x16_bf16 v[16:31], a[24:27], v[156:159], v[16:31]
    v_mfma_f32_32x32x16_bf16 v[32:47], a[28:31], v[156:159], v[32:47]
    s_waitcnt vmcnt(8) lgkmcnt(15)
    v_mfma_f32_32x32x16_bf16 v[16:31], a[32:35], v[160:163], v[16:31]
    v_mfma_f32_32x32x16_bf16 v[32:47], a[36:39], v[160:163], v[32:47]
    s_waitcnt vmcnt(2)
    v_cmp_ne_u32 vcc, s4, v248
    s_nop 1
    s_cbranch_vccz Lpcd_P_13
    s_nop 6
Lpc_P_12:
    s_sub_u32 s6, s6, 1
    s_cbranch_scc1 L_end_P
    buffer_load_dword v248, v12, s[40:43], s85 offen offset:0 sc1
    s_waitcnt vmcnt(0)
    v_cmp_ne_u32 vcc, s4, v248
    s_nop 1
    s_cbranch_vccnz Lpc_P_12
Lpcd_P_13:
    s_add_u32 s56, s59, s48
    buffer_load_dwordx4 v[192:195], v4, s[40:43], s56 offen offset:0 sc1
    buffer_load_dwordx4 v[196:199], v4, s[40:43], s56 offen offset:1024 sc1
    v_mfma_f32_32x32x16_bf16 v[16:31], a[40:43], v[164:167], v[16:31]
    v_mfma_f32_32x32x16_bf16 v[32:47], a[44:47], v[164:167], v[32:47]
    buffer_load_dwordx4 v[200:203], v4, s[40:43], s56 offen offset:2048 sc1
    buffer_load_dwordx4 v[204:207], v4, s[40:43], s56 offen offset:3072 sc1
    v_mfma_f32_32x32x16_bf16 v[16:31], a[48:51], v[168:171], v[16:31]
    v_mfma_f32_32x32x16_bf16 v[32:47], a[52:55], v[168:171], v[32:47]
    s_add_u32 s56, s59, s49
    buffer_load_dwordx4 v[80:83], v4, s[40:43], s56 offen offset:0 sc1
    v_mfma_f32_32x32x16_bf16 v[16:31], a[56:59], v[172:175], v[16:31]
    v_mfma_f32_32x32x16_bf16 v[32:47], a[60:63], v[172:175], v[32:47]
    buffer_load_dwordx4 v[84:87], v4, s[40:43], s56 offen offset:1024 sc1
    s_waitcnt lgkmcnt(14)
    v_mfma_f32_32x32x16_bf16 v[16:31], a[64:67], v[176:179], v[16:31]
    s_waitcnt lgkmcnt(12)
    v_mfma_f32_32x32x16_bf16 v[32:47], a[68:71], v[176:179], v[32:47]
    buffer_load_dwordx4 v[88:91], v4, s[40:43], s56 offen offset:2048 sc1
    s_waitcnt lgkmcnt(10)
    v_mfma_f32_32x32x16_bf16 v[16:31], a[72:75], v[180:183], v[16:31]
    s_waitcnt lgkmcnt(8)
    v_mfma_f32_32x32x16_bf16 v[32:47], a[76:79], v[180:183], v[32:47]
    buffer_load_dwordx4 v[92:95], v4, s[40:43], s56 offen offset:3072 sc1
    s_waitcnt vmcnt(9) lgkmcnt(6)
    v_mfma_f32_32x32x16_bf16 v[16:31], a[80:83], v[184:187], v[16:31]
    s_waitcnt lgkmcnt(4)
    v_mfma_f32_32x32x16_bf16 v[32:47], a[84:87], v[184:187], v[32:47]
    s_add_u32 s56, s59, s50
    buffer_load_dwordx4 v[96:99], v4, s[40:43], s56 offen offset:0 sc1
    s_waitcnt vmcnt(9) lgkmcnt(2)
    v_mfma_f32_32x32x16_bf16 v[16:31], a[88:91], v[188:191], v[16:31]
    s_waitcnt lgkmcnt(0)
    v_mfma_f32_32x32x16_bf16 v[32:47], a[92:95], v[188:191], v[32:47]
    buffer_load_dwordx4 v[100:103], v4, s[40:43], s56 offen offset:1024 sc1
    s_waitcnt vmcnt(9)
    v_mfma_f32_32x32x16_bf16 v[48:63], a[128:131], v[192:195], v[48:63]
    v_mfma_f32_32x32x16_bf16 v[64:79], a[132:135], v[192:195], 0
    s_nop 7
    ds_write_b32 v237, v32 offset:0
    ds_write_b32 v237, v34 offset:256
    ds_write_b32 v237, v33 offset:128
    ds_write_b32 v237, v35 offset:384
    ds_write_b32 v237, v36 offset:1024
    ds_write_b32 v237, v38 offset:1280
    buffer_load_dwordx4 v[104:107], v4, s[40:43], s56 offen offset:2048 sc1
    s_waitcnt vmcnt(9)
    v_mfma_f32_32x32x16_bf16 v[48:63], a[136:139], v[196:199], v[48:63]
    v_mfma_f32_32x32x16_bf16 v[64:79], a[140:143], v[196:199], v[64:79]
    ds_write_b32 v237, v37 offset:1152
    ds_write_b32 v237, v39 offset:1408
    ds_write_b32 v237, v40 offset:2048
    ds_write_b32 v237, v42 offset:2304
    ds_write_b32 v237, v41 offset:2176
    ds_write_b32 v237, v43 offset:2432
    buffer_load_dwordx4 v[108:111], v4, s[40:43], s56 offen offset:3072 sc1
    s_waitcnt vmcnt(9)
    v_mfma_f32_32x32x16_bf16 v[48:63], a[144:147], v[200:203], v[48:63]
    v_mfma_f32_32x32x16_bf16 v[64:79], a[148:151], v[200:203], v[64:79]
    ds_write_b32 v237, v44 offset:3072
    ds_write_b32 v237, v46 offset:3328
    ds_write_b32 v237, v45 offset:3200
    ds_write_b32 v237, v47 offset:3456
    ds_write_b32 v236, v16 offset:0
    ds_write_b32 v236, v18 offset:256
    s_add_u32 s56, s59, s51
    buffer_load_dwordx4 v[112:115], v4, s[40:43], s56 offen offset:0 sc1
    s_waitcnt vmcnt(9)
    v_mfma_f32_32x32x16_bf16 v[48:63], a[152:155], v[204:207], v[48:63]
    v_mfma_f32_32x32x16_bf16 v[64:79], a[156:159], v[204:207], v[64:79]
    ds_write_b32 v236, v17 offset:128
    ds_write_b32 v236, v19 offset:384
    ds_write_b32 v236, v20 offset:1024
    ds_write_b32 v236, v22 offset:1280
    ds_write_b32 v236, v21 offset:1152
    ds_write_b32 v236, v23 offset:1408
    buffer_load_dwordx4 v[116:119], v4, s[40:43], s56 offen offset:1024 sc1
    s_waitcnt vmcnt(9)
    v_mfma_f32_32x32x16_bf16 v[48:63], a[160:163], v[80:83], v[48:63]
    v_mfma_f32_32x32x16_bf16 v[64:79], a[164:167], v[80:83], v[64:79]
    ds_write_b32 v236, v24 offset:2048
    ds_write_b32 v236, v26 offset:2304
    ds_write_b32 v236, v25 offset:2176
    ds_write_b32 v236, v27 offset:2432
    ds_write_b32 v236, v28 offset:3072
    ds_write_b32 v236, v30 offset:3328
    buffer_load_dwordx4 v[120:123], v4, s[40:43], s56 offen offset:2048 sc1
    s_waitcnt vmcnt(9)
    v_mfma_f32_32x32x16_bf16 v[48:63], a[168:171], v[84:87], v[48:63]
    v_mfma_f32_32x32x16_bf16 v[64:79], a[172:175], v[84:87], v[64:79]
    ds_write_b32 v236, v29 offset:3200
    ds_write_b32 v236, v31 offset:3456
    buffer_load_dwordx4 v[124:127], v4, s[40:43], s56 offen offset:3072 sc1
    s_waitcnt vmcnt(9)
    v_mfma_f32_32x32x16_bf16 v[48:63], a[176:179], v[88:91], v[48:63]
    v_mfma_f32_32x32x16_bf16 v[64:79], a[180:183], v[88:91], v[64:79]
    s_add_u32 s56, s59, s52
    buffer_load_dwordx4 v[128:131], v4, s[40:43], s56 offen offset:0 sc1
    s_waitcnt vmcnt(9)
    v_mfma_f32_32x32x16_bf16 v[48:63], a[184:187], v[92:95], v[48:63]
    v_mfma_f32_32x32x16_bf16 v[64:79], a[188:191], v[92:95], v[64:79]
    s_waitcnt lgkmcnt(0)
    s_barrier
    ds_read_b128 v[16:19], v238 offset:0
    ds_read_b128 v[20:23], v238 offset:36864
    ds_read_b128 v[24:27], v239 offset:0
    ds_read_b128 v[28:31], v239 offset:36864
    ds_read_b128 v[32:35], v238 offset:1024
    ds_read_b128 v[36:39], v238 offset:37888
    ds_read_b128 v[40:43], v239 offset:1024
    ds_read_b128 v[44:47], v239 offset:37888
    buffer_load_dwordx4 v[132:135], v4, s[40:43], s56 offen offset:1024 sc1
    s_waitcnt vmcnt(9)
    v_mfma_f32_32x32x16_bf16 v[48:63], a[192:195], v[96:99], v[48:63]
    v_mfma_f32_32x32x16_bf16 v[64:79], a[196:199], v[96:99], v[64:79]
    buffer_load_dwordx4 v[136:139], v4, s[40:43], s56 offen offset:2048 sc1
    s_waitcnt vmcnt(9)
    v_mfma_f32_32x32x16_bf16 v[48:63], a[200:203], v[100:103], v[48:63]
    v_mfma_f32_32x32x16_bf16 v[64:79], a[204:207], v[100:103], v[64:79]
    s_waitcnt lgkmcnt(6)
    v_add_f32 v16, v16, v20
    s_waitcnt lgkmcnt(4)
    v_add_f32 v24, v24, v28
    v_add_f32 v17, v17, v21
    v_add_f32 v25, v25, v29
    v_add_f32 v18, v18, v22
    v_add_f32 v26, v26, v30
    buffer_load_dwordx4 v[140:143], v4, s[40:43], s56 offen offset:3072 sc1
    s_waitcnt vmcnt(9)
    v_mfma_f32_32x32x16_bf16 v[48:63], a[208:211], v[104:107], v[48:63]
    v_mfma_f32_32x32x16_bf16 v[64:79], a[212:215], v[104:107], v[64:79]
    v_add_f32 v19, v19, v23
    v_add_f32 v27, v27, v31
    v_add_f32 v16, v16, v24
    v_add_f32 v17, v17, v25
    v_add_f32 v18, v18, v26
    v_add_f32 v19, v19, v27
    s_add_u32 s56, s59, s53
    buffer_load_dwordx4 v[144:147], v4, s[40:43], s56 offen offset:0 sc1
    s_waitcnt vmcnt(9)
    v_mfma_f32_32x32x16_bf16 v[48:63], a[216:219], v[108:111], v[48:63]
    v_mfma_f32_32x32x16_bf16 v[64:79], a[220:223], v[108:111], v[64:79]
    v_cvt_pk_bf16_f32 v20, v16, v17
    v_cvt_pk_bf16_f32 v21, v18, v19
    buffer_store_dwordx2 v[20:21], v212, s[36:39], s68 offen offset:0
    s_waitcnt lgkmcnt(2)
    v_add_f32 v32, v32, v36
    s_waitcnt lgkmcnt(0)
    v_add_f32 v40, v40, v44
    v_add_f32 v33, v33, v37
    buffer_load_dwordx4 v[148:151], v4, s[40:43], s56 offen offset:1024 sc1
    s_waitcnt vmcnt(10)
    v_mfma_f32_32x32x16_bf16 v[48:63], a[224:227], v[112:115], v[48:63]
    v_mfma_f32_32x32x16_bf16 v[64:79], a[228:231], v[112:115], v[64:79]
    v_add_f32 v41, v41, v45
    v_add_f32 v34, v34, v38
    v_add_f32 v42, v42, v46
    v_add_f32 v35, v35, v39
    v_add_f32 v43, v43, v47
    v_add_f32 v32, v32, v40
    buffer_load_dwordx4 v[152:155], v4, s[40:43], s56 offen offset:2048 sc1
    s_waitcnt vmcnt(10)
    v_mfma_f32_32x32x16_bf16 v[48:63], a[232:235], v[116:119], v[48:63]
    v_mfma_f32_32x32x16_bf16 v[64:79], a[236:239], v[116:119], v[64:79]
    v_add_f32 v33, v33, v41
    v_add_f32 v34, v34, v42
    v_add_f32 v35, v35, v43
    v_cvt_pk_bf16_f32 v36, v32, v33
    v_cvt_pk_bf16_f32 v37, v34, v35
    buffer_store_dwordx2 v[36:37], v212, s[36:39], s69 offen offset:0
    buffer_load_dwordx4 v[156:159], v4, s[40:43], s56 offen offset:3072 sc1
    s_waitcnt vmcnt(11)
    v_mfma_f32_32x32x16_bf16 v[48:63], a[240:243], v[120:123], v[48:63]
    v_mfma_f32_32x32x16_bf16 v[64:79], a[244:247], v[120:123], v[64:79]
    s_add_u32 s56, s59, s54
    buffer_load_dwordx4 v[160:163], v4, s[40:43], s56 offen offset:0 sc1
    s_waitcnt vmcnt(11)
    v_mfma_f32_32x32x16_bf16 v[48:63], a[248:251], v[124:127], v[48:63]
    v_mfma_f32_32x32x16_bf16 v[64:79], a[252:255], v[124:127], v[64:79]
    buffer_load_dwordx4 v[164:167], v4, s[40:43], s56 offen offset:1024 sc1
    s_waitcnt vmcnt(11)
    v_mfma_f32_32x32x16_bf16 v[48:63], a[0:3], v[128:131], v[48:63]
    v_mfma_f32_32x32x16_bf16 v[64:79], a[4:7], v[128:131], v[64:79]
    buffer_load_dwordx4 v[168:171], v4, s[40:43], s56 offen offset:2048 sc1
    s_waitcnt vmcnt(11)
    v_mfma_f32_32x32x16_bf16 v[48:63], a[8:11], v[132:135], v[48:63]
    v_mfma_f32_32x32x16_bf16 v[64:79], a[12:15], v[132:135], v[64:79]
    buffer_load_dwordx4 v[172:175], v4, s[40:43], s56 offen offset:3072 sc1
    s_waitcnt vmcnt(11)
    v_mfma_f32_32x32x16_bf16 v[48:63], a[16:19], v[136:139], v[48:63]
    v_mfma_f32_32x32x16_bf16 v[64:79], a[20:23], v[136:139], v[64:79]
    s_waitcnt vmcnt(10)
    v_mfma_f32_32x32x16_bf16 v[48:63], a[24:27], v[140:143], v[48:63]
    v_mfma_f32_32x32x16_bf16 v[64:79], a[28:31], v[140:143], v[64:79]
    s_waitcnt vmcnt(9)
    v_mfma_f32_32x32x16_bf16 v[48:63], a[32:35], v[144:147], v[48:63]
    v_mfma_f32_32x32x16_bf16 v[64:79], a[36:39], v[144:147], v[64:79]
    s_waitcnt vmcnt(7)
    v_mfma_f32_32x32x16_bf16 v[48:63], a[40:43], v[148:151], v[48:63]
    v_mfma_f32_32x32x16_bf16 v[64:79], a[44:47], v[148:151], v[64:79]
    s_waitcnt vmcnt(6)
    v_mfma_f32_32x32x16_bf16 v[48:63], a[48:51], v[152:155], v[48:63]
    v_mfma_f32_32x32x16_bf16 v[64:79], a[52:55], v[152:155], v[64:79]
    s_waitcnt vmcnt(4)
    v_mfma_f32_32x32x16_bf16 v[48:63], a[56:59], v[156:159], v[48:63]
    v_mfma_f32_32x32x16_bf16 v[64:79], a[60:63], v[156:159], v[64:79]
    s_waitcnt vmcnt(3)
    v_mfma_f32_32x32x16_bf16 v[64:79], a[68:71], v[160:163], v[64:79]
    s_waitcnt vmcnt(2)
    v_mfma_f32_32x32x16_bf16 v[64:79], a[76:79], v[164:167], v[64:79]
    s_waitcnt vmcnt(1)
    v_mfma_f32_32x32x16_bf16 v[64:79], a[84:87], v[168:171], v[64:79]
    s_waitcnt vmcnt(0)
    v_mfma_f32_32x32x16_bf16 v[64:79], a[92:95], v[172:175], v[64:79]
    v_mfma_f32_32x32x16_bf16 v[48:63], a[64:67], v[160:163], v[48:63]
    v_mfma_f32_32x32x16_bf16 v[48:63], a[72:75], v[164:167], v[48:63]
    s_nop 9
    ds_write_b32 v237, v64 offset:8192
    ds_write_b32 v237, v66 offset:8448
    ds_write_b32 v237, v65 offset:8320
    ds_write_b32 v237, v67 offset:8576
    ds_write_b32 v237, v68 offset:9216
    ds_write_b32 v237, v70 offset:9472
    v_mfma_f32_32x32x16_bf16 v[48:63], a[80:83], v[168:171], v[48:63]
    ds_write_b32 v237, v69 offset:9344
    ds_write_b32 v237, v71 offset:9600
    ds_write_b32 v237, v72 offset:10240
    ds_write_b32 v237, v74 offset:10496
    ds_write_b32 v237, v73 offset:10368
    ds_write_b32 v237, v75 offset:10624
    v_mfma_f32_32x32x16_bf16 v[48:63], a[88:91], v[172:175], v[48:63]
    ds_write_b32 v237, v76 offset:11264
    ds_write_b32 v237, v78 offset:11520
    ds_write_b32 v237, v77 offset:11392
    ds_write_b32 v237, v79 offset:11648
    s_nop 7
    ds_write_b32 v236, v48 offset:8192
    ds_write_b32 v236, v50 offset:8448
    ds_write_b32 v236, v49 offset:8320
    ds_write_b32 v236, v51 offset:8576
    ds_write_b32 v236, v52 offset:9216
    ds_write_b32 v236, v54 offset:9472
    ds_write_b32 v236, v53 offset:9344
    ds_write_b32 v236, v55 offset:9600
    ds_write_b32 v236, v56 offset:10240
    ds_write_b32 v236, v58 offset:10496
    ds_write_b32 v236, v57 offset:10368
    ds_write_b32 v236, v59 offset:10624
    ds_write_b32 v236, v60 offset:11264
    ds_write_b32 v236, v62 offset:11520
    ds_write_b32 v236, v61 offset:11392
    ds_write_b32 v236, v63 offset:11648
    s_waitcnt lgkmcnt(0)
    s_barrier
    ds_read_b128 v[48:51], v238 offset:8192
    ds_read_b128 v[52:55], v238 offset:45056
    ds_read_b128 v[56:59], v239 offset:8192
    ds_read_b128 v[60:63], v239 offset:45056
    ds_read_b128 v[64:67], v238 offset:9216
    ds_read_b128 v[68:71], v238 offset:46080
    ds_read_b128 v[72:75], v239 offset:9216
    ds_read_b128 v[76:79], v239 offset:46080
    s_waitcnt lgkmcnt(6)
    v_pk_add_f32 v[48:49], v[48:49], v[52:53]
    s_waitcnt lgkmcnt(4)
    v_pk_add_f32 v[56:57], v[56:57], v[60:61]
    v_pk_add_f32 v[50:51], v[50:51], v[54:55]
    v_pk_add_f32 v[58:59], v[58:59], v[62:63]
    v_pk_add_f32 v[48:49], v[48:49], v[56:57]
    v_pk_add_f32 v[50:51], v[50:51], v[58:59]
    v_cvt_pk_bf16_f32 v52, v48, v49
    v_cvt_pk_bf16_f32 v53, v50, v51
    buffer_store_dwordx2 v[52:53], v212, s[36:39], s68 offen offset:64
    s_waitcnt lgkmcnt(2)
    v_pk_add_f32 v[64:65], v[64:65], v[68:69]
    s_waitcnt lgkmcnt(0)
    v_pk_add_f32 v[72:73], v[72:73], v[76:77]
    v_pk_add_f32 v[66:67], v[66:67], v[70:71]
    v_pk_add_f32 v[74:75], v[74:75], v[78:79]
    v_pk_add_f32 v[64:65], v[64:65], v[72:73]
    v_pk_add_f32 v[66:67], v[66:67], v[74:75]
    v_cvt_pk_bf16_f32 v68, v64, v65
    v_cvt_pk_bf16_f32 v69, v66, v67
    buffer_store_dwordx2 v[68:69], v212, s[36:39], s69 offen offset:64
L_end_P:
    s_endpgm

.section .rodata,"a"
.p2align 6
.amdhsa_kernel sequential_preLN__sliding_local_dilated__mixer_token_mlp__prompt_kernel
  .amdhsa_next_free_vgpr 508
  .amdhsa_next_free_sgpr 102
  .amdhsa_accum_offset 252
  .amdhsa_group_segment_fixed_size 0
  .amdhsa_kernarg_size 88
  .amdhsa_user_sgpr_count 2
  .amdhsa_user_sgpr_kernarg_segment_ptr 1
  .amdhsa_system_sgpr_workgroup_id_x 1
.end_amdhsa_kernel
```

```asm
; @launch grid=(256,1,1) block=(256,1,1) lds=163840
.amdgcn_target "amdgcn-amd-amdhsa--gfx950"
.text
.globl sequential_preLN__sliding_local_dilated__mixer_token_mlp__prompt_kernel
.p2align 8
.type sequential_preLN__sliding_local_dilated__mixer_token_mlp__prompt_kernel,@function
sequential_preLN__sliding_local_dilated__mixer_token_mlp__prompt_kernel:
    s_cmp_ge_u32 s2, 256
    s_cbranch_scc1 L_end_P
    s_load_dwordx2 s[8:9], s[0:1], 0
    s_load_dwordx2 s[12:13], s[0:1], 8
    s_load_dwordx2 s[44:45], s[0:1], 72
    s_load_dwordx2 s[40:41], s[0:1], 80
    s_load_dwordx2 s[16:17], s[0:1], 16
    s_load_dwordx2 s[20:21], s[0:1], 32
    s_load_dwordx2 s[24:25], s[0:1], 48
    s_load_dwordx2 s[28:29], s[0:1], 40
    s_load_dwordx2 s[32:33], s[0:1], 56
    s_load_dwordx2 s[36:37], s[0:1], 64
    v_lshrrev_b32 v1, 6, v0
    s_nop 0
    v_readfirstlane_b32 s3, v1
    v_and_b32 v1, 63, v0
    v_and_b32 v2, 15, v0
    v_lshrrev_b32 v3, 4, v1
    v_lshlrev_b32 v4, 4, v1
    s_mov_b32 s10, 0x1c0000
    s_mov_b32 s11, 0x00020000
    s_mov_b32 s14, 0x126000
    s_mov_b32 s15, 0x00020000
    s_mov_b32 s46, 0x100
    s_mov_b32 s47, 0x00020000
    s_mov_b32 s42, 0x600000
    s_mov_b32 s43, 0x00020000
    s_mov_b32 s18, 0x62000
    s_mov_b32 s19, 0x00020000
    s_mov_b32 s22, 0x700000
    s_mov_b32 s23, 0x00020000
    s_mov_b32 s26, 0x700000
    s_mov_b32 s27, 0x00020000
    s_mov_b32 s30, 0xe00
    s_mov_b32 s31, 0x00020000
    s_mov_b32 s34, 0x1000
    s_mov_b32 s35, 0x00020000
    s_mov_b32 s38, 0x1c0000
    s_mov_b32 s39, 0x00020000
    s_mov_b32 s5, 0x3f803f80
    s_mov_b32 s6, 0x200000
    s_bfe_u32 s48, s2, 0x20001
    s_lshl_b32 s48, s48, 2
    s_lshr_b32 s53, s2, 6
    s_add_u32 s48, s48, s53
    s_bfe_u32 s49, s2, 0x30003
    s_and_b32 s53, s2, 1
    s_lshl_b32 s53, s53, 3
    s_add_u32 s49, s49, s53
    v_lshrrev_b32 v237, 2, v1
    v_mul_u32_u24 v123, 2688, v237
    v_lshrrev_b32 v237, 5, v1
    v_lshlrev_b32 v237, 1, v237
    v_and_b32 v238, 3, v1
    v_xor_b32 v237, v237, v238
    v_lshl_add_u32 v123, v237, 4, v123
    s_mul_i32 s53, s49, 56
    s_min_u32 s53, s53, 832
    s_mul_i32 s51, s3, 43008
    s_add_u32 s53, s53, s51
    v_add_u32 v123, s53, v123
    s_lshr_b32 s53, s3, 1
    s_mul_i32 s51, s53, 6144
    s_and_b32 s53, s3, 1
    s_lshl_b32 s53, s53, 10
    s_add_u32 s51, s51, s53
    v_lshrrev_b32 v237, 3, v1
    v_mul_u32_u24 v122, 896, v237
    v_and_b32 v237, 7, v1
    v_xor_b32 v237, v237, v3
    v_lshl_add_u32 v120, v237, 4, v122
    s_lshl_b32 s50, s48, 7
    s_lshl_b32 s53, s3, 5
    s_add_u32 s53, s53, s50
    s_mul_i32 s53, s53, 896
    v_xor_b32 v121, 64, v120
    v_add_u32 v120, s53, v120
    s_add_u32 s53, s53, 7168
    v_add_u32 v121, s53, v121
    s_lshl_b32 s53, s3, 1
    v_xor_b32 v237, s53, v237
    v_lshl_add_u32 v122, v237, 4, v122
    s_lshl_b32 s53, s3, 2
    s_add_u32 s53, s53, s50
    s_sub_u32 s53, s53, 16
    s_mul_i32 s53, s53, 896
    s_cmp_eq_u32 s48, 0
    s_cselect_b32 s53, 0x40000000, s53
    v_add_u32 v122, s53, v122
    s_lshl_b32 s52, s3, 12
    s_add_u32 s52, s52, 63488
    s_lshl_b32 s7, s3, 9
    s_cmp_eq_u32 s3, 0
    s_cselect_b32 s54, 0xffffff00, -1
    s_mov_b32 s55, 0
    s_memrealtime s[86:87]
    v_mov_b32 v7, 0
    s_waitcnt lgkmcnt(0)
    s_or_b32 s86, s86, 1
    v_mov_b32 v6, s86
    s_or_b32 s86, s2, s3
    s_cmp_eq_u32 s86, 0
    s_cselect_b64 exec, 1, 0
    buffer_store_dword v6, v7, s[44:47], 0 offen sc1
    s_mov_b64 exec, -1
    s_add_u32 m0, s51, 12288
    s_mov_b32 s73, 0
    buffer_load_dwordx4 v123, s[12:15], s73 offen lds
    s_add_u32 m0, s51, 14336
    s_mov_b32 s73, 896
    buffer_load_dwordx4 v123, s[12:15], s73 offen lds
    s_add_u32 m0, s51, 16384
    s_mov_b32 s73, 1792
    buffer_load_dwordx4 v123, s[12:15], s73 offen lds
    s_add_u32 m0, s52, 36864
    s_mov_b32 s73, 0
    buffer_load_dwordx4 v120, s[8:11], s73 offen lds
    s_add_u32 m0, s52, 37888
    s_mov_b32 s73, 0
    buffer_load_dwordx4 v121, s[8:11], s73 offen lds
    s_add_u32 m0, s52, 38912
    s_mov_b32 s73, 14336
    buffer_load_dwordx4 v120, s[8:11], s73 offen lds
    s_add_u32 m0, s52, 39936
    s_mov_b32 s73, 14336
    buffer_load_dwordx4 v121, s[8:11], s73 offen lds
    s_add_u32 m0, s7, 98304
    s_mov_b32 s73, 0
    s_mov_b64 exec, s[54:55]
    buffer_load_dwordx4 v122, s[8:11], s73 offen lds
    s_mov_b64 exec, -1
    s_bfe_u32 s53, s2, 0x30003
    s_add_u32 s86, s53, 1
    s_lshr_b32 s86, s86, 1
    s_lshr_b32 s87, s2, 6
    s_mul_i32 s87, s87, 5
    s_add_u32 s86, s86, s87
    s_lshl_b32 s86, s86, 2
    s_add_u32 s53, s86, s3
    s_mov_b32 s56, s53
    s_mov_b32 s86, 0x2a54
    s_bitcmp1_b32 s86, s49
    s_cselect_b32 s57, 0x40000000, 0
    s_mul_i32 s86, s53, 58
    v_add_u32 v237, s86, v1
    v_mul_u32_u24 v238, 43691, v237
    v_lshrrev_b32 v238, 19, v238
    v_mul_u32_u24 v239, 12, v238
    v_sub_u32 v239, v237, v239
    v_lshrrev_b32 v239, 2, v239
    v_mul_u32_u24 v239, 896, v239
    v_mul_u32_u24 v238, 2688, v238
    v_and_b32 v237, 3, v237
    v_lshlrev_b32 v237, 7, v237
    v_add3_u32 v237, v237, v238, v239
    v_add_u32 v237, s57, v237
    s_and_b32 s87, s2, 1
    s_mul_i32 s87, s87, 384
    s_add_u32 s87, s87, 172032
    s_mov_b32 exec_lo, 0xffffffff
    s_mov_b32 exec_hi, 0x3ffffff
    buffer_load_dword v232, v237, s[12:15], s87 offen
    s_mov_b64 exec, -1
    v_lshlrev_b32 v237, 7, v1
    v_add_u32 v238, s57, v237
    s_mul_i32 s86, s53, 6016
    s_bfe_u32 s87, s2, 0x20001
    s_mul_i32 s87, s87, 458752
    s_add_u32 s86, s86, s87
    s_max_u32 s86, s86, 14336
    s_sub_u32 s86, s86, 14336
    s_mov_b32 exec_hi, 0x7fff
    buffer_load_dword v233, v238, s[8:11], s86 offen
    s_getpc_b64 s[86:87]
Lpc_P:
    s_mul_i32 s53, s53, 384
    v_add_u32 v237, s53, v237
    v_min_u32 v237, L_end_P-Lpc_P, v237
    s_mov_b64 exec, 7
    global_load_dword v236, v237, s[86:87]
    s_mov_b64 exec, -1
    v_mul_u32_u24 v237, 18432, v3
    v_lshl_add_u32 v237, v2, 3, v237
    v_mov_b32 v238, s5
    v_add_u32 v237, 61440, v237
    ds_write2_b32 v237, v238, v238 offset0:0 offset1:1
    s_lshr_b32 s68, s2, 3
    s_mul_i32 s69, s68, 37
    s_lshr_b32 s69, s69, 8
    s_mul_i32 s64, s69, 7
    s_sub_u32 s64, s68, s64
    s_mov_b32 s66, s64
    s_and_b32 s68, s2, 7
    s_lshl_b32 s67, s68, 2
    s_add_u32 s67, s67, s69
    s_cmp_ge_u32 s69, 4
    s_cselect_b32 s67, 99, s67
    s_mul_i32 s71, s68, 3
    s_add_u32 s71, s71, 4
    s_lshl_b32 s72, s68, 2
    s_cmp_lt_u32 s68, 4
    s_cselect_b32 s65, s72, s71
    s_cselect_b32 s71, 4, 3
    s_add_u32 s65, s65, s69
    s_cmp_ge_u32 s69, s71
    s_cselect_b32 s65, 99, s65
    v_lshrrev_b32 v219, 3, v1
    v_mul_u32_u24 v208, 896, v219
    v_and_b32 v219, 1, v3
    v_lshlrev_b32 v219, 2, v219
    v_and_b32 v220, 7, v1
    v_xor_b32 v219, v219, v220
    v_lshl_add_u32 v208, v219, 4, v208
    s_lshl_b32 s58, s66, 7
    s_mul_i32 s60, s3, 100352
    s_add_u32 s58, s58, s60
    v_add_u32 v208, s58, v208
    s_mul_i32 s59, s3, 36864
    s_add_u32 s59, s59, 12288
    v_lshrrev_b32 v219, 5, v1
    v_lshlrev_b32 v209, 9, v219
    v_bfe_u32 v219, v1, 2, 2
    v_lshl_add_u32 v209, v219, 7, v209
    v_lshrrev_b32 v219, 1, v219
    s_and_b32 s58, s3, 1
    v_xor_b32 v219, s58, v219
    v_lshl_add_u32 v209, v219, 6, v209
    v_and_b32 v219, 1, v3
    v_lshl_add_u32 v209, v219, 5, v209
    v_and_b32 v219, 3, v1
    v_lshl_add_u32 v209, v219, 3, v209
    v_add_u32 v209, 12288, v209
    v_lshrrev_b32 v219, 5, v1
    v_lshlrev_b32 v219, 10, v219
    v_sub_u32 v210, v209, v219
    s_mul_i32 s70, s3, 36864
    s_add_u32 s70, s70, 12288
    v_lshrrev_b32 v219, 3, v1
    v_mul_u32_u24 v213, 3584, v219
    v_and_b32 v219, 1, v3
    v_lshlrev_b32 v219, 2, v219
    v_and_b32 v220, 7, v1
    v_xor_b32 v219, v219, v220
    v_lshl_add_u32 v213, v219, 4, v213
    s_mul_i32 s68, s3, 1835008
    s_lshl_b32 s69, s65, 7
    s_add_u32 s68, s68, s69
    s_cmp_ge_u32 s65, 99
    s_cselect_b32 s68, 0x40000000, s68
    v_add_u32 v213, s68, v213
    s_cselect_b32 s68, 0x40000000, 0
    v_add_u32 v5, s68, v4
    v_lshrrev_b32 v219, 5, v1
    v_lshlrev_b32 v215, 9, v219
    v_bfe_u32 v219, v1, 2, 2
    v_lshl_add_u32 v215, v219, 7, v215
    v_lshrrev_b32 v219, 1, v219
    s_lshr_b32 s68, s3, 1
    v_xor_b32 v219, s68, v219
    v_lshl_add_u32 v215, v219, 6, v215
    v_and_b32 v219, 1, v3
    v_lshl_add_u32 v215, v219, 5, v215
    v_and_b32 v219, 3, v1
    v_lshl_add_u32 v215, v219, 3, v215
    s_and_b32 s68, s3, 1
    s_lshl_b32 s68, s68, 5
    v_xor_b32 v215, s68, v215
    v_add_u32 v215, s70, v215
    v_xor_b32 v216, 64, v215
    s_mul_i32 s70, s3, 36864
    s_add_u32 s70, s70, 12288
    v_lshrrev_b32 v219, 3, v1
    v_mul_u32_u24 v214, 4096, v219
    v_and_b32 v219, 1, v3
    v_lshlrev_b32 v219, 2, v219
    v_and_b32 v220, 7, v1
    v_xor_b32 v219, v219, v220
    v_lshl_add_u32 v214, v219, 4, v214
    s_mul_i32 s68, s3, 1835008
    s_lshl_b32 s69, s67, 7
    s_add_u32 s68, s68, s69
    s_cmp_ge_u32 s67, 99
    s_cselect_b32 s68, 0x40000000, s68
    v_add_u32 v214, s68, v214
    v_lshrrev_b32 v219, 5, v1
    v_lshlrev_b32 v217, 9, v219
    v_bfe_u32 v219, v1, 2, 2
    v_lshl_add_u32 v217, v219, 7, v217
    v_lshrrev_b32 v219, 1, v219
    s_lshr_b32 s68, s3, 1
    v_xor_b32 v219, s68, v219
    v_lshl_add_u32 v217, v219, 6, v217
    v_and_b32 v219, 1, v3
    v_lshl_add_u32 v217, v219, 5, v217
    v_and_b32 v219, 3, v1
    v_lshl_add_u32 v217, v219, 3, v217
    v_add_u32 v217, s70, v217
    v_xor_b32 v218, 64, v217
    s_and_b32 s68, s2, 7
    s_cmp_ge_u32 s68, 8
    s_cselect_b32 s94, 8, 0
    s_sub_u32 s68, s68, s94
    s_lshl_b32 s94, s68, 12
    s_add_u32 s68, s68, 1
    s_cmp_ge_u32 s68, 8
    s_cselect_b32 s95, 8, 0
    s_sub_u32 s68, s68, s95
    s_lshl_b32 s95, s68, 12
    s_add_u32 s68, s68, 1
    s_cmp_ge_u32 s68, 8
    s_cselect_b32 s96, 8, 0
    s_sub_u32 s68, s68, s96
    s_lshl_b32 s96, s68, 12
    s_add_u32 s68, s68, 1
    s_cmp_ge_u32 s68, 8
    s_cselect_b32 s97, 8, 0
    s_sub_u32 s68, s68, s97
    s_lshl_b32 s97, s68, 12
    s_add_u32 s68, s68, 1
    s_cmp_ge_u32 s68, 8
    s_cselect_b32 s98, 8, 0
    s_sub_u32 s68, s68, s98
    s_lshl_b32 s98, s68, 12
    s_add_u32 s68, s68, 1
    s_cmp_ge_u32 s68, 8
    s_cselect_b32 s99, 8, 0
    s_sub_u32 s68, s68, s99
    s_lshl_b32 s99, s68, 12
    s_add_u32 s68, s68, 1
    s_cmp_ge_u32 s68, 8
    s_cselect_b32 s100, 8, 0
    s_sub_u32 s68, s68, s100
    s_lshl_b32 s100, s68, 12
    s_add_u32 s68, s68, 1
    s_cmp_ge_u32 s68, 8
    s_cselect_b32 s101, 8, 0
    s_sub_u32 s68, s68, s101
    s_lshl_b32 s101, s68, 12
    s_lshl_b32 s80, s48, 2
    s_add_u32 s80, s80, s3
    s_lshl_b32 s80, s80, 11
    s_lshr_b32 s93, s49, 2
    s_lshl_b32 s93, s93, 7
    s_add_u32 s80, s80, s93
    s_and_b32 s93, s49, 3
    s_lshl_b32 s93, s93, 2
    s_add_u32 s80, s80, s93
    s_add_u32 s80, s80, 0x5c8000
    s_lshl_b32 s83, s67, 1
    s_lshr_b32 s93, s3, 1
    s_add_u32 s83, s83, s93
    s_lshl_b32 s83, s83, 11
    s_add_u32 s83, s83, 0x5c8000
    v_lshrrev_b32 v10, 2, v2
    v_lshlrev_b32 v10, 7, v10
    v_and_b32 v219, 3, v2
    v_lshl_add_u32 v10, v219, 2, v10
    s_lshl_b32 s84, s64, 12
    s_lshl_b32 s85, s84, 1
    s_add_u32 s85, s85, 0x5f0000
    s_add_u32 s84, s84, 0x5e8000
    s_lshl_b32 s81, s67, 5
    s_add_u32 s81, s81, s3
    s_lshl_b32 s81, s81, 2
    s_add_u32 s81, s81, s84
    s_lshl_b32 s93, s3, 10
    s_add_u32 s84, s84, s93
    v_bfe_u32 v11, v1, 2, 3
    v_min_u32 v12, 6, v11
    v_and_b32 v219, 3, v1
    v_lshlrev_b32 v219, 2, v219
    v_lshl_add_u32 v11, v11, 7, v219
    v_lshl_add_u32 v12, v12, 7, v219
    s_lshl_b32 s82, s65, 5
    s_add_u32 s82, s82, s3
    s_lshl_b32 s82, s82, 2
    s_add_u32 s82, s82, s85
    s_mul_i32 s93, s3, 896
    s_add_u32 s85, s85, s93
    v_mov_b32 v9, 0
    v_lshlrev_b32 v124, 9, v3
    v_bfe_u32 v237, v1, 2, 2
    v_lshl_add_u32 v124, v237, 6, v124
    v_and_b32 v237, 3, v1
    v_lshl_add_u32 v124, v237, 3, v124
    v_and_b32 v237, 1, v3
    v_lshlrev_b32 v237, 5, v237
    v_add_u32 v124, v124, v237
    v_add_u32 v124, 12288, v124
    v_xor_b32 v125, 32, v124
    s_and_b32 s53, s3, 1
    s_lshl_b32 s53, s53, 5
    v_xor_b32 v127, s53, v124
    s_lshr_b32 s53, s3, 1
    s_lshl_b32 s53, s53, 11
    s_add_u32 s53, s53, 2048
    v_add_u32 v126, s53, v127
    v_lshrrev_b32 v237, 1, v2
    v_xor_b32 v237, v237, v3
    v_lshlrev_b32 v237, 4, v237
    v_lshl_add_u32 v237, v2, 7, v237
    v_add_u32 v130, 61440, v237
    v_xor_b32 v131, 64, v130
    v_add_u32 v128, s52, v237
    v_xor_b32 v129, 64, v128
    v_lshlrev_b32 v237, 2, v3
    v_sub_u32 v237, v2, v237
    v_mov_b32 v239, 0xf149f2ca
    v_add_u32 v238, 16, v237
    v_and_b32 v238, 0xfffffff1, v238
    v_cmp_eq_u32 vcc, 0, v238
    s_nop 1
    v_cndmask_b32 v240, v239, 0, vcc
    v_add_u32 v238, 15, v237
    v_and_b32 v238, 0xfffffff1, v238
    v_cmp_eq_u32 vcc, 0, v238
    s_nop 1
    v_cndmask_b32 v241, v239, 0, vcc
    v_add_u32 v238, 14, v237
    v_and_b32 v238, 0xfffffff1, v238
    v_cmp_eq_u32 vcc, 0, v238
    s_nop 1
    v_cndmask_b32 v242, v239, 0, vcc
    v_add_u32 v238, 13, v237
    v_and_b32 v238, 0xfffffff1, v238
    v_cmp_eq_u32 vcc, 0, v238
    s_nop 1
    v_cndmask_b32 v243, v239, 0, vcc
    v_add_u32 v238, 0, v237
    v_and_b32 v238, 0xfffffff1, v238
    v_cmp_eq_u32 vcc, 0, v238
    s_nop 1
    v_cndmask_b32 v244, v239, 0, vcc
    v_add_u32 v238, -1, v237
    v_and_b32 v238, 0xfffffff1, v238
    v_cmp_eq_u32 vcc, 0, v238
    s_nop 1
    v_cndmask_b32 v245, v239, 0, vcc
    v_add_u32 v238, -2, v237
    v_and_b32 v238, 0xfffffff1, v238
    v_cmp_eq_u32 vcc, 0, v238
    s_nop 1
    v_cndmask_b32 v246, v239, 0, vcc
    v_add_u32 v238, -3, v237
    v_and_b32 v238, 0xfffffff1, v238
    v_cmp_eq_u32 vcc, 0, v238
    s_nop 1
    v_cndmask_b32 v247, v239, 0, vcc
    s_or_b32 s53, s48, s3
    s_cmp_eq_u32 s53, 0
    s_cselect_b64 vcc, -1, 0
    v_cndmask_b32 v248, v240, v239, vcc
    v_cndmask_b32 v249, v241, v239, vcc
    v_cndmask_b32 v250, v242, v239, vcc
    v_cndmask_b32 v251, v243, v239, vcc
    v_mov_b32 v40, s5
    v_mov_b32 v41, s5
    v_mov_b32 v42, s5
    v_mov_b32 v43, s5
    s_mov_b32 s88, 0x22222222
    s_mov_b32 s89, 0x22222222
    s_mov_b32 s90, 0x44444444
    s_mov_b32 s91, 0x44444444
    s_mov_b32 s92, 0x88888888
    s_mov_b32 s93, 0x88888888
    v_lshlrev_b32 v72, 4, v3
    s_lshl_b32 s53, s3, 6
    v_add_u32 v73, s53, v72
    s_and_b32 s53, s53, 64
    v_add_u32 v74, s53, v72
    s_mul_i32 s53, s3, 384
    v_lshl_add_u32 v75, v2, 2, s53
    v_add_u32 v76, s53, v72
    s_and_b32 s53, s3, 1
    s_lshl_b32 s53, s53, 3
    v_add_u32 v80, s53, v4
    v_lshrrev_b32 v81, 2, v2
    v_lshlrev_b32 v81, 8, v81
    v_lshl_add_u32 v81, v3, 6, v81
    v_and_b32 v82, 3, v2
    v_lshl_add_u32 v81, v82, 1, v81
    v_add_u32 v81, s53, v81
    v_add_u32 v81, 1024, v81
    s_cmp_lt_u32 s3, 2
    s_cselect_b64 vcc, -1, 0
    s_cselect_b32 s53, 2, 16
    v_cndmask_b32 v80, v81, v80, vcc
    v_add_u32 v81, s53, v80
    v_add_u32 v82, s53, v81
    v_add_u32 v83, s53, v82
    v_lshlrev_b32 v77, 2, v2
    s_lshl_b32 s53, s3, 11
    v_add_u32 v78, s53, v4
    s_lshl_b32 s62, s48, 3
    s_lshl_b32 s63, s3, 1
    s_add_u32 s62, s62, s63
    s_lshl_b32 s62, s62, 4
    s_add_u32 s62, s62, s49
    s_lshl_b32 s62, s62, 10
    s_add_u32 s63, s62, 16384
    s_add_u32 m0, s51, 24576
    s_mov_b32 s73, 172032
    buffer_load_dwordx4 v123, s[12:15], s73 offen lds
    s_add_u32 m0, s51, 26624
    s_mov_b32 s73, 172928
    buffer_load_dwordx4 v123, s[12:15], s73 offen lds
    s_add_u32 m0, s51, 28672
    s_mov_b32 s73, 173824
    buffer_load_dwordx4 v123, s[12:15], s73 offen lds
    s_add_u32 m0, s52, 18432
    s_mov_b32 s73, 128
    buffer_load_dwordx4 v120, s[8:11], s73 offen lds
    s_add_u32 m0, s52, 19456
    s_mov_b32 s73, 128
    buffer_load_dwordx4 v121, s[8:11], s73 offen lds
    s_add_u32 m0, s52, 20480
    s_mov_b32 s73, 14464
    buffer_load_dwordx4 v120, s[8:11], s73 offen lds
    s_add_u32 m0, s52, 21504
    s_mov_b32 s73, 14464
    buffer_load_dwordx4 v121, s[8:11], s73 offen lds
    s_add_u32 m0, s7, 79872
    s_mov_b32 s73, 128
    s_mov_b64 exec, s[54:55]
    buffer_load_dwordx4 v122, s[8:11], s73 offen lds
    s_mov_b64 exec, -1
    s_waitcnt vmcnt(11)
    s_waitcnt lgkmcnt(0)
    s_barrier
    ds_read_b128 v[16:19], v128 offset:36864
    ds_read_b128 v[20:23], v128 offset:38912
    ds_read_b128 v[24:27], v130 offset:36864
    ds_read_b64_tr_b16 v[88:89], v124 offset:0
    ds_read_b64_tr_b16 v[90:91], v124 offset:256
    ds_read_b64_tr_b16 v[92:93], v125 offset:0
    ds_read_b64_tr_b16 v[94:95], v125 offset:256
    ds_read_b64_tr_b16 v[96:97], v124 offset:2048
    ds_read_b64_tr_b16 v[98:99], v124 offset:2304
    ds_read_b64_tr_b16 v[100:101], v125 offset:2048
    ds_read_b64_tr_b16 v[102:103], v125 offset:2304
    ds_read_b64_tr_b16 v[104:105], v124 offset:4096
    ds_read_b64_tr_b16 v[106:107], v124 offset:4352
    ds_read_b64_tr_b16 v[108:109], v125 offset:4096
    ds_read_b64_tr_b16 v[110:111], v125 offset:4352
    ds_read_b64_tr_b16 v[112:113], v126 offset:0
    ds_read_b64_tr_b16 v[114:115], v126 offset:256
    ds_read_b64_tr_b16 v[116:117], v127 offset:0
    ds_read_b64_tr_b16 v[118:119], v127 offset:256
    s_waitcnt lgkmcnt(8)
    v_mfma_f32_16x16x32_bf16 v[136:139], v[88:91], v[16:19], 0
    ds_read_b128 v[28:31], v129 offset:36864
    v_mfma_f32_16x16x32_bf16 v[160:163], v[88:91], v[20:23], 0
    ds_read_b128 v[32:35], v129 offset:38912
    v_mfma_f32_16x16x32_bf16 v[140:143], v[92:95], v[16:19], 0
    ds_read_b128 v[36:39], v131 offset:36864
    v_mfma_f32_16x16x32_bf16 v[164:167], v[92:95], v[20:23], 0
    ds_read_b64_tr_b16 v[88:89], v124 offset:6144
    v_mfma_f32_16x16x32_bf16 v[144:147], v[96:99], v[16:19], 0
    ds_read_b64_tr_b16 v[90:91], v124 offset:6400
    s_add_u32 m0, s51, 36864
    s_mov_b32 s73, 344064
    buffer_load_dwordx4 v123, s[12:15], s73 offen lds
    v_mfma_f32_16x16x32_bf16 v[168:171], v[96:99], v[20:23], 0
    ds_read_b64_tr_b16 v[92:93], v125 offset:6144
    v_mfma_f32_16x16x32_bf16 v[148:151], v[100:103], v[16:19], 0
    ds_read_b64_tr_b16 v[94:95], v125 offset:6400
    v_mfma_f32_16x16x32_bf16 v[172:175], v[100:103], v[20:23], 0
    ds_read_b64_tr_b16 v[96:97], v124 offset:8192
    s_waitcnt lgkmcnt(8)
    v_mfma_f32_16x16x32_bf16 v[152:155], v[16:19], v[104:107], 0
    ds_read_b64_tr_b16 v[98:99], v124 offset:8448
    v_mfma_f32_16x16x32_bf16 v[176:179], v[20:23], v[104:107], 0
    ds_read_b64_tr_b16 v[100:101], v125 offset:8192
    s_add_u32 m0, s51, 38912
    s_mov_b32 s73, 344960
    buffer_load_dwordx4 v123, s[12:15], s73 offen lds
    v_mfma_f32_16x16x32_bf16 v[156:159], v[16:19], v[108:111], 0
    ds_read_b64_tr_b16 v[102:103], v125 offset:8448
    v_mfma_f32_16x16x32_bf16 v[180:183], v[20:23], v[108:111], 0
    ds_read_b64_tr_b16 v[104:105], v124 offset:10240
    v_mfma_f32_16x16x32_bf16 v[184:187], v[112:115], v[24:27], 0
    ds_read_b64_tr_b16 v[106:107], v124 offset:10496
    v_mfma_f32_16x16x32_bf16 v[188:191], v[116:119], v[24:27], 0
    ds_read_b64_tr_b16 v[108:109], v125 offset:10240
    v_mfma_f32_16x16x32_bf16 v[48:51], v[16:19], v[16:19], 0
    ds_read_b64_tr_b16 v[110:111], v125 offset:10496
    s_add_u32 m0, s51, 40960
    s_mov_b32 s73, 345856
    buffer_load_dwordx4 v123, s[12:15], s73 offen lds
    v_mfma_f32_16x16x32_bf16 v[52:55], v[20:23], v[20:23], 0
    ds_read_b64_tr_b16 v[112:113], v126 offset:6144
    v_mfma_f32_16x16x32_bf16 v[56:59], v[24:27], v[24:27], 0
    ds_read_b64_tr_b16 v[114:115], v126 offset:6400
    v_mfma_f32_16x16x32_bf16 v[60:63], v[40:43], v[16:19], 0
    ds_read_b64_tr_b16 v[116:117], v127 offset:6144
    v_mfma_f32_16x16x32_bf16 v[64:67], v[40:43], v[20:23], 0
    ds_read_b64_tr_b16 v[118:119], v127 offset:6400
    v_mfma_f32_16x16x32_bf16 v[68:71], v[40:43], v[24:27], 0
    s_add_u32 m0, s52, 0
    s_mov_b32 s73, 256
    buffer_load_dwordx4 v120, s[8:11], s73 offen lds
    s_add_u32 m0, s52, 1024
    s_mov_b32 s73, 256
    buffer_load_dwordx4 v121, s[8:11], s73 offen lds
    s_add_u32 m0, s52, 2048
    s_mov_b32 s73, 14592
    buffer_load_dwordx4 v120, s[8:11], s73 offen lds
    s_add_u32 m0, s52, 3072
    s_mov_b32 s73, 14592
    buffer_load_dwordx4 v121, s[8:11], s73 offen lds
    s_add_u32 m0, s7, 61440
    s_mov_b32 s73, 256
    s_mov_b64 exec, s[54:55]
    buffer_load_dwordx4 v122, s[8:11], s73 offen lds
    s_mov_b64 exec, -1
    s_waitcnt vmcnt(8)
    s_barrier
    s_waitcnt lgkmcnt(8)
    v_mfma_f32_16x16x32_bf16 v[136:139], v[88:91], v[28:31], v[136:139]
    ds_read_b128 v[16:19], v128 offset:18432
    v_mfma_f32_16x16x32_bf16 v[160:163], v[88:91], v[32:35], v[160:163]
    ds_read_b128 v[20:23], v128 offset:20480
    v_mfma_f32_16x16x32_bf16 v[140:143], v[92:95], v[28:31], v[140:143]
    ds_read_b128 v[24:27], v130 offset:18432
    v_mfma_f32_16x16x32_bf16 v[164:167], v[92:95], v[32:35], v[164:167]
    ds_read_b64_tr_b16 v[88:89], v124 offset:12288
    v_mfma_f32_16x16x32_bf16 v[144:147], v[96:99], v[28:31], v[144:147]
    ds_read_b64_tr_b16 v[90:91], v124 offset:12544
    s_add_u32 m0, s51, 49152
    s_mov_b32 s73, 516096
    buffer_load_dwordx4 v123, s[12:15], s73 offen lds
    v_mfma_f32_16x16x32_bf16 v[168:171], v[96:99], v[32:35], v[168:171]
    ds_read_b64_tr_b16 v[92:93], v125 offset:12288
    v_mfma_f32_16x16x32_bf16 v[148:151], v[100:103], v[28:31], v[148:151]
    ds_read_b64_tr_b16 v[94:95], v125 offset:12544
    v_mfma_f32_16x16x32_bf16 v[172:175], v[100:103], v[32:35], v[172:175]
    ds_read_b64_tr_b16 v[96:97], v124 offset:14336
    s_waitcnt lgkmcnt(8)
    v_mfma_f32_16x16x32_bf16 v[152:155], v[28:31], v[104:107], v[152:155]
    ds_read_b64_tr_b16 v[98:99], v124 offset:14592
    v_mfma_f32_16x16x32_bf16 v[176:179], v[32:35], v[104:107], v[176:179]
    ds_read_b64_tr_b16 v[100:101], v125 offset:14336
    s_add_u32 m0, s51, 51200
    s_mov_b32 s73, 516992
    buffer_load_dwordx4 v123, s[12:15], s73 offen lds
    v_mfma_f32_16x16x32_bf16 v[156:159], v[28:31], v[108:111], v[156:159]
    ds_read_b64_tr_b16 v[102:103], v125 offset:14592
    v_mfma_f32_16x16x32_bf16 v[180:183], v[32:35], v[108:111], v[180:183]
    ds_read_b64_tr_b16 v[104:105], v124 offset:16384
    v_mfma_f32_16x16x32_bf16 v[184:187], v[112:115], v[36:39], v[184:187]
    ds_read_b64_tr_b16 v[106:107], v124 offset:16640
    v_mfma_f32_16x16x32_bf16 v[188:191], v[116:119], v[36:39], v[188:191]
    ds_read_b64_tr_b16 v[108:109], v125 offset:16384
    v_mfma_f32_16x16x32_bf16 v[48:51], v[28:31], v[28:31], v[48:51]
    ds_read_b64_tr_b16 v[110:111], v125 offset:16640
    s_add_u32 m0, s51, 53248
    s_mov_b32 s73, 517888
    buffer_load_dwordx4 v123, s[12:15], s73 offen lds
    v_mfma_f32_16x16x32_bf16 v[52:55], v[32:35], v[32:35], v[52:55]
    ds_read_b64_tr_b16 v[112:113], v126 offset:12288
    v_mfma_f32_16x16x32_bf16 v[56:59], v[36:39], v[36:39], v[56:59]
    ds_read_b64_tr_b16 v[114:115], v126 offset:12544
    v_mfma_f32_16x16x32_bf16 v[60:63], v[40:43], v[28:31], v[60:63]
    ds_read_b64_tr_b16 v[116:117], v127 offset:12288
    v_mfma_f32_16x16x32_bf16 v[64:67], v[40:43], v[32:35], v[64:67]
    ds_read_b64_tr_b16 v[118:119], v127 offset:12544
    v_mfma_f32_16x16x32_bf16 v[68:71], v[40:43], v[36:39], v[68:71]
    s_add_u32 m0, s52, 55296
    s_mov_b32 s73, 384
    buffer_load_dwordx4 v120, s[8:11], s73 offen lds
    s_waitcnt lgkmcnt(8)
    v_mfma_f32_16x16x32_bf16 v[136:139], v[88:91], v[16:19], v[136:139]
    ds_read_b128 v[28:31], v129 offset:18432
    v_mfma_f32_16x16x32_bf16 v[160:163], v[88:91], v[20:23], v[160:163]
    ds_read_b128 v[32:35], v129 offset:20480
    v_mfma_f32_16x16x32_bf16 v[140:143], v[92:95], v[16:19], v[140:143]
    ds_read_b128 v[36:39], v131 offset:18432
    v_mfma_f32_16x16x32_bf16 v[164:167], v[92:95], v[20:23], v[164:167]
    ds_read_b64_tr_b16 v[88:89], v124 offset:18432
    v_mfma_f32_16x16x32_bf16 v[144:147], v[96:99], v[16:19], v[144:147]
    ds_read_b64_tr_b16 v[90:91], v124 offset:18688
    s_add_u32 m0, s52, 56320
    s_mov_b32 s73, 384
    buffer_load_dwordx4 v121, s[8:11], s73 offen lds
    v_mfma_f32_16x16x32_bf16 v[168:171], v[96:99], v[20:23], v[168:171]
    ds_read_b64_tr_b16 v[92:93], v125 offset:18432
    v_mfma_f32_16x16x32_bf16 v[148:151], v[100:103], v[16:19], v[148:151]
    ds_read_b64_tr_b16 v[94:95], v125 offset:18688
    v_mfma_f32_16x16x32_bf16 v[172:175], v[100:103], v[20:23], v[172:175]
    ds_read_b64_tr_b16 v[96:97], v124 offset:20480
    s_waitcnt lgkmcnt(8)
    v_mfma_f32_16x16x32_bf16 v[152:155], v[16:19], v[104:107], v[152:155]
    ds_read_b64_tr_b16 v[98:99], v124 offset:20736
    v_mfma_f32_16x16x32_bf16 v[176:179], v[20:23], v[104:107], v[176:179]
    ds_read_b64_tr_b16 v[100:101], v125 offset:20480
    s_add_u32 m0, s52, 57344
    s_mov_b32 s73, 14720
    buffer_load_dwordx4 v120, s[8:11], s73 offen lds
    v_mfma_f32_16x16x32_bf16 v[156:159], v[16:19], v[108:111], v[156:159]
    ds_read_b64_tr_b16 v[102:103], v125 offset:20736
    v_mfma_f32_16x16x32_bf16 v[180:183], v[20:23], v[108:111], v[180:183]
    ds_read_b64_tr_b16 v[104:105], v124 offset:22528
    v_mfma_f32_16x16x32_bf16 v[184:187], v[112:115], v[24:27], v[184:187]
    ds_read_b64_tr_b16 v[106:107], v124 offset:22784
    v_mfma_f32_16x16x32_bf16 v[188:191], v[116:119], v[24:27], v[188:191]
    ds_read_b64_tr_b16 v[108:109], v125 offset:22528
    v_mfma_f32_16x16x32_bf16 v[48:51], v[16:19], v[16:19], v[48:51]
    ds_read_b64_tr_b16 v[110:111], v125 offset:22784
    s_add_u32 m0, s52, 58368
    s_mov_b32 s73, 14720
    buffer_load_dwordx4 v121, s[8:11], s73 offen lds
    v_mfma_f32_16x16x32_bf16 v[52:55], v[20:23], v[20:23], v[52:55]
    ds_read_b64_tr_b16 v[112:113], v126 offset:18432
    v_mfma_f32_16x16x32_bf16 v[56:59], v[24:27], v[24:27], v[56:59]
    ds_read_b64_tr_b16 v[114:115], v126 offset:18688
    v_mfma_f32_16x16x32_bf16 v[60:63], v[40:43], v[16:19], v[60:63]
    ds_read_b64_tr_b16 v[116:117], v127 offset:18432
    v_mfma_f32_16x16x32_bf16 v[64:67], v[40:43], v[20:23], v[64:67]
    ds_read_b64_tr_b16 v[118:119], v127 offset:18688
    v_mfma_f32_16x16x32_bf16 v[68:71], v[40:43], v[24:27], v[68:71]
    s_add_u32 m0, s7, 116736
    s_mov_b32 s73, 384
    s_mov_b64 exec, s[54:55]
    buffer_load_dwordx4 v122, s[8:11], s73 offen lds
    s_mov_b64 exec, -1
    s_waitcnt vmcnt(8)
    s_barrier
    s_waitcnt lgkmcnt(8)
    v_mfma_f32_16x16x32_bf16 v[136:139], v[88:91], v[28:31], v[136:139]
    ds_read_b128 v[16:19], v128 offset:0
    v_mfma_f32_16x16x32_bf16 v[160:163], v[88:91], v[32:35], v[160:163]
    ds_read_b128 v[20:23], v128 offset:2048
    v_mfma_f32_16x16x32_bf16 v[140:143], v[92:95], v[28:31], v[140:143]
    ds_read_b128 v[24:27], v130 offset:0
    v_mfma_f32_16x16x32_bf16 v[164:167], v[92:95], v[32:35], v[164:167]
    ds_read_b64_tr_b16 v[88:89], v124 offset:24576
    v_mfma_f32_16x16x32_bf16 v[144:147], v[96:99], v[28:31], v[144:147]
    ds_read_b64_tr_b16 v[90:91], v124 offset:24832
    s_add_u32 m0, s51, 12288
    s_mov_b32 s73, 688128
    buffer_load_dwordx4 v123, s[12:15], s73 offen lds
    v_mfma_f32_16x16x32_bf16 v[168:171], v[96:99], v[32:35], v[168:171]
    ds_read_b64_tr_b16 v[92:93], v125 offset:24576
    v_mfma_f32_16x16x32_bf16 v[148:151], v[100:103], v[28:31], v[148:151]
    ds_read_b64_tr_b16 v[94:95], v125 offset:24832
    v_mfma_f32_16x16x32_bf16 v[172:175], v[100:103], v[32:35], v[172:175]
    ds_read_b64_tr_b16 v[96:97], v124 offset:26624
    s_waitcnt lgkmcnt(8)
    v_mfma_f32_16x16x32_bf16 v[152:155], v[28:31], v[104:107], v[152:155]
    ds_read_b64_tr_b16 v[98:99], v124 offset:26880
    v_mfma_f32_16x16x32_bf16 v[176:179], v[32:35], v[104:107], v[176:179]
    ds_read_b64_tr_b16 v[100:101], v125 offset:26624
    s_add_u32 m0, s51, 14336
    s_mov_b32 s73, 689024
    buffer_load_dwordx4 v123, s[12:15], s73 offen lds
    v_mfma_f32_16x16x32_bf16 v[156:159], v[28:31], v[108:111], v[156:159]
    ds_read_b64_tr_b16 v[102:103], v125 offset:26880
    v_mfma_f32_16x16x32_bf16 v[180:183], v[32:35], v[108:111], v[180:183]
    ds_read_b64_tr_b16 v[104:105], v124 offset:28672
    v_mfma_f32_16x16x32_bf16 v[184:187], v[112:115], v[36:39], v[184:187]
    ds_read_b64_tr_b16 v[106:107], v124 offset:28928
    v_mfma_f32_16x16x32_bf16 v[188:191], v[116:119], v[36:39], v[188:191]
    ds_read_b64_tr_b16 v[108:109], v125 offset:28672
    v_mfma_f32_16x16x32_bf16 v[48:51], v[28:31], v[28:31], v[48:51]
    ds_read_b64_tr_b16 v[110:111], v125 offset:28928
    s_add_u32 m0, s51, 16384
    s_mov_b32 s73, 689920
    buffer_load_dwordx4 v123, s[12:15], s73 offen lds
    v_mfma_f32_16x16x32_bf16 v[52:55], v[32:35], v[32:35], v[52:55]
    ds_read_b64_tr_b16 v[112:113], v126 offset:24576
    v_mfma_f32_16x16x32_bf16 v[56:59], v[36:39], v[36:39], v[56:59]
    ds_read_b64_tr_b16 v[114:115], v126 offset:24832
    v_mfma_f32_16x16x32_bf16 v[60:63], v[40:43], v[28:31], v[60:63]
    ds_read_b64_tr_b16 v[116:117], v127 offset:24576
    v_mfma_f32_16x16x32_bf16 v[64:67], v[40:43], v[32:35], v[64:67]
    ds_read_b64_tr_b16 v[118:119], v127 offset:24832
    v_mfma_f32_16x16x32_bf16 v[68:71], v[40:43], v[36:39], v[68:71]
    s_add_u32 m0, s52, 36864
    s_mov_b32 s73, 512
    buffer_load_dwordx4 v120, s[8:11], s73 offen lds
    s_waitcnt lgkmcnt(8)
    v_mfma_f32_16x16x32_bf16 v[136:139], v[88:91], v[16:19], v[136:139]
    ds_read_b128 v[28:31], v129 offset:0
    v_mfma_f32_16x16x32_bf16 v[160:163], v[88:91], v[20:23], v[160:163]
    ds_read_b128 v[32:35], v129 offset:2048
    v_mfma_f32_16x16x32_bf16 v[140:143], v[92:95], v[16:19], v[140:143]
    ds_read_b128 v[36:39], v131 offset:0
    v_mfma_f32_16x16x32_bf16 v[164:167], v[92:95], v[20:23], v[164:167]
    ds_read_b64_tr_b16 v[88:89], v124 offset:30720
    v_mfma_f32_16x16x32_bf16 v[144:147], v[96:99], v[16:19], v[144:147]
    ds_read_b64_tr_b16 v[90:91], v124 offset:30976
    s_add_u32 m0, s52, 37888
    s_mov_b32 s73, 512
    buffer_load_dwordx4 v121, s[8:11], s73 offen lds
    v_mfma_f32_16x16x32_bf16 v[168:171], v[96:99], v[20:23], v[168:171]
    ds_read_b64_tr_b16 v[92:93], v125 offset:30720
    v_mfma_f32_16x16x32_bf16 v[148:151], v[100:103], v[16:19], v[148:151]
    ds_read_b64_tr_b16 v[94:95], v125 offset:30976
    v_mfma_f32_16x16x32_bf16 v[172:175], v[100:103], v[20:23], v[172:175]
    ds_read_b64_tr_b16 v[96:97], v124 offset:32768
    s_waitcnt lgkmcnt(8)
    v_mfma_f32_16x16x32_bf16 v[152:155], v[16:19], v[104:107], v[152:155]
    ds_read_b64_tr_b16 v[98:99], v124 offset:33024
    v_mfma_f32_16x16x32_bf16 v[176:179], v[20:23], v[104:107], v[176:179]
    ds_read_b64_tr_b16 v[100:101], v125 offset:32768
    s_add_u32 m0, s52, 38912
    s_mov_b32 s73, 14848
    buffer_load_dwordx4 v120, s[8:11], s73 offen lds
    v_mfma_f32_16x16x32_bf16 v[156:159], v[16:19], v[108:111], v[156:159]
    ds_read_b64_tr_b16 v[102:103], v125 offset:33024
    v_mfma_f32_16x16x32_bf16 v[180:183], v[20:23], v[108:111], v[180:183]
    ds_read_b64_tr_b16 v[104:105], v124 offset:34816
    v_mfma_f32_16x16x32_bf16 v[184:187], v[112:115], v[24:27], v[184:187]
    ds_read_b64_tr_b16 v[106:107], v124 offset:35072
    v_mfma_f32_16x16x32_bf16 v[188:191], v[116:119], v[24:27], v[188:191]
    ds_read_b64_tr_b16 v[108:109], v125 offset:34816
    v_mfma_f32_16x16x32_bf16 v[48:51], v[16:19], v[16:19], v[48:51]
    ds_read_b64_tr_b16 v[110:111], v125 offset:35072
    s_add_u32 m0, s52, 39936
    s_mov_b32 s73, 14848
    buffer_load_dwordx4 v121, s[8:11], s73 offen lds
    v_mfma_f32_16x16x32_bf16 v[52:55], v[20:23], v[20:23], v[52:55]
    ds_read_b64_tr_b16 v[112:113], v126 offset:30720
    v_mfma_f32_16x16x32_bf16 v[56:59], v[24:27], v[24:27], v[56:59]
    ds_read_b64_tr_b16 v[114:115], v126 offset:30976
    v_mfma_f32_16x16x32_bf16 v[60:63], v[40:43], v[16:19], v[60:63]
    ds_read_b64_tr_b16 v[116:117], v127 offset:30720
    v_mfma_f32_16x16x32_bf16 v[64:67], v[40:43], v[20:23], v[64:67]
    ds_read_b64_tr_b16 v[118:119], v127 offset:30976
    v_mfma_f32_16x16x32_bf16 v[68:71], v[40:43], v[24:27], v[68:71]
    s_add_u32 m0, s7, 98304
    s_mov_b32 s73, 512
    s_mov_b64 exec, s[54:55]
    buffer_load_dwordx4 v122, s[8:11], s73 offen lds
    s_mov_b64 exec, -1
    s_waitcnt vmcnt(8)
    s_barrier
    s_waitcnt lgkmcnt(8)
    v_mfma_f32_16x16x32_bf16 v[136:139], v[88:91], v[28:31], v[136:139]
    ds_read_b128 v[16:19], v128 offset:55296
    v_mfma_f32_16x16x32_bf16 v[160:163], v[88:91], v[32:35], v[160:163]
    ds_read_b128 v[20:23], v128 offset:57344
    v_mfma_f32_16x16x32_bf16 v[140:143], v[92:95], v[28:31], v[140:143]
    ds_read_b128 v[24:27], v130 offset:55296
    v_mfma_f32_16x16x32_bf16 v[164:167], v[92:95], v[32:35], v[164:167]
    ds_read_b64_tr_b16 v[88:89], v124 offset:36864
    v_mfma_f32_16x16x32_bf16 v[144:147], v[96:99], v[28:31], v[144:147]
    ds_read_b64_tr_b16 v[90:91], v124 offset:37120
    s_add_u32 m0, s51, 24576
    s_mov_b32 s73, 860160
    buffer_load_dwordx4 v123, s[12:15], s73 offen lds
    v_mfma_f32_16x16x32_bf16 v[168:171], v[96:99], v[32:35], v[168:171]
    ds_read_b64_tr_b16 v[92:93], v125 offset:36864
    v_mfma_f32_16x16x32_bf16 v[148:151], v[100:103], v[28:31], v[148:151]
    ds_read_b64_tr_b16 v[94:95], v125 offset:37120
    v_mfma_f32_16x16x32_bf16 v[172:175], v[100:103], v[32:35], v[172:175]
    ds_read_b64_tr_b16 v[96:97], v124 offset:38912
    s_waitcnt lgkmcnt(8)
    v_mfma_f32_16x16x32_bf16 v[152:155], v[28:31], v[104:107], v[152:155]
    ds_read_b64_tr_b16 v[98:99], v124 offset:39168
    v_mfma_f32_16x16x32_bf16 v[176:179], v[32:35], v[104:107], v[176:179]
    ds_read_b64_tr_b16 v[100:101], v125 offset:38912
    s_add_u32 m0, s51, 26624
    s_mov_b32 s73, 861056
    buffer_load_dwordx4 v123, s[12:15], s73 offen lds
    v_mfma_f32_16x16x32_bf16 v[156:159], v[28:31], v[108:111], v[156:159]
    ds_read_b64_tr_b16 v[102:103], v125 offset:39168
    v_mfma_f32_16x16x32_bf16 v[180:183], v[32:35], v[108:111], v[180:183]
    ds_read_b64_tr_b16 v[104:105], v124 offset:40960
    v_mfma_f32_16x16x32_bf16 v[184:187], v[112:115], v[36:39], v[184:187]
    ds_read_b64_tr_b16 v[106:107], v124 offset:41216
    v_mfma_f32_16x16x32_bf16 v[188:191], v[116:119], v[36:39], v[188:191]
    ds_read_b64_tr_b16 v[108:109], v125 offset:40960
    v_mfma_f32_16x16x32_bf16 v[48:51], v[28:31], v[28:31], v[48:51]
    ds_read_b64_tr_b16 v[110:111], v125 offset:41216
    s_add_u32 m0, s51, 28672
    s_mov_b32 s73, 861952
    buffer_load_dwordx4 v123, s[12:15], s73 offen lds
    v_mfma_f32_16x16x32_bf16 v[52:55], v[32:35], v[32:35], v[52:55]
    ds_read_b64_tr_b16 v[112:113], v126 offset:36864
    v_mfma_f32_16x16x32_bf16 v[56:59], v[36:39], v[36:39], v[56:59]
    ds_read_b64_tr_b16 v[114:115], v126 offset:37120
    v_mfma_f32_16x16x32_bf16 v[60:63], v[40:43], v[28:31], v[60:63]
    ds_read_b64_tr_b16 v[116:117], v127 offset:36864
    v_mfma_f32_16x16x32_bf16 v[64:67], v[40:43], v[32:35], v[64:67]
    ds_read_b64_tr_b16 v[118:119], v127 offset:37120
    v_mfma_f32_16x16x32_bf16 v[68:71], v[40:43], v[36:39], v[68:71]
    s_add_u32 m0, s52, 18432
    s_mov_b32 s73, 640
    buffer_load_dwordx4 v120, s[8:11], s73 offen lds
    s_waitcnt lgkmcnt(8)
    v_mfma_f32_16x16x32_bf16 v[136:139], v[88:91], v[16:19], v[136:139]
    ds_read_b128 v[28:31], v129 offset:55296
    v_mfma_f32_16x16x32_bf16 v[160:163], v[88:91], v[20:23], v[160:163]
    ds_read_b128 v[32:35], v129 offset:57344
    v_mfma_f32_16x16x32_bf16 v[140:143], v[92:95], v[16:19], v[140:143]
    ds_read_b128 v[36:39], v131 offset:55296
    v_mfma_f32_16x16x32_bf16 v[164:167], v[92:95], v[20:23], v[164:167]
    ds_read_b64_tr_b16 v[88:89], v124 offset:43008
    v_mfma_f32_16x16x32_bf16 v[144:147], v[96:99], v[16:19], v[144:147]
    ds_read_b64_tr_b16 v[90:91], v124 offset:43264
    s_add_u32 m0, s52, 19456
    s_mov_b32 s73, 640
    buffer_load_dwordx4 v121, s[8:11], s73 offen lds
    v_mfma_f32_16x16x32_bf16 v[168:171], v[96:99], v[20:23], v[168:171]
    ds_read_b64_tr_b16 v[92:93], v125 offset:43008
    v_mfma_f32_16x16x32_bf16 v[148:151], v[100:103], v[16:19], v[148:151]
    ds_read_b64_tr_b16 v[94:95], v125 offset:43264
    v_mfma_f32_16x16x32_bf16 v[172:175], v[100:103], v[20:23], v[172:175]
    ds_read_b64_tr_b16 v[96:97], v124 offset:45056
    s_waitcnt lgkmcnt(8)
    v_mfma_f32_16x16x32_bf16 v[152:155], v[16:19], v[104:107], v[152:155]
    ds_read_b64_tr_b16 v[98:99], v124 offset:45312
    v_mfma_f32_16x16x32_bf16 v[176:179], v[20:23], v[104:107], v[176:179]
    ds_read_b64_tr_b16 v[100:101], v125 offset:45056
    s_add_u32 m0, s52, 20480
    s_mov_b32 s73, 14976
    buffer_load_dwordx4 v120, s[8:11], s73 offen lds
    v_mfma_f32_16x16x32_bf16 v[156:159], v[16:19], v[108:111], v[156:159]
    ds_read_b64_tr_b16 v[102:103], v125 offset:45312
    v_mfma_f32_16x16x32_bf16 v[180:183], v[20:23], v[108:111], v[180:183]
    ds_read_b64_tr_b16 v[104:105], v124 offset:47104
    v_mfma_f32_16x16x32_bf16 v[184:187], v[112:115], v[24:27], v[184:187]
    ds_read_b64_tr_b16 v[106:107], v124 offset:47360
    v_mfma_f32_16x16x32_bf16 v[188:191], v[116:119], v[24:27], v[188:191]
    ds_read_b64_tr_b16 v[108:109], v125 offset:47104
    v_mfma_f32_16x16x32_bf16 v[48:51], v[16:19], v[16:19], v[48:51]
    ds_read_b64_tr_b16 v[110:111], v125 offset:47360
    s_add_u32 m0, s52, 21504
    s_mov_b32 s73, 14976
    buffer_load_dwordx4 v121, s[8:11], s73 offen lds
    v_mfma_f32_16x16x32_bf16 v[52:55], v[20:23], v[20:23], v[52:55]
    ds_read_b64_tr_b16 v[112:113], v126 offset:43008
    v_mfma_f32_16x16x32_bf16 v[56:59], v[24:27], v[24:27], v[56:59]
    ds_read_b64_tr_b16 v[114:115], v126 offset:43264
    v_mfma_f32_16x16x32_bf16 v[60:63], v[40:43], v[16:19], v[60:63]
    ds_read_b64_tr_b16 v[116:117], v127 offset:43008
    v_mfma_f32_16x16x32_bf16 v[64:67], v[40:43], v[20:23], v[64:67]
    ds_read_b64_tr_b16 v[118:119], v127 offset:43264
    v_mfma_f32_16x16x32_bf16 v[68:71], v[40:43], v[24:27], v[68:71]
    s_add_u32 m0, s7, 79872
    s_mov_b32 s73, 640
    s_mov_b64 exec, s[54:55]
    buffer_load_dwordx4 v122, s[8:11], s73 offen lds
    s_mov_b64 exec, -1
    s_waitcnt vmcnt(8)
    s_barrier
    s_waitcnt lgkmcnt(8)
    v_mfma_f32_16x16x32_bf16 v[136:139], v[88:91], v[28:31], v[136:139]
    ds_read_b128 v[16:19], v128 offset:36864
    v_mfma_f32_16x16x32_bf16 v[160:163], v[88:91], v[32:35], v[160:163]
    ds_read_b128 v[20:23], v128 offset:38912
    v_mfma_f32_16x16x32_bf16 v[140:143], v[92:95], v[28:31], v[140:143]
    ds_read_b128 v[24:27], v130 offset:36864
    v_mfma_f32_16x16x32_bf16 v[164:167], v[92:95], v[32:35], v[164:167]
    ds_read_b64_tr_b16 v[88:89], v124 offset:0
    v_mfma_f32_16x16x32_bf16 v[144:147], v[96:99], v[28:31], v[144:147]
    ds_read_b64_tr_b16 v[90:91], v124 offset:256
    s_add_u32 m0, s51, 36864
    s_mov_b32 s73, 1032192
    buffer_load_dwordx4 v123, s[12:15], s73 offen lds
    v_mfma_f32_16x16x32_bf16 v[168:171], v[96:99], v[32:35], v[168:171]
    ds_read_b64_tr_b16 v[92:93], v125 offset:0
    v_mfma_f32_16x16x32_bf16 v[148:151], v[100:103], v[28:31], v[148:151]
    ds_read_b64_tr_b16 v[94:95], v125 offset:256
    v_mfma_f32_16x16x32_bf16 v[172:175], v[100:103], v[32:35], v[172:175]
    ds_read_b64_tr_b16 v[96:97], v124 offset:2048
    s_waitcnt lgkmcnt(8)
    v_mfma_f32_16x16x32_bf16 v[152:155], v[28:31], v[104:107], v[152:155]
    ds_read_b64_tr_b16 v[98:99], v124 offset:2304
    v_mfma_f32_16x16x32_bf16 v[176:179], v[32:35], v[104:107], v[176:179]
    ds_read_b64_tr_b16 v[100:101], v125 offset:2048
    s_add_u32 m0, s51, 38912
    s_mov_b32 s73, 1033088
    buffer_load_dwordx4 v123, s[12:15], s73 offen lds
    v_mfma_f32_16x16x32_bf16 v[156:159], v[28:31], v[108:111], v[156:159]
    ds_read_b64_tr_b16 v[102:103], v125 offset:2304
    v_mfma_f32_16x16x32_bf16 v[180:183], v[32:35], v[108:111], v[180:183]
    ds_read_b64_tr_b16 v[104:105], v124 offset:4096
    v_mfma_f32_16x16x32_bf16 v[184:187], v[112:115], v[36:39], v[184:187]
    ds_read_b64_tr_b16 v[106:107], v124 offset:4352
    v_mfma_f32_16x16x32_bf16 v[188:191], v[116:119], v[36:39], v[188:191]
    ds_read_b64_tr_b16 v[108:109], v125 offset:4096
    v_mfma_f32_16x16x32_bf16 v[48:51], v[28:31], v[28:31], v[48:51]
    ds_read_b64_tr_b16 v[110:111], v125 offset:4352
    s_add_u32 m0, s51, 40960
    s_mov_b32 s73, 1033984
    buffer_load_dwordx4 v123, s[12:15], s73 offen lds
    v_mfma_f32_16x16x32_bf16 v[52:55], v[32:35], v[32:35], v[52:55]
    ds_read_b64_tr_b16 v[112:113], v126 offset:0
    v_mfma_f32_16x16x32_bf16 v[56:59], v[36:39], v[36:39], v[56:59]
    ds_read_b64_tr_b16 v[114:115], v126 offset:256
    v_mfma_f32_16x16x32_bf16 v[60:63], v[40:43], v[28:31], v[60:63]
    ds_read_b64_tr_b16 v[116:117], v127 offset:0
    v_mfma_f32_16x16x32_bf16 v[64:67], v[40:43], v[32:35], v[64:67]
    ds_read_b64_tr_b16 v[118:119], v127 offset:256
    v_mfma_f32_16x16x32_bf16 v[68:71], v[40:43], v[36:39], v[68:71]
    s_add_u32 m0, s52, 0
    s_mov_b32 s73, 768
    buffer_load_dwordx4 v120, s[8:11], s73 offen lds
    s_waitcnt lgkmcnt(8)
    v_mfma_f32_16x16x32_bf16 v[136:139], v[88:91], v[16:19], v[136:139]
    ds_read_b128 v[28:31], v129 offset:36864
    v_mfma_f32_16x16x32_bf16 v[160:163], v[88:91], v[20:23], v[160:163]
    ds_read_b128 v[32:35], v129 offset:38912
    v_mfma_f32_16x16x32_bf16 v[140:143], v[92:95], v[16:19], v[140:143]
    ds_read_b128 v[36:39], v131 offset:36864
    v_mfma_f32_16x16x32_bf16 v[164:167], v[92:95], v[20:23], v[164:167]
    ds_read_b64_tr_b16 v[88:89], v124 offset:6144
    v_mfma_f32_16x16x32_bf16 v[144:147], v[96:99], v[16:19], v[144:147]
    ds_read_b64_tr_b16 v[90:91], v124 offset:6400
    s_add_u32 m0, s52, 1024
    s_mov_b32 s73, 768
    buffer_load_dwordx4 v121, s[8:11], s73 offen lds
    v_mfma_f32_16x16x32_bf16 v[168:171], v[96:99], v[20:23], v[168:171]
    ds_read_b64_tr_b16 v[92:93], v125 offset:6144
    v_mfma_f32_16x16x32_bf16 v[148:151], v[100:103], v[16:19], v[148:151]
    ds_read_b64_tr_b16 v[94:95], v125 offset:6400
    v_mfma_f32_16x16x32_bf16 v[172:175], v[100:103], v[20:23], v[172:175]
    ds_read_b64_tr_b16 v[96:97], v124 offset:8192
    s_waitcnt lgkmcnt(8)
    v_mfma_f32_16x16x32_bf16 v[152:155], v[16:19], v[104:107], v[152:155]
    ds_read_b64_tr_b16 v[98:99], v124 offset:8448
    v_mfma_f32_16x16x32_bf16 v[176:179], v[20:23], v[104:107], v[176:179]
    ds_read_b64_tr_b16 v[100:101], v125 offset:8192
    s_add_u32 m0, s52, 2048
    s_mov_b32 s73, 15104
    buffer_load_dwordx4 v120, s[8:11], s73 offen lds
    v_mfma_f32_16x16x32_bf16 v[156:159], v[16:19], v[108:111], v[156:159]
    ds_read_b64_tr_b16 v[102:103], v125 offset:8448
    v_mfma_f32_16x16x32_bf16 v[180:183], v[20:23], v[108:111], v[180:183]
    ds_read_b64_tr_b16 v[104:105], v124 offset:10240
    v_mfma_f32_16x16x32_bf16 v[184:187], v[112:115], v[24:27], v[184:187]
    ds_read_b64_tr_b16 v[106:107], v124 offset:10496
    v_mfma_f32_16x16x32_bf16 v[188:191], v[116:119], v[24:27], v[188:191]
    ds_read_b64_tr_b16 v[108:109], v125 offset:10240
    v_mfma_f32_16x16x32_bf16 v[48:51], v[16:19], v[16:19], v[48:51]
    ds_read_b64_tr_b16 v[110:111], v125 offset:10496
    s_add_u32 m0, s52, 3072
    s_mov_b32 s73, 15104
    buffer_load_dwordx4 v121, s[8:11], s73 offen lds
    v_mfma_f32_16x16x32_bf16 v[52:55], v[20:23], v[20:23], v[52:55]
    ds_read_b64_tr_b16 v[112:113], v126 offset:6144
    v_mfma_f32_16x16x32_bf16 v[56:59], v[24:27], v[24:27], v[56:59]
    ds_read_b64_tr_b16 v[114:115], v126 offset:6400
    v_mfma_f32_16x16x32_bf16 v[60:63], v[40:43], v[16:19], v[60:63]
    ds_read_b64_tr_b16 v[116:117], v127 offset:6144
    v_mfma_f32_16x16x32_bf16 v[64:67], v[40:43], v[20:23], v[64:67]
    ds_read_b64_tr_b16 v[118:119], v127 offset:6400
    v_mfma_f32_16x16x32_bf16 v[68:71], v[40:43], v[24:27], v[68:71]
    s_add_u32 m0, s7, 61440
    s_mov_b32 s73, 768
    s_mov_b64 exec, s[54:55]
    buffer_load_dwordx4 v122, s[8:11], s73 offen lds
    s_mov_b64 exec, -1
    v_mov_b32 v7, 0
    buffer_load_dword v6, v7, s[44:47], 0 offen sc1
    s_lshr_b32 s68, s2, 3
    s_lshl_b32 s68, s68, 2
    s_add_u32 s68, s68, s3
    v_lshlrev_b32 v219, 7, v1
    s_mul_i32 s86, s68, 3200
    s_mov_b64 exec, 0x1ffffff
    buffer_load_dword v234, v219, s[16:19], s86 offen
    s_mov_b64 exec, -1
    v_lshrrev_b32 v219, 2, v1
    v_mul_u32_u24 v219, 3584, v219
    v_and_b32 v220, 3, v1
    v_lshl_add_u32 v219, v220, 7, v219
    s_mul_i32 s68, s68, 57344
    s_and_b32 s69, s2, 7
    s_mul_i32 s86, s69, 3
    s_add_u32 s86, s86, 4
    s_lshl_b32 s87, s69, 2
    s_min_u32 s86, s86, s87
    s_lshl_b32 s86, s86, 7
    s_add_u32 s86, s86, s68
    s_cmp_lt_u32 s69, 4
    s_cselect_b32 exec_lo, -1, 0x77777777
    s_cselect_b32 exec_hi, -1, 0x77777777
    buffer_load_dword v235, v219, s[20:23], s86 offen
    s_mov_b64 exec, -1
    s_waitcnt vmcnt(11)
    s_barrier
    s_waitcnt lgkmcnt(8)
    v_mfma_f32_16x16x32_bf16 v[136:139], v[88:91], v[28:31], v[136:139]
    ds_read_b128 v[16:19], v128 offset:18432
    v_mfma_f32_16x16x32_bf16 v[160:163], v[88:91], v[32:35], v[160:163]
    ds_read_b128 v[20:23], v128 offset:20480
    v_mfma_f32_16x16x32_bf16 v[140:143], v[92:95], v[28:31], v[140:143]
    ds_read_b128 v[24:27], v130 offset:18432
    v_mfma_f32_16x16x32_bf16 v[164:167], v[92:95], v[32:35], v[164:167]
    ds_read_b64_tr_b16 v[88:89], v124 offset:12288
    v_mfma_f32_16x16x32_bf16 v[144:147], v[96:99], v[28:31], v[144:147]
    ds_read_b64_tr_b16 v[90:91], v124 offset:12544
    v_mfma_f32_16x16x32_bf16 v[168:171], v[96:99], v[32:35], v[168:171]
    ds_read_b64_tr_b16 v[92:93], v125 offset:12288
    v_mfma_f32_16x16x32_bf16 v[148:151], v[100:103], v[28:31], v[148:151]
    ds_read_b64_tr_b16 v[94:95], v125 offset:12544
    v_mfma_f32_16x16x32_bf16 v[172:175], v[100:103], v[32:35], v[172:175]
    ds_read_b64_tr_b16 v[96:97], v124 offset:14336
    s_waitcnt lgkmcnt(8)
    v_mfma_f32_16x16x32_bf16 v[152:155], v[28:31], v[104:107], v[152:155]
    ds_read_b64_tr_b16 v[98:99], v124 offset:14592
    v_mfma_f32_16x16x32_bf16 v[176:179], v[32:35], v[104:107], v[176:179]
    ds_read_b64_tr_b16 v[100:101], v125 offset:14336
    v_mfma_f32_16x16x32_bf16 v[156:159], v[28:31], v[108:111], v[156:159]
    ds_read_b64_tr_b16 v[102:103], v125 offset:14592
    v_mfma_f32_16x16x32_bf16 v[180:183], v[32:35], v[108:111], v[180:183]
    ds_read_b64_tr_b16 v[104:105], v124 offset:16384
    v_mfma_f32_16x16x32_bf16 v[184:187], v[112:115], v[36:39], v[184:187]
    ds_read_b64_tr_b16 v[106:107], v124 offset:16640
    v_mfma_f32_16x16x32_bf16 v[188:191], v[116:119], v[36:39], v[188:191]
    ds_read_b64_tr_b16 v[108:109], v125 offset:16384
    v_mfma_f32_16x16x32_bf16 v[48:51], v[28:31], v[28:31], v[48:51]
    ds_read_b64_tr_b16 v[110:111], v125 offset:16640
    v_mfma_f32_16x16x32_bf16 v[52:55], v[32:35], v[32:35], v[52:55]
    ds_read_b64_tr_b16 v[112:113], v126 offset:12288
    v_mfma_f32_16x16x32_bf16 v[56:59], v[36:39], v[36:39], v[56:59]
    ds_read_b64_tr_b16 v[114:115], v126 offset:12544
    v_mfma_f32_16x16x32_bf16 v[60:63], v[40:43], v[28:31], v[60:63]
    ds_read_b64_tr_b16 v[116:117], v127 offset:12288
    v_mfma_f32_16x16x32_bf16 v[64:67], v[40:43], v[32:35], v[64:67]
    ds_read_b64_tr_b16 v[118:119], v127 offset:12544
    v_mfma_f32_16x16x32_bf16 v[68:71], v[40:43], v[36:39], v[68:71]
    s_waitcnt lgkmcnt(8)
    v_mfma_f32_16x16x32_bf16 v[136:139], v[88:91], v[16:19], v[136:139]
    ds_read_b128 v[28:31], v129 offset:18432
    v_mfma_f32_16x16x32_bf16 v[160:163], v[88:91], v[20:23], v[160:163]
    ds_read_b128 v[32:35], v129 offset:20480
    v_mfma_f32_16x16x32_bf16 v[140:143], v[92:95], v[16:19], v[140:143]
    ds_read_b128 v[36:39], v131 offset:18432
    v_mfma_f32_16x16x32_bf16 v[164:167], v[92:95], v[20:23], v[164:167]
    ds_read_b64_tr_b16 v[88:89], v124 offset:18432
    v_mfma_f32_16x16x32_bf16 v[144:147], v[96:99], v[16:19], v[144:147]
    ds_read_b64_tr_b16 v[90:91], v124 offset:18688
    v_mfma_f32_16x16x32_bf16 v[168:171], v[96:99], v[20:23], v[168:171]
    ds_read_b64_tr_b16 v[92:93], v125 offset:18432
    v_mfma_f32_16x16x32_bf16 v[148:151], v[100:103], v[16:19], v[148:151]
    ds_read_b64_tr_b16 v[94:95], v125 offset:18688
    v_mfma_f32_16x16x32_bf16 v[172:175], v[100:103], v[20:23], v[172:175]
    ds_read_b64_tr_b16 v[96:97], v124 offset:20480
    s_waitcnt lgkmcnt(8)
    v_mfma_f32_16x16x32_bf16 v[152:155], v[16:19], v[104:107], v[152:155]
    ds_read_b64_tr_b16 v[98:99], v124 offset:20736
    v_mfma_f32_16x16x32_bf16 v[176:179], v[20:23], v[104:107], v[176:179]
    ds_read_b64_tr_b16 v[100:101], v125 offset:20480
    v_mfma_f32_16x16x32_bf16 v[156:159], v[16:19], v[108:111], v[156:159]
    ds_read_b64_tr_b16 v[102:103], v125 offset:20736
    v_mfma_f32_16x16x32_bf16 v[180:183], v[20:23], v[108:111], v[180:183]
    ds_read_b64_tr_b16 v[104:105], v124 offset:22528
    v_mfma_f32_16x16x32_bf16 v[184:187], v[112:115], v[24:27], v[184:187]
    ds_read_b64_tr_b16 v[106:107], v124 offset:22784
    v_mfma_f32_16x16x32_bf16 v[188:191], v[116:119], v[24:27], v[188:191]
    ds_read_b64_tr_b16 v[108:109], v125 offset:22528
    v_mfma_f32_16x16x32_bf16 v[48:51], v[16:19], v[16:19], v[48:51]
    ds_read_b64_tr_b16 v[110:111], v125 offset:22784
    v_mfma_f32_16x16x32_bf16 v[52:55], v[20:23], v[20:23], v[52:55]
    ds_read_b64_tr_b16 v[112:113], v126 offset:18432
    v_mfma_f32_16x16x32_bf16 v[56:59], v[24:27], v[24:27], v[56:59]
    ds_read_b64_tr_b16 v[114:115], v126 offset:18688
    v_mfma_f32_16x16x32_bf16 v[60:63], v[40:43], v[16:19], v[60:63]
    ds_read_b64_tr_b16 v[116:117], v127 offset:18432
    v_mfma_f32_16x16x32_bf16 v[64:67], v[40:43], v[20:23], v[64:67]
    ds_read_b64_tr_b16 v[118:119], v127 offset:18688
    v_mfma_f32_16x16x32_bf16 v[68:71], v[40:43], v[24:27], v[68:71]
    s_waitcnt vmcnt(3)
    s_barrier
    s_waitcnt lgkmcnt(8)
    v_mfma_f32_16x16x32_bf16 v[136:139], v[88:91], v[28:31], v[136:139]
    ds_read_b128 v[16:19], v128 offset:0
    v_mfma_f32_16x16x32_bf16 v[160:163], v[88:91], v[32:35], v[160:163]
    ds_read_b128 v[20:23], v128 offset:2048
    v_mfma_f32_16x16x32_bf16 v[140:143], v[92:95], v[28:31], v[140:143]
    ds_read_b128 v[24:27], v130 offset:0
    v_mfma_f32_16x16x32_bf16 v[164:167], v[92:95], v[32:35], v[164:167]
    ds_read_b64_tr_b16 v[88:89], v124 offset:24576
    v_mfma_f32_16x16x32_bf16 v[144:147], v[96:99], v[28:31], v[144:147]
    ds_read_b64_tr_b16 v[90:91], v124 offset:24832
    v_mfma_f32_16x16x32_bf16 v[168:171], v[96:99], v[32:35], v[168:171]
    ds_read_b64_tr_b16 v[92:93], v125 offset:24576
    v_mfma_f32_16x16x32_bf16 v[148:151], v[100:103], v[28:31], v[148:151]
    ds_read_b64_tr_b16 v[94:95], v125 offset:24832
    v_mfma_f32_16x16x32_bf16 v[172:175], v[100:103], v[32:35], v[172:175]
    ds_read_b64_tr_b16 v[96:97], v124 offset:26624
    s_waitcnt lgkmcnt(8)
    v_mfma_f32_16x16x32_bf16 v[152:155], v[28:31], v[104:107], v[152:155]
    ds_read_b64_tr_b16 v[98:99], v124 offset:26880
    v_mfma_f32_16x16x32_bf16 v[176:179], v[32:35], v[104:107], v[176:179]
    ds_read_b64_tr_b16 v[100:101], v125 offset:26624
    v_mfma_f32_16x16x32_bf16 v[156:159], v[28:31], v[108:111], v[156:159]
    ds_read_b64_tr_b16 v[102:103], v125 offset:26880
    v_mfma_f32_16x16x32_bf16 v[180:183], v[32:35], v[108:111], v[180:183]
    ds_read_b64_tr_b16 v[104:105], v124 offset:28672
    v_mfma_f32_16x16x32_bf16 v[184:187], v[112:115], v[36:39], v[184:187]
    ds_read_b64_tr_b16 v[106:107], v124 offset:28928
    v_mfma_f32_16x16x32_bf16 v[188:191], v[116:119], v[36:39], v[188:191]
    ds_read_b64_tr_b16 v[108:109], v125 offset:28672
    v_mfma_f32_16x16x32_bf16 v[48:51], v[28:31], v[28:31], v[48:51]
    ds_read_b64_tr_b16 v[110:111], v125 offset:28928
    v_mfma_f32_16x16x32_bf16 v[52:55], v[32:35], v[32:35], v[52:55]
    ds_read_b64_tr_b16 v[112:113], v126 offset:24576
    v_mfma_f32_16x16x32_bf16 v[56:59], v[36:39], v[36:39], v[56:59]
    ds_read_b64_tr_b16 v[114:115], v126 offset:24832
    v_mfma_f32_16x16x32_bf16 v[60:63], v[40:43], v[28:31], v[60:63]
    ds_read_b64_tr_b16 v[116:117], v127 offset:24576
    v_mfma_f32_16x16x32_bf16 v[64:67], v[40:43], v[32:35], v[64:67]
    ds_read_b64_tr_b16 v[118:119], v127 offset:24832
    v_mfma_f32_16x16x32_bf16 v[68:71], v[40:43], v[36:39], v[68:71]
    s_waitcnt lgkmcnt(8)
    v_mfma_f32_16x16x32_bf16 v[136:139], v[88:91], v[16:19], v[136:139]
    ds_read_b128 v[28:31], v129 offset:0
    v_mfma_f32_16x16x32_bf16 v[160:163], v[88:91], v[20:23], v[160:163]
    ds_read_b128 v[32:35], v129 offset:2048
    v_mfma_f32_16x16x32_bf16 v[140:143], v[92:95], v[16:19], v[140:143]
    ds_read_b128 v[36:39], v131 offset:0
    v_mfma_f32_16x16x32_bf16 v[164:167], v[92:95], v[20:23], v[164:167]
    ds_read_b64_tr_b16 v[88:89], v124 offset:30720
    v_mfma_f32_16x16x32_bf16 v[144:147], v[96:99], v[16:19], v[144:147]
    ds_read_b64_tr_b16 v[90:91], v124 offset:30976
    v_mfma_f32_16x16x32_bf16 v[168:171], v[96:99], v[20:23], v[168:171]
    ds_read_b64_tr_b16 v[92:93], v125 offset:30720
    v_mfma_f32_16x16x32_bf16 v[148:151], v[100:103], v[16:19], v[148:151]
    ds_read_b64_tr_b16 v[94:95], v125 offset:30976
    v_mfma_f32_16x16x32_bf16 v[172:175], v[100:103], v[20:23], v[172:175]
    ds_read_b64_tr_b16 v[96:97], v124 offset:32768
    s_waitcnt lgkmcnt(8)
    v_mfma_f32_16x16x32_bf16 v[152:155], v[16:19], v[104:107], v[152:155]
    ds_read_b64_tr_b16 v[98:99], v124 offset:33024
    v_mfma_f32_16x16x32_bf16 v[176:179], v[20:23], v[104:107], v[176:179]
    ds_read_b64_tr_b16 v[100:101], v125 offset:32768
    v_mfma_f32_16x16x32_bf16 v[156:159], v[16:19], v[108:111], v[156:159]
    ds_read_b64_tr_b16 v[102:103], v125 offset:33024
    v_mfma_f32_16x16x32_bf16 v[180:183], v[20:23], v[108:111], v[180:183]
    ds_read_b64_tr_b16 v[104:105], v124 offset:34816
    v_mfma_f32_16x16x32_bf16 v[184:187], v[112:115], v[24:27], v[184:187]
    ds_read_b64_tr_b16 v[106:107], v124 offset:35072
    v_mfma_f32_16x16x32_bf16 v[188:191], v[116:119], v[24:27], v[188:191]
    ds_read_b64_tr_b16 v[108:109], v125 offset:34816
    v_mfma_f32_16x16x32_bf16 v[48:51], v[16:19], v[16:19], v[48:51]
    ds_read_b64_tr_b16 v[110:111], v125 offset:35072
    v_mfma_f32_16x16x32_bf16 v[52:55], v[20:23], v[20:23], v[52:55]
    ds_read_b64_tr_b16 v[112:113], v126 offset:30720
    v_mfma_f32_16x16x32_bf16 v[56:59], v[24:27], v[24:27], v[56:59]
    ds_read_b64_tr_b16 v[114:115], v126 offset:30976
    v_mfma_f32_16x16x32_bf16 v[60:63], v[40:43], v[16:19], v[60:63]
    ds_read_b64_tr_b16 v[116:117], v127 offset:30720
    v_mfma_f32_16x16x32_bf16 v[64:67], v[40:43], v[20:23], v[64:67]
    ds_read_b64_tr_b16 v[118:119], v127 offset:30976
    v_mfma_f32_16x16x32_bf16 v[68:71], v[40:43], v[24:27], v[68:71]
    s_waitcnt lgkmcnt(9)
    v_mfma_f32_16x16x32_bf16 v[48:51], v[28:31], v[28:31], v[48:51]
    v_mfma_f32_16x16x32_bf16 v[52:55], v[32:35], v[32:35], v[52:55]
    v_mfma_f32_16x16x32_bf16 v[56:59], v[36:39], v[36:39], v[56:59]
    v_mfma_f32_16x16x32_bf16 v[60:63], v[40:43], v[28:31], v[60:63]
    v_mfma_f32_16x16x32_bf16 v[64:67], v[40:43], v[32:35], v[64:67]
    v_mfma_f32_16x16x32_bf16 v[68:71], v[40:43], v[36:39], v[68:71]
    s_waitcnt lgkmcnt(2)
    v_mfma_f32_16x16x32_bf16 v[184:187], v[112:115], v[36:39], v[184:187]
    s_waitcnt lgkmcnt(0)
    v_mfma_f32_16x16x32_bf16 v[188:191], v[116:119], v[36:39], v[188:191]
    v_mfma_f32_16x16x32_bf16 v[144:147], v[96:99], v[28:31], v[144:147]
    v_cndmask_b32 v48, v48, v49, s[88:89]
    v_cndmask_b32 v52, v52, v53, s[88:89]
    v_cndmask_b32 v56, v56, v57, s[88:89]
    v_mfma_f32_16x16x32_bf16 v[168:171], v[96:99], v[32:35], v[168:171]
    v_cndmask_b32 v48, v48, v50, s[90:91]
    v_cndmask_b32 v52, v52, v54, s[90:91]
    v_cndmask_b32 v56, v56, v58, s[90:91]
    v_mfma_f32_16x16x32_bf16 v[148:151], v[100:103], v[28:31], v[148:151]
    v_cndmask_b32 v48, v48, v51, s[92:93]
    v_cndmask_b32 v52, v52, v55, s[92:93]
    v_cndmask_b32 v56, v56, v59, s[92:93]
    v_mfma_f32_16x16x32_bf16 v[172:175], v[100:103], v[32:35], v[172:175]
    v_mul_f32 v133, 0x3b124925, v60
    v_mul_f32 v135, 0x3b124925, v64
    v_mul_f32 v85, 0x3b124925, v68
    v_mfma_f32_16x16x32_bf16 v[152:155], v[28:31], v[104:107], v[152:155]
    v_mul_f32 v132, v133, v133
    v_mul_f32 v134, v135, v135
    v_mul_f32 v84, v85, v85
    v_mfma_f32_16x16x32_bf16 v[176:179], v[32:35], v[104:107], v[176:179]
    v_mul_f32 v48, 0x3b124925, v48
    v_mul_f32 v52, 0x3b124925, v52
    v_mul_f32 v56, 0x3b124925, v56
    v_mfma_f32_16x16x32_bf16 v[156:159], v[28:31], v[108:111], v[156:159]
    s_mov_b32 exec_lo, 0x00010001
    s_mov_b32 exec_hi, 0x00010001
    ds_write_b128 v73, v[184:187] offset:128
    ds_write_b128 v74, v[188:191] offset:0
    s_mov_b64 exec, -1
    v_sub_f32 v132, v48, v132
    v_sub_f32 v134, v52, v134
    v_mfma_f32_16x16x32_bf16 v[180:183], v[32:35], v[108:111], v[180:183]
    v_sub_f32 v84, v56, v84
    v_max_f32 v132, 0, v132
    v_max_f32 v134, 0, v134
    v_mfma_f32_16x16x32_bf16 v[136:139], v[88:91], v[28:31], v[136:139]
    v_max_f32 v84, 0, v84
    v_add_f32 v132, 0x3727c5ac, v132
    v_add_f32 v134, 0x3727c5ac, v134
    v_mfma_f32_16x16x32_bf16 v[160:163], v[88:91], v[32:35], v[160:163]
    v_add_f32 v84, 0x3727c5ac, v84
    v_rsq_f32 v132, v132
    v_rsq_f32 v134, v134
    v_mfma_f32_16x16x32_bf16 v[140:143], v[92:95], v[28:31], v[140:143]
    v_rsq_f32 v84, v84
    s_mov_b32 exec_lo, 0x00f0000f
    s_mov_b32 exec_hi, 0xf0000f00
    ds_write2_b32 v75, v132, v133 offset0:128 offset1:144
    ds_write2_b32 v75, v134, v135 offset0:160 offset1:176
    ds_write2_b32 v75, v84, v85 offset0:192 offset1:208
    s_mov_b64 exec, -1
    v_mov_b32_dpp v224, v184 row_newbcast:0 row_mask:0xf bank_mask:0xf
    v_mfma_f32_16x16x32_bf16 v[164:167], v[92:95], v[32:35], v[164:167]
    v_mov_b32_dpp v225, v185 row_newbcast:0 row_mask:0xf bank_mask:0xf
    v_mov_b32_dpp v226, v186 row_newbcast:0 row_mask:0xf bank_mask:0xf
    v_mov_b32_dpp v227, v187 row_newbcast:0 row_mask:0xf bank_mask:0xf
    v_fma_f32 v224, -v224, v85, v184
    v_fma_f32 v225, -v225, v85, v185
    v_fma_f32 v226, -v226, v85, v186
    v_fma_f32 v227, -v227, v85, v187
    s_cmp_eq_u32 s49, 15
    s_cselect_b32 s88, 0xffff0000, -1
    s_mov_b32 s89, -1
    s_mov_b32 s90, -1
    s_cselect_b32 s91, -1, 0xffff
    s_waitcnt lgkmcnt(0)
    s_barrier
    ds_read_b32 v134, v75 offset:640
    ds_read_b32 v84, v75 offset:768
    ds_read_b32 v132, v75 offset:512
    ds_read_b128 v[56:59], v72 offset:128
    ds_read_b128 v[60:63], v72 offset:192
    ds_read_b32 v64, v77 offset:256
    ds_read_b32 v65, v77 offset:320
    ds_read_b128 v[44:47], v76 offset:704
    ds_read_b128 v[40:43], v76 offset:640
    ds_read_b128 v[36:39], v76 offset:576
    ds_read_b128 v[32:35], v76 offset:512
    ds_read_b128 v[48:51], v72 offset:0
    ds_read_b128 v[52:55], v72 offset:64
    s_waitcnt lgkmcnt(9)
    v_pk_fma_f32 v[168:169], v[56:57], v[134:135], v[168:169] op_sel:[0,1,0] op_sel_hi:[1,1,1] neg_lo:[0,1,0] neg_hi:[0,1,0]
    v_pk_fma_f32 v[170:171], v[58:59], v[134:135], v[170:171] op_sel:[0,1,0] op_sel_hi:[1,1,1] neg_lo:[0,1,0] neg_hi:[0,1,0]
    v_pk_mul_f32 v[168:169], v[168:169], v[134:135] op_sel:[0,0] op_sel_hi:[1,0]
    v_pk_mul_f32 v[170:171], v[170:171], v[134:135] op_sel:[0,0] op_sel_hi:[1,0]
    v_cvt_pk_bf16_f32 v104, v168, v169
    v_cvt_pk_bf16_f32 v105, v170, v171
    s_waitcnt lgkmcnt(8)
    v_pk_fma_f32 v[172:173], v[60:61], v[134:135], v[172:173] op_sel:[0,1,0] op_sel_hi:[1,1,1] neg_lo:[0,1,0] neg_hi:[0,1,0]
    v_pk_fma_f32 v[174:175], v[62:63], v[134:135], v[174:175] op_sel:[0,1,0] op_sel_hi:[1,1,1] neg_lo:[0,1,0] neg_hi:[0,1,0]
    v_pk_mul_f32 v[172:173], v[172:173], v[134:135] op_sel:[0,0] op_sel_hi:[1,0]
    v_pk_mul_f32 v[174:175], v[174:175], v[134:135] op_sel:[0,0] op_sel_hi:[1,0]
    v_cvt_pk_bf16_f32 v106, v172, v173
    v_cvt_pk_bf16_f32 v107, v174, v175
    ds_write_b128 v78, v[104:107] offset:4096
    v_pk_mul_f32 v[224:225], v[224:225], v[84:85] op_sel_hi:[1,0]
    v_pk_mul_f32 v[226:227], v[226:227], v[84:85] op_sel_hi:[1,0]
    v_cvt_pk_bf16_f32 v224, v224, v225
    v_cvt_pk_bf16_f32 v226, v226, v227
    ds_write_b16 v80, v224 offset:2048
    ds_write_b16_d16_hi v81, v224 offset:2048
    ds_write_b16 v82, v226 offset:2048
    ds_write_b16_d16_hi v83, v226 offset:2048
    s_waitcnt lgkmcnt(10)
    v_pk_fma_f32 v[176:177], v[44:45], v[64:65], v[176:177] op_sel:[0,0,0] op_sel_hi:[1,0,1] neg_lo:[0,1,0] neg_hi:[0,1,0]
    v_pk_fma_f32 v[178:179], v[46:47], v[64:65], v[178:179] op_sel:[0,0,0] op_sel_hi:[1,0,1] neg_lo:[0,1,0] neg_hi:[0,1,0]
    s_waitcnt lgkmcnt(9)
    v_pk_mul_f32 v[176:177], v[176:177], v[40:41]
    v_pk_mul_f32 v[178:179], v[178:179], v[42:43]
    v_cvt_pk_bf16_f32 v112, v176, v177
    v_cvt_pk_bf16_f32 v113, v178, v179
    v_pk_fma_f32 v[180:181], v[44:45], v[64:65], v[180:181] op_sel:[0,1,0] op_sel_hi:[1,1,1] neg_lo:[0,1,0] neg_hi:[0,1,0]
    v_pk_fma_f32 v[182:183], v[46:47], v[64:65], v[182:183] op_sel:[0,1,0] op_sel_hi:[1,1,1] neg_lo:[0,1,0] neg_hi:[0,1,0]
    v_pk_mul_f32 v[180:181], v[180:181], v[40:41]
    v_pk_mul_f32 v[182:183], v[182:183], v[42:43]
    v_cvt_pk_bf16_f32 v118, v180, v181
    v_cvt_pk_bf16_f32 v119, v182, v183
    ds_write_b64 v78, v[112:113] offset:5120
    ds_write_b64 v78, v[118:119] offset:5128
    v_mul_f32 v68, 0x3e8b97f6, v132
    v_mul_f32 v70, 0x3e8b97f6, v134
    v_cndmask_b32 v69, 0, v68, s[90:91]
    v_cndmask_b32 v68, 0, v68, s[88:89]
    v_cndmask_b32 v71, 0, v70, s[90:91]
    v_cndmask_b32 v70, 0, v70, s[88:89]
    v_pk_fma_f32 v[144:145], v[56:57], v[132:133], v[144:145] op_sel:[0,1,0] op_sel_hi:[1,1,1] neg_lo:[0,1,0] neg_hi:[0,1,0]
    v_pk_fma_f32 v[146:147], v[58:59], v[132:133], v[146:147] op_sel:[0,1,0] op_sel_hi:[1,1,1] neg_lo:[0,1,0] neg_hi:[0,1,0]
    v_pk_mul_f32 v[144:145], v[144:145], v[132:133] op_sel:[0,0] op_sel_hi:[1,0]
    v_pk_mul_f32 v[146:147], v[146:147], v[132:133] op_sel:[0,0] op_sel_hi:[1,0]
    v_cvt_pk_bf16_f32 v100, v144, v145
    v_cvt_pk_bf16_f32 v101, v146, v147
    v_pk_fma_f32 v[148:149], v[60:61], v[132:133], v[148:149] op_sel:[0,1,0] op_sel_hi:[1,1,1] neg_lo:[0,1,0] neg_hi:[0,1,0]
    v_pk_fma_f32 v[150:151], v[62:63], v[132:133], v[150:151] op_sel:[0,1,0] op_sel_hi:[1,1,1] neg_lo:[0,1,0] neg_hi:[0,1,0]
    v_pk_mul_f32 v[148:149], v[148:149], v[132:133] op_sel:[0,0] op_sel_hi:[1,0]
    v_pk_mul_f32 v[150:151], v[150:151], v[132:133] op_sel:[0,0] op_sel_hi:[1,0]
    v_cvt_pk_bf16_f32 v102, v148, v149
    v_cvt_pk_bf16_f32 v103, v150, v151
    s_waitcnt lgkmcnt(0)
    s_barrier
    ds_read_b128 v[96:99], v78 offset:2048
    ds_read_b64 v[108:109], v78 offset:3072
    ds_read_b64 v[114:115], v78 offset:3080
    v_pk_fma_f32 v[160:161], v[48:49], v[134:135], v[160:161] op_sel:[0,1,0] op_sel_hi:[1,1,1] neg_lo:[0,1,0] neg_hi:[0,1,0]
    v_pk_fma_f32 v[162:163], v[50:51], v[134:135], v[162:163] op_sel:[0,1,0] op_sel_hi:[1,1,1] neg_lo:[0,1,0] neg_hi:[0,1,0]
    v_pk_mul_f32 v[160:161], v[160:161], v[70:71] op_sel:[0,0] op_sel_hi:[1,0]
    v_pk_mul_f32 v[162:163], v[162:163], v[70:71] op_sel:[0,0] op_sel_hi:[1,0]
    v_cvt_pk_bf16_f32 v92, v160, v161
    v_cvt_pk_bf16_f32 v93, v162, v163
    v_pk_fma_f32 v[164:165], v[52:53], v[134:135], v[164:165] op_sel:[0,1,0] op_sel_hi:[1,1,1] neg_lo:[0,1,0] neg_hi:[0,1,0]
    v_pk_fma_f32 v[166:167], v[54:55], v[134:135], v[166:167] op_sel:[0,1,0] op_sel_hi:[1,1,1] neg_lo:[0,1,0] neg_hi:[0,1,0]
    v_pk_mul_f32 v[164:165], v[164:165], v[70:71] op_sel:[0,1] op_sel_hi:[1,1]
    v_pk_mul_f32 v[166:167], v[166:167], v[70:71] op_sel:[0,1] op_sel_hi:[1,1]
    v_cvt_pk_bf16_f32 v94, v164, v165
    v_cvt_pk_bf16_f32 v95, v166, v167
    s_nop 1
    v_mfma_f32_16x16x32_bf16 v[24:27], v[100:103], v[92:95], v[240:243]
    v_mfma_f32_16x16x32_bf16 v[28:31], v[104:107], v[92:95], v[244:247]
    v_pk_fma_f32 v[136:137], v[48:49], v[132:133], v[136:137] op_sel:[0,1,0] op_sel_hi:[1,1,1] neg_lo:[0,1,0] neg_hi:[0,1,0]
    v_pk_fma_f32 v[138:139], v[50:51], v[132:133], v[138:139] op_sel:[0,1,0] op_sel_hi:[1,1,1] neg_lo:[0,1,0] neg_hi:[0,1,0]
    v_pk_mul_f32 v[136:137], v[136:137], v[68:69] op_sel:[0,0] op_sel_hi:[1,0]
    v_pk_mul_f32 v[138:139], v[138:139], v[68:69] op_sel:[0,0] op_sel_hi:[1,0]
    v_cvt_pk_bf16_f32 v88, v136, v137
    v_cvt_pk_bf16_f32 v89, v138, v139
    v_pk_fma_f32 v[140:141], v[52:53], v[132:133], v[140:141] op_sel:[0,1,0] op_sel_hi:[1,1,1] neg_lo:[0,1,0] neg_hi:[0,1,0]
    v_pk_fma_f32 v[142:143], v[54:55], v[132:133], v[142:143] op_sel:[0,1,0] op_sel_hi:[1,1,1] neg_lo:[0,1,0] neg_hi:[0,1,0]
    v_pk_mul_f32 v[140:141], v[140:141], v[68:69] op_sel:[0,1] op_sel_hi:[1,1]
    v_pk_mul_f32 v[142:143], v[142:143], v[68:69] op_sel:[0,1] op_sel_hi:[1,1]
    v_cvt_pk_bf16_f32 v90, v140, v141
    v_cvt_pk_bf16_f32 v91, v142, v143
    s_waitcnt lgkmcnt(2)
    s_nop 0
    v_mfma_f32_16x16x32_bf16 v[16:19], v[96:99], v[88:91], v[248:251]
    v_mfma_f32_16x16x32_bf16 v[20:23], v[100:103], v[88:91], v[244:247]
    v_pk_fma_f32 v[152:153], v[36:37], v[64:65], v[152:153] op_sel:[0,0,0] op_sel_hi:[1,0,1] neg_lo:[0,1,0] neg_hi:[0,1,0]
    v_pk_fma_f32 v[154:155], v[38:39], v[64:65], v[154:155] op_sel:[0,0,0] op_sel_hi:[1,0,1] neg_lo:[0,1,0] neg_hi:[0,1,0]
    v_pk_mul_f32 v[152:153], v[152:153], v[32:33]
    v_pk_mul_f32 v[154:155], v[154:155], v[34:35]
    v_cvt_pk_bf16_f32 v110, v152, v153
    v_cvt_pk_bf16_f32 v111, v154, v155
    v_pk_fma_f32 v[156:157], v[36:37], v[64:65], v[156:157] op_sel:[0,1,0] op_sel_hi:[1,1,1] neg_lo:[0,1,0] neg_hi:[0,1,0]
    v_pk_fma_f32 v[158:159], v[38:39], v[64:65], v[158:159] op_sel:[0,1,0] op_sel_hi:[1,1,1] neg_lo:[0,1,0] neg_hi:[0,1,0]
    v_pk_mul_f32 v[156:157], v[156:157], v[32:33]
    v_pk_mul_f32 v[158:159], v[158:159], v[34:35]
    v_cvt_pk_bf16_f32 v116, v156, v157
    v_cvt_pk_bf16_f32 v117, v158, v159
    v_max3_f32 v137, v24, v25, v26
    v_max3_f32 v139, v27, v28, v29
    v_max3_f32 v137, v137, v30, v31
    v_max_f32 v137, v137, v139
    v_max3_f32 v136, v16, v17, v18
    v_max3_f32 v138, v19, v20, v21
    v_max3_f32 v136, v136, v22, v23
    v_max_f32 v136, v136, v138
    v_mov_b32 v138, v136
    v_mov_b32 v139, v137
    s_nop 0
    v_permlane32_swap_b32 v136, v138
    v_permlane32_swap_b32 v137, v139
    v_max_f32 v136, v136, v138
    v_max_f32 v137, v137, v139
    v_mov_b32 v138, v136
    v_mov_b32 v139, v137
    s_nop 0
    v_permlane16_swap_b32 v136, v138
    v_permlane16_swap_b32 v137, v139
    v_max_f32 v136, v136, v138
    v_max_f32 v137, v137, v139
    v_pk_add_f32 v[24:25], v[24:25], v[136:137] op_sel:[0,1] op_sel_hi:[1,1] neg_lo:[0,1] neg_hi:[0,1]
    v_pk_add_f32 v[26:27], v[26:27], v[136:137] op_sel:[0,1] op_sel_hi:[1,1] neg_lo:[0,1] neg_hi:[0,1]
    v_pk_add_f32 v[28:29], v[28:29], v[136:137] op_sel:[0,1] op_sel_hi:[1,1] neg_lo:[0,1] neg_hi:[0,1]
    v_pk_add_f32 v[30:31], v[30:31], v[136:137] op_sel:[0,1] op_sel_hi:[1,1] neg_lo:[0,1] neg_hi:[0,1]
    v_exp_f32 v24, v24
    v_exp_f32 v25, v25
    v_exp_f32 v26, v26
    v_exp_f32 v27, v27
    v_exp_f32 v28, v28
    v_exp_f32 v29, v29
    v_exp_f32 v30, v30
    v_exp_f32 v31, v31
    v_cvt_pk_bf16_f32 v148, v24, v25
    v_cvt_pk_bf16_f32 v149, v26, v27
    v_cvt_pk_bf16_f32 v150, v28, v29
    v_cvt_pk_bf16_f32 v151, v30, v31
    s_nop 1
    v_mfma_f32_16x16x32_bf16 v[160:163], v[110:113], v[148:151], 0
    v_mfma_f32_16x16x32_bf16 v[164:167], v[116:119], v[148:151], 0
    v_pk_add_f32 v[16:17], v[16:17], v[136:137] op_sel:[0,0] op_sel_hi:[1,0] neg_lo:[0,1] neg_hi:[0,1]
    v_pk_add_f32 v[18:19], v[18:19], v[136:137] op_sel:[0,0] op_sel_hi:[1,0] neg_lo:[0,1] neg_hi:[0,1]
    v_pk_add_f32 v[20:21], v[20:21], v[136:137] op_sel:[0,0] op_sel_hi:[1,0] neg_lo:[0,1] neg_hi:[0,1]
    v_pk_add_f32 v[22:23], v[22:23], v[136:137] op_sel:[0,0] op_sel_hi:[1,0] neg_lo:[0,1] neg_hi:[0,1]
    v_exp_f32 v16, v16
    v_exp_f32 v17, v17
    v_exp_f32 v18, v18
    v_exp_f32 v19, v19
    v_exp_f32 v20, v20
    v_exp_f32 v21, v21
    v_exp_f32 v22, v22
    v_exp_f32 v23, v23
    v_cvt_pk_bf16_f32 v144, v16, v17
    v_cvt_pk_bf16_f32 v145, v18, v19
    v_cvt_pk_bf16_f32 v146, v20, v21
    v_cvt_pk_bf16_f32 v147, v22, v23
    s_waitcnt lgkmcnt(1)
    s_nop 0
    v_mfma_f32_16x16x32_bf16 v[152:155], v[108:111], v[144:147], 0
    s_waitcnt lgkmcnt(0)
    v_mfma_f32_16x16x32_bf16 v[156:159], v[114:117], v[144:147], 0
    v_pk_add_f32 v[16:17], v[16:17], v[18:19]
    v_pk_add_f32 v[20:21], v[20:21], v[22:23]
    v_pk_add_f32 v[24:25], v[24:25], v[26:27]
    v_pk_add_f32 v[28:29], v[28:29], v[30:31]
    v_pk_add_f32 v[16:17], v[16:17], v[20:21]
    v_pk_add_f32 v[24:25], v[24:25], v[28:29]
    v_add_f32 v140, v16, v17
    v_add_f32 v142, v24, v25
    v_mov_b32 v138, v140
    v_mov_b32 v139, v142
    s_nop 0
    v_permlane32_swap_b32 v140, v138
    v_permlane32_swap_b32 v142, v139
    v_add_f32 v140, v140, v138
    v_add_f32 v142, v142, v139
    v_mov_b32 v138, v140
    v_mov_b32 v139, v142
    s_nop 0
    v_permlane16_swap_b32 v140, v138
    v_permlane16_swap_b32 v142, v139
    v_add_f32 v140, v140, v138
    v_add_f32 v142, v142, v139
    v_rcp_f32 v140, v140
    v_rcp_f32 v142, v142
    v_cndmask_b32 v141, 0, v140, s[90:91]
    v_cndmask_b32 v140, 0, v140, s[88:89]
    v_cndmask_b32 v143, 0, v142, s[90:91]
    v_cndmask_b32 v142, 0, v142, s[88:89]
    v_pk_mul_f32 v[152:153], v[152:153], v[140:141] op_sel_hi:[1,0]
    v_pk_mul_f32 v[154:155], v[154:155], v[140:141] op_sel_hi:[1,0]
    v_pk_mul_f32 v[156:157], v[156:157], v[140:141] op_sel:[0,1] op_sel_hi:[1,1]
    v_pk_mul_f32 v[158:159], v[158:159], v[140:141] op_sel:[0,1] op_sel_hi:[1,1]
    v_cvt_pk_bf16_f32 v144, v152, v153
    v_cvt_pk_bf16_f32 v145, v154, v155
    v_cvt_pk_bf16_f32 v146, v156, v157
    v_cvt_pk_bf16_f32 v147, v158, v159
    buffer_store_dwordx4 v[144:147], v4, s[40:43], s62 offen sc1
    v_pk_mul_f32 v[160:161], v[160:161], v[142:143] op_sel_hi:[1,0]
    v_pk_mul_f32 v[162:163], v[162:163], v[142:143] op_sel_hi:[1,0]
    v_pk_mul_f32 v[164:165], v[164:165], v[142:143] op_sel:[0,1] op_sel_hi:[1,1]
    v_pk_mul_f32 v[166:167], v[166:167], v[142:143] op_sel:[0,1] op_sel_hi:[1,1]
    v_cvt_pk_bf16_f32 v148, v160, v161
    v_cvt_pk_bf16_f32 v149, v162, v163
    v_cvt_pk_bf16_f32 v150, v164, v165
    v_cvt_pk_bf16_f32 v151, v166, v167
    buffer_store_dwordx4 v[148:151], v4, s[40:43], s63 offen sc1
    s_add_u32 m0, s59, 0
    s_mov_b32 s73, 0
    buffer_load_dwordx4 v208, s[16:19], s73 offen lds
    s_add_u32 m0, s59, 1024
    s_mov_b32 s73, 7168
    buffer_load_dwordx4 v208, s[16:19], s73 offen lds
    s_add_u32 m0, s59, 2048
    s_mov_b32 s73, 14336
    buffer_load_dwordx4 v208, s[16:19], s73 offen lds
    s_add_u32 m0, s59, 3072
    s_mov_b32 s73, 21504
    buffer_load_dwordx4 v208, s[16:19], s73 offen lds
    s_add_u32 m0, s59, 4096
    s_mov_b32 s73, 28672
    buffer_load_dwordx4 v208, s[16:19], s73 offen lds
    s_add_u32 m0, s59, 5120
    s_mov_b32 s73, 35840
    buffer_load_dwordx4 v208, s[16:19], s73 offen lds
    s_add_u32 m0, s59, 6144
    s_mov_b32 s73, 43008
    buffer_load_dwordx4 v208, s[16:19], s73 offen lds
    s_add_u32 m0, s59, 7168
    s_mov_b32 s73, 50176
    buffer_load_dwordx4 v208, s[16:19], s73 offen lds
    s_add_u32 m0, s59, 8192
    s_mov_b32 s73, 57344
    buffer_load_dwordx4 v208, s[16:19], s73 offen lds
    s_add_u32 m0, s59, 9216
    s_mov_b32 s73, 64512
    buffer_load_dwordx4 v208, s[16:19], s73 offen lds
    s_add_u32 m0, s59, 10240
    s_mov_b32 s73, 71680
    buffer_load_dwordx4 v208, s[16:19], s73 offen lds
    s_add_u32 m0, s59, 11264
    s_mov_b32 s73, 78848
    buffer_load_dwordx4 v208, s[16:19], s73 offen lds
    s_add_u32 m0, s59, 12288
    s_mov_b32 s73, 86016
    buffer_load_dwordx4 v208, s[16:19], s73 offen lds
    s_add_u32 m0, s59, 13312
    s_mov_b32 s73, 93184
    buffer_load_dwordx4 v208, s[16:19], s73 offen lds
    s_waitcnt vmcnt(18)
    v_readfirstlane_b32 s4, v6
    s_nop 1
    s_cmp_lg_u32 s4, 0
    s_cbranch_scc1 Lepd_P_2
    s_nop 0
Lepg_P_1:
    s_sub_u32 s6, s6, 1
    s_cbranch_scc1 L_end_P
    buffer_load_dword v6, v7, s[44:47], 0 offen sc1
    s_waitcnt vmcnt(0)
    v_readfirstlane_b32 s4, v6
    s_nop 1
    s_cmp_eq_u32 s4, 0
    s_cbranch_scc1 Lepg_P_1
Lepd_P_2:
    s_waitcnt vmcnt(14)
    v_mov_b32 v8, s4
    s_mov_b64 exec, 1
    buffer_store_dword v8, v9, s[40:43], s80 offen sc1
    s_mov_b64 exec, -1
    s_cmp_lt_u32 s67, 99
    s_cbranch_scc1 Lnotag_P_3
    s_lshr_b32 s68, s2, 3
    s_sub_u32 s68, s68, 28
    s_lshl_b32 s68, s68, 2
    s_add_u32 s68, s68, s3
    s_lshl_b32 s68, s68, 16
    s_and_b32 s69, s2, 7
    s_lshl_b32 s69, s69, 9
    s_add_u32 s68, s68, s69
    v_lshrrev_b32 v16, 2, v1
    v_lshlrev_b32 v16, 12, v16
    v_and_b32 v17, 3, v1
    v_lshl_add_u32 v16, v17, 7, v16
    buffer_load_dword v18, v16, s[24:27], s68 offen
    s_add_u32 s68, s68, 0x100000
    s_waitcnt vmcnt(3)
    buffer_load_dword v19, v16, s[24:27], s68 offen
    s_add_u32 s68, s68, 0x100000
    s_waitcnt vmcnt(3)
    buffer_load_dword v20, v16, s[24:27], s68 offen
    s_add_u32 s68, s68, 0x100000
    s_waitcnt vmcnt(3)
    buffer_load_dword v21, v16, s[24:27], s68 offen
    s_add_u32 s68, s68, 0x100000
    s_waitcnt vmcnt(3)
    buffer_load_dword v22, v16, s[24:27], s68 offen
    s_add_u32 s68, s68, 0x100000
    s_waitcnt vmcnt(3)
    buffer_load_dword v23, v16, s[24:27], s68 offen
    s_add_u32 s68, s68, 0x100000
    s_waitcnt vmcnt(3)
    buffer_load_dword v24, v16, s[24:27], s68 offen
    s_add_u32 s68, s68, 0x100000
    s_waitcnt vmcnt(3)
    s_waitcnt vmcnt(0)
    s_branch L_end_P
Lnotag_P_3:
    v_lshrrev_b32 v221, 5, v1
    v_mul_u32_u24 v221, 3584, v221
    v_and_b32 v222, 31, v1
    v_lshl_add_u32 v221, v222, 1, v221
    s_lshl_b32 s58, s67, 1
    s_lshr_b32 s60, s3, 1
    s_add_u32 s58, s58, s60
    s_mul_i32 s58, s58, 28672
    s_lshl_b32 s60, s66, 7
    s_add_u32 s58, s58, s60
    s_and_b32 s60, s3, 1
    s_lshl_b32 s60, s60, 6
    s_add_u32 s58, s58, s60
    buffer_load_ushort v192, v221, s[8:11], s58 offen offset:0
    buffer_load_ushort v193, v221, s[8:11], s58 offen offset:896
    buffer_load_ushort v194, v221, s[8:11], s58 offen offset:1792
    buffer_load_ushort v195, v221, s[8:11], s58 offen offset:2688
    s_add_u32 s58, s58, 7168
    buffer_load_ushort v196, v221, s[8:11], s58 offen offset:0
    buffer_load_ushort v197, v221, s[8:11], s58 offen offset:896
    buffer_load_ushort v198, v221, s[8:11], s58 offen offset:1792
    buffer_load_ushort v199, v221, s[8:11], s58 offen offset:2688
    s_add_u32 s58, s58, 7168
    buffer_load_ushort v200, v221, s[8:11], s58 offen offset:0
    buffer_load_ushort v201, v221, s[8:11], s58 offen offset:896
    buffer_load_ushort v202, v221, s[8:11], s58 offen offset:1792
    buffer_load_ushort v203, v221, s[8:11], s58 offen offset:2688
    s_add_u32 s58, s58, 7168
    buffer_load_ushort v204, v221, s[8:11], s58 offen offset:0
    buffer_load_ushort v205, v221, s[8:11], s58 offen offset:896
    buffer_load_ushort v206, v221, s[8:11], s58 offen offset:1792
    buffer_load_ushort v207, v221, s[8:11], s58 offen offset:2688
    s_and_b32 s68, s2, 7
    s_cmp_ge_u32 s68, 7
    s_cselect_b32 s48, 7, 0
    s_sub_u32 s68, s68, s48
    s_lshl_b32 s48, s68, 12
    s_add_u32 s68, s68, 1
    s_cmp_ge_u32 s68, 7
    s_cselect_b32 s49, 7, 0
    s_sub_u32 s68, s68, s49
    s_lshl_b32 s49, s68, 12
    s_add_u32 s68, s68, 1
    s_cmp_ge_u32 s68, 7
    s_cselect_b32 s50, 7, 0
    s_sub_u32 s68, s68, s50
    s_lshl_b32 s50, s68, 12
    s_add_u32 s68, s68, 1
    s_cmp_ge_u32 s68, 7
    s_cselect_b32 s51, 7, 0
    s_sub_u32 s68, s68, s51
    s_lshl_b32 s51, s68, 12
    s_add_u32 s68, s68, 1
    s_cmp_ge_u32 s68, 7
    s_cselect_b32 s52, 7, 0
    s_sub_u32 s68, s68, s52
    s_lshl_b32 s52, s68, 12
    s_add_u32 s68, s68, 1
    s_cmp_ge_u32 s68, 7
    s_cselect_b32 s53, 7, 0
    s_sub_u32 s68, s68, s53
    s_lshl_b32 s53, s68, 12
    s_add_u32 s68, s68, 1
    s_cmp_ge_u32 s68, 7
    s_cselect_b32 s54, 7, 0
    s_sub_u32 s68, s68, s54
    s_lshl_b32 s54, s68, 12
    s_add_u32 m0, s70, 16384
    s_mul_i32 s73, s94, 56
    s_add_u32 s73, s73, 0
    buffer_load_dwordx4 v213, s[20:23], s73 offen lds
    s_add_u32 m0, s70, 17408
    s_mul_i32 s73, s94, 56
    s_add_u32 s73, s73, 28672
    buffer_load_dwordx4 v213, s[20:23], s73 offen lds
    s_add_u32 m0, s70, 18432
    s_mul_i32 s73, s94, 56
    s_add_u32 s73, s73, 57344
    buffer_load_dwordx4 v213, s[20:23], s73 offen lds
    s_add_u32 m0, s70, 19456
    s_mul_i32 s73, s94, 56
    s_add_u32 s73, s73, 86016
    buffer_load_dwordx4 v213, s[20:23], s73 offen lds
    s_add_u32 m0, s70, 20480
    s_mul_i32 s73, s94, 56
    s_add_u32 s73, s73, 114688
    buffer_load_dwordx4 v213, s[20:23], s73 offen lds
    s_add_u32 m0, s70, 21504
    s_mul_i32 s73, s94, 56
    s_add_u32 s73, s73, 143360
    buffer_load_dwordx4 v213, s[20:23], s73 offen lds
    s_add_u32 m0, s70, 22528
    s_mul_i32 s73, s94, 56
    s_add_u32 s73, s73, 172032
    buffer_load_dwordx4 v213, s[20:23], s73 offen lds
    s_add_u32 m0, s70, 23552
    s_mul_i32 s73, s94, 56
    s_add_u32 s73, s73, 200704
    buffer_load_dwordx4 v213, s[20:23], s73 offen lds
    s_waitcnt vmcnt(25)
    s_barrier
    ds_read_b64_tr_b16 a[0:1], v209 offset:0
    ds_read_b64_tr_b16 a[2:3], v209 offset:2048
    s_add_u32 m0, s70, 24576
    s_mul_i32 s73, s95, 56
    s_add_u32 s73, s73, 0
    buffer_load_dwordx4 v213, s[20:23], s73 offen lds
    ds_read_b64_tr_b16 a[4:5], v209 offset:1024
    ds_read_b64_tr_b16 a[6:7], v209 offset:3072
    s_add_u32 m0, s70, 25600
    s_mul_i32 s73, s95, 56
    s_add_u32 s73, s73, 28672
    buffer_load_dwordx4 v213, s[20:23], s73 offen lds
    ds_read_b64_tr_b16 a[8:9], v209 offset:3584
    ds_read_b64_tr_b16 a[10:11], v209 offset:5632
    ds_read_b64_tr_b16 a[12:13], v209 offset:4608
    ds_read_b64_tr_b16 a[14:15], v209 offset:6656
    s_add_u32 m0, s70, 26624
    s_mul_i32 s73, s95, 56
    s_add_u32 s73, s73, 57344
    buffer_load_dwordx4 v213, s[20:23], s73 offen lds
    ds_read_b64_tr_b16 a[16:17], v209 offset:7168
    ds_read_b64_tr_b16 a[18:19], v209 offset:9216
    s_add_u32 m0, s70, 27648
    s_mul_i32 s73, s95, 56
    s_add_u32 s73, s73, 86016
    buffer_load_dwordx4 v213, s[20:23], s73 offen lds
    ds_read_b64_tr_b16 a[20:21], v209 offset:8192
    ds_read_b64_tr_b16 a[22:23], v209 offset:10240
    ds_read_b64_tr_b16 a[24:25], v209 offset:10752
    ds_read_b64_tr_b16 a[26:27], v209 offset:12800
    s_add_u32 m0, s70, 28672
    s_mul_i32 s73, s95, 56
    s_add_u32 s73, s73, 114688
    buffer_load_dwordx4 v213, s[20:23], s73 offen lds
    ds_read_b64_tr_b16 a[28:29], v209 offset:11776
    ds_read_b64_tr_b16 a[30:31], v210 offset:13824
    s_add_u32 m0, s70, 29696
    s_mul_i32 s73, s95, 56
    s_add_u32 s73, s73, 143360
    buffer_load_dwordx4 v213, s[20:23], s73 offen lds
    ds_read_b64_tr_b16 a[32:33], v209 offset:36864
    ds_read_b64_tr_b16 a[34:35], v209 offset:38912
    ds_read_b64_tr_b16 a[36:37], v209 offset:37888
    ds_read_b64_tr_b16 a[38:39], v209 offset:39936
    s_add_u32 m0, s70, 30720
    s_mul_i32 s73, s95, 56
    s_add_u32 s73, s73, 172032
    buffer_load_dwordx4 v213, s[20:23], s73 offen lds
    ds_read_b64_tr_b16 a[40:41], v209 offset:40448
    ds_read_b64_tr_b16 a[42:43], v209 offset:42496
    s_add_u32 m0, s70, 31744
    s_mul_i32 s73, s95, 56
    s_add_u32 s73, s73, 200704
    buffer_load_dwordx4 v213, s[20:23], s73 offen lds
    ds_read_b64_tr_b16 a[44:45], v209 offset:41472
    ds_read_b64_tr_b16 a[46:47], v209 offset:43520
    ds_read_b64_tr_b16 a[48:49], v209 offset:44032
    ds_read_b64_tr_b16 a[50:51], v209 offset:46080
    s_add_u32 m0, s70, 32768
    s_mul_i32 s73, s96, 56
    s_add_u32 s73, s73, 0
    buffer_load_dwordx4 v213, s[20:23], s73 offen lds
    ds_read_b64_tr_b16 a[52:53], v209 offset:45056
    ds_read_b64_tr_b16 a[54:55], v209 offset:47104
    s_add_u32 m0, s70, 33792
    s_mul_i32 s73, s96, 56
    s_add_u32 s73, s73, 28672
    buffer_load_dwordx4 v213, s[20:23], s73 offen lds
    ds_read_b64_tr_b16 a[56:57], v209 offset:47616
    ds_read_b64_tr_b16 a[58:59], v209 offset:49664
    ds_read_b64_tr_b16 a[60:61], v209 offset:48640
    ds_read_b64_tr_b16 a[62:63], v210 offset:50688
    s_add_u32 m0, s70, 34816
    s_mul_i32 s73, s96, 56
    s_add_u32 s73, s73, 57344
    buffer_load_dwordx4 v213, s[20:23], s73 offen lds
    v_add_u32 v209, 73728, v209
    v_add_u32 v210, 73728, v210
    ds_read_b64_tr_b16 a[64:65], v209 offset:0
    ds_read_b64_tr_b16 a[66:67], v209 offset:2048
    s_add_u32 m0, s70, 35840
    s_mul_i32 s73, s96, 56
    s_add_u32 s73, s73, 86016
    buffer_load_dwordx4 v213, s[20:23], s73 offen lds
    ds_read_b64_tr_b16 a[68:69], v209 offset:1024
    ds_read_b64_tr_b16 a[70:71], v209 offset:3072
    ds_read_b64_tr_b16 a[72:73], v209 offset:3584
    ds_read_b64_tr_b16 a[74:75], v209 offset:5632
    ds_read_b64_tr_b16 a[76:77], v209 offset:4608
    ds_read_b64_tr_b16 a[78:79], v209 offset:6656
    ds_read_b64_tr_b16 a[80:81], v209 offset:7168
    ds_read_b64_tr_b16 a[82:83], v209 offset:9216
    ds_read_b64_tr_b16 a[84:85], v209 offset:8192
    ds_read_b64_tr_b16 a[86:87], v209 offset:10240
    ds_read_b64_tr_b16 a[88:89], v209 offset:10752
    ds_read_b64_tr_b16 a[90:91], v209 offset:12800
    ds_read_b64_tr_b16 a[92:93], v209 offset:11776
    ds_read_b64_tr_b16 a[94:95], v210 offset:13824
    ds_read_b64_tr_b16 a[96:97], v209 offset:36864
    ds_read_b64_tr_b16 a[98:99], v209 offset:38912
    ds_read_b64_tr_b16 a[100:101], v209 offset:37888
    ds_read_b64_tr_b16 a[102:103], v209 offset:39936
    ds_read_b64_tr_b16 a[104:105], v209 offset:40448
    ds_read_b64_tr_b16 a[106:107], v209 offset:42496
    ds_read_b64_tr_b16 a[108:109], v209 offset:41472
    ds_read_b64_tr_b16 a[110:111], v209 offset:43520
    ds_read_b64_tr_b16 a[112:113], v209 offset:44032
    ds_read_b64_tr_b16 a[114:115], v209 offset:46080
    ds_read_b64_tr_b16 a[116:117], v209 offset:45056
    ds_read_b64_tr_b16 a[118:119], v209 offset:47104
    ds_read_b64_tr_b16 a[120:121], v209 offset:47104
    ds_read_b64_tr_b16 a[122:123], v209 offset:49152
    ds_read_b64_tr_b16 a[124:125], v209 offset:48128
    ds_read_b64_tr_b16 a[126:127], v209 offset:50176
    s_waitcnt lgkmcnt(0)
    s_barrier
    buffer_load_dword v249, v10, s[40:43], s83 offen sc1
    s_sleep 3
    buffer_load_dword v250, v10, s[40:43], s83 offen sc1
    s_sleep 3
    s_nop 0
Lpoll_P_4:
    s_sub_u32 s6, s6, 1
    s_cbranch_scc1 L_end_P
    buffer_load_dword v251, v10, s[40:43], s83 offen sc1
    s_waitcnt vmcnt(2)
    v_cmp_ne_u32 vcc, s4, v249
    s_nop 1
    s_cbranch_vccz Lpd_P_5
    buffer_load_dword v249, v10, s[40:43], s83 offen sc1
    s_waitcnt vmcnt(2)
    v_cmp_ne_u32 vcc, s4, v250
    s_nop 1
    s_cbranch_vccz Lpd_P_5
    buffer_load_dword v250, v10, s[40:43], s83 offen sc1
    s_waitcnt vmcnt(2)
    v_cmp_ne_u32 vcc, s4, v251
    s_nop 1
    s_cbranch_vccnz Lpoll_P_4
    s_nop 1
Lpd_P_5:
    s_lshl_b32 s58, s67, 16
    s_lshl_b32 s60, s3, 14
    s_add_u32 s58, s58, s60
    s_add_u32 m0, s70, 0
    s_nop 0
    buffer_load_dwordx4 v4, s[40:43], s58 offen offset:0 sc1 lds
    buffer_load_dwordx4 v4, s[40:43], s58 offen offset:1024 sc1 lds
    buffer_load_dwordx4 v4, s[40:43], s58 offen offset:2048 sc1 lds
    buffer_load_dwordx4 v4, s[40:43], s58 offen offset:3072 sc1 lds
    s_add_u32 m0, s70, 4096
    s_add_u32 s58, s58, 4096
    buffer_load_dwordx4 v4, s[40:43], s58 offen offset:0 sc1 lds
    buffer_load_dwordx4 v4, s[40:43], s58 offen offset:1024 sc1 lds
    buffer_load_dwordx4 v4, s[40:43], s58 offen offset:2048 sc1 lds
    buffer_load_dwordx4 v4, s[40:43], s58 offen offset:3072 sc1 lds
    s_add_u32 m0, s70, 8192
    s_add_u32 s58, s58, 4096
    buffer_load_dwordx4 v4, s[40:43], s58 offen offset:0 sc1 lds
    buffer_load_dwordx4 v4, s[40:43], s58 offen offset:1024 sc1 lds
    buffer_load_dwordx4 v4, s[40:43], s58 offen offset:2048 sc1 lds
    buffer_load_dwordx4 v4, s[40:43], s58 offen offset:3072 sc1 lds
    s_add_u32 m0, s70, 12288
    s_add_u32 s58, s58, 4096
    buffer_load_dwordx4 v4, s[40:43], s58 offen offset:0 sc1 lds
    buffer_load_dwordx4 v4, s[40:43], s58 offen offset:1024 sc1 lds
    buffer_load_dwordx4 v4, s[40:43], s58 offen offset:2048 sc1 lds
    buffer_load_dwordx4 v4, s[40:43], s58 offen offset:3072 sc1 lds
    v_and_b32 v64, 1, v3
    v_mul_u32_u24 v64, 36864, v64
    v_lshl_add_u32 v64, v2, 4, v64
    v_lshrrev_b32 v65, 5, v1
    v_lshl_add_u32 v64, v65, 8, v64
    s_lshr_b32 s60, s3, 1
    s_mul_i32 s60, s60, 73728
    s_add_u32 s60, s60, 12288
    v_add_u32 v64, s60, v64
    ds_read_b64_tr_b16 a[128:129], v215 offset:16384
    ds_read_b64_tr_b16 a[130:131], v215 offset:17408
    ds_read_b64_tr_b16 a[132:133], v216 offset:16384
    ds_read_b64_tr_b16 a[134:135], v216 offset:17408
    ds_read_b64_tr_b16 a[136:137], v215 offset:18432
    ds_read_b64_tr_b16 a[138:139], v215 offset:19456
    ds_read_b64_tr_b16 a[140:141], v216 offset:18432
    ds_read_b64_tr_b16 a[142:143], v216 offset:19456
    ds_read_b64_tr_b16 a[144:145], v215 offset:20480
    ds_read_b64_tr_b16 a[146:147], v215 offset:21504
    ds_read_b64_tr_b16 a[148:149], v216 offset:20480
    ds_read_b64_tr_b16 a[150:151], v216 offset:21504
    ds_read_b64_tr_b16 a[152:153], v215 offset:22528
    ds_read_b64_tr_b16 a[154:155], v215 offset:23552
    ds_read_b64_tr_b16 a[156:157], v216 offset:22528
    ds_read_b64_tr_b16 a[158:159], v216 offset:23552
    ds_read_b64_tr_b16 a[160:161], v215 offset:24576
    ds_read_b64_tr_b16 a[162:163], v215 offset:25600
    ds_read_b64_tr_b16 a[164:165], v216 offset:24576
    ds_read_b64_tr_b16 a[166:167], v216 offset:25600
    ds_read_b64_tr_b16 a[168:169], v215 offset:26624
    ds_read_b64_tr_b16 a[170:171], v215 offset:27648
    ds_read_b64_tr_b16 a[172:173], v216 offset:26624
    ds_read_b64_tr_b16 a[174:175], v216 offset:27648
    ds_read_b64_tr_b16 a[176:177], v215 offset:28672
    ds_read_b64_tr_b16 a[178:179], v215 offset:29696
    ds_read_b64_tr_b16 a[180:181], v216 offset:28672
    ds_read_b64_tr_b16 a[182:183], v216 offset:29696
    ds_read_b64_tr_b16 a[184:185], v215 offset:30720
    ds_read_b64_tr_b16 a[186:187], v215 offset:31744
    ds_read_b64_tr_b16 a[188:189], v216 offset:30720
    ds_read_b64_tr_b16 a[190:191], v216 offset:31744
    ds_read_b64_tr_b16 a[192:193], v215 offset:32768
    ds_read_b64_tr_b16 a[194:195], v215 offset:33792
    ds_read_b64_tr_b16 a[196:197], v216 offset:32768
    ds_read_b64_tr_b16 a[198:199], v216 offset:33792
    ds_read_b64_tr_b16 a[200:201], v215 offset:34816
    ds_read_b64_tr_b16 a[202:203], v215 offset:35840
    ds_read_b64_tr_b16 a[204:205], v216 offset:34816
    ds_read_b64_tr_b16 a[206:207], v216 offset:35840
    v_lshlrev_b32 v192, 16, v192
    v_lshlrev_b32 v193, 16, v193
    v_lshlrev_b32 v194, 16, v194
    v_lshlrev_b32 v195, 16, v195
    v_lshlrev_b32 v196, 16, v196
    v_lshlrev_b32 v197, 16, v197
    v_lshlrev_b32 v198, 16, v198
    v_lshlrev_b32 v199, 16, v199
    v_lshlrev_b32 v200, 16, v200
    v_lshlrev_b32 v201, 16, v201
    v_lshlrev_b32 v202, 16, v202
    v_lshlrev_b32 v203, 16, v203
    v_lshlrev_b32 v204, 16, v204
    v_lshlrev_b32 v205, 16, v205
    v_lshlrev_b32 v206, 16, v206
    v_lshlrev_b32 v207, 16, v207
    s_waitcnt vmcnt(8)
    s_barrier
    ds_read_b128 v[32:35], v64 offset:0
    ds_read_b128 v[36:39], v64 offset:512
    ds_read_b128 v[40:43], v64 offset:1024
    ds_read_b128 v[44:47], v64 offset:1536
    ds_read_b128 v[48:51], v64 offset:2048
    ds_read_b128 v[52:55], v64 offset:2560
    s_waitcnt lgkmcnt(5)
    v_mfma_f32_32x32x16_bf16 v[192:207], v[32:35], a[0:3], v[192:207]
    ds_read_b128 v[56:59], v64 offset:3072
    s_add_u32 m0, s70, 16384
    s_mul_i32 s73, s96, 56
    s_add_u32 s73, s73, 114688
    buffer_load_dwordx4 v213, s[20:23], s73 offen lds
    s_waitcnt lgkmcnt(5)
    v_mfma_f32_32x32x16_bf16 v[192:207], v[36:39], a[4:7], v[192:207]
    ds_read_b128 v[60:63], v64 offset:3584
    s_waitcnt lgkmcnt(5)
    v_mfma_f32_32x32x16_bf16 v[192:207], v[40:43], a[8:11], v[192:207]
    ds_read_b128 v[32:35], v64 offset:4096
    s_waitcnt lgkmcnt(5)
    v_mfma_f32_32x32x16_bf16 v[192:207], v[44:47], a[12:15], v[192:207]
    ds_read_b128 v[36:39], v64 offset:4608
    s_add_u32 m0, s70, 17408
    s_mul_i32 s73, s96, 56
    s_add_u32 s73, s73, 143360
    buffer_load_dwordx4 v213, s[20:23], s73 offen lds
    s_waitcnt lgkmcnt(5)
    v_mfma_f32_32x32x16_bf16 v[192:207], v[48:51], a[16:19], v[192:207]
    ds_read_b128 v[40:43], v64 offset:5120
    s_waitcnt lgkmcnt(5)
    v_mfma_f32_32x32x16_bf16 v[192:207], v[52:55], a[20:23], v[192:207]
    ds_read_b128 v[44:47], v64 offset:5632
    s_waitcnt lgkmcnt(5)
    v_mfma_f32_32x32x16_bf16 v[192:207], v[56:59], a[24:27], v[192:207]
    ds_read_b128 v[48:51], v64 offset:6144
    s_add_u32 m0, s70, 18432
    s_mul_i32 s73, s96, 56
    s_add_u32 s73, s73, 172032
    buffer_load_dwordx4 v213, s[20:23], s73 offen lds
    s_waitcnt lgkmcnt(5)
    v_mfma_f32_32x32x16_bf16 v[192:207], v[60:63], a[28:31], v[192:207]
    ds_read_b128 v[52:55], v64 offset:6656
    s_waitcnt lgkmcnt(5)
    v_mfma_f32_32x32x16_bf16 v[192:207], v[32:35], a[32:35], v[192:207]
    ds_read_b128 v[56:59], v64 offset:7168
    s_waitcnt lgkmcnt(5)
    v_mfma_f32_32x32x16_bf16 v[192:207], v[36:39], a[36:39], v[192:207]
    ds_read_b128 v[60:63], v64 offset:7680
    s_add_u32 m0, s70, 19456
    s_mul_i32 s73, s96, 56
    s_add_u32 s73, s73, 200704
    buffer_load_dwordx4 v213, s[20:23], s73 offen lds
    s_waitcnt lgkmcnt(5)
    v_mfma_f32_32x32x16_bf16 v[192:207], v[40:43], a[40:43], v[192:207]
    s_waitcnt lgkmcnt(4)
    v_mfma_f32_32x32x16_bf16 v[192:207], v[44:47], a[44:47], v[192:207]
    s_waitcnt vmcnt(4)
    s_barrier
    ds_read_b128 v[32:35], v64 offset:8192
    ds_read_b128 v[36:39], v64 offset:8704
    s_waitcnt lgkmcnt(5)
    v_mfma_f32_32x32x16_bf16 v[192:207], v[48:51], a[48:51], v[192:207]
    ds_read_b128 v[40:43], v64 offset:9216
    s_add_u32 m0, s70, 20480
    s_mul_i32 s73, s97, 56
    s_add_u32 s73, s73, 0
    buffer_load_dwordx4 v213, s[20:23], s73 offen lds
    s_waitcnt lgkmcnt(5)
    v_mfma_f32_32x32x16_bf16 v[192:207], v[52:55], a[52:55], v[192:207]
    ds_read_b128 v[44:47], v64 offset:9728
    s_waitcnt lgkmcnt(5)
    v_mfma_f32_32x32x16_bf16 v[192:207], v[56:59], a[56:59], v[192:207]
    ds_read_b128 v[48:51], v64 offset:10240
    s_waitcnt lgkmcnt(5)
    v_mfma_f32_32x32x16_bf16 v[192:207], v[60:63], a[60:63], v[192:207]
    ds_read_b128 v[52:55], v64 offset:10752
    s_add_u32 m0, s70, 21504
    s_mul_i32 s73, s97, 56
    s_add_u32 s73, s73, 28672
    buffer_load_dwordx4 v213, s[20:23], s73 offen lds
    s_waitcnt lgkmcnt(5)
    v_mfma_f32_32x32x16_bf16 v[192:207], v[32:35], a[64:67], v[192:207]
    ds_read_b128 v[56:59], v64 offset:11264
    s_waitcnt lgkmcnt(5)
    v_mfma_f32_32x32x16_bf16 v[192:207], v[36:39], a[68:71], v[192:207]
    ds_read_b128 v[60:63], v64 offset:11776
    s_waitcnt lgkmcnt(5)
    v_mfma_f32_32x32x16_bf16 v[192:207], v[40:43], a[72:75], v[192:207]
    ds_read_b128 v[32:35], v64 offset:12288
    s_add_u32 m0, s70, 22528
    s_mul_i32 s73, s97, 56
    s_add_u32 s73, s73, 57344
    buffer_load_dwordx4 v213, s[20:23], s73 offen lds
    s_waitcnt lgkmcnt(5)
    v_mfma_f32_32x32x16_bf16 v[192:207], v[44:47], a[76:79], v[192:207]
    ds_read_b128 v[36:39], v64 offset:12800
    s_waitcnt lgkmcnt(5)
    v_mfma_f32_32x32x16_bf16 v[192:207], v[48:51], a[80:83], v[192:207]
    ds_read_b128 v[40:43], v64 offset:13312
    s_waitcnt lgkmcnt(5)
    v_mfma_f32_32x32x16_bf16 v[192:207], v[52:55], a[84:87], v[192:207]
    ds_read_b128 v[44:47], v64 offset:13824
    s_add_u32 m0, s70, 23552
    s_mul_i32 s73, s97, 56
    s_add_u32 s73, s73, 86016
    buffer_load_dwordx4 v213, s[20:23], s73 offen lds
    s_waitcnt lgkmcnt(5)
    v_mfma_f32_32x32x16_bf16 v[192:207], v[56:59], a[88:91], v[192:207]
    ds_read_b128 v[48:51], v64 offset:14336
    s_waitcnt lgkmcnt(5)
    v_mfma_f32_32x32x16_bf16 v[192:207], v[60:63], a[92:95], v[192:207]
    ds_read_b128 v[52:55], v64 offset:14848
    s_waitcnt lgkmcnt(5)
    v_mfma_f32_32x32x16_bf16 v[192:207], v[32:35], a[96:99], v[192:207]
    ds_read_b128 v[56:59], v64 offset:15360
    s_add_u32 m0, s70, 24576
    s_mul_i32 s73, s97, 56
    s_add_u32 s73, s73, 114688
    buffer_load_dwordx4 v213, s[20:23], s73 offen lds
    s_waitcnt lgkmcnt(5)
    v_mfma_f32_32x32x16_bf16 v[192:207], v[36:39], a[100:103], v[192:207]
    ds_read_b128 v[60:63], v64 offset:15872
    s_waitcnt lgkmcnt(5)
    v_mfma_f32_32x32x16_bf16 v[192:207], v[40:43], a[104:107], v[192:207]
    s_waitcnt lgkmcnt(4)
    v_mfma_f32_32x32x16_bf16 v[192:207], v[44:47], a[108:111], v[192:207]
    s_add_u32 m0, s70, 25600
    s_mul_i32 s73, s97, 56
    s_add_u32 s73, s73, 143360
    buffer_load_dwordx4 v213, s[20:23], s73 offen lds
    s_waitcnt lgkmcnt(3)
    v_mfma_f32_32x32x16_bf16 v[192:207], v[48:51], a[112:115], v[192:207]
    s_waitcnt lgkmcnt(2)
    v_mfma_f32_32x32x16_bf16 v[192:207], v[52:55], a[116:119], v[192:207]
    s_waitcnt lgkmcnt(1)
    v_mfma_f32_32x32x16_bf16 v[192:207], v[56:59], a[120:123], v[192:207]
    s_add_u32 m0, s70, 26624
    s_mul_i32 s73, s97, 56
    s_add_u32 s73, s73, 172032
    buffer_load_dwordx4 v213, s[20:23], s73 offen lds
    s_waitcnt lgkmcnt(0)
    v_mfma_f32_32x32x16_bf16 v[192:207], v[60:63], a[124:127], v[192:207]
    s_nop 11
    v_pk_mul_f32 v[68:69], v[192:193], v[192:193]
    v_pk_mul_f32 v[70:71], v[194:195], v[194:195]
    v_pk_mul_f32 v[72:73], v[196:197], v[196:197]
    v_pk_mul_f32 v[74:75], v[198:199], v[198:199]
    v_pk_mul_f32 v[76:77], v[200:201], v[200:201]
    v_pk_mul_f32 v[78:79], v[202:203], v[202:203]
    v_pk_mul_f32 v[80:81], v[204:205], v[204:205]
    v_pk_mul_f32 v[82:83], v[206:207], v[206:207]
    s_add_u32 m0, s70, 27648
    s_mul_i32 s73, s97, 56
    s_add_u32 s73, s73, 200704
    buffer_load_dwordx4 v213, s[20:23], s73 offen lds
    v_add_f32_dpp v84, v192, v192 row_mirror row_mask:0xf bank_mask:0x3
    v_add_f32_dpp v85, v193, v193 row_mirror row_mask:0xf bank_mask:0x3
    v_add_f32_dpp v86, v196, v196 row_mirror row_mask:0xf bank_mask:0x3
    v_add_f32_dpp v87, v197, v197 row_mirror row_mask:0xf bank_mask:0x3
    v_add_f32_dpp v88, v200, v200 row_mirror row_mask:0xf bank_mask:0x3
    v_add_f32_dpp v89, v201, v201 row_mirror row_mask:0xf bank_mask:0x3
    v_add_f32_dpp v90, v204, v204 row_mirror row_mask:0xf bank_mask:0x3
    v_add_f32_dpp v91, v205, v205 row_mirror row_mask:0xf bank_mask:0x3
    s_add_u32 m0, s70, 28672
    s_mul_i32 s73, s98, 56
    s_add_u32 s73, s73, 0
    buffer_load_dwordx4 v213, s[20:23], s73 offen lds
    v_add_f32_dpp v92, v68, v68 row_mirror row_mask:0xf bank_mask:0x3
    v_add_f32_dpp v93, v69, v69 row_mirror row_mask:0xf bank_mask:0x3
    v_add_f32_dpp v94, v72, v72 row_mirror row_mask:0xf bank_mask:0x3
    v_add_f32_dpp v95, v73, v73 row_mirror row_mask:0xf bank_mask:0x3
    v_add_f32_dpp v96, v76, v76 row_mirror row_mask:0xf bank_mask:0x3
    v_add_f32_dpp v97, v77, v77 row_mirror row_mask:0xf bank_mask:0x3
    v_add_f32_dpp v98, v80, v80 row_mirror row_mask:0xf bank_mask:0x3
    v_add_f32_dpp v99, v81, v81 row_mirror row_mask:0xf bank_mask:0x3
    s_add_u32 m0, s70, 29696
    s_mul_i32 s73, s98, 56
    s_add_u32 s73, s73, 28672
    buffer_load_dwordx4 v213, s[20:23], s73 offen lds
    v_add_f32_dpp v84, v194, v194 row_mirror row_mask:0xf bank_mask:0xc
    v_add_f32_dpp v85, v195, v195 row_mirror row_mask:0xf bank_mask:0xc
    v_add_f32_dpp v86, v198, v198 row_mirror row_mask:0xf bank_mask:0xc
    v_add_f32_dpp v87, v199, v199 row_mirror row_mask:0xf bank_mask:0xc
    v_add_f32_dpp v88, v202, v202 row_mirror row_mask:0xf bank_mask:0xc
    v_add_f32_dpp v89, v203, v203 row_mirror row_mask:0xf bank_mask:0xc
    v_add_f32_dpp v90, v206, v206 row_mirror row_mask:0xf bank_mask:0xc
    v_add_f32_dpp v91, v207, v207 row_mirror row_mask:0xf bank_mask:0xc
    s_add_u32 m0, s70, 30720
    s_mul_i32 s73, s98, 56
    s_add_u32 s73, s73, 57344
    buffer_load_dwordx4 v213, s[20:23], s73 offen lds
    v_add_f32_dpp v92, v70, v70 row_mirror row_mask:0xf bank_mask:0xc
    v_add_f32_dpp v93, v71, v71 row_mirror row_mask:0xf bank_mask:0xc
    v_add_f32_dpp v94, v74, v74 row_mirror row_mask:0xf bank_mask:0xc
    v_add_f32_dpp v95, v75, v75 row_mirror row_mask:0xf bank_mask:0xc
    v_add_f32_dpp v96, v78, v78 row_mirror row_mask:0xf bank_mask:0xc
    v_add_f32_dpp v97, v79, v79 row_mirror row_mask:0xf bank_mask:0xc
    v_add_f32_dpp v98, v82, v82 row_mirror row_mask:0xf bank_mask:0xc
    v_add_f32_dpp v99, v83, v83 row_mirror row_mask:0xf bank_mask:0xc
    s_add_u32 m0, s70, 31744
    s_mul_i32 s73, s98, 56
    s_add_u32 s73, s73, 86016
    buffer_load_dwordx4 v213, s[20:23], s73 offen lds
    v_add_f32_dpp v84, v84, v84 row_half_mirror row_mask:0xf bank_mask:0x5
    v_add_f32_dpp v86, v86, v86 row_half_mirror row_mask:0xf bank_mask:0x5
    v_add_f32_dpp v88, v88, v88 row_half_mirror row_mask:0xf bank_mask:0x5
    v_add_f32_dpp v90, v90, v90 row_half_mirror row_mask:0xf bank_mask:0x5
    v_add_f32_dpp v92, v92, v92 row_half_mirror row_mask:0xf bank_mask:0x5
    v_add_f32_dpp v94, v94, v94 row_half_mirror row_mask:0xf bank_mask:0x5
    v_add_f32_dpp v96, v96, v96 row_half_mirror row_mask:0xf bank_mask:0x5
    v_add_f32_dpp v98, v98, v98 row_half_mirror row_mask:0xf bank_mask:0x5
    v_add_f32_dpp v84, v85, v85 row_half_mirror row_mask:0xf bank_mask:0xa
    v_add_f32_dpp v86, v87, v87 row_half_mirror row_mask:0xf bank_mask:0xa
    v_add_f32_dpp v88, v89, v89 row_half_mirror row_mask:0xf bank_mask:0xa
    v_add_f32_dpp v90, v91, v91 row_half_mirror row_mask:0xf bank_mask:0xa
    v_add_f32_dpp v92, v93, v93 row_half_mirror row_mask:0xf bank_mask:0xa
    v_add_f32_dpp v94, v95, v95 row_half_mirror row_mask:0xf bank_mask:0xa
    v_add_f32_dpp v96, v97, v97 row_half_mirror row_mask:0xf bank_mask:0xa
    v_add_f32_dpp v98, v99, v99 row_half_mirror row_mask:0xf bank_mask:0xa
    v_add_f32_dpp v85, v84, v84 quad_perm:[1,0,3,2] row_mask:0xf bank_mask:0xf
    v_add_f32_dpp v87, v86, v86 quad_perm:[1,0,3,2] row_mask:0xf bank_mask:0xf
    v_add_f32_dpp v89, v88, v88 quad_perm:[1,0,3,2] row_mask:0xf bank_mask:0xf
    v_add_f32_dpp v91, v90, v90 quad_perm:[1,0,3,2] row_mask:0xf bank_mask:0xf
    v_add_f32_dpp v93, v92, v92 quad_perm:[1,0,3,2] row_mask:0xf bank_mask:0xf
    v_add_f32_dpp v95, v94, v94 quad_perm:[1,0,3,2] row_mask:0xf bank_mask:0xf
    v_add_f32_dpp v97, v96, v96 quad_perm:[1,0,3,2] row_mask:0xf bank_mask:0xf
    v_add_f32_dpp v99, v98, v98 quad_perm:[1,0,3,2] row_mask:0xf bank_mask:0xf
    v_add_f32_dpp v68, v85, v85 quad_perm:[2,3,0,1] row_mask:0xf bank_mask:0xf
    v_add_f32_dpp v69, v87, v87 quad_perm:[2,3,0,1] row_mask:0xf bank_mask:0xf
    v_add_f32_dpp v70, v89, v89 quad_perm:[2,3,0,1] row_mask:0xf bank_mask:0xf
    v_add_f32_dpp v71, v91, v91 quad_perm:[2,3,0,1] row_mask:0xf bank_mask:0xf
    v_add_f32_dpp v72, v93, v93 quad_perm:[2,3,0,1] row_mask:0xf bank_mask:0xf
    v_add_f32_dpp v73, v95, v95 quad_perm:[2,3,0,1] row_mask:0xf bank_mask:0xf
    v_add_f32_dpp v74, v97, v97 quad_perm:[2,3,0,1] row_mask:0xf bank_mask:0xf
    v_add_f32_dpp v75, v99, v99 quad_perm:[2,3,0,1] row_mask:0xf bank_mask:0xf
    v_permlane16_swap_b32 v68, v69
    v_permlane16_swap_b32 v70, v71
    v_permlane16_swap_b32 v72, v73
    v_permlane16_swap_b32 v74, v75
    v_add_f32 v84, v68, v69
    v_add_f32 v85, v72, v73
    v_add_f32 v86, v70, v71
    v_add_f32 v87, v74, v75
    v_and_b32 v65, 1, v3
    v_lshlrev_b32 v65, 6, v65
    v_lshrrev_b32 v66, 5, v1
    v_lshl_add_u32 v65, v66, 5, v65
    v_bfe_u32 v67, v1, 2, 2
    v_lshl_add_u32 v65, v67, 3, v65
    s_lshl_b32 s58, s3, 8
    v_add_u32 v65, s58, v65
    ds_write_b64 v65, v[84:85] offset:0
    ds_write_b64 v65, v[86:87] offset:128
    v_and_b32 v67, 31, v1
    v_lshlrev_b32 v65, 9, v66
    v_lshl_add_u32 v65, v67, 4, v65
    v_lshlrev_b32 v66, 8, v66
    v_lshl_add_u32 v66, v67, 3, v66
    s_and_b32 s58, s58, 512
    v_add_u32 v66, s58, v66
    s_lshl_b32 s58, s67, 1
    s_lshr_b32 s60, s3, 1
    s_add_u32 s58, s58, s60
    s_lshl_b32 s58, s58, 12
    s_add_u32 s58, s58, 0x548000
    s_lshl_b32 s60, s66, 9
    s_add_u32 s60, s60, s58
    s_waitcnt lgkmcnt(0)
    s_barrier
    ds_read_b64 v[84:85], v66 offset:0
    v_mov_b32 v89, s4
    v_mov_b32 v91, s4
    s_waitcnt lgkmcnt(0)
    v_mov_b32 v88, v84
    v_mov_b32 v90, v85
    s_nop 0
    v_permlane32_swap_b32 v88, v84
    v_permlane32_swap_b32 v90, v85
    v_add_f32 v88, v88, v84
    v_add_f32 v90, v90, v85
    s_bitcmp0_b32 s3, 0
    s_cselect_b32 exec_lo, -1, 0
    s_mov_b32 exec_hi, 0
    buffer_store_dwordx4 v[88:91], v65, s[40:43], s60 offen sc1
    s_mov_b64 exec, -1
    v_cvt_pk_bf16_f32 v240, v192, v193
    v_cvt_pk_bf16_f32 v241, v194, v195
    v_cvt_pk_bf16_f32 v242, v196, v197
    v_cvt_pk_bf16_f32 v243, v198, v199
    v_cvt_pk_bf16_f32 v244, v200, v201
    v_cvt_pk_bf16_f32 v245, v202, v203
    v_cvt_pk_bf16_f32 v246, v204, v205
    v_cvt_pk_bf16_f32 v247, v206, v207
    s_lshl_b32 s61, s66, 1
    s_and_b32 s60, s3, 1
    s_add_u32 s61, s61, s60
    s_lshl_b32 s61, s61, 7
    s_lshl_b32 s60, s67, 2
    s_add_u32 s61, s61, s60
    s_and_b32 s60, s3, 2
    s_add_u32 s61, s61, s60
    s_lshl_b32 s61, s61, 10
    s_add_u32 s61, s61, 0x200000
    v_lshlrev_b32 v66, 4, v67
    v_cmp_gt_u32 s[86:87], 32, v1
    s_add_u32 m0, s70, 0
    s_mul_i32 s73, s98, 56
    s_add_u32 s73, s73, 114688
    buffer_load_dwordx4 v213, s[20:23], s73 offen lds
    s_add_u32 m0, s70, 1024
    s_mul_i32 s73, s98, 56
    s_add_u32 s73, s73, 143360
    buffer_load_dwordx4 v213, s[20:23], s73 offen lds
    s_add_u32 m0, s70, 2048
    s_mul_i32 s73, s98, 56
    s_add_u32 s73, s73, 172032
    buffer_load_dwordx4 v213, s[20:23], s73 offen lds
    s_add_u32 m0, s70, 3072
    s_mul_i32 s73, s98, 56
    s_add_u32 s73, s73, 200704
    buffer_load_dwordx4 v213, s[20:23], s73 offen lds
    s_add_u32 m0, s70, 4096
    s_mul_i32 s73, s99, 56
    s_add_u32 s73, s73, 0
    buffer_load_dwordx4 v213, s[20:23], s73 offen lds
    s_add_u32 m0, s70, 5120
    s_mul_i32 s73, s99, 56
    s_add_u32 s73, s73, 28672
    buffer_load_dwordx4 v213, s[20:23], s73 offen lds
    s_add_u32 m0, s70, 6144
    s_mul_i32 s73, s99, 56
    s_add_u32 s73, s73, 57344
    buffer_load_dwordx4 v213, s[20:23], s73 offen lds
    s_add_u32 m0, s70, 7168
    s_mul_i32 s73, s99, 56
    s_add_u32 s73, s73, 86016
    buffer_load_dwordx4 v213, s[20:23], s73 offen lds
    s_add_u32 m0, s70, 8192
    s_mul_i32 s73, s99, 56
    s_add_u32 s73, s73, 114688
    buffer_load_dwordx4 v213, s[20:23], s73 offen lds
    s_add_u32 m0, s70, 9216
    s_mul_i32 s73, s99, 56
    s_add_u32 s73, s73, 143360
    buffer_load_dwordx4 v213, s[20:23], s73 offen lds
    s_add_u32 m0, s70, 10240
    s_mul_i32 s73, s99, 56
    s_add_u32 s73, s73, 172032
    buffer_load_dwordx4 v213, s[20:23], s73 offen lds
    s_add_u32 m0, s70, 11264
    s_mul_i32 s73, s99, 56
    s_add_u32 s73, s73, 200704
    buffer_load_dwordx4 v213, s[20:23], s73 offen lds
    s_add_u32 m0, s70, 12288
    s_mul_i32 s73, s100, 56
    s_add_u32 s73, s73, 0
    buffer_load_dwordx4 v213, s[20:23], s73 offen lds
    s_add_u32 m0, s70, 13312
    s_mul_i32 s73, s100, 56
    s_add_u32 s73, s73, 28672
    buffer_load_dwordx4 v213, s[20:23], s73 offen lds
    s_add_u32 m0, s70, 14336
    s_mul_i32 s73, s100, 56
    s_add_u32 s73, s73, 57344
    buffer_load_dwordx4 v213, s[20:23], s73 offen lds
    s_add_u32 m0, s70, 15360
    s_mul_i32 s73, s100, 56
    s_add_u32 s73, s73, 86016
    buffer_load_dwordx4 v213, s[20:23], s73 offen lds
    buffer_load_dwordx4 v[96:99], v65, s[40:43], s58 offen offset:0 sc1
    buffer_load_dwordx4 v[100:103], v65, s[40:43], s58 offen offset:1024 sc1
    buffer_load_dwordx4 v[104:107], v65, s[40:43], s58 offen offset:2048 sc1
    buffer_load_dwordx4 v[108:111], v66, s[40:43], s58 offen offset:3072 sc1
    s_sleep 5
    s_nop 0
Lst_P_6:
    s_sub_u32 s6, s6, 1
    s_cbranch_scc1 L_end_P
    buffer_load_dwordx4 v[112:115], v65, s[40:43], s58 offen offset:0 sc1
    buffer_load_dwordx4 v[116:119], v65, s[40:43], s58 offen offset:1024 sc1
    buffer_load_dwordx4 v[120:123], v65, s[40:43], s58 offen offset:2048 sc1
    buffer_load_dwordx4 v[124:127], v66, s[40:43], s58 offen offset:3072 sc1
    s_waitcnt vmcnt(4)
    v_xor_b32 v97, s4, v97
    v_xor_b32 v99, s4, v99
    v_xor_b32 v101, s4, v101
    v_xor_b32 v103, s4, v103
    v_xor_b32 v105, s4, v105
    v_xor_b32 v107, s4, v107
    v_xor_b32 v109, s4, v109
    v_xor_b32 v111, s4, v111
    v_cndmask_b32 v108, 0, v108, s[86:87]
    v_cndmask_b32 v110, 0, v110, s[86:87]
    v_or3_b32 v97, v97, v99, v101
    v_or3_b32 v103, v103, v105, v107
    v_or3_b32 v97, v97, v109, v111
    v_or_b32 v97, v97, v103
    v_cmp_ne_u32 vcc, 0, v97
    v_add_f32 v128, v96, v100
    v_add_f32 v129, v104, v108
    v_add_f32 v130, v98, v102
    v_add_f32 v131, v106, v110
    s_cbranch_vccz Lstd_P_7
    buffer_load_dwordx4 v[96:99], v65, s[40:43], s58 offen offset:0 sc1
    buffer_load_dwordx4 v[100:103], v65, s[40:43], s58 offen offset:1024 sc1
    buffer_load_dwordx4 v[104:107], v65, s[40:43], s58 offen offset:2048 sc1
    buffer_load_dwordx4 v[108:111], v66, s[40:43], s58 offen offset:3072 sc1
    s_waitcnt vmcnt(4)
    v_xor_b32 v113, s4, v113
    v_xor_b32 v115, s4, v115
    v_xor_b32 v117, s4, v117
    v_xor_b32 v119, s4, v119
    v_xor_b32 v121, s4, v121
    v_xor_b32 v123, s4, v123
    v_xor_b32 v125, s4, v125
    v_xor_b32 v127, s4, v127
    v_cndmask_b32 v124, 0, v124, s[86:87]
    v_cndmask_b32 v126, 0, v126, s[86:87]
    v_or3_b32 v113, v113, v115, v117
    v_or3_b32 v119, v119, v121, v123
    v_or3_b32 v113, v113, v125, v127
    v_or_b32 v113, v113, v119
    v_cmp_ne_u32 vcc, 0, v113
    v_add_f32 v128, v112, v116
    v_add_f32 v129, v120, v124
    v_add_f32 v130, v114, v118
    v_add_f32 v131, v122, v126
    s_cbranch_vccnz Lst_P_6
    s_nop 3
Lstd_P_7:
    v_add_f32 v128, v128, v129
    v_add_f32 v130, v130, v131
    v_mov_b32 v136, v128
    v_mov_b32 v138, v130
    s_nop 0
    v_permlane32_swap_b32 v128, v136
    v_permlane32_swap_b32 v130, v138
    v_add_f32 v128, v128, v136
    v_add_f32 v130, v130, v138
    v_mul_f32 v133, 0x3b124925, v128
    v_mul_f32 v130, 0x3b124925, v130
    v_fma_f32 v130, -v133, v133, v130
    v_max_f32 v130, 0, v130
    v_add_f32 v135, 0x3727c5ac, v130
    v_rsq_f32 v135, v135
    s_nop 0
    v_mul_f32 v130, v130, v135
    v_fmaak_f32 v130, v130, v135, 0x3727c5ac
    v_rsq_f32 v130, v130
    s_nop 0
    v_mul_f32 v135, v135, v130
    s_lshl_b32 s60, s3, 8
    v_lshl_add_u32 v66, v67, 2, s60
    ds_write_b32 v66, v133 offset:1024
    ds_write_b32 v66, v135 offset:1152
    v_lshrrev_b32 v66, 5, v1
    v_lshl_add_u32 v66, v66, 4, s60
    s_waitcnt lgkmcnt(0)
    ds_read_b128 v[140:143], v66 offset:1024
    ds_read_b128 v[156:159], v66 offset:1152
    ds_read_b128 v[144:147], v66 offset:1056
    ds_read_b128 v[160:163], v66 offset:1184
    ds_read_b128 v[148:151], v66 offset:1088
    ds_read_b128 v[164:167], v66 offset:1216
    ds_read_b128 v[152:155], v66 offset:1120
    ds_read_b128 v[168:171], v66 offset:1248
    s_waitcnt lgkmcnt(7)
    v_pk_add_f32 v[192:193], v[192:193], v[140:141] neg_lo:[0,1] neg_hi:[0,1]
    v_pk_add_f32 v[194:195], v[194:195], v[142:143] neg_lo:[0,1] neg_hi:[0,1]
    s_waitcnt lgkmcnt(5)
    v_pk_add_f32 v[196:197], v[196:197], v[144:145] neg_lo:[0,1] neg_hi:[0,1]
    v_pk_add_f32 v[198:199], v[198:199], v[146:147] neg_lo:[0,1] neg_hi:[0,1]
    v_pk_mul_f32 v[192:193], v[192:193], v[156:157]
    v_pk_mul_f32 v[194:195], v[194:195], v[158:159]
    s_waitcnt lgkmcnt(4)
    v_pk_mul_f32 v[196:197], v[196:197], v[160:161]
    v_pk_mul_f32 v[198:199], v[198:199], v[162:163]
    v_cvt_pk_bf16_f32 v84, v192, v193
    v_cvt_pk_bf16_f32 v85, v194, v195
    v_cvt_pk_bf16_f32 v86, v196, v197
    v_cvt_pk_bf16_f32 v87, v198, v199
    buffer_store_dwordx4 v[84:87], v4, s[40:43], s61 offen offset:0 sc1
    s_waitcnt lgkmcnt(3)
    v_pk_add_f32 v[200:201], v[200:201], v[148:149] neg_lo:[0,1] neg_hi:[0,1]
    v_pk_add_f32 v[202:203], v[202:203], v[150:151] neg_lo:[0,1] neg_hi:[0,1]
    s_waitcnt lgkmcnt(1)
    v_pk_add_f32 v[204:205], v[204:205], v[152:153] neg_lo:[0,1] neg_hi:[0,1]
    v_pk_add_f32 v[206:207], v[206:207], v[154:155] neg_lo:[0,1] neg_hi:[0,1]
    v_pk_mul_f32 v[200:201], v[200:201], v[164:165]
    v_pk_mul_f32 v[202:203], v[202:203], v[166:167]
    s_waitcnt lgkmcnt(0)
    v_pk_mul_f32 v[204:205], v[204:205], v[168:169]
    v_pk_mul_f32 v[206:207], v[206:207], v[170:171]
    v_cvt_pk_bf16_f32 v88, v200, v201
    v_cvt_pk_bf16_f32 v89, v202, v203
    v_cvt_pk_bf16_f32 v90, v204, v205
    v_cvt_pk_bf16_f32 v91, v206, v207
    buffer_store_dwordx4 v[88:91], v4, s[40:43], s61 offen offset:1024 sc1
    ds_read_b64_tr_b16 a[208:209], v215 offset:16384
    ds_read_b64_tr_b16 a[210:211], v215 offset:17408
    ds_read_b64_tr_b16 a[212:213], v216 offset:16384
    ds_read_b64_tr_b16 a[214:215], v216 offset:17408
    ds_read_b64_tr_b16 a[216:217], v215 offset:18432
    ds_read_b64_tr_b16 a[218:219], v215 offset:19456
    ds_read_b64_tr_b16 a[220:221], v216 offset:18432
    ds_read_b64_tr_b16 a[222:223], v216 offset:19456
    ds_read_b64_tr_b16 a[224:225], v215 offset:20480
    ds_read_b64_tr_b16 a[226:227], v215 offset:21504
    ds_read_b64_tr_b16 a[228:229], v216 offset:20480
    ds_read_b64_tr_b16 a[230:231], v216 offset:21504
    ds_read_b64_tr_b16 a[232:233], v215 offset:22528
    ds_read_b64_tr_b16 a[234:235], v215 offset:23552
    ds_read_b64_tr_b16 a[236:237], v216 offset:22528
    ds_read_b64_tr_b16 a[238:239], v216 offset:23552
    ds_read_b64_tr_b16 a[240:241], v215 offset:24576
    ds_read_b64_tr_b16 a[242:243], v215 offset:25600
    ds_read_b64_tr_b16 a[244:245], v216 offset:24576
    ds_read_b64_tr_b16 a[246:247], v216 offset:25600
    ds_read_b64_tr_b16 a[248:249], v215 offset:26624
    ds_read_b64_tr_b16 a[250:251], v215 offset:27648
    ds_read_b64_tr_b16 a[252:253], v216 offset:26624
    ds_read_b64_tr_b16 a[254:255], v216 offset:27648
    ds_read_b64_tr_b16 a[0:1], v215 offset:28672
    ds_read_b64_tr_b16 a[2:3], v215 offset:29696
    ds_read_b64_tr_b16 a[4:5], v216 offset:28672
    ds_read_b64_tr_b16 a[6:7], v216 offset:29696
    ds_read_b64_tr_b16 a[8:9], v215 offset:30720
    ds_read_b64_tr_b16 a[10:11], v215 offset:31744
    ds_read_b64_tr_b16 a[12:13], v216 offset:30720
    ds_read_b64_tr_b16 a[14:15], v216 offset:31744
    ds_read_b64_tr_b16 a[16:17], v215 offset:0
    ds_read_b64_tr_b16 a[18:19], v215 offset:1024
    ds_read_b64_tr_b16 a[20:21], v216 offset:0
    ds_read_b64_tr_b16 a[22:23], v216 offset:1024
    ds_read_b64_tr_b16 a[24:25], v215 offset:2048
    ds_read_b64_tr_b16 a[26:27], v215 offset:3072
    ds_read_b64_tr_b16 a[28:29], v216 offset:2048
    ds_read_b64_tr_b16 a[30:31], v216 offset:3072
    ds_read_b64_tr_b16 a[32:33], v215 offset:4096
    ds_read_b64_tr_b16 a[34:35], v215 offset:5120
    ds_read_b64_tr_b16 a[36:37], v216 offset:4096
    ds_read_b64_tr_b16 a[38:39], v216 offset:5120
    ds_read_b64_tr_b16 a[40:41], v215 offset:6144
    ds_read_b64_tr_b16 a[42:43], v215 offset:7168
    ds_read_b64_tr_b16 a[44:45], v216 offset:6144
    ds_read_b64_tr_b16 a[46:47], v216 offset:7168
    ds_read_b64_tr_b16 a[48:49], v215 offset:8192
    ds_read_b64_tr_b16 a[50:51], v215 offset:9216
    ds_read_b64_tr_b16 a[52:53], v216 offset:8192
    ds_read_b64_tr_b16 a[54:55], v216 offset:9216
    ds_read_b64_tr_b16 a[56:57], v215 offset:10240
    ds_read_b64_tr_b16 a[58:59], v215 offset:11264
    ds_read_b64_tr_b16 a[60:61], v216 offset:10240
    ds_read_b64_tr_b16 a[62:63], v216 offset:11264
    ds_read_b64_tr_b16 a[64:65], v215 offset:12288
    ds_read_b64_tr_b16 a[66:67], v215 offset:13312
    ds_read_b64_tr_b16 a[68:69], v216 offset:12288
    ds_read_b64_tr_b16 a[70:71], v216 offset:13312
    ds_read_b64_tr_b16 a[72:73], v215 offset:14336
    ds_read_b64_tr_b16 a[74:75], v215 offset:15360
    ds_read_b64_tr_b16 a[76:77], v216 offset:14336
    ds_read_b64_tr_b16 a[78:79], v216 offset:15360
    s_waitcnt vmcnt(0)
    v_mov_b32 v8, s4
    s_mov_b64 exec, 1
    buffer_store_dword v8, v9, s[40:43], s81 offen sc1
    s_mov_b64 exec, -1
    s_waitcnt lgkmcnt(4)
    s_add_u32 m0, s70, 12288
    s_mul_i32 s73, s100, 56
    s_add_u32 s73, s73, 114688
    buffer_load_dwordx4 v213, s[20:23], s73 offen lds
    s_add_u32 m0, s70, 13312
    s_mul_i32 s73, s100, 56
    s_add_u32 s73, s73, 143360
    buffer_load_dwordx4 v213, s[20:23], s73 offen lds
    s_waitcnt lgkmcnt(0)
    s_add_u32 m0, s70, 14336
    s_mul_i32 s73, s100, 56
    s_add_u32 s73, s73, 172032
    buffer_load_dwordx4 v213, s[20:23], s73 offen lds
    s_add_u32 m0, s70, 15360
    s_mul_i32 s73, s100, 56
    s_add_u32 s73, s73, 200704
    buffer_load_dwordx4 v213, s[20:23], s73 offen lds
    s_add_u32 m0, s70, 16384
    s_mul_i32 s73, s101, 56
    s_add_u32 s73, s73, 0
    buffer_load_dwordx4 v213, s[20:23], s73 offen lds
    s_add_u32 m0, s70, 17408
    s_mul_i32 s73, s101, 56
    s_add_u32 s73, s73, 28672
    buffer_load_dwordx4 v213, s[20:23], s73 offen lds
    s_add_u32 m0, s70, 18432
    s_mul_i32 s73, s101, 56
    s_add_u32 s73, s73, 57344
    buffer_load_dwordx4 v213, s[20:23], s73 offen lds
    s_add_u32 m0, s70, 19456
    s_mul_i32 s73, s101, 56
    s_add_u32 s73, s73, 86016
    buffer_load_dwordx4 v213, s[20:23], s73 offen lds
    s_add_u32 m0, s70, 20480
    s_mul_i32 s73, s101, 56
    s_add_u32 s73, s73, 114688
    buffer_load_dwordx4 v213, s[20:23], s73 offen lds
    s_add_u32 m0, s70, 21504
    s_mul_i32 s73, s101, 56
    s_add_u32 s73, s73, 143360
    buffer_load_dwordx4 v213, s[20:23], s73 offen lds
    s_add_u32 m0, s70, 22528
    s_mul_i32 s73, s101, 56
    s_add_u32 s73, s73, 172032
    buffer_load_dwordx4 v213, s[20:23], s73 offen lds
    s_add_u32 m0, s70, 23552
    s_mul_i32 s73, s101, 56
    s_add_u32 s73, s73, 200704
    buffer_load_dwordx4 v213, s[20:23], s73 offen lds
    s_add_u32 m0, s70, 24576
    s_mul_i32 s73, s48, 64
    s_add_u32 s73, s73, 0
    buffer_load_dwordx4 v214, s[24:27], s73 offen lds
    s_add_u32 m0, s70, 25600
    s_mul_i32 s73, s48, 64
    s_add_u32 s73, s73, 32768
    buffer_load_dwordx4 v214, s[24:27], s73 offen lds
    s_add_u32 m0, s70, 26624
    s_mul_i32 s73, s48, 64
    s_add_u32 s73, s73, 65536
    buffer_load_dwordx4 v214, s[24:27], s73 offen lds
    s_add_u32 m0, s70, 27648
    s_mul_i32 s73, s48, 64
    s_add_u32 s73, s73, 98304
    buffer_load_dwordx4 v214, s[24:27], s73 offen lds
    s_add_u32 m0, s70, 28672
    s_mul_i32 s73, s48, 64
    s_add_u32 s73, s73, 131072
    buffer_load_dwordx4 v214, s[24:27], s73 offen lds
    s_add_u32 m0, s70, 29696
    s_mul_i32 s73, s48, 64
    s_add_u32 s73, s73, 163840
    buffer_load_dwordx4 v214, s[24:27], s73 offen lds
    s_add_u32 m0, s70, 30720
    s_mul_i32 s73, s48, 64
    s_add_u32 s73, s73, 196608
    buffer_load_dwordx4 v214, s[24:27], s73 offen lds
    s_add_u32 m0, s70, 31744
    s_mul_i32 s73, s48, 64
    s_add_u32 s73, s73, 229376
    buffer_load_dwordx4 v214, s[24:27], s73 offen lds
    s_add_u32 m0, s70, 32768
    s_mul_i32 s73, s49, 64
    s_add_u32 s73, s73, 0
    buffer_load_dwordx4 v214, s[24:27], s73 offen lds
    s_add_u32 m0, s70, 33792
    s_mul_i32 s73, s49, 64
    s_add_u32 s73, s73, 32768
    buffer_load_dwordx4 v214, s[24:27], s73 offen lds
    s_add_u32 m0, s70, 34816
    s_mul_i32 s73, s49, 64
    s_add_u32 s73, s73, 65536
    buffer_load_dwordx4 v214, s[24:27], s73 offen lds
    s_add_u32 m0, s70, 35840
    s_mul_i32 s73, s49, 64
    s_add_u32 s73, s73, 98304
    buffer_load_dwordx4 v214, s[24:27], s73 offen lds
    s_lshl_b32 s71, s64, 18
    s_lshl_b32 s86, s3, 15
    s_add_u32 s71, s71, s86
    s_add_u32 s71, s71, 0x200000
    s_add_u32 s72, s71, 0x20000
    s_mul_i32 s58, s66, 229376
    s_add_u32 s58, s58, 0x3c0000
    s_lshl_b32 s86, s65, 2
    s_add_u32 s86, s86, s3
    s_lshl_b32 s86, s86, 10
    s_add_u32 s57, s58, s86
    s_mul_i32 s86, s3, 28672
    s_add_u32 s58, s58, s86
    s_add_u32 s59, s58, 114688
    v_lshrrev_b32 v208, 5, v1
    v_lshlrev_b32 v208, 3, v208
    s_lshl_b32 s86, s65, 7
    s_lshl_b32 s87, s3, 5
    s_add_u32 s86, s86, s87
    buffer_load_dwordx2 v[220:221], v208, s[28:31], s86 offen offset:0
    buffer_load_dwordx2 v[222:223], v208, s[28:31], s86 offen offset:16
    s_lshl_b32 s86, s67, 7
    s_lshr_b32 s87, s3, 1
    s_lshl_b32 s87, s87, 6
    s_add_u32 s86, s86, s87
    buffer_load_dwordx2 v[224:225], v208, s[32:35], s86 offen offset:0
    buffer_load_dwordx2 v[226:227], v208, s[32:35], s86 offen offset:16
    buffer_load_dwordx2 v[228:229], v208, s[32:35], s86 offen offset:32
    buffer_load_dwordx2 v[230:231], v208, s[32:35], s86 offen offset:48
    v_add_u32 v232, s70, v4
    s_xor_b32 s86, s3, 1
    s_mul_i32 s86, s86, 36864
    s_add_u32 s86, s86, 12288
    v_add_u32 v233, s86, v4
    s_xor_b32 s86, s3, 2
    s_mul_i32 s86, s86, 36864
    s_add_u32 s86, s86, 14336
    v_add_u32 v234, s86, v4
    s_xor_b32 s86, s3, 3
    s_mul_i32 s86, s86, 36864
    s_add_u32 s86, s86, 16384
    v_add_u32 v235, s86, v4
    v_lshrrev_b32 v208, 5, v1
    v_lshlrev_b32 v208, 9, v208
    v_and_b32 v209, 31, v1
    v_lshl_add_u32 v208, v209, 2, v208
    s_lshr_b32 s86, s3, 1
    s_lshl_b32 s86, s86, 12
    v_add_u32 v208, s86, v208
    v_xor_b32 v209, 0x1000, v208
    v_add_u32 v236, s70, v208
    v_add_u32 v237, s70, v209
    s_lshl_b32 s86, s3, 11
    s_add_u32 s86, s86, 12288
    v_add_u32 v238, s86, v4
    v_add_u32 v239, 73728, v238
    v_lshrrev_b32 v208, 3, v1
    v_mul_u32_u24 v212, 896, v208
    v_and_b32 v208, 7, v1
    v_lshl_add_u32 v212, v208, 3, v212
    s_lshl_b32 s68, s67, 2
    s_add_u32 s68, s68, s3
    s_mul_i32 s68, s68, 14336
    s_lshl_b32 s86, s66, 7
    s_add_u32 s68, s68, s86
    s_add_u32 s69, s68, 7168
    s_mov_b32 s88, 0xc0135761
    s_mov_b32 s89, 0xc0135761
    s_mov_b32 s90, 0xbdd2d3e8
    s_mov_b32 s91, 0xffff0000
    buffer_load_dword v249, v11, s[40:43], s84 offen sc1
    s_sleep 3
    buffer_load_dword v250, v11, s[40:43], s84 offen sc1
    s_sleep 3
    s_nop 0
Lpoll_P_8:
    s_sub_u32 s6, s6, 1
    s_cbranch_scc1 L_end_P
    buffer_load_dword v251, v11, s[40:43], s84 offen sc1
    s_waitcnt vmcnt(2)
    v_cmp_ne_u32 vcc, s4, v249
    s_nop 1
    s_cbranch_vccz Lpd_P_9
    buffer_load_dword v249, v11, s[40:43], s84 offen sc1
    s_waitcnt vmcnt(2)
    v_cmp_ne_u32 vcc, s4, v250
    s_nop 1
    s_cbranch_vccz Lpd_P_9
    buffer_load_dword v250, v11, s[40:43], s84 offen sc1
    s_waitcnt vmcnt(2)
    v_cmp_ne_u32 vcc, s4, v251
    s_nop 1
    s_cbranch_vccnz Lpoll_P_8
    s_nop 1
Lpd_P_9:
    s_add_u32 s56, s71, s94
    buffer_load_dwordx4 v[80:83], v5, s[40:43], s56 offen offset:0 sc1
    buffer_load_dwordx4 v[84:87], v5, s[40:43], s56 offen offset:1024 sc1
    buffer_load_dwordx4 v[88:91], v5, s[40:43], s56 offen offset:2048 sc1
    buffer_load_dwordx4 v[92:95], v5, s[40:43], s56 offen offset:3072 sc1
    s_add_u32 s56, s71, s95
    buffer_load_dwordx4 v[96:99], v5, s[40:43], s56 offen offset:0 sc1
    buffer_load_dwordx4 v[100:103], v5, s[40:43], s56 offen offset:1024 sc1
    buffer_load_dwordx4 v[104:107], v5, s[40:43], s56 offen offset:2048 sc1
    buffer_load_dwordx4 v[108:111], v5, s[40:43], s56 offen offset:3072 sc1
    v_lshlrev_b32 v16, 16, v220
    v_and_b32 v17, s91, v220
    v_lshlrev_b32 v18, 16, v221
    v_and_b32 v19, s91, v221
    v_lshlrev_b32 v20, 16, v222
    v_and_b32 v21, s91, v222
    v_lshlrev_b32 v22, 16, v223
    v_and_b32 v23, s91, v223
    v_mov_b64 v[24:25], 0
    v_mov_b64 v[26:27], 0
    v_mov_b64 v[28:29], 0
    v_mov_b64 v[30:31], 0
    ds_read_b64_tr_b16 a[80:81], v215 offset:12288
    ds_read_b64_tr_b16 a[82:83], v215 offset:13312
    ds_read_b64_tr_b16 a[84:85], v216 offset:12288
    ds_read_b64_tr_b16 a[86:87], v216 offset:13312
    ds_read_b64_tr_b16 a[88:89], v215 offset:14336
    ds_read_b64_tr_b16 a[90:91], v215 offset:15360
    ds_read_b64_tr_b16 a[92:93], v216 offset:14336
    ds_read_b64_tr_b16 a[94:95], v216 offset:15360
    ds_read_b64_tr_b16 a[96:97], v215 offset:16384
    ds_read_b64_tr_b16 a[98:99], v215 offset:17408
    ds_read_b64_tr_b16 a[100:101], v216 offset:16384
    ds_read_b64_tr_b16 a[102:103], v216 offset:17408
    ds_read_b64_tr_b16 a[104:105], v215 offset:18432
    ds_read_b64_tr_b16 a[106:107], v215 offset:19456
    ds_read_b64_tr_b16 a[108:109], v216 offset:18432
    ds_read_b64_tr_b16 a[110:111], v216 offset:19456
    ds_read_b64_tr_b16 a[112:113], v215 offset:20480
    ds_read_b64_tr_b16 a[114:115], v215 offset:21504
    ds_read_b64_tr_b16 a[116:117], v216 offset:20480
    ds_read_b64_tr_b16 a[118:119], v216 offset:21504
    ds_read_b64_tr_b16 a[120:121], v215 offset:22528
    ds_read_b64_tr_b16 a[122:123], v215 offset:23552
    ds_read_b64_tr_b16 a[124:125], v216 offset:22528
    ds_read_b64_tr_b16 a[126:127], v216 offset:23552
    v_mov_b32 v9, v5
    s_add_u32 s56, s71, s96
    buffer_load_dwordx4 v[112:115], v5, s[40:43], s56 offen offset:0 sc1
    buffer_load_dwordx4 v[116:119], v5, s[40:43], s56 offen offset:1024 sc1
    s_waitcnt vmcnt(9)
    v_mfma_f32_32x32x16_bf16 v[16:31], a[128:131], v[80:83], v[16:31]
    v_mfma_f32_32x32x16_bf16 v[32:47], a[132:135], v[80:83], 0
    buffer_load_dwordx4 v[120:123], v5, s[40:43], s56 offen offset:2048 sc1
    s_waitcnt vmcnt(9)
    v_mfma_f32_32x32x16_bf16 v[16:31], a[136:139], v[84:87], v[16:31]
    v_mfma_f32_32x32x16_bf16 v[32:47], a[140:143], v[84:87], v[32:47]
    buffer_load_dwordx4 v[124:127], v5, s[40:43], s56 offen offset:3072 sc1
    s_waitcnt vmcnt(9)
    v_mfma_f32_32x32x16_bf16 v[16:31], a[144:147], v[88:91], v[16:31]
    v_mfma_f32_32x32x16_bf16 v[32:47], a[148:151], v[88:91], v[32:47]
    s_add_u32 s56, s71, s97
    buffer_load_dwordx4 v[128:131], v5, s[40:43], s56 offen offset:0 sc1
    s_waitcnt vmcnt(9)
    v_mfma_f32_32x32x16_bf16 v[16:31], a[152:155], v[92:95], v[16:31]
    v_mfma_f32_32x32x16_bf16 v[32:47], a[156:159], v[92:95], v[32:47]
    buffer_load_dwordx4 v[132:135], v5, s[40:43], s56 offen offset:1024 sc1
    s_waitcnt vmcnt(9)
    v_mfma_f32_32x32x16_bf16 v[16:31], a[160:163], v[96:99], v[16:31]
    v_mfma_f32_32x32x16_bf16 v[32:47], a[164:167], v[96:99], v[32:47]
    buffer_load_dwordx4 v[136:139], v5, s[40:43], s56 offen offset:2048 sc1
    s_waitcnt vmcnt(9)
    v_mfma_f32_32x32x16_bf16 v[16:31], a[168:171], v[100:103], v[16:31]
    v_mfma_f32_32x32x16_bf16 v[32:47], a[172:175], v[100:103], v[32:47]
    buffer_load_dwordx4 v[140:143], v5, s[40:43], s56 offen offset:3072 sc1
    s_waitcnt vmcnt(9)
    v_mfma_f32_32x32x16_bf16 v[16:31], a[176:179], v[104:107], v[16:31]
    v_mfma_f32_32x32x16_bf16 v[32:47], a[180:183], v[104:107], v[32:47]
    s_add_u32 s56, s71, s98
    buffer_load_dwordx4 v[144:147], v5, s[40:43], s56 offen offset:0 sc1
    s_waitcnt vmcnt(9)
    v_mfma_f32_32x32x16_bf16 v[16:31], a[184:187], v[108:111], v[16:31]
    v_mfma_f32_32x32x16_bf16 v[32:47], a[188:191], v[108:111], v[32:47]
    buffer_load_dwordx4 v[148:151], v5, s[40:43], s56 offen offset:1024 sc1
    s_waitcnt vmcnt(9)
    v_mfma_f32_32x32x16_bf16 v[16:31], a[192:195], v[112:115], v[16:31]
    v_mfma_f32_32x32x16_bf16 v[32:47], a[196:199], v[112:115], v[32:47]
    buffer_load_dwordx4 v[152:155], v5, s[40:43], s56 offen offset:2048 sc1
    s_waitcnt vmcnt(9)
    v_mfma_f32_32x32x16_bf16 v[16:31], a[200:203], v[116:119], v[16:31]
    v_mfma_f32_32x32x16_bf16 v[32:47], a[204:207], v[116:119], v[32:47]
    buffer_load_dwordx4 v[156:159], v5, s[40:43], s56 offen offset:3072 sc1
    s_waitcnt vmcnt(9)
    v_mfma_f32_32x32x16_bf16 v[16:31], a[208:211], v[120:123], v[16:31]
    v_mfma_f32_32x32x16_bf16 v[32:47], a[212:215], v[120:123], v[32:47]
    s_add_u32 s56, s71, s99
    buffer_load_dwordx4 v[160:163], v5, s[40:43], s56 offen offset:0 sc1
    s_waitcnt vmcnt(9)
    v_mfma_f32_32x32x16_bf16 v[16:31], a[216:219], v[124:127], v[16:31]
    v_mfma_f32_32x32x16_bf16 v[32:47], a[220:223], v[124:127], v[32:47]
    buffer_load_dwordx4 v[164:167], v5, s[40:43], s56 offen offset:1024 sc1
    s_waitcnt vmcnt(9)
    v_mfma_f32_32x32x16_bf16 v[16:31], a[224:227], v[128:131], v[16:31]
    v_mfma_f32_32x32x16_bf16 v[32:47], a[228:231], v[128:131], v[32:47]
    buffer_load_dwordx4 v[168:171], v5, s[40:43], s56 offen offset:2048 sc1
    s_waitcnt vmcnt(9)
    v_mfma_f32_32x32x16_bf16 v[16:31], a[232:235], v[132:135], v[16:31]
    v_mfma_f32_32x32x16_bf16 v[32:47], a[236:239], v[132:135], v[32:47]
    buffer_load_dwordx4 v[172:175], v5, s[40:43], s56 offen offset:3072 sc1
    s_waitcnt vmcnt(9)
    v_mfma_f32_32x32x16_bf16 v[16:31], a[240:243], v[136:139], v[16:31]
    v_mfma_f32_32x32x16_bf16 v[32:47], a[244:247], v[136:139], v[32:47]
    s_add_u32 s56, s71, s100
    buffer_load_dwordx4 v[176:179], v5, s[40:43], s56 offen offset:0 sc1
    s_waitcnt vmcnt(9)
    v_mfma_f32_32x32x16_bf16 v[16:31], a[248:251], v[140:143], v[16:31]
    v_mfma_f32_32x32x16_bf16 v[32:47], a[252:255], v[140:143], v[32:47]
    buffer_load_dwordx4 v[180:183], v5, s[40:43], s56 offen offset:1024 sc1
    s_waitcnt vmcnt(9)
    v_mfma_f32_32x32x16_bf16 v[16:31], a[0:3], v[144:147], v[16:31]
    v_mfma_f32_32x32x16_bf16 v[32:47], a[4:7], v[144:147], v[32:47]
    s_barrier
    buffer_load_dwordx4 v[184:187], v5, s[40:43], s56 offen offset:2048 sc1
    s_waitcnt vmcnt(9)
    v_mfma_f32_32x32x16_bf16 v[16:31], a[8:11], v[148:151], v[16:31]
    v_mfma_f32_32x32x16_bf16 v[32:47], a[12:15], v[148:151], v[32:47]
    buffer_load_dwordx4 v[188:191], v5, s[40:43], s56 offen offset:3072 sc1
    s_waitcnt vmcnt(9)
    v_mfma_f32_32x32x16_bf16 v[16:31], a[16:19], v[152:155], v[16:31]
    v_mfma_f32_32x32x16_bf16 v[32:47], a[20:23], v[152:155], v[32:47]
    s_add_u32 s56, s71, s101
    buffer_load_dwordx4 v[192:195], v5, s[40:43], s56 offen offset:0 sc1
    s_waitcnt vmcnt(9)
    v_mfma_f32_32x32x16_bf16 v[16:31], a[24:27], v[156:159], v[16:31]
    v_mfma_f32_32x32x16_bf16 v[32:47], a[28:31], v[156:159], v[32:47]
    buffer_load_dwordx4 v[196:199], v5, s[40:43], s56 offen offset:1024 sc1
    s_waitcnt vmcnt(9)
    v_mfma_f32_32x32x16_bf16 v[16:31], a[32:35], v[160:163], v[16:31]
    v_mfma_f32_32x32x16_bf16 v[32:47], a[36:39], v[160:163], v[32:47]
    v_lshlrev_b32 v48, 16, v220
    v_and_b32 v49, s91, v220
    v_lshlrev_b32 v50, 16, v221
    v_and_b32 v51, s91, v221
    buffer_load_dwordx4 v[200:203], v5, s[40:43], s56 offen offset:2048 sc1
    s_waitcnt vmcnt(9)
    v_mfma_f32_32x32x16_bf16 v[16:31], a[40:43], v[164:167], v[16:31]
    v_mfma_f32_32x32x16_bf16 v[32:47], a[44:47], v[164:167], v[32:47]
    v_lshlrev_b32 v52, 16, v222
    v_and_b32 v53, s91, v222
    v_lshlrev_b32 v54, 16, v223
    v_and_b32 v55, s91, v223
    buffer_load_dwordx4 v[204:207], v5, s[40:43], s56 offen offset:3072 sc1
    s_waitcnt vmcnt(9)
    v_mfma_f32_32x32x16_bf16 v[16:31], a[48:51], v[168:171], v[16:31]
    v_mfma_f32_32x32x16_bf16 v[32:47], a[52:55], v[168:171], v[32:47]
    v_mov_b64 v[56:57], 0
    v_mov_b64 v[58:59], 0
    v_mov_b64 v[60:61], 0
    v_mov_b64 v[62:63], 0
    s_add_u32 s56, s72, s94
    buffer_load_dwordx4 v[80:83], v5, s[40:43], s56 offen offset:0 sc1
    s_waitcnt vmcnt(9)
    v_mfma_f32_32x32x16_bf16 v[16:31], a[56:59], v[172:175], v[16:31]
    v_mfma_f32_32x32x16_bf16 v[32:47], a[60:63], v[172:175], v[32:47]
    buffer_load_dwordx4 v[84:87], v5, s[40:43], s56 offen offset:1024 sc1
    s_waitcnt vmcnt(9)
    v_mfma_f32_32x32x16_bf16 v[16:31], a[64:67], v[176:179], v[16:31]
    v_mfma_f32_32x32x16_bf16 v[32:47], a[68:71], v[176:179], v[32:47]
    s_waitcnt lgkmcnt(15)
    s_add_u32 m0, s70, 12288
    s_mul_i32 s73, s49, 64
    s_add_u32 s73, s73, 131072
    buffer_load_dwordx4 v214, s[24:27], s73 offen lds
    s_add_u32 m0, s70, 13312
    s_mul_i32 s73, s49, 64
    s_add_u32 s73, s73, 163840
    buffer_load_dwordx4 v214, s[24:27], s73 offen lds
    buffer_load_dwordx4 v[88:91], v5, s[40:43], s56 offen offset:2048 sc1
    s_waitcnt vmcnt(11)
    v_mfma_f32_32x32x16_bf16 v[16:31], a[72:75], v[180:183], v[16:31]
    v_mfma_f32_32x32x16_bf16 v[32:47], a[76:79], v[180:183], v[32:47]
    s_add_u32 m0, s70, 14336
    s_mul_i32 s73, s49, 64
    s_add_u32 s73, s73, 196608
    buffer_load_dwordx4 v214, s[24:27], s73 offen lds
    s_add_u32 m0, s70, 15360
    s_mul_i32 s73, s49, 64
    s_add_u32 s73, s73, 229376
    buffer_load_dwordx4 v214, s[24:27], s73 offen lds
    buffer_load_dwordx4 v[92:95], v5, s[40:43], s56 offen offset:3072 sc1
    s_waitcnt vmcnt(13)
    v_mfma_f32_32x32x16_bf16 v[16:31], a[80:83], v[184:187], v[16:31]
    v_mfma_f32_32x32x16_bf16 v[32:47], a[84:87], v[184:187], v[32:47]
    s_waitcnt lgkmcnt(12)
    s_add_u32 m0, s70, 16384
    s_mul_i32 s73, s50, 64
    s_add_u32 s73, s73, 0
    buffer_load_dwordx4 v214, s[24:27], s73 offen lds
    s_add_u32 m0, s70, 17408
    s_mul_i32 s73, s50, 64
    s_add_u32 s73, s73, 32768
    buffer_load_dwordx4 v214, s[24:27], s73 offen lds
    s_add_u32 s56, s72, s95
    buffer_load_dwordx4 v[96:99], v5, s[40:43], s56 offen offset:0 sc1
    s_waitcnt vmcnt(15)
    v_mfma_f32_32x32x16_bf16 v[16:31], a[88:91], v[188:191], v[16:31]
    v_mfma_f32_32x32x16_bf16 v[32:47], a[92:95], v[188:191], v[32:47]
    s_waitcnt lgkmcnt(8)
    s_add_u32 m0, s70, 18432
    s_mul_i32 s73, s50, 64
    s_add_u32 s73, s73, 65536
    buffer_load_dwordx4 v214, s[24:27], s73 offen lds
    s_add_u32 m0, s70, 19456
    s_mul_i32 s73, s50, 64
    s_add_u32 s73, s73, 98304
    buffer_load_dwordx4 v214, s[24:27], s73 offen lds
    buffer_load_dwordx4 v[100:103], v5, s[40:43], s56 offen offset:1024 sc1
    s_waitcnt vmcnt(17)
    v_mfma_f32_32x32x16_bf16 v[16:31], a[96:99], v[192:195], v[16:31]
    v_mfma_f32_32x32x16_bf16 v[32:47], a[100:103], v[192:195], v[32:47]
    s_waitcnt lgkmcnt(4)
    s_add_u32 m0, s70, 20480
    s_mul_i32 s73, s50, 64
    s_add_u32 s73, s73, 131072
    buffer_load_dwordx4 v214, s[24:27], s73 offen lds
    s_add_u32 m0, s70, 21504
    s_mul_i32 s73, s50, 64
    s_add_u32 s73, s73, 163840
    buffer_load_dwordx4 v214, s[24:27], s73 offen lds
    buffer_load_dwordx4 v[104:107], v5, s[40:43], s56 offen offset:2048 sc1
    s_waitcnt vmcnt(19)
    v_mfma_f32_32x32x16_bf16 v[16:31], a[104:107], v[196:199], v[16:31]
    v_mfma_f32_32x32x16_bf16 v[32:47], a[108:111], v[196:199], v[32:47]
    s_waitcnt lgkmcnt(0)
    s_add_u32 m0, s70, 22528
    s_mul_i32 s73, s50, 64
    s_add_u32 s73, s73, 196608
    buffer_load_dwordx4 v214, s[24:27], s73 offen lds
    s_add_u32 m0, s70, 23552
    s_mul_i32 s73, s50, 64
    s_add_u32 s73, s73, 229376
    buffer_load_dwordx4 v214, s[24:27], s73 offen lds
    buffer_load_dwordx4 v[108:111], v5, s[40:43], s56 offen offset:3072 sc1
    s_waitcnt vmcnt(21)
    v_mfma_f32_32x32x16_bf16 v[16:31], a[112:115], v[200:203], v[16:31]
    v_mfma_f32_32x32x16_bf16 v[32:47], a[116:119], v[200:203], v[32:47]
    s_add_u32 s56, s72, s96
    buffer_load_dwordx4 v[112:115], v5, s[40:43], s56 offen offset:0 sc1
    s_waitcnt vmcnt(21)
    v_mfma_f32_32x32x16_bf16 v[16:31], a[120:123], v[204:207], v[16:31]
    v_mfma_f32_32x32x16_bf16 v[32:47], a[124:127], v[204:207], v[32:47]
    buffer_load_dwordx4 v[116:119], v5, s[40:43], s56 offen offset:1024 sc1
    s_waitcnt vmcnt(21)
    v_mfma_f32_32x32x16_bf16 v[48:63], a[128:131], v[80:83], v[48:63]
    v_mfma_f32_32x32x16_bf16 v[64:79], a[132:135], v[80:83], 0
    s_nop 7
    ds_write_b128 v235, v[40:43] offset:0
    ds_write_b128 v235, v[44:47] offset:1024
    ds_write_b128 v234, v[32:35] offset:0
    buffer_load_dwordx4 v[120:123], v5, s[40:43], s56 offen offset:2048 sc1
    s_waitcnt vmcnt(21)
    v_mfma_f32_32x32x16_bf16 v[48:63], a[136:139], v[84:87], v[48:63]
    v_mfma_f32_32x32x16_bf16 v[64:79], a[140:143], v[84:87], v[64:79]
    ds_write_b128 v234, v[36:39] offset:1024
    ds_write_b128 v233, v[24:27] offset:0
    ds_write_b128 v233, v[28:31] offset:1024
    buffer_load_dwordx4 v[124:127], v5, s[40:43], s56 offen offset:3072 sc1
    s_waitcnt vmcnt(19)
    v_mfma_f32_32x32x16_bf16 v[48:63], a[144:147], v[88:91], v[48:63]
    v_mfma_f32_32x32x16_bf16 v[64:79], a[148:151], v[88:91], v[64:79]
    s_waitcnt lgkmcnt(0)
    s_barrier
    ds_read_b128 v[24:27], v232 offset:0
    ds_read_b128 v[32:35], v232 offset:2048
    ds_read_b128 v[40:43], v232 offset:4096
    ds_read_b128 v[28:31], v232 offset:1024
    ds_read_b128 v[36:39], v232 offset:3072
    ds_read_b128 v[44:47], v232 offset:5120
    s_add_u32 s56, s72, s97
    buffer_load_dwordx4 v[128:131], v5, s[40:43], s56 offen offset:0 sc1
    s_waitcnt vmcnt(17)
    v_mfma_f32_32x32x16_bf16 v[48:63], a[152:155], v[92:95], v[48:63]
    v_mfma_f32_32x32x16_bf16 v[64:79], a[156:159], v[92:95], v[64:79]
    buffer_load_dwordx4 v[132:135], v5, s[40:43], s56 offen offset:1024 sc1
    s_waitcnt vmcnt(15)
    v_mfma_f32_32x32x16_bf16 v[48:63], a[160:163], v[96:99], v[48:63]
    v_mfma_f32_32x32x16_bf16 v[64:79], a[164:167], v[96:99], v[64:79]
    v_mov_b32 v211, s88
    s_waitcnt lgkmcnt(4)
    v_add_f32 v24, v24, v32
    s_waitcnt lgkmcnt(3)
    v_add_f32 v16, v16, v40
    v_add_f32 v25, v25, v33
    v_add_f32 v17, v17, v41
    v_add_f32 v26, v26, v34
    v_add_f32 v18, v18, v42
    v_add_f32 v27, v27, v35
    v_add_f32 v19, v19, v43
    s_waitcnt lgkmcnt(1)
    v_add_f32 v28, v28, v36
    s_waitcnt lgkmcnt(0)
    v_add_f32 v20, v20, v44
    v_add_f32 v29, v29, v37
    v_add_f32 v21, v21, v45
    v_add_f32 v30, v30, v38
    v_add_f32 v22, v22, v46
    v_add_f32 v31, v31, v39
    buffer_load_dwordx4 v[136:139], v5, s[40:43], s56 offen offset:2048 sc1
    s_waitcnt vmcnt(13)
    v_mfma_f32_32x32x16_bf16 v[48:63], a[168:171], v[100:103], v[48:63]
    v_mfma_f32_32x32x16_bf16 v[64:79], a[172:175], v[100:103], v[64:79]
    v_add_f32 v23, v23, v47
    v_add_f32 v16, v16, v24
    v_add_f32 v17, v17, v25
    v_add_f32 v18, v18, v26
    v_add_f32 v19, v19, v27
    v_add_f32 v20, v20, v28
    v_add_f32 v21, v21, v29
    v_add_f32 v22, v22, v30
    v_add_f32 v23, v23, v31
    v_mul_f32 v24, v16, v16
    v_mul_f32 v25, v17, v17
    v_mul_f32 v26, v18, v18
    v_mul_f32 v27, v19, v19
    v_mul_f32 v28, v20, v20
    v_mul_f32 v29, v21, v21
    v_mul_f32 v30, v22, v22
    buffer_load_dwordx4 v[140:143], v5, s[40:43], s56 offen offset:3072 sc1
    s_waitcnt vmcnt(11)
    v_mfma_f32_32x32x16_bf16 v[48:63], a[176:179], v[104:107], v[48:63]
    v_mfma_f32_32x32x16_bf16 v[64:79], a[180:183], v[104:107], v[64:79]
    v_mul_f32 v31, v23, v23
    v_fma_f32 v24, v24, s90, v211
    v_fma_f32 v25, v25, s90, v211
    v_fma_f32 v26, v26, s90, v211
    v_fma_f32 v27, v27, s90, v211
    v_fma_f32 v28, v28, s90, v211
    v_fma_f32 v29, v29, s90, v211
    v_fma_f32 v30, v30, s90, v211
    v_fma_f32 v31, v31, s90, v211
    v_mul_f32 v24, v24, v16
    v_mul_f32 v25, v25, v17
    v_mul_f32 v26, v26, v18
    v_mul_f32 v27, v27, v19
    v_mul_f32 v28, v28, v20
    v_mul_f32 v29, v29, v21
    v_mul_f32 v30, v30, v22
    s_add_u32 s56, s72, s98
    buffer_load_dwordx4 v[144:147], v5, s[40:43], s56 offen offset:0 sc1
    s_waitcnt vmcnt(9)
    v_mfma_f32_32x32x16_bf16 v[48:63], a[184:187], v[108:111], v[48:63]
    v_mfma_f32_32x32x16_bf16 v[64:79], a[188:191], v[108:111], v[64:79]
    v_mul_f32 v31, v31, v23
    v_exp_f32 v24, v24
    v_exp_f32 v25, v25
    v_exp_f32 v26, v26
    v_exp_f32 v27, v27
    v_exp_f32 v28, v28
    v_exp_f32 v29, v29
    v_exp_f32 v30, v30
    v_exp_f32 v31, v31
    v_add_f32 v24, 1.0, v24
    v_add_f32 v25, 1.0, v25
    v_add_f32 v26, 1.0, v26
    v_add_f32 v27, 1.0, v27
    v_add_f32 v28, 1.0, v28
    v_add_f32 v29, 1.0, v29
    v_add_f32 v30, 1.0, v30
    ds_read_b64_tr_b16 a[128:129], v217 offset:24576
    ds_read_b64_tr_b16 a[130:131], v217 offset:25600
    ds_read_b64_tr_b16 a[132:133], v218 offset:24576
    ds_read_b64_tr_b16 a[134:135], v218 offset:25600
    ds_read_b64_tr_b16 a[136:137], v217 offset:26624
    ds_read_b64_tr_b16 a[138:139], v217 offset:27648
    ds_read_b64_tr_b16 a[140:141], v218 offset:26624
    ds_read_b64_tr_b16 a[142:143], v218 offset:27648
    buffer_load_dwordx4 v[148:151], v5, s[40:43], s56 offen offset:1024 sc1
    s_waitcnt vmcnt(9)
    v_mfma_f32_32x32x16_bf16 v[48:63], a[192:195], v[112:115], v[48:63]
    v_mfma_f32_32x32x16_bf16 v[64:79], a[196:199], v[112:115], v[64:79]
    v_add_f32 v31, 1.0, v31
    v_rcp_f32 v24, v24
    v_rcp_f32 v25, v25
    v_rcp_f32 v26, v26
    v_rcp_f32 v27, v27
    v_rcp_f32 v28, v28
    v_rcp_f32 v29, v29
    v_rcp_f32 v30, v30
    v_rcp_f32 v31, v31
    v_mul_f32 v24, v24, v16
    v_mul_f32 v25, v25, v17
    v_mul_f32 v26, v26, v18
    v_mul_f32 v27, v27, v19
    v_mul_f32 v28, v28, v20
    v_mul_f32 v29, v29, v21
    v_mul_f32 v30, v30, v22
    ds_read_b64_tr_b16 a[144:145], v217 offset:28672
    ds_read_b64_tr_b16 a[146:147], v217 offset:29696
    ds_read_b64_tr_b16 a[148:149], v218 offset:28672
    ds_read_b64_tr_b16 a[150:151], v218 offset:29696
    ds_read_b64_tr_b16 a[152:153], v217 offset:30720
    ds_read_b64_tr_b16 a[154:155], v217 offset:31744
    ds_read_b64_tr_b16 a[156:157], v218 offset:30720
    ds_read_b64_tr_b16 a[158:159], v218 offset:31744
    buffer_load_dwordx4 v[152:155], v5, s[40:43], s56 offen offset:2048 sc1
    s_waitcnt vmcnt(9)
    v_mfma_f32_32x32x16_bf16 v[48:63], a[200:203], v[116:119], v[48:63]
    v_mfma_f32_32x32x16_bf16 v[64:79], a[204:207], v[116:119], v[64:79]
    v_mul_f32 v31, v31, v23
    v_cvt_pk_bf16_f32 v32, v24, v25
    v_cvt_pk_bf16_f32 v33, v26, v27
    v_cvt_pk_bf16_f32 v34, v28, v29
    v_cvt_pk_bf16_f32 v35, v30, v31
    buffer_store_dwordx4 v[32:35], v5, s[40:43], s57 offen sc1
    ds_read_b64_tr_b16 a[160:161], v217 offset:32768
    ds_read_b64_tr_b16 a[162:163], v217 offset:33792
    ds_read_b64_tr_b16 a[164:165], v218 offset:32768
    ds_read_b64_tr_b16 a[166:167], v218 offset:33792
    ds_read_b64_tr_b16 a[168:169], v217 offset:34816
    ds_read_b64_tr_b16 a[170:171], v217 offset:35840
    ds_read_b64_tr_b16 a[172:173], v218 offset:34816
    ds_read_b64_tr_b16 a[174:175], v218 offset:35840
    buffer_load_dwordx4 v[156:159], v5, s[40:43], s56 offen offset:3072 sc1
    s_waitcnt vmcnt(10)
    v_mfma_f32_32x32x16_bf16 v[48:63], a[208:211], v[120:123], v[48:63]
    v_mfma_f32_32x32x16_bf16 v[64:79], a[212:215], v[120:123], v[64:79]
    ds_read_b64_tr_b16 a[176:177], v217 offset:12288
    ds_read_b64_tr_b16 a[178:179], v217 offset:13312
    ds_read_b64_tr_b16 a[180:181], v218 offset:12288
    ds_read_b64_tr_b16 a[182:183], v218 offset:13312
    ds_read_b64_tr_b16 a[184:185], v217 offset:14336
    ds_read_b64_tr_b16 a[186:187], v217 offset:15360
    ds_read_b64_tr_b16 a[188:189], v218 offset:14336
    ds_read_b64_tr_b16 a[190:191], v218 offset:15360
    s_and_b32 s60, s3, 1
    s_cmp_eq_u32 s60, 0
    s_cselect_b32 s60, 1.0, 0
    v_lshlrev_b32 v16, 16, v224
    v_and_b32 v17, s91, v224
    v_lshlrev_b32 v208, 16, v240
    v_and_b32 v209, s91, v240
    v_add_f32 v16, v16, v208
    s_add_u32 s56, s72, s99
    buffer_load_dwordx4 v[160:163], v5, s[40:43], s56 offen offset:0 sc1
    s_waitcnt vmcnt(10)
    v_mfma_f32_32x32x16_bf16 v[48:63], a[216:219], v[124:127], v[48:63]
    v_mfma_f32_32x32x16_bf16 v[64:79], a[220:223], v[124:127], v[64:79]
    ds_read_b64_tr_b16 a[192:193], v217 offset:16384
    ds_read_b64_tr_b16 a[194:195], v217 offset:17408
    ds_read_b64_tr_b16 a[196:197], v218 offset:16384
    ds_read_b64_tr_b16 a[198:199], v218 offset:17408
    ds_read_b64_tr_b16 a[200:201], v217 offset:18432
    ds_read_b64_tr_b16 a[202:203], v217 offset:19456
    ds_read_b64_tr_b16 a[204:205], v218 offset:18432
    ds_read_b64_tr_b16 a[206:207], v218 offset:19456
    v_add_f32 v17, v17, v209
    v_mul_f32 v16, s60, v16
    v_mul_f32 v17, s60, v17
    v_lshlrev_b32 v18, 16, v225
    v_and_b32 v19, s91, v225
    v_lshlrev_b32 v210, 16, v241
    buffer_load_dwordx4 v[164:167], v5, s[40:43], s56 offen offset:1024 sc1
    s_waitcnt vmcnt(10)
    v_mfma_f32_32x32x16_bf16 v[48:63], a[224:227], v[128:131], v[48:63]
    v_mfma_f32_32x32x16_bf16 v[64:79], a[228:231], v[128:131], v[64:79]
    ds_read_b64_tr_b16 a[208:209], v217 offset:20480
    ds_read_b64_tr_b16 a[210:211], v217 offset:21504
    ds_read_b64_tr_b16 a[212:213], v218 offset:20480
    ds_read_b64_tr_b16 a[214:215], v218 offset:21504
    ds_read_b64_tr_b16 a[216:217], v217 offset:22528
    ds_read_b64_tr_b16 a[218:219], v217 offset:23552
    ds_read_b64_tr_b16 a[220:221], v218 offset:22528
    ds_read_b64_tr_b16 a[222:223], v218 offset:23552
    s_waitcnt lgkmcnt(15)
    s_add_u32 m0, s70, 24576
    s_mul_i32 s73, s51, 64
    s_add_u32 s73, s73, 0
    buffer_load_dwordx4 v214, s[24:27], s73 offen lds
    s_add_u32 m0, s70, 25600
    s_mul_i32 s73, s51, 64
    s_add_u32 s73, s73, 32768
    buffer_load_dwordx4 v214, s[24:27], s73 offen lds
    v_and_b32 v211, s91, v241
    v_add_f32 v18, v18, v210
    v_add_f32 v19, v19, v211
    v_mul_f32 v18, s60, v18
    v_mul_f32 v19, s60, v19
    v_lshlrev_b32 v20, 16, v226
    buffer_load_dwordx4 v[168:171], v5, s[40:43], s56 offen offset:2048 sc1
    s_waitcnt vmcnt(12)
    v_mfma_f32_32x32x16_bf16 v[48:63], a[232:235], v[132:135], v[48:63]
    v_mfma_f32_32x32x16_bf16 v[64:79], a[236:239], v[132:135], v[64:79]
    s_waitcnt vmcnt(6)
    v_mov_b32 v8, s4
    s_mov_b64 exec, 1
    buffer_store_dword v8, v9, s[40:43], s82 offen sc1
    s_mov_b64 exec, -1
    s_add_u32 m0, s70, 26624
    s_mul_i32 s73, s51, 64
    s_add_u32 s73, s73, 65536
    buffer_load_dwordx4 v214, s[24:27], s73 offen lds
    s_add_u32 m0, s70, 27648
    s_mul_i32 s73, s51, 64
    s_add_u32 s73, s73, 98304
    buffer_load_dwordx4 v214, s[24:27], s73 offen lds
    v_and_b32 v21, s91, v226
    v_lshlrev_b32 v208, 16, v242
    v_and_b32 v209, s91, v242
    v_add_f32 v20, v20, v208
    v_add_f32 v21, v21, v209
    v_mul_f32 v20, s60, v20
    buffer_load_dwordx4 v[172:175], v5, s[40:43], s56 offen offset:3072 sc1
    v_mfma_f32_32x32x16_bf16 v[48:63], a[240:243], v[136:139], v[48:63]
    v_mfma_f32_32x32x16_bf16 v[64:79], a[244:247], v[136:139], v[64:79]
    s_add_u32 m0, s70, 28672
    s_mul_i32 s73, s51, 64
    s_add_u32 s73, s73, 131072
    buffer_load_dwordx4 v214, s[24:27], s73 offen lds
    s_add_u32 m0, s70, 29696
    s_mul_i32 s73, s51, 64
    s_add_u32 s73, s73, 163840
    buffer_load_dwordx4 v214, s[24:27], s73 offen lds
    v_mul_f32 v21, s60, v21
    v_lshlrev_b32 v22, 16, v227
    v_and_b32 v23, s91, v227
    v_lshlrev_b32 v210, 16, v243
    v_and_b32 v211, s91, v243
    v_add_f32 v22, v22, v210
    s_add_u32 s56, s72, s100
    buffer_load_dwordx4 v[176:179], v5, s[40:43], s56 offen offset:0 sc1
    v_mfma_f32_32x32x16_bf16 v[48:63], a[248:251], v[140:143], v[48:63]
    v_mfma_f32_32x32x16_bf16 v[64:79], a[252:255], v[140:143], v[64:79]
    s_add_u32 m0, s70, 30720
    s_mul_i32 s73, s51, 64
    s_add_u32 s73, s73, 196608
    buffer_load_dwordx4 v214, s[24:27], s73 offen lds
    s_add_u32 m0, s70, 31744
    s_mul_i32 s73, s51, 64
    s_add_u32 s73, s73, 229376
    buffer_load_dwordx4 v214, s[24:27], s73 offen lds
    v_add_f32 v23, v23, v211
    v_mul_f32 v22, s60, v22
    v_mul_f32 v23, s60, v23
    v_lshlrev_b32 v24, 16, v228
    v_and_b32 v25, s91, v228
    v_lshlrev_b32 v208, 16, v244
    buffer_load_dwordx4 v[180:183], v5, s[40:43], s56 offen offset:1024 sc1
    v_mfma_f32_32x32x16_bf16 v[48:63], a[0:3], v[144:147], v[48:63]
    v_mfma_f32_32x32x16_bf16 v[64:79], a[4:7], v[144:147], v[64:79]
    s_add_u32 m0, s70, 32768
    s_mul_i32 s73, s52, 64
    s_add_u32 s73, s73, 0
    buffer_load_dwordx4 v214, s[24:27], s73 offen lds
    s_add_u32 m0, s70, 33792
    s_mul_i32 s73, s52, 64
    s_add_u32 s73, s73, 32768
    buffer_load_dwordx4 v214, s[24:27], s73 offen lds
    v_and_b32 v209, s91, v244
    v_add_f32 v24, v24, v208
    v_add_f32 v25, v25, v209
    v_mul_f32 v24, s60, v24
    v_mul_f32 v25, s60, v25
    v_lshlrev_b32 v26, 16, v229
    buffer_load_dwordx4 v[184:187], v5, s[40:43], s56 offen offset:2048 sc1
    v_mfma_f32_32x32x16_bf16 v[48:63], a[8:11], v[148:151], v[48:63]
    v_mfma_f32_32x32x16_bf16 v[64:79], a[12:15], v[148:151], v[64:79]
    s_add_u32 m0, s70, 34816
    s_mul_i32 s73, s52, 64
    s_add_u32 s73, s73, 65536
    buffer_load_dwordx4 v214, s[24:27], s73 offen lds
    s_add_u32 m0, s70, 35840
    s_mul_i32 s73, s52, 64
    s_add_u32 s73, s73, 98304
    buffer_load_dwordx4 v214, s[24:27], s73 offen lds
    v_and_b32 v27, s91, v229
    v_lshlrev_b32 v210, 16, v245
    v_and_b32 v211, s91, v245
    v_add_f32 v26, v26, v210
    v_add_f32 v27, v27, v211
    v_mul_f32 v26, s60, v26
    buffer_load_dwordx4 v[188:191], v5, s[40:43], s56 offen offset:3072 sc1
    v_mfma_f32_32x32x16_bf16 v[48:63], a[16:19], v[152:155], v[48:63]
    v_mfma_f32_32x32x16_bf16 v[64:79], a[20:23], v[152:155], v[64:79]
    s_add_u32 m0, s70, 12288
    s_mul_i32 s73, s52, 64
    s_add_u32 s73, s73, 131072
    buffer_load_dwordx4 v214, s[24:27], s73 offen lds
    s_add_u32 m0, s70, 13312
    s_mul_i32 s73, s52, 64
    s_add_u32 s73, s73, 163840
    buffer_load_dwordx4 v214, s[24:27], s73 offen lds
    v_mul_f32 v27, s60, v27
    v_lshlrev_b32 v28, 16, v230
    v_and_b32 v29, s91, v230
    v_lshlrev_b32 v208, 16, v246
    v_and_b32 v209, s91, v246
    v_add_f32 v28, v28, v208
    buffer_load_dword v248, v12, s[40:43], s85 offen offset:0 sc1
    s_add_u32 s56, s72, s101
    buffer_load_dwordx4 v[192:195], v5, s[40:43], s56 offen offset:0 sc1
    s_waitcnt vmcnt(25)
    v_mfma_f32_32x32x16_bf16 v[48:63], a[24:27], v[156:159], v[48:63]
    v_mfma_f32_32x32x16_bf16 v[64:79], a[28:31], v[156:159], v[64:79]
    s_add_u32 m0, s70, 14336
    s_mul_i32 s73, s52, 64
    s_add_u32 s73, s73, 196608
    buffer_load_dwordx4 v214, s[24:27], s73 offen lds
    s_add_u32 m0, s70, 15360
    s_mul_i32 s73, s52, 64
    s_add_u32 s73, s73, 229376
    buffer_load_dwordx4 v214, s[24:27], s73 offen lds
    v_add_f32 v29, v29, v209
    v_mul_f32 v28, s60, v28
    v_mul_f32 v29, s60, v29
    v_lshlrev_b32 v30, 16, v231
    v_and_b32 v31, s91, v231
    v_lshlrev_b32 v210, 16, v247
    buffer_load_dwordx4 v[196:199], v5, s[40:43], s56 offen offset:1024 sc1
    s_waitcnt vmcnt(27)
    v_mfma_f32_32x32x16_bf16 v[48:63], a[32:35], v[160:163], v[48:63]
    v_mfma_f32_32x32x16_bf16 v[64:79], a[36:39], v[160:163], v[64:79]
    s_waitcnt vmcnt(24)
    ds_read_b64_tr_b16 a[224:225], v217 offset:24576
    ds_read_b64_tr_b16 a[226:227], v217 offset:25600
    ds_read_b64_tr_b16 a[228:229], v218 offset:24576
    ds_read_b64_tr_b16 a[230:231], v218 offset:25600
    v_and_b32 v211, s91, v247
    v_add_f32 v30, v30, v210
    v_add_f32 v31, v31, v211
    v_mul_f32 v30, s60, v30
    v_mul_f32 v31, s60, v31
    buffer_load_dwordx4 v[200:203], v5, s[40:43], s56 offen offset:2048 sc1
    v_mfma_f32_32x32x16_bf16 v[48:63], a[40:43], v[164:167], v[48:63]
    v_mfma_f32_32x32x16_bf16 v[64:79], a[44:47], v[164:167], v[64:79]
    s_waitcnt vmcnt(21)
    ds_read_b64_tr_b16 a[232:233], v217 offset:26624
    ds_read_b64_tr_b16 a[234:235], v217 offset:27648
    ds_read_b64_tr_b16 a[236:237], v218 offset:26624
    ds_read_b64_tr_b16 a[238:239], v218 offset:27648
    buffer_load_dwordx4 v[204:207], v5, s[40:43], s56 offen offset:3072 sc1
    v_mfma_f32_32x32x16_bf16 v[48:63], a[48:51], v[168:171], v[48:63]
    v_mfma_f32_32x32x16_bf16 v[64:79], a[52:55], v[168:171], v[64:79]
    s_waitcnt vmcnt(19)
    ds_read_b64_tr_b16 a[240:241], v217 offset:28672
    ds_read_b64_tr_b16 a[242:243], v217 offset:29696
    ds_read_b64_tr_b16 a[244:245], v218 offset:28672
    ds_read_b64_tr_b16 a[246:247], v218 offset:29696
    s_waitcnt vmcnt(6)
    v_cmp_ne_u32 vcc, s4, v248
    s_nop 1
    s_cbranch_vccz Lpcd_P_11
    s_nop 1
Lpc_P_10:
    s_sub_u32 s6, s6, 1
    s_cbranch_scc1 L_end_P
    buffer_load_dword v248, v12, s[40:43], s85 offen offset:0 sc1
    s_waitcnt vmcnt(0)
    v_cmp_ne_u32 vcc, s4, v248
    s_nop 1
    s_cbranch_vccnz Lpc_P_10
Lpcd_P_11:
    s_add_u32 s56, s58, s48
    buffer_load_dwordx4 v[80:83], v4, s[40:43], s56 offen offset:0 sc1
    v_mfma_f32_32x32x16_bf16 v[48:63], a[56:59], v[172:175], v[48:63]
    v_mfma_f32_32x32x16_bf16 v[64:79], a[60:63], v[172:175], v[64:79]
    ds_read_b64_tr_b16 a[248:249], v217 offset:30720
    ds_read_b64_tr_b16 a[250:251], v217 offset:31744
    ds_read_b64_tr_b16 a[252:253], v218 offset:30720
    ds_read_b64_tr_b16 a[254:255], v218 offset:31744
    buffer_load_dwordx4 v[84:87], v4, s[40:43], s56 offen offset:1024 sc1
    v_mfma_f32_32x32x16_bf16 v[48:63], a[64:67], v[176:179], v[48:63]
    v_mfma_f32_32x32x16_bf16 v[64:79], a[68:71], v[176:179], v[64:79]
    ds_read_b64_tr_b16 a[0:1], v217 offset:32768
    ds_read_b64_tr_b16 a[2:3], v217 offset:33792
    ds_read_b64_tr_b16 a[4:5], v218 offset:32768
    ds_read_b64_tr_b16 a[6:7], v218 offset:33792
    buffer_load_dwordx4 v[88:91], v4, s[40:43], s56 offen offset:2048 sc1
    v_mfma_f32_32x32x16_bf16 v[48:63], a[72:75], v[180:183], v[48:63]
    v_mfma_f32_32x32x16_bf16 v[64:79], a[76:79], v[180:183], v[64:79]
    ds_read_b64_tr_b16 a[8:9], v217 offset:34816
    ds_read_b64_tr_b16 a[10:11], v217 offset:35840
    ds_read_b64_tr_b16 a[12:13], v218 offset:34816
    ds_read_b64_tr_b16 a[14:15], v218 offset:35840
    buffer_load_dwordx4 v[92:95], v4, s[40:43], s56 offen offset:3072 sc1
    v_mfma_f32_32x32x16_bf16 v[48:63], a[80:83], v[184:187], v[48:63]
    v_mfma_f32_32x32x16_bf16 v[64:79], a[84:87], v[184:187], v[64:79]
    ds_read_b64_tr_b16 a[16:17], v217 offset:12288
    ds_read_b64_tr_b16 a[18:19], v217 offset:13312
    ds_read_b64_tr_b16 a[20:21], v218 offset:12288
    ds_read_b64_tr_b16 a[22:23], v218 offset:13312
    s_add_u32 s56, s58, s49
    buffer_load_dwordx4 v[96:99], v4, s[40:43], s56 offen offset:0 sc1
    v_mfma_f32_32x32x16_bf16 v[48:63], a[88:91], v[188:191], v[48:63]
    v_mfma_f32_32x32x16_bf16 v[64:79], a[92:95], v[188:191], v[64:79]
    s_waitcnt vmcnt(8)
    ds_read_b64_tr_b16 a[24:25], v217 offset:14336
    ds_read_b64_tr_b16 a[26:27], v217 offset:15360
    ds_read_b64_tr_b16 a[28:29], v218 offset:14336
    ds_read_b64_tr_b16 a[30:31], v218 offset:15360
    buffer_load_dwordx4 v[100:103], v4, s[40:43], s56 offen offset:1024 sc1
    buffer_load_dwordx4 v[104:107], v4, s[40:43], s56 offen offset:2048 sc1
    buffer_load_dwordx4 v[108:111], v4, s[40:43], s56 offen offset:3072 sc1
    s_add_u32 s56, s58, s50
    buffer_load_dwordx4 v[112:115], v4, s[40:43], s56 offen offset:0 sc1
    v_mfma_f32_32x32x16_bf16 v[64:79], a[100:103], v[192:195], v[64:79]
    s_waitcnt vmcnt(11)
    v_mfma_f32_32x32x16_bf16 v[64:79], a[108:111], v[196:199], v[64:79]
    s_waitcnt vmcnt(10)
    v_mfma_f32_32x32x16_bf16 v[64:79], a[116:119], v[200:203], v[64:79]
    s_waitcnt vmcnt(9)
    v_mfma_f32_32x32x16_bf16 v[64:79], a[124:127], v[204:207], v[64:79]
    v_mfma_f32_32x32x16_bf16 v[48:63], a[96:99], v[192:195], v[48:63]
    v_mfma_f32_32x32x16_bf16 v[48:63], a[104:107], v[196:199], v[48:63]
    s_nop 9
    ds_write_b128 v235, v[72:75] offset:6144
    ds_write_b128 v235, v[76:79] offset:7168
    v_mfma_f32_32x32x16_bf16 v[48:63], a[112:115], v[200:203], v[48:63]
    ds_write_b128 v234, v[64:67] offset:6144
    ds_write_b128 v234, v[68:71] offset:7168
    v_mfma_f32_32x32x16_bf16 v[48:63], a[120:123], v[204:207], v[48:63]
    s_nop 11
    ds_write_b128 v233, v[56:59] offset:6144
    ds_write_b128 v233, v[60:63] offset:7168
    s_waitcnt lgkmcnt(0)
    s_barrier
    ds_read_b128 v[56:59], v232 offset:6144
    ds_read_b128 v[64:67], v232 offset:8192
    ds_read_b128 v[72:75], v232 offset:10240
    ds_read_b128 v[60:63], v232 offset:7168
    ds_read_b128 v[68:71], v232 offset:9216
    ds_read_b128 v[76:79], v232 offset:11264
    v_mov_b32 v211, s88
    s_waitcnt lgkmcnt(4)
    v_pk_add_f32 v[56:57], v[56:57], v[64:65]
    s_waitcnt lgkmcnt(3)
    v_pk_add_f32 v[48:49], v[48:49], v[72:73]
    v_pk_add_f32 v[58:59], v[58:59], v[66:67]
    v_pk_add_f32 v[50:51], v[50:51], v[74:75]
    s_waitcnt lgkmcnt(1)
    v_pk_add_f32 v[60:61], v[60:61], v[68:69]
    s_waitcnt lgkmcnt(0)
    v_pk_add_f32 v[52:53], v[52:53], v[76:77]
    v_pk_add_f32 v[62:63], v[62:63], v[70:71]
    v_pk_add_f32 v[54:55], v[54:55], v[78:79]
    v_pk_add_f32 v[48:49], v[48:49], v[56:57]
    v_pk_add_f32 v[50:51], v[50:51], v[58:59]
    v_pk_add_f32 v[52:53], v[52:53], v[60:61]
    v_pk_add_f32 v[54:55], v[54:55], v[62:63]
    v_pk_mul_f32 v[56:57], v[48:49], v[48:49]
    v_pk_mul_f32 v[58:59], v[50:51], v[50:51]
    v_pk_mul_f32 v[60:61], v[52:53], v[52:53]
    v_pk_mul_f32 v[62:63], v[54:55], v[54:55]
    v_fma_f32 v56, v56, s90, v211
    v_fma_f32 v57, v57, s90, v211
    v_fma_f32 v58, v58, s90, v211
    v_fma_f32 v59, v59, s90, v211
    v_fma_f32 v60, v60, s90, v211
    v_fma_f32 v61, v61, s90, v211
    v_fma_f32 v62, v62, s90, v211
    v_fma_f32 v63, v63, s90, v211
    v_pk_mul_f32 v[56:57], v[56:57], v[48:49]
    v_pk_mul_f32 v[58:59], v[58:59], v[50:51]
    v_pk_mul_f32 v[60:61], v[60:61], v[52:53]
    v_pk_mul_f32 v[62:63], v[62:63], v[54:55]
    v_exp_f32 v56, v56
    v_exp_f32 v57, v57
    v_exp_f32 v58, v58
    v_exp_f32 v59, v59
    v_exp_f32 v60, v60
    v_exp_f32 v61, v61
    v_exp_f32 v62, v62
    v_exp_f32 v63, v63
    v_add_f32 v56, 1.0, v56
    v_add_f32 v57, 1.0, v57
    v_add_f32 v58, 1.0, v58
    v_add_f32 v59, 1.0, v59
    v_add_f32 v60, 1.0, v60
    v_add_f32 v61, 1.0, v61
    v_add_f32 v62, 1.0, v62
    v_add_f32 v63, 1.0, v63
    v_rcp_f32 v56, v56
    v_rcp_f32 v57, v57
    v_rcp_f32 v58, v58
    v_rcp_f32 v59, v59
    v_rcp_f32 v60, v60
    v_rcp_f32 v61, v61
    v_rcp_f32 v62, v62
    v_rcp_f32 v63, v63
    v_mul_f32 v56, v56, v48
    v_mul_f32 v57, v57, v49
    v_mul_f32 v58, v58, v50
    v_mul_f32 v59, v59, v51
    v_mul_f32 v60, v60, v52
    v_mul_f32 v61, v61, v53
    v_mul_f32 v62, v62, v54
    v_mul_f32 v63, v63, v55
    v_cvt_pk_bf16_f32 v64, v56, v57
    v_cvt_pk_bf16_f32 v65, v58, v59
    v_cvt_pk_bf16_f32 v66, v60, v61
    v_cvt_pk_bf16_f32 v67, v62, v63
    s_add_u32 s57, s57, 114688
    buffer_store_dwordx4 v[64:67], v5, s[40:43], s57 offen sc1
    s_add_u32 s82, s82, 4096
    s_add_u32 s85, s85, 4096
    buffer_load_dwordx4 v[116:119], v4, s[40:43], s56 offen offset:1024 sc1
    s_waitcnt vmcnt(10)
    v_mfma_f32_32x32x16_bf16 v[16:31], a[128:131], v[80:83], v[16:31]
    v_mfma_f32_32x32x16_bf16 v[32:47], a[132:135], v[80:83], 0
    s_add_u32 m0, s70, 16384
    s_mul_i32 s73, s53, 64
    s_add_u32 s73, s73, 0
    buffer_load_dwordx4 v214, s[24:27], s73 offen lds
    s_add_u32 m0, s70, 17408
    s_mul_i32 s73, s53, 64
    s_add_u32 s73, s73, 32768
    buffer_load_dwordx4 v214, s[24:27], s73 offen lds
    buffer_load_dwordx4 v[120:123], v4, s[40:43], s56 offen offset:2048 sc1
    s_waitcnt vmcnt(12)
    v_mfma_f32_32x32x16_bf16 v[16:31], a[136:139], v[84:87], v[16:31]
    v_mfma_f32_32x32x16_bf16 v[32:47], a[140:143], v[84:87], v[32:47]
    s_add_u32 m0, s70, 18432
    s_mul_i32 s73, s53, 64
    s_add_u32 s73, s73, 65536
    buffer_load_dwordx4 v214, s[24:27], s73 offen lds
    s_add_u32 m0, s70, 19456
    s_mul_i32 s73, s53, 64
    s_add_u32 s73, s73, 98304
    buffer_load_dwordx4 v214, s[24:27], s73 offen lds
    buffer_load_dwordx4 v[124:127], v4, s[40:43], s56 offen offset:3072 sc1
    s_waitcnt vmcnt(14)
    v_mfma_f32_32x32x16_bf16 v[16:31], a[144:147], v[88:91], v[16:31]
    v_mfma_f32_32x32x16_bf16 v[32:47], a[148:151], v[88:91], v[32:47]
    s_add_u32 m0, s70, 20480
    s_mul_i32 s73, s53, 64
    s_add_u32 s73, s73, 131072
    buffer_load_dwordx4 v214, s[24:27], s73 offen lds
    s_add_u32 m0, s70, 21504
    s_mul_i32 s73, s53, 64
    s_add_u32 s73, s73, 163840
    buffer_load_dwordx4 v214, s[24:27], s73 offen lds
    s_add_u32 s56, s58, s51
    buffer_load_dwordx4 v[128:131], v4, s[40:43], s56 offen offset:0 sc1
    s_waitcnt vmcnt(16)
    v_mfma_f32_32x32x16_bf16 v[16:31], a[152:155], v[92:95], v[16:31]
    v_mfma_f32_32x32x16_bf16 v[32:47], a[156:159], v[92:95], v[32:47]
    s_add_u32 m0, s70, 22528
    s_mul_i32 s73, s53, 64
    s_add_u32 s73, s73, 196608
    buffer_load_dwordx4 v214, s[24:27], s73 offen lds
    s_add_u32 m0, s70, 23552
    s_mul_i32 s73, s53, 64
    s_add_u32 s73, s73, 229376
    buffer_load_dwordx4 v214, s[24:27], s73 offen lds
    buffer_load_dwordx4 v[132:135], v4, s[40:43], s56 offen offset:1024 sc1
    s_waitcnt vmcnt(18)
    v_mfma_f32_32x32x16_bf16 v[16:31], a[160:163], v[96:99], v[16:31]
    v_mfma_f32_32x32x16_bf16 v[32:47], a[164:167], v[96:99], v[32:47]
    s_add_u32 m0, s70, 24576
    s_mul_i32 s73, s54, 64
    s_add_u32 s73, s73, 0
    buffer_load_dwordx4 v214, s[24:27], s73 offen lds
    s_add_u32 m0, s70, 25600
    s_mul_i32 s73, s54, 64
    s_add_u32 s73, s73, 32768
    buffer_load_dwordx4 v214, s[24:27], s73 offen lds
    s_waitcnt vmcnt(15)
    v_mov_b32 v8, s4
    s_mov_b64 exec, 1
    buffer_store_dword v8, v9, s[40:43], s82 offen sc1
    s_mov_b64 exec, -1
    buffer_load_dwordx4 v[136:139], v4, s[40:43], s56 offen offset:2048 sc1
    v_mfma_f32_32x32x16_bf16 v[16:31], a[168:171], v[100:103], v[16:31]
    v_mfma_f32_32x32x16_bf16 v[32:47], a[172:175], v[100:103], v[32:47]
    s_add_u32 m0, s70, 26624
    s_mul_i32 s73, s54, 64
    s_add_u32 s73, s73, 65536
    buffer_load_dwordx4 v214, s[24:27], s73 offen lds
    s_add_u32 m0, s70, 27648
    s_mul_i32 s73, s54, 64
    s_add_u32 s73, s73, 98304
    buffer_load_dwordx4 v214, s[24:27], s73 offen lds
    buffer_load_dwordx4 v[140:143], v4, s[40:43], s56 offen offset:3072 sc1
    v_mfma_f32_32x32x16_bf16 v[16:31], a[176:179], v[104:107], v[16:31]
    v_mfma_f32_32x32x16_bf16 v[32:47], a[180:183], v[104:107], v[32:47]
    s_add_u32 m0, s70, 28672
    s_mul_i32 s73, s54, 64
    s_add_u32 s73, s73, 131072
    buffer_load_dwordx4 v214, s[24:27], s73 offen lds
    s_add_u32 m0, s70, 29696
    s_mul_i32 s73, s54, 64
    s_add_u32 s73, s73, 163840
    buffer_load_dwordx4 v214, s[24:27], s73 offen lds
    s_and_b32 s60, s3, 1
    s_cmp_eq_u32 s60, 1
    s_cselect_b32 s60, 1.0, 0
    v_lshlrev_b32 v48, 16, v224
    v_and_b32 v49, s91, v224
    v_lshlrev_b32 v208, 16, v240
    v_and_b32 v209, s91, v240
    v_add_f32 v48, v48, v208
    s_add_u32 s56, s58, s52
    buffer_load_dwordx4 v[144:147], v4, s[40:43], s56 offen offset:0 sc1
    v_mfma_f32_32x32x16_bf16 v[16:31], a[184:187], v[108:111], v[16:31]
    v_mfma_f32_32x32x16_bf16 v[32:47], a[188:191], v[108:111], v[32:47]
    s_add_u32 m0, s70, 30720
    s_mul_i32 s73, s54, 64
    s_add_u32 s73, s73, 196608
    buffer_load_dwordx4 v214, s[24:27], s73 offen lds
    s_add_u32 m0, s70, 31744
    s_mul_i32 s73, s54, 64
    s_add_u32 s73, s73, 229376
    buffer_load_dwordx4 v214, s[24:27], s73 offen lds
    v_add_f32 v49, v49, v209
    v_mul_f32 v48, s60, v48
    v_mul_f32 v49, s60, v49
    v_lshlrev_b32 v50, 16, v225
    v_and_b32 v51, s91, v225
    v_lshlrev_b32 v210, 16, v241
    buffer_load_dwordx4 v[148:151], v4, s[40:43], s56 offen offset:1024 sc1
    v_mfma_f32_32x32x16_bf16 v[16:31], a[192:195], v[112:115], v[16:31]
    v_mfma_f32_32x32x16_bf16 v[32:47], a[196:199], v[112:115], v[32:47]
    s_waitcnt vmcnt(23)
    ds_read_b64_tr_b16 a[32:33], v217 offset:16384
    ds_read_b64_tr_b16 a[34:35], v217 offset:17408
    ds_read_b64_tr_b16 a[36:37], v218 offset:16384
    ds_read_b64_tr_b16 a[38:39], v218 offset:17408
    v_and_b32 v211, s91, v241
    v_add_f32 v50, v50, v210
    v_add_f32 v51, v51, v211
    v_mul_f32 v50, s60, v50
    v_mul_f32 v51, s60, v51
    v_lshlrev_b32 v52, 16, v226
    buffer_load_dwordx4 v[152:155], v4, s[40:43], s56 offen offset:2048 sc1
    v_mfma_f32_32x32x16_bf16 v[16:31], a[200:203], v[116:119], v[16:31]
    v_mfma_f32_32x32x16_bf16 v[32:47], a[204:207], v[116:119], v[32:47]
    s_waitcnt vmcnt(21)
    ds_read_b64_tr_b16 a[40:41], v217 offset:18432
    ds_read_b64_tr_b16 a[42:43], v217 offset:19456
    ds_read_b64_tr_b16 a[44:45], v218 offset:18432
    ds_read_b64_tr_b16 a[46:47], v218 offset:19456
    v_and_b32 v53, s91, v226
    v_lshlrev_b32 v208, 16, v242
    v_and_b32 v209, s91, v242
    v_add_f32 v52, v52, v208
    v_add_f32 v53, v53, v209
    v_mul_f32 v52, s60, v52
    buffer_load_dwordx4 v[156:159], v4, s[40:43], s56 offen offset:3072 sc1
    v_mfma_f32_32x32x16_bf16 v[16:31], a[208:211], v[120:123], v[16:31]
    v_mfma_f32_32x32x16_bf16 v[32:47], a[212:215], v[120:123], v[32:47]
    s_waitcnt vmcnt(19)
    ds_read_b64_tr_b16 a[48:49], v217 offset:20480
    ds_read_b64_tr_b16 a[50:51], v217 offset:21504
    ds_read_b64_tr_b16 a[52:53], v218 offset:20480
    ds_read_b64_tr_b16 a[54:55], v218 offset:21504
    v_mul_f32 v53, s60, v53
    v_lshlrev_b32 v54, 16, v227
    v_and_b32 v55, s91, v227
    v_lshlrev_b32 v210, 16, v243
    v_and_b32 v211, s91, v243
    v_add_f32 v54, v54, v210
    s_add_u32 s56, s58, s53
    buffer_load_dwordx4 v[160:163], v4, s[40:43], s56 offen offset:0 sc1
    v_mfma_f32_32x32x16_bf16 v[16:31], a[216:219], v[124:127], v[16:31]
    v_mfma_f32_32x32x16_bf16 v[32:47], a[220:223], v[124:127], v[32:47]
    s_waitcnt vmcnt(17)
    ds_read_b64_tr_b16 a[56:57], v217 offset:22528
    ds_read_b64_tr_b16 a[58:59], v217 offset:23552
    ds_read_b64_tr_b16 a[60:61], v218 offset:22528
    ds_read_b64_tr_b16 a[62:63], v218 offset:23552
    v_add_f32 v55, v55, v211
    v_mul_f32 v54, s60, v54
    v_mul_f32 v55, s60, v55
    v_lshlrev_b32 v56, 16, v228
    v_and_b32 v57, s91, v228
    v_lshlrev_b32 v208, 16, v244
    buffer_load_dwordx4 v[164:167], v4, s[40:43], s56 offen offset:1024 sc1
    v_mfma_f32_32x32x16_bf16 v[16:31], a[224:227], v[128:131], v[16:31]
    v_mfma_f32_32x32x16_bf16 v[32:47], a[228:231], v[128:131], v[32:47]
    s_waitcnt vmcnt(15)
    ds_read_b64_tr_b16 a[64:65], v217 offset:24576
    ds_read_b64_tr_b16 a[66:67], v217 offset:25600
    ds_read_b64_tr_b16 a[68:69], v218 offset:24576
    ds_read_b64_tr_b16 a[70:71], v218 offset:25600
    v_and_b32 v209, s91, v244
    v_add_f32 v56, v56, v208
    v_add_f32 v57, v57, v209
    v_mul_f32 v56, s60, v56
    v_mul_f32 v57, s60, v57
    v_lshlrev_b32 v58, 16, v229
    buffer_load_dwordx4 v[168:171], v4, s[40:43], s56 offen offset:2048 sc1
    v_mfma_f32_32x32x16_bf16 v[16:31], a[232:235], v[132:135], v[16:31]
    v_mfma_f32_32x32x16_bf16 v[32:47], a[236:239], v[132:135], v[32:47]
    s_waitcnt vmcnt(12)
    ds_read_b64_tr_b16 a[72:73], v217 offset:26624
    ds_read_b64_tr_b16 a[74:75], v217 offset:27648
    ds_read_b64_tr_b16 a[76:77], v218 offset:26624
    ds_read_b64_tr_b16 a[78:79], v218 offset:27648
    v_and_b32 v59, s91, v229
    v_lshlrev_b32 v210, 16, v245
    v_and_b32 v211, s91, v245
    v_add_f32 v58, v58, v210
    v_add_f32 v59, v59, v211
    v_mul_f32 v58, s60, v58
    buffer_load_dwordx4 v[172:175], v4, s[40:43], s56 offen offset:3072 sc1
    v_mfma_f32_32x32x16_bf16 v[16:31], a[240:243], v[136:139], v[16:31]
    v_mfma_f32_32x32x16_bf16 v[32:47], a[244:247], v[136:139], v[32:47]
    s_waitcnt vmcnt(10)
    ds_read_b64_tr_b16 a[80:81], v217 offset:28672
    ds_read_b64_tr_b16 a[82:83], v217 offset:29696
    ds_read_b64_tr_b16 a[84:85], v218 offset:28672
    ds_read_b64_tr_b16 a[86:87], v218 offset:29696
    v_mul_f32 v59, s60, v59
    v_lshlrev_b32 v60, 16, v230
    v_and_b32 v61, s91, v230
    v_lshlrev_b32 v208, 16, v246
    v_and_b32 v209, s91, v246
    v_add_f32 v60, v60, v208
    s_add_u32 s56, s58, s54
    buffer_load_dwordx4 v[176:179], v4, s[40:43], s56 offen offset:0 sc1
    v_mfma_f32_32x32x16_bf16 v[16:31], a[248:251], v[140:143], v[16:31]
    v_mfma_f32_32x32x16_bf16 v[32:47], a[252:255], v[140:143], v[32:47]
    s_waitcnt vmcnt(8)
    ds_read_b64_tr_b16 a[88:89], v217 offset:30720
    ds_read_b64_tr_b16 a[90:91], v217 offset:31744
    ds_read_b64_tr_b16 a[92:93], v218 offset:30720
    ds_read_b64_tr_b16 a[94:95], v218 offset:31744
    v_add_f32 v61, v61, v209
    v_mul_f32 v60, s60, v60
    v_mul_f32 v61, s60, v61
    v_lshlrev_b32 v62, 16, v231
    v_and_b32 v63, s91, v231
    v_lshlrev_b32 v210, 16, v247
    buffer_load_dwordx4 v[180:183], v4, s[40:43], s56 offen offset:1024 sc1
    v_mfma_f32_32x32x16_bf16 v[16:31], a[0:3], v[144:147], v[16:31]
    v_mfma_f32_32x32x16_bf16 v[32:47], a[4:7], v[144:147], v[32:47]
    v_and_b32 v211, s91, v247
    v_add_f32 v62, v62, v210
    v_add_f32 v63, v63, v211
    v_mul_f32 v62, s60, v62
    v_mul_f32 v63, s60, v63
    buffer_load_dword v248, v12, s[40:43], s85 offen offset:0 sc1
    buffer_load_dwordx4 v[184:187], v4, s[40:43], s56 offen offset:2048 sc1
    s_waitcnt vmcnt(10)
    v_mfma_f32_32x32x16_bf16 v[16:31], a[8:11], v[148:151], v[16:31]
    v_mfma_f32_32x32x16_bf16 v[32:47], a[12:15], v[148:151], v[32:47]
    buffer_load_dwordx4 v[188:191], v4, s[40:43], s56 offen offset:3072 sc1
    s_waitcnt vmcnt(10)
    v_mfma_f32_32x32x16_bf16 v[16:31], a[16:19], v[152:155], v[16:31]
    v_mfma_f32_32x32x16_bf16 v[32:47], a[20:23], v[152:155], v[32:47]
    s_waitcnt vmcnt(9)
    v_mfma_f32_32x32x16_bf16 v[16:31], a[24:27], v[156:159], v[16:31]
    v_mfma_f32_32x32x16_bf16 v[32:47], a[28:31], v[156:159], v[32:47]
    s_waitcnt vmcnt(8) lgkmcnt(15)
    v_mfma_f32_32x32x16_bf16 v[16:31], a[32:35], v[160:163], v[16:31]
    v_mfma_f32_32x32x16_bf16 v[32:47], a[36:39], v[160:163], v[32:47]
    s_waitcnt vmcnt(2)
    v_cmp_ne_u32 vcc, s4, v248
    s_nop 1
    s_cbranch_vccz Lpcd_P_13
    s_nop 6
Lpc_P_12:
    s_sub_u32 s6, s6, 1
    s_cbranch_scc1 L_end_P
    buffer_load_dword v248, v12, s[40:43], s85 offen offset:0 sc1
    s_waitcnt vmcnt(0)
    v_cmp_ne_u32 vcc, s4, v248
    s_nop 1
    s_cbranch_vccnz Lpc_P_12
Lpcd_P_13:
    s_add_u32 s56, s59, s48
    buffer_load_dwordx4 v[192:195], v4, s[40:43], s56 offen offset:0 sc1
    buffer_load_dwordx4 v[196:199], v4, s[40:43], s56 offen offset:1024 sc1
    v_mfma_f32_32x32x16_bf16 v[16:31], a[40:43], v[164:167], v[16:31]
    v_mfma_f32_32x32x16_bf16 v[32:47], a[44:47], v[164:167], v[32:47]
    buffer_load_dwordx4 v[200:203], v4, s[40:43], s56 offen offset:2048 sc1
    buffer_load_dwordx4 v[204:207], v4, s[40:43], s56 offen offset:3072 sc1
    v_mfma_f32_32x32x16_bf16 v[16:31], a[48:51], v[168:171], v[16:31]
    v_mfma_f32_32x32x16_bf16 v[32:47], a[52:55], v[168:171], v[32:47]
    s_add_u32 s56, s59, s49
    buffer_load_dwordx4 v[80:83], v4, s[40:43], s56 offen offset:0 sc1
    v_mfma_f32_32x32x16_bf16 v[16:31], a[56:59], v[172:175], v[16:31]
    v_mfma_f32_32x32x16_bf16 v[32:47], a[60:63], v[172:175], v[32:47]
    buffer_load_dwordx4 v[84:87], v4, s[40:43], s56 offen offset:1024 sc1
    s_waitcnt lgkmcnt(14)
    v_mfma_f32_32x32x16_bf16 v[16:31], a[64:67], v[176:179], v[16:31]
    s_waitcnt lgkmcnt(12)
    v_mfma_f32_32x32x16_bf16 v[32:47], a[68:71], v[176:179], v[32:47]
    buffer_load_dwordx4 v[88:91], v4, s[40:43], s56 offen offset:2048 sc1
    s_waitcnt lgkmcnt(10)
    v_mfma_f32_32x32x16_bf16 v[16:31], a[72:75], v[180:183], v[16:31]
    s_waitcnt lgkmcnt(8)
    v_mfma_f32_32x32x16_bf16 v[32:47], a[76:79], v[180:183], v[32:47]
    buffer_load_dwordx4 v[92:95], v4, s[40:43], s56 offen offset:3072 sc1
    s_waitcnt vmcnt(9) lgkmcnt(6)
    v_mfma_f32_32x32x16_bf16 v[16:31], a[80:83], v[184:187], v[16:31]
    s_waitcnt lgkmcnt(4)
    v_mfma_f32_32x32x16_bf16 v[32:47], a[84:87], v[184:187], v[32:47]
    s_add_u32 s56, s59, s50
    buffer_load_dwordx4 v[96:99], v4, s[40:43], s56 offen offset:0 sc1
    s_waitcnt vmcnt(9) lgkmcnt(2)
    v_mfma_f32_32x32x16_bf16 v[16:31], a[88:91], v[188:191], v[16:31]
    s_waitcnt lgkmcnt(0)
    v_mfma_f32_32x32x16_bf16 v[32:47], a[92:95], v[188:191], v[32:47]
    buffer_load_dwordx4 v[100:103], v4, s[40:43], s56 offen offset:1024 sc1
    s_waitcnt vmcnt(9)
    v_mfma_f32_32x32x16_bf16 v[48:63], a[128:131], v[192:195], v[48:63]
    v_mfma_f32_32x32x16_bf16 v[64:79], a[132:135], v[192:195], 0
    s_nop 7
    ds_write_b32 v237, v32 offset:0
    ds_write_b32 v237, v34 offset:256
    ds_write_b32 v237, v33 offset:128
    ds_write_b32 v237, v35 offset:384
    ds_write_b32 v237, v36 offset:1024
    ds_write_b32 v237, v38 offset:1280
    buffer_load_dwordx4 v[104:107], v4, s[40:43], s56 offen offset:2048 sc1
    s_waitcnt vmcnt(9)
    v_mfma_f32_32x32x16_bf16 v[48:63], a[136:139], v[196:199], v[48:63]
    v_mfma_f32_32x32x16_bf16 v[64:79], a[140:143], v[196:199], v[64:79]
    ds_write_b32 v237, v37 offset:1152
    ds_write_b32 v237, v39 offset:1408
    ds_write_b32 v237, v40 offset:2048
    ds_write_b32 v237, v42 offset:2304
    ds_write_b32 v237, v41 offset:2176
    ds_write_b32 v237, v43 offset:2432
    buffer_load_dwordx4 v[108:111], v4, s[40:43], s56 offen offset:3072 sc1
    s_waitcnt vmcnt(9)
    v_mfma_f32_32x32x16_bf16 v[48:63], a[144:147], v[200:203], v[48:63]
    v_mfma_f32_32x32x16_bf16 v[64:79], a[148:151], v[200:203], v[64:79]
    ds_write_b32 v237, v44 offset:3072
    ds_write_b32 v237, v46 offset:3328
    ds_write_b32 v237, v45 offset:3200
    ds_write_b32 v237, v47 offset:3456
    ds_write_b32 v236, v16 offset:0
    ds_write_b32 v236, v18 offset:256
    s_add_u32 s56, s59, s51
    buffer_load_dwordx4 v[112:115], v4, s[40:43], s56 offen offset:0 sc1
    s_waitcnt vmcnt(9)
    v_mfma_f32_32x32x16_bf16 v[48:63], a[152:155], v[204:207], v[48:63]
    v_mfma_f32_32x32x16_bf16 v[64:79], a[156:159], v[204:207], v[64:79]
    ds_write_b32 v236, v17 offset:128
    ds_write_b32 v236, v19 offset:384
    ds_write_b32 v236, v20 offset:1024
    ds_write_b32 v236, v22 offset:1280
    ds_write_b32 v236, v21 offset:1152
    ds_write_b32 v236, v23 offset:1408
    buffer_load_dwordx4 v[116:119], v4, s[40:43], s56 offen offset:1024 sc1
    s_waitcnt vmcnt(9)
    v_mfma_f32_32x32x16_bf16 v[48:63], a[160:163], v[80:83], v[48:63]
    v_mfma_f32_32x32x16_bf16 v[64:79], a[164:167], v[80:83], v[64:79]
    ds_write_b32 v236, v24 offset:2048
    ds_write_b32 v236, v26 offset:2304
    ds_write_b32 v236, v25 offset:2176
    ds_write_b32 v236, v27 offset:2432
    ds_write_b32 v236, v28 offset:3072
    ds_write_b32 v236, v30 offset:3328
    buffer_load_dwordx4 v[120:123], v4, s[40:43], s56 offen offset:2048 sc1
    s_waitcnt vmcnt(9)
    v_mfma_f32_32x32x16_bf16 v[48:63], a[168:171], v[84:87], v[48:63]
    v_mfma_f32_32x32x16_bf16 v[64:79], a[172:175], v[84:87], v[64:79]
    ds_write_b32 v236, v29 offset:3200
    ds_write_b32 v236, v31 offset:3456
    buffer_load_dwordx4 v[124:127], v4, s[40:43], s56 offen offset:3072 sc1
    s_waitcnt vmcnt(9)
    v_mfma_f32_32x32x16_bf16 v[48:63], a[176:179], v[88:91], v[48:63]
    v_mfma_f32_32x32x16_bf16 v[64:79], a[180:183], v[88:91], v[64:79]
    s_add_u32 s56, s59, s52
    buffer_load_dwordx4 v[128:131], v4, s[40:43], s56 offen offset:0 sc1
    s_waitcnt vmcnt(9)
    v_mfma_f32_32x32x16_bf16 v[48:63], a[184:187], v[92:95], v[48:63]
    v_mfma_f32_32x32x16_bf16 v[64:79], a[188:191], v[92:95], v[64:79]
    s_waitcnt lgkmcnt(0)
    s_barrier
    ds_read_b128 v[16:19], v238 offset:0
    ds_read_b128 v[20:23], v238 offset:36864
    ds_read_b128 v[24:27], v239 offset:0
    ds_read_b128 v[28:31], v239 offset:36864
    ds_read_b128 v[32:35], v238 offset:1024
    ds_read_b128 v[36:39], v238 offset:37888
    ds_read_b128 v[40:43], v239 offset:1024
    ds_read_b128 v[44:47], v239 offset:37888
    buffer_load_dwordx4 v[132:135], v4, s[40:43], s56 offen offset:1024 sc1
    s_waitcnt vmcnt(9)
    v_mfma_f32_32x32x16_bf16 v[48:63], a[192:195], v[96:99], v[48:63]
    v_mfma_f32_32x32x16_bf16 v[64:79], a[196:199], v[96:99], v[64:79]
    buffer_load_dwordx4 v[136:139], v4, s[40:43], s56 offen offset:2048 sc1
    s_waitcnt vmcnt(9)
    v_mfma_f32_32x32x16_bf16 v[48:63], a[200:203], v[100:103], v[48:63]
    v_mfma_f32_32x32x16_bf16 v[64:79], a[204:207], v[100:103], v[64:79]
    s_waitcnt lgkmcnt(6)
    v_add_f32 v16, v16, v20
    s_waitcnt lgkmcnt(4)
    v_add_f32 v24, v24, v28
    v_add_f32 v17, v17, v21
    v_add_f32 v25, v25, v29
    v_add_f32 v18, v18, v22
    v_add_f32 v26, v26, v30
    buffer_load_dwordx4 v[140:143], v4, s[40:43], s56 offen offset:3072 sc1
    s_waitcnt vmcnt(9)
    v_mfma_f32_32x32x16_bf16 v[48:63], a[208:211], v[104:107], v[48:63]
    v_mfma_f32_32x32x16_bf16 v[64:79], a[212:215], v[104:107], v[64:79]
    v_add_f32 v19, v19, v23
    v_add_f32 v27, v27, v31
    v_add_f32 v16, v16, v24
    v_add_f32 v17, v17, v25
    v_add_f32 v18, v18, v26
    v_add_f32 v19, v19, v27
    s_add_u32 s56, s59, s53
    buffer_load_dwordx4 v[144:147], v4, s[40:43], s56 offen offset:0 sc1
    s_waitcnt vmcnt(9)
    v_mfma_f32_32x32x16_bf16 v[48:63], a[216:219], v[108:111], v[48:63]
    v_mfma_f32_32x32x16_bf16 v[64:79], a[220:223], v[108:111], v[64:79]
    v_cvt_pk_bf16_f32 v20, v16, v17
    v_cvt_pk_bf16_f32 v21, v18, v19
    buffer_store_dwordx2 v[20:21], v212, s[36:39], s68 offen offset:0
    s_waitcnt lgkmcnt(2)
    v_add_f32 v32, v32, v36
    s_waitcnt lgkmcnt(0)
    v_add_f32 v40, v40, v44
    v_add_f32 v33, v33, v37
    buffer_load_dwordx4 v[148:151], v4, s[40:43], s56 offen offset:1024 sc1
    s_waitcnt vmcnt(10)
    v_mfma_f32_32x32x16_bf16 v[48:63], a[224:227], v[112:115], v[48:63]
    v_mfma_f32_32x32x16_bf16 v[64:79], a[228:231], v[112:115], v[64:79]
    v_add_f32 v41, v41, v45
    v_add_f32 v34, v34, v38
    v_add_f32 v42, v42, v46
    v_add_f32 v35, v35, v39
    v_add_f32 v43, v43, v47
    v_add_f32 v32, v32, v40
    buffer_load_dwordx4 v[152:155], v4, s[40:43], s56 offen offset:2048 sc1
    s_waitcnt vmcnt(10)
    v_mfma_f32_32x32x16_bf16 v[48:63], a[232:235], v[116:119], v[48:63]
    v_mfma_f32_32x32x16_bf16 v[64:79], a[236:239], v[116:119], v[64:79]
    v_add_f32 v33, v33, v41
    v_add_f32 v34, v34, v42
    v_add_f32 v35, v35, v43
    v_cvt_pk_bf16_f32 v36, v32, v33
    v_cvt_pk_bf16_f32 v37, v34, v35
    buffer_store_dwordx2 v[36:37], v212, s[36:39], s69 offen offset:0
    buffer_load_dwordx4 v[156:159], v4, s[40:43], s56 offen offset:3072 sc1
    s_waitcnt vmcnt(11)
    v_mfma_f32_32x32x16_bf16 v[48:63], a[240:243], v[120:123], v[48:63]
    v_mfma_f32_32x32x16_bf16 v[64:79], a[244:247], v[120:123], v[64:79]
    s_add_u32 s56, s59, s54
    buffer_load_dwordx4 v[160:163], v4, s[40:43], s56 offen offset:0 sc1
    s_waitcnt vmcnt(11)
    v_mfma_f32_32x32x16_bf16 v[48:63], a[248:251], v[124:127], v[48:63]
    v_mfma_f32_32x32x16_bf16 v[64:79], a[252:255], v[124:127], v[64:79]
    buffer_load_dwordx4 v[164:167], v4, s[40:43], s56 offen offset:1024 sc1
    s_waitcnt vmcnt(11)
    v_mfma_f32_32x32x16_bf16 v[48:63], a[0:3], v[128:131], v[48:63]
    v_mfma_f32_32x32x16_bf16 v[64:79], a[4:7], v[128:131], v[64:79]
    buffer_load_dwordx4 v[168:171], v4, s[40:43], s56 offen offset:2048 sc1
    s_waitcnt vmcnt(11)
    v_mfma_f32_32x32x16_bf16 v[48:63], a[8:11], v[132:135], v[48:63]
    v_mfma_f32_32x32x16_bf16 v[64:79], a[12:15], v[132:135], v[64:79]
    buffer_load_dwordx4 v[172:175], v4, s[40:43], s56 offen offset:3072 sc1
    s_waitcnt vmcnt(11)
    v_mfma_f32_32x32x16_bf16 v[48:63], a[16:19], v[136:139], v[48:63]
    v_mfma_f32_32x32x16_bf16 v[64:79], a[20:23], v[136:139], v[64:79]
    s_waitcnt vmcnt(10)
    v_mfma_f32_32x32x16_bf16 v[48:63], a[24:27], v[140:143], v[48:63]
    v_mfma_f32_32x32x16_bf16 v[64:79], a[28:31], v[140:143], v[64:79]
    s_waitcnt vmcnt(9)
    v_mfma_f32_32x32x16_bf16 v[48:63], a[32:35], v[144:147], v[48:63]
    v_mfma_f32_32x32x16_bf16 v[64:79], a[36:39], v[144:147], v[64:79]
    s_waitcnt vmcnt(7)
    v_mfma_f32_32x32x16_bf16 v[48:63], a[40:43], v[148:151], v[48:63]
    v_mfma_f32_32x32x16_bf16 v[64:79], a[44:47], v[148:151], v[64:79]
    s_waitcnt vmcnt(6)
    v_mfma_f32_32x32x16_bf16 v[48:63], a[48:51], v[152:155], v[48:63]
    v_mfma_f32_32x32x16_bf16 v[64:79], a[52:55], v[152:155], v[64:79]
    s_waitcnt vmcnt(4)
    v_mfma_f32_32x32x16_bf16 v[48:63], a[56:59], v[156:159], v[48:63]
    v_mfma_f32_32x32x16_bf16 v[64:79], a[60:63], v[156:159], v[64:79]
    s_waitcnt vmcnt(3)
    v_mfma_f32_32x32x16_bf16 v[64:79], a[68:71], v[160:163], v[64:79]
    s_waitcnt vmcnt(2)
    v_mfma_f32_32x32x16_bf16 v[64:79], a[76:79], v[164:167], v[64:79]
    s_waitcnt vmcnt(1)
    v_mfma_f32_32x32x16_bf16 v[64:79], a[84:87], v[168:171], v[64:79]
    s_waitcnt vmcnt(0)
    v_mfma_f32_32x32x16_bf16 v[64:79], a[92:95], v[172:175], v[64:79]
    v_mfma_f32_32x32x16_bf16 v[48:63], a[64:67], v[160:163], v[48:63]
    v_mfma_f32_32x32x16_bf16 v[48:63], a[72:75], v[164:167], v[48:63]
    s_nop 9
    ds_write_b32 v237, v64 offset:8192
    ds_write_b32 v237, v66 offset:8448
    ds_write_b32 v237, v65 offset:8320
    ds_write_b32 v237, v67 offset:8576
    ds_write_b32 v237, v68 offset:9216
    ds_write_b32 v237, v70 offset:9472
    v_mfma_f32_32x32x16_bf16 v[48:63], a[80:83], v[168:171], v[48:63]
    ds_write_b32 v237, v69 offset:9344
    ds_write_b32 v237, v71 offset:9600
    ds_write_b32 v237, v72 offset:10240
    ds_write_b32 v237, v74 offset:10496
    ds_write_b32 v237, v73 offset:10368
    ds_write_b32 v237, v75 offset:10624
    v_mfma_f32_32x32x16_bf16 v[48:63], a[88:91], v[172:175], v[48:63]
    ds_write_b32 v237, v76 offset:11264
    ds_write_b32 v237, v78 offset:11520
    ds_write_b32 v237, v77 offset:11392
    ds_write_b32 v237, v79 offset:11648
    s_nop 7
    ds_write_b32 v236, v48 offset:8192
    ds_write_b32 v236, v50 offset:8448
    ds_write_b32 v236, v49 offset:8320
    ds_write_b32 v236, v51 offset:8576
    ds_write_b32 v236, v52 offset:9216
    ds_write_b32 v236, v54 offset:9472
    ds_write_b32 v236, v53 offset:9344
    ds_write_b32 v236, v55 offset:9600
    ds_write_b32 v236, v56 offset:10240
    ds_write_b32 v236, v58 offset:10496
    ds_write_b32 v236, v57 offset:10368
    ds_write_b32 v236, v59 offset:10624
    ds_write_b32 v236, v60 offset:11264
    ds_write_b32 v236, v62 offset:11520
    ds_write_b32 v236, v61 offset:11392
    ds_write_b32 v236, v63 offset:11648
    s_waitcnt lgkmcnt(0)
    s_barrier
    ds_read_b128 v[48:51], v238 offset:8192
    ds_read_b128 v[52:55], v238 offset:45056
    ds_read_b128 v[56:59], v239 offset:8192
    ds_read_b128 v[60:63], v239 offset:45056
    ds_read_b128 v[64:67], v238 offset:9216
    ds_read_b128 v[68:71], v238 offset:46080
    ds_read_b128 v[72:75], v239 offset:9216
    ds_read_b128 v[76:79], v239 offset:46080
    s_waitcnt lgkmcnt(6)
    v_pk_add_f32 v[48:49], v[48:49], v[52:53]
    s_waitcnt lgkmcnt(4)
    v_pk_add_f32 v[56:57], v[56:57], v[60:61]
    v_pk_add_f32 v[50:51], v[50:51], v[54:55]
    v_pk_add_f32 v[58:59], v[58:59], v[62:63]
    v_pk_add_f32 v[48:49], v[48:49], v[56:57]
    v_pk_add_f32 v[50:51], v[50:51], v[58:59]
    v_cvt_pk_bf16_f32 v52, v48, v49
    v_cvt_pk_bf16_f32 v53, v50, v51
    buffer_store_dwordx2 v[52:53], v212, s[36:39], s68 offen offset:64
    s_waitcnt lgkmcnt(2)
    v_pk_add_f32 v[64:65], v[64:65], v[68:69]
    s_waitcnt lgkmcnt(0)
    v_pk_add_f32 v[72:73], v[72:73], v[76:77]
    v_pk_add_f32 v[66:67], v[66:67], v[70:71]
    v_pk_add_f32 v[74:75], v[74:75], v[78:79]
    v_pk_add_f32 v[64:65], v[64:65], v[72:73]
    v_pk_add_f32 v[66:67], v[66:67], v[74:75]
    v_cvt_pk_bf16_f32 v68, v64, v65
    v_cvt_pk_bf16_f32 v69, v66, v67
    buffer_store_dwordx2 v[68:69], v212, s[36:39], s69 offen offset:64
L_end_P:
    s_endpgm

.section .rodata,"a"
.p2align 6
.amdhsa_kernel sequential_preLN__sliding_local_dilated__mixer_token_mlp__prompt_kernel
  .amdhsa_next_free_vgpr 508
  .amdhsa_next_free_sgpr 102
  .amdhsa_accum_offset 252
  .amdhsa_group_segment_fixed_size 0
  .amdhsa_kernarg_size 88
  .amdhsa_user_sgpr_count 2
  .amdhsa_user_sgpr_kernarg_segment_ptr 1
  .amdhsa_system_sgpr_workgroup_id_x 1
.end_amdhsa_kernel
```

```asm
; @launch grid=(256,1,1) block=(256,1,1) lds=163840
.amdgcn_target "amdgcn-amd-amdhsa--gfx950"
.text
.globl sequential_preLN__sliding_local_dilated__mixer_token_mlp__prompt_kernel
.p2align 8
.type sequential_preLN__sliding_local_dilated__mixer_token_mlp__prompt_kernel,@function
sequential_preLN__sliding_local_dilated__mixer_token_mlp__prompt_kernel:
    s_cmp_ge_u32 s2, 256
    s_cbranch_scc1 L_end_P
    s_load_dwordx2 s[8:9], s[0:1], 0
    s_load_dwordx2 s[12:13], s[0:1], 8
    s_load_dwordx2 s[44:45], s[0:1], 72
    s_load_dwordx2 s[40:41], s[0:1], 80
    s_load_dwordx2 s[16:17], s[0:1], 16
    s_load_dwordx2 s[20:21], s[0:1], 32
    s_load_dwordx2 s[24:25], s[0:1], 48
    s_load_dwordx2 s[28:29], s[0:1], 40
    s_load_dwordx2 s[32:33], s[0:1], 56
    s_load_dwordx2 s[36:37], s[0:1], 64
    v_lshrrev_b32 v1, 6, v0
    s_nop 0
    v_readfirstlane_b32 s3, v1
    v_and_b32 v1, 63, v0
    v_and_b32 v2, 15, v0
    v_lshrrev_b32 v3, 4, v1
    v_lshlrev_b32 v4, 4, v1
    s_mov_b32 s10, 0x1c0000
    s_mov_b32 s11, 0x00020000
    s_mov_b32 s14, 0x126000
    s_mov_b32 s15, 0x00020000
    s_mov_b32 s46, 0x100
    s_mov_b32 s47, 0x00020000
    s_mov_b32 s42, 0x600000
    s_mov_b32 s43, 0x00020000
    s_mov_b32 s18, 0x62000
    s_mov_b32 s19, 0x00020000
    s_mov_b32 s22, 0x700000
    s_mov_b32 s23, 0x00020000
    s_mov_b32 s26, 0x700000
    s_mov_b32 s27, 0x00020000
    s_mov_b32 s30, 0xe00
    s_mov_b32 s31, 0x00020000
    s_mov_b32 s34, 0x1000
    s_mov_b32 s35, 0x00020000
    s_mov_b32 s38, 0x1c0000
    s_mov_b32 s39, 0x00020000
    s_mov_b32 s5, 0x3f803f80
    s_mov_b32 s6, 0x200000
    s_bfe_u32 s48, s2, 0x20001
    s_lshl_b32 s48, s48, 2
    s_lshr_b32 s53, s2, 6
    s_add_u32 s48, s48, s53
    s_bfe_u32 s49, s2, 0x30003
    s_and_b32 s53, s2, 1
    s_lshl_b32 s53, s53, 3
    s_add_u32 s49, s49, s53
    v_lshrrev_b32 v237, 2, v1
    v_mul_u32_u24 v123, 2688, v237
    v_lshrrev_b32 v237, 5, v1
    v_lshlrev_b32 v237, 1, v237
    v_and_b32 v238, 3, v1
    v_xor_b32 v237, v237, v238
    v_lshl_add_u32 v123, v237, 4, v123
    s_mul_i32 s53, s49, 56
    s_min_u32 s53, s53, 832
    s_mul_i32 s51, s3, 43008
    s_add_u32 s53, s53, s51
    v_add_u32 v123, s53, v123
    s_lshr_b32 s53, s3, 1
    s_mul_i32 s51, s53, 6144
    s_and_b32 s53, s3, 1
    s_lshl_b32 s53, s53, 10
    s_add_u32 s51, s51, s53
    v_lshrrev_b32 v237, 3, v1
    v_mul_u32_u24 v122, 896, v237
    v_and_b32 v237, 7, v1
    v_xor_b32 v237, v237, v3
    v_lshl_add_u32 v120, v237, 4, v122
    s_lshl_b32 s50, s48, 7
    s_lshl_b32 s53, s3, 5
    s_add_u32 s53, s53, s50
    s_mul_i32 s53, s53, 896
    v_xor_b32 v121, 64, v120
    v_add_u32 v120, s53, v120
    s_add_u32 s53, s53, 7168
    v_add_u32 v121, s53, v121
    s_lshl_b32 s53, s3, 1
    v_xor_b32 v237, s53, v237
    v_lshl_add_u32 v122, v237, 4, v122
    s_lshl_b32 s53, s3, 2
    s_add_u32 s53, s53, s50
    s_sub_u32 s53, s53, 16
    s_mul_i32 s53, s53, 896
    s_cmp_eq_u32 s48, 0
    s_cselect_b32 s53, 0x40000000, s53
    v_add_u32 v122, s53, v122
    s_lshl_b32 s52, s3, 12
    s_add_u32 s52, s52, 63488
    s_lshl_b32 s7, s3, 9
    s_cmp_eq_u32 s3, 0
    s_cselect_b32 s54, 0xffffff00, -1
    s_mov_b32 s55, 0
    s_memrealtime s[86:87]
    v_mov_b32 v7, 0
    s_waitcnt lgkmcnt(0)
    s_or_b32 s86, s86, 1
    v_mov_b32 v6, s86
    s_or_b32 s86, s2, s3
    s_cmp_eq_u32 s86, 0
    s_cselect_b64 exec, 1, 0
    buffer_store_dword v6, v7, s[44:47], 0 offen sc1
    s_mov_b64 exec, -1
    s_add_u32 m0, s51, 12288
    s_mov_b32 s73, 0
    buffer_load_dwordx4 v123, s[12:15], s73 offen lds
    s_add_u32 m0, s51, 14336
    s_mov_b32 s73, 896
    buffer_load_dwordx4 v123, s[12:15], s73 offen lds
    s_add_u32 m0, s51, 16384
    s_mov_b32 s73, 1792
    buffer_load_dwordx4 v123, s[12:15], s73 offen lds
    s_add_u32 m0, s52, 36864
    s_mov_b32 s73, 0
    buffer_load_dwordx4 v120, s[8:11], s73 offen lds
    s_add_u32 m0, s52, 37888
    s_mov_b32 s73, 0
    buffer_load_dwordx4 v121, s[8:11], s73 offen lds
    s_add_u32 m0, s52, 38912
    s_mov_b32 s73, 14336
    buffer_load_dwordx4 v120, s[8:11], s73 offen lds
    s_add_u32 m0, s52, 39936
    s_mov_b32 s73, 14336
    buffer_load_dwordx4 v121, s[8:11], s73 offen lds
    s_add_u32 m0, s7, 98304
    s_mov_b32 s73, 0
    s_mov_b64 exec, s[54:55]
    buffer_load_dwordx4 v122, s[8:11], s73 offen lds
    s_mov_b64 exec, -1
    s_bfe_u32 s53, s2, 0x30003
    s_add_u32 s86, s53, 1
    s_lshr_b32 s86, s86, 1
    s_lshr_b32 s87, s2, 6
    s_mul_i32 s87, s87, 5
    s_add_u32 s86, s86, s87
    s_lshl_b32 s86, s86, 2
    s_add_u32 s53, s86, s3
    s_mov_b32 s56, s53
    s_mov_b32 s86, 0x2a54
    s_bitcmp1_b32 s86, s49
    s_cselect_b32 s57, 0x40000000, 0
    s_mul_i32 s86, s53, 58
    v_add_u32 v237, s86, v1
    v_mul_u32_u24 v238, 43691, v237
    v_lshrrev_b32 v238, 19, v238
    v_mul_u32_u24 v239, 12, v238
    v_sub_u32 v239, v237, v239
    v_lshrrev_b32 v239, 2, v239
    v_mul_u32_u24 v239, 896, v239
    v_mul_u32_u24 v238, 2688, v238
    v_and_b32 v237, 3, v237
    v_lshlrev_b32 v237, 7, v237
    v_add3_u32 v237, v237, v238, v239
    v_add_u32 v237, s57, v237
    s_and_b32 s87, s2, 1
    s_mul_i32 s87, s87, 384
    s_add_u32 s87, s87, 172032
    s_mov_b32 exec_lo, 0xffffffff
    s_mov_b32 exec_hi, 0x3ffffff
    buffer_load_dword v232, v237, s[12:15], s87 offen
    s_mov_b64 exec, -1
    v_lshlrev_b32 v237, 7, v1
    v_add_u32 v238, s57, v237
    s_mul_i32 s86, s53, 6016
    s_bfe_u32 s87, s2, 0x20001
    s_mul_i32 s87, s87, 458752
    s_add_u32 s86, s86, s87
    s_max_u32 s86, s86, 14336
    s_sub_u32 s86, s86, 14336
    s_mov_b32 exec_hi, 0x7fff
    buffer_load_dword v233, v238, s[8:11], s86 offen
    s_getpc_b64 s[86:87]
Lpc_P:
    s_mul_i32 s53, s53, 384
    v_add_u32 v237, s53, v237
    v_min_u32 v237, L_end_P-Lpc_P, v237
    s_mov_b64 exec, 7
    global_load_dword v236, v237, s[86:87]
    s_mov_b64 exec, -1
    v_mul_u32_u24 v237, 18432, v3
    v_lshl_add_u32 v237, v2, 3, v237
    v_mov_b32 v238, s5
    v_add_u32 v237, 61440, v237
    ds_write2_b32 v237, v238, v238 offset0:0 offset1:1
    s_lshr_b32 s68, s2, 3
    s_mul_i32 s69, s68, 37
    s_lshr_b32 s69, s69, 8
    s_mul_i32 s64, s69, 7
    s_sub_u32 s64, s68, s64
    s_mov_b32 s66, s64
    s_and_b32 s68, s2, 7
    s_lshl_b32 s67, s68, 2
    s_add_u32 s67, s67, s69
    s_cmp_ge_u32 s69, 4
    s_cselect_b32 s67, 99, s67
    s_mul_i32 s71, s68, 3
    s_add_u32 s71, s71, 4
    s_lshl_b32 s72, s68, 2
    s_cmp_lt_u32 s68, 4
    s_cselect_b32 s65, s72, s71
    s_cselect_b32 s71, 4, 3
    s_add_u32 s65, s65, s69
    s_cmp_ge_u32 s69, s71
    s_cselect_b32 s65, 99, s65
    v_lshrrev_b32 v219, 3, v1
    v_mul_u32_u24 v208, 896, v219
    v_and_b32 v219, 1, v3
    v_lshlrev_b32 v219, 2, v219
    v_and_b32 v220, 7, v1
    v_xor_b32 v219, v219, v220
    v_lshl_add_u32 v208, v219, 4, v208
    s_lshl_b32 s58, s66, 7
    s_mul_i32 s60, s3, 100352
    s_add_u32 s58, s58, s60
    v_add_u32 v208, s58, v208
    s_mul_i32 s59, s3, 36864
    s_add_u32 s59, s59, 12288
    v_lshrrev_b32 v219, 5, v1
    v_lshlrev_b32 v209, 9, v219
    v_bfe_u32 v219, v1, 2, 2
    v_lshl_add_u32 v209, v219, 7, v209
    v_lshrrev_b32 v219, 1, v219
    s_and_b32 s58, s3, 1
    v_xor_b32 v219, s58, v219
    v_lshl_add_u32 v209, v219, 6, v209
    v_and_b32 v219, 1, v3
    v_lshl_add_u32 v209, v219, 5, v209
    v_and_b32 v219, 3, v1
    v_lshl_add_u32 v209, v219, 3, v209
    v_add_u32 v209, 12288, v209
    v_lshrrev_b32 v219, 5, v1
    v_lshlrev_b32 v219, 10, v219
    v_sub_u32 v210, v209, v219
    s_mul_i32 s70, s3, 36864
    s_add_u32 s70, s70, 12288
    v_lshrrev_b32 v219, 3, v1
    v_mul_u32_u24 v213, 3584, v219
    v_and_b32 v219, 1, v3
    v_lshlrev_b32 v219, 2, v219
    v_and_b32 v220, 7, v1
    v_xor_b32 v219, v219, v220
    v_lshl_add_u32 v213, v219, 4, v213
    s_mul_i32 s68, s3, 1835008
    s_lshl_b32 s69, s65, 7
    s_add_u32 s68, s68, s69
    s_cmp_ge_u32 s65, 99
    s_cselect_b32 s68, 0x40000000, s68
    v_add_u32 v213, s68, v213
    s_cselect_b32 s68, 0x40000000, 0
    v_add_u32 v5, s68, v4
    v_lshrrev_b32 v219, 5, v1
    v_lshlrev_b32 v215, 9, v219
    v_bfe_u32 v219, v1, 2, 2
    v_lshl_add_u32 v215, v219, 7, v215
    v_lshrrev_b32 v219, 1, v219
    s_lshr_b32 s68, s3, 1
    v_xor_b32 v219, s68, v219
    v_lshl_add_u32 v215, v219, 6, v215
    v_and_b32 v219, 1, v3
    v_lshl_add_u32 v215, v219, 5, v215
    v_and_b32 v219, 3, v1
    v_lshl_add_u32 v215, v219, 3, v215
    s_and_b32 s68, s3, 1
    s_lshl_b32 s68, s68, 5
    v_xor_b32 v215, s68, v215
    v_add_u32 v215, s70, v215
    v_xor_b32 v216, 64, v215
    s_mul_i32 s70, s3, 36864
    s_add_u32 s70, s70, 12288
    v_lshrrev_b32 v219, 3, v1
    v_mul_u32_u24 v214, 4096, v219
    v_and_b32 v219, 1, v3
    v_lshlrev_b32 v219, 2, v219
    v_and_b32 v220, 7, v1
    v_xor_b32 v219, v219, v220
    v_lshl_add_u32 v214, v219, 4, v214
    s_mul_i32 s68, s3, 1835008
    s_lshl_b32 s69, s67, 7
    s_add_u32 s68, s68, s69
    s_cmp_ge_u32 s67, 99
    s_cselect_b32 s68, 0x40000000, s68
    v_add_u32 v214, s68, v214
    v_lshrrev_b32 v219, 5, v1
    v_lshlrev_b32 v217, 9, v219
    v_bfe_u32 v219, v1, 2, 2
    v_lshl_add_u32 v217, v219, 7, v217
    v_lshrrev_b32 v219, 1, v219
    s_lshr_b32 s68, s3, 1
    v_xor_b32 v219, s68, v219
    v_lshl_add_u32 v217, v219, 6, v217
    v_and_b32 v219, 1, v3
    v_lshl_add_u32 v217, v219, 5, v217
    v_and_b32 v219, 3, v1
    v_lshl_add_u32 v217, v219, 3, v217
    v_add_u32 v217, s70, v217
    v_xor_b32 v218, 64, v217
    s_and_b32 s68, s2, 7
    s_cmp_ge_u32 s68, 8
    s_cselect_b32 s94, 8, 0
    s_sub_u32 s68, s68, s94
    s_lshl_b32 s94, s68, 12
    s_add_u32 s68, s68, 1
    s_cmp_ge_u32 s68, 8
    s_cselect_b32 s95, 8, 0
    s_sub_u32 s68, s68, s95
    s_lshl_b32 s95, s68, 12
    s_add_u32 s68, s68, 1
    s_cmp_ge_u32 s68, 8
    s_cselect_b32 s96, 8, 0
    s_sub_u32 s68, s68, s96
    s_lshl_b32 s96, s68, 12
    s_add_u32 s68, s68, 1
    s_cmp_ge_u32 s68, 8
    s_cselect_b32 s97, 8, 0
    s_sub_u32 s68, s68, s97
    s_lshl_b32 s97, s68, 12
    s_add_u32 s68, s68, 1
    s_cmp_ge_u32 s68, 8
    s_cselect_b32 s98, 8, 0
    s_sub_u32 s68, s68, s98
    s_lshl_b32 s98, s68, 12
    s_add_u32 s68, s68, 1
    s_cmp_ge_u32 s68, 8
    s_cselect_b32 s99, 8, 0
    s_sub_u32 s68, s68, s99
    s_lshl_b32 s99, s68, 12
    s_add_u32 s68, s68, 1
    s_cmp_ge_u32 s68, 8
    s_cselect_b32 s100, 8, 0
    s_sub_u32 s68, s68, s100
    s_lshl_b32 s100, s68, 12
    s_add_u32 s68, s68, 1
    s_cmp_ge_u32 s68, 8
    s_cselect_b32 s101, 8, 0
    s_sub_u32 s68, s68, s101
    s_lshl_b32 s101, s68, 12
    s_lshl_b32 s80, s48, 2
    s_add_u32 s80, s80, s3
    s_lshl_b32 s80, s80, 11
    s_lshr_b32 s93, s49, 2
    s_lshl_b32 s93, s93, 7
    s_add_u32 s80, s80, s93
    s_and_b32 s93, s49, 3
    s_lshl_b32 s93, s93, 2
    s_add_u32 s80, s80, s93
    s_add_u32 s80, s80, 0x5c8000
    s_lshl_b32 s83, s67, 1
    s_lshr_b32 s93, s3, 1
    s_add_u32 s83, s83, s93
    s_lshl_b32 s83, s83, 11
    s_add_u32 s83, s83, 0x5c8000
    v_lshrrev_b32 v10, 2, v2
    v_lshlrev_b32 v10, 7, v10
    v_and_b32 v219, 3, v2
    v_lshl_add_u32 v10, v219, 2, v10
    s_lshl_b32 s84, s64, 12
    s_lshl_b32 s85, s84, 1
    s_add_u32 s85, s85, 0x5f0000
    s_add_u32 s84, s84, 0x5e8000
    s_lshl_b32 s81, s67, 5
    s_add_u32 s81, s81, s3
    s_lshl_b32 s81, s81, 2
    s_add_u32 s81, s81, s84
    s_lshl_b32 s93, s3, 10
    s_add_u32 s84, s84, s93
    v_bfe_u32 v11, v1, 2, 3
    v_min_u32 v12, 6, v11
    v_and_b32 v219, 3, v1
    v_lshlrev_b32 v219, 2, v219
    v_lshl_add_u32 v11, v11, 7, v219
    v_lshl_add_u32 v12, v12, 7, v219
    s_lshl_b32 s82, s65, 5
    s_add_u32 s82, s82, s3
    s_lshl_b32 s82, s82, 2
    s_add_u32 s82, s82, s85
    s_mul_i32 s93, s3, 896
    s_add_u32 s85, s85, s93
    v_mov_b32 v9, 0
    v_lshlrev_b32 v124, 9, v3
    v_bfe_u32 v237, v1, 2, 2
    v_lshl_add_u32 v124, v237, 6, v124
    v_and_b32 v237, 3, v1
    v_lshl_add_u32 v124, v237, 3, v124
    v_and_b32 v237, 1, v3
    v_lshlrev_b32 v237, 5, v237
    v_add_u32 v124, v124, v237
    v_add_u32 v124, 12288, v124
    v_xor_b32 v125, 32, v124
    s_and_b32 s53, s3, 1
    s_lshl_b32 s53, s53, 5
    v_xor_b32 v127, s53, v124
    s_lshr_b32 s53, s3, 1
    s_lshl_b32 s53, s53, 11
    s_add_u32 s53, s53, 2048
    v_add_u32 v126, s53, v127
    v_lshrrev_b32 v237, 1, v2
    v_xor_b32 v237, v237, v3
    v_lshlrev_b32 v237, 4, v237
    v_lshl_add_u32 v237, v2, 7, v237
    v_add_u32 v130, 61440, v237
    v_xor_b32 v131, 64, v130
    v_add_u32 v128, s52, v237
    v_xor_b32 v129, 64, v128
    v_lshlrev_b32 v237, 2, v3
    v_sub_u32 v237, v2, v237
    v_mov_b32 v239, 0xf149f2ca
    v_add_u32 v238, 16, v237
    v_and_b32 v238, 0xfffffff1, v238
    v_cmp_eq_u32 vcc, 0, v238
    s_nop 1
    v_cndmask_b32 v240, v239, 0, vcc
    v_add_u32 v238, 15, v237
    v_and_b32 v238, 0xfffffff1, v238
    v_cmp_eq_u32 vcc, 0, v238
    s_nop 1
    v_cndmask_b32 v241, v239, 0, vcc
    v_add_u32 v238, 14, v237
    v_and_b32 v238, 0xfffffff1, v238
    v_cmp_eq_u32 vcc, 0, v238
    s_nop 1
    v_cndmask_b32 v242, v239, 0, vcc
    v_add_u32 v238, 13, v237
    v_and_b32 v238, 0xfffffff1, v238
    v_cmp_eq_u32 vcc, 0, v238
    s_nop 1
    v_cndmask_b32 v243, v239, 0, vcc
    v_add_u32 v238, 0, v237
    v_and_b32 v238, 0xfffffff1, v238
    v_cmp_eq_u32 vcc, 0, v238
    s_nop 1
    v_cndmask_b32 v244, v239, 0, vcc
    v_add_u32 v238, -1, v237
    v_and_b32 v238, 0xfffffff1, v238
    v_cmp_eq_u32 vcc, 0, v238
    s_nop 1
    v_cndmask_b32 v245, v239, 0, vcc
    v_add_u32 v238, -2, v237
    v_and_b32 v238, 0xfffffff1, v238
    v_cmp_eq_u32 vcc, 0, v238
    s_nop 1
    v_cndmask_b32 v246, v239, 0, vcc
    v_add_u32 v238, -3, v237
    v_and_b32 v238, 0xfffffff1, v238
    v_cmp_eq_u32 vcc, 0, v238
    s_nop 1
    v_cndmask_b32 v247, v239, 0, vcc
    s_or_b32 s53, s48, s3
    s_cmp_eq_u32 s53, 0
    s_cselect_b64 vcc, -1, 0
    v_cndmask_b32 v248, v240, v239, vcc
    v_cndmask_b32 v249, v241, v239, vcc
    v_cndmask_b32 v250, v242, v239, vcc
    v_cndmask_b32 v251, v243, v239, vcc
    v_mov_b32 v40, s5
    v_mov_b32 v41, s5
    v_mov_b32 v42, s5
    v_mov_b32 v43, s5
    s_mov_b32 s88, 0x22222222
    s_mov_b32 s89, 0x22222222
    s_mov_b32 s90, 0x44444444
    s_mov_b32 s91, 0x44444444
    s_mov_b32 s92, 0x88888888
    s_mov_b32 s93, 0x88888888
    v_lshlrev_b32 v72, 4, v3
    s_lshl_b32 s53, s3, 6
    v_add_u32 v73, s53, v72
    s_and_b32 s53, s53, 64
    v_add_u32 v74, s53, v72
    s_mul_i32 s53, s3, 384
    v_lshl_add_u32 v75, v2, 2, s53
    v_add_u32 v76, s53, v72
    s_and_b32 s53, s3, 1
    s_lshl_b32 s53, s53, 3
    v_add_u32 v80, s53, v4
    v_lshrrev_b32 v81, 2, v2
    v_lshlrev_b32 v81, 8, v81
    v_lshl_add_u32 v81, v3, 6, v81
    v_and_b32 v82, 3, v2
    v_lshl_add_u32 v81, v82, 1, v81
    v_add_u32 v81, s53, v81
    v_add_u32 v81, 1024, v81
    s_cmp_lt_u32 s3, 2
    s_cselect_b64 vcc, -1, 0
    s_cselect_b32 s53, 2, 16
    v_cndmask_b32 v80, v81, v80, vcc
    v_add_u32 v81, s53, v80
    v_add_u32 v82, s53, v81
    v_add_u32 v83, s53, v82
    v_lshlrev_b32 v77, 2, v2
    s_lshl_b32 s53, s3, 11
    v_add_u32 v78, s53, v4
    s_lshl_b32 s62, s48, 3
    s_lshl_b32 s63, s3, 1
    s_add_u32 s62, s62, s63
    s_lshl_b32 s62, s62, 4
    s_add_u32 s62, s62, s49
    s_lshl_b32 s62, s62, 10
    s_add_u32 s63, s62, 16384
    s_add_u32 m0, s51, 24576
    s_mov_b32 s73, 172032
    buffer_load_dwordx4 v123, s[12:15], s73 offen lds
    s_add_u32 m0, s51, 26624
    s_mov_b32 s73, 172928
    buffer_load_dwordx4 v123, s[12:15], s73 offen lds
    s_add_u32 m0, s51, 28672
    s_mov_b32 s73, 173824
    buffer_load_dwordx4 v123, s[12:15], s73 offen lds
    s_add_u32 m0, s52, 18432
    s_mov_b32 s73, 128
    buffer_load_dwordx4 v120, s[8:11], s73 offen lds
    s_add_u32 m0, s52, 19456
    s_mov_b32 s73, 128
    buffer_load_dwordx4 v121, s[8:11], s73 offen lds
    s_add_u32 m0, s52, 20480
    s_mov_b32 s73, 14464
    buffer_load_dwordx4 v120, s[8:11], s73 offen lds
    s_add_u32 m0, s52, 21504
    s_mov_b32 s73, 14464
    buffer_load_dwordx4 v121, s[8:11], s73 offen lds
    s_add_u32 m0, s7, 79872
    s_mov_b32 s73, 128
    s_mov_b64 exec, s[54:55]
    buffer_load_dwordx4 v122, s[8:11], s73 offen lds
    s_mov_b64 exec, -1
    s_waitcnt vmcnt(11)
    s_waitcnt lgkmcnt(0)
    s_barrier
    ds_read_b128 v[16:19], v128 offset:36864
    ds_read_b128 v[20:23], v128 offset:38912
    ds_read_b128 v[24:27], v130 offset:36864
    ds_read_b64_tr_b16 v[88:89], v124 offset:0
    ds_read_b64_tr_b16 v[90:91], v124 offset:256
    ds_read_b64_tr_b16 v[92:93], v125 offset:0
    ds_read_b64_tr_b16 v[94:95], v125 offset:256
    ds_read_b64_tr_b16 v[96:97], v124 offset:2048
    ds_read_b64_tr_b16 v[98:99], v124 offset:2304
    ds_read_b64_tr_b16 v[100:101], v125 offset:2048
    ds_read_b64_tr_b16 v[102:103], v125 offset:2304
    ds_read_b64_tr_b16 v[104:105], v124 offset:4096
    ds_read_b64_tr_b16 v[106:107], v124 offset:4352
    ds_read_b64_tr_b16 v[108:109], v125 offset:4096
    ds_read_b64_tr_b16 v[110:111], v125 offset:4352
    ds_read_b64_tr_b16 v[112:113], v126 offset:0
    ds_read_b64_tr_b16 v[114:115], v126 offset:256
    ds_read_b64_tr_b16 v[116:117], v127 offset:0
    ds_read_b64_tr_b16 v[118:119], v127 offset:256
    s_waitcnt lgkmcnt(8)
    v_mfma_f32_16x16x32_bf16 v[136:139], v[88:91], v[16:19], 0
    ds_read_b128 v[28:31], v129 offset:36864
    v_mfma_f32_16x16x32_bf16 v[160:163], v[88:91], v[20:23], 0
    ds_read_b128 v[32:35], v129 offset:38912
    v_mfma_f32_16x16x32_bf16 v[140:143], v[92:95], v[16:19], 0
    ds_read_b128 v[36:39], v131 offset:36864
    v_mfma_f32_16x16x32_bf16 v[164:167], v[92:95], v[20:23], 0
    ds_read_b64_tr_b16 v[88:89], v124 offset:6144
    v_mfma_f32_16x16x32_bf16 v[144:147], v[96:99], v[16:19], 0
    ds_read_b64_tr_b16 v[90:91], v124 offset:6400
    s_add_u32 m0, s51, 36864
    s_mov_b32 s73, 344064
    buffer_load_dwordx4 v123, s[12:15], s73 offen lds
    v_mfma_f32_16x16x32_bf16 v[168:171], v[96:99], v[20:23], 0
    ds_read_b64_tr_b16 v[92:93], v125 offset:6144
    v_mfma_f32_16x16x32_bf16 v[148:151], v[100:103], v[16:19], 0
    ds_read_b64_tr_b16 v[94:95], v125 offset:6400
    v_mfma_f32_16x16x32_bf16 v[172:175], v[100:103], v[20:23], 0
    ds_read_b64_tr_b16 v[96:97], v124 offset:8192
    s_waitcnt lgkmcnt(8)
    v_mfma_f32_16x16x32_bf16 v[152:155], v[16:19], v[104:107], 0
    ds_read_b64_tr_b16 v[98:99], v124 offset:8448
    v_mfma_f32_16x16x32_bf16 v[176:179], v[20:23], v[104:107], 0
    ds_read_b64_tr_b16 v[100:101], v125 offset:8192
    s_add_u32 m0, s51, 38912
    s_mov_b32 s73, 344960
    buffer_load_dwordx4 v123, s[12:15], s73 offen lds
    v_mfma_f32_16x16x32_bf16 v[156:159], v[16:19], v[108:111], 0
    ds_read_b64_tr_b16 v[102:103], v125 offset:8448
    v_mfma_f32_16x16x32_bf16 v[180:183], v[20:23], v[108:111], 0
    ds_read_b64_tr_b16 v[104:105], v124 offset:10240
    v_mfma_f32_16x16x32_bf16 v[184:187], v[112:115], v[24:27], 0
    ds_read_b64_tr_b16 v[106:107], v124 offset:10496
    v_mfma_f32_16x16x32_bf16 v[188:191], v[116:119], v[24:27], 0
    ds_read_b64_tr_b16 v[108:109], v125 offset:10240
    v_mfma_f32_16x16x32_bf16 v[48:51], v[16:19], v[16:19], 0
    ds_read_b64_tr_b16 v[110:111], v125 offset:10496
    s_add_u32 m0, s51, 40960
    s_mov_b32 s73, 345856
    buffer_load_dwordx4 v123, s[12:15], s73 offen lds
    v_mfma_f32_16x16x32_bf16 v[52:55], v[20:23], v[20:23], 0
    ds_read_b64_tr_b16 v[112:113], v126 offset:6144
    v_mfma_f32_16x16x32_bf16 v[56:59], v[24:27], v[24:27], 0
    ds_read_b64_tr_b16 v[114:115], v126 offset:6400
    v_mfma_f32_16x16x32_bf16 v[60:63], v[40:43], v[16:19], 0
    ds_read_b64_tr_b16 v[116:117], v127 offset:6144
    v_mfma_f32_16x16x32_bf16 v[64:67], v[40:43], v[20:23], 0
    ds_read_b64_tr_b16 v[118:119], v127 offset:6400
    v_mfma_f32_16x16x32_bf16 v[68:71], v[40:43], v[24:27], 0
    s_add_u32 m0, s52, 0
    s_mov_b32 s73, 256
    buffer_load_dwordx4 v120, s[8:11], s73 offen lds
    s_add_u32 m0, s52, 1024
    s_mov_b32 s73, 256
    buffer_load_dwordx4 v121, s[8:11], s73 offen lds
    s_add_u32 m0, s52, 2048
    s_mov_b32 s73, 14592
    buffer_load_dwordx4 v120, s[8:11], s73 offen lds
    s_add_u32 m0, s52, 3072
    s_mov_b32 s73, 14592
    buffer_load_dwordx4 v121, s[8:11], s73 offen lds
    s_add_u32 m0, s7, 61440
    s_mov_b32 s73, 256
    s_mov_b64 exec, s[54:55]
    buffer_load_dwordx4 v122, s[8:11], s73 offen lds
    s_mov_b64 exec, -1
    s_waitcnt vmcnt(8)
    s_barrier
    s_waitcnt lgkmcnt(8)
    v_mfma_f32_16x16x32_bf16 v[136:139], v[88:91], v[28:31], v[136:139]
    ds_read_b128 v[16:19], v128 offset:18432
    v_mfma_f32_16x16x32_bf16 v[160:163], v[88:91], v[32:35], v[160:163]
    ds_read_b128 v[20:23], v128 offset:20480
    v_mfma_f32_16x16x32_bf16 v[140:143], v[92:95], v[28:31], v[140:143]
    ds_read_b128 v[24:27], v130 offset:18432
    v_mfma_f32_16x16x32_bf16 v[164:167], v[92:95], v[32:35], v[164:167]
    ds_read_b64_tr_b16 v[88:89], v124 offset:12288
    v_mfma_f32_16x16x32_bf16 v[144:147], v[96:99], v[28:31], v[144:147]
    ds_read_b64_tr_b16 v[90:91], v124 offset:12544
    s_add_u32 m0, s51, 49152
    s_mov_b32 s73, 516096
    buffer_load_dwordx4 v123, s[12:15], s73 offen lds
    v_mfma_f32_16x16x32_bf16 v[168:171], v[96:99], v[32:35], v[168:171]
    ds_read_b64_tr_b16 v[92:93], v125 offset:12288
    v_mfma_f32_16x16x32_bf16 v[148:151], v[100:103], v[28:31], v[148:151]
    ds_read_b64_tr_b16 v[94:95], v125 offset:12544
    v_mfma_f32_16x16x32_bf16 v[172:175], v[100:103], v[32:35], v[172:175]
    ds_read_b64_tr_b16 v[96:97], v124 offset:14336
    s_waitcnt lgkmcnt(8)
    v_mfma_f32_16x16x32_bf16 v[152:155], v[28:31], v[104:107], v[152:155]
    ds_read_b64_tr_b16 v[98:99], v124 offset:14592
    v_mfma_f32_16x16x32_bf16 v[176:179], v[32:35], v[104:107], v[176:179]
    ds_read_b64_tr_b16 v[100:101], v125 offset:14336
    s_add_u32 m0, s51, 51200
    s_mov_b32 s73, 516992
    buffer_load_dwordx4 v123, s[12:15], s73 offen lds
    v_mfma_f32_16x16x32_bf16 v[156:159], v[28:31], v[108:111], v[156:159]
    ds_read_b64_tr_b16 v[102:103], v125 offset:14592
    v_mfma_f32_16x16x32_bf16 v[180:183], v[32:35], v[108:111], v[180:183]
    ds_read_b64_tr_b16 v[104:105], v124 offset:16384
    v_mfma_f32_16x16x32_bf16 v[184:187], v[112:115], v[36:39], v[184:187]
    ds_read_b64_tr_b16 v[106:107], v124 offset:16640
    v_mfma_f32_16x16x32_bf16 v[188:191], v[116:119], v[36:39], v[188:191]
    ds_read_b64_tr_b16 v[108:109], v125 offset:16384
    v_mfma_f32_16x16x32_bf16 v[48:51], v[28:31], v[28:31], v[48:51]
    ds_read_b64_tr_b16 v[110:111], v125 offset:16640
    s_add_u32 m0, s51, 53248
    s_mov_b32 s73, 517888
    buffer_load_dwordx4 v123, s[12:15], s73 offen lds
    v_mfma_f32_16x16x32_bf16 v[52:55], v[32:35], v[32:35], v[52:55]
    ds_read_b64_tr_b16 v[112:113], v126 offset:12288
    v_mfma_f32_16x16x32_bf16 v[56:59], v[36:39], v[36:39], v[56:59]
    ds_read_b64_tr_b16 v[114:115], v126 offset:12544
    v_mfma_f32_16x16x32_bf16 v[60:63], v[40:43], v[28:31], v[60:63]
    ds_read_b64_tr_b16 v[116:117], v127 offset:12288
    v_mfma_f32_16x16x32_bf16 v[64:67], v[40:43], v[32:35], v[64:67]
    ds_read_b64_tr_b16 v[118:119], v127 offset:12544
    v_mfma_f32_16x16x32_bf16 v[68:71], v[40:43], v[36:39], v[68:71]
    s_add_u32 m0, s52, 55296
    s_mov_b32 s73, 384
    buffer_load_dwordx4 v120, s[8:11], s73 offen lds
    s_waitcnt lgkmcnt(8)
    v_mfma_f32_16x16x32_bf16 v[136:139], v[88:91], v[16:19], v[136:139]
    ds_read_b128 v[28:31], v129 offset:18432
    v_mfma_f32_16x16x32_bf16 v[160:163], v[88:91], v[20:23], v[160:163]
    ds_read_b128 v[32:35], v129 offset:20480
    v_mfma_f32_16x16x32_bf16 v[140:143], v[92:95], v[16:19], v[140:143]
    ds_read_b128 v[36:39], v131 offset:18432
    v_mfma_f32_16x16x32_bf16 v[164:167], v[92:95], v[20:23], v[164:167]
    ds_read_b64_tr_b16 v[88:89], v124 offset:18432
    v_mfma_f32_16x16x32_bf16 v[144:147], v[96:99], v[16:19], v[144:147]
    ds_read_b64_tr_b16 v[90:91], v124 offset:18688
    s_add_u32 m0, s52, 56320
    s_mov_b32 s73, 384
    buffer_load_dwordx4 v121, s[8:11], s73 offen lds
    v_mfma_f32_16x16x32_bf16 v[168:171], v[96:99], v[20:23], v[168:171]
    ds_read_b64_tr_b16 v[92:93], v125 offset:18432
    v_mfma_f32_16x16x32_bf16 v[148:151], v[100:103], v[16:19], v[148:151]
    ds_read_b64_tr_b16 v[94:95], v125 offset:18688
    v_mfma_f32_16x16x32_bf16 v[172:175], v[100:103], v[20:23], v[172:175]
    ds_read_b64_tr_b16 v[96:97], v124 offset:20480
    s_waitcnt lgkmcnt(8)
    v_mfma_f32_16x16x32_bf16 v[152:155], v[16:19], v[104:107], v[152:155]
    ds_read_b64_tr_b16 v[98:99], v124 offset:20736
    v_mfma_f32_16x16x32_bf16 v[176:179], v[20:23], v[104:107], v[176:179]
    ds_read_b64_tr_b16 v[100:101], v125 offset:20480
    s_add_u32 m0, s52, 57344
    s_mov_b32 s73, 14720
    buffer_load_dwordx4 v120, s[8:11], s73 offen lds
    v_mfma_f32_16x16x32_bf16 v[156:159], v[16:19], v[108:111], v[156:159]
    ds_read_b64_tr_b16 v[102:103], v125 offset:20736
    v_mfma_f32_16x16x32_bf16 v[180:183], v[20:23], v[108:111], v[180:183]
    ds_read_b64_tr_b16 v[104:105], v124 offset:22528
    v_mfma_f32_16x16x32_bf16 v[184:187], v[112:115], v[24:27], v[184:187]
    ds_read_b64_tr_b16 v[106:107], v124 offset:22784
    v_mfma_f32_16x16x32_bf16 v[188:191], v[116:119], v[24:27], v[188:191]
    ds_read_b64_tr_b16 v[108:109], v125 offset:22528
    v_mfma_f32_16x16x32_bf16 v[48:51], v[16:19], v[16:19], v[48:51]
    ds_read_b64_tr_b16 v[110:111], v125 offset:22784
    s_add_u32 m0, s52, 58368
    s_mov_b32 s73, 14720
    buffer_load_dwordx4 v121, s[8:11], s73 offen lds
    v_mfma_f32_16x16x32_bf16 v[52:55], v[20:23], v[20:23], v[52:55]
    ds_read_b64_tr_b16 v[112:113], v126 offset:18432
    v_mfma_f32_16x16x32_bf16 v[56:59], v[24:27], v[24:27], v[56:59]
    ds_read_b64_tr_b16 v[114:115], v126 offset:18688
    v_mfma_f32_16x16x32_bf16 v[60:63], v[40:43], v[16:19], v[60:63]
    ds_read_b64_tr_b16 v[116:117], v127 offset:18432
    v_mfma_f32_16x16x32_bf16 v[64:67], v[40:43], v[20:23], v[64:67]
    ds_read_b64_tr_b16 v[118:119], v127 offset:18688
    v_mfma_f32_16x16x32_bf16 v[68:71], v[40:43], v[24:27], v[68:71]
    s_add_u32 m0, s7, 116736
    s_mov_b32 s73, 384
    s_mov_b64 exec, s[54:55]
    buffer_load_dwordx4 v122, s[8:11], s73 offen lds
    s_mov_b64 exec, -1
    s_waitcnt vmcnt(8)
    s_barrier
    s_waitcnt lgkmcnt(8)
    v_mfma_f32_16x16x32_bf16 v[136:139], v[88:91], v[28:31], v[136:139]
    ds_read_b128 v[16:19], v128 offset:0
    v_mfma_f32_16x16x32_bf16 v[160:163], v[88:91], v[32:35], v[160:163]
    ds_read_b128 v[20:23], v128 offset:2048
    v_mfma_f32_16x16x32_bf16 v[140:143], v[92:95], v[28:31], v[140:143]
    ds_read_b128 v[24:27], v130 offset:0
    v_mfma_f32_16x16x32_bf16 v[164:167], v[92:95], v[32:35], v[164:167]
    ds_read_b64_tr_b16 v[88:89], v124 offset:24576
    v_mfma_f32_16x16x32_bf16 v[144:147], v[96:99], v[28:31], v[144:147]
    ds_read_b64_tr_b16 v[90:91], v124 offset:24832
    s_add_u32 m0, s51, 12288
    s_mov_b32 s73, 688128
    buffer_load_dwordx4 v123, s[12:15], s73 offen lds
    v_mfma_f32_16x16x32_bf16 v[168:171], v[96:99], v[32:35], v[168:171]
    ds_read_b64_tr_b16 v[92:93], v125 offset:24576
    v_mfma_f32_16x16x32_bf16 v[148:151], v[100:103], v[28:31], v[148:151]
    ds_read_b64_tr_b16 v[94:95], v125 offset:24832
    v_mfma_f32_16x16x32_bf16 v[172:175], v[100:103], v[32:35], v[172:175]
    ds_read_b64_tr_b16 v[96:97], v124 offset:26624
    s_waitcnt lgkmcnt(8)
    v_mfma_f32_16x16x32_bf16 v[152:155], v[28:31], v[104:107], v[152:155]
    ds_read_b64_tr_b16 v[98:99], v124 offset:26880
    v_mfma_f32_16x16x32_bf16 v[176:179], v[32:35], v[104:107], v[176:179]
    ds_read_b64_tr_b16 v[100:101], v125 offset:26624
    s_add_u32 m0, s51, 14336
    s_mov_b32 s73, 689024
    buffer_load_dwordx4 v123, s[12:15], s73 offen lds
    v_mfma_f32_16x16x32_bf16 v[156:159], v[28:31], v[108:111], v[156:159]
    ds_read_b64_tr_b16 v[102:103], v125 offset:26880
    v_mfma_f32_16x16x32_bf16 v[180:183], v[32:35], v[108:111], v[180:183]
    ds_read_b64_tr_b16 v[104:105], v124 offset:28672
    v_mfma_f32_16x16x32_bf16 v[184:187], v[112:115], v[36:39], v[184:187]
    ds_read_b64_tr_b16 v[106:107], v124 offset:28928
    v_mfma_f32_16x16x32_bf16 v[188:191], v[116:119], v[36:39], v[188:191]
    ds_read_b64_tr_b16 v[108:109], v125 offset:28672
    v_mfma_f32_16x16x32_bf16 v[48:51], v[28:31], v[28:31], v[48:51]
    ds_read_b64_tr_b16 v[110:111], v125 offset:28928
    s_add_u32 m0, s51, 16384
    s_mov_b32 s73, 689920
    buffer_load_dwordx4 v123, s[12:15], s73 offen lds
    v_mfma_f32_16x16x32_bf16 v[52:55], v[32:35], v[32:35], v[52:55]
    ds_read_b64_tr_b16 v[112:113], v126 offset:24576
    v_mfma_f32_16x16x32_bf16 v[56:59], v[36:39], v[36:39], v[56:59]
    ds_read_b64_tr_b16 v[114:115], v126 offset:24832
    v_mfma_f32_16x16x32_bf16 v[60:63], v[40:43], v[28:31], v[60:63]
    ds_read_b64_tr_b16 v[116:117], v127 offset:24576
    v_mfma_f32_16x16x32_bf16 v[64:67], v[40:43], v[32:35], v[64:67]
    ds_read_b64_tr_b16 v[118:119], v127 offset:24832
    v_mfma_f32_16x16x32_bf16 v[68:71], v[40:43], v[36:39], v[68:71]
    s_add_u32 m0, s52, 36864
    s_mov_b32 s73, 512
    buffer_load_dwordx4 v120, s[8:11], s73 offen lds
    s_waitcnt lgkmcnt(8)
    v_mfma_f32_16x16x32_bf16 v[136:139], v[88:91], v[16:19], v[136:139]
    ds_read_b128 v[28:31], v129 offset:0
    v_mfma_f32_16x16x32_bf16 v[160:163], v[88:91], v[20:23], v[160:163]
    ds_read_b128 v[32:35], v129 offset:2048
    v_mfma_f32_16x16x32_bf16 v[140:143], v[92:95], v[16:19], v[140:143]
    ds_read_b128 v[36:39], v131 offset:0
    v_mfma_f32_16x16x32_bf16 v[164:167], v[92:95], v[20:23], v[164:167]
    ds_read_b64_tr_b16 v[88:89], v124 offset:30720
    v_mfma_f32_16x16x32_bf16 v[144:147], v[96:99], v[16:19], v[144:147]
    ds_read_b64_tr_b16 v[90:91], v124 offset:30976
    s_add_u32 m0, s52, 37888
    s_mov_b32 s73, 512
    buffer_load_dwordx4 v121, s[8:11], s73 offen lds
    v_mfma_f32_16x16x32_bf16 v[168:171], v[96:99], v[20:23], v[168:171]
    ds_read_b64_tr_b16 v[92:93], v125 offset:30720
    v_mfma_f32_16x16x32_bf16 v[148:151], v[100:103], v[16:19], v[148:151]
    ds_read_b64_tr_b16 v[94:95], v125 offset:30976
    v_mfma_f32_16x16x32_bf16 v[172:175], v[100:103], v[20:23], v[172:175]
    ds_read_b64_tr_b16 v[96:97], v124 offset:32768
    s_waitcnt lgkmcnt(8)
    v_mfma_f32_16x16x32_bf16 v[152:155], v[16:19], v[104:107], v[152:155]
    ds_read_b64_tr_b16 v[98:99], v124 offset:33024
    v_mfma_f32_16x16x32_bf16 v[176:179], v[20:23], v[104:107], v[176:179]
    ds_read_b64_tr_b16 v[100:101], v125 offset:32768
    s_add_u32 m0, s52, 38912
    s_mov_b32 s73, 14848
    buffer_load_dwordx4 v120, s[8:11], s73 offen lds
    v_mfma_f32_16x16x32_bf16 v[156:159], v[16:19], v[108:111], v[156:159]
    ds_read_b64_tr_b16 v[102:103], v125 offset:33024
    v_mfma_f32_16x16x32_bf16 v[180:183], v[20:23], v[108:111], v[180:183]
    ds_read_b64_tr_b16 v[104:105], v124 offset:34816
    v_mfma_f32_16x16x32_bf16 v[184:187], v[112:115], v[24:27], v[184:187]
    ds_read_b64_tr_b16 v[106:107], v124 offset:35072
    v_mfma_f32_16x16x32_bf16 v[188:191], v[116:119], v[24:27], v[188:191]
    ds_read_b64_tr_b16 v[108:109], v125 offset:34816
    v_mfma_f32_16x16x32_bf16 v[48:51], v[16:19], v[16:19], v[48:51]
    ds_read_b64_tr_b16 v[110:111], v125 offset:35072
    s_add_u32 m0, s52, 39936
    s_mov_b32 s73, 14848
    buffer_load_dwordx4 v121, s[8:11], s73 offen lds
    v_mfma_f32_16x16x32_bf16 v[52:55], v[20:23], v[20:23], v[52:55]
    ds_read_b64_tr_b16 v[112:113], v126 offset:30720
    v_mfma_f32_16x16x32_bf16 v[56:59], v[24:27], v[24:27], v[56:59]
    ds_read_b64_tr_b16 v[114:115], v126 offset:30976
    v_mfma_f32_16x16x32_bf16 v[60:63], v[40:43], v[16:19], v[60:63]
    ds_read_b64_tr_b16 v[116:117], v127 offset:30720
    v_mfma_f32_16x16x32_bf16 v[64:67], v[40:43], v[20:23], v[64:67]
    ds_read_b64_tr_b16 v[118:119], v127 offset:30976
    v_mfma_f32_16x16x32_bf16 v[68:71], v[40:43], v[24:27], v[68:71]
    s_add_u32 m0, s7, 98304
    s_mov_b32 s73, 512
    s_mov_b64 exec, s[54:55]
    buffer_load_dwordx4 v122, s[8:11], s73 offen lds
    s_mov_b64 exec, -1
    s_waitcnt vmcnt(8)
    s_barrier
    s_waitcnt lgkmcnt(8)
    v_mfma_f32_16x16x32_bf16 v[136:139], v[88:91], v[28:31], v[136:139]
    ds_read_b128 v[16:19], v128 offset:55296
    v_mfma_f32_16x16x32_bf16 v[160:163], v[88:91], v[32:35], v[160:163]
    ds_read_b128 v[20:23], v128 offset:57344
    v_mfma_f32_16x16x32_bf16 v[140:143], v[92:95], v[28:31], v[140:143]
    ds_read_b128 v[24:27], v130 offset:55296
    v_mfma_f32_16x16x32_bf16 v[164:167], v[92:95], v[32:35], v[164:167]
    ds_read_b64_tr_b16 v[88:89], v124 offset:36864
    v_mfma_f32_16x16x32_bf16 v[144:147], v[96:99], v[28:31], v[144:147]
    ds_read_b64_tr_b16 v[90:91], v124 offset:37120
    s_add_u32 m0, s51, 24576
    s_mov_b32 s73, 860160
    buffer_load_dwordx4 v123, s[12:15], s73 offen lds
    v_mfma_f32_16x16x32_bf16 v[168:171], v[96:99], v[32:35], v[168:171]
    ds_read_b64_tr_b16 v[92:93], v125 offset:36864
    v_mfma_f32_16x16x32_bf16 v[148:151], v[100:103], v[28:31], v[148:151]
    ds_read_b64_tr_b16 v[94:95], v125 offset:37120
    v_mfma_f32_16x16x32_bf16 v[172:175], v[100:103], v[32:35], v[172:175]
    ds_read_b64_tr_b16 v[96:97], v124 offset:38912
    s_waitcnt lgkmcnt(8)
    v_mfma_f32_16x16x32_bf16 v[152:155], v[28:31], v[104:107], v[152:155]
    ds_read_b64_tr_b16 v[98:99], v124 offset:39168
    v_mfma_f32_16x16x32_bf16 v[176:179], v[32:35], v[104:107], v[176:179]
    ds_read_b64_tr_b16 v[100:101], v125 offset:38912
    s_add_u32 m0, s51, 26624
    s_mov_b32 s73, 861056
    buffer_load_dwordx4 v123, s[12:15], s73 offen lds
    v_mfma_f32_16x16x32_bf16 v[156:159], v[28:31], v[108:111], v[156:159]
    ds_read_b64_tr_b16 v[102:103], v125 offset:39168
    v_mfma_f32_16x16x32_bf16 v[180:183], v[32:35], v[108:111], v[180:183]
    ds_read_b64_tr_b16 v[104:105], v124 offset:40960
    v_mfma_f32_16x16x32_bf16 v[184:187], v[112:115], v[36:39], v[184:187]
    ds_read_b64_tr_b16 v[106:107], v124 offset:41216
    v_mfma_f32_16x16x32_bf16 v[188:191], v[116:119], v[36:39], v[188:191]
    ds_read_b64_tr_b16 v[108:109], v125 offset:40960
    v_mfma_f32_16x16x32_bf16 v[48:51], v[28:31], v[28:31], v[48:51]
    ds_read_b64_tr_b16 v[110:111], v125 offset:41216
    s_add_u32 m0, s51, 28672
    s_mov_b32 s73, 861952
    buffer_load_dwordx4 v123, s[12:15], s73 offen lds
    v_mfma_f32_16x16x32_bf16 v[52:55], v[32:35], v[32:35], v[52:55]
    ds_read_b64_tr_b16 v[112:113], v126 offset:36864
    v_mfma_f32_16x16x32_bf16 v[56:59], v[36:39], v[36:39], v[56:59]
    ds_read_b64_tr_b16 v[114:115], v126 offset:37120
    v_mfma_f32_16x16x32_bf16 v[60:63], v[40:43], v[28:31], v[60:63]
    ds_read_b64_tr_b16 v[116:117], v127 offset:36864
    v_mfma_f32_16x16x32_bf16 v[64:67], v[40:43], v[32:35], v[64:67]
    ds_read_b64_tr_b16 v[118:119], v127 offset:37120
    v_mfma_f32_16x16x32_bf16 v[68:71], v[40:43], v[36:39], v[68:71]
    s_add_u32 m0, s52, 18432
    s_mov_b32 s73, 640
    buffer_load_dwordx4 v120, s[8:11], s73 offen lds
    s_waitcnt lgkmcnt(8)
    v_mfma_f32_16x16x32_bf16 v[136:139], v[88:91], v[16:19], v[136:139]
    ds_read_b128 v[28:31], v129 offset:55296
    v_mfma_f32_16x16x32_bf16 v[160:163], v[88:91], v[20:23], v[160:163]
    ds_read_b128 v[32:35], v129 offset:57344
    v_mfma_f32_16x16x32_bf16 v[140:143], v[92:95], v[16:19], v[140:143]
    ds_read_b128 v[36:39], v131 offset:55296
    v_mfma_f32_16x16x32_bf16 v[164:167], v[92:95], v[20:23], v[164:167]
    ds_read_b64_tr_b16 v[88:89], v124 offset:43008
    v_mfma_f32_16x16x32_bf16 v[144:147], v[96:99], v[16:19], v[144:147]
    ds_read_b64_tr_b16 v[90:91], v124 offset:43264
    s_add_u32 m0, s52, 19456
    s_mov_b32 s73, 640
    buffer_load_dwordx4 v121, s[8:11], s73 offen lds
    v_mfma_f32_16x16x32_bf16 v[168:171], v[96:99], v[20:23], v[168:171]
    ds_read_b64_tr_b16 v[92:93], v125 offset:43008
    v_mfma_f32_16x16x32_bf16 v[148:151], v[100:103], v[16:19], v[148:151]
    ds_read_b64_tr_b16 v[94:95], v125 offset:43264
    v_mfma_f32_16x16x32_bf16 v[172:175], v[100:103], v[20:23], v[172:175]
    ds_read_b64_tr_b16 v[96:97], v124 offset:45056
    s_waitcnt lgkmcnt(8)
    v_mfma_f32_16x16x32_bf16 v[152:155], v[16:19], v[104:107], v[152:155]
    ds_read_b64_tr_b16 v[98:99], v124 offset:45312
    v_mfma_f32_16x16x32_bf16 v[176:179], v[20:23], v[104:107], v[176:179]
    ds_read_b64_tr_b16 v[100:101], v125 offset:45056
    s_add_u32 m0, s52, 20480
    s_mov_b32 s73, 14976
    buffer_load_dwordx4 v120, s[8:11], s73 offen lds
    v_mfma_f32_16x16x32_bf16 v[156:159], v[16:19], v[108:111], v[156:159]
    ds_read_b64_tr_b16 v[102:103], v125 offset:45312
    v_mfma_f32_16x16x32_bf16 v[180:183], v[20:23], v[108:111], v[180:183]
    ds_read_b64_tr_b16 v[104:105], v124 offset:47104
    v_mfma_f32_16x16x32_bf16 v[184:187], v[112:115], v[24:27], v[184:187]
    ds_read_b64_tr_b16 v[106:107], v124 offset:47360
    v_mfma_f32_16x16x32_bf16 v[188:191], v[116:119], v[24:27], v[188:191]
    ds_read_b64_tr_b16 v[108:109], v125 offset:47104
    v_mfma_f32_16x16x32_bf16 v[48:51], v[16:19], v[16:19], v[48:51]
    ds_read_b64_tr_b16 v[110:111], v125 offset:47360
    s_add_u32 m0, s52, 21504
    s_mov_b32 s73, 14976
    buffer_load_dwordx4 v121, s[8:11], s73 offen lds
    v_mfma_f32_16x16x32_bf16 v[52:55], v[20:23], v[20:23], v[52:55]
    ds_read_b64_tr_b16 v[112:113], v126 offset:43008
    v_mfma_f32_16x16x32_bf16 v[56:59], v[24:27], v[24:27], v[56:59]
    ds_read_b64_tr_b16 v[114:115], v126 offset:43264
    v_mfma_f32_16x16x32_bf16 v[60:63], v[40:43], v[16:19], v[60:63]
    ds_read_b64_tr_b16 v[116:117], v127 offset:43008
    v_mfma_f32_16x16x32_bf16 v[64:67], v[40:43], v[20:23], v[64:67]
    ds_read_b64_tr_b16 v[118:119], v127 offset:43264
    v_mfma_f32_16x16x32_bf16 v[68:71], v[40:43], v[24:27], v[68:71]
    s_add_u32 m0, s7, 79872
    s_mov_b32 s73, 640
    s_mov_b64 exec, s[54:55]
    buffer_load_dwordx4 v122, s[8:11], s73 offen lds
    s_mov_b64 exec, -1
    s_waitcnt vmcnt(8)
    s_barrier
    s_waitcnt lgkmcnt(8)
    v_mfma_f32_16x16x32_bf16 v[136:139], v[88:91], v[28:31], v[136:139]
    ds_read_b128 v[16:19], v128 offset:36864
    v_mfma_f32_16x16x32_bf16 v[160:163], v[88:91], v[32:35], v[160:163]
    ds_read_b128 v[20:23], v128 offset:38912
    v_mfma_f32_16x16x32_bf16 v[140:143], v[92:95], v[28:31], v[140:143]
    ds_read_b128 v[24:27], v130 offset:36864
    v_mfma_f32_16x16x32_bf16 v[164:167], v[92:95], v[32:35], v[164:167]
    ds_read_b64_tr_b16 v[88:89], v124 offset:0
    v_mfma_f32_16x16x32_bf16 v[144:147], v[96:99], v[28:31], v[144:147]
    ds_read_b64_tr_b16 v[90:91], v124 offset:256
    s_add_u32 m0, s51, 36864
    s_mov_b32 s73, 1032192
    buffer_load_dwordx4 v123, s[12:15], s73 offen lds
    v_mfma_f32_16x16x32_bf16 v[168:171], v[96:99], v[32:35], v[168:171]
    ds_read_b64_tr_b16 v[92:93], v125 offset:0
    v_mfma_f32_16x16x32_bf16 v[148:151], v[100:103], v[28:31], v[148:151]
    ds_read_b64_tr_b16 v[94:95], v125 offset:256
    v_mfma_f32_16x16x32_bf16 v[172:175], v[100:103], v[32:35], v[172:175]
    ds_read_b64_tr_b16 v[96:97], v124 offset:2048
    s_waitcnt lgkmcnt(8)
    v_mfma_f32_16x16x32_bf16 v[152:155], v[28:31], v[104:107], v[152:155]
    ds_read_b64_tr_b16 v[98:99], v124 offset:2304
    v_mfma_f32_16x16x32_bf16 v[176:179], v[32:35], v[104:107], v[176:179]
    ds_read_b64_tr_b16 v[100:101], v125 offset:2048
    s_add_u32 m0, s51, 38912
    s_mov_b32 s73, 1033088
    buffer_load_dwordx4 v123, s[12:15], s73 offen lds
    v_mfma_f32_16x16x32_bf16 v[156:159], v[28:31], v[108:111], v[156:159]
    ds_read_b64_tr_b16 v[102:103], v125 offset:2304
    v_mfma_f32_16x16x32_bf16 v[180:183], v[32:35], v[108:111], v[180:183]
    ds_read_b64_tr_b16 v[104:105], v124 offset:4096
    v_mfma_f32_16x16x32_bf16 v[184:187], v[112:115], v[36:39], v[184:187]
    ds_read_b64_tr_b16 v[106:107], v124 offset:4352
    v_mfma_f32_16x16x32_bf16 v[188:191], v[116:119], v[36:39], v[188:191]
    ds_read_b64_tr_b16 v[108:109], v125 offset:4096
    v_mfma_f32_16x16x32_bf16 v[48:51], v[28:31], v[28:31], v[48:51]
    ds_read_b64_tr_b16 v[110:111], v125 offset:4352
    s_add_u32 m0, s51, 40960
    s_mov_b32 s73, 1033984
    buffer_load_dwordx4 v123, s[12:15], s73 offen lds
    v_mfma_f32_16x16x32_bf16 v[52:55], v[32:35], v[32:35], v[52:55]
    ds_read_b64_tr_b16 v[112:113], v126 offset:0
    v_mfma_f32_16x16x32_bf16 v[56:59], v[36:39], v[36:39], v[56:59]
    ds_read_b64_tr_b16 v[114:115], v126 offset:256
    v_mfma_f32_16x16x32_bf16 v[60:63], v[40:43], v[28:31], v[60:63]
    ds_read_b64_tr_b16 v[116:117], v127 offset:0
    v_mfma_f32_16x16x32_bf16 v[64:67], v[40:43], v[32:35], v[64:67]
    ds_read_b64_tr_b16 v[118:119], v127 offset:256
    v_mfma_f32_16x16x32_bf16 v[68:71], v[40:43], v[36:39], v[68:71]
    s_add_u32 m0, s52, 0
    s_mov_b32 s73, 768
    buffer_load_dwordx4 v120, s[8:11], s73 offen lds
    s_waitcnt lgkmcnt(8)
    v_mfma_f32_16x16x32_bf16 v[136:139], v[88:91], v[16:19], v[136:139]
    ds_read_b128 v[28:31], v129 offset:36864
    v_mfma_f32_16x16x32_bf16 v[160:163], v[88:91], v[20:23], v[160:163]
    ds_read_b128 v[32:35], v129 offset:38912
    v_mfma_f32_16x16x32_bf16 v[140:143], v[92:95], v[16:19], v[140:143]
    ds_read_b128 v[36:39], v131 offset:36864
    v_mfma_f32_16x16x32_bf16 v[164:167], v[92:95], v[20:23], v[164:167]
    ds_read_b64_tr_b16 v[88:89], v124 offset:6144
    v_mfma_f32_16x16x32_bf16 v[144:147], v[96:99], v[16:19], v[144:147]
    ds_read_b64_tr_b16 v[90:91], v124 offset:6400
    s_add_u32 m0, s52, 1024
    s_mov_b32 s73, 768
    buffer_load_dwordx4 v121, s[8:11], s73 offen lds
    v_mfma_f32_16x16x32_bf16 v[168:171], v[96:99], v[20:23], v[168:171]
    ds_read_b64_tr_b16 v[92:93], v125 offset:6144
    v_mfma_f32_16x16x32_bf16 v[148:151], v[100:103], v[16:19], v[148:151]
    ds_read_b64_tr_b16 v[94:95], v125 offset:6400
    v_mfma_f32_16x16x32_bf16 v[172:175], v[100:103], v[20:23], v[172:175]
    ds_read_b64_tr_b16 v[96:97], v124 offset:8192
    s_waitcnt lgkmcnt(8)
    v_mfma_f32_16x16x32_bf16 v[152:155], v[16:19], v[104:107], v[152:155]
    ds_read_b64_tr_b16 v[98:99], v124 offset:8448
    v_mfma_f32_16x16x32_bf16 v[176:179], v[20:23], v[104:107], v[176:179]
    ds_read_b64_tr_b16 v[100:101], v125 offset:8192
    s_add_u32 m0, s52, 2048
    s_mov_b32 s73, 15104
    buffer_load_dwordx4 v120, s[8:11], s73 offen lds
    v_mfma_f32_16x16x32_bf16 v[156:159], v[16:19], v[108:111], v[156:159]
    ds_read_b64_tr_b16 v[102:103], v125 offset:8448
    v_mfma_f32_16x16x32_bf16 v[180:183], v[20:23], v[108:111], v[180:183]
    ds_read_b64_tr_b16 v[104:105], v124 offset:10240
    v_mfma_f32_16x16x32_bf16 v[184:187], v[112:115], v[24:27], v[184:187]
    ds_read_b64_tr_b16 v[106:107], v124 offset:10496
    v_mfma_f32_16x16x32_bf16 v[188:191], v[116:119], v[24:27], v[188:191]
    ds_read_b64_tr_b16 v[108:109], v125 offset:10240
    v_mfma_f32_16x16x32_bf16 v[48:51], v[16:19], v[16:19], v[48:51]
    ds_read_b64_tr_b16 v[110:111], v125 offset:10496
    s_add_u32 m0, s52, 3072
    s_mov_b32 s73, 15104
    buffer_load_dwordx4 v121, s[8:11], s73 offen lds
    v_mfma_f32_16x16x32_bf16 v[52:55], v[20:23], v[20:23], v[52:55]
    ds_read_b64_tr_b16 v[112:113], v126 offset:6144
    v_mfma_f32_16x16x32_bf16 v[56:59], v[24:27], v[24:27], v[56:59]
    ds_read_b64_tr_b16 v[114:115], v126 offset:6400
    v_mfma_f32_16x16x32_bf16 v[60:63], v[40:43], v[16:19], v[60:63]
    ds_read_b64_tr_b16 v[116:117], v127 offset:6144
    v_mfma_f32_16x16x32_bf16 v[64:67], v[40:43], v[20:23], v[64:67]
    ds_read_b64_tr_b16 v[118:119], v127 offset:6400
    v_mfma_f32_16x16x32_bf16 v[68:71], v[40:43], v[24:27], v[68:71]
    s_add_u32 m0, s7, 61440
    s_mov_b32 s73, 768
    s_mov_b64 exec, s[54:55]
    buffer_load_dwordx4 v122, s[8:11], s73 offen lds
    s_mov_b64 exec, -1
    v_mov_b32 v7, 0
    buffer_load_dword v6, v7, s[44:47], 0 offen sc1
    s_lshr_b32 s68, s2, 3
    s_lshl_b32 s68, s68, 2
    s_add_u32 s68, s68, s3
    v_lshlrev_b32 v219, 7, v1
    s_mul_i32 s86, s68, 3200
    s_mov_b64 exec, 0x1ffffff
    buffer_load_dword v234, v219, s[16:19], s86 offen
    s_mov_b64 exec, -1
    v_lshrrev_b32 v219, 2, v1
    v_mul_u32_u24 v219, 3584, v219
    v_and_b32 v220, 3, v1
    v_lshl_add_u32 v219, v220, 7, v219
    s_mul_i32 s68, s68, 57344
    s_and_b32 s69, s2, 7
    s_mul_i32 s86, s69, 3
    s_add_u32 s86, s86, 4
    s_lshl_b32 s87, s69, 2
    s_min_u32 s86, s86, s87
    s_lshl_b32 s86, s86, 7
    s_add_u32 s86, s86, s68
    s_cmp_lt_u32 s69, 4
    s_cselect_b32 exec_lo, -1, 0x77777777
    s_cselect_b32 exec_hi, -1, 0x77777777
    buffer_load_dword v235, v219, s[20:23], s86 offen
    s_mov_b64 exec, -1
    s_waitcnt vmcnt(11)
    s_barrier
    s_waitcnt lgkmcnt(8)
    v_mfma_f32_16x16x32_bf16 v[136:139], v[88:91], v[28:31], v[136:139]
    ds_read_b128 v[16:19], v128 offset:18432
    v_mfma_f32_16x16x32_bf16 v[160:163], v[88:91], v[32:35], v[160:163]
    ds_read_b128 v[20:23], v128 offset:20480
    v_mfma_f32_16x16x32_bf16 v[140:143], v[92:95], v[28:31], v[140:143]
    ds_read_b128 v[24:27], v130 offset:18432
    v_mfma_f32_16x16x32_bf16 v[164:167], v[92:95], v[32:35], v[164:167]
    ds_read_b64_tr_b16 v[88:89], v124 offset:12288
    v_mfma_f32_16x16x32_bf16 v[144:147], v[96:99], v[28:31], v[144:147]
    ds_read_b64_tr_b16 v[90:91], v124 offset:12544
    v_mfma_f32_16x16x32_bf16 v[168:171], v[96:99], v[32:35], v[168:171]
    ds_read_b64_tr_b16 v[92:93], v125 offset:12288
    v_mfma_f32_16x16x32_bf16 v[148:151], v[100:103], v[28:31], v[148:151]
    ds_read_b64_tr_b16 v[94:95], v125 offset:12544
    v_mfma_f32_16x16x32_bf16 v[172:175], v[100:103], v[32:35], v[172:175]
    ds_read_b64_tr_b16 v[96:97], v124 offset:14336
    s_waitcnt lgkmcnt(8)
    v_mfma_f32_16x16x32_bf16 v[152:155], v[28:31], v[104:107], v[152:155]
    ds_read_b64_tr_b16 v[98:99], v124 offset:14592
    v_mfma_f32_16x16x32_bf16 v[176:179], v[32:35], v[104:107], v[176:179]
    ds_read_b64_tr_b16 v[100:101], v125 offset:14336
    v_mfma_f32_16x16x32_bf16 v[156:159], v[28:31], v[108:111], v[156:159]
    ds_read_b64_tr_b16 v[102:103], v125 offset:14592
    v_mfma_f32_16x16x32_bf16 v[180:183], v[32:35], v[108:111], v[180:183]
    ds_read_b64_tr_b16 v[104:105], v124 offset:16384
    v_mfma_f32_16x16x32_bf16 v[184:187], v[112:115], v[36:39], v[184:187]
    ds_read_b64_tr_b16 v[106:107], v124 offset:16640
    v_mfma_f32_16x16x32_bf16 v[188:191], v[116:119], v[36:39], v[188:191]
    ds_read_b64_tr_b16 v[108:109], v125 offset:16384
    v_mfma_f32_16x16x32_bf16 v[48:51], v[28:31], v[28:31], v[48:51]
    ds_read_b64_tr_b16 v[110:111], v125 offset:16640
    v_mfma_f32_16x16x32_bf16 v[52:55], v[32:35], v[32:35], v[52:55]
    ds_read_b64_tr_b16 v[112:113], v126 offset:12288
    v_mfma_f32_16x16x32_bf16 v[56:59], v[36:39], v[36:39], v[56:59]
    ds_read_b64_tr_b16 v[114:115], v126 offset:12544
    v_mfma_f32_16x16x32_bf16 v[60:63], v[40:43], v[28:31], v[60:63]
    ds_read_b64_tr_b16 v[116:117], v127 offset:12288
    v_mfma_f32_16x16x32_bf16 v[64:67], v[40:43], v[32:35], v[64:67]
    ds_read_b64_tr_b16 v[118:119], v127 offset:12544
    v_mfma_f32_16x16x32_bf16 v[68:71], v[40:43], v[36:39], v[68:71]
    s_waitcnt lgkmcnt(8)
    v_mfma_f32_16x16x32_bf16 v[136:139], v[88:91], v[16:19], v[136:139]
    ds_read_b128 v[28:31], v129 offset:18432
    v_mfma_f32_16x16x32_bf16 v[160:163], v[88:91], v[20:23], v[160:163]
    ds_read_b128 v[32:35], v129 offset:20480
    v_mfma_f32_16x16x32_bf16 v[140:143], v[92:95], v[16:19], v[140:143]
    ds_read_b128 v[36:39], v131 offset:18432
    v_mfma_f32_16x16x32_bf16 v[164:167], v[92:95], v[20:23], v[164:167]
    ds_read_b64_tr_b16 v[88:89], v124 offset:18432
    v_mfma_f32_16x16x32_bf16 v[144:147], v[96:99], v[16:19], v[144:147]
    ds_read_b64_tr_b16 v[90:91], v124 offset:18688
    v_mfma_f32_16x16x32_bf16 v[168:171], v[96:99], v[20:23], v[168:171]
    ds_read_b64_tr_b16 v[92:93], v125 offset:18432
    v_mfma_f32_16x16x32_bf16 v[148:151], v[100:103], v[16:19], v[148:151]
    ds_read_b64_tr_b16 v[94:95], v125 offset:18688
    v_mfma_f32_16x16x32_bf16 v[172:175], v[100:103], v[20:23], v[172:175]
    ds_read_b64_tr_b16 v[96:97], v124 offset:20480
    s_waitcnt lgkmcnt(8)
    v_mfma_f32_16x16x32_bf16 v[152:155], v[16:19], v[104:107], v[152:155]
    ds_read_b64_tr_b16 v[98:99], v124 offset:20736
    v_mfma_f32_16x16x32_bf16 v[176:179], v[20:23], v[104:107], v[176:179]
    ds_read_b64_tr_b16 v[100:101], v125 offset:20480
    v_mfma_f32_16x16x32_bf16 v[156:159], v[16:19], v[108:111], v[156:159]
    ds_read_b64_tr_b16 v[102:103], v125 offset:20736
    v_mfma_f32_16x16x32_bf16 v[180:183], v[20:23], v[108:111], v[180:183]
    ds_read_b64_tr_b16 v[104:105], v124 offset:22528
    v_mfma_f32_16x16x32_bf16 v[184:187], v[112:115], v[24:27], v[184:187]
    ds_read_b64_tr_b16 v[106:107], v124 offset:22784
    v_mfma_f32_16x16x32_bf16 v[188:191], v[116:119], v[24:27], v[188:191]
    ds_read_b64_tr_b16 v[108:109], v125 offset:22528
    v_mfma_f32_16x16x32_bf16 v[48:51], v[16:19], v[16:19], v[48:51]
    ds_read_b64_tr_b16 v[110:111], v125 offset:22784
    v_mfma_f32_16x16x32_bf16 v[52:55], v[20:23], v[20:23], v[52:55]
    ds_read_b64_tr_b16 v[112:113], v126 offset:18432
    v_mfma_f32_16x16x32_bf16 v[56:59], v[24:27], v[24:27], v[56:59]
    ds_read_b64_tr_b16 v[114:115], v126 offset:18688
    v_mfma_f32_16x16x32_bf16 v[60:63], v[40:43], v[16:19], v[60:63]
    ds_read_b64_tr_b16 v[116:117], v127 offset:18432
    v_mfma_f32_16x16x32_bf16 v[64:67], v[40:43], v[20:23], v[64:67]
    ds_read_b64_tr_b16 v[118:119], v127 offset:18688
    v_mfma_f32_16x16x32_bf16 v[68:71], v[40:43], v[24:27], v[68:71]
    s_waitcnt vmcnt(3)
    s_barrier
    s_waitcnt lgkmcnt(8)
    v_mfma_f32_16x16x32_bf16 v[136:139], v[88:91], v[28:31], v[136:139]
    ds_read_b128 v[16:19], v128 offset:0
    v_mfma_f32_16x16x32_bf16 v[160:163], v[88:91], v[32:35], v[160:163]
    ds_read_b128 v[20:23], v128 offset:2048
    v_mfma_f32_16x16x32_bf16 v[140:143], v[92:95], v[28:31], v[140:143]
    ds_read_b128 v[24:27], v130 offset:0
    v_mfma_f32_16x16x32_bf16 v[164:167], v[92:95], v[32:35], v[164:167]
    ds_read_b64_tr_b16 v[88:89], v124 offset:24576
    v_mfma_f32_16x16x32_bf16 v[144:147], v[96:99], v[28:31], v[144:147]
    ds_read_b64_tr_b16 v[90:91], v124 offset:24832
    v_mfma_f32_16x16x32_bf16 v[168:171], v[96:99], v[32:35], v[168:171]
    ds_read_b64_tr_b16 v[92:93], v125 offset:24576
    v_mfma_f32_16x16x32_bf16 v[148:151], v[100:103], v[28:31], v[148:151]
    ds_read_b64_tr_b16 v[94:95], v125 offset:24832
    v_mfma_f32_16x16x32_bf16 v[172:175], v[100:103], v[32:35], v[172:175]
    ds_read_b64_tr_b16 v[96:97], v124 offset:26624
    s_waitcnt lgkmcnt(8)
    v_mfma_f32_16x16x32_bf16 v[152:155], v[28:31], v[104:107], v[152:155]
    ds_read_b64_tr_b16 v[98:99], v124 offset:26880
    v_mfma_f32_16x16x32_bf16 v[176:179], v[32:35], v[104:107], v[176:179]
    ds_read_b64_tr_b16 v[100:101], v125 offset:26624
    v_mfma_f32_16x16x32_bf16 v[156:159], v[28:31], v[108:111], v[156:159]
    ds_read_b64_tr_b16 v[102:103], v125 offset:26880
    v_mfma_f32_16x16x32_bf16 v[180:183], v[32:35], v[108:111], v[180:183]
    ds_read_b64_tr_b16 v[104:105], v124 offset:28672
    v_mfma_f32_16x16x32_bf16 v[184:187], v[112:115], v[36:39], v[184:187]
    ds_read_b64_tr_b16 v[106:107], v124 offset:28928
    v_mfma_f32_16x16x32_bf16 v[188:191], v[116:119], v[36:39], v[188:191]
    ds_read_b64_tr_b16 v[108:109], v125 offset:28672
    v_mfma_f32_16x16x32_bf16 v[48:51], v[28:31], v[28:31], v[48:51]
    ds_read_b64_tr_b16 v[110:111], v125 offset:28928
    v_mfma_f32_16x16x32_bf16 v[52:55], v[32:35], v[32:35], v[52:55]
    ds_read_b64_tr_b16 v[112:113], v126 offset:24576
    v_mfma_f32_16x16x32_bf16 v[56:59], v[36:39], v[36:39], v[56:59]
    ds_read_b64_tr_b16 v[114:115], v126 offset:24832
    v_mfma_f32_16x16x32_bf16 v[60:63], v[40:43], v[28:31], v[60:63]
    ds_read_b64_tr_b16 v[116:117], v127 offset:24576
    v_mfma_f32_16x16x32_bf16 v[64:67], v[40:43], v[32:35], v[64:67]
    ds_read_b64_tr_b16 v[118:119], v127 offset:24832
    v_mfma_f32_16x16x32_bf16 v[68:71], v[40:43], v[36:39], v[68:71]
    s_waitcnt lgkmcnt(8)
    v_mfma_f32_16x16x32_bf16 v[136:139], v[88:91], v[16:19], v[136:139]
    ds_read_b128 v[28:31], v129 offset:0
    v_mfma_f32_16x16x32_bf16 v[160:163], v[88:91], v[20:23], v[160:163]
    ds_read_b128 v[32:35], v129 offset:2048
    v_mfma_f32_16x16x32_bf16 v[140:143], v[92:95], v[16:19], v[140:143]
    ds_read_b128 v[36:39], v131 offset:0
    v_mfma_f32_16x16x32_bf16 v[164:167], v[92:95], v[20:23], v[164:167]
    ds_read_b64_tr_b16 v[88:89], v124 offset:30720
    v_mfma_f32_16x16x32_bf16 v[144:147], v[96:99], v[16:19], v[144:147]
    ds_read_b64_tr_b16 v[90:91], v124 offset:30976
    v_mfma_f32_16x16x32_bf16 v[168:171], v[96:99], v[20:23], v[168:171]
    ds_read_b64_tr_b16 v[92:93], v125 offset:30720
    v_mfma_f32_16x16x32_bf16 v[148:151], v[100:103], v[16:19], v[148:151]
    ds_read_b64_tr_b16 v[94:95], v125 offset:30976
    v_mfma_f32_16x16x32_bf16 v[172:175], v[100:103], v[20:23], v[172:175]
    ds_read_b64_tr_b16 v[96:97], v124 offset:32768
    s_waitcnt lgkmcnt(8)
    v_mfma_f32_16x16x32_bf16 v[152:155], v[16:19], v[104:107], v[152:155]
    ds_read_b64_tr_b16 v[98:99], v124 offset:33024
    v_mfma_f32_16x16x32_bf16 v[176:179], v[20:23], v[104:107], v[176:179]
    ds_read_b64_tr_b16 v[100:101], v125 offset:32768
    v_mfma_f32_16x16x32_bf16 v[156:159], v[16:19], v[108:111], v[156:159]
    ds_read_b64_tr_b16 v[102:103], v125 offset:33024
    v_mfma_f32_16x16x32_bf16 v[180:183], v[20:23], v[108:111], v[180:183]
    ds_read_b64_tr_b16 v[104:105], v124 offset:34816
    v_mfma_f32_16x16x32_bf16 v[184:187], v[112:115], v[24:27], v[184:187]
    ds_read_b64_tr_b16 v[106:107], v124 offset:35072
    v_mfma_f32_16x16x32_bf16 v[188:191], v[116:119], v[24:27], v[188:191]
    ds_read_b64_tr_b16 v[108:109], v125 offset:34816
    v_mfma_f32_16x16x32_bf16 v[48:51], v[16:19], v[16:19], v[48:51]
    ds_read_b64_tr_b16 v[110:111], v125 offset:35072
    v_mfma_f32_16x16x32_bf16 v[52:55], v[20:23], v[20:23], v[52:55]
    ds_read_b64_tr_b16 v[112:113], v126 offset:30720
    v_mfma_f32_16x16x32_bf16 v[56:59], v[24:27], v[24:27], v[56:59]
    ds_read_b64_tr_b16 v[114:115], v126 offset:30976
    v_mfma_f32_16x16x32_bf16 v[60:63], v[40:43], v[16:19], v[60:63]
    ds_read_b64_tr_b16 v[116:117], v127 offset:30720
    v_mfma_f32_16x16x32_bf16 v[64:67], v[40:43], v[20:23], v[64:67]
    ds_read_b64_tr_b16 v[118:119], v127 offset:30976
    v_mfma_f32_16x16x32_bf16 v[68:71], v[40:43], v[24:27], v[68:71]
    s_waitcnt lgkmcnt(9)
    v_mfma_f32_16x16x32_bf16 v[48:51], v[28:31], v[28:31], v[48:51]
    v_mfma_f32_16x16x32_bf16 v[52:55], v[32:35], v[32:35], v[52:55]
    v_mfma_f32_16x16x32_bf16 v[56:59], v[36:39], v[36:39], v[56:59]
    v_mfma_f32_16x16x32_bf16 v[60:63], v[40:43], v[28:31], v[60:63]
    v_mfma_f32_16x16x32_bf16 v[64:67], v[40:43], v[32:35], v[64:67]
    v_mfma_f32_16x16x32_bf16 v[68:71], v[40:43], v[36:39], v[68:71]
    s_waitcnt lgkmcnt(2)
    v_mfma_f32_16x16x32_bf16 v[184:187], v[112:115], v[36:39], v[184:187]
    s_waitcnt lgkmcnt(0)
    v_mfma_f32_16x16x32_bf16 v[188:191], v[116:119], v[36:39], v[188:191]
    v_mfma_f32_16x16x32_bf16 v[144:147], v[96:99], v[28:31], v[144:147]
    v_cndmask_b32 v48, v48, v49, s[88:89]
    v_cndmask_b32 v52, v52, v53, s[88:89]
    v_cndmask_b32 v56, v56, v57, s[88:89]
    v_mfma_f32_16x16x32_bf16 v[168:171], v[96:99], v[32:35], v[168:171]
    v_cndmask_b32 v48, v48, v50, s[90:91]
    v_cndmask_b32 v52, v52, v54, s[90:91]
    v_cndmask_b32 v56, v56, v58, s[90:91]
    v_mfma_f32_16x16x32_bf16 v[148:151], v[100:103], v[28:31], v[148:151]
    v_cndmask_b32 v48, v48, v51, s[92:93]
    v_cndmask_b32 v52, v52, v55, s[92:93]
    v_cndmask_b32 v56, v56, v59, s[92:93]
    v_mfma_f32_16x16x32_bf16 v[172:175], v[100:103], v[32:35], v[172:175]
    v_mul_f32 v133, 0x3b124925, v60
    v_mul_f32 v135, 0x3b124925, v64
    v_mul_f32 v85, 0x3b124925, v68
    v_mfma_f32_16x16x32_bf16 v[152:155], v[28:31], v[104:107], v[152:155]
    v_mul_f32 v132, v133, v133
    v_mul_f32 v134, v135, v135
    v_mul_f32 v84, v85, v85
    v_mfma_f32_16x16x32_bf16 v[176:179], v[32:35], v[104:107], v[176:179]
    v_mul_f32 v48, 0x3b124925, v48
    v_mul_f32 v52, 0x3b124925, v52
    v_mul_f32 v56, 0x3b124925, v56
    v_mfma_f32_16x16x32_bf16 v[156:159], v[28:31], v[108:111], v[156:159]
    s_mov_b32 exec_lo, 0x00010001
    s_mov_b32 exec_hi, 0x00010001
    ds_write_b128 v73, v[184:187] offset:128
    ds_write_b128 v74, v[188:191] offset:0
    s_mov_b64 exec, -1
    v_sub_f32 v132, v48, v132
    v_sub_f32 v134, v52, v134
    v_mfma_f32_16x16x32_bf16 v[180:183], v[32:35], v[108:111], v[180:183]
    v_sub_f32 v84, v56, v84
    v_max_f32 v132, 0, v132
    v_max_f32 v134, 0, v134
    v_mfma_f32_16x16x32_bf16 v[136:139], v[88:91], v[28:31], v[136:139]
    v_max_f32 v84, 0, v84
    v_add_f32 v132, 0x3727c5ac, v132
    v_add_f32 v134, 0x3727c5ac, v134
    v_mfma_f32_16x16x32_bf16 v[160:163], v[88:91], v[32:35], v[160:163]
    v_add_f32 v84, 0x3727c5ac, v84
    v_rsq_f32 v132, v132
    v_rsq_f32 v134, v134
    v_mfma_f32_16x16x32_bf16 v[140:143], v[92:95], v[28:31], v[140:143]
    v_rsq_f32 v84, v84
    s_mov_b32 exec_lo, 0x00f0000f
    s_mov_b32 exec_hi, 0xf0000f00
    ds_write2_b32 v75, v132, v133 offset0:128 offset1:144
    ds_write2_b32 v75, v134, v135 offset0:160 offset1:176
    ds_write2_b32 v75, v84, v85 offset0:192 offset1:208
    s_mov_b64 exec, -1
    v_mov_b32_dpp v224, v184 row_newbcast:0 row_mask:0xf bank_mask:0xf
    v_mfma_f32_16x16x32_bf16 v[164:167], v[92:95], v[32:35], v[164:167]
    v_mov_b32_dpp v225, v185 row_newbcast:0 row_mask:0xf bank_mask:0xf
    v_mov_b32_dpp v226, v186 row_newbcast:0 row_mask:0xf bank_mask:0xf
    v_mov_b32_dpp v227, v187 row_newbcast:0 row_mask:0xf bank_mask:0xf
    v_fma_f32 v224, -v224, v85, v184
    v_fma_f32 v225, -v225, v85, v185
    v_fma_f32 v226, -v226, v85, v186
    v_fma_f32 v227, -v227, v85, v187
    s_cmp_eq_u32 s49, 15
    s_cselect_b32 s88, 0xffff0000, -1
    s_mov_b32 s89, -1
    s_mov_b32 s90, -1
    s_cselect_b32 s91, -1, 0xffff
    s_waitcnt lgkmcnt(0)
    s_barrier
    ds_read_b32 v134, v75 offset:640
    ds_read_b32 v84, v75 offset:768
    ds_read_b32 v132, v75 offset:512
    ds_read_b128 v[56:59], v72 offset:128
    ds_read_b128 v[60:63], v72 offset:192
    ds_read_b32 v64, v77 offset:256
    ds_read_b32 v65, v77 offset:320
    ds_read_b128 v[44:47], v76 offset:704
    ds_read_b128 v[40:43], v76 offset:640
    ds_read_b128 v[36:39], v76 offset:576
    ds_read_b128 v[32:35], v76 offset:512
    ds_read_b128 v[48:51], v72 offset:0
    ds_read_b128 v[52:55], v72 offset:64
    s_waitcnt lgkmcnt(9)
    v_pk_fma_f32 v[168:169], v[56:57], v[134:135], v[168:169] op_sel:[0,1,0] op_sel_hi:[1,1,1] neg_lo:[0,1,0] neg_hi:[0,1,0]
    v_pk_fma_f32 v[170:171], v[58:59], v[134:135], v[170:171] op_sel:[0,1,0] op_sel_hi:[1,1,1] neg_lo:[0,1,0] neg_hi:[0,1,0]
    v_pk_mul_f32 v[168:169], v[168:169], v[134:135] op_sel:[0,0] op_sel_hi:[1,0]
    v_pk_mul_f32 v[170:171], v[170:171], v[134:135] op_sel:[0,0] op_sel_hi:[1,0]
    v_cvt_pk_bf16_f32 v104, v168, v169
    v_cvt_pk_bf16_f32 v105, v170, v171
    s_waitcnt lgkmcnt(8)
    v_pk_fma_f32 v[172:173], v[60:61], v[134:135], v[172:173] op_sel:[0,1,0] op_sel_hi:[1,1,1] neg_lo:[0,1,0] neg_hi:[0,1,0]
    v_pk_fma_f32 v[174:175], v[62:63], v[134:135], v[174:175] op_sel:[0,1,0] op_sel_hi:[1,1,1] neg_lo:[0,1,0] neg_hi:[0,1,0]
    v_pk_mul_f32 v[172:173], v[172:173], v[134:135] op_sel:[0,0] op_sel_hi:[1,0]
    v_pk_mul_f32 v[174:175], v[174:175], v[134:135] op_sel:[0,0] op_sel_hi:[1,0]
    v_cvt_pk_bf16_f32 v106, v172, v173
    v_cvt_pk_bf16_f32 v107, v174, v175
    ds_write_b128 v78, v[104:107] offset:4096
    v_pk_mul_f32 v[224:225], v[224:225], v[84:85] op_sel_hi:[1,0]
    v_pk_mul_f32 v[226:227], v[226:227], v[84:85] op_sel_hi:[1,0]
    v_cvt_pk_bf16_f32 v224, v224, v225
    v_cvt_pk_bf16_f32 v226, v226, v227
    ds_write_b16 v80, v224 offset:2048
    ds_write_b16_d16_hi v81, v224 offset:2048
    ds_write_b16 v82, v226 offset:2048
    ds_write_b16_d16_hi v83, v226 offset:2048
    s_waitcnt lgkmcnt(10)
    v_pk_fma_f32 v[176:177], v[44:45], v[64:65], v[176:177] op_sel:[0,0,0] op_sel_hi:[1,0,1] neg_lo:[0,1,0] neg_hi:[0,1,0]
    v_pk_fma_f32 v[178:179], v[46:47], v[64:65], v[178:179] op_sel:[0,0,0] op_sel_hi:[1,0,1] neg_lo:[0,1,0] neg_hi:[0,1,0]
    s_waitcnt lgkmcnt(9)
    v_pk_mul_f32 v[176:177], v[176:177], v[40:41]
    v_pk_mul_f32 v[178:179], v[178:179], v[42:43]
    v_cvt_pk_bf16_f32 v112, v176, v177
    v_cvt_pk_bf16_f32 v113, v178, v179
    v_pk_fma_f32 v[180:181], v[44:45], v[64:65], v[180:181] op_sel:[0,1,0] op_sel_hi:[1,1,1] neg_lo:[0,1,0] neg_hi:[0,1,0]
    v_pk_fma_f32 v[182:183], v[46:47], v[64:65], v[182:183] op_sel:[0,1,0] op_sel_hi:[1,1,1] neg_lo:[0,1,0] neg_hi:[0,1,0]
    v_pk_mul_f32 v[180:181], v[180:181], v[40:41]
    v_pk_mul_f32 v[182:183], v[182:183], v[42:43]
    v_cvt_pk_bf16_f32 v118, v180, v181
    v_cvt_pk_bf16_f32 v119, v182, v183
    ds_write_b64 v78, v[112:113] offset:5120
    ds_write_b64 v78, v[118:119] offset:5128
    v_mul_f32 v68, 0x3e8b97f6, v132
    v_mul_f32 v70, 0x3e8b97f6, v134
    v_cndmask_b32 v69, 0, v68, s[90:91]
    v_cndmask_b32 v68, 0, v68, s[88:89]
    v_cndmask_b32 v71, 0, v70, s[90:91]
    v_cndmask_b32 v70, 0, v70, s[88:89]
    v_pk_fma_f32 v[144:145], v[56:57], v[132:133], v[144:145] op_sel:[0,1,0] op_sel_hi:[1,1,1] neg_lo:[0,1,0] neg_hi:[0,1,0]
    v_pk_fma_f32 v[146:147], v[58:59], v[132:133], v[146:147] op_sel:[0,1,0] op_sel_hi:[1,1,1] neg_lo:[0,1,0] neg_hi:[0,1,0]
    v_pk_mul_f32 v[144:145], v[144:145], v[132:133] op_sel:[0,0] op_sel_hi:[1,0]
    v_pk_mul_f32 v[146:147], v[146:147], v[132:133] op_sel:[0,0] op_sel_hi:[1,0]
    v_cvt_pk_bf16_f32 v100, v144, v145
    v_cvt_pk_bf16_f32 v101, v146, v147
    v_pk_fma_f32 v[148:149], v[60:61], v[132:133], v[148:149] op_sel:[0,1,0] op_sel_hi:[1,1,1] neg_lo:[0,1,0] neg_hi:[0,1,0]
    v_pk_fma_f32 v[150:151], v[62:63], v[132:133], v[150:151] op_sel:[0,1,0] op_sel_hi:[1,1,1] neg_lo:[0,1,0] neg_hi:[0,1,0]
    v_pk_mul_f32 v[148:149], v[148:149], v[132:133] op_sel:[0,0] op_sel_hi:[1,0]
    v_pk_mul_f32 v[150:151], v[150:151], v[132:133] op_sel:[0,0] op_sel_hi:[1,0]
    v_cvt_pk_bf16_f32 v102, v148, v149
    v_cvt_pk_bf16_f32 v103, v150, v151
    s_waitcnt lgkmcnt(0)
    s_barrier
    ds_read_b128 v[96:99], v78 offset:2048
    ds_read_b64 v[108:109], v78 offset:3072
    ds_read_b64 v[114:115], v78 offset:3080
    v_pk_fma_f32 v[160:161], v[48:49], v[134:135], v[160:161] op_sel:[0,1,0] op_sel_hi:[1,1,1] neg_lo:[0,1,0] neg_hi:[0,1,0]
    v_pk_fma_f32 v[162:163], v[50:51], v[134:135], v[162:163] op_sel:[0,1,0] op_sel_hi:[1,1,1] neg_lo:[0,1,0] neg_hi:[0,1,0]
    v_pk_mul_f32 v[160:161], v[160:161], v[70:71] op_sel:[0,0] op_sel_hi:[1,0]
    v_pk_mul_f32 v[162:163], v[162:163], v[70:71] op_sel:[0,0] op_sel_hi:[1,0]
    v_cvt_pk_bf16_f32 v92, v160, v161
    v_cvt_pk_bf16_f32 v93, v162, v163
    v_pk_fma_f32 v[164:165], v[52:53], v[134:135], v[164:165] op_sel:[0,1,0] op_sel_hi:[1,1,1] neg_lo:[0,1,0] neg_hi:[0,1,0]
    v_pk_fma_f32 v[166:167], v[54:55], v[134:135], v[166:167] op_sel:[0,1,0] op_sel_hi:[1,1,1] neg_lo:[0,1,0] neg_hi:[0,1,0]
    v_pk_mul_f32 v[164:165], v[164:165], v[70:71] op_sel:[0,1] op_sel_hi:[1,1]
    v_pk_mul_f32 v[166:167], v[166:167], v[70:71] op_sel:[0,1] op_sel_hi:[1,1]
    v_cvt_pk_bf16_f32 v94, v164, v165
    v_cvt_pk_bf16_f32 v95, v166, v167
    s_nop 1
    v_mfma_f32_16x16x32_bf16 v[24:27], v[100:103], v[92:95], v[240:243]
    v_mfma_f32_16x16x32_bf16 v[28:31], v[104:107], v[92:95], v[244:247]
    v_pk_fma_f32 v[136:137], v[48:49], v[132:133], v[136:137] op_sel:[0,1,0] op_sel_hi:[1,1,1] neg_lo:[0,1,0] neg_hi:[0,1,0]
    v_pk_fma_f32 v[138:139], v[50:51], v[132:133], v[138:139] op_sel:[0,1,0] op_sel_hi:[1,1,1] neg_lo:[0,1,0] neg_hi:[0,1,0]
    v_pk_mul_f32 v[136:137], v[136:137], v[68:69] op_sel:[0,0] op_sel_hi:[1,0]
    v_pk_mul_f32 v[138:139], v[138:139], v[68:69] op_sel:[0,0] op_sel_hi:[1,0]
    v_cvt_pk_bf16_f32 v88, v136, v137
    v_cvt_pk_bf16_f32 v89, v138, v139
    v_pk_fma_f32 v[140:141], v[52:53], v[132:133], v[140:141] op_sel:[0,1,0] op_sel_hi:[1,1,1] neg_lo:[0,1,0] neg_hi:[0,1,0]
    v_pk_fma_f32 v[142:143], v[54:55], v[132:133], v[142:143] op_sel:[0,1,0] op_sel_hi:[1,1,1] neg_lo:[0,1,0] neg_hi:[0,1,0]
    v_pk_mul_f32 v[140:141], v[140:141], v[68:69] op_sel:[0,1] op_sel_hi:[1,1]
    v_pk_mul_f32 v[142:143], v[142:143], v[68:69] op_sel:[0,1] op_sel_hi:[1,1]
    v_cvt_pk_bf16_f32 v90, v140, v141
    v_cvt_pk_bf16_f32 v91, v142, v143
    s_waitcnt lgkmcnt(2)
    s_nop 0
    v_mfma_f32_16x16x32_bf16 v[16:19], v[96:99], v[88:91], v[248:251]
    v_mfma_f32_16x16x32_bf16 v[20:23], v[100:103], v[88:91], v[244:247]
    v_pk_fma_f32 v[152:153], v[36:37], v[64:65], v[152:153] op_sel:[0,0,0] op_sel_hi:[1,0,1] neg_lo:[0,1,0] neg_hi:[0,1,0]
    v_pk_fma_f32 v[154:155], v[38:39], v[64:65], v[154:155] op_sel:[0,0,0] op_sel_hi:[1,0,1] neg_lo:[0,1,0] neg_hi:[0,1,0]
    v_pk_mul_f32 v[152:153], v[152:153], v[32:33]
    v_pk_mul_f32 v[154:155], v[154:155], v[34:35]
    v_cvt_pk_bf16_f32 v110, v152, v153
    v_cvt_pk_bf16_f32 v111, v154, v155
    v_pk_fma_f32 v[156:157], v[36:37], v[64:65], v[156:157] op_sel:[0,1,0] op_sel_hi:[1,1,1] neg_lo:[0,1,0] neg_hi:[0,1,0]
    v_pk_fma_f32 v[158:159], v[38:39], v[64:65], v[158:159] op_sel:[0,1,0] op_sel_hi:[1,1,1] neg_lo:[0,1,0] neg_hi:[0,1,0]
    v_pk_mul_f32 v[156:157], v[156:157], v[32:33]
    v_pk_mul_f32 v[158:159], v[158:159], v[34:35]
    v_cvt_pk_bf16_f32 v116, v156, v157
    v_cvt_pk_bf16_f32 v117, v158, v159
    v_max3_f32 v137, v24, v25, v26
    v_max3_f32 v139, v27, v28, v29
    v_max3_f32 v137, v137, v30, v31
    v_max_f32 v137, v137, v139
    v_max3_f32 v136, v16, v17, v18
    v_max3_f32 v138, v19, v20, v21
    v_max3_f32 v136, v136, v22, v23
    v_max_f32 v136, v136, v138
    v_mov_b32 v138, v136
    v_mov_b32 v139, v137
    s_nop 0
    v_permlane32_swap_b32 v136, v138
    v_permlane32_swap_b32 v137, v139
    v_max_f32 v136, v136, v138
    v_max_f32 v137, v137, v139
    v_mov_b32 v138, v136
    v_mov_b32 v139, v137
    s_nop 0
    v_permlane16_swap_b32 v136, v138
    v_permlane16_swap_b32 v137, v139
    v_max_f32 v136, v136, v138
    v_max_f32 v137, v137, v139
    v_pk_add_f32 v[24:25], v[24:25], v[136:137] op_sel:[0,1] op_sel_hi:[1,1] neg_lo:[0,1] neg_hi:[0,1]
    v_pk_add_f32 v[26:27], v[26:27], v[136:137] op_sel:[0,1] op_sel_hi:[1,1] neg_lo:[0,1] neg_hi:[0,1]
    v_pk_add_f32 v[28:29], v[28:29], v[136:137] op_sel:[0,1] op_sel_hi:[1,1] neg_lo:[0,1] neg_hi:[0,1]
    v_pk_add_f32 v[30:31], v[30:31], v[136:137] op_sel:[0,1] op_sel_hi:[1,1] neg_lo:[0,1] neg_hi:[0,1]
    v_exp_f32 v24, v24
    v_exp_f32 v25, v25
    v_exp_f32 v26, v26
    v_exp_f32 v27, v27
    v_exp_f32 v28, v28
    v_exp_f32 v29, v29
    v_exp_f32 v30, v30
    v_exp_f32 v31, v31
    v_cvt_pk_bf16_f32 v148, v24, v25
    v_cvt_pk_bf16_f32 v149, v26, v27
    v_cvt_pk_bf16_f32 v150, v28, v29
    v_cvt_pk_bf16_f32 v151, v30, v31
    s_nop 1
    v_mfma_f32_16x16x32_bf16 v[160:163], v[110:113], v[148:151], 0
    v_mfma_f32_16x16x32_bf16 v[164:167], v[116:119], v[148:151], 0
    v_pk_add_f32 v[16:17], v[16:17], v[136:137] op_sel:[0,0] op_sel_hi:[1,0] neg_lo:[0,1] neg_hi:[0,1]
    v_pk_add_f32 v[18:19], v[18:19], v[136:137] op_sel:[0,0] op_sel_hi:[1,0] neg_lo:[0,1] neg_hi:[0,1]
    v_pk_add_f32 v[20:21], v[20:21], v[136:137] op_sel:[0,0] op_sel_hi:[1,0] neg_lo:[0,1] neg_hi:[0,1]
    v_pk_add_f32 v[22:23], v[22:23], v[136:137] op_sel:[0,0] op_sel_hi:[1,0] neg_lo:[0,1] neg_hi:[0,1]
    v_exp_f32 v16, v16
    v_exp_f32 v17, v17
    v_exp_f32 v18, v18
    v_exp_f32 v19, v19
    v_exp_f32 v20, v20
    v_exp_f32 v21, v21
    v_exp_f32 v22, v22
    v_exp_f32 v23, v23
    v_cvt_pk_bf16_f32 v144, v16, v17
    v_cvt_pk_bf16_f32 v145, v18, v19
    v_cvt_pk_bf16_f32 v146, v20, v21
    v_cvt_pk_bf16_f32 v147, v22, v23
    s_waitcnt lgkmcnt(1)
    s_nop 0
    v_mfma_f32_16x16x32_bf16 v[152:155], v[108:111], v[144:147], 0
    s_waitcnt lgkmcnt(0)
    v_mfma_f32_16x16x32_bf16 v[156:159], v[114:117], v[144:147], 0
    v_pk_add_f32 v[16:17], v[16:17], v[18:19]
    v_pk_add_f32 v[20:21], v[20:21], v[22:23]
    v_pk_add_f32 v[24:25], v[24:25], v[26:27]
    v_pk_add_f32 v[28:29], v[28:29], v[30:31]
    v_pk_add_f32 v[16:17], v[16:17], v[20:21]
    v_pk_add_f32 v[24:25], v[24:25], v[28:29]
    v_add_f32 v140, v16, v17
    v_add_f32 v142, v24, v25
    v_mov_b32 v138, v140
    v_mov_b32 v139, v142
    s_nop 0
    v_permlane32_swap_b32 v140, v138
    v_permlane32_swap_b32 v142, v139
    v_add_f32 v140, v140, v138
    v_add_f32 v142, v142, v139
    v_mov_b32 v138, v140
    v_mov_b32 v139, v142
    s_nop 0
    v_permlane16_swap_b32 v140, v138
    v_permlane16_swap_b32 v142, v139
    v_add_f32 v140, v140, v138
    v_add_f32 v142, v142, v139
    v_rcp_f32 v140, v140
    v_rcp_f32 v142, v142
    v_cndmask_b32 v141, 0, v140, s[90:91]
    v_cndmask_b32 v140, 0, v140, s[88:89]
    v_cndmask_b32 v143, 0, v142, s[90:91]
    v_cndmask_b32 v142, 0, v142, s[88:89]
    v_pk_mul_f32 v[152:153], v[152:153], v[140:141] op_sel_hi:[1,0]
    v_pk_mul_f32 v[154:155], v[154:155], v[140:141] op_sel_hi:[1,0]
    v_pk_mul_f32 v[156:157], v[156:157], v[140:141] op_sel:[0,1] op_sel_hi:[1,1]
    v_pk_mul_f32 v[158:159], v[158:159], v[140:141] op_sel:[0,1] op_sel_hi:[1,1]
    v_cvt_pk_bf16_f32 v144, v152, v153
    v_cvt_pk_bf16_f32 v145, v154, v155
    v_cvt_pk_bf16_f32 v146, v156, v157
    v_cvt_pk_bf16_f32 v147, v158, v159
    buffer_store_dwordx4 v[144:147], v4, s[40:43], s62 offen sc1
    v_pk_mul_f32 v[160:161], v[160:161], v[142:143] op_sel_hi:[1,0]
    v_pk_mul_f32 v[162:163], v[162:163], v[142:143] op_sel_hi:[1,0]
    v_pk_mul_f32 v[164:165], v[164:165], v[142:143] op_sel:[0,1] op_sel_hi:[1,1]
    v_pk_mul_f32 v[166:167], v[166:167], v[142:143] op_sel:[0,1] op_sel_hi:[1,1]
    v_cvt_pk_bf16_f32 v148, v160, v161
    v_cvt_pk_bf16_f32 v149, v162, v163
    v_cvt_pk_bf16_f32 v150, v164, v165
    v_cvt_pk_bf16_f32 v151, v166, v167
    buffer_store_dwordx4 v[148:151], v4, s[40:43], s63 offen sc1
    s_add_u32 m0, s59, 0
    s_mov_b32 s73, 0
    buffer_load_dwordx4 v208, s[16:19], s73 offen lds
    s_add_u32 m0, s59, 1024
    s_mov_b32 s73, 7168
    buffer_load_dwordx4 v208, s[16:19], s73 offen lds
    s_add_u32 m0, s59, 2048
    s_mov_b32 s73, 14336
    buffer_load_dwordx4 v208, s[16:19], s73 offen lds
    s_add_u32 m0, s59, 3072
    s_mov_b32 s73, 21504
    buffer_load_dwordx4 v208, s[16:19], s73 offen lds
    s_add_u32 m0, s59, 4096
    s_mov_b32 s73, 28672
    buffer_load_dwordx4 v208, s[16:19], s73 offen lds
    s_add_u32 m0, s59, 5120
    s_mov_b32 s73, 35840
    buffer_load_dwordx4 v208, s[16:19], s73 offen lds
    s_add_u32 m0, s59, 6144
    s_mov_b32 s73, 43008
    buffer_load_dwordx4 v208, s[16:19], s73 offen lds
    s_add_u32 m0, s59, 7168
    s_mov_b32 s73, 50176
    buffer_load_dwordx4 v208, s[16:19], s73 offen lds
    s_add_u32 m0, s59, 8192
    s_mov_b32 s73, 57344
    buffer_load_dwordx4 v208, s[16:19], s73 offen lds
    s_add_u32 m0, s59, 9216
    s_mov_b32 s73, 64512
    buffer_load_dwordx4 v208, s[16:19], s73 offen lds
    s_add_u32 m0, s59, 10240
    s_mov_b32 s73, 71680
    buffer_load_dwordx4 v208, s[16:19], s73 offen lds
    s_add_u32 m0, s59, 11264
    s_mov_b32 s73, 78848
    buffer_load_dwordx4 v208, s[16:19], s73 offen lds
    s_add_u32 m0, s59, 12288
    s_mov_b32 s73, 86016
    buffer_load_dwordx4 v208, s[16:19], s73 offen lds
    s_add_u32 m0, s59, 13312
    s_mov_b32 s73, 93184
    buffer_load_dwordx4 v208, s[16:19], s73 offen lds
    s_waitcnt vmcnt(18)
    v_readfirstlane_b32 s4, v6
    s_nop 1
    s_cmp_lg_u32 s4, 0
    s_cbranch_scc1 Lepd_P_2
    s_nop 0
Lepg_P_1:
    s_sub_u32 s6, s6, 1
    s_cbranch_scc1 L_end_P
    buffer_load_dword v6, v7, s[44:47], 0 offen sc1
    s_waitcnt vmcnt(0)
    v_readfirstlane_b32 s4, v6
    s_nop 1
    s_cmp_eq_u32 s4, 0
    s_cbranch_scc1 Lepg_P_1
Lepd_P_2:
    s_waitcnt vmcnt(14)
    v_mov_b32 v8, s4
    s_mov_b64 exec, 1
    buffer_store_dword v8, v9, s[40:43], s80 offen sc1
    s_mov_b64 exec, -1
    s_cmp_lt_u32 s67, 99
    s_cbranch_scc1 Lnotag_P_3
    s_lshr_b32 s68, s2, 3
    s_sub_u32 s68, s68, 28
    s_lshl_b32 s68, s68, 2
    s_add_u32 s68, s68, s3
    s_lshl_b32 s68, s68, 16
    s_and_b32 s69, s2, 7
    s_lshl_b32 s69, s69, 9
    s_add_u32 s68, s68, s69
    v_lshrrev_b32 v16, 2, v1
    v_lshlrev_b32 v16, 12, v16
    v_and_b32 v17, 3, v1
    v_lshl_add_u32 v16, v17, 7, v16
    buffer_load_dword v18, v16, s[24:27], s68 offen
    s_add_u32 s68, s68, 0x100000
    s_waitcnt vmcnt(3)
    buffer_load_dword v19, v16, s[24:27], s68 offen
    s_add_u32 s68, s68, 0x100000
    s_waitcnt vmcnt(3)
    buffer_load_dword v20, v16, s[24:27], s68 offen
    s_add_u32 s68, s68, 0x100000
    s_waitcnt vmcnt(3)
    buffer_load_dword v21, v16, s[24:27], s68 offen
    s_add_u32 s68, s68, 0x100000
    s_waitcnt vmcnt(3)
    buffer_load_dword v22, v16, s[24:27], s68 offen
    s_add_u32 s68, s68, 0x100000
    s_waitcnt vmcnt(3)
    buffer_load_dword v23, v16, s[24:27], s68 offen
    s_add_u32 s68, s68, 0x100000
    s_waitcnt vmcnt(3)
    buffer_load_dword v24, v16, s[24:27], s68 offen
    s_add_u32 s68, s68, 0x100000
    s_waitcnt vmcnt(3)
    s_waitcnt vmcnt(0)
    s_branch L_end_P
Lnotag_P_3:
    v_lshrrev_b32 v221, 5, v1
    v_mul_u32_u24 v221, 3584, v221
    v_and_b32 v222, 31, v1
    v_lshl_add_u32 v221, v222, 1, v221
    s_lshl_b32 s58, s67, 1
    s_lshr_b32 s60, s3, 1
    s_add_u32 s58, s58, s60
    s_mul_i32 s58, s58, 28672
    s_lshl_b32 s60, s66, 7
    s_add_u32 s58, s58, s60
    s_and_b32 s60, s3, 1
    s_lshl_b32 s60, s60, 6
    s_add_u32 s58, s58, s60
    buffer_load_ushort v192, v221, s[8:11], s58 offen offset:0
    buffer_load_ushort v193, v221, s[8:11], s58 offen offset:896
    buffer_load_ushort v194, v221, s[8:11], s58 offen offset:1792
    buffer_load_ushort v195, v221, s[8:11], s58 offen offset:2688
    s_add_u32 s58, s58, 7168
    buffer_load_ushort v196, v221, s[8:11], s58 offen offset:0
    buffer_load_ushort v197, v221, s[8:11], s58 offen offset:896
    buffer_load_ushort v198, v221, s[8:11], s58 offen offset:1792
    buffer_load_ushort v199, v221, s[8:11], s58 offen offset:2688
    s_add_u32 s58, s58, 7168
    buffer_load_ushort v200, v221, s[8:11], s58 offen offset:0
    buffer_load_ushort v201, v221, s[8:11], s58 offen offset:896
    buffer_load_ushort v202, v221, s[8:11], s58 offen offset:1792
    buffer_load_ushort v203, v221, s[8:11], s58 offen offset:2688
    s_add_u32 s58, s58, 7168
    buffer_load_ushort v204, v221, s[8:11], s58 offen offset:0
    buffer_load_ushort v205, v221, s[8:11], s58 offen offset:896
    buffer_load_ushort v206, v221, s[8:11], s58 offen offset:1792
    buffer_load_ushort v207, v221, s[8:11], s58 offen offset:2688
    s_and_b32 s68, s2, 7
    s_cmp_ge_u32 s68, 7
    s_cselect_b32 s48, 7, 0
    s_sub_u32 s68, s68, s48
    s_lshl_b32 s48, s68, 12
    s_add_u32 s68, s68, 1
    s_cmp_ge_u32 s68, 7
    s_cselect_b32 s49, 7, 0
    s_sub_u32 s68, s68, s49
    s_lshl_b32 s49, s68, 12
    s_add_u32 s68, s68, 1
    s_cmp_ge_u32 s68, 7
    s_cselect_b32 s50, 7, 0
    s_sub_u32 s68, s68, s50
    s_lshl_b32 s50, s68, 12
    s_add_u32 s68, s68, 1
    s_cmp_ge_u32 s68, 7
    s_cselect_b32 s51, 7, 0
    s_sub_u32 s68, s68, s51
    s_lshl_b32 s51, s68, 12
    s_add_u32 s68, s68, 1
    s_cmp_ge_u32 s68, 7
    s_cselect_b32 s52, 7, 0
    s_sub_u32 s68, s68, s52
    s_lshl_b32 s52, s68, 12
    s_add_u32 s68, s68, 1
    s_cmp_ge_u32 s68, 7
    s_cselect_b32 s53, 7, 0
    s_sub_u32 s68, s68, s53
    s_lshl_b32 s53, s68, 12
    s_add_u32 s68, s68, 1
    s_cmp_ge_u32 s68, 7
    s_cselect_b32 s54, 7, 0
    s_sub_u32 s68, s68, s54
    s_lshl_b32 s54, s68, 12
    s_add_u32 m0, s70, 16384
    s_mul_i32 s73, s94, 56
    s_add_u32 s73, s73, 0
    buffer_load_dwordx4 v213, s[20:23], s73 offen lds
    s_add_u32 m0, s70, 17408
    s_mul_i32 s73, s94, 56
    s_add_u32 s73, s73, 28672
    buffer_load_dwordx4 v213, s[20:23], s73 offen lds
    s_add_u32 m0, s70, 18432
    s_mul_i32 s73, s94, 56
    s_add_u32 s73, s73, 57344
    buffer_load_dwordx4 v213, s[20:23], s73 offen lds
    s_add_u32 m0, s70, 19456
    s_mul_i32 s73, s94, 56
    s_add_u32 s73, s73, 86016
    buffer_load_dwordx4 v213, s[20:23], s73 offen lds
    s_add_u32 m0, s70, 20480
    s_mul_i32 s73, s94, 56
    s_add_u32 s73, s73, 114688
    buffer_load_dwordx4 v213, s[20:23], s73 offen lds
    s_add_u32 m0, s70, 21504
    s_mul_i32 s73, s94, 56
    s_add_u32 s73, s73, 143360
    buffer_load_dwordx4 v213, s[20:23], s73 offen lds
    s_add_u32 m0, s70, 22528
    s_mul_i32 s73, s94, 56
    s_add_u32 s73, s73, 172032
    buffer_load_dwordx4 v213, s[20:23], s73 offen lds
    s_add_u32 m0, s70, 23552
    s_mul_i32 s73, s94, 56
    s_add_u32 s73, s73, 200704
    buffer_load_dwordx4 v213, s[20:23], s73 offen lds
    s_waitcnt vmcnt(25)
    s_barrier
    ds_read_b64_tr_b16 a[0:1], v209 offset:0
    ds_read_b64_tr_b16 a[2:3], v209 offset:2048
    s_add_u32 m0, s70, 24576
    s_mul_i32 s73, s95, 56
    s_add_u32 s73, s73, 0
    buffer_load_dwordx4 v213, s[20:23], s73 offen lds
    ds_read_b64_tr_b16 a[4:5], v209 offset:1024
    ds_read_b64_tr_b16 a[6:7], v209 offset:3072
    s_add_u32 m0, s70, 25600
    s_mul_i32 s73, s95, 56
    s_add_u32 s73, s73, 28672
    buffer_load_dwordx4 v213, s[20:23], s73 offen lds
    ds_read_b64_tr_b16 a[8:9], v209 offset:3584
    ds_read_b64_tr_b16 a[10:11], v209 offset:5632
    ds_read_b64_tr_b16 a[12:13], v209 offset:4608
    ds_read_b64_tr_b16 a[14:15], v209 offset:6656
    s_add_u32 m0, s70, 26624
    s_mul_i32 s73, s95, 56
    s_add_u32 s73, s73, 57344
    buffer_load_dwordx4 v213, s[20:23], s73 offen lds
    ds_read_b64_tr_b16 a[16:17], v209 offset:7168
    ds_read_b64_tr_b16 a[18:19], v209 offset:9216
    s_add_u32 m0, s70, 27648
    s_mul_i32 s73, s95, 56
    s_add_u32 s73, s73, 86016
    buffer_load_dwordx4 v213, s[20:23], s73 offen lds
    ds_read_b64_tr_b16 a[20:21], v209 offset:8192
    ds_read_b64_tr_b16 a[22:23], v209 offset:10240
    ds_read_b64_tr_b16 a[24:25], v209 offset:10752
    ds_read_b64_tr_b16 a[26:27], v209 offset:12800
    s_add_u32 m0, s70, 28672
    s_mul_i32 s73, s95, 56
    s_add_u32 s73, s73, 114688
    buffer_load_dwordx4 v213, s[20:23], s73 offen lds
    ds_read_b64_tr_b16 a[28:29], v209 offset:11776
    ds_read_b64_tr_b16 a[30:31], v210 offset:13824
    s_add_u32 m0, s70, 29696
    s_mul_i32 s73, s95, 56
    s_add_u32 s73, s73, 143360
    buffer_load_dwordx4 v213, s[20:23], s73 offen lds
    ds_read_b64_tr_b16 a[32:33], v209 offset:36864
    ds_read_b64_tr_b16 a[34:35], v209 offset:38912
    ds_read_b64_tr_b16 a[36:37], v209 offset:37888
    ds_read_b64_tr_b16 a[38:39], v209 offset:39936
    s_add_u32 m0, s70, 30720
    s_mul_i32 s73, s95, 56
    s_add_u32 s73, s73, 172032
    buffer_load_dwordx4 v213, s[20:23], s73 offen lds
    ds_read_b64_tr_b16 a[40:41], v209 offset:40448
    ds_read_b64_tr_b16 a[42:43], v209 offset:42496
    s_add_u32 m0, s70, 31744
    s_mul_i32 s73, s95, 56
    s_add_u32 s73, s73, 200704
    buffer_load_dwordx4 v213, s[20:23], s73 offen lds
    ds_read_b64_tr_b16 a[44:45], v209 offset:41472
    ds_read_b64_tr_b16 a[46:47], v209 offset:43520
    ds_read_b64_tr_b16 a[48:49], v209 offset:44032
    ds_read_b64_tr_b16 a[50:51], v209 offset:46080
    s_add_u32 m0, s70, 32768
    s_mul_i32 s73, s96, 56
    s_add_u32 s73, s73, 0
    buffer_load_dwordx4 v213, s[20:23], s73 offen lds
    ds_read_b64_tr_b16 a[52:53], v209 offset:45056
    ds_read_b64_tr_b16 a[54:55], v209 offset:47104
    s_add_u32 m0, s70, 33792
    s_mul_i32 s73, s96, 56
    s_add_u32 s73, s73, 28672
    buffer_load_dwordx4 v213, s[20:23], s73 offen lds
    ds_read_b64_tr_b16 a[56:57], v209 offset:47616
    ds_read_b64_tr_b16 a[58:59], v209 offset:49664
    ds_read_b64_tr_b16 a[60:61], v209 offset:48640
    ds_read_b64_tr_b16 a[62:63], v210 offset:50688
    s_add_u32 m0, s70, 34816
    s_mul_i32 s73, s96, 56
    s_add_u32 s73, s73, 57344
    buffer_load_dwordx4 v213, s[20:23], s73 offen lds
    v_add_u32 v209, 73728, v209
    v_add_u32 v210, 73728, v210
    ds_read_b64_tr_b16 a[64:65], v209 offset:0
    ds_read_b64_tr_b16 a[66:67], v209 offset:2048
    s_add_u32 m0, s70, 35840
    s_mul_i32 s73, s96, 56
    s_add_u32 s73, s73, 86016
    buffer_load_dwordx4 v213, s[20:23], s73 offen lds
    ds_read_b64_tr_b16 a[68:69], v209 offset:1024
    ds_read_b64_tr_b16 a[70:71], v209 offset:3072
    ds_read_b64_tr_b16 a[72:73], v209 offset:3584
    ds_read_b64_tr_b16 a[74:75], v209 offset:5632
    ds_read_b64_tr_b16 a[76:77], v209 offset:4608
    ds_read_b64_tr_b16 a[78:79], v209 offset:6656
    ds_read_b64_tr_b16 a[80:81], v209 offset:7168
    ds_read_b64_tr_b16 a[82:83], v209 offset:9216
    ds_read_b64_tr_b16 a[84:85], v209 offset:8192
    ds_read_b64_tr_b16 a[86:87], v209 offset:10240
    ds_read_b64_tr_b16 a[88:89], v209 offset:10752
    ds_read_b64_tr_b16 a[90:91], v209 offset:12800
    ds_read_b64_tr_b16 a[92:93], v209 offset:11776
    ds_read_b64_tr_b16 a[94:95], v210 offset:13824
    ds_read_b64_tr_b16 a[96:97], v209 offset:36864
    ds_read_b64_tr_b16 a[98:99], v209 offset:38912
    ds_read_b64_tr_b16 a[100:101], v209 offset:37888
    ds_read_b64_tr_b16 a[102:103], v209 offset:39936
    ds_read_b64_tr_b16 a[104:105], v209 offset:40448
    ds_read_b64_tr_b16 a[106:107], v209 offset:42496
    ds_read_b64_tr_b16 a[108:109], v209 offset:41472
    ds_read_b64_tr_b16 a[110:111], v209 offset:43520
    ds_read_b64_tr_b16 a[112:113], v209 offset:44032
    ds_read_b64_tr_b16 a[114:115], v209 offset:46080
    ds_read_b64_tr_b16 a[116:117], v209 offset:45056
    ds_read_b64_tr_b16 a[118:119], v209 offset:47104
    ds_read_b64_tr_b16 a[120:121], v209 offset:47104
    ds_read_b64_tr_b16 a[122:123], v209 offset:49152
    ds_read_b64_tr_b16 a[124:125], v209 offset:48128
    ds_read_b64_tr_b16 a[126:127], v209 offset:50176
    s_waitcnt lgkmcnt(0)
    s_barrier
    buffer_load_dword v249, v10, s[40:43], s83 offen sc1
    s_sleep 3
    buffer_load_dword v250, v10, s[40:43], s83 offen sc1
    s_sleep 3
    s_nop 0
Lpoll_P_4:
    s_sub_u32 s6, s6, 1
    s_cbranch_scc1 L_end_P
    buffer_load_dword v251, v10, s[40:43], s83 offen sc1
    s_waitcnt vmcnt(2)
    v_cmp_ne_u32 vcc, s4, v249
    s_nop 1
    s_cbranch_vccz Lpd_P_5
    buffer_load_dword v249, v10, s[40:43], s83 offen sc1
    s_waitcnt vmcnt(2)
    v_cmp_ne_u32 vcc, s4, v250
    s_nop 1
    s_cbranch_vccz Lpd_P_5
    buffer_load_dword v250, v10, s[40:43], s83 offen sc1
    s_waitcnt vmcnt(2)
    v_cmp_ne_u32 vcc, s4, v251
    s_nop 1
    s_cbranch_vccnz Lpoll_P_4
    s_nop 1
Lpd_P_5:
    s_lshl_b32 s58, s67, 16
    s_lshl_b32 s60, s3, 14
    s_add_u32 s58, s58, s60
    s_add_u32 m0, s70, 0
    s_nop 0
    buffer_load_dwordx4 v4, s[40:43], s58 offen offset:0 sc1 lds
    buffer_load_dwordx4 v4, s[40:43], s58 offen offset:1024 sc1 lds
    buffer_load_dwordx4 v4, s[40:43], s58 offen offset:2048 sc1 lds
    buffer_load_dwordx4 v4, s[40:43], s58 offen offset:3072 sc1 lds
    s_add_u32 m0, s70, 4096
    s_add_u32 s58, s58, 4096
    buffer_load_dwordx4 v4, s[40:43], s58 offen offset:0 sc1 lds
    buffer_load_dwordx4 v4, s[40:43], s58 offen offset:1024 sc1 lds
    buffer_load_dwordx4 v4, s[40:43], s58 offen offset:2048 sc1 lds
    buffer_load_dwordx4 v4, s[40:43], s58 offen offset:3072 sc1 lds
    s_add_u32 m0, s70, 8192
    s_add_u32 s58, s58, 4096
    buffer_load_dwordx4 v4, s[40:43], s58 offen offset:0 sc1 lds
    buffer_load_dwordx4 v4, s[40:43], s58 offen offset:1024 sc1 lds
    buffer_load_dwordx4 v4, s[40:43], s58 offen offset:2048 sc1 lds
    buffer_load_dwordx4 v4, s[40:43], s58 offen offset:3072 sc1 lds
    s_add_u32 m0, s70, 12288
    s_add_u32 s58, s58, 4096
    buffer_load_dwordx4 v4, s[40:43], s58 offen offset:0 sc1 lds
    buffer_load_dwordx4 v4, s[40:43], s58 offen offset:1024 sc1 lds
    buffer_load_dwordx4 v4, s[40:43], s58 offen offset:2048 sc1 lds
    buffer_load_dwordx4 v4, s[40:43], s58 offen offset:3072 sc1 lds
    v_and_b32 v64, 1, v3
    v_mul_u32_u24 v64, 36864, v64
    v_lshl_add_u32 v64, v2, 4, v64
    v_lshrrev_b32 v65, 5, v1
    v_lshl_add_u32 v64, v65, 8, v64
    s_lshr_b32 s60, s3, 1
    s_mul_i32 s60, s60, 73728
    s_add_u32 s60, s60, 12288
    v_add_u32 v64, s60, v64
    ds_read_b64_tr_b16 a[128:129], v215 offset:16384
    ds_read_b64_tr_b16 a[130:131], v215 offset:17408
    ds_read_b64_tr_b16 a[132:133], v216 offset:16384
    ds_read_b64_tr_b16 a[134:135], v216 offset:17408
    ds_read_b64_tr_b16 a[136:137], v215 offset:18432
    ds_read_b64_tr_b16 a[138:139], v215 offset:19456
    ds_read_b64_tr_b16 a[140:141], v216 offset:18432
    ds_read_b64_tr_b16 a[142:143], v216 offset:19456
    ds_read_b64_tr_b16 a[144:145], v215 offset:20480
    ds_read_b64_tr_b16 a[146:147], v215 offset:21504
    ds_read_b64_tr_b16 a[148:149], v216 offset:20480
    ds_read_b64_tr_b16 a[150:151], v216 offset:21504
    ds_read_b64_tr_b16 a[152:153], v215 offset:22528
    ds_read_b64_tr_b16 a[154:155], v215 offset:23552
    ds_read_b64_tr_b16 a[156:157], v216 offset:22528
    ds_read_b64_tr_b16 a[158:159], v216 offset:23552
    ds_read_b64_tr_b16 a[160:161], v215 offset:24576
    ds_read_b64_tr_b16 a[162:163], v215 offset:25600
    ds_read_b64_tr_b16 a[164:165], v216 offset:24576
    ds_read_b64_tr_b16 a[166:167], v216 offset:25600
    ds_read_b64_tr_b16 a[168:169], v215 offset:26624
    ds_read_b64_tr_b16 a[170:171], v215 offset:27648
    ds_read_b64_tr_b16 a[172:173], v216 offset:26624
    ds_read_b64_tr_b16 a[174:175], v216 offset:27648
    ds_read_b64_tr_b16 a[176:177], v215 offset:28672
    ds_read_b64_tr_b16 a[178:179], v215 offset:29696
    ds_read_b64_tr_b16 a[180:181], v216 offset:28672
    ds_read_b64_tr_b16 a[182:183], v216 offset:29696
    ds_read_b64_tr_b16 a[184:185], v215 offset:30720
    ds_read_b64_tr_b16 a[186:187], v215 offset:31744
    ds_read_b64_tr_b16 a[188:189], v216 offset:30720
    ds_read_b64_tr_b16 a[190:191], v216 offset:31744
    ds_read_b64_tr_b16 a[192:193], v215 offset:32768
    ds_read_b64_tr_b16 a[194:195], v215 offset:33792
    ds_read_b64_tr_b16 a[196:197], v216 offset:32768
    ds_read_b64_tr_b16 a[198:199], v216 offset:33792
    ds_read_b64_tr_b16 a[200:201], v215 offset:34816
    ds_read_b64_tr_b16 a[202:203], v215 offset:35840
    ds_read_b64_tr_b16 a[204:205], v216 offset:34816
    ds_read_b64_tr_b16 a[206:207], v216 offset:35840
    v_lshlrev_b32 v192, 16, v192
    v_lshlrev_b32 v193, 16, v193
    v_lshlrev_b32 v194, 16, v194
    v_lshlrev_b32 v195, 16, v195
    v_lshlrev_b32 v196, 16, v196
    v_lshlrev_b32 v197, 16, v197
    v_lshlrev_b32 v198, 16, v198
    v_lshlrev_b32 v199, 16, v199
    v_lshlrev_b32 v200, 16, v200
    v_lshlrev_b32 v201, 16, v201
    v_lshlrev_b32 v202, 16, v202
    v_lshlrev_b32 v203, 16, v203
    v_lshlrev_b32 v204, 16, v204
    v_lshlrev_b32 v205, 16, v205
    v_lshlrev_b32 v206, 16, v206
    v_lshlrev_b32 v207, 16, v207
    s_waitcnt vmcnt(8)
    s_barrier
    ds_read_b128 v[32:35], v64 offset:0
    ds_read_b128 v[36:39], v64 offset:512
    ds_read_b128 v[40:43], v64 offset:1024
    ds_read_b128 v[44:47], v64 offset:1536
    ds_read_b128 v[48:51], v64 offset:2048
    ds_read_b128 v[52:55], v64 offset:2560
    s_waitcnt lgkmcnt(5)
    v_mfma_f32_32x32x16_bf16 v[192:207], v[32:35], a[0:3], v[192:207]
    ds_read_b128 v[56:59], v64 offset:3072
    s_add_u32 m0, s70, 16384
    s_mul_i32 s73, s96, 56
    s_add_u32 s73, s73, 114688
    buffer_load_dwordx4 v213, s[20:23], s73 offen lds
    s_waitcnt lgkmcnt(5)
    v_mfma_f32_32x32x16_bf16 v[192:207], v[36:39], a[4:7], v[192:207]
    ds_read_b128 v[60:63], v64 offset:3584
    s_waitcnt lgkmcnt(5)
    v_mfma_f32_32x32x16_bf16 v[192:207], v[40:43], a[8:11], v[192:207]
    ds_read_b128 v[32:35], v64 offset:4096
    s_waitcnt lgkmcnt(5)
    v_mfma_f32_32x32x16_bf16 v[192:207], v[44:47], a[12:15], v[192:207]
    ds_read_b128 v[36:39], v64 offset:4608
    s_add_u32 m0, s70, 17408
    s_mul_i32 s73, s96, 56
    s_add_u32 s73, s73, 143360
    buffer_load_dwordx4 v213, s[20:23], s73 offen lds
    s_waitcnt lgkmcnt(5)
    v_mfma_f32_32x32x16_bf16 v[192:207], v[48:51], a[16:19], v[192:207]
    ds_read_b128 v[40:43], v64 offset:5120
    s_waitcnt lgkmcnt(5)
    v_mfma_f32_32x32x16_bf16 v[192:207], v[52:55], a[20:23], v[192:207]
    ds_read_b128 v[44:47], v64 offset:5632
    s_waitcnt lgkmcnt(5)
    v_mfma_f32_32x32x16_bf16 v[192:207], v[56:59], a[24:27], v[192:207]
    ds_read_b128 v[48:51], v64 offset:6144
    s_add_u32 m0, s70, 18432
    s_mul_i32 s73, s96, 56
    s_add_u32 s73, s73, 172032
    buffer_load_dwordx4 v213, s[20:23], s73 offen lds
    s_waitcnt lgkmcnt(5)
    v_mfma_f32_32x32x16_bf16 v[192:207], v[60:63], a[28:31], v[192:207]
    ds_read_b128 v[52:55], v64 offset:6656
    s_waitcnt lgkmcnt(5)
    v_mfma_f32_32x32x16_bf16 v[192:207], v[32:35], a[32:35], v[192:207]
    ds_read_b128 v[56:59], v64 offset:7168
    s_waitcnt lgkmcnt(5)
    v_mfma_f32_32x32x16_bf16 v[192:207], v[36:39], a[36:39], v[192:207]
    ds_read_b128 v[60:63], v64 offset:7680
    s_add_u32 m0, s70, 19456
    s_mul_i32 s73, s96, 56
    s_add_u32 s73, s73, 200704
    buffer_load_dwordx4 v213, s[20:23], s73 offen lds
    s_waitcnt lgkmcnt(5)
    v_mfma_f32_32x32x16_bf16 v[192:207], v[40:43], a[40:43], v[192:207]
    s_waitcnt lgkmcnt(4)
    v_mfma_f32_32x32x16_bf16 v[192:207], v[44:47], a[44:47], v[192:207]
    s_waitcnt vmcnt(4)
    s_barrier
    ds_read_b128 v[32:35], v64 offset:8192
    ds_read_b128 v[36:39], v64 offset:8704
    s_waitcnt lgkmcnt(5)
    v_mfma_f32_32x32x16_bf16 v[192:207], v[48:51], a[48:51], v[192:207]
    ds_read_b128 v[40:43], v64 offset:9216
    s_add_u32 m0, s70, 20480
    s_mul_i32 s73, s97, 56
    s_add_u32 s73, s73, 0
    buffer_load_dwordx4 v213, s[20:23], s73 offen lds
    s_waitcnt lgkmcnt(5)
    v_mfma_f32_32x32x16_bf16 v[192:207], v[52:55], a[52:55], v[192:207]
    ds_read_b128 v[44:47], v64 offset:9728
    s_waitcnt lgkmcnt(5)
    v_mfma_f32_32x32x16_bf16 v[192:207], v[56:59], a[56:59], v[192:207]
    ds_read_b128 v[48:51], v64 offset:10240
    s_waitcnt lgkmcnt(5)
    v_mfma_f32_32x32x16_bf16 v[192:207], v[60:63], a[60:63], v[192:207]
    ds_read_b128 v[52:55], v64 offset:10752
    s_add_u32 m0, s70, 21504
    s_mul_i32 s73, s97, 56
    s_add_u32 s73, s73, 28672
    buffer_load_dwordx4 v213, s[20:23], s73 offen lds
    s_waitcnt lgkmcnt(5)
    v_mfma_f32_32x32x16_bf16 v[192:207], v[32:35], a[64:67], v[192:207]
    ds_read_b128 v[56:59], v64 offset:11264
    s_waitcnt lgkmcnt(5)
    v_mfma_f32_32x32x16_bf16 v[192:207], v[36:39], a[68:71], v[192:207]
    ds_read_b128 v[60:63], v64 offset:11776
    s_waitcnt lgkmcnt(5)
    v_mfma_f32_32x32x16_bf16 v[192:207], v[40:43], a[72:75], v[192:207]
    ds_read_b128 v[32:35], v64 offset:12288
    s_add_u32 m0, s70, 22528
    s_mul_i32 s73, s97, 56
    s_add_u32 s73, s73, 57344
    buffer_load_dwordx4 v213, s[20:23], s73 offen lds
    s_waitcnt lgkmcnt(5)
    v_mfma_f32_32x32x16_bf16 v[192:207], v[44:47], a[76:79], v[192:207]
    ds_read_b128 v[36:39], v64 offset:12800
    s_waitcnt lgkmcnt(5)
    v_mfma_f32_32x32x16_bf16 v[192:207], v[48:51], a[80:83], v[192:207]
    ds_read_b128 v[40:43], v64 offset:13312
    s_waitcnt lgkmcnt(5)
    v_mfma_f32_32x32x16_bf16 v[192:207], v[52:55], a[84:87], v[192:207]
    ds_read_b128 v[44:47], v64 offset:13824
    s_add_u32 m0, s70, 23552
    s_mul_i32 s73, s97, 56
    s_add_u32 s73, s73, 86016
    buffer_load_dwordx4 v213, s[20:23], s73 offen lds
    s_waitcnt lgkmcnt(5)
    v_mfma_f32_32x32x16_bf16 v[192:207], v[56:59], a[88:91], v[192:207]
    ds_read_b128 v[48:51], v64 offset:14336
    s_waitcnt lgkmcnt(5)
    v_mfma_f32_32x32x16_bf16 v[192:207], v[60:63], a[92:95], v[192:207]
    ds_read_b128 v[52:55], v64 offset:14848
    s_waitcnt lgkmcnt(5)
    v_mfma_f32_32x32x16_bf16 v[192:207], v[32:35], a[96:99], v[192:207]
    ds_read_b128 v[56:59], v64 offset:15360
    s_add_u32 m0, s70, 24576
    s_mul_i32 s73, s97, 56
    s_add_u32 s73, s73, 114688
    buffer_load_dwordx4 v213, s[20:23], s73 offen lds
    s_waitcnt lgkmcnt(5)
    v_mfma_f32_32x32x16_bf16 v[192:207], v[36:39], a[100:103], v[192:207]
    ds_read_b128 v[60:63], v64 offset:15872
    s_waitcnt lgkmcnt(5)
    v_mfma_f32_32x32x16_bf16 v[192:207], v[40:43], a[104:107], v[192:207]
    s_waitcnt lgkmcnt(4)
    v_mfma_f32_32x32x16_bf16 v[192:207], v[44:47], a[108:111], v[192:207]
    s_add_u32 m0, s70, 25600
    s_mul_i32 s73, s97, 56
    s_add_u32 s73, s73, 143360
    buffer_load_dwordx4 v213, s[20:23], s73 offen lds
    s_waitcnt lgkmcnt(3)
    v_mfma_f32_32x32x16_bf16 v[192:207], v[48:51], a[112:115], v[192:207]
    s_waitcnt lgkmcnt(2)
    v_mfma_f32_32x32x16_bf16 v[192:207], v[52:55], a[116:119], v[192:207]
    s_waitcnt lgkmcnt(1)
    v_mfma_f32_32x32x16_bf16 v[192:207], v[56:59], a[120:123], v[192:207]
    s_add_u32 m0, s70, 26624
    s_mul_i32 s73, s97, 56
    s_add_u32 s73, s73, 172032
    buffer_load_dwordx4 v213, s[20:23], s73 offen lds
    s_waitcnt lgkmcnt(0)
    v_mfma_f32_32x32x16_bf16 v[192:207], v[60:63], a[124:127], v[192:207]
    s_nop 11
    v_pk_mul_f32 v[68:69], v[192:193], v[192:193]
    v_pk_mul_f32 v[70:71], v[194:195], v[194:195]
    v_pk_mul_f32 v[72:73], v[196:197], v[196:197]
    v_pk_mul_f32 v[74:75], v[198:199], v[198:199]
    v_pk_mul_f32 v[76:77], v[200:201], v[200:201]
    v_pk_mul_f32 v[78:79], v[202:203], v[202:203]
    v_pk_mul_f32 v[80:81], v[204:205], v[204:205]
    v_pk_mul_f32 v[82:83], v[206:207], v[206:207]
    s_add_u32 m0, s70, 27648
    s_mul_i32 s73, s97, 56
    s_add_u32 s73, s73, 200704
    buffer_load_dwordx4 v213, s[20:23], s73 offen lds
    v_add_f32_dpp v84, v192, v192 row_mirror row_mask:0xf bank_mask:0x3
    v_add_f32_dpp v85, v193, v193 row_mirror row_mask:0xf bank_mask:0x3
    v_add_f32_dpp v86, v196, v196 row_mirror row_mask:0xf bank_mask:0x3
    v_add_f32_dpp v87, v197, v197 row_mirror row_mask:0xf bank_mask:0x3
    v_add_f32_dpp v88, v200, v200 row_mirror row_mask:0xf bank_mask:0x3
    v_add_f32_dpp v89, v201, v201 row_mirror row_mask:0xf bank_mask:0x3
    v_add_f32_dpp v90, v204, v204 row_mirror row_mask:0xf bank_mask:0x3
    v_add_f32_dpp v91, v205, v205 row_mirror row_mask:0xf bank_mask:0x3
    s_add_u32 m0, s70, 28672
    s_mul_i32 s73, s98, 56
    s_add_u32 s73, s73, 0
    buffer_load_dwordx4 v213, s[20:23], s73 offen lds
    v_add_f32_dpp v92, v68, v68 row_mirror row_mask:0xf bank_mask:0x3
    v_add_f32_dpp v93, v69, v69 row_mirror row_mask:0xf bank_mask:0x3
    v_add_f32_dpp v94, v72, v72 row_mirror row_mask:0xf bank_mask:0x3
    v_add_f32_dpp v95, v73, v73 row_mirror row_mask:0xf bank_mask:0x3
    v_add_f32_dpp v96, v76, v76 row_mirror row_mask:0xf bank_mask:0x3
    v_add_f32_dpp v97, v77, v77 row_mirror row_mask:0xf bank_mask:0x3
    v_add_f32_dpp v98, v80, v80 row_mirror row_mask:0xf bank_mask:0x3
    v_add_f32_dpp v99, v81, v81 row_mirror row_mask:0xf bank_mask:0x3
    s_add_u32 m0, s70, 29696
    s_mul_i32 s73, s98, 56
    s_add_u32 s73, s73, 28672
    buffer_load_dwordx4 v213, s[20:23], s73 offen lds
    v_add_f32_dpp v84, v194, v194 row_mirror row_mask:0xf bank_mask:0xc
    v_add_f32_dpp v85, v195, v195 row_mirror row_mask:0xf bank_mask:0xc
    v_add_f32_dpp v86, v198, v198 row_mirror row_mask:0xf bank_mask:0xc
    v_add_f32_dpp v87, v199, v199 row_mirror row_mask:0xf bank_mask:0xc
    v_add_f32_dpp v88, v202, v202 row_mirror row_mask:0xf bank_mask:0xc
    v_add_f32_dpp v89, v203, v203 row_mirror row_mask:0xf bank_mask:0xc
    v_add_f32_dpp v90, v206, v206 row_mirror row_mask:0xf bank_mask:0xc
    v_add_f32_dpp v91, v207, v207 row_mirror row_mask:0xf bank_mask:0xc
    s_add_u32 m0, s70, 30720
    s_mul_i32 s73, s98, 56
    s_add_u32 s73, s73, 57344
    buffer_load_dwordx4 v213, s[20:23], s73 offen lds
    v_add_f32_dpp v92, v70, v70 row_mirror row_mask:0xf bank_mask:0xc
    v_add_f32_dpp v93, v71, v71 row_mirror row_mask:0xf bank_mask:0xc
    v_add_f32_dpp v94, v74, v74 row_mirror row_mask:0xf bank_mask:0xc
    v_add_f32_dpp v95, v75, v75 row_mirror row_mask:0xf bank_mask:0xc
    v_add_f32_dpp v96, v78, v78 row_mirror row_mask:0xf bank_mask:0xc
    v_add_f32_dpp v97, v79, v79 row_mirror row_mask:0xf bank_mask:0xc
    v_add_f32_dpp v98, v82, v82 row_mirror row_mask:0xf bank_mask:0xc
    v_add_f32_dpp v99, v83, v83 row_mirror row_mask:0xf bank_mask:0xc
    s_add_u32 m0, s70, 31744
    s_mul_i32 s73, s98, 56
    s_add_u32 s73, s73, 86016
    buffer_load_dwordx4 v213, s[20:23], s73 offen lds
    v_add_f32_dpp v84, v84, v84 row_half_mirror row_mask:0xf bank_mask:0x5
    v_add_f32_dpp v86, v86, v86 row_half_mirror row_mask:0xf bank_mask:0x5
    v_add_f32_dpp v88, v88, v88 row_half_mirror row_mask:0xf bank_mask:0x5
    v_add_f32_dpp v90, v90, v90 row_half_mirror row_mask:0xf bank_mask:0x5
    v_add_f32_dpp v92, v92, v92 row_half_mirror row_mask:0xf bank_mask:0x5
    v_add_f32_dpp v94, v94, v94 row_half_mirror row_mask:0xf bank_mask:0x5
    v_add_f32_dpp v96, v96, v96 row_half_mirror row_mask:0xf bank_mask:0x5
    v_add_f32_dpp v98, v98, v98 row_half_mirror row_mask:0xf bank_mask:0x5
    v_add_f32_dpp v84, v85, v85 row_half_mirror row_mask:0xf bank_mask:0xa
    v_add_f32_dpp v86, v87, v87 row_half_mirror row_mask:0xf bank_mask:0xa
    v_add_f32_dpp v88, v89, v89 row_half_mirror row_mask:0xf bank_mask:0xa
    v_add_f32_dpp v90, v91, v91 row_half_mirror row_mask:0xf bank_mask:0xa
    v_add_f32_dpp v92, v93, v93 row_half_mirror row_mask:0xf bank_mask:0xa
    v_add_f32_dpp v94, v95, v95 row_half_mirror row_mask:0xf bank_mask:0xa
    v_add_f32_dpp v96, v97, v97 row_half_mirror row_mask:0xf bank_mask:0xa
    v_add_f32_dpp v98, v99, v99 row_half_mirror row_mask:0xf bank_mask:0xa
    v_add_f32_dpp v85, v84, v84 quad_perm:[1,0,3,2] row_mask:0xf bank_mask:0xf
    v_add_f32_dpp v87, v86, v86 quad_perm:[1,0,3,2] row_mask:0xf bank_mask:0xf
    v_add_f32_dpp v89, v88, v88 quad_perm:[1,0,3,2] row_mask:0xf bank_mask:0xf
    v_add_f32_dpp v91, v90, v90 quad_perm:[1,0,3,2] row_mask:0xf bank_mask:0xf
    v_add_f32_dpp v93, v92, v92 quad_perm:[1,0,3,2] row_mask:0xf bank_mask:0xf
    v_add_f32_dpp v95, v94, v94 quad_perm:[1,0,3,2] row_mask:0xf bank_mask:0xf
    v_add_f32_dpp v97, v96, v96 quad_perm:[1,0,3,2] row_mask:0xf bank_mask:0xf
    v_add_f32_dpp v99, v98, v98 quad_perm:[1,0,3,2] row_mask:0xf bank_mask:0xf
    v_add_f32_dpp v68, v85, v85 quad_perm:[2,3,0,1] row_mask:0xf bank_mask:0xf
    v_add_f32_dpp v69, v87, v87 quad_perm:[2,3,0,1] row_mask:0xf bank_mask:0xf
    v_add_f32_dpp v70, v89, v89 quad_perm:[2,3,0,1] row_mask:0xf bank_mask:0xf
    v_add_f32_dpp v71, v91, v91 quad_perm:[2,3,0,1] row_mask:0xf bank_mask:0xf
    v_add_f32_dpp v72, v93, v93 quad_perm:[2,3,0,1] row_mask:0xf bank_mask:0xf
    v_add_f32_dpp v73, v95, v95 quad_perm:[2,3,0,1] row_mask:0xf bank_mask:0xf
    v_add_f32_dpp v74, v97, v97 quad_perm:[2,3,0,1] row_mask:0xf bank_mask:0xf
    v_add_f32_dpp v75, v99, v99 quad_perm:[2,3,0,1] row_mask:0xf bank_mask:0xf
    v_permlane16_swap_b32 v68, v69
    v_permlane16_swap_b32 v70, v71
    v_permlane16_swap_b32 v72, v73
    v_permlane16_swap_b32 v74, v75
    v_add_f32 v84, v68, v69
    v_add_f32 v85, v72, v73
    v_add_f32 v86, v70, v71
    v_add_f32 v87, v74, v75
    v_and_b32 v65, 1, v3
    v_lshlrev_b32 v65, 6, v65
    v_lshrrev_b32 v66, 5, v1
    v_lshl_add_u32 v65, v66, 5, v65
    v_bfe_u32 v67, v1, 2, 2
    v_lshl_add_u32 v65, v67, 3, v65
    s_lshl_b32 s58, s3, 8
    v_add_u32 v65, s58, v65
    ds_write_b64 v65, v[84:85] offset:0
    ds_write_b64 v65, v[86:87] offset:128
    v_and_b32 v67, 31, v1
    v_lshlrev_b32 v65, 9, v66
    v_lshl_add_u32 v65, v67, 4, v65
    v_lshlrev_b32 v66, 8, v66
    v_lshl_add_u32 v66, v67, 3, v66
    s_and_b32 s58, s58, 512
    v_add_u32 v66, s58, v66
    s_lshl_b32 s58, s67, 1
    s_lshr_b32 s60, s3, 1
    s_add_u32 s58, s58, s60
    s_lshl_b32 s58, s58, 12
    s_add_u32 s58, s58, 0x548000
    s_lshl_b32 s60, s66, 9
    s_add_u32 s60, s60, s58
    s_waitcnt lgkmcnt(0)
    s_barrier
    ds_read_b64 v[84:85], v66 offset:0
    v_mov_b32 v89, s4
    v_mov_b32 v91, s4
    s_waitcnt lgkmcnt(0)
    v_mov_b32 v88, v84
    v_mov_b32 v90, v85
    s_nop 0
    v_permlane32_swap_b32 v88, v84
    v_permlane32_swap_b32 v90, v85
    v_add_f32 v88, v88, v84
    v_add_f32 v90, v90, v85
    s_bitcmp0_b32 s3, 0
    s_cselect_b32 exec_lo, -1, 0
    s_mov_b32 exec_hi, 0
    buffer_store_dwordx4 v[88:91], v65, s[40:43], s60 offen sc1
    s_mov_b64 exec, -1
    v_cvt_pk_bf16_f32 v240, v192, v193
    v_cvt_pk_bf16_f32 v241, v194, v195
    v_cvt_pk_bf16_f32 v242, v196, v197
    v_cvt_pk_bf16_f32 v243, v198, v199
    v_cvt_pk_bf16_f32 v244, v200, v201
    v_cvt_pk_bf16_f32 v245, v202, v203
    v_cvt_pk_bf16_f32 v246, v204, v205
    v_cvt_pk_bf16_f32 v247, v206, v207
    s_lshl_b32 s61, s66, 1
    s_and_b32 s60, s3, 1
    s_add_u32 s61, s61, s60
    s_lshl_b32 s61, s61, 7
    s_lshl_b32 s60, s67, 2
    s_add_u32 s61, s61, s60
    s_and_b32 s60, s3, 2
    s_add_u32 s61, s61, s60
    s_lshl_b32 s61, s61, 10
    s_add_u32 s61, s61, 0x200000
    v_lshlrev_b32 v66, 4, v67
    v_cmp_gt_u32 s[86:87], 32, v1
    s_add_u32 m0, s70, 0
    s_mul_i32 s73, s98, 56
    s_add_u32 s73, s73, 114688
    buffer_load_dwordx4 v213, s[20:23], s73 offen lds
    s_add_u32 m0, s70, 1024
    s_mul_i32 s73, s98, 56
    s_add_u32 s73, s73, 143360
    buffer_load_dwordx4 v213, s[20:23], s73 offen lds
    s_add_u32 m0, s70, 2048
    s_mul_i32 s73, s98, 56
    s_add_u32 s73, s73, 172032
    buffer_load_dwordx4 v213, s[20:23], s73 offen lds
    s_add_u32 m0, s70, 3072
    s_mul_i32 s73, s98, 56
    s_add_u32 s73, s73, 200704
    buffer_load_dwordx4 v213, s[20:23], s73 offen lds
    s_add_u32 m0, s70, 4096
    s_mul_i32 s73, s99, 56
    s_add_u32 s73, s73, 0
    buffer_load_dwordx4 v213, s[20:23], s73 offen lds
    s_add_u32 m0, s70, 5120
    s_mul_i32 s73, s99, 56
    s_add_u32 s73, s73, 28672
    buffer_load_dwordx4 v213, s[20:23], s73 offen lds
    s_add_u32 m0, s70, 6144
    s_mul_i32 s73, s99, 56
    s_add_u32 s73, s73, 57344
    buffer_load_dwordx4 v213, s[20:23], s73 offen lds
    s_add_u32 m0, s70, 7168
    s_mul_i32 s73, s99, 56
    s_add_u32 s73, s73, 86016
    buffer_load_dwordx4 v213, s[20:23], s73 offen lds
    s_add_u32 m0, s70, 8192
    s_mul_i32 s73, s99, 56
    s_add_u32 s73, s73, 114688
    buffer_load_dwordx4 v213, s[20:23], s73 offen lds
    s_add_u32 m0, s70, 9216
    s_mul_i32 s73, s99, 56
    s_add_u32 s73, s73, 143360
    buffer_load_dwordx4 v213, s[20:23], s73 offen lds
    s_add_u32 m0, s70, 10240
    s_mul_i32 s73, s99, 56
    s_add_u32 s73, s73, 172032
    buffer_load_dwordx4 v213, s[20:23], s73 offen lds
    s_add_u32 m0, s70, 11264
    s_mul_i32 s73, s99, 56
    s_add_u32 s73, s73, 200704
    buffer_load_dwordx4 v213, s[20:23], s73 offen lds
    s_add_u32 m0, s70, 12288
    s_mul_i32 s73, s100, 56
    s_add_u32 s73, s73, 0
    buffer_load_dwordx4 v213, s[20:23], s73 offen lds
    s_add_u32 m0, s70, 13312
    s_mul_i32 s73, s100, 56
    s_add_u32 s73, s73, 28672
    buffer_load_dwordx4 v213, s[20:23], s73 offen lds
    s_add_u32 m0, s70, 14336
    s_mul_i32 s73, s100, 56
    s_add_u32 s73, s73, 57344
    buffer_load_dwordx4 v213, s[20:23], s73 offen lds
    s_add_u32 m0, s70, 15360
    s_mul_i32 s73, s100, 56
    s_add_u32 s73, s73, 86016
    buffer_load_dwordx4 v213, s[20:23], s73 offen lds
    buffer_load_dwordx4 v[96:99], v65, s[40:43], s58 offen offset:0 sc1
    buffer_load_dwordx4 v[100:103], v65, s[40:43], s58 offen offset:1024 sc1
    buffer_load_dwordx4 v[104:107], v65, s[40:43], s58 offen offset:2048 sc1
    buffer_load_dwordx4 v[108:111], v66, s[40:43], s58 offen offset:3072 sc1
    s_sleep 5
    s_nop 0
Lst_P_6:
    s_sub_u32 s6, s6, 1
    s_cbranch_scc1 L_end_P
    buffer_load_dwordx4 v[112:115], v65, s[40:43], s58 offen offset:0 sc1
    buffer_load_dwordx4 v[116:119], v65, s[40:43], s58 offen offset:1024 sc1
    buffer_load_dwordx4 v[120:123], v65, s[40:43], s58 offen offset:2048 sc1
    buffer_load_dwordx4 v[124:127], v66, s[40:43], s58 offen offset:3072 sc1
    s_waitcnt vmcnt(4)
    v_xor_b32 v97, s4, v97
    v_xor_b32 v99, s4, v99
    v_xor_b32 v101, s4, v101
    v_xor_b32 v103, s4, v103
    v_xor_b32 v105, s4, v105
    v_xor_b32 v107, s4, v107
    v_xor_b32 v109, s4, v109
    v_xor_b32 v111, s4, v111
    v_cndmask_b32 v108, 0, v108, s[86:87]
    v_cndmask_b32 v110, 0, v110, s[86:87]
    v_or3_b32 v97, v97, v99, v101
    v_or3_b32 v103, v103, v105, v107
    v_or3_b32 v97, v97, v109, v111
    v_or_b32 v97, v97, v103
    v_cmp_ne_u32 vcc, 0, v97
    v_add_f32 v128, v96, v100
    v_add_f32 v129, v104, v108
    v_add_f32 v130, v98, v102
    v_add_f32 v131, v106, v110
    s_cbranch_vccz Lstd_P_7
    buffer_load_dwordx4 v[96:99], v65, s[40:43], s58 offen offset:0 sc1
    buffer_load_dwordx4 v[100:103], v65, s[40:43], s58 offen offset:1024 sc1
    buffer_load_dwordx4 v[104:107], v65, s[40:43], s58 offen offset:2048 sc1
    buffer_load_dwordx4 v[108:111], v66, s[40:43], s58 offen offset:3072 sc1
    s_waitcnt vmcnt(4)
    v_xor_b32 v113, s4, v113
    v_xor_b32 v115, s4, v115
    v_xor_b32 v117, s4, v117
    v_xor_b32 v119, s4, v119
    v_xor_b32 v121, s4, v121
    v_xor_b32 v123, s4, v123
    v_xor_b32 v125, s4, v125
    v_xor_b32 v127, s4, v127
    v_cndmask_b32 v124, 0, v124, s[86:87]
    v_cndmask_b32 v126, 0, v126, s[86:87]
    v_or3_b32 v113, v113, v115, v117
    v_or3_b32 v119, v119, v121, v123
    v_or3_b32 v113, v113, v125, v127
    v_or_b32 v113, v113, v119
    v_cmp_ne_u32 vcc, 0, v113
    v_add_f32 v128, v112, v116
    v_add_f32 v129, v120, v124
    v_add_f32 v130, v114, v118
    v_add_f32 v131, v122, v126
    s_cbranch_vccnz Lst_P_6
    s_nop 3
Lstd_P_7:
    v_add_f32 v128, v128, v129
    v_add_f32 v130, v130, v131
    v_mov_b32 v136, v128
    v_mov_b32 v138, v130
    s_nop 0
    v_permlane32_swap_b32 v128, v136
    v_permlane32_swap_b32 v130, v138
    v_add_f32 v128, v128, v136
    v_add_f32 v130, v130, v138
    v_mul_f32 v133, 0x3b124925, v128
    v_mul_f32 v130, 0x3b124925, v130
    v_fma_f32 v130, -v133, v133, v130
    v_max_f32 v130, 0, v130
    v_add_f32 v135, 0x3727c5ac, v130
    v_rsq_f32 v135, v135
    s_nop 0
    v_mul_f32 v130, v130, v135
    v_fmaak_f32 v130, v130, v135, 0x3727c5ac
    v_rsq_f32 v130, v130
    s_nop 0
    v_mul_f32 v135, v135, v130
    s_lshl_b32 s60, s3, 8
    v_lshl_add_u32 v66, v67, 2, s60
    ds_write_b32 v66, v133 offset:1024
    ds_write_b32 v66, v135 offset:1152
    v_lshrrev_b32 v66, 5, v1
    v_lshl_add_u32 v66, v66, 4, s60
    s_waitcnt lgkmcnt(0)
    ds_read_b128 v[140:143], v66 offset:1024
    ds_read_b128 v[156:159], v66 offset:1152
    ds_read_b128 v[144:147], v66 offset:1056
    ds_read_b128 v[160:163], v66 offset:1184
    ds_read_b128 v[148:151], v66 offset:1088
    ds_read_b128 v[164:167], v66 offset:1216
    ds_read_b128 v[152:155], v66 offset:1120
    ds_read_b128 v[168:171], v66 offset:1248
    s_waitcnt lgkmcnt(7)
    v_pk_add_f32 v[192:193], v[192:193], v[140:141] neg_lo:[0,1] neg_hi:[0,1]
    v_pk_add_f32 v[194:195], v[194:195], v[142:143] neg_lo:[0,1] neg_hi:[0,1]
    s_waitcnt lgkmcnt(5)
    v_pk_add_f32 v[196:197], v[196:197], v[144:145] neg_lo:[0,1] neg_hi:[0,1]
    v_pk_add_f32 v[198:199], v[198:199], v[146:147] neg_lo:[0,1] neg_hi:[0,1]
    v_pk_mul_f32 v[192:193], v[192:193], v[156:157]
    v_pk_mul_f32 v[194:195], v[194:195], v[158:159]
    s_waitcnt lgkmcnt(4)
    v_pk_mul_f32 v[196:197], v[196:197], v[160:161]
    v_pk_mul_f32 v[198:199], v[198:199], v[162:163]
    v_cvt_pk_bf16_f32 v84, v192, v193
    v_cvt_pk_bf16_f32 v85, v194, v195
    v_cvt_pk_bf16_f32 v86, v196, v197
    v_cvt_pk_bf16_f32 v87, v198, v199
    buffer_store_dwordx4 v[84:87], v4, s[40:43], s61 offen offset:0 sc1
    s_waitcnt lgkmcnt(3)
    v_pk_add_f32 v[200:201], v[200:201], v[148:149] neg_lo:[0,1] neg_hi:[0,1]
    v_pk_add_f32 v[202:203], v[202:203], v[150:151] neg_lo:[0,1] neg_hi:[0,1]
    s_waitcnt lgkmcnt(1)
    v_pk_add_f32 v[204:205], v[204:205], v[152:153] neg_lo:[0,1] neg_hi:[0,1]
    v_pk_add_f32 v[206:207], v[206:207], v[154:155] neg_lo:[0,1] neg_hi:[0,1]
    v_pk_mul_f32 v[200:201], v[200:201], v[164:165]
    v_pk_mul_f32 v[202:203], v[202:203], v[166:167]
    s_waitcnt lgkmcnt(0)
    v_pk_mul_f32 v[204:205], v[204:205], v[168:169]
    v_pk_mul_f32 v[206:207], v[206:207], v[170:171]
    v_cvt_pk_bf16_f32 v88, v200, v201
    v_cvt_pk_bf16_f32 v89, v202, v203
    v_cvt_pk_bf16_f32 v90, v204, v205
    v_cvt_pk_bf16_f32 v91, v206, v207
    buffer_store_dwordx4 v[88:91], v4, s[40:43], s61 offen offset:1024 sc1
    ds_read_b64_tr_b16 a[208:209], v215 offset:16384
    ds_read_b64_tr_b16 a[210:211], v215 offset:17408
    ds_read_b64_tr_b16 a[212:213], v216 offset:16384
    ds_read_b64_tr_b16 a[214:215], v216 offset:17408
    ds_read_b64_tr_b16 a[216:217], v215 offset:18432
    ds_read_b64_tr_b16 a[218:219], v215 offset:19456
    ds_read_b64_tr_b16 a[220:221], v216 offset:18432
    ds_read_b64_tr_b16 a[222:223], v216 offset:19456
    ds_read_b64_tr_b16 a[224:225], v215 offset:20480
    ds_read_b64_tr_b16 a[226:227], v215 offset:21504
    ds_read_b64_tr_b16 a[228:229], v216 offset:20480
    ds_read_b64_tr_b16 a[230:231], v216 offset:21504
    ds_read_b64_tr_b16 a[232:233], v215 offset:22528
    ds_read_b64_tr_b16 a[234:235], v215 offset:23552
    ds_read_b64_tr_b16 a[236:237], v216 offset:22528
    ds_read_b64_tr_b16 a[238:239], v216 offset:23552
    ds_read_b64_tr_b16 a[240:241], v215 offset:24576
    ds_read_b64_tr_b16 a[242:243], v215 offset:25600
    ds_read_b64_tr_b16 a[244:245], v216 offset:24576
    ds_read_b64_tr_b16 a[246:247], v216 offset:25600
    ds_read_b64_tr_b16 a[248:249], v215 offset:26624
    ds_read_b64_tr_b16 a[250:251], v215 offset:27648
    ds_read_b64_tr_b16 a[252:253], v216 offset:26624
    ds_read_b64_tr_b16 a[254:255], v216 offset:27648
    ds_read_b64_tr_b16 a[0:1], v215 offset:28672
    ds_read_b64_tr_b16 a[2:3], v215 offset:29696
    ds_read_b64_tr_b16 a[4:5], v216 offset:28672
    ds_read_b64_tr_b16 a[6:7], v216 offset:29696
    ds_read_b64_tr_b16 a[8:9], v215 offset:30720
    ds_read_b64_tr_b16 a[10:11], v215 offset:31744
    ds_read_b64_tr_b16 a[12:13], v216 offset:30720
    ds_read_b64_tr_b16 a[14:15], v216 offset:31744
    ds_read_b64_tr_b16 a[16:17], v215 offset:0
    ds_read_b64_tr_b16 a[18:19], v215 offset:1024
    ds_read_b64_tr_b16 a[20:21], v216 offset:0
    ds_read_b64_tr_b16 a[22:23], v216 offset:1024
    ds_read_b64_tr_b16 a[24:25], v215 offset:2048
    ds_read_b64_tr_b16 a[26:27], v215 offset:3072
    ds_read_b64_tr_b16 a[28:29], v216 offset:2048
    ds_read_b64_tr_b16 a[30:31], v216 offset:3072
    ds_read_b64_tr_b16 a[32:33], v215 offset:4096
    ds_read_b64_tr_b16 a[34:35], v215 offset:5120
    ds_read_b64_tr_b16 a[36:37], v216 offset:4096
    ds_read_b64_tr_b16 a[38:39], v216 offset:5120
    ds_read_b64_tr_b16 a[40:41], v215 offset:6144
    ds_read_b64_tr_b16 a[42:43], v215 offset:7168
    ds_read_b64_tr_b16 a[44:45], v216 offset:6144
    ds_read_b64_tr_b16 a[46:47], v216 offset:7168
    ds_read_b64_tr_b16 a[48:49], v215 offset:8192
    ds_read_b64_tr_b16 a[50:51], v215 offset:9216
    ds_read_b64_tr_b16 a[52:53], v216 offset:8192
    ds_read_b64_tr_b16 a[54:55], v216 offset:9216
    ds_read_b64_tr_b16 a[56:57], v215 offset:10240
    ds_read_b64_tr_b16 a[58:59], v215 offset:11264
    ds_read_b64_tr_b16 a[60:61], v216 offset:10240
    ds_read_b64_tr_b16 a[62:63], v216 offset:11264
    ds_read_b64_tr_b16 a[64:65], v215 offset:12288
    ds_read_b64_tr_b16 a[66:67], v215 offset:13312
    ds_read_b64_tr_b16 a[68:69], v216 offset:12288
    ds_read_b64_tr_b16 a[70:71], v216 offset:13312
    ds_read_b64_tr_b16 a[72:73], v215 offset:14336
    ds_read_b64_tr_b16 a[74:75], v215 offset:15360
    ds_read_b64_tr_b16 a[76:77], v216 offset:14336
    ds_read_b64_tr_b16 a[78:79], v216 offset:15360
    s_waitcnt vmcnt(0)
    v_mov_b32 v8, s4
    s_mov_b64 exec, 1
    buffer_store_dword v8, v9, s[40:43], s81 offen sc1
    s_mov_b64 exec, -1
    s_waitcnt lgkmcnt(4)
    s_add_u32 m0, s70, 12288
    s_mul_i32 s73, s100, 56
    s_add_u32 s73, s73, 114688
    buffer_load_dwordx4 v213, s[20:23], s73 offen lds
    s_add_u32 m0, s70, 13312
    s_mul_i32 s73, s100, 56
    s_add_u32 s73, s73, 143360
    buffer_load_dwordx4 v213, s[20:23], s73 offen lds
    s_waitcnt lgkmcnt(0)
    s_add_u32 m0, s70, 14336
    s_mul_i32 s73, s100, 56
    s_add_u32 s73, s73, 172032
    buffer_load_dwordx4 v213, s[20:23], s73 offen lds
    s_add_u32 m0, s70, 15360
    s_mul_i32 s73, s100, 56
    s_add_u32 s73, s73, 200704
    buffer_load_dwordx4 v213, s[20:23], s73 offen lds
    s_add_u32 m0, s70, 16384
    s_mul_i32 s73, s101, 56
    s_add_u32 s73, s73, 0
    buffer_load_dwordx4 v213, s[20:23], s73 offen lds
    s_add_u32 m0, s70, 17408
    s_mul_i32 s73, s101, 56
    s_add_u32 s73, s73, 28672
    buffer_load_dwordx4 v213, s[20:23], s73 offen lds
    s_add_u32 m0, s70, 18432
    s_mul_i32 s73, s101, 56
    s_add_u32 s73, s73, 57344
    buffer_load_dwordx4 v213, s[20:23], s73 offen lds
    s_add_u32 m0, s70, 19456
    s_mul_i32 s73, s101, 56
    s_add_u32 s73, s73, 86016
    buffer_load_dwordx4 v213, s[20:23], s73 offen lds
    s_add_u32 m0, s70, 20480
    s_mul_i32 s73, s101, 56
    s_add_u32 s73, s73, 114688
    buffer_load_dwordx4 v213, s[20:23], s73 offen lds
    s_add_u32 m0, s70, 21504
    s_mul_i32 s73, s101, 56
    s_add_u32 s73, s73, 143360
    buffer_load_dwordx4 v213, s[20:23], s73 offen lds
    s_add_u32 m0, s70, 22528
    s_mul_i32 s73, s101, 56
    s_add_u32 s73, s73, 172032
    buffer_load_dwordx4 v213, s[20:23], s73 offen lds
    s_add_u32 m0, s70, 23552
    s_mul_i32 s73, s101, 56
    s_add_u32 s73, s73, 200704
    buffer_load_dwordx4 v213, s[20:23], s73 offen lds
    s_add_u32 m0, s70, 24576
    s_mul_i32 s73, s48, 64
    s_add_u32 s73, s73, 0
    buffer_load_dwordx4 v214, s[24:27], s73 offen lds
    s_add_u32 m0, s70, 25600
    s_mul_i32 s73, s48, 64
    s_add_u32 s73, s73, 32768
    buffer_load_dwordx4 v214, s[24:27], s73 offen lds
    s_add_u32 m0, s70, 26624
    s_mul_i32 s73, s48, 64
    s_add_u32 s73, s73, 65536
    buffer_load_dwordx4 v214, s[24:27], s73 offen lds
    s_add_u32 m0, s70, 27648
    s_mul_i32 s73, s48, 64
    s_add_u32 s73, s73, 98304
    buffer_load_dwordx4 v214, s[24:27], s73 offen lds
    s_add_u32 m0, s70, 28672
    s_mul_i32 s73, s48, 64
    s_add_u32 s73, s73, 131072
    buffer_load_dwordx4 v214, s[24:27], s73 offen lds
    s_add_u32 m0, s70, 29696
    s_mul_i32 s73, s48, 64
    s_add_u32 s73, s73, 163840
    buffer_load_dwordx4 v214, s[24:27], s73 offen lds
    s_add_u32 m0, s70, 30720
    s_mul_i32 s73, s48, 64
    s_add_u32 s73, s73, 196608
    buffer_load_dwordx4 v214, s[24:27], s73 offen lds
    s_add_u32 m0, s70, 31744
    s_mul_i32 s73, s48, 64
    s_add_u32 s73, s73, 229376
    buffer_load_dwordx4 v214, s[24:27], s73 offen lds
    s_add_u32 m0, s70, 32768
    s_mul_i32 s73, s49, 64
    s_add_u32 s73, s73, 0
    buffer_load_dwordx4 v214, s[24:27], s73 offen lds
    s_add_u32 m0, s70, 33792
    s_mul_i32 s73, s49, 64
    s_add_u32 s73, s73, 32768
    buffer_load_dwordx4 v214, s[24:27], s73 offen lds
    s_add_u32 m0, s70, 34816
    s_mul_i32 s73, s49, 64
    s_add_u32 s73, s73, 65536
    buffer_load_dwordx4 v214, s[24:27], s73 offen lds
    s_add_u32 m0, s70, 35840
    s_mul_i32 s73, s49, 64
    s_add_u32 s73, s73, 98304
    buffer_load_dwordx4 v214, s[24:27], s73 offen lds
    s_lshl_b32 s71, s64, 18
    s_lshl_b32 s86, s3, 15
    s_add_u32 s71, s71, s86
    s_add_u32 s71, s71, 0x200000
    s_add_u32 s72, s71, 0x20000
    s_mul_i32 s58, s66, 229376
    s_add_u32 s58, s58, 0x3c0000
    s_lshl_b32 s86, s65, 2
    s_add_u32 s86, s86, s3
    s_lshl_b32 s86, s86, 10
    s_add_u32 s57, s58, s86
    s_mul_i32 s86, s3, 28672
    s_add_u32 s58, s58, s86
    s_add_u32 s59, s58, 114688
    v_lshrrev_b32 v208, 5, v1
    v_lshlrev_b32 v208, 3, v208
    s_lshl_b32 s86, s65, 7
    s_lshl_b32 s87, s3, 5
    s_add_u32 s86, s86, s87
    buffer_load_dwordx2 v[220:221], v208, s[28:31], s86 offen offset:0
    buffer_load_dwordx2 v[222:223], v208, s[28:31], s86 offen offset:16
    s_lshl_b32 s86, s67, 7
    s_lshr_b32 s87, s3, 1
    s_lshl_b32 s87, s87, 6
    s_add_u32 s86, s86, s87
    buffer_load_dwordx2 v[224:225], v208, s[32:35], s86 offen offset:0
    buffer_load_dwordx2 v[226:227], v208, s[32:35], s86 offen offset:16
    buffer_load_dwordx2 v[228:229], v208, s[32:35], s86 offen offset:32
    buffer_load_dwordx2 v[230:231], v208, s[32:35], s86 offen offset:48
    v_add_u32 v232, s70, v4
    s_xor_b32 s86, s3, 1
    s_mul_i32 s86, s86, 36864
    s_add_u32 s86, s86, 12288
    v_add_u32 v233, s86, v4
    s_xor_b32 s86, s3, 2
    s_mul_i32 s86, s86, 36864
    s_add_u32 s86, s86, 14336
    v_add_u32 v234, s86, v4
    s_xor_b32 s86, s3, 3
    s_mul_i32 s86, s86, 36864
    s_add_u32 s86, s86, 16384
    v_add_u32 v235, s86, v4
    v_lshrrev_b32 v208, 5, v1
    v_lshlrev_b32 v208, 9, v208
    v_and_b32 v209, 31, v1
    v_lshl_add_u32 v208, v209, 2, v208
    s_lshr_b32 s86, s3, 1
    s_lshl_b32 s86, s86, 12
    v_add_u32 v208, s86, v208
    v_xor_b32 v209, 0x1000, v208
    v_add_u32 v236, s70, v208
    v_add_u32 v237, s70, v209
    s_lshl_b32 s86, s3, 11
    s_add_u32 s86, s86, 12288
    v_add_u32 v238, s86, v4
    v_add_u32 v239, 73728, v238
    v_lshrrev_b32 v208, 3, v1
    v_mul_u32_u24 v212, 896, v208
    v_and_b32 v208, 7, v1
    v_lshl_add_u32 v212, v208, 3, v212
    s_lshl_b32 s68, s67, 2
    s_add_u32 s68, s68, s3
    s_mul_i32 s68, s68, 14336
    s_lshl_b32 s86, s66, 7
    s_add_u32 s68, s68, s86
    s_add_u32 s69, s68, 7168
    s_mov_b32 s88, 0xc0135761
    s_mov_b32 s89, 0xc0135761
    s_mov_b32 s90, 0xbdd2d3e8
    s_mov_b32 s91, 0xffff0000
    buffer_load_dword v249, v11, s[40:43], s84 offen sc1
    s_sleep 3
    buffer_load_dword v250, v11, s[40:43], s84 offen sc1
    s_sleep 3
    s_nop 0
Lpoll_P_8:
    s_sub_u32 s6, s6, 1
    s_cbranch_scc1 L_end_P
    buffer_load_dword v251, v11, s[40:43], s84 offen sc1
    s_waitcnt vmcnt(2)
    v_cmp_ne_u32 vcc, s4, v249
    s_nop 1
    s_cbranch_vccz Lpd_P_9
    buffer_load_dword v249, v11, s[40:43], s84 offen sc1
    s_waitcnt vmcnt(2)
    v_cmp_ne_u32 vcc, s4, v250
    s_nop 1
    s_cbranch_vccz Lpd_P_9
    buffer_load_dword v250, v11, s[40:43], s84 offen sc1
    s_waitcnt vmcnt(2)
    v_cmp_ne_u32 vcc, s4, v251
    s_nop 1
    s_cbranch_vccnz Lpoll_P_8
    s_nop 1
Lpd_P_9:
    s_add_u32 s56, s71, s94
    buffer_load_dwordx4 v[80:83], v5, s[40:43], s56 offen offset:0 sc1
    buffer_load_dwordx4 v[84:87], v5, s[40:43], s56 offen offset:1024 sc1
    buffer_load_dwordx4 v[88:91], v5, s[40:43], s56 offen offset:2048 sc1
    buffer_load_dwordx4 v[92:95], v5, s[40:43], s56 offen offset:3072 sc1
    s_add_u32 s56, s71, s95
    buffer_load_dwordx4 v[96:99], v5, s[40:43], s56 offen offset:0 sc1
    buffer_load_dwordx4 v[100:103], v5, s[40:43], s56 offen offset:1024 sc1
    buffer_load_dwordx4 v[104:107], v5, s[40:43], s56 offen offset:2048 sc1
    buffer_load_dwordx4 v[108:111], v5, s[40:43], s56 offen offset:3072 sc1
    v_lshlrev_b32 v16, 16, v220
    v_and_b32 v17, s91, v220
    v_lshlrev_b32 v18, 16, v221
    v_and_b32 v19, s91, v221
    v_lshlrev_b32 v20, 16, v222
    v_and_b32 v21, s91, v222
    v_lshlrev_b32 v22, 16, v223
    v_and_b32 v23, s91, v223
    v_mov_b64 v[24:25], 0
    v_mov_b64 v[26:27], 0
    v_mov_b64 v[28:29], 0
    v_mov_b64 v[30:31], 0
    ds_read_b64_tr_b16 a[80:81], v215 offset:12288
    ds_read_b64_tr_b16 a[82:83], v215 offset:13312
    ds_read_b64_tr_b16 a[84:85], v216 offset:12288
    ds_read_b64_tr_b16 a[86:87], v216 offset:13312
    ds_read_b64_tr_b16 a[88:89], v215 offset:14336
    ds_read_b64_tr_b16 a[90:91], v215 offset:15360
    ds_read_b64_tr_b16 a[92:93], v216 offset:14336
    ds_read_b64_tr_b16 a[94:95], v216 offset:15360
    ds_read_b64_tr_b16 a[96:97], v215 offset:16384
    ds_read_b64_tr_b16 a[98:99], v215 offset:17408
    ds_read_b64_tr_b16 a[100:101], v216 offset:16384
    ds_read_b64_tr_b16 a[102:103], v216 offset:17408
    ds_read_b64_tr_b16 a[104:105], v215 offset:18432
    ds_read_b64_tr_b16 a[106:107], v215 offset:19456
    ds_read_b64_tr_b16 a[108:109], v216 offset:18432
    ds_read_b64_tr_b16 a[110:111], v216 offset:19456
    ds_read_b64_tr_b16 a[112:113], v215 offset:20480
    ds_read_b64_tr_b16 a[114:115], v215 offset:21504
    ds_read_b64_tr_b16 a[116:117], v216 offset:20480
    ds_read_b64_tr_b16 a[118:119], v216 offset:21504
    ds_read_b64_tr_b16 a[120:121], v215 offset:22528
    ds_read_b64_tr_b16 a[122:123], v215 offset:23552
    ds_read_b64_tr_b16 a[124:125], v216 offset:22528
    ds_read_b64_tr_b16 a[126:127], v216 offset:23552
    v_mov_b32 v9, v5
    s_add_u32 s56, s71, s96
    buffer_load_dwordx4 v[112:115], v5, s[40:43], s56 offen offset:0 sc1
    buffer_load_dwordx4 v[116:119], v5, s[40:43], s56 offen offset:1024 sc1
    s_waitcnt vmcnt(9)
    v_mfma_f32_32x32x16_bf16 v[16:31], a[128:131], v[80:83], v[16:31]
    v_mfma_f32_32x32x16_bf16 v[32:47], a[132:135], v[80:83], 0
    buffer_load_dwordx4 v[120:123], v5, s[40:43], s56 offen offset:2048 sc1
    s_waitcnt vmcnt(9)
    v_mfma_f32_32x32x16_bf16 v[16:31], a[136:139], v[84:87], v[16:31]
    v_mfma_f32_32x32x16_bf16 v[32:47], a[140:143], v[84:87], v[32:47]
    buffer_load_dwordx4 v[124:127], v5, s[40:43], s56 offen offset:3072 sc1
    s_waitcnt vmcnt(9)
    v_mfma_f32_32x32x16_bf16 v[16:31], a[144:147], v[88:91], v[16:31]
    v_mfma_f32_32x32x16_bf16 v[32:47], a[148:151], v[88:91], v[32:47]
    s_add_u32 s56, s71, s97
    buffer_load_dwordx4 v[128:131], v5, s[40:43], s56 offen offset:0 sc1
    s_waitcnt vmcnt(9)
    v_mfma_f32_32x32x16_bf16 v[16:31], a[152:155], v[92:95], v[16:31]
    v_mfma_f32_32x32x16_bf16 v[32:47], a[156:159], v[92:95], v[32:47]
    buffer_load_dwordx4 v[132:135], v5, s[40:43], s56 offen offset:1024 sc1
    s_waitcnt vmcnt(9)
    v_mfma_f32_32x32x16_bf16 v[16:31], a[160:163], v[96:99], v[16:31]
    v_mfma_f32_32x32x16_bf16 v[32:47], a[164:167], v[96:99], v[32:47]
    buffer_load_dwordx4 v[136:139], v5, s[40:43], s56 offen offset:2048 sc1
    s_waitcnt vmcnt(9)
    v_mfma_f32_32x32x16_bf16 v[16:31], a[168:171], v[100:103], v[16:31]
    v_mfma_f32_32x32x16_bf16 v[32:47], a[172:175], v[100:103], v[32:47]
    buffer_load_dwordx4 v[140:143], v5, s[40:43], s56 offen offset:3072 sc1
    s_waitcnt vmcnt(9)
    v_mfma_f32_32x32x16_bf16 v[16:31], a[176:179], v[104:107], v[16:31]
    v_mfma_f32_32x32x16_bf16 v[32:47], a[180:183], v[104:107], v[32:47]
    s_add_u32 s56, s71, s98
    buffer_load_dwordx4 v[144:147], v5, s[40:43], s56 offen offset:0 sc1
    s_waitcnt vmcnt(9)
    v_mfma_f32_32x32x16_bf16 v[16:31], a[184:187], v[108:111], v[16:31]
    v_mfma_f32_32x32x16_bf16 v[32:47], a[188:191], v[108:111], v[32:47]
    buffer_load_dwordx4 v[148:151], v5, s[40:43], s56 offen offset:1024 sc1
    s_waitcnt vmcnt(9)
    v_mfma_f32_32x32x16_bf16 v[16:31], a[192:195], v[112:115], v[16:31]
    v_mfma_f32_32x32x16_bf16 v[32:47], a[196:199], v[112:115], v[32:47]
    buffer_load_dwordx4 v[152:155], v5, s[40:43], s56 offen offset:2048 sc1
    s_waitcnt vmcnt(9)
    v_mfma_f32_32x32x16_bf16 v[16:31], a[200:203], v[116:119], v[16:31]
    v_mfma_f32_32x32x16_bf16 v[32:47], a[204:207], v[116:119], v[32:47]
    buffer_load_dwordx4 v[156:159], v5, s[40:43], s56 offen offset:3072 sc1
    s_waitcnt vmcnt(9)
    v_mfma_f32_32x32x16_bf16 v[16:31], a[208:211], v[120:123], v[16:31]
    v_mfma_f32_32x32x16_bf16 v[32:47], a[212:215], v[120:123], v[32:47]
    s_waitcnt lgkmcnt(15)
    s_add_u32 m0, s70, 12288
    s_mul_i32 s73, s49, 64
    s_add_u32 s73, s73, 131072
    buffer_load_dwordx4 v214, s[24:27], s73 offen lds
    s_add_u32 m0, s70, 13312
    s_mul_i32 s73, s49, 64
    s_add_u32 s73, s73, 163840
    buffer_load_dwordx4 v214, s[24:27], s73 offen lds
    s_add_u32 s56, s71, s99
    buffer_load_dwordx4 v[160:163], v5, s[40:43], s56 offen offset:0 sc1
    s_waitcnt vmcnt(11)
    v_mfma_f32_32x32x16_bf16 v[16:31], a[216:219], v[124:127], v[16:31]
    v_mfma_f32_32x32x16_bf16 v[32:47], a[220:223], v[124:127], v[32:47]
    s_add_u32 m0, s70, 14336
    s_mul_i32 s73, s49, 64
    s_add_u32 s73, s73, 196608
    buffer_load_dwordx4 v214, s[24:27], s73 offen lds
    s_add_u32 m0, s70, 15360
    s_mul_i32 s73, s49, 64
    s_add_u32 s73, s73, 229376
    buffer_load_dwordx4 v214, s[24:27], s73 offen lds
    buffer_load_dwordx4 v[164:167], v5, s[40:43], s56 offen offset:1024 sc1
    s_waitcnt vmcnt(13)
    v_mfma_f32_32x32x16_bf16 v[16:31], a[224:227], v[128:131], v[16:31]
    v_mfma_f32_32x32x16_bf16 v[32:47], a[228:231], v[128:131], v[32:47]
    s_waitcnt lgkmcnt(12)
    s_add_u32 m0, s70, 16384
    s_mul_i32 s73, s50, 64
    s_add_u32 s73, s73, 0
    buffer_load_dwordx4 v214, s[24:27], s73 offen lds
    s_add_u32 m0, s70, 17408
    s_mul_i32 s73, s50, 64
    s_add_u32 s73, s73, 32768
    buffer_load_dwordx4 v214, s[24:27], s73 offen lds
    buffer_load_dwordx4 v[168:171], v5, s[40:43], s56 offen offset:2048 sc1
    s_waitcnt vmcnt(15)
    v_mfma_f32_32x32x16_bf16 v[16:31], a[232:235], v[132:135], v[16:31]
    v_mfma_f32_32x32x16_bf16 v[32:47], a[236:239], v[132:135], v[32:47]
    s_waitcnt lgkmcnt(8)
    s_add_u32 m0, s70, 18432
    s_mul_i32 s73, s50, 64
    s_add_u32 s73, s73, 65536
    buffer_load_dwordx4 v214, s[24:27], s73 offen lds
    s_add_u32 m0, s70, 19456
    s_mul_i32 s73, s50, 64
    s_add_u32 s73, s73, 98304
    buffer_load_dwordx4 v214, s[24:27], s73 offen lds
    buffer_load_dwordx4 v[172:175], v5, s[40:43], s56 offen offset:3072 sc1
    s_waitcnt vmcnt(17)
    v_mfma_f32_32x32x16_bf16 v[16:31], a[240:243], v[136:139], v[16:31]
    v_mfma_f32_32x32x16_bf16 v[32:47], a[244:247], v[136:139], v[32:47]
    s_waitcnt lgkmcnt(4)
    s_add_u32 m0, s70, 20480
    s_mul_i32 s73, s50, 64
    s_add_u32 s73, s73, 131072
    buffer_load_dwordx4 v214, s[24:27], s73 offen lds
    s_add_u32 m0, s70, 21504
    s_mul_i32 s73, s50, 64
    s_add_u32 s73, s73, 163840
    buffer_load_dwordx4 v214, s[24:27], s73 offen lds
    s_add_u32 s56, s71, s100
    buffer_load_dwordx4 v[176:179], v5, s[40:43], s56 offen offset:0 sc1
    s_waitcnt vmcnt(19)
    v_mfma_f32_32x32x16_bf16 v[16:31], a[248:251], v[140:143], v[16:31]
    v_mfma_f32_32x32x16_bf16 v[32:47], a[252:255], v[140:143], v[32:47]
    s_waitcnt lgkmcnt(0)
    s_add_u32 m0, s70, 22528
    s_mul_i32 s73, s50, 64
    s_add_u32 s73, s73, 196608
    buffer_load_dwordx4 v214, s[24:27], s73 offen lds
    s_add_u32 m0, s70, 23552
    s_mul_i32 s73, s50, 64
    s_add_u32 s73, s73, 229376
    buffer_load_dwordx4 v214, s[24:27], s73 offen lds
    buffer_load_dwordx4 v[180:183], v5, s[40:43], s56 offen offset:1024 sc1
    s_waitcnt vmcnt(21)
    v_mfma_f32_32x32x16_bf16 v[16:31], a[0:3], v[144:147], v[16:31]
    v_mfma_f32_32x32x16_bf16 v[32:47], a[4:7], v[144:147], v[32:47]
    s_barrier
    buffer_load_dwordx4 v[184:187], v5, s[40:43], s56 offen offset:2048 sc1
    s_waitcnt vmcnt(21)
    v_mfma_f32_32x32x16_bf16 v[16:31], a[8:11], v[148:151], v[16:31]
    v_mfma_f32_32x32x16_bf16 v[32:47], a[12:15], v[148:151], v[32:47]
    buffer_load_dwordx4 v[188:191], v5, s[40:43], s56 offen offset:3072 sc1
    s_waitcnt vmcnt(21)
    v_mfma_f32_32x32x16_bf16 v[16:31], a[16:19], v[152:155], v[16:31]
    v_mfma_f32_32x32x16_bf16 v[32:47], a[20:23], v[152:155], v[32:47]
    s_add_u32 s56, s71, s101
    buffer_load_dwordx4 v[192:195], v5, s[40:43], s56 offen offset:0 sc1
    s_waitcnt vmcnt(21)
    v_mfma_f32_32x32x16_bf16 v[16:31], a[24:27], v[156:159], v[16:31]
    v_mfma_f32_32x32x16_bf16 v[32:47], a[28:31], v[156:159], v[32:47]
    buffer_load_dwordx4 v[196:199], v5, s[40:43], s56 offen offset:1024 sc1
    s_waitcnt vmcnt(19)
    v_mfma_f32_32x32x16_bf16 v[16:31], a[32:35], v[160:163], v[16:31]
    v_mfma_f32_32x32x16_bf16 v[32:47], a[36:39], v[160:163], v[32:47]
    v_lshlrev_b32 v48, 16, v220
    v_and_b32 v49, s91, v220
    v_lshlrev_b32 v50, 16, v221
    v_and_b32 v51, s91, v221
    buffer_load_dwordx4 v[200:203], v5, s[40:43], s56 offen offset:2048 sc1
    s_waitcnt vmcnt(17)
    v_mfma_f32_32x32x16_bf16 v[16:31], a[40:43], v[164:167], v[16:31]
    v_mfma_f32_32x32x16_bf16 v[32:47], a[44:47], v[164:167], v[32:47]
    v_lshlrev_b32 v52, 16, v222
    v_and_b32 v53, s91, v222
    v_lshlrev_b32 v54, 16, v223
    v_and_b32 v55, s91, v223
    buffer_load_dwordx4 v[204:207], v5, s[40:43], s56 offen offset:3072 sc1
    s_waitcnt vmcnt(15)
    v_mfma_f32_32x32x16_bf16 v[16:31], a[48:51], v[168:171], v[16:31]
    v_mfma_f32_32x32x16_bf16 v[32:47], a[52:55], v[168:171], v[32:47]
    v_mov_b64 v[56:57], 0
    v_mov_b64 v[58:59], 0
    v_mov_b64 v[60:61], 0
    v_mov_b64 v[62:63], 0
    s_add_u32 s56, s72, s94
    buffer_load_dwordx4 v[80:83], v5, s[40:43], s56 offen offset:0 sc1
    s_waitcnt vmcnt(13)
    v_mfma_f32_32x32x16_bf16 v[16:31], a[56:59], v[172:175], v[16:31]
    v_mfma_f32_32x32x16_bf16 v[32:47], a[60:63], v[172:175], v[32:47]
    buffer_load_dwordx4 v[84:87], v5, s[40:43], s56 offen offset:1024 sc1
    s_waitcnt vmcnt(11)
    v_mfma_f32_32x32x16_bf16 v[16:31], a[64:67], v[176:179], v[16:31]
    v_mfma_f32_32x32x16_bf16 v[32:47], a[68:71], v[176:179], v[32:47]
    buffer_load_dwordx4 v[88:91], v5, s[40:43], s56 offen offset:2048 sc1
    s_waitcnt vmcnt(9)
    v_mfma_f32_32x32x16_bf16 v[16:31], a[72:75], v[180:183], v[16:31]
    v_mfma_f32_32x32x16_bf16 v[32:47], a[76:79], v[180:183], v[32:47]
    buffer_load_dwordx4 v[92:95], v5, s[40:43], s56 offen offset:3072 sc1
    s_waitcnt vmcnt(9)
    v_mfma_f32_32x32x16_bf16 v[16:31], a[80:83], v[184:187], v[16:31]
    v_mfma_f32_32x32x16_bf16 v[32:47], a[84:87], v[184:187], v[32:47]
    s_add_u32 s56, s72, s95
    buffer_load_dwordx4 v[96:99], v5, s[40:43], s56 offen offset:0 sc1
    s_waitcnt vmcnt(9)
    v_mfma_f32_32x32x16_bf16 v[16:31], a[88:91], v[188:191], v[16:31]
    v_mfma_f32_32x32x16_bf16 v[32:47], a[92:95], v[188:191], v[32:47]
    buffer_load_dwordx4 v[100:103], v5, s[40:43], s56 offen offset:1024 sc1
    s_waitcnt vmcnt(9)
    v_mfma_f32_32x32x16_bf16 v[16:31], a[96:99], v[192:195], v[16:31]
    v_mfma_f32_32x32x16_bf16 v[32:47], a[100:103], v[192:195], v[32:47]
    buffer_load_dwordx4 v[104:107], v5, s[40:43], s56 offen offset:2048 sc1
    s_waitcnt vmcnt(9)
    v_mfma_f32_32x32x16_bf16 v[16:31], a[104:107], v[196:199], v[16:31]
    v_mfma_f32_32x32x16_bf16 v[32:47], a[108:111], v[196:199], v[32:47]
    buffer_load_dwordx4 v[108:111], v5, s[40:43], s56 offen offset:3072 sc1
    s_waitcnt vmcnt(9)
    v_mfma_f32_32x32x16_bf16 v[16:31], a[112:115], v[200:203], v[16:31]
    v_mfma_f32_32x32x16_bf16 v[32:47], a[116:119], v[200:203], v[32:47]
    s_add_u32 s56, s72, s96
    buffer_load_dwordx4 v[112:115], v5, s[40:43], s56 offen offset:0 sc1
    s_waitcnt vmcnt(9)
    v_mfma_f32_32x32x16_bf16 v[16:31], a[120:123], v[204:207], v[16:31]
    v_mfma_f32_32x32x16_bf16 v[32:47], a[124:127], v[204:207], v[32:47]
    buffer_load_dwordx4 v[116:119], v5, s[40:43], s56 offen offset:1024 sc1
    s_waitcnt vmcnt(9)
    v_mfma_f32_32x32x16_bf16 v[48:63], a[128:131], v[80:83], v[48:63]
    v_mfma_f32_32x32x16_bf16 v[64:79], a[132:135], v[80:83], 0
    s_nop 7
    ds_write_b128 v235, v[40:43] offset:0
    ds_write_b128 v235, v[44:47] offset:1024
    ds_write_b128 v234, v[32:35] offset:0
    buffer_load_dwordx4 v[120:123], v5, s[40:43], s56 offen offset:2048 sc1
    s_waitcnt vmcnt(9)
    v_mfma_f32_32x32x16_bf16 v[48:63], a[136:139], v[84:87], v[48:63]
    v_mfma_f32_32x32x16_bf16 v[64:79], a[140:143], v[84:87], v[64:79]
    ds_write_b128 v234, v[36:39] offset:1024
    ds_write_b128 v233, v[24:27] offset:0
    ds_write_b128 v233, v[28:31] offset:1024
    buffer_load_dwordx4 v[124:127], v5, s[40:43], s56 offen offset:3072 sc1
    s_waitcnt vmcnt(9)
    v_mfma_f32_32x32x16_bf16 v[48:63], a[144:147], v[88:91], v[48:63]
    v_mfma_f32_32x32x16_bf16 v[64:79], a[148:151], v[88:91], v[64:79]
    s_waitcnt lgkmcnt(0)
    s_barrier
    ds_read_b128 v[24:27], v232 offset:0
    ds_read_b128 v[32:35], v232 offset:2048
    ds_read_b128 v[40:43], v232 offset:4096
    ds_read_b128 v[28:31], v232 offset:1024
    ds_read_b128 v[36:39], v232 offset:3072
    ds_read_b128 v[44:47], v232 offset:5120
    s_add_u32 s56, s72, s97
    buffer_load_dwordx4 v[128:131], v5, s[40:43], s56 offen offset:0 sc1
    s_waitcnt vmcnt(9)
    v_mfma_f32_32x32x16_bf16 v[48:63], a[152:155], v[92:95], v[48:63]
    v_mfma_f32_32x32x16_bf16 v[64:79], a[156:159], v[92:95], v[64:79]
    buffer_load_dwordx4 v[132:135], v5, s[40:43], s56 offen offset:1024 sc1
    s_waitcnt vmcnt(9)
    v_mfma_f32_32x32x16_bf16 v[48:63], a[160:163], v[96:99], v[48:63]
    v_mfma_f32_32x32x16_bf16 v[64:79], a[164:167], v[96:99], v[64:79]
    v_mov_b32 v211, s88
    s_waitcnt lgkmcnt(4)
    v_add_f32 v24, v24, v32
    s_waitcnt lgkmcnt(3)
    v_add_f32 v16, v16, v40
    v_add_f32 v25, v25, v33
    v_add_f32 v17, v17, v41
    v_add_f32 v26, v26, v34
    v_add_f32 v18, v18, v42
    v_add_f32 v27, v27, v35
    v_add_f32 v19, v19, v43
    s_waitcnt lgkmcnt(1)
    v_add_f32 v28, v28, v36
    s_waitcnt lgkmcnt(0)
    v_add_f32 v20, v20, v44
    v_add_f32 v29, v29, v37
    v_add_f32 v21, v21, v45
    v_add_f32 v30, v30, v38
    v_add_f32 v22, v22, v46
    v_add_f32 v31, v31, v39
    buffer_load_dwordx4 v[136:139], v5, s[40:43], s56 offen offset:2048 sc1
    s_waitcnt vmcnt(9)
    v_mfma_f32_32x32x16_bf16 v[48:63], a[168:171], v[100:103], v[48:63]
    v_mfma_f32_32x32x16_bf16 v[64:79], a[172:175], v[100:103], v[64:79]
    v_add_f32 v23, v23, v47
    v_add_f32 v16, v16, v24
    v_add_f32 v17, v17, v25
    v_add_f32 v18, v18, v26
    v_add_f32 v19, v19, v27
    v_add_f32 v20, v20, v28
    v_add_f32 v21, v21, v29
    v_add_f32 v22, v22, v30
    v_add_f32 v23, v23, v31
    v_mul_f32 v24, v16, v16
    v_mul_f32 v25, v17, v17
    v_mul_f32 v26, v18, v18
    v_mul_f32 v27, v19, v19
    v_mul_f32 v28, v20, v20
    v_mul_f32 v29, v21, v21
    v_mul_f32 v30, v22, v22
    buffer_load_dwordx4 v[140:143], v5, s[40:43], s56 offen offset:3072 sc1
    s_waitcnt vmcnt(9)
    v_mfma_f32_32x32x16_bf16 v[48:63], a[176:179], v[104:107], v[48:63]
    v_mfma_f32_32x32x16_bf16 v[64:79], a[180:183], v[104:107], v[64:79]
    v_mul_f32 v31, v23, v23
    v_fma_f32 v24, v24, s90, v211
    v_fma_f32 v25, v25, s90, v211
    v_fma_f32 v26, v26, s90, v211
    v_fma_f32 v27, v27, s90, v211
    v_fma_f32 v28, v28, s90, v211
    v_fma_f32 v29, v29, s90, v211
    v_fma_f32 v30, v30, s90, v211
    v_fma_f32 v31, v31, s90, v211
    v_mul_f32 v24, v24, v16
    v_mul_f32 v25, v25, v17
    v_mul_f32 v26, v26, v18
    v_mul_f32 v27, v27, v19
    v_mul_f32 v28, v28, v20
    v_mul_f32 v29, v29, v21
    v_mul_f32 v30, v30, v22
    s_add_u32 s56, s72, s98
    buffer_load_dwordx4 v[144:147], v5, s[40:43], s56 offen offset:0 sc1
    s_waitcnt vmcnt(9)
    v_mfma_f32_32x32x16_bf16 v[48:63], a[184:187], v[108:111], v[48:63]
    v_mfma_f32_32x32x16_bf16 v[64:79], a[188:191], v[108:111], v[64:79]
    v_mul_f32 v31, v31, v23
    v_exp_f32 v24, v24
    v_exp_f32 v25, v25
    v_exp_f32 v26, v26
    v_exp_f32 v27, v27
    v_exp_f32 v28, v28
    v_exp_f32 v29, v29
    v_exp_f32 v30, v30
    v_exp_f32 v31, v31
    v_add_f32 v24, 1.0, v24
    v_add_f32 v25, 1.0, v25
    v_add_f32 v26, 1.0, v26
    v_add_f32 v27, 1.0, v27
    v_add_f32 v28, 1.0, v28
    v_add_f32 v29, 1.0, v29
    v_add_f32 v30, 1.0, v30
    ds_read_b64_tr_b16 a[128:129], v217 offset:24576
    ds_read_b64_tr_b16 a[130:131], v217 offset:25600
    ds_read_b64_tr_b16 a[132:133], v218 offset:24576
    ds_read_b64_tr_b16 a[134:135], v218 offset:25600
    ds_read_b64_tr_b16 a[136:137], v217 offset:26624
    ds_read_b64_tr_b16 a[138:139], v217 offset:27648
    ds_read_b64_tr_b16 a[140:141], v218 offset:26624
    ds_read_b64_tr_b16 a[142:143], v218 offset:27648
    buffer_load_dwordx4 v[148:151], v5, s[40:43], s56 offen offset:1024 sc1
    s_waitcnt vmcnt(9)
    v_mfma_f32_32x32x16_bf16 v[48:63], a[192:195], v[112:115], v[48:63]
    v_mfma_f32_32x32x16_bf16 v[64:79], a[196:199], v[112:115], v[64:79]
    v_add_f32 v31, 1.0, v31
    v_rcp_f32 v24, v24
    v_rcp_f32 v25, v25
    v_rcp_f32 v26, v26
    v_rcp_f32 v27, v27
    v_rcp_f32 v28, v28
    v_rcp_f32 v29, v29
    v_rcp_f32 v30, v30
    v_rcp_f32 v31, v31
    v_mul_f32 v24, v24, v16
    v_mul_f32 v25, v25, v17
    v_mul_f32 v26, v26, v18
    v_mul_f32 v27, v27, v19
    v_mul_f32 v28, v28, v20
    v_mul_f32 v29, v29, v21
    v_mul_f32 v30, v30, v22
    ds_read_b64_tr_b16 a[144:145], v217 offset:28672
    ds_read_b64_tr_b16 a[146:147], v217 offset:29696
    ds_read_b64_tr_b16 a[148:149], v218 offset:28672
    ds_read_b64_tr_b16 a[150:151], v218 offset:29696
    ds_read_b64_tr_b16 a[152:153], v217 offset:30720
    ds_read_b64_tr_b16 a[154:155], v217 offset:31744
    ds_read_b64_tr_b16 a[156:157], v218 offset:30720
    ds_read_b64_tr_b16 a[158:159], v218 offset:31744
    buffer_load_dwordx4 v[152:155], v5, s[40:43], s56 offen offset:2048 sc1
    s_waitcnt vmcnt(9)
    v_mfma_f32_32x32x16_bf16 v[48:63], a[200:203], v[116:119], v[48:63]
    v_mfma_f32_32x32x16_bf16 v[64:79], a[204:207], v[116:119], v[64:79]
    v_mul_f32 v31, v31, v23
    v_cvt_pk_bf16_f32 v32, v24, v25
    v_cvt_pk_bf16_f32 v33, v26, v27
    v_cvt_pk_bf16_f32 v34, v28, v29
    v_cvt_pk_bf16_f32 v35, v30, v31
    buffer_store_dwordx4 v[32:35], v5, s[40:43], s57 offen sc1
    ds_read_b64_tr_b16 a[160:161], v217 offset:32768
    ds_read_b64_tr_b16 a[162:163], v217 offset:33792
    ds_read_b64_tr_b16 a[164:165], v218 offset:32768
    ds_read_b64_tr_b16 a[166:167], v218 offset:33792
    ds_read_b64_tr_b16 a[168:169], v217 offset:34816
    ds_read_b64_tr_b16 a[170:171], v217 offset:35840
    ds_read_b64_tr_b16 a[172:173], v218 offset:34816
    ds_read_b64_tr_b16 a[174:175], v218 offset:35840
    buffer_load_dwordx4 v[156:159], v5, s[40:43], s56 offen offset:3072 sc1
    s_waitcnt vmcnt(10)
    v_mfma_f32_32x32x16_bf16 v[48:63], a[208:211], v[120:123], v[48:63]
    v_mfma_f32_32x32x16_bf16 v[64:79], a[212:215], v[120:123], v[64:79]
    ds_read_b64_tr_b16 a[176:177], v217 offset:12288
    ds_read_b64_tr_b16 a[178:179], v217 offset:13312
    ds_read_b64_tr_b16 a[180:181], v218 offset:12288
    ds_read_b64_tr_b16 a[182:183], v218 offset:13312
    ds_read_b64_tr_b16 a[184:185], v217 offset:14336
    ds_read_b64_tr_b16 a[186:187], v217 offset:15360
    ds_read_b64_tr_b16 a[188:189], v218 offset:14336
    ds_read_b64_tr_b16 a[190:191], v218 offset:15360
    s_and_b32 s60, s3, 1
    s_cmp_eq_u32 s60, 0
    s_cselect_b32 s60, 1.0, 0
    v_lshlrev_b32 v16, 16, v224
    v_and_b32 v17, s91, v224
    v_lshlrev_b32 v208, 16, v240
    v_and_b32 v209, s91, v240
    v_add_f32 v16, v16, v208
    s_add_u32 s56, s72, s99
    buffer_load_dwordx4 v[160:163], v5, s[40:43], s56 offen offset:0 sc1
    s_waitcnt vmcnt(10)
    v_mfma_f32_32x32x16_bf16 v[48:63], a[216:219], v[124:127], v[48:63]
    v_mfma_f32_32x32x16_bf16 v[64:79], a[220:223], v[124:127], v[64:79]
    ds_read_b64_tr_b16 a[192:193], v217 offset:16384
    ds_read_b64_tr_b16 a[194:195], v217 offset:17408
    ds_read_b64_tr_b16 a[196:197], v218 offset:16384
    ds_read_b64_tr_b16 a[198:199], v218 offset:17408
    ds_read_b64_tr_b16 a[200:201], v217 offset:18432
    ds_read_b64_tr_b16 a[202:203], v217 offset:19456
    ds_read_b64_tr_b16 a[204:205], v218 offset:18432
    ds_read_b64_tr_b16 a[206:207], v218 offset:19456
    v_add_f32 v17, v17, v209
    v_mul_f32 v16, s60, v16
    v_mul_f32 v17, s60, v17
    v_lshlrev_b32 v18, 16, v225
    v_and_b32 v19, s91, v225
    v_lshlrev_b32 v210, 16, v241
    buffer_load_dwordx4 v[164:167], v5, s[40:43], s56 offen offset:1024 sc1
    s_waitcnt vmcnt(10)
    v_mfma_f32_32x32x16_bf16 v[48:63], a[224:227], v[128:131], v[48:63]
    v_mfma_f32_32x32x16_bf16 v[64:79], a[228:231], v[128:131], v[64:79]
    ds_read_b64_tr_b16 a[208:209], v217 offset:20480
    ds_read_b64_tr_b16 a[210:211], v217 offset:21504
    ds_read_b64_tr_b16 a[212:213], v218 offset:20480
    ds_read_b64_tr_b16 a[214:215], v218 offset:21504
    ds_read_b64_tr_b16 a[216:217], v217 offset:22528
    ds_read_b64_tr_b16 a[218:219], v217 offset:23552
    ds_read_b64_tr_b16 a[220:221], v218 offset:22528
    ds_read_b64_tr_b16 a[222:223], v218 offset:23552
    s_waitcnt lgkmcnt(15)
    s_add_u32 m0, s70, 24576
    s_mul_i32 s73, s51, 64
    s_add_u32 s73, s73, 0
    buffer_load_dwordx4 v214, s[24:27], s73 offen lds
    s_add_u32 m0, s70, 25600
    s_mul_i32 s73, s51, 64
    s_add_u32 s73, s73, 32768
    buffer_load_dwordx4 v214, s[24:27], s73 offen lds
    v_and_b32 v211, s91, v241
    v_add_f32 v18, v18, v210
    v_add_f32 v19, v19, v211
    v_mul_f32 v18, s60, v18
    v_mul_f32 v19, s60, v19
    v_lshlrev_b32 v20, 16, v226
    buffer_load_dwordx4 v[168:171], v5, s[40:43], s56 offen offset:2048 sc1
    s_waitcnt vmcnt(12)
    v_mfma_f32_32x32x16_bf16 v[48:63], a[232:235], v[132:135], v[48:63]
    v_mfma_f32_32x32x16_bf16 v[64:79], a[236:239], v[132:135], v[64:79]
    s_waitcnt vmcnt(6)
    v_mov_b32 v8, s4
    s_mov_b64 exec, 1
    buffer_store_dword v8, v9, s[40:43], s82 offen sc1
    s_mov_b64 exec, -1
    s_add_u32 m0, s70, 26624
    s_mul_i32 s73, s51, 64
    s_add_u32 s73, s73, 65536
    buffer_load_dwordx4 v214, s[24:27], s73 offen lds
    s_add_u32 m0, s70, 27648
    s_mul_i32 s73, s51, 64
    s_add_u32 s73, s73, 98304
    buffer_load_dwordx4 v214, s[24:27], s73 offen lds
    v_and_b32 v21, s91, v226
    v_lshlrev_b32 v208, 16, v242
    v_and_b32 v209, s91, v242
    v_add_f32 v20, v20, v208
    v_add_f32 v21, v21, v209
    v_mul_f32 v20, s60, v20
    buffer_load_dwordx4 v[172:175], v5, s[40:43], s56 offen offset:3072 sc1
    v_mfma_f32_32x32x16_bf16 v[48:63], a[240:243], v[136:139], v[48:63]
    v_mfma_f32_32x32x16_bf16 v[64:79], a[244:247], v[136:139], v[64:79]
    s_add_u32 m0, s70, 28672
    s_mul_i32 s73, s51, 64
    s_add_u32 s73, s73, 131072
    buffer_load_dwordx4 v214, s[24:27], s73 offen lds
    s_add_u32 m0, s70, 29696
    s_mul_i32 s73, s51, 64
    s_add_u32 s73, s73, 163840
    buffer_load_dwordx4 v214, s[24:27], s73 offen lds
    v_mul_f32 v21, s60, v21
    v_lshlrev_b32 v22, 16, v227
    v_and_b32 v23, s91, v227
    v_lshlrev_b32 v210, 16, v243
    v_and_b32 v211, s91, v243
    v_add_f32 v22, v22, v210
    s_add_u32 s56, s72, s100
    buffer_load_dwordx4 v[176:179], v5, s[40:43], s56 offen offset:0 sc1
    v_mfma_f32_32x32x16_bf16 v[48:63], a[248:251], v[140:143], v[48:63]
    v_mfma_f32_32x32x16_bf16 v[64:79], a[252:255], v[140:143], v[64:79]
    s_add_u32 m0, s70, 30720
    s_mul_i32 s73, s51, 64
    s_add_u32 s73, s73, 196608
    buffer_load_dwordx4 v214, s[24:27], s73 offen lds
    s_add_u32 m0, s70, 31744
    s_mul_i32 s73, s51, 64
    s_add_u32 s73, s73, 229376
    buffer_load_dwordx4 v214, s[24:27], s73 offen lds
    v_add_f32 v23, v23, v211
    v_mul_f32 v22, s60, v22
    v_mul_f32 v23, s60, v23
    v_lshlrev_b32 v24, 16, v228
    v_and_b32 v25, s91, v228
    v_lshlrev_b32 v208, 16, v244
    buffer_load_dwordx4 v[180:183], v5, s[40:43], s56 offen offset:1024 sc1
    v_mfma_f32_32x32x16_bf16 v[48:63], a[0:3], v[144:147], v[48:63]
    v_mfma_f32_32x32x16_bf16 v[64:79], a[4:7], v[144:147], v[64:79]
    s_add_u32 m0, s70, 32768
    s_mul_i32 s73, s52, 64
    s_add_u32 s73, s73, 0
    buffer_load_dwordx4 v214, s[24:27], s73 offen lds
    s_add_u32 m0, s70, 33792
    s_mul_i32 s73, s52, 64
    s_add_u32 s73, s73, 32768
    buffer_load_dwordx4 v214, s[24:27], s73 offen lds
    v_and_b32 v209, s91, v244
    v_add_f32 v24, v24, v208
    v_add_f32 v25, v25, v209
    v_mul_f32 v24, s60, v24
    v_mul_f32 v25, s60, v25
    v_lshlrev_b32 v26, 16, v229
    buffer_load_dwordx4 v[184:187], v5, s[40:43], s56 offen offset:2048 sc1
    v_mfma_f32_32x32x16_bf16 v[48:63], a[8:11], v[148:151], v[48:63]
    v_mfma_f32_32x32x16_bf16 v[64:79], a[12:15], v[148:151], v[64:79]
    s_add_u32 m0, s70, 34816
    s_mul_i32 s73, s52, 64
    s_add_u32 s73, s73, 65536
    buffer_load_dwordx4 v214, s[24:27], s73 offen lds
    s_add_u32 m0, s70, 35840
    s_mul_i32 s73, s52, 64
    s_add_u32 s73, s73, 98304
    buffer_load_dwordx4 v214, s[24:27], s73 offen lds
    v_and_b32 v27, s91, v229
    v_lshlrev_b32 v210, 16, v245
    v_and_b32 v211, s91, v245
    v_add_f32 v26, v26, v210
    v_add_f32 v27, v27, v211
    v_mul_f32 v26, s60, v26
    buffer_load_dwordx4 v[188:191], v5, s[40:43], s56 offen offset:3072 sc1
    v_mfma_f32_32x32x16_bf16 v[48:63], a[16:19], v[152:155], v[48:63]
    v_mfma_f32_32x32x16_bf16 v[64:79], a[20:23], v[152:155], v[64:79]
    s_add_u32 m0, s70, 12288
    s_mul_i32 s73, s52, 64
    s_add_u32 s73, s73, 131072
    buffer_load_dwordx4 v214, s[24:27], s73 offen lds
    s_add_u32 m0, s70, 13312
    s_mul_i32 s73, s52, 64
    s_add_u32 s73, s73, 163840
    buffer_load_dwordx4 v214, s[24:27], s73 offen lds
    v_mul_f32 v27, s60, v27
    v_lshlrev_b32 v28, 16, v230
    v_and_b32 v29, s91, v230
    v_lshlrev_b32 v208, 16, v246
    v_and_b32 v209, s91, v246
    v_add_f32 v28, v28, v208
    buffer_load_dword v248, v12, s[40:43], s85 offen offset:0 sc1
    s_add_u32 s56, s72, s101
    buffer_load_dwordx4 v[192:195], v5, s[40:43], s56 offen offset:0 sc1
    s_waitcnt vmcnt(25)
    v_mfma_f32_32x32x16_bf16 v[48:63], a[24:27], v[156:159], v[48:63]
    v_mfma_f32_32x32x16_bf16 v[64:79], a[28:31], v[156:159], v[64:79]
    s_add_u32 m0, s70, 14336
    s_mul_i32 s73, s52, 64
    s_add_u32 s73, s73, 196608
    buffer_load_dwordx4 v214, s[24:27], s73 offen lds
    s_add_u32 m0, s70, 15360
    s_mul_i32 s73, s52, 64
    s_add_u32 s73, s73, 229376
    buffer_load_dwordx4 v214, s[24:27], s73 offen lds
    v_add_f32 v29, v29, v209
    v_mul_f32 v28, s60, v28
    v_mul_f32 v29, s60, v29
    v_lshlrev_b32 v30, 16, v231
    v_and_b32 v31, s91, v231
    v_lshlrev_b32 v210, 16, v247
    buffer_load_dwordx4 v[196:199], v5, s[40:43], s56 offen offset:1024 sc1
    s_waitcnt vmcnt(27)
    v_mfma_f32_32x32x16_bf16 v[48:63], a[32:35], v[160:163], v[48:63]
    v_mfma_f32_32x32x16_bf16 v[64:79], a[36:39], v[160:163], v[64:79]
    s_waitcnt vmcnt(24)
    ds_read_b64_tr_b16 a[224:225], v217 offset:24576
    ds_read_b64_tr_b16 a[226:227], v217 offset:25600
    ds_read_b64_tr_b16 a[228:229], v218 offset:24576
    ds_read_b64_tr_b16 a[230:231], v218 offset:25600
    v_and_b32 v211, s91, v247
    v_add_f32 v30, v30, v210
    v_add_f32 v31, v31, v211
    v_mul_f32 v30, s60, v30
    v_mul_f32 v31, s60, v31
    buffer_load_dwordx4 v[200:203], v5, s[40:43], s56 offen offset:2048 sc1
    v_mfma_f32_32x32x16_bf16 v[48:63], a[40:43], v[164:167], v[48:63]
    v_mfma_f32_32x32x16_bf16 v[64:79], a[44:47], v[164:167], v[64:79]
    s_waitcnt vmcnt(21)
    ds_read_b64_tr_b16 a[232:233], v217 offset:26624
    ds_read_b64_tr_b16 a[234:235], v217 offset:27648
    ds_read_b64_tr_b16 a[236:237], v218 offset:26624
    ds_read_b64_tr_b16 a[238:239], v218 offset:27648
    buffer_load_dwordx4 v[204:207], v5, s[40:43], s56 offen offset:3072 sc1
    v_mfma_f32_32x32x16_bf16 v[48:63], a[48:51], v[168:171], v[48:63]
    v_mfma_f32_32x32x16_bf16 v[64:79], a[52:55], v[168:171], v[64:79]
    s_waitcnt vmcnt(19)
    ds_read_b64_tr_b16 a[240:241], v217 offset:28672
    ds_read_b64_tr_b16 a[242:243], v217 offset:29696
    ds_read_b64_tr_b16 a[244:245], v218 offset:28672
    ds_read_b64_tr_b16 a[246:247], v218 offset:29696
    s_waitcnt vmcnt(6)
    v_cmp_ne_u32 vcc, s4, v248
    s_nop 1
    s_cbranch_vccz Lpcd_P_11
    s_nop 1
Lpc_P_10:
    s_sub_u32 s6, s6, 1
    s_cbranch_scc1 L_end_P
    buffer_load_dword v248, v12, s[40:43], s85 offen offset:0 sc1
    s_waitcnt vmcnt(0)
    v_cmp_ne_u32 vcc, s4, v248
    s_nop 1
    s_cbranch_vccnz Lpc_P_10
Lpcd_P_11:
    s_add_u32 s56, s58, s48
    buffer_load_dwordx4 v[80:83], v4, s[40:43], s56 offen offset:0 sc1
    v_mfma_f32_32x32x16_bf16 v[48:63], a[56:59], v[172:175], v[48:63]
    v_mfma_f32_32x32x16_bf16 v[64:79], a[60:63], v[172:175], v[64:79]
    ds_read_b64_tr_b16 a[248:249], v217 offset:30720
    ds_read_b64_tr_b16 a[250:251], v217 offset:31744
    ds_read_b64_tr_b16 a[252:253], v218 offset:30720
    ds_read_b64_tr_b16 a[254:255], v218 offset:31744
    buffer_load_dwordx4 v[84:87], v4, s[40:43], s56 offen offset:1024 sc1
    v_mfma_f32_32x32x16_bf16 v[48:63], a[64:67], v[176:179], v[48:63]
    v_mfma_f32_32x32x16_bf16 v[64:79], a[68:71], v[176:179], v[64:79]
    ds_read_b64_tr_b16 a[0:1], v217 offset:32768
    ds_read_b64_tr_b16 a[2:3], v217 offset:33792
    ds_read_b64_tr_b16 a[4:5], v218 offset:32768
    ds_read_b64_tr_b16 a[6:7], v218 offset:33792
    buffer_load_dwordx4 v[88:91], v4, s[40:43], s56 offen offset:2048 sc1
    v_mfma_f32_32x32x16_bf16 v[48:63], a[72:75], v[180:183], v[48:63]
    v_mfma_f32_32x32x16_bf16 v[64:79], a[76:79], v[180:183], v[64:79]
    ds_read_b64_tr_b16 a[8:9], v217 offset:34816
    ds_read_b64_tr_b16 a[10:11], v217 offset:35840
    ds_read_b64_tr_b16 a[12:13], v218 offset:34816
    ds_read_b64_tr_b16 a[14:15], v218 offset:35840
    buffer_load_dwordx4 v[92:95], v4, s[40:43], s56 offen offset:3072 sc1
    v_mfma_f32_32x32x16_bf16 v[48:63], a[80:83], v[184:187], v[48:63]
    v_mfma_f32_32x32x16_bf16 v[64:79], a[84:87], v[184:187], v[64:79]
    ds_read_b64_tr_b16 a[16:17], v217 offset:12288
    ds_read_b64_tr_b16 a[18:19], v217 offset:13312
    ds_read_b64_tr_b16 a[20:21], v218 offset:12288
    ds_read_b64_tr_b16 a[22:23], v218 offset:13312
    s_add_u32 s56, s58, s49
    buffer_load_dwordx4 v[96:99], v4, s[40:43], s56 offen offset:0 sc1
    v_mfma_f32_32x32x16_bf16 v[48:63], a[88:91], v[188:191], v[48:63]
    v_mfma_f32_32x32x16_bf16 v[64:79], a[92:95], v[188:191], v[64:79]
    s_waitcnt vmcnt(8)
    ds_read_b64_tr_b16 a[24:25], v217 offset:14336
    ds_read_b64_tr_b16 a[26:27], v217 offset:15360
    ds_read_b64_tr_b16 a[28:29], v218 offset:14336
    ds_read_b64_tr_b16 a[30:31], v218 offset:15360
    buffer_load_dwordx4 v[100:103], v4, s[40:43], s56 offen offset:1024 sc1
    buffer_load_dwordx4 v[104:107], v4, s[40:43], s56 offen offset:2048 sc1
    buffer_load_dwordx4 v[108:111], v4, s[40:43], s56 offen offset:3072 sc1
    s_add_u32 s56, s58, s50
    buffer_load_dwordx4 v[112:115], v4, s[40:43], s56 offen offset:0 sc1
    v_mfma_f32_32x32x16_bf16 v[64:79], a[100:103], v[192:195], v[64:79]
    s_waitcnt vmcnt(11)
    v_mfma_f32_32x32x16_bf16 v[64:79], a[108:111], v[196:199], v[64:79]
    s_waitcnt vmcnt(10)
    v_mfma_f32_32x32x16_bf16 v[64:79], a[116:119], v[200:203], v[64:79]
    s_waitcnt vmcnt(9)
    v_mfma_f32_32x32x16_bf16 v[64:79], a[124:127], v[204:207], v[64:79]
    v_mfma_f32_32x32x16_bf16 v[48:63], a[96:99], v[192:195], v[48:63]
    v_mfma_f32_32x32x16_bf16 v[48:63], a[104:107], v[196:199], v[48:63]
    s_nop 9
    ds_write_b128 v235, v[72:75] offset:6144
    ds_write_b128 v235, v[76:79] offset:7168
    v_mfma_f32_32x32x16_bf16 v[48:63], a[112:115], v[200:203], v[48:63]
    ds_write_b128 v234, v[64:67] offset:6144
    ds_write_b128 v234, v[68:71] offset:7168
    v_mfma_f32_32x32x16_bf16 v[48:63], a[120:123], v[204:207], v[48:63]
    s_nop 11
    ds_write_b128 v233, v[56:59] offset:6144
    ds_write_b128 v233, v[60:63] offset:7168
    s_waitcnt lgkmcnt(0)
    s_barrier
    ds_read_b128 v[56:59], v232 offset:6144
    ds_read_b128 v[64:67], v232 offset:8192
    ds_read_b128 v[72:75], v232 offset:10240
    ds_read_b128 v[60:63], v232 offset:7168
    ds_read_b128 v[68:71], v232 offset:9216
    ds_read_b128 v[76:79], v232 offset:11264
    v_mov_b32 v211, s88
    s_waitcnt lgkmcnt(4)
    v_pk_add_f32 v[56:57], v[56:57], v[64:65]
    s_waitcnt lgkmcnt(3)
    v_pk_add_f32 v[48:49], v[48:49], v[72:73]
    v_pk_add_f32 v[58:59], v[58:59], v[66:67]
    v_pk_add_f32 v[50:51], v[50:51], v[74:75]
    s_waitcnt lgkmcnt(1)
    v_pk_add_f32 v[60:61], v[60:61], v[68:69]
    s_waitcnt lgkmcnt(0)
    v_pk_add_f32 v[52:53], v[52:53], v[76:77]
    v_pk_add_f32 v[62:63], v[62:63], v[70:71]
    v_pk_add_f32 v[54:55], v[54:55], v[78:79]
    v_pk_add_f32 v[48:49], v[48:49], v[56:57]
    v_pk_add_f32 v[50:51], v[50:51], v[58:59]
    v_pk_add_f32 v[52:53], v[52:53], v[60:61]
    v_pk_add_f32 v[54:55], v[54:55], v[62:63]
    v_pk_mul_f32 v[56:57], v[48:49], v[48:49]
    v_pk_mul_f32 v[58:59], v[50:51], v[50:51]
    v_pk_mul_f32 v[60:61], v[52:53], v[52:53]
    v_pk_mul_f32 v[62:63], v[54:55], v[54:55]
    v_fma_f32 v56, v56, s90, v211
    v_fma_f32 v57, v57, s90, v211
    v_fma_f32 v58, v58, s90, v211
    v_fma_f32 v59, v59, s90, v211
    v_fma_f32 v60, v60, s90, v211
    v_fma_f32 v61, v61, s90, v211
    v_fma_f32 v62, v62, s90, v211
    v_fma_f32 v63, v63, s90, v211
    v_pk_mul_f32 v[56:57], v[56:57], v[48:49]
    v_pk_mul_f32 v[58:59], v[58:59], v[50:51]
    v_pk_mul_f32 v[60:61], v[60:61], v[52:53]
    v_pk_mul_f32 v[62:63], v[62:63], v[54:55]
    v_exp_f32 v56, v56
    v_exp_f32 v57, v57
    v_exp_f32 v58, v58
    v_exp_f32 v59, v59
    v_exp_f32 v60, v60
    v_exp_f32 v61, v61
    v_exp_f32 v62, v62
    v_exp_f32 v63, v63
    v_add_f32 v56, 1.0, v56
    v_add_f32 v57, 1.0, v57
    v_add_f32 v58, 1.0, v58
    v_add_f32 v59, 1.0, v59
    v_add_f32 v60, 1.0, v60
    v_add_f32 v61, 1.0, v61
    v_add_f32 v62, 1.0, v62
    v_add_f32 v63, 1.0, v63
    v_rcp_f32 v56, v56
    v_rcp_f32 v57, v57
    v_rcp_f32 v58, v58
    v_rcp_f32 v59, v59
    v_rcp_f32 v60, v60
    v_rcp_f32 v61, v61
    v_rcp_f32 v62, v62
    v_rcp_f32 v63, v63
    v_mul_f32 v56, v56, v48
    v_mul_f32 v57, v57, v49
    v_mul_f32 v58, v58, v50
    v_mul_f32 v59, v59, v51
    v_mul_f32 v60, v60, v52
    v_mul_f32 v61, v61, v53
    v_mul_f32 v62, v62, v54
    v_mul_f32 v63, v63, v55
    v_cvt_pk_bf16_f32 v64, v56, v57
    v_cvt_pk_bf16_f32 v65, v58, v59
    v_cvt_pk_bf16_f32 v66, v60, v61
    v_cvt_pk_bf16_f32 v67, v62, v63
    s_add_u32 s57, s57, 114688
    buffer_store_dwordx4 v[64:67], v5, s[40:43], s57 offen sc1
    s_add_u32 s82, s82, 4096
    s_add_u32 s85, s85, 4096
    buffer_load_dwordx4 v[116:119], v4, s[40:43], s56 offen offset:1024 sc1
    s_waitcnt vmcnt(10)
    v_mfma_f32_32x32x16_bf16 v[16:31], a[128:131], v[80:83], v[16:31]
    v_mfma_f32_32x32x16_bf16 v[32:47], a[132:135], v[80:83], 0
    s_add_u32 m0, s70, 16384
    s_mul_i32 s73, s53, 64
    s_add_u32 s73, s73, 0
    buffer_load_dwordx4 v214, s[24:27], s73 offen lds
    s_add_u32 m0, s70, 17408
    s_mul_i32 s73, s53, 64
    s_add_u32 s73, s73, 32768
    buffer_load_dwordx4 v214, s[24:27], s73 offen lds
    buffer_load_dwordx4 v[120:123], v4, s[40:43], s56 offen offset:2048 sc1
    s_waitcnt vmcnt(12)
    v_mfma_f32_32x32x16_bf16 v[16:31], a[136:139], v[84:87], v[16:31]
    v_mfma_f32_32x32x16_bf16 v[32:47], a[140:143], v[84:87], v[32:47]
    s_add_u32 m0, s70, 18432
    s_mul_i32 s73, s53, 64
    s_add_u32 s73, s73, 65536
    buffer_load_dwordx4 v214, s[24:27], s73 offen lds
    s_add_u32 m0, s70, 19456
    s_mul_i32 s73, s53, 64
    s_add_u32 s73, s73, 98304
    buffer_load_dwordx4 v214, s[24:27], s73 offen lds
    buffer_load_dwordx4 v[124:127], v4, s[40:43], s56 offen offset:3072 sc1
    s_waitcnt vmcnt(14)
    v_mfma_f32_32x32x16_bf16 v[16:31], a[144:147], v[88:91], v[16:31]
    v_mfma_f32_32x32x16_bf16 v[32:47], a[148:151], v[88:91], v[32:47]
    s_add_u32 m0, s70, 20480
    s_mul_i32 s73, s53, 64
    s_add_u32 s73, s73, 131072
    buffer_load_dwordx4 v214, s[24:27], s73 offen lds
    s_add_u32 m0, s70, 21504
    s_mul_i32 s73, s53, 64
    s_add_u32 s73, s73, 163840
    buffer_load_dwordx4 v214, s[24:27], s73 offen lds
    s_add_u32 s56, s58, s51
    buffer_load_dwordx4 v[128:131], v4, s[40:43], s56 offen offset:0 sc1
    s_waitcnt vmcnt(16)
    v_mfma_f32_32x32x16_bf16 v[16:31], a[152:155], v[92:95], v[16:31]
    v_mfma_f32_32x32x16_bf16 v[32:47], a[156:159], v[92:95], v[32:47]
    s_add_u32 m0, s70, 22528
    s_mul_i32 s73, s53, 64
    s_add_u32 s73, s73, 196608
    buffer_load_dwordx4 v214, s[24:27], s73 offen lds
    s_add_u32 m0, s70, 23552
    s_mul_i32 s73, s53, 64
    s_add_u32 s73, s73, 229376
    buffer_load_dwordx4 v214, s[24:27], s73 offen lds
    buffer_load_dwordx4 v[132:135], v4, s[40:43], s56 offen offset:1024 sc1
    s_waitcnt vmcnt(18)
    v_mfma_f32_32x32x16_bf16 v[16:31], a[160:163], v[96:99], v[16:31]
    v_mfma_f32_32x32x16_bf16 v[32:47], a[164:167], v[96:99], v[32:47]
    s_add_u32 m0, s70, 24576
    s_mul_i32 s73, s54, 64
    s_add_u32 s73, s73, 0
    buffer_load_dwordx4 v214, s[24:27], s73 offen lds
    s_add_u32 m0, s70, 25600
    s_mul_i32 s73, s54, 64
    s_add_u32 s73, s73, 32768
    buffer_load_dwordx4 v214, s[24:27], s73 offen lds
    s_waitcnt vmcnt(15)
    v_mov_b32 v8, s4
    s_mov_b64 exec, 1
    buffer_store_dword v8, v9, s[40:43], s82 offen sc1
    s_mov_b64 exec, -1
    buffer_load_dwordx4 v[136:139], v4, s[40:43], s56 offen offset:2048 sc1
    v_mfma_f32_32x32x16_bf16 v[16:31], a[168:171], v[100:103], v[16:31]
    v_mfma_f32_32x32x16_bf16 v[32:47], a[172:175], v[100:103], v[32:47]
    s_add_u32 m0, s70, 26624
    s_mul_i32 s73, s54, 64
    s_add_u32 s73, s73, 65536
    buffer_load_dwordx4 v214, s[24:27], s73 offen lds
    s_add_u32 m0, s70, 27648
    s_mul_i32 s73, s54, 64
    s_add_u32 s73, s73, 98304
    buffer_load_dwordx4 v214, s[24:27], s73 offen lds
    buffer_load_dwordx4 v[140:143], v4, s[40:43], s56 offen offset:3072 sc1
    v_mfma_f32_32x32x16_bf16 v[16:31], a[176:179], v[104:107], v[16:31]
    v_mfma_f32_32x32x16_bf16 v[32:47], a[180:183], v[104:107], v[32:47]
    s_add_u32 m0, s70, 28672
    s_mul_i32 s73, s54, 64
    s_add_u32 s73, s73, 131072
    buffer_load_dwordx4 v214, s[24:27], s73 offen lds
    s_add_u32 m0, s70, 29696
    s_mul_i32 s73, s54, 64
    s_add_u32 s73, s73, 163840
    buffer_load_dwordx4 v214, s[24:27], s73 offen lds
    s_and_b32 s60, s3, 1
    s_cmp_eq_u32 s60, 1
    s_cselect_b32 s60, 1.0, 0
    v_lshlrev_b32 v48, 16, v224
    v_and_b32 v49, s91, v224
    v_lshlrev_b32 v208, 16, v240
    v_and_b32 v209, s91, v240
    v_add_f32 v48, v48, v208
    s_add_u32 s56, s58, s52
    buffer_load_dwordx4 v[144:147], v4, s[40:43], s56 offen offset:0 sc1
    v_mfma_f32_32x32x16_bf16 v[16:31], a[184:187], v[108:111], v[16:31]
    v_mfma_f32_32x32x16_bf16 v[32:47], a[188:191], v[108:111], v[32:47]
    s_add_u32 m0, s70, 30720
    s_mul_i32 s73, s54, 64
    s_add_u32 s73, s73, 196608
    buffer_load_dwordx4 v214, s[24:27], s73 offen lds
    s_add_u32 m0, s70, 31744
    s_mul_i32 s73, s54, 64
    s_add_u32 s73, s73, 229376
    buffer_load_dwordx4 v214, s[24:27], s73 offen lds
    v_add_f32 v49, v49, v209
    v_mul_f32 v48, s60, v48
    v_mul_f32 v49, s60, v49
    v_lshlrev_b32 v50, 16, v225
    v_and_b32 v51, s91, v225
    v_lshlrev_b32 v210, 16, v241
    buffer_load_dwordx4 v[148:151], v4, s[40:43], s56 offen offset:1024 sc1
    v_mfma_f32_32x32x16_bf16 v[16:31], a[192:195], v[112:115], v[16:31]
    v_mfma_f32_32x32x16_bf16 v[32:47], a[196:199], v[112:115], v[32:47]
    s_waitcnt vmcnt(23)
    ds_read_b64_tr_b16 a[32:33], v217 offset:16384
    ds_read_b64_tr_b16 a[34:35], v217 offset:17408
    ds_read_b64_tr_b16 a[36:37], v218 offset:16384
    ds_read_b64_tr_b16 a[38:39], v218 offset:17408
    v_and_b32 v211, s91, v241
    v_add_f32 v50, v50, v210
    v_add_f32 v51, v51, v211
    v_mul_f32 v50, s60, v50
    v_mul_f32 v51, s60, v51
    v_lshlrev_b32 v52, 16, v226
    buffer_load_dwordx4 v[152:155], v4, s[40:43], s56 offen offset:2048 sc1
    v_mfma_f32_32x32x16_bf16 v[16:31], a[200:203], v[116:119], v[16:31]
    v_mfma_f32_32x32x16_bf16 v[32:47], a[204:207], v[116:119], v[32:47]
    s_waitcnt vmcnt(21)
    ds_read_b64_tr_b16 a[40:41], v217 offset:18432
    ds_read_b64_tr_b16 a[42:43], v217 offset:19456
    ds_read_b64_tr_b16 a[44:45], v218 offset:18432
    ds_read_b64_tr_b16 a[46:47], v218 offset:19456
    v_and_b32 v53, s91, v226
    v_lshlrev_b32 v208, 16, v242
    v_and_b32 v209, s91, v242
    v_add_f32 v52, v52, v208
    v_add_f32 v53, v53, v209
    v_mul_f32 v52, s60, v52
    buffer_load_dwordx4 v[156:159], v4, s[40:43], s56 offen offset:3072 sc1
    v_mfma_f32_32x32x16_bf16 v[16:31], a[208:211], v[120:123], v[16:31]
    v_mfma_f32_32x32x16_bf16 v[32:47], a[212:215], v[120:123], v[32:47]
    s_waitcnt vmcnt(19)
    ds_read_b64_tr_b16 a[48:49], v217 offset:20480
    ds_read_b64_tr_b16 a[50:51], v217 offset:21504
    ds_read_b64_tr_b16 a[52:53], v218 offset:20480
    ds_read_b64_tr_b16 a[54:55], v218 offset:21504
    v_mul_f32 v53, s60, v53
    v_lshlrev_b32 v54, 16, v227
    v_and_b32 v55, s91, v227
    v_lshlrev_b32 v210, 16, v243
    v_and_b32 v211, s91, v243
    v_add_f32 v54, v54, v210
    s_add_u32 s56, s58, s53
    buffer_load_dwordx4 v[160:163], v4, s[40:43], s56 offen offset:0 sc1
    v_mfma_f32_32x32x16_bf16 v[16:31], a[216:219], v[124:127], v[16:31]
    v_mfma_f32_32x32x16_bf16 v[32:47], a[220:223], v[124:127], v[32:47]
    s_waitcnt vmcnt(17)
    ds_read_b64_tr_b16 a[56:57], v217 offset:22528
    ds_read_b64_tr_b16 a[58:59], v217 offset:23552
    ds_read_b64_tr_b16 a[60:61], v218 offset:22528
    ds_read_b64_tr_b16 a[62:63], v218 offset:23552
    v_add_f32 v55, v55, v211
    v_mul_f32 v54, s60, v54
    v_mul_f32 v55, s60, v55
    v_lshlrev_b32 v56, 16, v228
    v_and_b32 v57, s91, v228
    v_lshlrev_b32 v208, 16, v244
    buffer_load_dwordx4 v[164:167], v4, s[40:43], s56 offen offset:1024 sc1
    v_mfma_f32_32x32x16_bf16 v[16:31], a[224:227], v[128:131], v[16:31]
    v_mfma_f32_32x32x16_bf16 v[32:47], a[228:231], v[128:131], v[32:47]
    s_waitcnt vmcnt(15)
    ds_read_b64_tr_b16 a[64:65], v217 offset:24576
    ds_read_b64_tr_b16 a[66:67], v217 offset:25600
    ds_read_b64_tr_b16 a[68:69], v218 offset:24576
    ds_read_b64_tr_b16 a[70:71], v218 offset:25600
    v_and_b32 v209, s91, v244
    v_add_f32 v56, v56, v208
    v_add_f32 v57, v57, v209
    v_mul_f32 v56, s60, v56
    v_mul_f32 v57, s60, v57
    v_lshlrev_b32 v58, 16, v229
    buffer_load_dword v248, v12, s[40:43], s85 offen offset:0 sc1
    buffer_load_dwordx4 v[168:171], v4, s[40:43], s56 offen offset:2048 sc1
    v_mfma_f32_32x32x16_bf16 v[16:31], a[232:235], v[132:135], v[16:31]
    v_mfma_f32_32x32x16_bf16 v[32:47], a[236:239], v[132:135], v[32:47]
    s_waitcnt vmcnt(13)
    ds_read_b64_tr_b16 a[72:73], v217 offset:26624
    ds_read_b64_tr_b16 a[74:75], v217 offset:27648
    ds_read_b64_tr_b16 a[76:77], v218 offset:26624
    ds_read_b64_tr_b16 a[78:79], v218 offset:27648
    v_and_b32 v59, s91, v229
    v_lshlrev_b32 v210, 16, v245
    v_and_b32 v211, s91, v245
    v_add_f32 v58, v58, v210
    v_add_f32 v59, v59, v211
    v_mul_f32 v58, s60, v58
    buffer_load_dwordx4 v[172:175], v4, s[40:43], s56 offen offset:3072 sc1
    v_mfma_f32_32x32x16_bf16 v[16:31], a[240:243], v[136:139], v[16:31]
    v_mfma_f32_32x32x16_bf16 v[32:47], a[244:247], v[136:139], v[32:47]
    s_waitcnt vmcnt(11)
    ds_read_b64_tr_b16 a[80:81], v217 offset:28672
    ds_read_b64_tr_b16 a[82:83], v217 offset:29696
    ds_read_b64_tr_b16 a[84:85], v218 offset:28672
    ds_read_b64_tr_b16 a[86:87], v218 offset:29696
    v_mul_f32 v59, s60, v59
    v_lshlrev_b32 v60, 16, v230
    v_and_b32 v61, s91, v230
    v_lshlrev_b32 v208, 16, v246
    v_and_b32 v209, s91, v246
    v_add_f32 v60, v60, v208
    s_add_u32 s56, s58, s54
    buffer_load_dwordx4 v[176:179], v4, s[40:43], s56 offen offset:0 sc1
    v_mfma_f32_32x32x16_bf16 v[16:31], a[248:251], v[140:143], v[16:31]
    v_mfma_f32_32x32x16_bf16 v[32:47], a[252:255], v[140:143], v[32:47]
    s_waitcnt vmcnt(9)
    ds_read_b64_tr_b16 a[88:89], v217 offset:30720
    ds_read_b64_tr_b16 a[90:91], v217 offset:31744
    ds_read_b64_tr_b16 a[92:93], v218 offset:30720
    ds_read_b64_tr_b16 a[94:95], v218 offset:31744
    v_add_f32 v61, v61, v209
    v_mul_f32 v60, s60, v60
    v_mul_f32 v61, s60, v61
    v_lshlrev_b32 v62, 16, v231
    v_and_b32 v63, s91, v231
    v_lshlrev_b32 v210, 16, v247
    buffer_load_dwordx4 v[180:183], v4, s[40:43], s56 offen offset:1024 sc1
    v_mfma_f32_32x32x16_bf16 v[16:31], a[0:3], v[144:147], v[16:31]
    v_mfma_f32_32x32x16_bf16 v[32:47], a[4:7], v[144:147], v[32:47]
    v_and_b32 v211, s91, v247
    v_add_f32 v62, v62, v210
    v_add_f32 v63, v63, v211
    v_mul_f32 v62, s60, v62
    v_mul_f32 v63, s60, v63
    s_waitcnt vmcnt(4)
    v_cmp_ne_u32 vcc, s4, v248
    s_nop 1
    s_cbranch_vccz Lpcd_P_13
    s_nop 1
Lpc_P_12:
    s_sub_u32 s6, s6, 1
    s_cbranch_scc1 L_end_P
    buffer_load_dword v248, v12, s[40:43], s85 offen offset:0 sc1
    s_waitcnt vmcnt(0)
    v_cmp_ne_u32 vcc, s4, v248
    s_nop 1
    s_cbranch_vccnz Lpc_P_12
Lpcd_P_13:
    buffer_load_dwordx4 v[184:187], v4, s[40:43], s56 offen offset:2048 sc1
    v_mfma_f32_32x32x16_bf16 v[16:31], a[8:11], v[148:151], v[16:31]
    v_mfma_f32_32x32x16_bf16 v[32:47], a[12:15], v[148:151], v[32:47]
    buffer_load_dwordx4 v[188:191], v4, s[40:43], s56 offen offset:3072 sc1
    v_mfma_f32_32x32x16_bf16 v[16:31], a[16:19], v[152:155], v[16:31]
    v_mfma_f32_32x32x16_bf16 v[32:47], a[20:23], v[152:155], v[32:47]
    s_add_u32 s56, s59, s48
    buffer_load_dwordx4 v[192:195], v4, s[40:43], s56 offen offset:0 sc1
    v_mfma_f32_32x32x16_bf16 v[16:31], a[24:27], v[156:159], v[16:31]
    v_mfma_f32_32x32x16_bf16 v[32:47], a[28:31], v[156:159], v[32:47]
    buffer_load_dwordx4 v[196:199], v4, s[40:43], s56 offen offset:1024 sc1
    s_waitcnt lgkmcnt(15)
    v_mfma_f32_32x32x16_bf16 v[16:31], a[32:35], v[160:163], v[16:31]
    v_mfma_f32_32x32x16_bf16 v[32:47], a[36:39], v[160:163], v[32:47]
    buffer_load_dwordx4 v[200:203], v4, s[40:43], s56 offen offset:2048 sc1
    v_mfma_f32_32x32x16_bf16 v[16:31], a[40:43], v[164:167], v[16:31]
    v_mfma_f32_32x32x16_bf16 v[32:47], a[44:47], v[164:167], v[32:47]
    buffer_load_dwordx4 v[204:207], v4, s[40:43], s56 offen offset:3072 sc1
    s_waitcnt vmcnt(9)
    v_mfma_f32_32x32x16_bf16 v[16:31], a[48:51], v[168:171], v[16:31]
    v_mfma_f32_32x32x16_bf16 v[32:47], a[52:55], v[168:171], v[32:47]
    s_add_u32 s56, s59, s49
    buffer_load_dwordx4 v[80:83], v4, s[40:43], s56 offen offset:0 sc1
    s_waitcnt vmcnt(9)
    v_mfma_f32_32x32x16_bf16 v[16:31], a[56:59], v[172:175], v[16:31]
    v_mfma_f32_32x32x16_bf16 v[32:47], a[60:63], v[172:175], v[32:47]
    buffer_load_dwordx4 v[84:87], v4, s[40:43], s56 offen offset:1024 sc1
    s_waitcnt vmcnt(9) lgkmcnt(14)
    v_mfma_f32_32x32x16_bf16 v[16:31], a[64:67], v[176:179], v[16:31]
    s_waitcnt lgkmcnt(12)
    v_mfma_f32_32x32x16_bf16 v[32:47], a[68:71], v[176:179], v[32:47]
    buffer_load_dwordx4 v[88:91], v4, s[40:43], s56 offen offset:2048 sc1
    s_waitcnt vmcnt(9) lgkmcnt(10)
    v_mfma_f32_32x32x16_bf16 v[16:31], a[72:75], v[180:183], v[16:31]
    s_waitcnt lgkmcnt(8)
    v_mfma_f32_32x32x16_bf16 v[32:47], a[76:79], v[180:183], v[32:47]
    buffer_load_dwordx4 v[92:95], v4, s[40:43], s56 offen offset:3072 sc1
    s_waitcnt vmcnt(9) lgkmcnt(6)
    v_mfma_f32_32x32x16_bf16 v[16:31], a[80:83], v[184:187], v[16:31]
    s_waitcnt lgkmcnt(4)
    v_mfma_f32_32x32x16_bf16 v[32:47], a[84:87], v[184:187], v[32:47]
    s_add_u32 s56, s59, s50
    buffer_load_dwordx4 v[96:99], v4, s[40:43], s56 offen offset:0 sc1
    s_waitcnt vmcnt(9) lgkmcnt(2)
    v_mfma_f32_32x32x16_bf16 v[16:31], a[88:91], v[188:191], v[16:31]
    s_waitcnt lgkmcnt(0)
    v_mfma_f32_32x32x16_bf16 v[32:47], a[92:95], v[188:191], v[32:47]
    buffer_load_dwordx4 v[100:103], v4, s[40:43], s56 offen offset:1024 sc1
    s_waitcnt vmcnt(9)
    v_mfma_f32_32x32x16_bf16 v[48:63], a[128:131], v[192:195], v[48:63]
    v_mfma_f32_32x32x16_bf16 v[64:79], a[132:135], v[192:195], 0
    s_nop 7
    ds_write_b32 v237, v32 offset:0
    ds_write_b32 v237, v34 offset:256
    ds_write_b32 v237, v33 offset:128
    ds_write_b32 v237, v35 offset:384
    ds_write_b32 v237, v36 offset:1024
    ds_write_b32 v237, v38 offset:1280
    buffer_load_dwordx4 v[104:107], v4, s[40:43], s56 offen offset:2048 sc1
    s_waitcnt vmcnt(9)
    v_mfma_f32_32x32x16_bf16 v[48:63], a[136:139], v[196:199], v[48:63]
    v_mfma_f32_32x32x16_bf16 v[64:79], a[140:143], v[196:199], v[64:79]
    ds_write_b32 v237, v37 offset:1152
    ds_write_b32 v237, v39 offset:1408
    ds_write_b32 v237, v40 offset:2048
    ds_write_b32 v237, v42 offset:2304
    ds_write_b32 v237, v41 offset:2176
    ds_write_b32 v237, v43 offset:2432
    buffer_load_dwordx4 v[108:111], v4, s[40:43], s56 offen offset:3072 sc1
    s_waitcnt vmcnt(9)
    v_mfma_f32_32x32x16_bf16 v[48:63], a[144:147], v[200:203], v[48:63]
    v_mfma_f32_32x32x16_bf16 v[64:79], a[148:151], v[200:203], v[64:79]
    ds_write_b32 v237, v44 offset:3072
    ds_write_b32 v237, v46 offset:3328
    ds_write_b32 v237, v45 offset:3200
    ds_write_b32 v237, v47 offset:3456
    ds_write_b32 v236, v16 offset:0
    ds_write_b32 v236, v18 offset:256
    s_add_u32 s56, s59, s51
    buffer_load_dwordx4 v[112:115], v4, s[40:43], s56 offen offset:0 sc1
    s_waitcnt vmcnt(9)
    v_mfma_f32_32x32x16_bf16 v[48:63], a[152:155], v[204:207], v[48:63]
    v_mfma_f32_32x32x16_bf16 v[64:79], a[156:159], v[204:207], v[64:79]
    ds_write_b32 v236, v17 offset:128
    ds_write_b32 v236, v19 offset:384
    ds_write_b32 v236, v20 offset:1024
    ds_write_b32 v236, v22 offset:1280
    ds_write_b32 v236, v21 offset:1152
    ds_write_b32 v236, v23 offset:1408
    buffer_load_dwordx4 v[116:119], v4, s[40:43], s56 offen offset:1024 sc1
    s_waitcnt vmcnt(9)
    v_mfma_f32_32x32x16_bf16 v[48:63], a[160:163], v[80:83], v[48:63]
    v_mfma_f32_32x32x16_bf16 v[64:79], a[164:167], v[80:83], v[64:79]
    ds_write_b32 v236, v24 offset:2048
    ds_write_b32 v236, v26 offset:2304
    ds_write_b32 v236, v25 offset:2176
    ds_write_b32 v236, v27 offset:2432
    ds_write_b32 v236, v28 offset:3072
    ds_write_b32 v236, v30 offset:3328
    buffer_load_dwordx4 v[120:123], v4, s[40:43], s56 offen offset:2048 sc1
    s_waitcnt vmcnt(9)
    v_mfma_f32_32x32x16_bf16 v[48:63], a[168:171], v[84:87], v[48:63]
    v_mfma_f32_32x32x16_bf16 v[64:79], a[172:175], v[84:87], v[64:79]
    ds_write_b32 v236, v29 offset:3200
    ds_write_b32 v236, v31 offset:3456
    buffer_load_dwordx4 v[124:127], v4, s[40:43], s56 offen offset:3072 sc1
    s_waitcnt vmcnt(9)
    v_mfma_f32_32x32x16_bf16 v[48:63], a[176:179], v[88:91], v[48:63]
    v_mfma_f32_32x32x16_bf16 v[64:79], a[180:183], v[88:91], v[64:79]
    s_add_u32 s56, s59, s52
    buffer_load_dwordx4 v[128:131], v4, s[40:43], s56 offen offset:0 sc1
    s_waitcnt vmcnt(9)
    v_mfma_f32_32x32x16_bf16 v[48:63], a[184:187], v[92:95], v[48:63]
    v_mfma_f32_32x32x16_bf16 v[64:79], a[188:191], v[92:95], v[64:79]
    s_waitcnt lgkmcnt(0)
    s_barrier
    ds_read_b128 v[16:19], v238 offset:0
    ds_read_b128 v[20:23], v238 offset:36864
    ds_read_b128 v[24:27], v239 offset:0
    ds_read_b128 v[28:31], v239 offset:36864
    ds_read_b128 v[32:35], v238 offset:1024
    ds_read_b128 v[36:39], v238 offset:37888
    ds_read_b128 v[40:43], v239 offset:1024
    ds_read_b128 v[44:47], v239 offset:37888
    buffer_load_dwordx4 v[132:135], v4, s[40:43], s56 offen offset:1024 sc1
    s_waitcnt vmcnt(9)
    v_mfma_f32_32x32x16_bf16 v[48:63], a[192:195], v[96:99], v[48:63]
    v_mfma_f32_32x32x16_bf16 v[64:79], a[196:199], v[96:99], v[64:79]
    buffer_load_dwordx4 v[136:139], v4, s[40:43], s56 offen offset:2048 sc1
    s_waitcnt vmcnt(9)
    v_mfma_f32_32x32x16_bf16 v[48:63], a[200:203], v[100:103], v[48:63]
    v_mfma_f32_32x32x16_bf16 v[64:79], a[204:207], v[100:103], v[64:79]
    s_waitcnt lgkmcnt(6)
    v_add_f32 v16, v16, v20
    s_waitcnt lgkmcnt(4)
    v_add_f32 v24, v24, v28
    v_add_f32 v17, v17, v21
    v_add_f32 v25, v25, v29
    v_add_f32 v18, v18, v22
    v_add_f32 v26, v26, v30
    buffer_load_dwordx4 v[140:143], v4, s[40:43], s56 offen offset:3072 sc1
    s_waitcnt vmcnt(9)
    v_mfma_f32_32x32x16_bf16 v[48:63], a[208:211], v[104:107], v[48:63]
    v_mfma_f32_32x32x16_bf16 v[64:79], a[212:215], v[104:107], v[64:79]
    v_add_f32 v19, v19, v23
    v_add_f32 v27, v27, v31
    v_add_f32 v16, v16, v24
    v_add_f32 v17, v17, v25
    v_add_f32 v18, v18, v26
    v_add_f32 v19, v19, v27
    s_add_u32 s56, s59, s53
    buffer_load_dwordx4 v[144:147], v4, s[40:43], s56 offen offset:0 sc1
    s_waitcnt vmcnt(9)
    v_mfma_f32_32x32x16_bf16 v[48:63], a[216:219], v[108:111], v[48:63]
    v_mfma_f32_32x32x16_bf16 v[64:79], a[220:223], v[108:111], v[64:79]
    v_cvt_pk_bf16_f32 v20, v16, v17
    v_cvt_pk_bf16_f32 v21, v18, v19
    buffer_store_dwordx2 v[20:21], v212, s[36:39], s68 offen offset:0
    s_waitcnt lgkmcnt(2)
    v_add_f32 v32, v32, v36
    s_waitcnt lgkmcnt(0)
    v_add_f32 v40, v40, v44
    v_add_f32 v33, v33, v37
    buffer_load_dwordx4 v[148:151], v4, s[40:43], s56 offen offset:1024 sc1
    s_waitcnt vmcnt(10)
    v_mfma_f32_32x32x16_bf16 v[48:63], a[224:227], v[112:115], v[48:63]
    v_mfma_f32_32x32x16_bf16 v[64:79], a[228:231], v[112:115], v[64:79]
    v_add_f32 v41, v41, v45
    v_add_f32 v34, v34, v38
    v_add_f32 v42, v42, v46
    v_add_f32 v35, v35, v39
    v_add_f32 v43, v43, v47
    v_add_f32 v32, v32, v40
    buffer_load_dwordx4 v[152:155], v4, s[40:43], s56 offen offset:2048 sc1
    s_waitcnt vmcnt(10)
    v_mfma_f32_32x32x16_bf16 v[48:63], a[232:235], v[116:119], v[48:63]
    v_mfma_f32_32x32x16_bf16 v[64:79], a[236:239], v[116:119], v[64:79]
    v_add_f32 v33, v33, v41
    v_add_f32 v34, v34, v42
    v_add_f32 v35, v35, v43
    v_cvt_pk_bf16_f32 v36, v32, v33
    v_cvt_pk_bf16_f32 v37, v34, v35
    buffer_store_dwordx2 v[36:37], v212, s[36:39], s69 offen offset:0
    buffer_load_dwordx4 v[156:159], v4, s[40:43], s56 offen offset:3072 sc1
    s_waitcnt vmcnt(11)
    v_mfma_f32_32x32x16_bf16 v[48:63], a[240:243], v[120:123], v[48:63]
    v_mfma_f32_32x32x16_bf16 v[64:79], a[244:247], v[120:123], v[64:79]
    s_add_u32 s56, s59, s54
    buffer_load_dwordx4 v[160:163], v4, s[40:43], s56 offen offset:0 sc1
    s_waitcnt vmcnt(11)
    v_mfma_f32_32x32x16_bf16 v[48:63], a[248:251], v[124:127], v[48:63]
    v_mfma_f32_32x32x16_bf16 v[64:79], a[252:255], v[124:127], v[64:79]
    buffer_load_dwordx4 v[164:167], v4, s[40:43], s56 offen offset:1024 sc1
    s_waitcnt vmcnt(11)
    v_mfma_f32_32x32x16_bf16 v[48:63], a[0:3], v[128:131], v[48:63]
    v_mfma_f32_32x32x16_bf16 v[64:79], a[4:7], v[128:131], v[64:79]
    buffer_load_dwordx4 v[168:171], v4, s[40:43], s56 offen offset:2048 sc1
    s_waitcnt vmcnt(11)
    v_mfma_f32_32x32x16_bf16 v[48:63], a[8:11], v[132:135], v[48:63]
    v_mfma_f32_32x32x16_bf16 v[64:79], a[12:15], v[132:135], v[64:79]
    buffer_load_dwordx4 v[172:175], v4, s[40:43], s56 offen offset:3072 sc1
    s_waitcnt vmcnt(11)
    v_mfma_f32_32x32x16_bf16 v[48:63], a[16:19], v[136:139], v[48:63]
    v_mfma_f32_32x32x16_bf16 v[64:79], a[20:23], v[136:139], v[64:79]
    s_waitcnt vmcnt(10)
    v_mfma_f32_32x32x16_bf16 v[48:63], a[24:27], v[140:143], v[48:63]
    v_mfma_f32_32x32x16_bf16 v[64:79], a[28:31], v[140:143], v[64:79]
    s_waitcnt vmcnt(9)
    v_mfma_f32_32x32x16_bf16 v[48:63], a[32:35], v[144:147], v[48:63]
    v_mfma_f32_32x32x16_bf16 v[64:79], a[36:39], v[144:147], v[64:79]
    s_waitcnt vmcnt(7)
    v_mfma_f32_32x32x16_bf16 v[48:63], a[40:43], v[148:151], v[48:63]
    v_mfma_f32_32x32x16_bf16 v[64:79], a[44:47], v[148:151], v[64:79]
    s_waitcnt vmcnt(6)
    v_mfma_f32_32x32x16_bf16 v[48:63], a[48:51], v[152:155], v[48:63]
    v_mfma_f32_32x32x16_bf16 v[64:79], a[52:55], v[152:155], v[64:79]
    s_waitcnt vmcnt(4)
    v_mfma_f32_32x32x16_bf16 v[48:63], a[56:59], v[156:159], v[48:63]
    v_mfma_f32_32x32x16_bf16 v[64:79], a[60:63], v[156:159], v[64:79]
    s_waitcnt vmcnt(3)
    v_mfma_f32_32x32x16_bf16 v[64:79], a[68:71], v[160:163], v[64:79]
    s_waitcnt vmcnt(2)
    v_mfma_f32_32x32x16_bf16 v[64:79], a[76:79], v[164:167], v[64:79]
    s_waitcnt vmcnt(1)
    v_mfma_f32_32x32x16_bf16 v[64:79], a[84:87], v[168:171], v[64:79]
    s_waitcnt vmcnt(0)
    v_mfma_f32_32x32x16_bf16 v[64:79], a[92:95], v[172:175], v[64:79]
    v_mfma_f32_32x32x16_bf16 v[48:63], a[64:67], v[160:163], v[48:63]
    v_mfma_f32_32x32x16_bf16 v[48:63], a[72:75], v[164:167], v[48:63]
    s_nop 9
    ds_write_b32 v237, v64 offset:8192
    ds_write_b32 v237, v66 offset:8448
    ds_write_b32 v237, v65 offset:8320
    ds_write_b32 v237, v67 offset:8576
    ds_write_b32 v237, v68 offset:9216
    ds_write_b32 v237, v70 offset:9472
    v_mfma_f32_32x32x16_bf16 v[48:63], a[80:83], v[168:171], v[48:63]
    ds_write_b32 v237, v69 offset:9344
    ds_write_b32 v237, v71 offset:9600
    ds_write_b32 v237, v72 offset:10240
    ds_write_b32 v237, v74 offset:10496
    ds_write_b32 v237, v73 offset:10368
    ds_write_b32 v237, v75 offset:10624
    v_mfma_f32_32x32x16_bf16 v[48:63], a[88:91], v[172:175], v[48:63]
    ds_write_b32 v237, v76 offset:11264
    ds_write_b32 v237, v78 offset:11520
    ds_write_b32 v237, v77 offset:11392
    ds_write_b32 v237, v79 offset:11648
    s_nop 7
    ds_write_b32 v236, v48 offset:8192
    ds_write_b32 v236, v50 offset:8448
    ds_write_b32 v236, v49 offset:8320
    ds_write_b32 v236, v51 offset:8576
    ds_write_b32 v236, v52 offset:9216
    ds_write_b32 v236, v54 offset:9472
    ds_write_b32 v236, v53 offset:9344
    ds_write_b32 v236, v55 offset:9600
    ds_write_b32 v236, v56 offset:10240
    ds_write_b32 v236, v58 offset:10496
    ds_write_b32 v236, v57 offset:10368
    ds_write_b32 v236, v59 offset:10624
    ds_write_b32 v236, v60 offset:11264
    ds_write_b32 v236, v62 offset:11520
    ds_write_b32 v236, v61 offset:11392
    ds_write_b32 v236, v63 offset:11648
    s_waitcnt lgkmcnt(0)
    s_barrier
    ds_read_b128 v[48:51], v238 offset:8192
    ds_read_b128 v[52:55], v238 offset:45056
    ds_read_b128 v[56:59], v239 offset:8192
    ds_read_b128 v[60:63], v239 offset:45056
    ds_read_b128 v[64:67], v238 offset:9216
    ds_read_b128 v[68:71], v238 offset:46080
    ds_read_b128 v[72:75], v239 offset:9216
    ds_read_b128 v[76:79], v239 offset:46080
    s_waitcnt lgkmcnt(6)
    v_pk_add_f32 v[48:49], v[48:49], v[52:53]
    s_waitcnt lgkmcnt(4)
    v_pk_add_f32 v[56:57], v[56:57], v[60:61]
    v_pk_add_f32 v[50:51], v[50:51], v[54:55]
    v_pk_add_f32 v[58:59], v[58:59], v[62:63]
    v_pk_add_f32 v[48:49], v[48:49], v[56:57]
    v_pk_add_f32 v[50:51], v[50:51], v[58:59]
    v_cvt_pk_bf16_f32 v52, v48, v49
    v_cvt_pk_bf16_f32 v53, v50, v51
    buffer_store_dwordx2 v[52:53], v212, s[36:39], s68 offen offset:64
    s_waitcnt lgkmcnt(2)
    v_pk_add_f32 v[64:65], v[64:65], v[68:69]
    s_waitcnt lgkmcnt(0)
    v_pk_add_f32 v[72:73], v[72:73], v[76:77]
    v_pk_add_f32 v[66:67], v[66:67], v[70:71]
    v_pk_add_f32 v[74:75], v[74:75], v[78:79]
    v_pk_add_f32 v[64:65], v[64:65], v[72:73]
    v_pk_add_f32 v[66:67], v[66:67], v[74:75]
    v_cvt_pk_bf16_f32 v68, v64, v65
    v_cvt_pk_bf16_f32 v69, v66, v67
    buffer_store_dwordx2 v[68:69], v212, s[36:39], s69 offen offset:64
L_end_P:
    s_endpgm

.section .rodata,"a"
.p2align 6
.amdhsa_kernel sequential_preLN__sliding_local_dilated__mixer_token_mlp__prompt_kernel
  .amdhsa_next_free_vgpr 508
  .amdhsa_next_free_sgpr 102
  .amdhsa_accum_offset 252
  .amdhsa_group_segment_fixed_size 0
  .amdhsa_kernarg_size 88
  .amdhsa_user_sgpr_count 2
  .amdhsa_user_sgpr_kernarg_segment_ptr 1
  .amdhsa_system_sgpr_workgroup_id_x 1
.end_amdhsa_kernel
```

```asm
; @launch grid=(256,1,1) block=(256,1,1) lds=163840
.amdgcn_target "amdgcn-amd-amdhsa--gfx950"
.text
.globl sequential_preLN__sliding_local_dilated__mixer_token_mlp__prompt_kernel
.p2align 8
.type sequential_preLN__sliding_local_dilated__mixer_token_mlp__prompt_kernel,@function
sequential_preLN__sliding_local_dilated__mixer_token_mlp__prompt_kernel:
    s_cmp_ge_u32 s2, 256
    s_cbranch_scc1 L_end_P
    s_load_dwordx2 s[8:9], s[0:1], 0
    s_load_dwordx2 s[12:13], s[0:1], 8
    s_load_dwordx2 s[44:45], s[0:1], 72
    s_load_dwordx2 s[40:41], s[0:1], 80
    s_load_dwordx2 s[16:17], s[0:1], 16
    s_load_dwordx2 s[20:21], s[0:1], 32
    s_load_dwordx2 s[24:25], s[0:1], 48
    s_load_dwordx2 s[28:29], s[0:1], 40
    s_load_dwordx2 s[32:33], s[0:1], 56
    s_load_dwordx2 s[36:37], s[0:1], 64
    v_lshrrev_b32 v1, 6, v0
    s_nop 0
    v_readfirstlane_b32 s3, v1
    v_and_b32 v1, 63, v0
    v_and_b32 v2, 15, v0
    v_lshrrev_b32 v3, 4, v1
    v_lshlrev_b32 v4, 4, v1
    s_mov_b32 s10, 0x1c0000
    s_mov_b32 s11, 0x00020000
    s_mov_b32 s14, 0x126000
    s_mov_b32 s15, 0x00020000
    s_mov_b32 s46, 0x100
    s_mov_b32 s47, 0x00020000
    s_mov_b32 s42, 0x610000
    s_mov_b32 s43, 0x00020000
    s_mov_b32 s18, 0x62000
    s_mov_b32 s19, 0x00020000
    s_mov_b32 s22, 0x700000
    s_mov_b32 s23, 0x00020000
    s_mov_b32 s26, 0x700000
    s_mov_b32 s27, 0x00020000
    s_mov_b32 s30, 0xe00
    s_mov_b32 s31, 0x00020000
    s_mov_b32 s34, 0x1000
    s_mov_b32 s35, 0x00020000
    s_mov_b32 s38, 0x1c0000
    s_mov_b32 s39, 0x00020000
    s_mov_b32 s5, 0x3f803f80
    s_mov_b32 s6, 0x200000
    s_bfe_u32 s48, s2, 0x20001
    s_lshl_b32 s48, s48, 2
    s_lshr_b32 s53, s2, 6
    s_add_u32 s48, s48, s53
    s_bfe_u32 s49, s2, 0x30003
    s_and_b32 s53, s2, 1
    s_lshl_b32 s53, s53, 3
    s_add_u32 s49, s49, s53
    v_lshrrev_b32_e64 v237, 2, v1
    v_mul_u32_u24 v123, 2688, v237
    v_lshrrev_b32 v237, 5, v1
    v_lshlrev_b32 v237, 1, v237
    v_and_b32 v238, 3, v1
    v_xor_b32 v237, v237, v238
    v_lshl_add_u32 v123, v237, 4, v123
    s_mul_i32 s53, s49, 56
    s_min_u32 s53, s53, 832
    s_mul_i32 s51, s3, 43008
    s_add_u32 s53, s53, s51
    v_add_u32 v123, s53, v123
    s_lshr_b32 s53, s3, 1
    s_mul_i32 s51, s53, 6144
    s_and_b32 s53, s3, 1
    s_lshl_b32 s53, s53, 10
    s_add_u32 s51, s51, s53
    v_lshrrev_b32 v237, 3, v1
    v_mul_u32_u24 v122, 896, v237
    v_and_b32 v237, 7, v1
    v_xor_b32 v237, v237, v3
    v_lshl_add_u32 v120, v237, 4, v122
    s_lshl_b32 s50, s48, 7
    s_lshl_b32 s53, s3, 5
    s_add_u32 s53, s53, s50
    s_mul_i32 s53, s53, 896
    v_xor_b32 v121, 64, v120
    v_add_u32_e64 v120, s53, v120
    s_add_u32 s53, s53, 7168
    v_add_u32 v121, s53, v121
    s_lshl_b32 s53, s3, 1
    v_xor_b32 v237, s53, v237
    v_lshl_add_u32 v122, v237, 4, v122
    s_lshl_b32 s53, s3, 2
    s_add_u32 s53, s53, s50
    s_sub_u32 s53, s53, 16
    s_mul_i32 s53, s53, 896
    s_cmp_eq_u32 s48, 0
    s_cselect_b32 s53, 0x40000000, s53
    v_add_u32 v122, s53, v122
    s_lshl_b32 s52, s3, 12
    s_add_u32 s52, s52, 63488
    s_lshl_b32 s7, s3, 9
    s_cmp_eq_u32 s3, 0
    s_cselect_b32 s54, 0xffffff00, -1
    s_mov_b32 s55, 0
    s_memrealtime s[86:87]
    v_mov_b32 v7, 0
    s_waitcnt lgkmcnt(0)
    s_or_b32 s86, s86, 1
    v_mov_b32 v6, s86
    s_or_b32 s86, s2, s3
    s_cmp_eq_u32 s86, 0
    s_cselect_b64 exec, 1, 0
    buffer_store_dword v6, v7, s[44:47], 0 offen sc1
    s_mov_b64 exec, -1
    s_add_u32 m0, s51, 12288
    s_mov_b32 s73, 0
    buffer_load_dwordx4 v123, s[12:15], s73 offen lds
    s_add_u32 m0, s51, 14336
    s_mov_b32 s73, 896
    buffer_load_dwordx4 v123, s[12:15], s73 offen lds
    s_add_u32 m0, s51, 16384
    s_mov_b32 s73, 1792
    buffer_load_dwordx4 v123, s[12:15], s73 offen lds
    s_add_u32 m0, s52, 36864
    s_mov_b32 s73, 0
    buffer_load_dwordx4 v120, s[8:11], s73 offen lds
    s_add_u32 m0, s52, 37888
    s_mov_b32 s73, 0
    buffer_load_dwordx4 v121, s[8:11], s73 offen lds
    s_add_u32 m0, s52, 38912
    s_mov_b32 s73, 14336
    buffer_load_dwordx4 v120, s[8:11], s73 offen lds
    s_add_u32 m0, s52, 39936
    s_mov_b32 s73, 14336
    buffer_load_dwordx4 v121, s[8:11], s73 offen lds
    s_add_u32 m0, s7, 98304
    s_mov_b32 s73, 0
    s_mov_b64 exec, s[54:55]
    buffer_load_dwordx4 v122, s[8:11], s73 offen lds
    s_mov_b64 exec, -1
    s_bfe_u32 s53, s2, 0x30003
    s_add_u32 s86, s53, 1
    s_lshr_b32 s86, s86, 1
    s_lshr_b32 s87, s2, 6
    s_mul_i32 s87, s87, 5
    s_add_u32 s86, s86, s87
    s_lshl_b32 s86, s86, 2
    s_add_u32 s53, s86, s3
    s_mov_b32 s56, s53
    s_mov_b32 s86, 0x2a54
    s_bitcmp1_b32 s86, s49
    s_cselect_b32 s57, 0x40000000, 0
    s_mul_i32 s86, s53, 58
    v_add_u32_e64 v237, s86, v1
    v_mul_u32_u24 v238, 43691, v237
    v_lshrrev_b32 v238, 19, v238
    v_mul_u32_u24 v239, 12, v238
    v_sub_u32 v239, v237, v239
    v_lshrrev_b32 v239, 2, v239
    v_mul_u32_u24 v239, 896, v239
    v_mul_u32_u24 v238, 2688, v238
    v_and_b32 v237, 3, v237
    v_lshlrev_b32 v237, 7, v237
    v_add3_u32 v237, v237, v238, v239
    v_add_u32 v237, s57, v237
    s_and_b32 s87, s2, 1
    s_mul_i32 s87, s87, 384
    s_add_u32 s87, s87, 172032
    s_mov_b32 exec_lo, 0xffffffff
    s_mov_b32 exec_hi, 0x3ffffff
    buffer_load_dword v232, v237, s[12:15], s87 offen
    s_mov_b64 exec, -1
    v_lshlrev_b32 v237, 7, v1
    v_add_u32 v238, s57, v237
    s_mul_i32 s86, s53, 6016
    s_bfe_u32 s87, s2, 0x20001
    s_mul_i32 s87, s87, 458752
    s_add_u32 s86, s86, s87
    s_max_u32 s86, s86, 14336
    s_sub_u32 s86, s86, 14336
    s_mov_b32 exec_hi, 0x7fff
    buffer_load_dword v233, v238, s[8:11], s86 offen
    s_getpc_b64 s[86:87]
Lpc_P:
    s_mul_i32 s53, s53, 384
    v_add_u32_e64 v237, s53, v237
    v_min_u32 v237, L_end_P-Lpc_P, v237
    s_mov_b64 exec, 7
    global_load_dword v236, v237, s[86:87]
    s_mov_b64 exec, -1
    v_mul_u32_u24 v237, 18432, v3
    v_lshl_add_u32 v237, v2, 3, v237
    v_mov_b32_e64 v238, s5
    v_add_u32 v237, 61440, v237
    ds_write2_b32 v237, v238, v238 offset0:0 offset1:1
    s_lshr_b32 s68, s2, 3
    s_mul_i32 s69, s68, 37
    s_lshr_b32 s69, s69, 8
    s_mul_i32 s64, s69, 7
    s_sub_u32 s64, s68, s64
    s_mov_b32 s66, s64
    s_and_b32 s68, s2, 7
    s_lshl_b32 s67, s68, 2
    s_add_u32 s67, s67, s69
    s_cmp_ge_u32 s69, 4
    s_cselect_b32 s67, 99, s67
    s_mul_i32 s71, s68, 3
    s_add_u32 s71, s71, 4
    s_lshl_b32 s72, s68, 2
    s_cmp_lt_u32 s68, 4
    s_cselect_b32 s65, s72, s71
    s_cselect_b32 s71, 4, 3
    s_add_u32 s65, s65, s69
    s_cmp_ge_u32 s69, s71
    s_cselect_b32 s65, 99, s65
    v_lshrrev_b32_e64 v219, 3, v1
    v_mul_u32_u24 v208, 896, v219
    v_and_b32 v219, 1, v3
    v_lshlrev_b32 v219, 2, v219
    v_and_b32 v220, 7, v1
    v_xor_b32 v219, v219, v220
    v_lshl_add_u32 v208, v219, 4, v208
    s_lshl_b32 s58, s66, 7
    s_mul_i32 s60, s3, 100352
    s_add_u32 s58, s58, s60
    v_add_u32_e64 v208, s58, v208
    s_mul_i32 s59, s3, 36864
    s_add_u32 s59, s59, 12288
    v_lshrrev_b32 v219, 5, v1
    v_lshlrev_b32 v209, 9, v219
    v_bfe_u32 v219, v1, 2, 2
    v_lshl_add_u32 v209, v219, 7, v209
    v_lshrrev_b32 v219, 1, v219
    s_and_b32 s58, s3, 1
    v_xor_b32_e64 v219, s58, v219
    v_lshl_add_u32 v209, v219, 6, v209
    v_and_b32_e64 v219, 1, v3
    v_lshl_add_u32 v209, v219, 5, v209
    v_and_b32_e64 v219, 3, v1
    v_lshl_add_u32 v209, v219, 3, v209
    v_add_u32 v209, 12288, v209
    v_lshrrev_b32 v219, 5, v1
    v_lshlrev_b32 v219, 10, v219
    v_sub_u32_e64 v210, v209, v219
    s_mul_i32 s70, s3, 36864
    s_add_u32 s70, s70, 12288
    v_lshrrev_b32_e64 v219, 3, v1
    v_mul_u32_u24 v213, 3584, v219
    v_and_b32 v219, 1, v3
    v_lshlrev_b32 v219, 2, v219
    v_and_b32 v220, 7, v1
    v_xor_b32 v219, v219, v220
    v_lshl_add_u32 v213, v219, 4, v213
    s_mul_i32 s68, s3, 1835008
    s_lshl_b32 s69, s65, 7
    s_add_u32 s68, s68, s69
    s_cmp_ge_u32 s65, 99
    s_cselect_b32 s68, 0x40000000, s68
    v_add_u32 v213, s68, v213
    s_cselect_b32 s68, 0x40000000, 0
    v_add_u32 v5, s68, v4
    v_lshrrev_b32 v219, 5, v1
    v_lshlrev_b32 v215, 9, v219
    v_bfe_u32 v219, v1, 2, 2
    v_lshl_add_u32 v215, v219, 7, v215
    v_lshrrev_b32 v219, 1, v219
    s_lshr_b32 s68, s3, 1
    v_xor_b32_e64 v219, s68, v219
    v_lshl_add_u32 v215, v219, 6, v215
    v_and_b32_e64 v219, 1, v3
    v_lshl_add_u32 v215, v219, 5, v215
    v_and_b32_e64 v219, 3, v1
    v_lshl_add_u32 v215, v219, 3, v215
    s_and_b32 s68, s3, 1
    s_lshl_b32 s68, s68, 5
    v_xor_b32 v215, s68, v215
    v_add_u32 v215, s70, v215
    v_xor_b32_e64 v216, 64, v215
    s_mul_i32 s70, s3, 36864
    s_add_u32 s70, s70, 12288
    v_lshrrev_b32_e64 v219, 3, v1
    v_mul_u32_u24 v214, 4096, v219
    v_and_b32 v219, 1, v3
    v_lshlrev_b32 v219, 2, v219
    v_and_b32 v220, 7, v1
    v_xor_b32 v219, v219, v220
    v_lshl_add_u32 v214, v219, 4, v214
    s_mul_i32 s68, s3, 1835008
    s_lshl_b32 s69, s67, 7
    s_add_u32 s68, s68, s69
    s_cmp_ge_u32 s67, 99
    s_cselect_b32 s68, 0x40000000, s68
    v_add_u32 v214, s68, v214
    v_lshrrev_b32 v219, 5, v1
    v_lshlrev_b32 v217, 9, v219
    v_bfe_u32 v219, v1, 2, 2
    v_lshl_add_u32 v217, v219, 7, v217
    v_lshrrev_b32 v219, 1, v219
    s_lshr_b32 s68, s3, 1
    v_xor_b32_e64 v219, s68, v219
    v_lshl_add_u32 v217, v219, 6, v217
    v_and_b32_e64 v219, 1, v3
    v_lshl_add_u32 v217, v219, 5, v217
    v_and_b32_e64 v219, 3, v1
    v_lshl_add_u32 v217, v219, 3, v217
    v_add_u32_e64 v217, s70, v217
    v_xor_b32 v218, 64, v217
    s_and_b32 s68, s2, 7
    s_cmp_ge_u32 s68, 8
    s_cselect_b32 s94, 8, 0
    s_sub_u32 s68, s68, s94
    s_lshl_b32 s94, s68, 12
    s_add_u32 s68, s68, 1
    s_cmp_ge_u32 s68, 8
    s_cselect_b32 s95, 8, 0
    s_sub_u32 s68, s68, s95
    s_lshl_b32 s95, s68, 12
    s_add_u32 s68, s68, 1
    s_cmp_ge_u32 s68, 8
    s_cselect_b32 s96, 8, 0
    s_sub_u32 s68, s68, s96
    s_lshl_b32 s96, s68, 12
    s_add_u32 s68, s68, 1
    s_cmp_ge_u32 s68, 8
    s_cselect_b32 s97, 8, 0
    s_sub_u32 s68, s68, s97
    s_lshl_b32 s97, s68, 12
    s_add_u32 s68, s68, 1
    s_cmp_ge_u32 s68, 8
    s_cselect_b32 s98, 8, 0
    s_sub_u32 s68, s68, s98
    s_lshl_b32 s98, s68, 12
    s_add_u32 s68, s68, 1
    s_cmp_ge_u32 s68, 8
    s_cselect_b32 s99, 8, 0
    s_sub_u32 s68, s68, s99
    s_lshl_b32 s99, s68, 12
    s_add_u32 s68, s68, 1
    s_cmp_ge_u32 s68, 8
    s_cselect_b32 s100, 8, 0
    s_sub_u32 s68, s68, s100
    s_lshl_b32 s100, s68, 12
    s_add_u32 s68, s68, 1
    s_cmp_ge_u32 s68, 8
    s_cselect_b32 s101, 8, 0
    s_sub_u32 s68, s68, s101
    s_lshl_b32 s101, s68, 12
    s_lshl_b32 s80, s48, 2
    s_add_u32 s80, s80, s3
    s_lshl_b32 s80, s80, 11
    s_lshr_b32 s93, s49, 2
    s_lshl_b32 s93, s93, 7
    s_add_u32 s80, s80, s93
    s_and_b32 s93, s49, 3
    s_lshl_b32 s93, s93, 2
    s_add_u32 s80, s80, s93
    s_add_u32 s80, s80, 0x5c8000
    s_lshl_b32 s83, s67, 1
    s_lshr_b32 s93, s3, 1
    s_add_u32 s83, s83, s93
    s_lshl_b32 s83, s83, 11
    s_add_u32 s83, s83, 0x5c8000
    v_lshrrev_b32 v10, 2, v2
    v_lshlrev_b32 v10, 7, v10
    v_and_b32_e64 v219, 3, v2
    v_lshl_add_u32 v10, v219, 2, v10
    s_lshl_b32 s84, s64, 12
    s_lshl_b32 s85, s84, 1
    s_add_u32 s85, s85, 0x5f0000
    s_add_u32 s84, s84, 0x5e8000
    s_lshl_b32 s81, s67, 5
    s_add_u32 s81, s81, s3
    s_lshl_b32 s81, s81, 2
    s_add_u32 s81, s81, s84
    s_lshl_b32 s93, s3, 10
    s_add_u32 s84, s84, s93
    v_bfe_u32 v11, v1, 2, 3
    v_min_u32 v12, 6, v11
    v_and_b32 v219, 3, v1
    v_lshlrev_b32_e64 v219, 2, v219
    v_lshl_add_u32 v11, v11, 7, v219
    v_lshl_add_u32 v12, v12, 7, v219
    s_lshl_b32 s82, s65, 5
    s_add_u32 s82, s82, s3
    s_lshl_b32 s82, s82, 2
    s_add_u32 s82, s82, s85
    s_mul_i32 s93, s3, 896
    s_add_u32 s85, s85, s93
    v_mov_b32 v9, 0
    v_lshlrev_b32_e64 v124, 9, v3
    v_bfe_u32 v237, v1, 2, 2
    v_lshl_add_u32 v124, v237, 6, v124
    v_and_b32_e64 v237, 3, v1
    v_lshl_add_u32 v124, v237, 3, v124
    v_and_b32 v237, 1, v3
    v_lshlrev_b32 v237, 5, v237
    v_add_u32_e64 v124, v124, v237
    v_add_u32 v124, 12288, v124
    v_xor_b32 v125, 32, v124
    s_and_b32 s53, s3, 1
    s_lshl_b32 s53, s53, 5
    v_xor_b32 v127, s53, v124
    s_lshr_b32 s53, s3, 1
    s_lshl_b32 s53, s53, 11
    s_add_u32 s53, s53, 2048
    v_add_u32 v126, s53, v127
    v_lshrrev_b32 v237, 1, v2
    v_xor_b32 v237, v237, v3
    v_lshlrev_b32 v237, 4, v237
    v_lshl_add_u32 v237, v2, 7, v237
    v_add_u32 v130, 61440, v237
    v_xor_b32 v131, 64, v130
    v_add_u32 v128, s52, v237
    v_xor_b32 v129, 64, v128
    v_lshlrev_b32 v237, 2, v3
    v_sub_u32_e64 v237, v2, v237
    v_mov_b32 v239, 0xf149f2ca
    v_add_u32 v238, 16, v237
    v_and_b32 v238, 0xfffffff1, v238
    v_cmp_eq_u32 vcc, 0, v238
    s_nop 1
    v_cndmask_b32 v240, v239, 0, vcc
    v_add_u32 v238, 15, v237
    v_and_b32 v238, 0xfffffff1, v238
    v_cmp_eq_u32 vcc, 0, v238
    s_nop 1
    v_cndmask_b32 v241, v239, 0, vcc
    v_add_u32 v238, 14, v237
    v_and_b32 v238, 0xfffffff1, v238
    v_cmp_eq_u32 vcc, 0, v238
    s_nop 1
    v_cndmask_b32 v242, v239, 0, vcc
    v_add_u32 v238, 13, v237
    v_and_b32 v238, 0xfffffff1, v238
    v_cmp_eq_u32 vcc, 0, v238
    s_nop 1
    v_cndmask_b32 v243, v239, 0, vcc
    v_add_u32 v238, 0, v237
    v_and_b32 v238, 0xfffffff1, v238
    v_cmp_eq_u32 vcc, 0, v238
    s_nop 1
    v_cndmask_b32 v244, v239, 0, vcc
    v_add_u32 v238, -1, v237
    v_and_b32 v238, 0xfffffff1, v238
    v_cmp_eq_u32 vcc, 0, v238
    s_nop 1
    v_cndmask_b32 v245, v239, 0, vcc
    v_add_u32 v238, -2, v237
    v_and_b32 v238, 0xfffffff1, v238
    v_cmp_eq_u32 vcc, 0, v238
    s_nop 1
    v_cndmask_b32 v246, v239, 0, vcc
    v_add_u32 v238, -3, v237
    v_and_b32 v238, 0xfffffff1, v238
    v_cmp_eq_u32 vcc, 0, v238
    s_nop 1
    v_cndmask_b32 v247, v239, 0, vcc
    s_or_b32 s53, s48, s3
    s_cmp_eq_u32 s53, 0
    s_cselect_b64 vcc, -1, 0
    v_cndmask_b32 v248, v240, v239, vcc
    v_cndmask_b32 v249, v241, v239, vcc
    v_cndmask_b32 v250, v242, v239, vcc
    v_cndmask_b32 v251, v243, v239, vcc
    v_mov_b32 v40, s5
    v_mov_b32 v41, s5
    v_mov_b32 v42, s5
    v_mov_b32_e64 v43, s5
    s_mov_b32 s88, 0x22222222
    s_mov_b32 s89, 0x22222222
    s_mov_b32 s90, 0x44444444
    s_mov_b32 s91, 0x44444444
    s_mov_b32 s92, 0x88888888
    s_mov_b32 s93, 0x88888888
    v_lshlrev_b32 v72, 4, v3
    s_lshl_b32 s53, s3, 6
    v_add_u32 v73, s53, v72
    s_and_b32 s53, s53, 64
    v_add_u32_e64 v74, s53, v72
    s_mul_i32 s53, s3, 384
    v_lshl_add_u32 v75, v2, 2, s53
    v_add_u32 v76, s53, v72
    s_and_b32 s53, s3, 1
    s_lshl_b32 s53, s53, 3
    v_add_u32 v80, s53, v4
    v_lshrrev_b32 v81, 2, v2
    v_lshlrev_b32 v81, 8, v81
    v_lshl_add_u32 v81, v3, 6, v81
    v_and_b32_e64 v82, 3, v2
    v_lshl_add_u32 v81, v82, 1, v81
    v_add_u32_e64 v81, s53, v81
    v_add_u32 v81, 1024, v81
    s_cmp_lt_u32 s3, 2
    s_cselect_b64 vcc, -1, 0
    s_cselect_b32 s53, 2, 16
    v_cndmask_b32 v80, v81, v80, vcc
    v_add_u32 v81, s53, v80
    v_add_u32 v82, s53, v81
    v_add_u32 v83, s53, v82
    v_lshlrev_b32 v77, 2, v2
    s_lshl_b32 s53, s3, 11
    v_add_u32 v78, s53, v4
    s_lshl_b32 s62, s48, 3
    s_lshl_b32 s63, s3, 1
    s_add_u32 s62, s62, s63
    s_lshl_b32 s62, s62, 4
    s_add_u32 s62, s62, s49
    s_lshl_b32 s62, s62, 10
    s_add_u32 s63, s62, 16384
    s_add_u32 m0, s51, 24576
    s_mov_b32 s73, 172032
    buffer_load_dwordx4 v123, s[12:15], s73 offen lds
    s_add_u32 m0, s51, 26624
    s_mov_b32 s73, 172928
    buffer_load_dwordx4 v123, s[12:15], s73 offen lds
    s_add_u32 m0, s51, 28672
    s_mov_b32 s73, 173824
    buffer_load_dwordx4 v123, s[12:15], s73 offen lds
    s_add_u32 m0, s52, 18432
    s_mov_b32 s73, 128
    buffer_load_dwordx4 v120, s[8:11], s73 offen lds
    s_add_u32 m0, s52, 19456
    s_mov_b32 s73, 128
    buffer_load_dwordx4 v121, s[8:11], s73 offen lds
    s_add_u32 m0, s52, 20480
    s_mov_b32 s73, 14464
    buffer_load_dwordx4 v120, s[8:11], s73 offen lds
    s_add_u32 m0, s52, 21504
    s_mov_b32 s73, 14464
    buffer_load_dwordx4 v121, s[8:11], s73 offen lds
    s_add_u32 m0, s7, 79872
    s_mov_b32 s73, 128
    s_mov_b64 exec, s[54:55]
    buffer_load_dwordx4 v122, s[8:11], s73 offen lds
    s_mov_b64 exec, -1
    s_waitcnt vmcnt(11)
    s_waitcnt lgkmcnt(0)
    s_barrier
    ds_read_b128 v[16:19], v128 offset:36864
    ds_read_b128 v[20:23], v128 offset:38912
    ds_read_b128 v[24:27], v130 offset:36864
    ds_read_b64_tr_b16 v[88:89], v124 offset:0
    ds_read_b64_tr_b16 v[90:91], v124 offset:256
    ds_read_b64_tr_b16 v[92:93], v125 offset:0
    ds_read_b64_tr_b16 v[94:95], v125 offset:256
    ds_read_b64_tr_b16 v[96:97], v124 offset:2048
    ds_read_b64_tr_b16 v[98:99], v124 offset:2304
    ds_read_b64_tr_b16 v[100:101], v125 offset:2048
    ds_read_b64_tr_b16 v[102:103], v125 offset:2304
    ds_read_b64_tr_b16 v[104:105], v124 offset:4096
    ds_read_b64_tr_b16 v[106:107], v124 offset:4352
    ds_read_b64_tr_b16 v[108:109], v125 offset:4096
    ds_read_b64_tr_b16 v[110:111], v125 offset:4352
    ds_read_b64_tr_b16 v[112:113], v126 offset:0
    ds_read_b64_tr_b16 v[114:115], v126 offset:256
    ds_read_b64_tr_b16 v[116:117], v127 offset:0
    ds_read_b64_tr_b16 v[118:119], v127 offset:256
    s_waitcnt lgkmcnt(8)
    v_mfma_f32_16x16x32_bf16 v[136:139], v[88:91], v[16:19], 0
    ds_read_b128 v[28:31], v129 offset:36864
    v_mfma_f32_16x16x32_bf16 v[160:163], v[88:91], v[20:23], 0
    ds_read_b128 v[32:35], v129 offset:38912
    v_mfma_f32_16x16x32_bf16 v[140:143], v[92:95], v[16:19], 0
    ds_read_b128 v[36:39], v131 offset:36864
    v_mfma_f32_16x16x32_bf16 v[164:167], v[92:95], v[20:23], 0
    ds_read_b64_tr_b16 v[88:89], v124 offset:6144
    v_mfma_f32_16x16x32_bf16 v[144:147], v[96:99], v[16:19], 0
    ds_read_b64_tr_b16 v[90:91], v124 offset:6400
    s_add_u32 m0, s51, 36864
    s_mov_b32 s73, 344064
    buffer_load_dwordx4 v123, s[12:15], s73 offen lds
    v_mfma_f32_16x16x32_bf16 v[168:171], v[96:99], v[20:23], 0
    ds_read_b64_tr_b16 v[92:93], v125 offset:6144
    v_mfma_f32_16x16x32_bf16 v[148:151], v[100:103], v[16:19], 0
    ds_read_b64_tr_b16 v[94:95], v125 offset:6400
    v_mfma_f32_16x16x32_bf16 v[172:175], v[100:103], v[20:23], 0
    ds_read_b64_tr_b16 v[96:97], v124 offset:8192
    s_waitcnt lgkmcnt(8)
    v_mfma_f32_16x16x32_bf16 v[152:155], v[16:19], v[104:107], 0
    ds_read_b64_tr_b16 v[98:99], v124 offset:8448
    v_mfma_f32_16x16x32_bf16 v[176:179], v[20:23], v[104:107], 0
    ds_read_b64_tr_b16 v[100:101], v125 offset:8192
    s_add_u32 m0, s51, 38912
    s_mov_b32 s73, 344960
    buffer_load_dwordx4 v123, s[12:15], s73 offen lds
    v_mfma_f32_16x16x32_bf16 v[156:159], v[16:19], v[108:111], 0
    ds_read_b64_tr_b16 v[102:103], v125 offset:8448
    v_mfma_f32_16x16x32_bf16 v[180:183], v[20:23], v[108:111], 0
    ds_read_b64_tr_b16 v[104:105], v124 offset:10240
    v_mfma_f32_16x16x32_bf16 v[184:187], v[112:115], v[24:27], 0
    ds_read_b64_tr_b16 v[106:107], v124 offset:10496
    v_mfma_f32_16x16x32_bf16 v[188:191], v[116:119], v[24:27], 0
    ds_read_b64_tr_b16 v[108:109], v125 offset:10240
    v_mfma_f32_16x16x32_bf16 v[48:51], v[16:19], v[16:19], 0
    ds_read_b64_tr_b16 v[110:111], v125 offset:10496
    s_add_u32 m0, s51, 40960
    s_mov_b32 s73, 345856
    buffer_load_dwordx4 v123, s[12:15], s73 offen lds
    v_mfma_f32_16x16x32_bf16 v[52:55], v[20:23], v[20:23], 0
    ds_read_b64_tr_b16 v[112:113], v126 offset:6144
    v_mfma_f32_16x16x32_bf16 v[56:59], v[24:27], v[24:27], 0
    ds_read_b64_tr_b16 v[114:115], v126 offset:6400
    v_mfma_f32_16x16x32_bf16 v[60:63], v[40:43], v[16:19], 0
    ds_read_b64_tr_b16 v[116:117], v127 offset:6144
    v_mfma_f32_16x16x32_bf16 v[64:67], v[40:43], v[20:23], 0
    ds_read_b64_tr_b16 v[118:119], v127 offset:6400
    v_mfma_f32_16x16x32_bf16 v[68:71], v[40:43], v[24:27], 0
    s_add_u32 m0, s52, 0
    s_mov_b32 s73, 256
    buffer_load_dwordx4 v120, s[8:11], s73 offen lds
    s_add_u32 m0, s52, 1024
    s_mov_b32 s73, 256
    buffer_load_dwordx4 v121, s[8:11], s73 offen lds
    s_add_u32 m0, s52, 2048
    s_mov_b32 s73, 14592
    buffer_load_dwordx4 v120, s[8:11], s73 offen lds
    s_add_u32 m0, s52, 3072
    s_mov_b32 s73, 14592
    buffer_load_dwordx4 v121, s[8:11], s73 offen lds
    s_add_u32 m0, s7, 61440
    s_mov_b32 s73, 256
    s_mov_b64 exec, s[54:55]
    buffer_load_dwordx4 v122, s[8:11], s73 offen lds
    s_mov_b64 exec, -1
    s_waitcnt vmcnt(8)
    s_barrier
    s_waitcnt lgkmcnt(8)
    v_mfma_f32_16x16x32_bf16 v[136:139], v[88:91], v[28:31], v[136:139]
    ds_read_b128 v[16:19], v128 offset:18432
    v_mfma_f32_16x16x32_bf16 v[160:163], v[88:91], v[32:35], v[160:163]
    ds_read_b128 v[20:23], v128 offset:20480
    v_mfma_f32_16x16x32_bf16 v[140:143], v[92:95], v[28:31], v[140:143]
    ds_read_b128 v[24:27], v130 offset:18432
    v_mfma_f32_16x16x32_bf16 v[164:167], v[92:95], v[32:35], v[164:167]
    ds_read_b64_tr_b16 v[88:89], v124 offset:12288
    v_mfma_f32_16x16x32_bf16 v[144:147], v[96:99], v[28:31], v[144:147]
    ds_read_b64_tr_b16 v[90:91], v124 offset:12544
    s_add_u32 m0, s51, 49152
    s_mov_b32 s73, 516096
    buffer_load_dwordx4 v123, s[12:15], s73 offen lds
    v_mfma_f32_16x16x32_bf16 v[168:171], v[96:99], v[32:35], v[168:171]
    ds_read_b64_tr_b16 v[92:93], v125 offset:12288
    v_mfma_f32_16x16x32_bf16 v[148:151], v[100:103], v[28:31], v[148:151]
    ds_read_b64_tr_b16 v[94:95], v125 offset:12544
    v_mfma_f32_16x16x32_bf16 v[172:175], v[100:103], v[32:35], v[172:175]
    ds_read_b64_tr_b16 v[96:97], v124 offset:14336
    s_waitcnt lgkmcnt(8)
    v_mfma_f32_16x16x32_bf16 v[152:155], v[28:31], v[104:107], v[152:155]
    ds_read_b64_tr_b16 v[98:99], v124 offset:14592
    v_mfma_f32_16x16x32_bf16 v[176:179], v[32:35], v[104:107], v[176:179]
    ds_read_b64_tr_b16 v[100:101], v125 offset:14336
    s_add_u32 m0, s51, 51200
    s_mov_b32 s73, 516992
    buffer_load_dwordx4 v123, s[12:15], s73 offen lds
    v_mfma_f32_16x16x32_bf16 v[156:159], v[28:31], v[108:111], v[156:159]
    ds_read_b64_tr_b16 v[102:103], v125 offset:14592
    v_mfma_f32_16x16x32_bf16 v[180:183], v[32:35], v[108:111], v[180:183]
    ds_read_b64_tr_b16 v[104:105], v124 offset:16384
    v_mfma_f32_16x16x32_bf16 v[184:187], v[112:115], v[36:39], v[184:187]
    ds_read_b64_tr_b16 v[106:107], v124 offset:16640
    v_mfma_f32_16x16x32_bf16 v[188:191], v[116:119], v[36:39], v[188:191]
    ds_read_b64_tr_b16 v[108:109], v125 offset:16384
    v_mfma_f32_16x16x32_bf16 v[48:51], v[28:31], v[28:31], v[48:51]
    ds_read_b64_tr_b16 v[110:111], v125 offset:16640
    s_add_u32 m0, s51, 53248
    s_mov_b32 s73, 517888
    buffer_load_dwordx4 v123, s[12:15], s73 offen lds
    v_mfma_f32_16x16x32_bf16 v[52:55], v[32:35], v[32:35], v[52:55]
    ds_read_b64_tr_b16 v[112:113], v126 offset:12288
    v_mfma_f32_16x16x32_bf16 v[56:59], v[36:39], v[36:39], v[56:59]
    ds_read_b64_tr_b16 v[114:115], v126 offset:12544
    v_mfma_f32_16x16x32_bf16 v[60:63], v[40:43], v[28:31], v[60:63]
    ds_read_b64_tr_b16 v[116:117], v127 offset:12288
    v_mfma_f32_16x16x32_bf16 v[64:67], v[40:43], v[32:35], v[64:67]
    ds_read_b64_tr_b16 v[118:119], v127 offset:12544
    v_mfma_f32_16x16x32_bf16 v[68:71], v[40:43], v[36:39], v[68:71]
    s_add_u32 m0, s52, 55296
    s_mov_b32 s73, 384
    buffer_load_dwordx4 v120, s[8:11], s73 offen lds
    s_waitcnt lgkmcnt(8)
    v_mfma_f32_16x16x32_bf16 v[136:139], v[88:91], v[16:19], v[136:139]
    ds_read_b128 v[28:31], v129 offset:18432
    v_mfma_f32_16x16x32_bf16 v[160:163], v[88:91], v[20:23], v[160:163]
    ds_read_b128 v[32:35], v129 offset:20480
    v_mfma_f32_16x16x32_bf16 v[140:143], v[92:95], v[16:19], v[140:143]
    ds_read_b128 v[36:39], v131 offset:18432
    v_mfma_f32_16x16x32_bf16 v[164:167], v[92:95], v[20:23], v[164:167]
    ds_read_b64_tr_b16 v[88:89], v124 offset:18432
    v_mfma_f32_16x16x32_bf16 v[144:147], v[96:99], v[16:19], v[144:147]
    ds_read_b64_tr_b16 v[90:91], v124 offset:18688
    s_add_u32 m0, s52, 56320
    s_mov_b32 s73, 384
    buffer_load_dwordx4 v121, s[8:11], s73 offen lds
    v_mfma_f32_16x16x32_bf16 v[168:171], v[96:99], v[20:23], v[168:171]
    ds_read_b64_tr_b16 v[92:93], v125 offset:18432
    v_mfma_f32_16x16x32_bf16 v[148:151], v[100:103], v[16:19], v[148:151]
    ds_read_b64_tr_b16 v[94:95], v125 offset:18688
    v_mfma_f32_16x16x32_bf16 v[172:175], v[100:103], v[20:23], v[172:175]
    ds_read_b64_tr_b16 v[96:97], v124 offset:20480
    s_waitcnt lgkmcnt(8)
    v_mfma_f32_16x16x32_bf16 v[152:155], v[16:19], v[104:107], v[152:155]
    ds_read_b64_tr_b16 v[98:99], v124 offset:20736
    v_mfma_f32_16x16x32_bf16 v[176:179], v[20:23], v[104:107], v[176:179]
    ds_read_b64_tr_b16 v[100:101], v125 offset:20480
    s_add_u32 m0, s52, 57344
    s_mov_b32 s73, 14720
    buffer_load_dwordx4 v120, s[8:11], s73 offen lds
    v_mfma_f32_16x16x32_bf16 v[156:159], v[16:19], v[108:111], v[156:159]
    ds_read_b64_tr_b16 v[102:103], v125 offset:20736
    v_mfma_f32_16x16x32_bf16 v[180:183], v[20:23], v[108:111], v[180:183]
    ds_read_b64_tr_b16 v[104:105], v124 offset:22528
    v_mfma_f32_16x16x32_bf16 v[184:187], v[112:115], v[24:27], v[184:187]
    ds_read_b64_tr_b16 v[106:107], v124 offset:22784
    v_mfma_f32_16x16x32_bf16 v[188:191], v[116:119], v[24:27], v[188:191]
    ds_read_b64_tr_b16 v[108:109], v125 offset:22528
    v_mfma_f32_16x16x32_bf16 v[48:51], v[16:19], v[16:19], v[48:51]
    ds_read_b64_tr_b16 v[110:111], v125 offset:22784
    s_add_u32 m0, s52, 58368
    s_mov_b32 s73, 14720
    buffer_load_dwordx4 v121, s[8:11], s73 offen lds
    v_mfma_f32_16x16x32_bf16 v[52:55], v[20:23], v[20:23], v[52:55]
    ds_read_b64_tr_b16 v[112:113], v126 offset:18432
    v_mfma_f32_16x16x32_bf16 v[56:59], v[24:27], v[24:27], v[56:59]
    ds_read_b64_tr_b16 v[114:115], v126 offset:18688
    v_mfma_f32_16x16x32_bf16 v[60:63], v[40:43], v[16:19], v[60:63]
    ds_read_b64_tr_b16 v[116:117], v127 offset:18432
    v_mfma_f32_16x16x32_bf16 v[64:67], v[40:43], v[20:23], v[64:67]
    ds_read_b64_tr_b16 v[118:119], v127 offset:18688
    v_mfma_f32_16x16x32_bf16 v[68:71], v[40:43], v[24:27], v[68:71]
    s_add_u32 m0, s7, 116736
    s_mov_b32 s73, 384
    s_mov_b64 exec, s[54:55]
    buffer_load_dwordx4 v122, s[8:11], s73 offen lds
    s_mov_b64 exec, -1
    s_waitcnt vmcnt(8)
    s_barrier
    s_waitcnt lgkmcnt(8)
    v_mfma_f32_16x16x32_bf16 v[136:139], v[88:91], v[28:31], v[136:139]
    ds_read_b128 v[16:19], v128 offset:0
    v_mfma_f32_16x16x32_bf16 v[160:163], v[88:91], v[32:35], v[160:163]
    ds_read_b128 v[20:23], v128 offset:2048
    v_mfma_f32_16x16x32_bf16 v[140:143], v[92:95], v[28:31], v[140:143]
    ds_read_b128 v[24:27], v130 offset:0
    v_mfma_f32_16x16x32_bf16 v[164:167], v[92:95], v[32:35], v[164:167]
    ds_read_b64_tr_b16 v[88:89], v124 offset:24576
    v_mfma_f32_16x16x32_bf16 v[144:147], v[96:99], v[28:31], v[144:147]
    ds_read_b64_tr_b16 v[90:91], v124 offset:24832
    s_add_u32 m0, s51, 12288
    s_mov_b32 s73, 688128
    buffer_load_dwordx4 v123, s[12:15], s73 offen lds
    v_mfma_f32_16x16x32_bf16 v[168:171], v[96:99], v[32:35], v[168:171]
    ds_read_b64_tr_b16 v[92:93], v125 offset:24576
    v_mfma_f32_16x16x32_bf16 v[148:151], v[100:103], v[28:31], v[148:151]
    ds_read_b64_tr_b16 v[94:95], v125 offset:24832
    v_mfma_f32_16x16x32_bf16 v[172:175], v[100:103], v[32:35], v[172:175]
    ds_read_b64_tr_b16 v[96:97], v124 offset:26624
    s_waitcnt lgkmcnt(8)
    v_mfma_f32_16x16x32_bf16 v[152:155], v[28:31], v[104:107], v[152:155]
    ds_read_b64_tr_b16 v[98:99], v124 offset:26880
    v_mfma_f32_16x16x32_bf16 v[176:179], v[32:35], v[104:107], v[176:179]
    ds_read_b64_tr_b16 v[100:101], v125 offset:26624
    s_add_u32 m0, s51, 14336
    s_mov_b32 s73, 689024
    buffer_load_dwordx4 v123, s[12:15], s73 offen lds
    v_mfma_f32_16x16x32_bf16 v[156:159], v[28:31], v[108:111], v[156:159]
    ds_read_b64_tr_b16 v[102:103], v125 offset:26880
    v_mfma_f32_16x16x32_bf16 v[180:183], v[32:35], v[108:111], v[180:183]
    ds_read_b64_tr_b16 v[104:105], v124 offset:28672
    v_mfma_f32_16x16x32_bf16 v[184:187], v[112:115], v[36:39], v[184:187]
    ds_read_b64_tr_b16 v[106:107], v124 offset:28928
    v_mfma_f32_16x16x32_bf16 v[188:191], v[116:119], v[36:39], v[188:191]
    ds_read_b64_tr_b16 v[108:109], v125 offset:28672
    v_mfma_f32_16x16x32_bf16 v[48:51], v[28:31], v[28:31], v[48:51]
    ds_read_b64_tr_b16 v[110:111], v125 offset:28928
    s_add_u32 m0, s51, 16384
    s_mov_b32 s73, 689920
    buffer_load_dwordx4 v123, s[12:15], s73 offen lds
    v_mfma_f32_16x16x32_bf16 v[52:55], v[32:35], v[32:35], v[52:55]
    ds_read_b64_tr_b16 v[112:113], v126 offset:24576
    v_mfma_f32_16x16x32_bf16 v[56:59], v[36:39], v[36:39], v[56:59]
    ds_read_b64_tr_b16 v[114:115], v126 offset:24832
    v_mfma_f32_16x16x32_bf16 v[60:63], v[40:43], v[28:31], v[60:63]
    ds_read_b64_tr_b16 v[116:117], v127 offset:24576
    v_mfma_f32_16x16x32_bf16 v[64:67], v[40:43], v[32:35], v[64:67]
    ds_read_b64_tr_b16 v[118:119], v127 offset:24832
    v_mfma_f32_16x16x32_bf16 v[68:71], v[40:43], v[36:39], v[68:71]
    s_add_u32 m0, s52, 36864
    s_mov_b32 s73, 512
    buffer_load_dwordx4 v120, s[8:11], s73 offen lds
    s_waitcnt lgkmcnt(8)
    v_mfma_f32_16x16x32_bf16 v[136:139], v[88:91], v[16:19], v[136:139]
    ds_read_b128 v[28:31], v129 offset:0
    v_mfma_f32_16x16x32_bf16 v[160:163], v[88:91], v[20:23], v[160:163]
    ds_read_b128 v[32:35], v129 offset:2048
    v_mfma_f32_16x16x32_bf16 v[140:143], v[92:95], v[16:19], v[140:143]
    ds_read_b128 v[36:39], v131 offset:0
    v_mfma_f32_16x16x32_bf16 v[164:167], v[92:95], v[20:23], v[164:167]
    ds_read_b64_tr_b16 v[88:89], v124 offset:30720
    v_mfma_f32_16x16x32_bf16 v[144:147], v[96:99], v[16:19], v[144:147]
    ds_read_b64_tr_b16 v[90:91], v124 offset:30976
    s_add_u32 m0, s52, 37888
    s_mov_b32 s73, 512
    buffer_load_dwordx4 v121, s[8:11], s73 offen lds
    v_mfma_f32_16x16x32_bf16 v[168:171], v[96:99], v[20:23], v[168:171]
    ds_read_b64_tr_b16 v[92:93], v125 offset:30720
    v_mfma_f32_16x16x32_bf16 v[148:151], v[100:103], v[16:19], v[148:151]
    ds_read_b64_tr_b16 v[94:95], v125 offset:30976
    v_mfma_f32_16x16x32_bf16 v[172:175], v[100:103], v[20:23], v[172:175]
    ds_read_b64_tr_b16 v[96:97], v124 offset:32768
    s_waitcnt lgkmcnt(8)
    v_mfma_f32_16x16x32_bf16 v[152:155], v[16:19], v[104:107], v[152:155]
    ds_read_b64_tr_b16 v[98:99], v124 offset:33024
    v_mfma_f32_16x16x32_bf16 v[176:179], v[20:23], v[104:107], v[176:179]
    ds_read_b64_tr_b16 v[100:101], v125 offset:32768
    s_add_u32 m0, s52, 38912
    s_mov_b32 s73, 14848
    buffer_load_dwordx4 v120, s[8:11], s73 offen lds
    v_mfma_f32_16x16x32_bf16 v[156:159], v[16:19], v[108:111], v[156:159]
    ds_read_b64_tr_b16 v[102:103], v125 offset:33024
    v_mfma_f32_16x16x32_bf16 v[180:183], v[20:23], v[108:111], v[180:183]
    ds_read_b64_tr_b16 v[104:105], v124 offset:34816
    v_mfma_f32_16x16x32_bf16 v[184:187], v[112:115], v[24:27], v[184:187]
    ds_read_b64_tr_b16 v[106:107], v124 offset:35072
    v_mfma_f32_16x16x32_bf16 v[188:191], v[116:119], v[24:27], v[188:191]
    ds_read_b64_tr_b16 v[108:109], v125 offset:34816
    v_mfma_f32_16x16x32_bf16 v[48:51], v[16:19], v[16:19], v[48:51]
    ds_read_b64_tr_b16 v[110:111], v125 offset:35072
    s_add_u32 m0, s52, 39936
    s_mov_b32 s73, 14848
    buffer_load_dwordx4 v121, s[8:11], s73 offen lds
    v_mfma_f32_16x16x32_bf16 v[52:55], v[20:23], v[20:23], v[52:55]
    ds_read_b64_tr_b16 v[112:113], v126 offset:30720
    v_mfma_f32_16x16x32_bf16 v[56:59], v[24:27], v[24:27], v[56:59]
    ds_read_b64_tr_b16 v[114:115], v126 offset:30976
    v_mfma_f32_16x16x32_bf16 v[60:63], v[40:43], v[16:19], v[60:63]
    ds_read_b64_tr_b16 v[116:117], v127 offset:30720
    v_mfma_f32_16x16x32_bf16 v[64:67], v[40:43], v[20:23], v[64:67]
    ds_read_b64_tr_b16 v[118:119], v127 offset:30976
    v_mfma_f32_16x16x32_bf16 v[68:71], v[40:43], v[24:27], v[68:71]
    s_add_u32 m0, s7, 98304
    s_mov_b32 s73, 512
    s_mov_b64 exec, s[54:55]
    buffer_load_dwordx4 v122, s[8:11], s73 offen lds
    s_mov_b64 exec, -1
    s_waitcnt vmcnt(8)
    s_barrier
    s_waitcnt lgkmcnt(8)
    v_mfma_f32_16x16x32_bf16 v[136:139], v[88:91], v[28:31], v[136:139]
    ds_read_b128 v[16:19], v128 offset:55296
    v_mfma_f32_16x16x32_bf16 v[160:163], v[88:91], v[32:35], v[160:163]
    ds_read_b128 v[20:23], v128 offset:57344
    v_mfma_f32_16x16x32_bf16 v[140:143], v[92:95], v[28:31], v[140:143]
    ds_read_b128 v[24:27], v130 offset:55296
    v_mfma_f32_16x16x32_bf16 v[164:167], v[92:95], v[32:35], v[164:167]
    ds_read_b64_tr_b16 v[88:89], v124 offset:36864
    v_mfma_f32_16x16x32_bf16 v[144:147], v[96:99], v[28:31], v[144:147]
    ds_read_b64_tr_b16 v[90:91], v124 offset:37120
    s_add_u32 m0, s51, 24576
    s_mov_b32 s73, 860160
    buffer_load_dwordx4 v123, s[12:15], s73 offen lds
    v_mfma_f32_16x16x32_bf16 v[168:171], v[96:99], v[32:35], v[168:171]
    ds_read_b64_tr_b16 v[92:93], v125 offset:36864
    v_mfma_f32_16x16x32_bf16 v[148:151], v[100:103], v[28:31], v[148:151]
    ds_read_b64_tr_b16 v[94:95], v125 offset:37120
    v_mfma_f32_16x16x32_bf16 v[172:175], v[100:103], v[32:35], v[172:175]
    ds_read_b64_tr_b16 v[96:97], v124 offset:38912
    s_waitcnt lgkmcnt(8)
    v_mfma_f32_16x16x32_bf16 v[152:155], v[28:31], v[104:107], v[152:155]
    ds_read_b64_tr_b16 v[98:99], v124 offset:39168
    v_mfma_f32_16x16x32_bf16 v[176:179], v[32:35], v[104:107], v[176:179]
    ds_read_b64_tr_b16 v[100:101], v125 offset:38912
    s_add_u32 m0, s51, 26624
    s_mov_b32 s73, 861056
    buffer_load_dwordx4 v123, s[12:15], s73 offen lds
    v_mfma_f32_16x16x32_bf16 v[156:159], v[28:31], v[108:111], v[156:159]
    ds_read_b64_tr_b16 v[102:103], v125 offset:39168
    v_mfma_f32_16x16x32_bf16 v[180:183], v[32:35], v[108:111], v[180:183]
    ds_read_b64_tr_b16 v[104:105], v124 offset:40960
    v_mfma_f32_16x16x32_bf16 v[184:187], v[112:115], v[36:39], v[184:187]
    ds_read_b64_tr_b16 v[106:107], v124 offset:41216
    v_mfma_f32_16x16x32_bf16 v[188:191], v[116:119], v[36:39], v[188:191]
    ds_read_b64_tr_b16 v[108:109], v125 offset:40960
    v_mfma_f32_16x16x32_bf16 v[48:51], v[28:31], v[28:31], v[48:51]
    ds_read_b64_tr_b16 v[110:111], v125 offset:41216
    s_add_u32 m0, s51, 28672
    s_mov_b32 s73, 861952
    buffer_load_dwordx4 v123, s[12:15], s73 offen lds
    v_mfma_f32_16x16x32_bf16 v[52:55], v[32:35], v[32:35], v[52:55]
    ds_read_b64_tr_b16 v[112:113], v126 offset:36864
    v_mfma_f32_16x16x32_bf16 v[56:59], v[36:39], v[36:39], v[56:59]
    ds_read_b64_tr_b16 v[114:115], v126 offset:37120
    v_mfma_f32_16x16x32_bf16 v[60:63], v[40:43], v[28:31], v[60:63]
    ds_read_b64_tr_b16 v[116:117], v127 offset:36864
    v_mfma_f32_16x16x32_bf16 v[64:67], v[40:43], v[32:35], v[64:67]
    ds_read_b64_tr_b16 v[118:119], v127 offset:37120
    v_mfma_f32_16x16x32_bf16 v[68:71], v[40:43], v[36:39], v[68:71]
    s_add_u32 m0, s52, 18432
    s_mov_b32 s73, 640
    buffer_load_dwordx4 v120, s[8:11], s73 offen lds
    s_waitcnt lgkmcnt(8)
    v_mfma_f32_16x16x32_bf16 v[136:139], v[88:91], v[16:19], v[136:139]
    ds_read_b128 v[28:31], v129 offset:55296
    v_mfma_f32_16x16x32_bf16 v[160:163], v[88:91], v[20:23], v[160:163]
    ds_read_b128 v[32:35], v129 offset:57344
    v_mfma_f32_16x16x32_bf16 v[140:143], v[92:95], v[16:19], v[140:143]
    ds_read_b128 v[36:39], v131 offset:55296
    v_mfma_f32_16x16x32_bf16 v[164:167], v[92:95], v[20:23], v[164:167]
    ds_read_b64_tr_b16 v[88:89], v124 offset:43008
    v_mfma_f32_16x16x32_bf16 v[144:147], v[96:99], v[16:19], v[144:147]
    ds_read_b64_tr_b16 v[90:91], v124 offset:43264
    s_add_u32 m0, s52, 19456
    s_mov_b32 s73, 640
    buffer_load_dwordx4 v121, s[8:11], s73 offen lds
    v_mfma_f32_16x16x32_bf16 v[168:171], v[96:99], v[20:23], v[168:171]
    ds_read_b64_tr_b16 v[92:93], v125 offset:43008
    v_mfma_f32_16x16x32_bf16 v[148:151], v[100:103], v[16:19], v[148:151]
    ds_read_b64_tr_b16 v[94:95], v125 offset:43264
    v_mfma_f32_16x16x32_bf16 v[172:175], v[100:103], v[20:23], v[172:175]
    ds_read_b64_tr_b16 v[96:97], v124 offset:45056
    s_waitcnt lgkmcnt(8)
    v_mfma_f32_16x16x32_bf16 v[152:155], v[16:19], v[104:107], v[152:155]
    ds_read_b64_tr_b16 v[98:99], v124 offset:45312
    v_mfma_f32_16x16x32_bf16 v[176:179], v[20:23], v[104:107], v[176:179]
    ds_read_b64_tr_b16 v[100:101], v125 offset:45056
    s_add_u32 m0, s52, 20480
    s_mov_b32 s73, 14976
    buffer_load_dwordx4 v120, s[8:11], s73 offen lds
    v_mfma_f32_16x16x32_bf16 v[156:159], v[16:19], v[108:111], v[156:159]
    ds_read_b64_tr_b16 v[102:103], v125 offset:45312
    v_mfma_f32_16x16x32_bf16 v[180:183], v[20:23], v[108:111], v[180:183]
    ds_read_b64_tr_b16 v[104:105], v124 offset:47104
    v_mfma_f32_16x16x32_bf16 v[184:187], v[112:115], v[24:27], v[184:187]
    ds_read_b64_tr_b16 v[106:107], v124 offset:47360
    v_mfma_f32_16x16x32_bf16 v[188:191], v[116:119], v[24:27], v[188:191]
    ds_read_b64_tr_b16 v[108:109], v125 offset:47104
    v_mfma_f32_16x16x32_bf16 v[48:51], v[16:19], v[16:19], v[48:51]
    ds_read_b64_tr_b16 v[110:111], v125 offset:47360
    s_add_u32 m0, s52, 21504
    s_mov_b32 s73, 14976
    buffer_load_dwordx4 v121, s[8:11], s73 offen lds
    v_mfma_f32_16x16x32_bf16 v[52:55], v[20:23], v[20:23], v[52:55]
    ds_read_b64_tr_b16 v[112:113], v126 offset:43008
    v_mfma_f32_16x16x32_bf16 v[56:59], v[24:27], v[24:27], v[56:59]
    ds_read_b64_tr_b16 v[114:115], v126 offset:43264
    v_mfma_f32_16x16x32_bf16 v[60:63], v[40:43], v[16:19], v[60:63]
    ds_read_b64_tr_b16 v[116:117], v127 offset:43008
    v_mfma_f32_16x16x32_bf16 v[64:67], v[40:43], v[20:23], v[64:67]
    ds_read_b64_tr_b16 v[118:119], v127 offset:43264
    v_mfma_f32_16x16x32_bf16 v[68:71], v[40:43], v[24:27], v[68:71]
    s_add_u32 m0, s7, 79872
    s_mov_b32 s73, 640
    s_mov_b64 exec, s[54:55]
    buffer_load_dwordx4 v122, s[8:11], s73 offen lds
    s_mov_b64 exec, -1
    s_waitcnt vmcnt(8)
    s_barrier
    s_waitcnt lgkmcnt(8)
    v_mfma_f32_16x16x32_bf16 v[136:139], v[88:91], v[28:31], v[136:139]
    ds_read_b128 v[16:19], v128 offset:36864
    v_mfma_f32_16x16x32_bf16 v[160:163], v[88:91], v[32:35], v[160:163]
    ds_read_b128 v[20:23], v128 offset:38912
    v_mfma_f32_16x16x32_bf16 v[140:143], v[92:95], v[28:31], v[140:143]
    ds_read_b128 v[24:27], v130 offset:36864
    v_mfma_f32_16x16x32_bf16 v[164:167], v[92:95], v[32:35], v[164:167]
    ds_read_b64_tr_b16 v[88:89], v124 offset:0
    v_mfma_f32_16x16x32_bf16 v[144:147], v[96:99], v[28:31], v[144:147]
    ds_read_b64_tr_b16 v[90:91], v124 offset:256
    s_add_u32 m0, s51, 36864
    s_mov_b32 s73, 1032192
    buffer_load_dwordx4 v123, s[12:15], s73 offen lds
    v_mfma_f32_16x16x32_bf16 v[168:171], v[96:99], v[32:35], v[168:171]
    ds_read_b64_tr_b16 v[92:93], v125 offset:0
    v_mfma_f32_16x16x32_bf16 v[148:151], v[100:103], v[28:31], v[148:151]
    ds_read_b64_tr_b16 v[94:95], v125 offset:256
    v_mfma_f32_16x16x32_bf16 v[172:175], v[100:103], v[32:35], v[172:175]
    ds_read_b64_tr_b16 v[96:97], v124 offset:2048
    s_waitcnt lgkmcnt(8)
    v_mfma_f32_16x16x32_bf16 v[152:155], v[28:31], v[104:107], v[152:155]
    ds_read_b64_tr_b16 v[98:99], v124 offset:2304
    v_mfma_f32_16x16x32_bf16 v[176:179], v[32:35], v[104:107], v[176:179]
    ds_read_b64_tr_b16 v[100:101], v125 offset:2048
    s_add_u32 m0, s51, 38912
    s_mov_b32 s73, 1033088
    buffer_load_dwordx4 v123, s[12:15], s73 offen lds
    v_mfma_f32_16x16x32_bf16 v[156:159], v[28:31], v[108:111], v[156:159]
    ds_read_b64_tr_b16 v[102:103], v125 offset:2304
    v_mfma_f32_16x16x32_bf16 v[180:183], v[32:35], v[108:111], v[180:183]
    ds_read_b64_tr_b16 v[104:105], v124 offset:4096
    v_mfma_f32_16x16x32_bf16 v[184:187], v[112:115], v[36:39], v[184:187]
    ds_read_b64_tr_b16 v[106:107], v124 offset:4352
    v_mfma_f32_16x16x32_bf16 v[188:191], v[116:119], v[36:39], v[188:191]
    ds_read_b64_tr_b16 v[108:109], v125 offset:4096
    v_mfma_f32_16x16x32_bf16 v[48:51], v[28:31], v[28:31], v[48:51]
    ds_read_b64_tr_b16 v[110:111], v125 offset:4352
    s_add_u32 m0, s51, 40960
    s_mov_b32 s73, 1033984
    buffer_load_dwordx4 v123, s[12:15], s73 offen lds
    v_mfma_f32_16x16x32_bf16 v[52:55], v[32:35], v[32:35], v[52:55]
    ds_read_b64_tr_b16 v[112:113], v126 offset:0
    v_mfma_f32_16x16x32_bf16 v[56:59], v[36:39], v[36:39], v[56:59]
    ds_read_b64_tr_b16 v[114:115], v126 offset:256
    v_mfma_f32_16x16x32_bf16 v[60:63], v[40:43], v[28:31], v[60:63]
    ds_read_b64_tr_b16 v[116:117], v127 offset:0
    v_mfma_f32_16x16x32_bf16 v[64:67], v[40:43], v[32:35], v[64:67]
    ds_read_b64_tr_b16 v[118:119], v127 offset:256
    v_mfma_f32_16x16x32_bf16 v[68:71], v[40:43], v[36:39], v[68:71]
    s_add_u32 m0, s52, 0
    s_mov_b32 s73, 768
    buffer_load_dwordx4 v120, s[8:11], s73 offen lds
    s_waitcnt lgkmcnt(8)
    v_mfma_f32_16x16x32_bf16 v[136:139], v[88:91], v[16:19], v[136:139]
    ds_read_b128 v[28:31], v129 offset:36864
    v_mfma_f32_16x16x32_bf16 v[160:163], v[88:91], v[20:23], v[160:163]
    ds_read_b128 v[32:35], v129 offset:38912
    v_mfma_f32_16x16x32_bf16 v[140:143], v[92:95], v[16:19], v[140:143]
    ds_read_b128 v[36:39], v131 offset:36864
    v_mfma_f32_16x16x32_bf16 v[164:167], v[92:95], v[20:23], v[164:167]
    ds_read_b64_tr_b16 v[88:89], v124 offset:6144
    v_mfma_f32_16x16x32_bf16 v[144:147], v[96:99], v[16:19], v[144:147]
    ds_read_b64_tr_b16 v[90:91], v124 offset:6400
    s_add_u32 m0, s52, 1024
    s_mov_b32 s73, 768
    buffer_load_dwordx4 v121, s[8:11], s73 offen lds
    v_mfma_f32_16x16x32_bf16 v[168:171], v[96:99], v[20:23], v[168:171]
    ds_read_b64_tr_b16 v[92:93], v125 offset:6144
    v_mfma_f32_16x16x32_bf16 v[148:151], v[100:103], v[16:19], v[148:151]
    ds_read_b64_tr_b16 v[94:95], v125 offset:6400
    v_mfma_f32_16x16x32_bf16 v[172:175], v[100:103], v[20:23], v[172:175]
    ds_read_b64_tr_b16 v[96:97], v124 offset:8192
    s_waitcnt lgkmcnt(8)
    v_mfma_f32_16x16x32_bf16 v[152:155], v[16:19], v[104:107], v[152:155]
    ds_read_b64_tr_b16 v[98:99], v124 offset:8448
    v_mfma_f32_16x16x32_bf16 v[176:179], v[20:23], v[104:107], v[176:179]
    ds_read_b64_tr_b16 v[100:101], v125 offset:8192
    s_add_u32 m0, s52, 2048
    s_mov_b32 s73, 15104
    buffer_load_dwordx4 v120, s[8:11], s73 offen lds
    v_mfma_f32_16x16x32_bf16 v[156:159], v[16:19], v[108:111], v[156:159]
    ds_read_b64_tr_b16 v[102:103], v125 offset:8448
    v_mfma_f32_16x16x32_bf16 v[180:183], v[20:23], v[108:111], v[180:183]
    ds_read_b64_tr_b16 v[104:105], v124 offset:10240
    v_mfma_f32_16x16x32_bf16 v[184:187], v[112:115], v[24:27], v[184:187]
    ds_read_b64_tr_b16 v[106:107], v124 offset:10496
    v_mfma_f32_16x16x32_bf16 v[188:191], v[116:119], v[24:27], v[188:191]
    ds_read_b64_tr_b16 v[108:109], v125 offset:10240
    v_mfma_f32_16x16x32_bf16 v[48:51], v[16:19], v[16:19], v[48:51]
    ds_read_b64_tr_b16 v[110:111], v125 offset:10496
    s_add_u32 m0, s52, 3072
    s_mov_b32 s73, 15104
    buffer_load_dwordx4 v121, s[8:11], s73 offen lds
    v_mfma_f32_16x16x32_bf16 v[52:55], v[20:23], v[20:23], v[52:55]
    ds_read_b64_tr_b16 v[112:113], v126 offset:6144
    v_mfma_f32_16x16x32_bf16 v[56:59], v[24:27], v[24:27], v[56:59]
    ds_read_b64_tr_b16 v[114:115], v126 offset:6400
    v_mfma_f32_16x16x32_bf16 v[60:63], v[40:43], v[16:19], v[60:63]
    ds_read_b64_tr_b16 v[116:117], v127 offset:6144
    v_mfma_f32_16x16x32_bf16 v[64:67], v[40:43], v[20:23], v[64:67]
    ds_read_b64_tr_b16 v[118:119], v127 offset:6400
    v_mfma_f32_16x16x32_bf16 v[68:71], v[40:43], v[24:27], v[68:71]
    s_add_u32 m0, s7, 61440
    s_mov_b32 s73, 768
    s_mov_b64 exec, s[54:55]
    buffer_load_dwordx4 v122, s[8:11], s73 offen lds
    s_mov_b64 exec, -1
    v_mov_b32 v7, 0
    buffer_load_dword v6, v7, s[44:47], 0 offen sc1
    s_lshr_b32 s68, s2, 3
    s_lshl_b32 s68, s68, 2
    s_add_u32 s68, s68, s3
    v_lshlrev_b32 v219, 7, v1
    s_mul_i32 s86, s68, 3200
    s_mov_b64 exec, 0x1ffffff
    buffer_load_dword v234, v219, s[16:19], s86 offen
    s_mov_b64 exec, -1
    v_lshrrev_b32 v219, 2, v1
    v_mul_u32_u24 v219, 3584, v219
    v_and_b32 v220, 3, v1
    v_lshl_add_u32 v219, v220, 7, v219
    s_mul_i32 s68, s68, 57344
    s_and_b32 s69, s2, 7
    s_mul_i32 s86, s69, 3
    s_add_u32 s86, s86, 4
    s_lshl_b32 s87, s69, 2
    s_min_u32 s86, s86, s87
    s_lshl_b32 s86, s86, 7
    s_add_u32 s86, s86, s68
    s_cmp_lt_u32 s69, 4
    s_cselect_b32 exec_lo, -1, 0x77777777
    s_cselect_b32 exec_hi, -1, 0x77777777
    buffer_load_dword v235, v219, s[20:23], s86 offen
    s_mov_b64 exec, -1
    s_waitcnt vmcnt(11)
    s_barrier
    s_waitcnt lgkmcnt(8)
    v_mfma_f32_16x16x32_bf16 v[136:139], v[88:91], v[28:31], v[136:139]
    ds_read_b128 v[16:19], v128 offset:18432
    v_mfma_f32_16x16x32_bf16 v[160:163], v[88:91], v[32:35], v[160:163]
    ds_read_b128 v[20:23], v128 offset:20480
    v_mfma_f32_16x16x32_bf16 v[140:143], v[92:95], v[28:31], v[140:143]
    ds_read_b128 v[24:27], v130 offset:18432
    v_mfma_f32_16x16x32_bf16 v[164:167], v[92:95], v[32:35], v[164:167]
    ds_read_b64_tr_b16 v[88:89], v124 offset:12288
    v_mfma_f32_16x16x32_bf16 v[144:147], v[96:99], v[28:31], v[144:147]
    ds_read_b64_tr_b16 v[90:91], v124 offset:12544
    v_mfma_f32_16x16x32_bf16 v[168:171], v[96:99], v[32:35], v[168:171]
    ds_read_b64_tr_b16 v[92:93], v125 offset:12288
    v_mfma_f32_16x16x32_bf16 v[148:151], v[100:103], v[28:31], v[148:151]
    ds_read_b64_tr_b16 v[94:95], v125 offset:12544
    v_mfma_f32_16x16x32_bf16 v[172:175], v[100:103], v[32:35], v[172:175]
    ds_read_b64_tr_b16 v[96:97], v124 offset:14336
    s_waitcnt lgkmcnt(8)
    v_mfma_f32_16x16x32_bf16 v[152:155], v[28:31], v[104:107], v[152:155]
    ds_read_b64_tr_b16 v[98:99], v124 offset:14592
    v_mfma_f32_16x16x32_bf16 v[176:179], v[32:35], v[104:107], v[176:179]
    ds_read_b64_tr_b16 v[100:101], v125 offset:14336
    v_mfma_f32_16x16x32_bf16 v[156:159], v[28:31], v[108:111], v[156:159]
    ds_read_b64_tr_b16 v[102:103], v125 offset:14592
    v_mfma_f32_16x16x32_bf16 v[180:183], v[32:35], v[108:111], v[180:183]
    ds_read_b64_tr_b16 v[104:105], v124 offset:16384
    v_mfma_f32_16x16x32_bf16 v[184:187], v[112:115], v[36:39], v[184:187]
    ds_read_b64_tr_b16 v[106:107], v124 offset:16640
    v_mfma_f32_16x16x32_bf16 v[188:191], v[116:119], v[36:39], v[188:191]
    ds_read_b64_tr_b16 v[108:109], v125 offset:16384
    v_mfma_f32_16x16x32_bf16 v[48:51], v[28:31], v[28:31], v[48:51]
    ds_read_b64_tr_b16 v[110:111], v125 offset:16640
    v_mfma_f32_16x16x32_bf16 v[52:55], v[32:35], v[32:35], v[52:55]
    ds_read_b64_tr_b16 v[112:113], v126 offset:12288
    v_mfma_f32_16x16x32_bf16 v[56:59], v[36:39], v[36:39], v[56:59]
    ds_read_b64_tr_b16 v[114:115], v126 offset:12544
    v_mfma_f32_16x16x32_bf16 v[60:63], v[40:43], v[28:31], v[60:63]
    ds_read_b64_tr_b16 v[116:117], v127 offset:12288
    v_mfma_f32_16x16x32_bf16 v[64:67], v[40:43], v[32:35], v[64:67]
    ds_read_b64_tr_b16 v[118:119], v127 offset:12544
    v_mfma_f32_16x16x32_bf16 v[68:71], v[40:43], v[36:39], v[68:71]
    s_waitcnt lgkmcnt(8)
    v_mfma_f32_16x16x32_bf16 v[136:139], v[88:91], v[16:19], v[136:139]
    ds_read_b128 v[28:31], v129 offset:18432
    v_mfma_f32_16x16x32_bf16 v[160:163], v[88:91], v[20:23], v[160:163]
    ds_read_b128 v[32:35], v129 offset:20480
    v_mfma_f32_16x16x32_bf16 v[140:143], v[92:95], v[16:19], v[140:143]
    ds_read_b128 v[36:39], v131 offset:18432
    v_mfma_f32_16x16x32_bf16 v[164:167], v[92:95], v[20:23], v[164:167]
    ds_read_b64_tr_b16 v[88:89], v124 offset:18432
    v_mfma_f32_16x16x32_bf16 v[144:147], v[96:99], v[16:19], v[144:147]
    ds_read_b64_tr_b16 v[90:91], v124 offset:18688
    v_mfma_f32_16x16x32_bf16 v[168:171], v[96:99], v[20:23], v[168:171]
    ds_read_b64_tr_b16 v[92:93], v125 offset:18432
    v_mfma_f32_16x16x32_bf16 v[148:151], v[100:103], v[16:19], v[148:151]
    ds_read_b64_tr_b16 v[94:95], v125 offset:18688
    v_mfma_f32_16x16x32_bf16 v[172:175], v[100:103], v[20:23], v[172:175]
    ds_read_b64_tr_b16 v[96:97], v124 offset:20480
    s_waitcnt lgkmcnt(8)
    v_mfma_f32_16x16x32_bf16 v[152:155], v[16:19], v[104:107], v[152:155]
    ds_read_b64_tr_b16 v[98:99], v124 offset:20736
    v_mfma_f32_16x16x32_bf16 v[176:179], v[20:23], v[104:107], v[176:179]
    ds_read_b64_tr_b16 v[100:101], v125 offset:20480
    v_mfma_f32_16x16x32_bf16 v[156:159], v[16:19], v[108:111], v[156:159]
    ds_read_b64_tr_b16 v[102:103], v125 offset:20736
    v_mfma_f32_16x16x32_bf16 v[180:183], v[20:23], v[108:111], v[180:183]
    ds_read_b64_tr_b16 v[104:105], v124 offset:22528
    v_mfma_f32_16x16x32_bf16 v[184:187], v[112:115], v[24:27], v[184:187]
    ds_read_b64_tr_b16 v[106:107], v124 offset:22784
    v_mfma_f32_16x16x32_bf16 v[188:191], v[116:119], v[24:27], v[188:191]
    ds_read_b64_tr_b16 v[108:109], v125 offset:22528
    v_mfma_f32_16x16x32_bf16 v[48:51], v[16:19], v[16:19], v[48:51]
    ds_read_b64_tr_b16 v[110:111], v125 offset:22784
    v_mfma_f32_16x16x32_bf16 v[52:55], v[20:23], v[20:23], v[52:55]
    ds_read_b64_tr_b16 v[112:113], v126 offset:18432
    v_mfma_f32_16x16x32_bf16 v[56:59], v[24:27], v[24:27], v[56:59]
    ds_read_b64_tr_b16 v[114:115], v126 offset:18688
    v_mfma_f32_16x16x32_bf16 v[60:63], v[40:43], v[16:19], v[60:63]
    ds_read_b64_tr_b16 v[116:117], v127 offset:18432
    v_mfma_f32_16x16x32_bf16 v[64:67], v[40:43], v[20:23], v[64:67]
    ds_read_b64_tr_b16 v[118:119], v127 offset:18688
    v_mfma_f32_16x16x32_bf16 v[68:71], v[40:43], v[24:27], v[68:71]
    s_waitcnt vmcnt(3)
    s_barrier
    s_waitcnt lgkmcnt(8)
    v_mfma_f32_16x16x32_bf16 v[136:139], v[88:91], v[28:31], v[136:139]
    ds_read_b128 v[16:19], v128 offset:0
    v_mfma_f32_16x16x32_bf16 v[160:163], v[88:91], v[32:35], v[160:163]
    ds_read_b128 v[20:23], v128 offset:2048
    v_mfma_f32_16x16x32_bf16 v[140:143], v[92:95], v[28:31], v[140:143]
    ds_read_b128 v[24:27], v130 offset:0
    v_mfma_f32_16x16x32_bf16 v[164:167], v[92:95], v[32:35], v[164:167]
    ds_read_b64_tr_b16 v[88:89], v124 offset:24576
    v_mfma_f32_16x16x32_bf16 v[144:147], v[96:99], v[28:31], v[144:147]
    ds_read_b64_tr_b16 v[90:91], v124 offset:24832
    v_mfma_f32_16x16x32_bf16 v[168:171], v[96:99], v[32:35], v[168:171]
    ds_read_b64_tr_b16 v[92:93], v125 offset:24576
    v_mfma_f32_16x16x32_bf16 v[148:151], v[100:103], v[28:31], v[148:151]
    ds_read_b64_tr_b16 v[94:95], v125 offset:24832
    v_mfma_f32_16x16x32_bf16 v[172:175], v[100:103], v[32:35], v[172:175]
    ds_read_b64_tr_b16 v[96:97], v124 offset:26624
    s_waitcnt lgkmcnt(8)
    v_mfma_f32_16x16x32_bf16 v[152:155], v[28:31], v[104:107], v[152:155]
    ds_read_b64_tr_b16 v[98:99], v124 offset:26880
    v_mfma_f32_16x16x32_bf16 v[176:179], v[32:35], v[104:107], v[176:179]
    ds_read_b64_tr_b16 v[100:101], v125 offset:26624
    v_mfma_f32_16x16x32_bf16 v[156:159], v[28:31], v[108:111], v[156:159]
    ds_read_b64_tr_b16 v[102:103], v125 offset:26880
    v_mfma_f32_16x16x32_bf16 v[180:183], v[32:35], v[108:111], v[180:183]
    ds_read_b64_tr_b16 v[104:105], v124 offset:28672
    v_mfma_f32_16x16x32_bf16 v[184:187], v[112:115], v[36:39], v[184:187]
    ds_read_b64_tr_b16 v[106:107], v124 offset:28928
    v_mfma_f32_16x16x32_bf16 v[188:191], v[116:119], v[36:39], v[188:191]
    ds_read_b64_tr_b16 v[108:109], v125 offset:28672
    v_mfma_f32_16x16x32_bf16 v[48:51], v[28:31], v[28:31], v[48:51]
    ds_read_b64_tr_b16 v[110:111], v125 offset:28928
    v_mfma_f32_16x16x32_bf16 v[52:55], v[32:35], v[32:35], v[52:55]
    ds_read_b64_tr_b16 v[112:113], v126 offset:24576
    v_mfma_f32_16x16x32_bf16 v[56:59], v[36:39], v[36:39], v[56:59]
    ds_read_b64_tr_b16 v[114:115], v126 offset:24832
    v_mfma_f32_16x16x32_bf16 v[60:63], v[40:43], v[28:31], v[60:63]
    ds_read_b64_tr_b16 v[116:117], v127 offset:24576
    v_mfma_f32_16x16x32_bf16 v[64:67], v[40:43], v[32:35], v[64:67]
    ds_read_b64_tr_b16 v[118:119], v127 offset:24832
    v_mfma_f32_16x16x32_bf16 v[68:71], v[40:43], v[36:39], v[68:71]
    s_waitcnt lgkmcnt(8)
    v_mfma_f32_16x16x32_bf16 v[136:139], v[88:91], v[16:19], v[136:139]
    ds_read_b128 v[28:31], v129 offset:0
    v_mfma_f32_16x16x32_bf16 v[160:163], v[88:91], v[20:23], v[160:163]
    ds_read_b128 v[32:35], v129 offset:2048
    v_mfma_f32_16x16x32_bf16 v[140:143], v[92:95], v[16:19], v[140:143]
    ds_read_b128 v[36:39], v131 offset:0
    v_mfma_f32_16x16x32_bf16 v[164:167], v[92:95], v[20:23], v[164:167]
    ds_read_b64_tr_b16 v[88:89], v124 offset:30720
    v_mfma_f32_16x16x32_bf16 v[144:147], v[96:99], v[16:19], v[144:147]
    ds_read_b64_tr_b16 v[90:91], v124 offset:30976
    v_mfma_f32_16x16x32_bf16 v[168:171], v[96:99], v[20:23], v[168:171]
    ds_read_b64_tr_b16 v[92:93], v125 offset:30720
    v_mfma_f32_16x16x32_bf16 v[148:151], v[100:103], v[16:19], v[148:151]
    ds_read_b64_tr_b16 v[94:95], v125 offset:30976
    v_mfma_f32_16x16x32_bf16 v[172:175], v[100:103], v[20:23], v[172:175]
    ds_read_b64_tr_b16 v[96:97], v124 offset:32768
    s_waitcnt lgkmcnt(8)
    v_mfma_f32_16x16x32_bf16 v[152:155], v[16:19], v[104:107], v[152:155]
    ds_read_b64_tr_b16 v[98:99], v124 offset:33024
    v_mfma_f32_16x16x32_bf16 v[176:179], v[20:23], v[104:107], v[176:179]
    ds_read_b64_tr_b16 v[100:101], v125 offset:32768
    v_mfma_f32_16x16x32_bf16 v[156:159], v[16:19], v[108:111], v[156:159]
    ds_read_b64_tr_b16 v[102:103], v125 offset:33024
    v_mfma_f32_16x16x32_bf16 v[180:183], v[20:23], v[108:111], v[180:183]
    ds_read_b64_tr_b16 v[104:105], v124 offset:34816
    v_mfma_f32_16x16x32_bf16 v[184:187], v[112:115], v[24:27], v[184:187]
    ds_read_b64_tr_b16 v[106:107], v124 offset:35072
    v_mfma_f32_16x16x32_bf16 v[188:191], v[116:119], v[24:27], v[188:191]
    ds_read_b64_tr_b16 v[108:109], v125 offset:34816
    v_mfma_f32_16x16x32_bf16 v[48:51], v[16:19], v[16:19], v[48:51]
    ds_read_b64_tr_b16 v[110:111], v125 offset:35072
    v_mfma_f32_16x16x32_bf16 v[52:55], v[20:23], v[20:23], v[52:55]
    ds_read_b64_tr_b16 v[112:113], v126 offset:30720
    v_mfma_f32_16x16x32_bf16 v[56:59], v[24:27], v[24:27], v[56:59]
    ds_read_b64_tr_b16 v[114:115], v126 offset:30976
    v_mfma_f32_16x16x32_bf16 v[60:63], v[40:43], v[16:19], v[60:63]
    ds_read_b64_tr_b16 v[116:117], v127 offset:30720
    v_mfma_f32_16x16x32_bf16 v[64:67], v[40:43], v[20:23], v[64:67]
    ds_read_b64_tr_b16 v[118:119], v127 offset:30976
    v_mfma_f32_16x16x32_bf16 v[68:71], v[40:43], v[24:27], v[68:71]
    s_waitcnt lgkmcnt(9)
    v_mfma_f32_16x16x32_bf16 v[48:51], v[28:31], v[28:31], v[48:51]
    v_mfma_f32_16x16x32_bf16 v[52:55], v[32:35], v[32:35], v[52:55]
    v_mfma_f32_16x16x32_bf16 v[56:59], v[36:39], v[36:39], v[56:59]
    v_mfma_f32_16x16x32_bf16 v[60:63], v[40:43], v[28:31], v[60:63]
    v_mfma_f32_16x16x32_bf16 v[64:67], v[40:43], v[32:35], v[64:67]
    v_mfma_f32_16x16x32_bf16 v[68:71], v[40:43], v[36:39], v[68:71]
    s_waitcnt lgkmcnt(2)
    v_mfma_f32_16x16x32_bf16 v[184:187], v[112:115], v[36:39], v[184:187]
    s_waitcnt lgkmcnt(0)
    v_mfma_f32_16x16x32_bf16 v[188:191], v[116:119], v[36:39], v[188:191]
    v_mfma_f32_16x16x32_bf16 v[144:147], v[96:99], v[28:31], v[144:147]
    v_cndmask_b32 v48, v48, v49, s[88:89]
    v_cndmask_b32 v52, v52, v53, s[88:89]
    v_cndmask_b32 v56, v56, v57, s[88:89]
    v_mfma_f32_16x16x32_bf16 v[168:171], v[96:99], v[32:35], v[168:171]
    v_cndmask_b32 v48, v48, v50, s[90:91]
    v_cndmask_b32 v52, v52, v54, s[90:91]
    v_cndmask_b32 v56, v56, v58, s[90:91]
    v_mfma_f32_16x16x32_bf16 v[148:151], v[100:103], v[28:31], v[148:151]
    v_cndmask_b32 v48, v48, v51, s[92:93]
    v_cndmask_b32 v52, v52, v55, s[92:93]
    v_cndmask_b32 v56, v56, v59, s[92:93]
    v_mfma_f32_16x16x32_bf16 v[172:175], v[100:103], v[32:35], v[172:175]
    v_mul_f32 v133, 0x3b124925, v60
    v_mul_f32 v135, 0x3b124925, v64
    v_mul_f32 v85, 0x3b124925, v68
    v_mfma_f32_16x16x32_bf16 v[152:155], v[28:31], v[104:107], v[152:155]
    v_mul_f32 v132, v133, v133
    v_mul_f32 v134, v135, v135
    v_mul_f32 v84, v85, v85
    v_mfma_f32_16x16x32_bf16 v[176:179], v[32:35], v[104:107], v[176:179]
    v_mul_f32 v48, 0x3b124925, v48
    v_mul_f32 v52, 0x3b124925, v52
    v_mul_f32 v56, 0x3b124925, v56
    v_mfma_f32_16x16x32_bf16 v[156:159], v[28:31], v[108:111], v[156:159]
    s_mov_b32 exec_lo, 0x00010001
    s_mov_b32 exec_hi, 0x00010001
    ds_write_b128 v73, v[184:187] offset:128
    ds_write_b128 v74, v[188:191] offset:0
    s_mov_b64 exec, -1
    v_sub_f32 v132, v48, v132
    v_sub_f32_e64 v134, v52, v134
    v_mfma_f32_16x16x32_bf16 v[180:183], v[32:35], v[108:111], v[180:183]
    v_sub_f32 v84, v56, v84
    v_max_f32 v132, 0, v132
    v_max_f32_e64 v134, 0, v134
    v_mfma_f32_16x16x32_bf16 v[136:139], v[88:91], v[28:31], v[136:139]
    v_max_f32_e64 v84, 0, v84
    v_add_f32 v132, 0x3727c5ac, v132
    v_add_f32 v134, 0x3727c5ac, v134
    v_mfma_f32_16x16x32_bf16 v[160:163], v[88:91], v[32:35], v[160:163]
    v_add_f32 v84, 0x3727c5ac, v84
    v_rsq_f32 v132, v132
    v_rsq_f32 v134, v134
    v_mfma_f32_16x16x32_bf16 v[140:143], v[92:95], v[28:31], v[140:143]
    v_rsq_f32_e64 v84, v84
    s_mov_b32 exec_lo, 0x00f0000f
    s_mov_b32 exec_hi, 0xf0000f00
    ds_write2_b32 v75, v132, v133 offset0:128 offset1:144
    ds_write2_b32 v75, v134, v135 offset0:160 offset1:176
    ds_write2_b32 v75, v84, v85 offset0:192 offset1:208
    s_mov_b64 exec, -1
    v_mov_b32_dpp v224, v184 row_newbcast:0 row_mask:0xf bank_mask:0xf
    v_mfma_f32_16x16x32_bf16 v[164:167], v[92:95], v[32:35], v[164:167]
    v_mov_b32_dpp v225, v185 row_newbcast:0 row_mask:0xf bank_mask:0xf
    v_mov_b32_dpp v226, v186 row_newbcast:0 row_mask:0xf bank_mask:0xf
    v_mov_b32_dpp v227, v187 row_newbcast:0 row_mask:0xf bank_mask:0xf
    v_fma_f32 v224, -v224, v85, v184
    v_fma_f32 v225, -v225, v85, v185
    v_fma_f32 v226, -v226, v85, v186
    v_fma_f32 v227, -v227, v85, v187
    s_cmp_eq_u32 s49, 15
    s_cselect_b32 s88, 0xffff0000, -1
    s_mov_b32 s89, -1
    s_mov_b32 s90, -1
    s_cselect_b32 s91, -1, 0xffff
    s_waitcnt lgkmcnt(0)
    s_barrier
    ds_read_b32 v134, v75 offset:640
    ds_read_b32 v84, v75 offset:768
    ds_read_b32 v132, v75 offset:512
    ds_read_b128 v[56:59], v72 offset:128
    ds_read_b128 v[60:63], v72 offset:192
    ds_read_b32 v64, v77 offset:256
    ds_read_b32 v65, v77 offset:320
    ds_read_b128 v[44:47], v76 offset:704
    ds_read_b128 v[40:43], v76 offset:640
    ds_read_b128 v[36:39], v76 offset:576
    ds_read_b128 v[32:35], v76 offset:512
    ds_read_b128 v[48:51], v72 offset:0
    ds_read_b128 v[52:55], v72 offset:64
    s_waitcnt lgkmcnt(9)
    v_pk_fma_f32 v[168:169], v[56:57], v[134:135], v[168:169] op_sel:[0,1,0] op_sel_hi:[1,1,1] neg_lo:[0,1,0] neg_hi:[0,1,0]
    v_pk_fma_f32 v[170:171], v[58:59], v[134:135], v[170:171] op_sel:[0,1,0] op_sel_hi:[1,1,1] neg_lo:[0,1,0] neg_hi:[0,1,0]
    v_pk_mul_f32 v[168:169], v[168:169], v[134:135] op_sel:[0,0] op_sel_hi:[1,0]
    v_pk_mul_f32 v[170:171], v[170:171], v[134:135] op_sel:[0,0] op_sel_hi:[1,0]
    v_cvt_pk_bf16_f32 v104, v168, v169
    v_cvt_pk_bf16_f32 v105, v170, v171
    s_waitcnt lgkmcnt(8)
    v_pk_fma_f32 v[172:173], v[60:61], v[134:135], v[172:173] op_sel:[0,1,0] op_sel_hi:[1,1,1] neg_lo:[0,1,0] neg_hi:[0,1,0]
    v_pk_fma_f32 v[174:175], v[62:63], v[134:135], v[174:175] op_sel:[0,1,0] op_sel_hi:[1,1,1] neg_lo:[0,1,0] neg_hi:[0,1,0]
    v_pk_mul_f32 v[172:173], v[172:173], v[134:135] op_sel:[0,0] op_sel_hi:[1,0]
    v_pk_mul_f32 v[174:175], v[174:175], v[134:135] op_sel:[0,0] op_sel_hi:[1,0]
    v_cvt_pk_bf16_f32 v106, v172, v173
    v_cvt_pk_bf16_f32 v107, v174, v175
    ds_write_b128 v78, v[104:107] offset:4096
    v_pk_mul_f32 v[224:225], v[224:225], v[84:85] op_sel_hi:[1,0]
    v_pk_mul_f32 v[226:227], v[226:227], v[84:85] op_sel_hi:[1,0]
    v_cvt_pk_bf16_f32 v224, v224, v225
    v_cvt_pk_bf16_f32 v226, v226, v227
    ds_write_b16 v80, v224 offset:2048
    ds_write_b16_d16_hi v81, v224 offset:2048
    ds_write_b16 v82, v226 offset:2048
    ds_write_b16_d16_hi v83, v226 offset:2048
    s_waitcnt lgkmcnt(10)
    v_pk_fma_f32 v[176:177], v[44:45], v[64:65], v[176:177] op_sel:[0,0,0] op_sel_hi:[1,0,1] neg_lo:[0,1,0] neg_hi:[0,1,0]
    v_pk_fma_f32 v[178:179], v[46:47], v[64:65], v[178:179] op_sel:[0,0,0] op_sel_hi:[1,0,1] neg_lo:[0,1,0] neg_hi:[0,1,0]
    s_waitcnt lgkmcnt(9)
    v_pk_mul_f32 v[176:177], v[176:177], v[40:41]
    v_pk_mul_f32 v[178:179], v[178:179], v[42:43]
    v_cvt_pk_bf16_f32 v112, v176, v177
    v_cvt_pk_bf16_f32 v113, v178, v179
    v_pk_fma_f32 v[180:181], v[44:45], v[64:65], v[180:181] op_sel:[0,1,0] op_sel_hi:[1,1,1] neg_lo:[0,1,0] neg_hi:[0,1,0]
    v_pk_fma_f32 v[182:183], v[46:47], v[64:65], v[182:183] op_sel:[0,1,0] op_sel_hi:[1,1,1] neg_lo:[0,1,0] neg_hi:[0,1,0]
    v_pk_mul_f32 v[180:181], v[180:181], v[40:41]
    v_pk_mul_f32 v[182:183], v[182:183], v[42:43]
    v_cvt_pk_bf16_f32 v118, v180, v181
    v_cvt_pk_bf16_f32 v119, v182, v183
    ds_write_b64 v78, v[112:113] offset:5120
    ds_write_b64 v78, v[118:119] offset:5128
    v_mul_f32 v68, 0x3e8b97f6, v132
    v_mul_f32 v70, 0x3e8b97f6, v134
    v_cndmask_b32 v69, 0, v68, s[90:91]
    v_cndmask_b32 v68, 0, v68, s[88:89]
    v_cndmask_b32 v71, 0, v70, s[90:91]
    v_cndmask_b32 v70, 0, v70, s[88:89]
    v_pk_fma_f32 v[144:145], v[56:57], v[132:133], v[144:145] op_sel:[0,1,0] op_sel_hi:[1,1,1] neg_lo:[0,1,0] neg_hi:[0,1,0]
    v_pk_fma_f32 v[146:147], v[58:59], v[132:133], v[146:147] op_sel:[0,1,0] op_sel_hi:[1,1,1] neg_lo:[0,1,0] neg_hi:[0,1,0]
    v_pk_mul_f32 v[144:145], v[144:145], v[132:133] op_sel:[0,0] op_sel_hi:[1,0]
    v_pk_mul_f32 v[146:147], v[146:147], v[132:133] op_sel:[0,0] op_sel_hi:[1,0]
    v_cvt_pk_bf16_f32 v100, v144, v145
    v_cvt_pk_bf16_f32 v101, v146, v147
    v_pk_fma_f32 v[148:149], v[60:61], v[132:133], v[148:149] op_sel:[0,1,0] op_sel_hi:[1,1,1] neg_lo:[0,1,0] neg_hi:[0,1,0]
    v_pk_fma_f32 v[150:151], v[62:63], v[132:133], v[150:151] op_sel:[0,1,0] op_sel_hi:[1,1,1] neg_lo:[0,1,0] neg_hi:[0,1,0]
    v_pk_mul_f32 v[148:149], v[148:149], v[132:133] op_sel:[0,0] op_sel_hi:[1,0]
    v_pk_mul_f32 v[150:151], v[150:151], v[132:133] op_sel:[0,0] op_sel_hi:[1,0]
    v_cvt_pk_bf16_f32 v102, v148, v149
    v_cvt_pk_bf16_f32 v103, v150, v151
    s_waitcnt lgkmcnt(0)
    s_barrier
    ds_read_b128 v[96:99], v78 offset:2048
    ds_read_b64 v[108:109], v78 offset:3072
    ds_read_b64 v[114:115], v78 offset:3080
    v_pk_fma_f32 v[160:161], v[48:49], v[134:135], v[160:161] op_sel:[0,1,0] op_sel_hi:[1,1,1] neg_lo:[0,1,0] neg_hi:[0,1,0]
    v_pk_fma_f32 v[162:163], v[50:51], v[134:135], v[162:163] op_sel:[0,1,0] op_sel_hi:[1,1,1] neg_lo:[0,1,0] neg_hi:[0,1,0]
    v_pk_mul_f32 v[160:161], v[160:161], v[70:71] op_sel:[0,0] op_sel_hi:[1,0]
    v_pk_mul_f32 v[162:163], v[162:163], v[70:71] op_sel:[0,0] op_sel_hi:[1,0]
    v_cvt_pk_bf16_f32 v92, v160, v161
    v_cvt_pk_bf16_f32 v93, v162, v163
    v_pk_fma_f32 v[164:165], v[52:53], v[134:135], v[164:165] op_sel:[0,1,0] op_sel_hi:[1,1,1] neg_lo:[0,1,0] neg_hi:[0,1,0]
    v_pk_fma_f32 v[166:167], v[54:55], v[134:135], v[166:167] op_sel:[0,1,0] op_sel_hi:[1,1,1] neg_lo:[0,1,0] neg_hi:[0,1,0]
    v_pk_mul_f32 v[164:165], v[164:165], v[70:71] op_sel:[0,1] op_sel_hi:[1,1]
    v_pk_mul_f32 v[166:167], v[166:167], v[70:71] op_sel:[0,1] op_sel_hi:[1,1]
    v_cvt_pk_bf16_f32 v94, v164, v165
    v_cvt_pk_bf16_f32 v95, v166, v167
    s_nop 1
    v_mfma_f32_16x16x32_bf16 v[24:27], v[100:103], v[92:95], v[240:243]
    v_mfma_f32_16x16x32_bf16 v[28:31], v[104:107], v[92:95], v[244:247]
    v_pk_fma_f32 v[136:137], v[48:49], v[132:133], v[136:137] op_sel:[0,1,0] op_sel_hi:[1,1,1] neg_lo:[0,1,0] neg_hi:[0,1,0]
    v_pk_fma_f32 v[138:139], v[50:51], v[132:133], v[138:139] op_sel:[0,1,0] op_sel_hi:[1,1,1] neg_lo:[0,1,0] neg_hi:[0,1,0]
    v_pk_mul_f32 v[136:137], v[136:137], v[68:69] op_sel:[0,0] op_sel_hi:[1,0]
    v_pk_mul_f32 v[138:139], v[138:139], v[68:69] op_sel:[0,0] op_sel_hi:[1,0]
    v_cvt_pk_bf16_f32 v88, v136, v137
    v_cvt_pk_bf16_f32 v89, v138, v139
    v_pk_fma_f32 v[140:141], v[52:53], v[132:133], v[140:141] op_sel:[0,1,0] op_sel_hi:[1,1,1] neg_lo:[0,1,0] neg_hi:[0,1,0]
    v_pk_fma_f32 v[142:143], v[54:55], v[132:133], v[142:143] op_sel:[0,1,0] op_sel_hi:[1,1,1] neg_lo:[0,1,0] neg_hi:[0,1,0]
    v_pk_mul_f32 v[140:141], v[140:141], v[68:69] op_sel:[0,1] op_sel_hi:[1,1]
    v_pk_mul_f32 v[142:143], v[142:143], v[68:69] op_sel:[0,1] op_sel_hi:[1,1]
    v_cvt_pk_bf16_f32 v90, v140, v141
    v_cvt_pk_bf16_f32 v91, v142, v143
    s_waitcnt lgkmcnt(2)
    s_nop 0
    v_mfma_f32_16x16x32_bf16 v[16:19], v[96:99], v[88:91], v[248:251]
    v_mfma_f32_16x16x32_bf16 v[20:23], v[100:103], v[88:91], v[244:247]
    v_pk_fma_f32 v[152:153], v[36:37], v[64:65], v[152:153] op_sel:[0,0,0] op_sel_hi:[1,0,1] neg_lo:[0,1,0] neg_hi:[0,1,0]
    v_pk_fma_f32 v[154:155], v[38:39], v[64:65], v[154:155] op_sel:[0,0,0] op_sel_hi:[1,0,1] neg_lo:[0,1,0] neg_hi:[0,1,0]
    v_pk_mul_f32 v[152:153], v[152:153], v[32:33]
    v_pk_mul_f32 v[154:155], v[154:155], v[34:35]
    v_cvt_pk_bf16_f32 v110, v152, v153
    v_cvt_pk_bf16_f32 v111, v154, v155
    v_pk_fma_f32 v[156:157], v[36:37], v[64:65], v[156:157] op_sel:[0,1,0] op_sel_hi:[1,1,1] neg_lo:[0,1,0] neg_hi:[0,1,0]
    v_pk_fma_f32 v[158:159], v[38:39], v[64:65], v[158:159] op_sel:[0,1,0] op_sel_hi:[1,1,1] neg_lo:[0,1,0] neg_hi:[0,1,0]
    v_pk_mul_f32 v[156:157], v[156:157], v[32:33]
    v_pk_mul_f32 v[158:159], v[158:159], v[34:35]
    v_cvt_pk_bf16_f32 v116, v156, v157
    v_cvt_pk_bf16_f32 v117, v158, v159
    v_max3_f32 v137, v24, v25, v26
    v_max3_f32 v139, v27, v28, v29
    v_max3_f32 v137, v137, v30, v31
    v_max_f32 v137, v137, v139
    v_max3_f32 v136, v16, v17, v18
    v_max3_f32 v138, v19, v20, v21
    v_max3_f32 v136, v136, v22, v23
    v_max_f32 v136, v136, v138
    v_mov_b32 v138, v136
    v_mov_b32 v139, v137
    s_nop 0
    v_permlane32_swap_b32 v136, v138
    v_permlane32_swap_b32 v137, v139
    v_max_f32 v136, v136, v138
    v_max_f32 v137, v137, v139
    v_mov_b32 v138, v136
    v_mov_b32 v139, v137
    s_nop 0
    v_permlane16_swap_b32 v136, v138
    v_permlane16_swap_b32 v137, v139
    v_max_f32 v136, v136, v138
    v_max_f32_e64 v137, v137, v139
    v_pk_add_f32 v[24:25], v[24:25], v[136:137] op_sel:[0,1] op_sel_hi:[1,1] neg_lo:[0,1] neg_hi:[0,1]
    v_pk_add_f32 v[26:27], v[26:27], v[136:137] op_sel:[0,1] op_sel_hi:[1,1] neg_lo:[0,1] neg_hi:[0,1]
    v_pk_add_f32 v[28:29], v[28:29], v[136:137] op_sel:[0,1] op_sel_hi:[1,1] neg_lo:[0,1] neg_hi:[0,1]
    v_pk_add_f32 v[30:31], v[30:31], v[136:137] op_sel:[0,1] op_sel_hi:[1,1] neg_lo:[0,1] neg_hi:[0,1]
    v_exp_f32 v24, v24
    v_exp_f32 v25, v25
    v_exp_f32 v26, v26
    v_exp_f32 v27, v27
    v_exp_f32 v28, v28
    v_exp_f32 v29, v29
    v_exp_f32_e64 v30, v30
    v_exp_f32 v31, v31
    v_cvt_pk_bf16_f32 v148, v24, v25
    v_cvt_pk_bf16_f32 v149, v26, v27
    v_cvt_pk_bf16_f32 v150, v28, v29
    v_cvt_pk_bf16_f32 v151, v30, v31
    s_nop 1
    v_mfma_f32_16x16x32_bf16 v[160:163], v[110:113], v[148:151], 0
    v_mfma_f32_16x16x32_bf16 v[164:167], v[116:119], v[148:151], 0
    v_pk_add_f32 v[16:17], v[16:17], v[136:137] op_sel:[0,0] op_sel_hi:[1,0] neg_lo:[0,1] neg_hi:[0,1]
    v_pk_add_f32 v[18:19], v[18:19], v[136:137] op_sel:[0,0] op_sel_hi:[1,0] neg_lo:[0,1] neg_hi:[0,1]
    v_pk_add_f32 v[20:21], v[20:21], v[136:137] op_sel:[0,0] op_sel_hi:[1,0] neg_lo:[0,1] neg_hi:[0,1]
    v_pk_add_f32 v[22:23], v[22:23], v[136:137] op_sel:[0,0] op_sel_hi:[1,0] neg_lo:[0,1] neg_hi:[0,1]
    v_exp_f32 v16, v16
    v_exp_f32 v17, v17
    v_exp_f32 v18, v18
    v_exp_f32 v19, v19
    v_exp_f32 v20, v20
    v_exp_f32 v21, v21
    v_exp_f32_e64 v22, v22
    v_exp_f32 v23, v23
    v_cvt_pk_bf16_f32 v144, v16, v17
    v_cvt_pk_bf16_f32 v145, v18, v19
    v_cvt_pk_bf16_f32 v146, v20, v21
    v_cvt_pk_bf16_f32 v147, v22, v23
    s_waitcnt lgkmcnt(1)
    s_nop 0
    v_mfma_f32_16x16x32_bf16 v[152:155], v[108:111], v[144:147], 0
    s_waitcnt lgkmcnt(0)
    v_mfma_f32_16x16x32_bf16 v[156:159], v[114:117], v[144:147], 0
    v_pk_add_f32 v[16:17], v[16:17], v[18:19]
    v_pk_add_f32 v[20:21], v[20:21], v[22:23]
    v_pk_add_f32 v[24:25], v[24:25], v[26:27]
    v_pk_add_f32 v[28:29], v[28:29], v[30:31]
    v_pk_add_f32 v[16:17], v[16:17], v[20:21]
    v_pk_add_f32 v[24:25], v[24:25], v[28:29]
    v_add_f32 v140, v16, v17
    v_add_f32 v142, v24, v25
    v_mov_b32 v138, v140
    v_mov_b32 v139, v142
    s_nop 0
    v_permlane32_swap_b32 v140, v138
    v_permlane32_swap_b32 v142, v139
    v_add_f32 v140, v140, v138
    v_add_f32 v142, v142, v139
    v_mov_b32 v138, v140
    v_mov_b32 v139, v142
    s_nop 0
    v_permlane16_swap_b32 v140, v138
    v_permlane16_swap_b32 v142, v139
    v_add_f32 v140, v140, v138
    v_add_f32 v142, v142, v139
    v_rcp_f32 v140, v140
    v_rcp_f32 v142, v142
    v_cndmask_b32 v141, 0, v140, s[90:91]
    v_cndmask_b32 v140, 0, v140, s[88:89]
    v_cndmask_b32 v143, 0, v142, s[90:91]
    v_cndmask_b32 v142, 0, v142, s[88:89]
    v_pk_mul_f32 v[152:153], v[152:153], v[140:141] op_sel_hi:[1,0]
    v_pk_mul_f32 v[154:155], v[154:155], v[140:141] op_sel_hi:[1,0]
    v_pk_mul_f32 v[156:157], v[156:157], v[140:141] op_sel:[0,1] op_sel_hi:[1,1]
    v_pk_mul_f32 v[158:159], v[158:159], v[140:141] op_sel:[0,1] op_sel_hi:[1,1]
    v_cvt_pk_bf16_f32 v144, v152, v153
    v_cvt_pk_bf16_f32 v145, v154, v155
    v_cvt_pk_bf16_f32 v146, v156, v157
    v_cvt_pk_bf16_f32 v147, v158, v159
    buffer_store_dwordx4 v[144:147], v4, s[40:43], s62 offen sc1
    v_pk_mul_f32 v[160:161], v[160:161], v[142:143] op_sel_hi:[1,0]
    v_pk_mul_f32 v[162:163], v[162:163], v[142:143] op_sel_hi:[1,0]
    v_pk_mul_f32 v[164:165], v[164:165], v[142:143] op_sel:[0,1] op_sel_hi:[1,1]
    v_pk_mul_f32 v[166:167], v[166:167], v[142:143] op_sel:[0,1] op_sel_hi:[1,1]
    v_cvt_pk_bf16_f32 v148, v160, v161
    v_cvt_pk_bf16_f32 v149, v162, v163
    v_cvt_pk_bf16_f32 v150, v164, v165
    v_cvt_pk_bf16_f32 v151, v166, v167
    buffer_store_dwordx4 v[148:151], v4, s[40:43], s63 offen sc1
    s_add_u32 m0, s59, 0
    s_mov_b32 s73, 0
    buffer_load_dwordx4 v208, s[16:19], s73 offen lds
    s_add_u32 m0, s59, 1024
    s_mov_b32 s73, 7168
    buffer_load_dwordx4 v208, s[16:19], s73 offen lds
    s_add_u32 m0, s59, 2048
    s_mov_b32 s73, 14336
    buffer_load_dwordx4 v208, s[16:19], s73 offen lds
    s_add_u32 m0, s59, 3072
    s_mov_b32 s73, 21504
    buffer_load_dwordx4 v208, s[16:19], s73 offen lds
    s_add_u32 m0, s59, 4096
    s_mov_b32 s73, 28672
    buffer_load_dwordx4 v208, s[16:19], s73 offen lds
    s_add_u32 m0, s59, 5120
    s_mov_b32 s73, 35840
    buffer_load_dwordx4 v208, s[16:19], s73 offen lds
    s_add_u32 m0, s59, 6144
    s_mov_b32 s73, 43008
    buffer_load_dwordx4 v208, s[16:19], s73 offen lds
    s_add_u32 m0, s59, 7168
    s_mov_b32 s73, 50176
    buffer_load_dwordx4 v208, s[16:19], s73 offen lds
    s_add_u32 m0, s59, 8192
    s_mov_b32 s73, 57344
    buffer_load_dwordx4 v208, s[16:19], s73 offen lds
    s_add_u32 m0, s59, 9216
    s_mov_b32 s73, 64512
    buffer_load_dwordx4 v208, s[16:19], s73 offen lds
    s_add_u32 m0, s59, 10240
    s_mov_b32 s73, 71680
    buffer_load_dwordx4 v208, s[16:19], s73 offen lds
    s_add_u32 m0, s59, 11264
    s_mov_b32 s73, 78848
    buffer_load_dwordx4 v208, s[16:19], s73 offen lds
    s_add_u32 m0, s59, 12288
    s_mov_b32 s73, 86016
    buffer_load_dwordx4 v208, s[16:19], s73 offen lds
    s_add_u32 m0, s59, 13312
    s_mov_b32 s73, 93184
    buffer_load_dwordx4 v208, s[16:19], s73 offen lds
    s_waitcnt vmcnt(18)
    v_readfirstlane_b32 s4, v6
    s_nop 1
    s_cmp_lg_u32 s4, 0
    s_cbranch_scc1 Lepd_P_2
    s_nop 0
Lepg_P_1:
    s_sub_u32 s6, s6, 1
    s_cbranch_scc1 L_end_P
    buffer_load_dword v6, v7, s[44:47], 0 offen sc1
    s_waitcnt vmcnt(0)
    v_readfirstlane_b32 s4, v6
    s_nop 1
    s_cmp_eq_u32 s4, 0
    s_cbranch_scc1 Lepg_P_1
Lepd_P_2:
    s_waitcnt vmcnt(14)
    v_mov_b32 v8, s4
    s_mov_b64 exec, 1
    buffer_store_dword v8, v9, s[40:43], s80 offen sc1
    s_mov_b64 exec, -1
    s_cmp_lt_u32 s67, 99
    s_cbranch_scc1 Lnotag_P_3
    s_lshr_b32 s68, s2, 3
    s_sub_u32 s68, s68, 28
    s_lshl_b32 s68, s68, 2
    s_add_u32 s68, s68, s3
    s_lshl_b32 s68, s68, 16
    s_and_b32 s69, s2, 7
    s_lshl_b32 s69, s69, 9
    s_add_u32 s68, s68, s69
    v_lshrrev_b32 v16, 2, v1
    v_lshlrev_b32 v16, 12, v16
    v_and_b32_e64 v17, 3, v1
    v_lshl_add_u32 v16, v17, 7, v16
    buffer_load_dword v18, v16, s[24:27], s68 offen
    s_add_u32 s68, s68, 0x100000
    s_waitcnt vmcnt(3)
    buffer_load_dword v19, v16, s[24:27], s68 offen
    s_add_u32 s68, s68, 0x100000
    s_waitcnt vmcnt(3)
    buffer_load_dword v20, v16, s[24:27], s68 offen
    s_add_u32 s68, s68, 0x100000
    s_waitcnt vmcnt(3)
    buffer_load_dword v21, v16, s[24:27], s68 offen
    s_add_u32 s68, s68, 0x100000
    s_waitcnt vmcnt(3)
    buffer_load_dword v22, v16, s[24:27], s68 offen
    s_add_u32 s68, s68, 0x100000
    s_waitcnt vmcnt(3)
    buffer_load_dword v23, v16, s[24:27], s68 offen
    s_add_u32 s68, s68, 0x100000
    s_waitcnt vmcnt(3)
    buffer_load_dword v24, v16, s[24:27], s68 offen
    s_add_u32 s68, s68, 0x100000
    s_waitcnt vmcnt(3)
    s_waitcnt vmcnt(0)
    s_branch L_end_P
Lnotag_P_3:
    v_lshrrev_b32 v221, 5, v1
    v_mul_u32_u24 v221, 3584, v221
    v_and_b32_e64 v222, 31, v1
    v_lshl_add_u32 v221, v222, 1, v221
    s_lshl_b32 s58, s67, 1
    s_lshr_b32 s60, s3, 1
    s_add_u32 s58, s58, s60
    s_mul_i32 s58, s58, 28672
    s_lshl_b32 s60, s66, 7
    s_add_u32 s58, s58, s60
    s_and_b32 s60, s3, 1
    s_lshl_b32 s60, s60, 6
    s_add_u32 s58, s58, s60
    buffer_load_ushort v192, v221, s[8:11], s58 offen offset:0
    buffer_load_ushort v193, v221, s[8:11], s58 offen offset:896
    buffer_load_ushort v194, v221, s[8:11], s58 offen offset:1792
    buffer_load_ushort v195, v221, s[8:11], s58 offen offset:2688
    s_add_u32 s58, s58, 7168
    buffer_load_ushort v196, v221, s[8:11], s58 offen offset:0
    buffer_load_ushort v197, v221, s[8:11], s58 offen offset:896
    buffer_load_ushort v198, v221, s[8:11], s58 offen offset:1792
    buffer_load_ushort v199, v221, s[8:11], s58 offen offset:2688
    s_add_u32 s58, s58, 7168
    buffer_load_ushort v200, v221, s[8:11], s58 offen offset:0
    buffer_load_ushort v201, v221, s[8:11], s58 offen offset:896
    buffer_load_ushort v202, v221, s[8:11], s58 offen offset:1792
    buffer_load_ushort v203, v221, s[8:11], s58 offen offset:2688
    s_add_u32 s58, s58, 7168
    buffer_load_ushort v204, v221, s[8:11], s58 offen offset:0
    buffer_load_ushort v205, v221, s[8:11], s58 offen offset:896
    buffer_load_ushort v206, v221, s[8:11], s58 offen offset:1792
    buffer_load_ushort v207, v221, s[8:11], s58 offen offset:2688
    s_and_b32 s68, s2, 7
    s_cmp_ge_u32 s68, 7
    s_cselect_b32 s48, 7, 0
    s_sub_u32 s68, s68, s48
    s_lshl_b32 s48, s68, 12
    s_add_u32 s68, s68, 1
    s_cmp_ge_u32 s68, 7
    s_cselect_b32 s49, 7, 0
    s_sub_u32 s68, s68, s49
    s_lshl_b32 s49, s68, 12
    s_add_u32 s68, s68, 1
    s_cmp_ge_u32 s68, 7
    s_cselect_b32 s50, 7, 0
    s_sub_u32 s68, s68, s50
    s_lshl_b32 s50, s68, 12
    s_add_u32 s68, s68, 1
    s_cmp_ge_u32 s68, 7
    s_cselect_b32 s51, 7, 0
    s_sub_u32 s68, s68, s51
    s_lshl_b32 s51, s68, 12
    s_add_u32 s68, s68, 1
    s_cmp_ge_u32 s68, 7
    s_cselect_b32 s52, 7, 0
    s_sub_u32 s68, s68, s52
    s_lshl_b32 s52, s68, 12
    s_add_u32 s68, s68, 1
    s_cmp_ge_u32 s68, 7
    s_cselect_b32 s53, 7, 0
    s_sub_u32 s68, s68, s53
    s_lshl_b32 s53, s68, 12
    s_add_u32 s68, s68, 1
    s_cmp_ge_u32 s68, 7
    s_cselect_b32 s54, 7, 0
    s_sub_u32 s68, s68, s54
    s_lshl_b32 s54, s68, 12
    s_add_u32 m0, s70, 16384
    s_mul_i32 s73, s94, 56
    s_add_u32 s73, s73, 0
    buffer_load_dwordx4 v213, s[20:23], s73 offen lds
    s_add_u32 m0, s70, 17408
    s_mul_i32 s73, s94, 56
    s_add_u32 s73, s73, 28672
    buffer_load_dwordx4 v213, s[20:23], s73 offen lds
    s_add_u32 m0, s70, 18432
    s_mul_i32 s73, s94, 56
    s_add_u32 s73, s73, 57344
    buffer_load_dwordx4 v213, s[20:23], s73 offen lds
    s_add_u32 m0, s70, 19456
    s_mul_i32 s73, s94, 56
    s_add_u32 s73, s73, 86016
    buffer_load_dwordx4 v213, s[20:23], s73 offen lds
    s_add_u32 m0, s70, 20480
    s_mul_i32 s73, s94, 56
    s_add_u32 s73, s73, 114688
    buffer_load_dwordx4 v213, s[20:23], s73 offen lds
    s_add_u32 m0, s70, 21504
    s_mul_i32 s73, s94, 56
    s_add_u32 s73, s73, 143360
    buffer_load_dwordx4 v213, s[20:23], s73 offen lds
    s_add_u32 m0, s70, 22528
    s_mul_i32 s73, s94, 56
    s_add_u32 s73, s73, 172032
    buffer_load_dwordx4 v213, s[20:23], s73 offen lds
    s_add_u32 m0, s70, 23552
    s_mul_i32 s73, s94, 56
    s_add_u32 s73, s73, 200704
    buffer_load_dwordx4 v213, s[20:23], s73 offen lds
    s_waitcnt vmcnt(25)
    s_barrier
    ds_read_b64_tr_b16 a[0:1], v209 offset:0
    ds_read_b64_tr_b16 a[2:3], v209 offset:2048
    s_add_u32 m0, s70, 24576
    s_mul_i32 s73, s95, 56
    s_add_u32 s73, s73, 0
    buffer_load_dwordx4 v213, s[20:23], s73 offen lds
    ds_read_b64_tr_b16 a[4:5], v209 offset:1024
    ds_read_b64_tr_b16 a[6:7], v209 offset:3072
    s_add_u32 m0, s70, 25600
    s_mul_i32 s73, s95, 56
    s_add_u32 s73, s73, 28672
    buffer_load_dwordx4 v213, s[20:23], s73 offen lds
    ds_read_b64_tr_b16 a[8:9], v209 offset:3584
    ds_read_b64_tr_b16 a[10:11], v209 offset:5632
    ds_read_b64_tr_b16 a[12:13], v209 offset:4608
    ds_read_b64_tr_b16 a[14:15], v209 offset:6656
    s_add_u32 m0, s70, 26624
    s_mul_i32 s73, s95, 56
    s_add_u32 s73, s73, 57344
    buffer_load_dwordx4 v213, s[20:23], s73 offen lds
    ds_read_b64_tr_b16 a[16:17], v209 offset:7168
    ds_read_b64_tr_b16 a[18:19], v209 offset:9216
    s_add_u32 m0, s70, 27648
    s_mul_i32 s73, s95, 56
    s_add_u32 s73, s73, 86016
    buffer_load_dwordx4 v213, s[20:23], s73 offen lds
    ds_read_b64_tr_b16 a[20:21], v209 offset:8192
    ds_read_b64_tr_b16 a[22:23], v209 offset:10240
    ds_read_b64_tr_b16 a[24:25], v209 offset:10752
    ds_read_b64_tr_b16 a[26:27], v209 offset:12800
    s_add_u32 m0, s70, 28672
    s_mul_i32 s73, s95, 56
    s_add_u32 s73, s73, 114688
    buffer_load_dwordx4 v213, s[20:23], s73 offen lds
    ds_read_b64_tr_b16 a[28:29], v209 offset:11776
    ds_read_b64_tr_b16 a[30:31], v210 offset:13824
    s_add_u32 m0, s70, 29696
    s_mul_i32 s73, s95, 56
    s_add_u32 s73, s73, 143360
    buffer_load_dwordx4 v213, s[20:23], s73 offen lds
    ds_read_b64_tr_b16 a[32:33], v209 offset:36864
    ds_read_b64_tr_b16 a[34:35], v209 offset:38912
    ds_read_b64_tr_b16 a[36:37], v209 offset:37888
    ds_read_b64_tr_b16 a[38:39], v209 offset:39936
    s_add_u32 m0, s70, 30720
    s_mul_i32 s73, s95, 56
    s_add_u32 s73, s73, 172032
    buffer_load_dwordx4 v213, s[20:23], s73 offen lds
    ds_read_b64_tr_b16 a[40:41], v209 offset:40448
    ds_read_b64_tr_b16 a[42:43], v209 offset:42496
    s_add_u32 m0, s70, 31744
    s_mul_i32 s73, s95, 56
    s_add_u32 s73, s73, 200704
    buffer_load_dwordx4 v213, s[20:23], s73 offen lds
    ds_read_b64_tr_b16 a[44:45], v209 offset:41472
    ds_read_b64_tr_b16 a[46:47], v209 offset:43520
    ds_read_b64_tr_b16 a[48:49], v209 offset:44032
    ds_read_b64_tr_b16 a[50:51], v209 offset:46080
    s_add_u32 m0, s70, 32768
    s_mul_i32 s73, s96, 56
    s_add_u32 s73, s73, 0
    buffer_load_dwordx4 v213, s[20:23], s73 offen lds
    ds_read_b64_tr_b16 a[52:53], v209 offset:45056
    ds_read_b64_tr_b16 a[54:55], v209 offset:47104
    s_add_u32 m0, s70, 33792
    s_mul_i32 s73, s96, 56
    s_add_u32 s73, s73, 28672
    buffer_load_dwordx4 v213, s[20:23], s73 offen lds
    ds_read_b64_tr_b16 a[56:57], v209 offset:47616
    ds_read_b64_tr_b16 a[58:59], v209 offset:49664
    ds_read_b64_tr_b16 a[60:61], v209 offset:48640
    ds_read_b64_tr_b16 a[62:63], v210 offset:50688
    s_add_u32 m0, s70, 34816
    s_mul_i32 s73, s96, 56
    s_add_u32 s73, s73, 57344
    buffer_load_dwordx4 v213, s[20:23], s73 offen lds
    v_add_u32 v209, 73728, v209
    v_add_u32 v210, 73728, v210
    ds_read_b64_tr_b16 a[64:65], v209 offset:0
    ds_read_b64_tr_b16 a[66:67], v209 offset:2048
    s_add_u32 m0, s70, 35840
    s_mul_i32 s73, s96, 56
    s_add_u32 s73, s73, 86016
    buffer_load_dwordx4 v213, s[20:23], s73 offen lds
    ds_read_b64_tr_b16 a[68:69], v209 offset:1024
    ds_read_b64_tr_b16 a[70:71], v209 offset:3072
    ds_read_b64_tr_b16 a[72:73], v209 offset:3584
    ds_read_b64_tr_b16 a[74:75], v209 offset:5632
    ds_read_b64_tr_b16 a[76:77], v209 offset:4608
    ds_read_b64_tr_b16 a[78:79], v209 offset:6656
    ds_read_b64_tr_b16 a[80:81], v209 offset:7168
    ds_read_b64_tr_b16 a[82:83], v209 offset:9216
    ds_read_b64_tr_b16 a[84:85], v209 offset:8192
    ds_read_b64_tr_b16 a[86:87], v209 offset:10240
    ds_read_b64_tr_b16 a[88:89], v209 offset:10752
    ds_read_b64_tr_b16 a[90:91], v209 offset:12800
    ds_read_b64_tr_b16 a[92:93], v209 offset:11776
    ds_read_b64_tr_b16 a[94:95], v210 offset:13824
    ds_read_b64_tr_b16 a[96:97], v209 offset:36864
    ds_read_b64_tr_b16 a[98:99], v209 offset:38912
    ds_read_b64_tr_b16 a[100:101], v209 offset:37888
    ds_read_b64_tr_b16 a[102:103], v209 offset:39936
    ds_read_b64_tr_b16 a[104:105], v209 offset:40448
    ds_read_b64_tr_b16 a[106:107], v209 offset:42496
    ds_read_b64_tr_b16 a[108:109], v209 offset:41472
    ds_read_b64_tr_b16 a[110:111], v209 offset:43520
    ds_read_b64_tr_b16 a[112:113], v209 offset:44032
    ds_read_b64_tr_b16 a[114:115], v209 offset:46080
    ds_read_b64_tr_b16 a[116:117], v209 offset:45056
    ds_read_b64_tr_b16 a[118:119], v209 offset:47104
    ds_read_b64_tr_b16 a[120:121], v209 offset:47104
    ds_read_b64_tr_b16 a[122:123], v209 offset:49152
    ds_read_b64_tr_b16 a[124:125], v209 offset:48128
    ds_read_b64_tr_b16 a[126:127], v209 offset:50176
    s_waitcnt lgkmcnt(0)
    s_barrier
    buffer_load_dword v249, v10, s[40:43], s83 offen sc1
    s_sleep 3
    buffer_load_dword v250, v10, s[40:43], s83 offen sc1
    s_sleep 3
    s_nop 0
Lpoll_P_4:
    s_sub_u32 s6, s6, 1
    s_cbranch_scc1 L_end_P
    buffer_load_dword v251, v10, s[40:43], s83 offen sc1
    s_waitcnt vmcnt(2)
    v_cmp_ne_u32_e64 vcc, s4, v249
    s_nop 1
    s_cbranch_vccz Lpd_P_5
    buffer_load_dword v249, v10, s[40:43], s83 offen sc1
    s_waitcnt vmcnt(2)
    v_cmp_ne_u32 vcc, s4, v250
    s_nop 1
    s_cbranch_vccz Lpd_P_5
    buffer_load_dword v250, v10, s[40:43], s83 offen sc1
    s_waitcnt vmcnt(2)
    v_cmp_ne_u32 vcc, s4, v251
    s_nop 1
    s_cbranch_vccnz Lpoll_P_4
    s_nop 1
Lpd_P_5:
    s_lshl_b32 s58, s67, 16
    s_lshl_b32 s60, s3, 14
    s_add_u32 s58, s58, s60
    s_add_u32 m0, s70, 0
    s_nop 0
    buffer_load_dwordx4 v4, s[40:43], s58 offen offset:0 sc1 lds
    buffer_load_dwordx4 v4, s[40:43], s58 offen offset:1024 sc1 lds
    buffer_load_dwordx4 v4, s[40:43], s58 offen offset:2048 sc1 lds
    buffer_load_dwordx4 v4, s[40:43], s58 offen offset:3072 sc1 lds
    s_add_u32 m0, s70, 4096
    s_add_u32 s58, s58, 4096
    buffer_load_dwordx4 v4, s[40:43], s58 offen offset:0 sc1 lds
    buffer_load_dwordx4 v4, s[40:43], s58 offen offset:1024 sc1 lds
    buffer_load_dwordx4 v4, s[40:43], s58 offen offset:2048 sc1 lds
    buffer_load_dwordx4 v4, s[40:43], s58 offen offset:3072 sc1 lds
    s_add_u32 m0, s70, 8192
    s_add_u32 s58, s58, 4096
    buffer_load_dwordx4 v4, s[40:43], s58 offen offset:0 sc1 lds
    buffer_load_dwordx4 v4, s[40:43], s58 offen offset:1024 sc1 lds
    buffer_load_dwordx4 v4, s[40:43], s58 offen offset:2048 sc1 lds
    buffer_load_dwordx4 v4, s[40:43], s58 offen offset:3072 sc1 lds
    s_add_u32 m0, s70, 12288
    s_add_u32 s58, s58, 4096
    buffer_load_dwordx4 v4, s[40:43], s58 offen offset:0 sc1 lds
    buffer_load_dwordx4 v4, s[40:43], s58 offen offset:1024 sc1 lds
    buffer_load_dwordx4 v4, s[40:43], s58 offen offset:2048 sc1 lds
    buffer_load_dwordx4 v4, s[40:43], s58 offen offset:3072 sc1 lds
    v_and_b32_e64 v64, 1, v3
    v_mul_u32_u24 v64, 36864, v64
    v_lshl_add_u32 v64, v2, 4, v64
    v_lshrrev_b32 v65, 5, v1
    v_lshl_add_u32 v64, v65, 8, v64
    s_lshr_b32 s60, s3, 1
    s_mul_i32 s60, s60, 73728
    s_add_u32 s60, s60, 12288
    v_add_u32_e64 v64, s60, v64
    ds_read_b64_tr_b16 a[128:129], v215 offset:16384
    ds_read_b64_tr_b16 a[130:131], v215 offset:17408
    ds_read_b64_tr_b16 a[132:133], v216 offset:16384
    ds_read_b64_tr_b16 a[134:135], v216 offset:17408
    ds_read_b64_tr_b16 a[136:137], v215 offset:18432
    ds_read_b64_tr_b16 a[138:139], v215 offset:19456
    ds_read_b64_tr_b16 a[140:141], v216 offset:18432
    ds_read_b64_tr_b16 a[142:143], v216 offset:19456
    ds_read_b64_tr_b16 a[144:145], v215 offset:20480
    ds_read_b64_tr_b16 a[146:147], v215 offset:21504
    ds_read_b64_tr_b16 a[148:149], v216 offset:20480
    ds_read_b64_tr_b16 a[150:151], v216 offset:21504
    ds_read_b64_tr_b16 a[152:153], v215 offset:22528
    ds_read_b64_tr_b16 a[154:155], v215 offset:23552
    ds_read_b64_tr_b16 a[156:157], v216 offset:22528
    ds_read_b64_tr_b16 a[158:159], v216 offset:23552
    ds_read_b64_tr_b16 a[160:161], v215 offset:24576
    ds_read_b64_tr_b16 a[162:163], v215 offset:25600
    ds_read_b64_tr_b16 a[164:165], v216 offset:24576
    ds_read_b64_tr_b16 a[166:167], v216 offset:25600
    ds_read_b64_tr_b16 a[168:169], v215 offset:26624
    ds_read_b64_tr_b16 a[170:171], v215 offset:27648
    ds_read_b64_tr_b16 a[172:173], v216 offset:26624
    ds_read_b64_tr_b16 a[174:175], v216 offset:27648
    ds_read_b64_tr_b16 a[176:177], v215 offset:28672
    ds_read_b64_tr_b16 a[178:179], v215 offset:29696
    ds_read_b64_tr_b16 a[180:181], v216 offset:28672
    ds_read_b64_tr_b16 a[182:183], v216 offset:29696
    ds_read_b64_tr_b16 a[184:185], v215 offset:30720
    ds_read_b64_tr_b16 a[186:187], v215 offset:31744
    ds_read_b64_tr_b16 a[188:189], v216 offset:30720
    ds_read_b64_tr_b16 a[190:191], v216 offset:31744
    ds_read_b64_tr_b16 a[192:193], v215 offset:32768
    ds_read_b64_tr_b16 a[194:195], v215 offset:33792
    ds_read_b64_tr_b16 a[196:197], v216 offset:32768
    ds_read_b64_tr_b16 a[198:199], v216 offset:33792
    ds_read_b64_tr_b16 a[200:201], v215 offset:34816
    ds_read_b64_tr_b16 a[202:203], v215 offset:35840
    ds_read_b64_tr_b16 a[204:205], v216 offset:34816
    ds_read_b64_tr_b16 a[206:207], v216 offset:35840
    v_lshlrev_b32 v192, 16, v192
    v_lshlrev_b32 v193, 16, v193
    v_lshlrev_b32 v194, 16, v194
    v_lshlrev_b32 v195, 16, v195
    v_lshlrev_b32 v196, 16, v196
    v_lshlrev_b32 v197, 16, v197
    v_lshlrev_b32 v198, 16, v198
    v_lshlrev_b32 v199, 16, v199
    v_lshlrev_b32 v200, 16, v200
    v_lshlrev_b32 v201, 16, v201
    v_lshlrev_b32 v202, 16, v202
    v_lshlrev_b32 v203, 16, v203
    v_lshlrev_b32 v204, 16, v204
    v_lshlrev_b32 v205, 16, v205
    v_lshlrev_b32_e64 v206, 16, v206
    v_lshlrev_b32 v207, 16, v207
    s_waitcnt vmcnt(8)
    s_barrier
    ds_read_b128 v[32:35], v64 offset:0
    ds_read_b128 v[36:39], v64 offset:512
    ds_read_b128 v[40:43], v64 offset:1024
    ds_read_b128 v[44:47], v64 offset:1536
    ds_read_b128 v[48:51], v64 offset:2048
    ds_read_b128 v[52:55], v64 offset:2560
    s_waitcnt lgkmcnt(5)
    v_mfma_f32_32x32x16_bf16 v[192:207], v[32:35], a[0:3], v[192:207]
    ds_read_b128 v[56:59], v64 offset:3072
    s_add_u32 m0, s70, 16384
    s_mul_i32 s73, s96, 56
    s_add_u32 s73, s73, 114688
    buffer_load_dwordx4 v213, s[20:23], s73 offen lds
    s_waitcnt lgkmcnt(5)
    v_mfma_f32_32x32x16_bf16 v[192:207], v[36:39], a[4:7], v[192:207]
    ds_read_b128 v[60:63], v64 offset:3584
    s_waitcnt lgkmcnt(5)
    v_mfma_f32_32x32x16_bf16 v[192:207], v[40:43], a[8:11], v[192:207]
    ds_read_b128 v[32:35], v64 offset:4096
    s_waitcnt lgkmcnt(5)
    v_mfma_f32_32x32x16_bf16 v[192:207], v[44:47], a[12:15], v[192:207]
    ds_read_b128 v[36:39], v64 offset:4608
    s_add_u32 m0, s70, 17408
    s_mul_i32 s73, s96, 56
    s_add_u32 s73, s73, 143360
    buffer_load_dwordx4 v213, s[20:23], s73 offen lds
    s_waitcnt lgkmcnt(5)
    v_mfma_f32_32x32x16_bf16 v[192:207], v[48:51], a[16:19], v[192:207]
    ds_read_b128 v[40:43], v64 offset:5120
    s_waitcnt lgkmcnt(5)
    v_mfma_f32_32x32x16_bf16 v[192:207], v[52:55], a[20:23], v[192:207]
    ds_read_b128 v[44:47], v64 offset:5632
    s_waitcnt lgkmcnt(5)
    v_mfma_f32_32x32x16_bf16 v[192:207], v[56:59], a[24:27], v[192:207]
    ds_read_b128 v[48:51], v64 offset:6144
    s_add_u32 m0, s70, 18432
    s_mul_i32 s73, s96, 56
    s_add_u32 s73, s73, 172032
    buffer_load_dwordx4 v213, s[20:23], s73 offen lds
    s_waitcnt lgkmcnt(5)
    v_mfma_f32_32x32x16_bf16 v[192:207], v[60:63], a[28:31], v[192:207]
    ds_read_b128 v[52:55], v64 offset:6656
    s_waitcnt lgkmcnt(5)
    v_mfma_f32_32x32x16_bf16 v[192:207], v[32:35], a[32:35], v[192:207]
    ds_read_b128 v[56:59], v64 offset:7168
    s_waitcnt lgkmcnt(5)
    v_mfma_f32_32x32x16_bf16 v[192:207], v[36:39], a[36:39], v[192:207]
    ds_read_b128 v[60:63], v64 offset:7680
    s_add_u32 m0, s70, 19456
    s_mul_i32 s73, s96, 56
    s_add_u32 s73, s73, 200704
    buffer_load_dwordx4 v213, s[20:23], s73 offen lds
    s_waitcnt lgkmcnt(5)
    v_mfma_f32_32x32x16_bf16 v[192:207], v[40:43], a[40:43], v[192:207]
    s_waitcnt lgkmcnt(4)
    v_mfma_f32_32x32x16_bf16 v[192:207], v[44:47], a[44:47], v[192:207]
    s_waitcnt vmcnt(4)
    s_barrier
    ds_read_b128 v[32:35], v64 offset:8192
    ds_read_b128 v[36:39], v64 offset:8704
    s_waitcnt lgkmcnt(5)
    v_mfma_f32_32x32x16_bf16 v[192:207], v[48:51], a[48:51], v[192:207]
    ds_read_b128 v[40:43], v64 offset:9216
    s_add_u32 m0, s70, 20480
    s_mul_i32 s73, s97, 56
    s_add_u32 s73, s73, 0
    buffer_load_dwordx4 v213, s[20:23], s73 offen lds
    s_waitcnt lgkmcnt(5)
    v_mfma_f32_32x32x16_bf16 v[192:207], v[52:55], a[52:55], v[192:207]
    ds_read_b128 v[44:47], v64 offset:9728
    s_waitcnt lgkmcnt(5)
    v_mfma_f32_32x32x16_bf16 v[192:207], v[56:59], a[56:59], v[192:207]
    ds_read_b128 v[48:51], v64 offset:10240
    s_waitcnt lgkmcnt(5)
    v_mfma_f32_32x32x16_bf16 v[192:207], v[60:63], a[60:63], v[192:207]
    ds_read_b128 v[52:55], v64 offset:10752
    s_add_u32 m0, s70, 21504
    s_mul_i32 s73, s97, 56
    s_add_u32 s73, s73, 28672
    buffer_load_dwordx4 v213, s[20:23], s73 offen lds
    s_waitcnt lgkmcnt(5)
    v_mfma_f32_32x32x16_bf16 v[192:207], v[32:35], a[64:67], v[192:207]
    ds_read_b128 v[56:59], v64 offset:11264
    s_waitcnt lgkmcnt(5)
    v_mfma_f32_32x32x16_bf16 v[192:207], v[36:39], a[68:71], v[192:207]
    ds_read_b128 v[60:63], v64 offset:11776
    s_waitcnt lgkmcnt(5)
    v_mfma_f32_32x32x16_bf16 v[192:207], v[40:43], a[72:75], v[192:207]
    ds_read_b128 v[32:35], v64 offset:12288
    s_add_u32 m0, s70, 22528
    s_mul_i32 s73, s97, 56
    s_add_u32 s73, s73, 57344
    buffer_load_dwordx4 v213, s[20:23], s73 offen lds
    s_waitcnt lgkmcnt(5)
    v_mfma_f32_32x32x16_bf16 v[192:207], v[44:47], a[76:79], v[192:207]
    ds_read_b128 v[36:39], v64 offset:12800
    s_waitcnt lgkmcnt(5)
    v_mfma_f32_32x32x16_bf16 v[192:207], v[48:51], a[80:83], v[192:207]
    ds_read_b128 v[40:43], v64 offset:13312
    s_waitcnt lgkmcnt(5)
    v_mfma_f32_32x32x16_bf16 v[192:207], v[52:55], a[84:87], v[192:207]
    ds_read_b128 v[44:47], v64 offset:13824
    s_add_u32 m0, s70, 23552
    s_mul_i32 s73, s97, 56
    s_add_u32 s73, s73, 86016
    buffer_load_dwordx4 v213, s[20:23], s73 offen lds
    s_waitcnt lgkmcnt(5)
    v_mfma_f32_32x32x16_bf16 v[192:207], v[56:59], a[88:91], v[192:207]
    ds_read_b128 v[48:51], v64 offset:14336
    s_waitcnt lgkmcnt(5)
    v_mfma_f32_32x32x16_bf16 v[192:207], v[60:63], a[92:95], v[192:207]
    ds_read_b128 v[52:55], v64 offset:14848
    s_waitcnt lgkmcnt(5)
    v_mfma_f32_32x32x16_bf16 v[192:207], v[32:35], a[96:99], v[192:207]
    ds_read_b128 v[56:59], v64 offset:15360
    s_add_u32 m0, s70, 24576
    s_mul_i32 s73, s97, 56
    s_add_u32 s73, s73, 114688
    buffer_load_dwordx4 v213, s[20:23], s73 offen lds
    s_waitcnt lgkmcnt(5)
    v_mfma_f32_32x32x16_bf16 v[192:207], v[36:39], a[100:103], v[192:207]
    ds_read_b128 v[60:63], v64 offset:15872
    s_waitcnt lgkmcnt(5)
    v_mfma_f32_32x32x16_bf16 v[192:207], v[40:43], a[104:107], v[192:207]
    s_waitcnt lgkmcnt(4)
    v_mfma_f32_32x32x16_bf16 v[192:207], v[44:47], a[108:111], v[192:207]
    s_add_u32 m0, s70, 25600
    s_mul_i32 s73, s97, 56
    s_add_u32 s73, s73, 143360
    buffer_load_dwordx4 v213, s[20:23], s73 offen lds
    s_waitcnt lgkmcnt(3)
    v_mfma_f32_32x32x16_bf16 v[192:207], v[48:51], a[112:115], v[192:207]
    s_waitcnt lgkmcnt(2)
    v_mfma_f32_32x32x16_bf16 v[192:207], v[52:55], a[116:119], v[192:207]
    s_waitcnt lgkmcnt(1)
    v_mfma_f32_32x32x16_bf16 v[192:207], v[56:59], a[120:123], v[192:207]
    s_add_u32 m0, s70, 26624
    s_mul_i32 s73, s97, 56
    s_add_u32 s73, s73, 172032
    buffer_load_dwordx4 v213, s[20:23], s73 offen lds
    s_waitcnt lgkmcnt(0)
    v_mfma_f32_32x32x16_bf16 v[192:207], v[60:63], a[124:127], v[192:207]
    s_nop 11
    v_pk_mul_f32 v[68:69], v[192:193], v[192:193]
    v_pk_mul_f32 v[70:71], v[194:195], v[194:195]
    v_pk_mul_f32 v[72:73], v[196:197], v[196:197]
    v_pk_mul_f32 v[74:75], v[198:199], v[198:199]
    v_pk_mul_f32 v[76:77], v[200:201], v[200:201]
    v_pk_mul_f32 v[78:79], v[202:203], v[202:203]
    v_pk_mul_f32 v[80:81], v[204:205], v[204:205]
    v_pk_mul_f32 v[82:83], v[206:207], v[206:207]
    s_add_u32 m0, s70, 27648
    s_mul_i32 s73, s97, 56
    s_add_u32 s73, s73, 200704
    buffer_load_dwordx4 v213, s[20:23], s73 offen lds
    v_add_f32_dpp v84, v192, v192 row_mirror row_mask:0xf bank_mask:0x3
    v_add_f32_dpp v85, v193, v193 row_mirror row_mask:0xf bank_mask:0x3
    v_add_f32_dpp v86, v196, v196 row_mirror row_mask:0xf bank_mask:0x3
    v_add_f32_dpp v87, v197, v197 row_mirror row_mask:0xf bank_mask:0x3
    v_add_f32_dpp v88, v200, v200 row_mirror row_mask:0xf bank_mask:0x3
    v_add_f32_dpp v89, v201, v201 row_mirror row_mask:0xf bank_mask:0x3
    v_add_f32_dpp v90, v204, v204 row_mirror row_mask:0xf bank_mask:0x3
    v_add_f32_dpp v91, v205, v205 row_mirror row_mask:0xf bank_mask:0x3
    s_add_u32 m0, s70, 28672
    s_mul_i32 s73, s98, 56
    s_add_u32 s73, s73, 0
    buffer_load_dwordx4 v213, s[20:23], s73 offen lds
    v_add_f32_dpp v92, v68, v68 row_mirror row_mask:0xf bank_mask:0x3
    v_add_f32_dpp v93, v69, v69 row_mirror row_mask:0xf bank_mask:0x3
    v_add_f32_dpp v94, v72, v72 row_mirror row_mask:0xf bank_mask:0x3
    v_add_f32_dpp v95, v73, v73 row_mirror row_mask:0xf bank_mask:0x3
    v_add_f32_dpp v96, v76, v76 row_mirror row_mask:0xf bank_mask:0x3
    v_add_f32_dpp v97, v77, v77 row_mirror row_mask:0xf bank_mask:0x3
    v_add_f32_dpp v98, v80, v80 row_mirror row_mask:0xf bank_mask:0x3
    v_add_f32_dpp v99, v81, v81 row_mirror row_mask:0xf bank_mask:0x3
    s_add_u32 m0, s70, 29696
    s_mul_i32 s73, s98, 56
    s_add_u32 s73, s73, 28672
    buffer_load_dwordx4 v213, s[20:23], s73 offen lds
    v_add_f32_dpp v84, v194, v194 row_mirror row_mask:0xf bank_mask:0xc
    v_add_f32_dpp v85, v195, v195 row_mirror row_mask:0xf bank_mask:0xc
    v_add_f32_dpp v86, v198, v198 row_mirror row_mask:0xf bank_mask:0xc
    v_add_f32_dpp v87, v199, v199 row_mirror row_mask:0xf bank_mask:0xc
    v_add_f32_dpp v88, v202, v202 row_mirror row_mask:0xf bank_mask:0xc
    v_add_f32_dpp v89, v203, v203 row_mirror row_mask:0xf bank_mask:0xc
    v_add_f32_dpp v90, v206, v206 row_mirror row_mask:0xf bank_mask:0xc
    v_add_f32_dpp v91, v207, v207 row_mirror row_mask:0xf bank_mask:0xc
    s_add_u32 m0, s70, 30720
    s_mul_i32 s73, s98, 56
    s_add_u32 s73, s73, 57344
    buffer_load_dwordx4 v213, s[20:23], s73 offen lds
    v_add_f32_dpp v92, v70, v70 row_mirror row_mask:0xf bank_mask:0xc
    v_add_f32_dpp v93, v71, v71 row_mirror row_mask:0xf bank_mask:0xc
    v_add_f32_dpp v94, v74, v74 row_mirror row_mask:0xf bank_mask:0xc
    v_add_f32_dpp v95, v75, v75 row_mirror row_mask:0xf bank_mask:0xc
    v_add_f32_dpp v96, v78, v78 row_mirror row_mask:0xf bank_mask:0xc
    v_add_f32_dpp v97, v79, v79 row_mirror row_mask:0xf bank_mask:0xc
    v_add_f32_dpp v98, v82, v82 row_mirror row_mask:0xf bank_mask:0xc
    v_add_f32_dpp v99, v83, v83 row_mirror row_mask:0xf bank_mask:0xc
    s_add_u32 m0, s70, 31744
    s_mul_i32 s73, s98, 56
    s_add_u32 s73, s73, 86016
    buffer_load_dwordx4 v213, s[20:23], s73 offen lds
    v_add_f32_dpp v84, v84, v84 row_half_mirror row_mask:0xf bank_mask:0x5
    v_add_f32_dpp v86, v86, v86 row_half_mirror row_mask:0xf bank_mask:0x5
    v_add_f32_dpp v88, v88, v88 row_half_mirror row_mask:0xf bank_mask:0x5
    v_add_f32_dpp v90, v90, v90 row_half_mirror row_mask:0xf bank_mask:0x5
    v_add_f32_dpp v92, v92, v92 row_half_mirror row_mask:0xf bank_mask:0x5
    v_add_f32_dpp v94, v94, v94 row_half_mirror row_mask:0xf bank_mask:0x5
    v_add_f32_dpp v96, v96, v96 row_half_mirror row_mask:0xf bank_mask:0x5
    v_add_f32_dpp v98, v98, v98 row_half_mirror row_mask:0xf bank_mask:0x5
    v_add_f32_dpp v84, v85, v85 row_half_mirror row_mask:0xf bank_mask:0xa
    v_add_f32_dpp v86, v87, v87 row_half_mirror row_mask:0xf bank_mask:0xa
    v_add_f32_dpp v88, v89, v89 row_half_mirror row_mask:0xf bank_mask:0xa
    v_add_f32_dpp v90, v91, v91 row_half_mirror row_mask:0xf bank_mask:0xa
    v_add_f32_dpp v92, v93, v93 row_half_mirror row_mask:0xf bank_mask:0xa
    v_add_f32_dpp v94, v95, v95 row_half_mirror row_mask:0xf bank_mask:0xa
    v_add_f32_dpp v96, v97, v97 row_half_mirror row_mask:0xf bank_mask:0xa
    v_add_f32_dpp v98, v99, v99 row_half_mirror row_mask:0xf bank_mask:0xa
    v_add_f32_dpp v85, v84, v84 quad_perm:[1,0,3,2] row_mask:0xf bank_mask:0xf
    v_add_f32_dpp v87, v86, v86 quad_perm:[1,0,3,2] row_mask:0xf bank_mask:0xf
    v_add_f32_dpp v89, v88, v88 quad_perm:[1,0,3,2] row_mask:0xf bank_mask:0xf
    v_add_f32_dpp v91, v90, v90 quad_perm:[1,0,3,2] row_mask:0xf bank_mask:0xf
    v_add_f32_dpp v93, v92, v92 quad_perm:[1,0,3,2] row_mask:0xf bank_mask:0xf
    v_add_f32_dpp v95, v94, v94 quad_perm:[1,0,3,2] row_mask:0xf bank_mask:0xf
    v_add_f32_dpp v97, v96, v96 quad_perm:[1,0,3,2] row_mask:0xf bank_mask:0xf
    v_add_f32_dpp v99, v98, v98 quad_perm:[1,0,3,2] row_mask:0xf bank_mask:0xf
    v_add_f32_dpp v68, v85, v85 quad_perm:[2,3,0,1] row_mask:0xf bank_mask:0xf
    v_add_f32_dpp v69, v87, v87 quad_perm:[2,3,0,1] row_mask:0xf bank_mask:0xf
    v_add_f32_dpp v70, v89, v89 quad_perm:[2,3,0,1] row_mask:0xf bank_mask:0xf
    v_add_f32_dpp v71, v91, v91 quad_perm:[2,3,0,1] row_mask:0xf bank_mask:0xf
    v_add_f32_dpp v72, v93, v93 quad_perm:[2,3,0,1] row_mask:0xf bank_mask:0xf
    v_add_f32_dpp v73, v95, v95 quad_perm:[2,3,0,1] row_mask:0xf bank_mask:0xf
    v_add_f32_dpp v74, v97, v97 quad_perm:[2,3,0,1] row_mask:0xf bank_mask:0xf
    v_add_f32_dpp v75, v99, v99 quad_perm:[2,3,0,1] row_mask:0xf bank_mask:0xf
    v_permlane16_swap_b32 v68, v69
    v_permlane16_swap_b32 v70, v71
    v_permlane16_swap_b32 v72, v73
    v_permlane16_swap_b32 v74, v75
    v_add_f32 v84, v68, v69
    v_add_f32 v85, v72, v73
    v_add_f32 v86, v70, v71
    v_add_f32 v87, v74, v75
    v_and_b32 v65, 1, v3
    v_lshlrev_b32 v65, 6, v65
    v_lshrrev_b32_e64 v66, 5, v1
    v_lshl_add_u32 v65, v66, 5, v65
    v_bfe_u32 v67, v1, 2, 2
    v_lshl_add_u32 v65, v67, 3, v65
    s_lshl_b32 s58, s3, 8
    v_add_u32 v65, s58, v65
    ds_write_b64 v65, v[84:85] offset:0
    ds_write_b64 v65, v[86:87] offset:128
    v_and_b32 v67, 31, v1
    v_lshlrev_b32 v65, 9, v66
    v_lshl_add_u32 v65, v67, 4, v65
    v_lshlrev_b32_e64 v66, 8, v66
    v_lshl_add_u32 v66, v67, 3, v66
    s_and_b32 s58, s58, 512
    v_add_u32_e64 v66, s58, v66
    s_lshl_b32 s58, s67, 1
    s_lshr_b32 s60, s3, 1
    s_add_u32 s58, s58, s60
    s_lshl_b32 s58, s58, 12
    s_add_u32 s58, s58, 0x548000
    s_lshl_b32 s60, s66, 9
    s_add_u32 s60, s60, s58
    s_waitcnt lgkmcnt(0)
    s_barrier
    ds_read_b64 v[84:85], v66 offset:0
    v_mov_b32 v89, s4
    v_mov_b32 v91, s4
    s_waitcnt lgkmcnt(0)
    v_mov_b32 v88, v84
    v_mov_b32 v90, v85
    s_nop 0
    v_permlane32_swap_b32 v88, v84
    v_permlane32_swap_b32 v90, v85
    v_add_f32 v88, v88, v84
    v_add_f32 v90, v90, v85
    s_bitcmp0_b32 s3, 0
    s_cselect_b32 exec_lo, -1, 0
    s_mov_b32 exec_hi, 0
    buffer_store_dwordx4 v[88:91], v65, s[40:43], s60 offen sc1
    s_mov_b64 exec, -1
    v_cvt_pk_bf16_f32 v240, v192, v193
    v_cvt_pk_bf16_f32 v241, v194, v195
    v_cvt_pk_bf16_f32 v242, v196, v197
    v_cvt_pk_bf16_f32 v243, v198, v199
    v_cvt_pk_bf16_f32 v244, v200, v201
    v_cvt_pk_bf16_f32 v245, v202, v203
    v_cvt_pk_bf16_f32 v246, v204, v205
    v_cvt_pk_bf16_f32 v247, v206, v207
    s_lshl_b32 s61, s66, 1
    s_and_b32 s60, s3, 1
    s_add_u32 s61, s61, s60
    s_lshl_b32 s61, s61, 7
    s_lshl_b32 s60, s67, 2
    s_add_u32 s61, s61, s60
    s_and_b32 s60, s3, 2
    s_add_u32 s61, s61, s60
    s_lshl_b32 s61, s61, 10
    s_add_u32 s61, s61, 0x200000
    v_lshlrev_b32_e64 v66, 4, v67
    v_cmp_gt_u32 s[86:87], 32, v1
    s_add_u32 m0, s70, 0
    s_mul_i32 s73, s98, 56
    s_add_u32 s73, s73, 114688
    buffer_load_dwordx4 v213, s[20:23], s73 offen lds
    s_add_u32 m0, s70, 1024
    s_mul_i32 s73, s98, 56
    s_add_u32 s73, s73, 143360
    buffer_load_dwordx4 v213, s[20:23], s73 offen lds
    s_add_u32 m0, s70, 2048
    s_mul_i32 s73, s98, 56
    s_add_u32 s73, s73, 172032
    buffer_load_dwordx4 v213, s[20:23], s73 offen lds
    s_add_u32 m0, s70, 3072
    s_mul_i32 s73, s98, 56
    s_add_u32 s73, s73, 200704
    buffer_load_dwordx4 v213, s[20:23], s73 offen lds
    s_add_u32 m0, s70, 4096
    s_mul_i32 s73, s99, 56
    s_add_u32 s73, s73, 0
    buffer_load_dwordx4 v213, s[20:23], s73 offen lds
    s_add_u32 m0, s70, 5120
    s_mul_i32 s73, s99, 56
    s_add_u32 s73, s73, 28672
    buffer_load_dwordx4 v213, s[20:23], s73 offen lds
    s_add_u32 m0, s70, 6144
    s_mul_i32 s73, s99, 56
    s_add_u32 s73, s73, 57344
    buffer_load_dwordx4 v213, s[20:23], s73 offen lds
    s_add_u32 m0, s70, 7168
    s_mul_i32 s73, s99, 56
    s_add_u32 s73, s73, 86016
    buffer_load_dwordx4 v213, s[20:23], s73 offen lds
    s_add_u32 m0, s70, 8192
    s_mul_i32 s73, s99, 56
    s_add_u32 s73, s73, 114688
    buffer_load_dwordx4 v213, s[20:23], s73 offen lds
    s_add_u32 m0, s70, 9216
    s_mul_i32 s73, s99, 56
    s_add_u32 s73, s73, 143360
    buffer_load_dwordx4 v213, s[20:23], s73 offen lds
    s_add_u32 m0, s70, 10240
    s_mul_i32 s73, s99, 56
    s_add_u32 s73, s73, 172032
    buffer_load_dwordx4 v213, s[20:23], s73 offen lds
    s_add_u32 m0, s70, 11264
    s_mul_i32 s73, s99, 56
    s_add_u32 s73, s73, 200704
    buffer_load_dwordx4 v213, s[20:23], s73 offen lds
    s_add_u32 m0, s70, 12288
    s_mul_i32 s73, s100, 56
    s_add_u32 s73, s73, 0
    buffer_load_dwordx4 v213, s[20:23], s73 offen lds
    s_add_u32 m0, s70, 13312
    s_mul_i32 s73, s100, 56
    s_add_u32 s73, s73, 28672
    buffer_load_dwordx4 v213, s[20:23], s73 offen lds
    s_add_u32 m0, s70, 14336
    s_mul_i32 s73, s100, 56
    s_add_u32 s73, s73, 57344
    buffer_load_dwordx4 v213, s[20:23], s73 offen lds
    s_add_u32 m0, s70, 15360
    s_mul_i32 s73, s100, 56
    s_add_u32 s73, s73, 86016
    buffer_load_dwordx4 v213, s[20:23], s73 offen lds
    buffer_load_dwordx4 v[96:99], v65, s[40:43], s58 offen offset:0 sc1
    buffer_load_dwordx4 v[100:103], v65, s[40:43], s58 offen offset:1024 sc1
    buffer_load_dwordx4 v[104:107], v65, s[40:43], s58 offen offset:2048 sc1
    buffer_load_dwordx4 v[108:111], v66, s[40:43], s58 offen offset:3072 sc1
    s_sleep 5
    s_nop 0
Lst_P_6:
    s_sub_u32 s6, s6, 1
    s_cbranch_scc1 L_end_P
    buffer_load_dwordx4 v[112:115], v65, s[40:43], s58 offen offset:0 sc1
    buffer_load_dwordx4 v[116:119], v65, s[40:43], s58 offen offset:1024 sc1
    buffer_load_dwordx4 v[120:123], v65, s[40:43], s58 offen offset:2048 sc1
    buffer_load_dwordx4 v[124:127], v66, s[40:43], s58 offen offset:3072 sc1
    s_waitcnt vmcnt(4)
    v_xor_b32 v97, s4, v97
    v_xor_b32 v99, s4, v99
    v_xor_b32 v101, s4, v101
    v_xor_b32 v103, s4, v103
    v_xor_b32 v105, s4, v105
    v_xor_b32 v107, s4, v107
    v_xor_b32 v109, s4, v109
    v_xor_b32_e64 v111, s4, v111
    v_cndmask_b32 v108, 0, v108, s[86:87]
    v_cndmask_b32 v110, 0, v110, s[86:87]
    v_or3_b32 v97, v97, v99, v101
    v_or3_b32 v103, v103, v105, v107
    v_or3_b32 v97, v97, v109, v111
    v_or_b32 v97, v97, v103
    v_cmp_ne_u32 vcc, 0, v97
    v_add_f32 v128, v96, v100
    v_add_f32 v129, v104, v108
    v_add_f32_e64 v130, v98, v102
    v_add_f32 v131, v106, v110
    s_cbranch_vccz Lstd_P_7
    buffer_load_dwordx4 v[96:99], v65, s[40:43], s58 offen offset:0 sc1
    buffer_load_dwordx4 v[100:103], v65, s[40:43], s58 offen offset:1024 sc1
    buffer_load_dwordx4 v[104:107], v65, s[40:43], s58 offen offset:2048 sc1
    buffer_load_dwordx4 v[108:111], v66, s[40:43], s58 offen offset:3072 sc1
    s_waitcnt vmcnt(4)
    v_xor_b32 v113, s4, v113
    v_xor_b32 v115, s4, v115
    v_xor_b32 v117, s4, v117
    v_xor_b32 v119, s4, v119
    v_xor_b32 v121, s4, v121
    v_xor_b32 v123, s4, v123
    v_xor_b32 v125, s4, v125
    v_xor_b32_e64 v127, s4, v127
    v_cndmask_b32 v124, 0, v124, s[86:87]
    v_cndmask_b32 v126, 0, v126, s[86:87]
    v_or3_b32 v113, v113, v115, v117
    v_or3_b32 v119, v119, v121, v123
    v_or3_b32 v113, v113, v125, v127
    v_or_b32 v113, v113, v119
    v_cmp_ne_u32 vcc, 0, v113
    v_add_f32 v128, v112, v116
    v_add_f32 v129, v120, v124
    v_add_f32 v130, v114, v118
    v_add_f32 v131, v122, v126
    s_cbranch_vccnz Lst_P_6
    s_nop 3
Lstd_P_7:
    v_add_f32 v128, v128, v129
    v_add_f32 v130, v130, v131
    v_mov_b32 v136, v128
    v_mov_b32 v138, v130
    s_nop 0
    v_permlane32_swap_b32 v128, v136
    v_permlane32_swap_b32 v130, v138
    v_add_f32 v128, v128, v136
    v_add_f32_e64 v130, v130, v138
    v_mul_f32 v133, 0x3b124925, v128
    v_mul_f32 v130, 0x3b124925, v130
    v_fma_f32 v130, -v133, v133, v130
    v_max_f32_e64 v130, 0, v130
    v_add_f32 v135, 0x3727c5ac, v130
    v_rsq_f32 v135, v135
    s_nop 0
    v_mul_f32_e64 v130, v130, v135
    v_fmaak_f32 v130, v130, v135, 0x3727c5ac
    v_rsq_f32 v130, v130
    s_nop 0
    v_mul_f32 v135, v135, v130
    s_lshl_b32 s60, s3, 8
    v_lshl_add_u32 v66, v67, 2, s60
    ds_write_b32 v66, v133 offset:1024
    ds_write_b32 v66, v135 offset:1152
    v_lshrrev_b32 v66, 5, v1
    v_lshl_add_u32 v66, v66, 4, s60
    s_waitcnt lgkmcnt(0)
    ds_read_b128 v[140:143], v66 offset:1024
    ds_read_b128 v[156:159], v66 offset:1152
    ds_read_b128 v[144:147], v66 offset:1056
    ds_read_b128 v[160:163], v66 offset:1184
    ds_read_b128 v[148:151], v66 offset:1088
    ds_read_b128 v[164:167], v66 offset:1216
    ds_read_b128 v[152:155], v66 offset:1120
    ds_read_b128 v[168:171], v66 offset:1248
    s_waitcnt lgkmcnt(7)
    v_pk_add_f32 v[192:193], v[192:193], v[140:141] neg_lo:[0,1] neg_hi:[0,1]
    v_pk_add_f32 v[194:195], v[194:195], v[142:143] neg_lo:[0,1] neg_hi:[0,1]
    s_waitcnt lgkmcnt(5)
    v_pk_add_f32 v[196:197], v[196:197], v[144:145] neg_lo:[0,1] neg_hi:[0,1]
    v_pk_add_f32 v[198:199], v[198:199], v[146:147] neg_lo:[0,1] neg_hi:[0,1]
    v_pk_mul_f32 v[192:193], v[192:193], v[156:157]
    v_pk_mul_f32 v[194:195], v[194:195], v[158:159]
    s_waitcnt lgkmcnt(4)
    v_pk_mul_f32 v[196:197], v[196:197], v[160:161]
    v_pk_mul_f32 v[198:199], v[198:199], v[162:163]
    v_cvt_pk_bf16_f32 v84, v192, v193
    v_cvt_pk_bf16_f32 v85, v194, v195
    v_cvt_pk_bf16_f32 v86, v196, v197
    v_cvt_pk_bf16_f32 v87, v198, v199
    buffer_store_dwordx4 v[84:87], v4, s[40:43], s61 offen offset:0 sc1
    s_waitcnt lgkmcnt(3)
    v_pk_add_f32 v[200:201], v[200:201], v[148:149] neg_lo:[0,1] neg_hi:[0,1]
    v_pk_add_f32 v[202:203], v[202:203], v[150:151] neg_lo:[0,1] neg_hi:[0,1]
    s_waitcnt lgkmcnt(1)
    v_pk_add_f32 v[204:205], v[204:205], v[152:153] neg_lo:[0,1] neg_hi:[0,1]
    v_pk_add_f32 v[206:207], v[206:207], v[154:155] neg_lo:[0,1] neg_hi:[0,1]
    v_pk_mul_f32 v[200:201], v[200:201], v[164:165]
    v_pk_mul_f32 v[202:203], v[202:203], v[166:167]
    s_waitcnt lgkmcnt(0)
    v_pk_mul_f32 v[204:205], v[204:205], v[168:169]
    v_pk_mul_f32 v[206:207], v[206:207], v[170:171]
    v_cvt_pk_bf16_f32 v88, v200, v201
    v_cvt_pk_bf16_f32 v89, v202, v203
    v_cvt_pk_bf16_f32 v90, v204, v205
    v_cvt_pk_bf16_f32 v91, v206, v207
    buffer_store_dwordx4 v[88:91], v4, s[40:43], s61 offen offset:1024 sc1
    ds_read_b64_tr_b16 a[208:209], v215 offset:16384
    ds_read_b64_tr_b16 a[210:211], v215 offset:17408
    ds_read_b64_tr_b16 a[212:213], v216 offset:16384
    ds_read_b64_tr_b16 a[214:215], v216 offset:17408
    ds_read_b64_tr_b16 a[216:217], v215 offset:18432
    ds_read_b64_tr_b16 a[218:219], v215 offset:19456
    ds_read_b64_tr_b16 a[220:221], v216 offset:18432
    ds_read_b64_tr_b16 a[222:223], v216 offset:19456
    ds_read_b64_tr_b16 a[224:225], v215 offset:20480
    ds_read_b64_tr_b16 a[226:227], v215 offset:21504
    ds_read_b64_tr_b16 a[228:229], v216 offset:20480
    ds_read_b64_tr_b16 a[230:231], v216 offset:21504
    ds_read_b64_tr_b16 a[232:233], v215 offset:22528
    ds_read_b64_tr_b16 a[234:235], v215 offset:23552
    ds_read_b64_tr_b16 a[236:237], v216 offset:22528
    ds_read_b64_tr_b16 a[238:239], v216 offset:23552
    ds_read_b64_tr_b16 a[240:241], v215 offset:24576
    ds_read_b64_tr_b16 a[242:243], v215 offset:25600
    ds_read_b64_tr_b16 a[244:245], v216 offset:24576
    ds_read_b64_tr_b16 a[246:247], v216 offset:25600
    ds_read_b64_tr_b16 a[248:249], v215 offset:26624
    ds_read_b64_tr_b16 a[250:251], v215 offset:27648
    ds_read_b64_tr_b16 a[252:253], v216 offset:26624
    ds_read_b64_tr_b16 a[254:255], v216 offset:27648
    ds_read_b64_tr_b16 a[0:1], v215 offset:28672
    ds_read_b64_tr_b16 a[2:3], v215 offset:29696
    ds_read_b64_tr_b16 a[4:5], v216 offset:28672
    ds_read_b64_tr_b16 a[6:7], v216 offset:29696
    ds_read_b64_tr_b16 a[8:9], v215 offset:30720
    ds_read_b64_tr_b16 a[10:11], v215 offset:31744
    ds_read_b64_tr_b16 a[12:13], v216 offset:30720
    ds_read_b64_tr_b16 a[14:15], v216 offset:31744
    ds_read_b64_tr_b16 a[16:17], v215 offset:0
    ds_read_b64_tr_b16 a[18:19], v215 offset:1024
    ds_read_b64_tr_b16 a[20:21], v216 offset:0
    ds_read_b64_tr_b16 a[22:23], v216 offset:1024
    ds_read_b64_tr_b16 a[24:25], v215 offset:2048
    ds_read_b64_tr_b16 a[26:27], v215 offset:3072
    ds_read_b64_tr_b16 a[28:29], v216 offset:2048
    ds_read_b64_tr_b16 a[30:31], v216 offset:3072
    ds_read_b64_tr_b16 a[32:33], v215 offset:4096
    ds_read_b64_tr_b16 a[34:35], v215 offset:5120
    ds_read_b64_tr_b16 a[36:37], v216 offset:4096
    ds_read_b64_tr_b16 a[38:39], v216 offset:5120
    ds_read_b64_tr_b16 a[40:41], v215 offset:6144
    ds_read_b64_tr_b16 a[42:43], v215 offset:7168
    ds_read_b64_tr_b16 a[44:45], v216 offset:6144
    ds_read_b64_tr_b16 a[46:47], v216 offset:7168
    ds_read_b64_tr_b16 a[48:49], v215 offset:8192
    ds_read_b64_tr_b16 a[50:51], v215 offset:9216
    ds_read_b64_tr_b16 a[52:53], v216 offset:8192
    ds_read_b64_tr_b16 a[54:55], v216 offset:9216
    ds_read_b64_tr_b16 a[56:57], v215 offset:10240
    ds_read_b64_tr_b16 a[58:59], v215 offset:11264
    ds_read_b64_tr_b16 a[60:61], v216 offset:10240
    ds_read_b64_tr_b16 a[62:63], v216 offset:11264
    ds_read_b64_tr_b16 a[64:65], v215 offset:12288
    ds_read_b64_tr_b16 a[66:67], v215 offset:13312
    ds_read_b64_tr_b16 a[68:69], v216 offset:12288
    ds_read_b64_tr_b16 a[70:71], v216 offset:13312
    ds_read_b64_tr_b16 a[72:73], v215 offset:14336
    ds_read_b64_tr_b16 a[74:75], v215 offset:15360
    ds_read_b64_tr_b16 a[76:77], v216 offset:14336
    ds_read_b64_tr_b16 a[78:79], v216 offset:15360
    s_waitcnt vmcnt(0)
    v_mov_b32 v8, s4
    s_mov_b64 exec, 1
    buffer_store_dword v8, v9, s[40:43], s81 offen sc1
    s_mov_b64 exec, -1
    s_waitcnt lgkmcnt(4)
    s_add_u32 m0, s70, 12288
    s_mul_i32 s73, s100, 56
    s_add_u32 s73, s73, 114688
    buffer_load_dwordx4 v213, s[20:23], s73 offen lds
    s_add_u32 m0, s70, 13312
    s_mul_i32 s73, s100, 56
    s_add_u32 s73, s73, 143360
    buffer_load_dwordx4 v213, s[20:23], s73 offen lds
    s_waitcnt lgkmcnt(0)
    s_add_u32 m0, s70, 14336
    s_mul_i32 s73, s100, 56
    s_add_u32 s73, s73, 172032
    buffer_load_dwordx4 v213, s[20:23], s73 offen lds
    s_add_u32 m0, s70, 15360
    s_mul_i32 s73, s100, 56
    s_add_u32 s73, s73, 200704
    buffer_load_dwordx4 v213, s[20:23], s73 offen lds
    s_add_u32 m0, s70, 16384
    s_mul_i32 s73, s101, 56
    s_add_u32 s73, s73, 0
    buffer_load_dwordx4 v213, s[20:23], s73 offen lds
    s_add_u32 m0, s70, 17408
    s_mul_i32 s73, s101, 56
    s_add_u32 s73, s73, 28672
    buffer_load_dwordx4 v213, s[20:23], s73 offen lds
    s_add_u32 m0, s70, 18432
    s_mul_i32 s73, s101, 56
    s_add_u32 s73, s73, 57344
    buffer_load_dwordx4 v213, s[20:23], s73 offen lds
    s_add_u32 m0, s70, 19456
    s_mul_i32 s73, s101, 56
    s_add_u32 s73, s73, 86016
    buffer_load_dwordx4 v213, s[20:23], s73 offen lds
    s_add_u32 m0, s70, 20480
    s_mul_i32 s73, s101, 56
    s_add_u32 s73, s73, 114688
    buffer_load_dwordx4 v213, s[20:23], s73 offen lds
    s_add_u32 m0, s70, 21504
    s_mul_i32 s73, s101, 56
    s_add_u32 s73, s73, 143360
    buffer_load_dwordx4 v213, s[20:23], s73 offen lds
    s_add_u32 m0, s70, 22528
    s_mul_i32 s73, s101, 56
    s_add_u32 s73, s73, 172032
    buffer_load_dwordx4 v213, s[20:23], s73 offen lds
    s_add_u32 m0, s70, 23552
    s_mul_i32 s73, s101, 56
    s_add_u32 s73, s73, 200704
    buffer_load_dwordx4 v213, s[20:23], s73 offen lds
    s_add_u32 m0, s70, 24576
    s_mul_i32 s73, s48, 64
    s_add_u32 s73, s73, 0
    buffer_load_dwordx4 v214, s[24:27], s73 offen lds
    s_add_u32 m0, s70, 25600
    s_mul_i32 s73, s48, 64
    s_add_u32 s73, s73, 32768
    buffer_load_dwordx4 v214, s[24:27], s73 offen lds
    s_add_u32 m0, s70, 26624
    s_mul_i32 s73, s48, 64
    s_add_u32 s73, s73, 65536
    buffer_load_dwordx4 v214, s[24:27], s73 offen lds
    s_add_u32 m0, s70, 27648
    s_mul_i32 s73, s48, 64
    s_add_u32 s73, s73, 98304
    buffer_load_dwordx4 v214, s[24:27], s73 offen lds
    s_add_u32 m0, s70, 28672
    s_mul_i32 s73, s48, 64
    s_add_u32 s73, s73, 131072
    buffer_load_dwordx4 v214, s[24:27], s73 offen lds
    s_add_u32 m0, s70, 29696
    s_mul_i32 s73, s48, 64
    s_add_u32 s73, s73, 163840
    buffer_load_dwordx4 v214, s[24:27], s73 offen lds
    s_add_u32 m0, s70, 30720
    s_mul_i32 s73, s48, 64
    s_add_u32 s73, s73, 196608
    buffer_load_dwordx4 v214, s[24:27], s73 offen lds
    s_add_u32 m0, s70, 31744
    s_mul_i32 s73, s48, 64
    s_add_u32 s73, s73, 229376
    buffer_load_dwordx4 v214, s[24:27], s73 offen lds
    s_add_u32 m0, s70, 32768
    s_mul_i32 s73, s49, 64
    s_add_u32 s73, s73, 0
    buffer_load_dwordx4 v214, s[24:27], s73 offen lds
    s_add_u32 m0, s70, 33792
    s_mul_i32 s73, s49, 64
    s_add_u32 s73, s73, 32768
    buffer_load_dwordx4 v214, s[24:27], s73 offen lds
    s_add_u32 m0, s70, 34816
    s_mul_i32 s73, s49, 64
    s_add_u32 s73, s73, 65536
    buffer_load_dwordx4 v214, s[24:27], s73 offen lds
    s_add_u32 m0, s70, 35840
    s_mul_i32 s73, s49, 64
    s_add_u32 s73, s73, 98304
    buffer_load_dwordx4 v214, s[24:27], s73 offen lds
    s_lshl_b32 s71, s64, 18
    s_lshl_b32 s86, s3, 15
    s_add_u32 s71, s71, s86
    s_add_u32 s71, s71, 0x200000
    s_add_u32 s72, s71, 0x20000
    s_mul_i32 s58, s66, 229376
    s_add_u32 s58, s58, 0x3c0000
    s_lshl_b32 s86, s65, 2
    s_add_u32 s86, s86, s3
    s_lshl_b32 s86, s86, 10
    s_add_u32 s57, s58, s86
    s_mul_i32 s86, s3, 28672
    s_add_u32 s58, s58, s86
    s_add_u32 s59, s58, 114688
    v_lshrrev_b32 v208, 5, v1
    v_lshlrev_b32 v208, 3, v208
    s_lshl_b32 s86, s65, 7
    s_lshl_b32 s87, s3, 5
    s_add_u32 s86, s86, s87
    buffer_load_dwordx2 v[220:221], v208, s[28:31], s86 offen offset:0
    buffer_load_dwordx2 v[222:223], v208, s[28:31], s86 offen offset:16
    s_lshl_b32 s86, s67, 7
    s_lshr_b32 s87, s3, 1
    s_lshl_b32 s87, s87, 6
    s_add_u32 s86, s86, s87
    buffer_load_dwordx2 v[224:225], v208, s[32:35], s86 offen offset:0
    buffer_load_dwordx2 v[226:227], v208, s[32:35], s86 offen offset:16
    buffer_load_dwordx2 v[228:229], v208, s[32:35], s86 offen offset:32
    buffer_load_dwordx2 v[230:231], v208, s[32:35], s86 offen offset:48
    v_add_u32 v232, s70, v4
    s_xor_b32 s86, s3, 1
    s_mul_i32 s86, s86, 36864
    s_add_u32 s86, s86, 12288
    v_add_u32 v233, s86, v4
    s_xor_b32 s86, s3, 2
    s_mul_i32 s86, s86, 36864
    s_add_u32 s86, s86, 14336
    v_add_u32 v234, s86, v4
    s_xor_b32 s86, s3, 3
    s_mul_i32 s86, s86, 36864
    s_add_u32 s86, s86, 16384
    v_add_u32 v235, s86, v4
    v_lshrrev_b32 v208, 5, v1
    v_lshlrev_b32 v208, 9, v208
    v_and_b32 v209, 31, v1
    v_lshl_add_u32 v208, v209, 2, v208
    s_lshr_b32 s86, s3, 1
    s_lshl_b32 s86, s86, 12
    v_add_u32_e64 v208, s86, v208
    v_xor_b32 v209, 0x1000, v208
    v_add_u32_e64 v236, s70, v208
    v_add_u32 v237, s70, v209
    s_lshl_b32 s86, s3, 11
    s_add_u32 s86, s86, 12288
    v_add_u32_e64 v238, s86, v4
    v_add_u32 v239, 73728, v238
    v_lshrrev_b32_e64 v208, 3, v1
    v_mul_u32_u24 v212, 896, v208
    v_and_b32_e64 v208, 7, v1
    v_lshl_add_u32 v212, v208, 3, v212
    s_lshl_b32 s68, s67, 2
    s_add_u32 s68, s68, s3
    s_mul_i32 s68, s68, 14336
    s_lshl_b32 s86, s66, 7
    s_add_u32 s68, s68, s86
    s_add_u32 s69, s68, 7168
    s_mov_b32 s88, 0xc0135761
    s_mov_b32 s89, 0xc0135761
    s_mov_b32 s90, 0xbdd2d3e8
    s_mov_b32 s91, 0xffff0000
    buffer_load_dword v249, v11, s[40:43], s84 offen sc1
    s_sleep 3
    buffer_load_dword v250, v11, s[40:43], s84 offen sc1
    s_sleep 3
    s_nop 0
Lpoll_P_8:
    s_sub_u32 s6, s6, 1
    s_cbranch_scc1 L_end_P
    buffer_load_dword v251, v11, s[40:43], s84 offen sc1
    s_waitcnt vmcnt(2)
    v_cmp_ne_u32_e64 vcc, s4, v249
    s_nop 1
    s_cbranch_vccz Lpd_P_9
    buffer_load_dword v249, v11, s[40:43], s84 offen sc1
    s_waitcnt vmcnt(2)
    v_cmp_ne_u32 vcc, s4, v250
    s_nop 1
    s_cbranch_vccz Lpd_P_9
    buffer_load_dword v250, v11, s[40:43], s84 offen sc1
    s_waitcnt vmcnt(2)
    v_cmp_ne_u32 vcc, s4, v251
    s_nop 1
    s_cbranch_vccnz Lpoll_P_8
    s_nop 1
Lpd_P_9:
    s_add_u32 s56, s71, s94
    buffer_load_dwordx4 v[80:83], v5, s[40:43], s56 offen offset:0 sc1
    buffer_load_dwordx4 v[84:87], v5, s[40:43], s56 offen offset:1024 sc1
    buffer_load_dwordx4 v[88:91], v5, s[40:43], s56 offen offset:2048 sc1
    buffer_load_dwordx4 v[92:95], v5, s[40:43], s56 offen offset:3072 sc1
    s_add_u32 s56, s71, s95
    buffer_load_dwordx4 v[96:99], v5, s[40:43], s56 offen offset:0 sc1
    buffer_load_dwordx4 v[100:103], v5, s[40:43], s56 offen offset:1024 sc1
    buffer_load_dwordx4 v[104:107], v5, s[40:43], s56 offen offset:2048 sc1
    buffer_load_dwordx4 v[108:111], v5, s[40:43], s56 offen offset:3072 sc1
    v_lshlrev_b32 v16, 16, v220
    v_and_b32 v17, s91, v220
    v_lshlrev_b32 v18, 16, v221
    v_and_b32 v19, s91, v221
    v_lshlrev_b32 v20, 16, v222
    v_and_b32 v21, s91, v222
    v_lshlrev_b32 v22, 16, v223
    v_and_b32_e64 v23, s91, v223
    v_mov_b64 v[24:25], 0
    v_mov_b64 v[26:27], 0
    v_mov_b64 v[28:29], 0
    v_mov_b64 v[30:31], 0
    ds_read_b64_tr_b16 a[80:81], v215 offset:12288
    ds_read_b64_tr_b16 a[82:83], v215 offset:13312
    ds_read_b64_tr_b16 a[84:85], v216 offset:12288
    ds_read_b64_tr_b16 a[86:87], v216 offset:13312
    ds_read_b64_tr_b16 a[88:89], v215 offset:14336
    ds_read_b64_tr_b16 a[90:91], v215 offset:15360
    ds_read_b64_tr_b16 a[92:93], v216 offset:14336
    ds_read_b64_tr_b16 a[94:95], v216 offset:15360
    ds_read_b64_tr_b16 a[96:97], v215 offset:16384
    ds_read_b64_tr_b16 a[98:99], v215 offset:17408
    ds_read_b64_tr_b16 a[100:101], v216 offset:16384
    ds_read_b64_tr_b16 a[102:103], v216 offset:17408
    ds_read_b64_tr_b16 a[104:105], v215 offset:18432
    ds_read_b64_tr_b16 a[106:107], v215 offset:19456
    ds_read_b64_tr_b16 a[108:109], v216 offset:18432
    ds_read_b64_tr_b16 a[110:111], v216 offset:19456
    ds_read_b64_tr_b16 a[112:113], v215 offset:20480
    ds_read_b64_tr_b16 a[114:115], v215 offset:21504
    ds_read_b64_tr_b16 a[116:117], v216 offset:20480
    ds_read_b64_tr_b16 a[118:119], v216 offset:21504
    ds_read_b64_tr_b16 a[120:121], v215 offset:22528
    ds_read_b64_tr_b16 a[122:123], v215 offset:23552
    ds_read_b64_tr_b16 a[124:125], v216 offset:22528
    ds_read_b64_tr_b16 a[126:127], v216 offset:23552
    v_mov_b32 v9, v5
    s_add_u32 s56, s71, s96
    buffer_load_dwordx4 v[112:115], v5, s[40:43], s56 offen offset:0 sc1
    buffer_load_dwordx4 v[116:119], v5, s[40:43], s56 offen offset:1024 sc1
    s_waitcnt vmcnt(9)
    v_mfma_f32_32x32x16_bf16 v[16:31], a[128:131], v[80:83], v[16:31]
    v_mfma_f32_32x32x16_bf16 v[32:47], a[132:135], v[80:83], 0
    buffer_load_dwordx4 v[120:123], v5, s[40:43], s56 offen offset:2048 sc1
    s_waitcnt vmcnt(9)
    v_mfma_f32_32x32x16_bf16 v[16:31], a[136:139], v[84:87], v[16:31]
    v_mfma_f32_32x32x16_bf16 v[32:47], a[140:143], v[84:87], v[32:47]
    buffer_load_dwordx4 v[124:127], v5, s[40:43], s56 offen offset:3072 sc1
    s_waitcnt vmcnt(9)
    v_mfma_f32_32x32x16_bf16 v[16:31], a[144:147], v[88:91], v[16:31]
    v_mfma_f32_32x32x16_bf16 v[32:47], a[148:151], v[88:91], v[32:47]
    s_add_u32 s56, s71, s97
    buffer_load_dwordx4 v[128:131], v5, s[40:43], s56 offen offset:0 sc1
    s_waitcnt vmcnt(9)
    v_mfma_f32_32x32x16_bf16 v[16:31], a[152:155], v[92:95], v[16:31]
    v_mfma_f32_32x32x16_bf16 v[32:47], a[156:159], v[92:95], v[32:47]
    buffer_load_dwordx4 v[132:135], v5, s[40:43], s56 offen offset:1024 sc1
    s_waitcnt vmcnt(9)
    v_mfma_f32_32x32x16_bf16 v[16:31], a[160:163], v[96:99], v[16:31]
    v_mfma_f32_32x32x16_bf16 v[32:47], a[164:167], v[96:99], v[32:47]
    buffer_load_dwordx4 v[136:139], v5, s[40:43], s56 offen offset:2048 sc1
    s_waitcnt vmcnt(9)
    v_mfma_f32_32x32x16_bf16 v[16:31], a[168:171], v[100:103], v[16:31]
    v_mfma_f32_32x32x16_bf16 v[32:47], a[172:175], v[100:103], v[32:47]
    buffer_load_dwordx4 v[140:143], v5, s[40:43], s56 offen offset:3072 sc1
    s_waitcnt vmcnt(9)
    v_mfma_f32_32x32x16_bf16 v[16:31], a[176:179], v[104:107], v[16:31]
    v_mfma_f32_32x32x16_bf16 v[32:47], a[180:183], v[104:107], v[32:47]
    s_add_u32 s56, s71, s98
    buffer_load_dwordx4 v[144:147], v5, s[40:43], s56 offen offset:0 sc1
    s_waitcnt vmcnt(9)
    v_mfma_f32_32x32x16_bf16 v[16:31], a[184:187], v[108:111], v[16:31]
    v_mfma_f32_32x32x16_bf16 v[32:47], a[188:191], v[108:111], v[32:47]
    buffer_load_dwordx4 v[148:151], v5, s[40:43], s56 offen offset:1024 sc1
    s_waitcnt vmcnt(9)
    v_mfma_f32_32x32x16_bf16 v[16:31], a[192:195], v[112:115], v[16:31]
    v_mfma_f32_32x32x16_bf16 v[32:47], a[196:199], v[112:115], v[32:47]
    buffer_load_dwordx4 v[152:155], v5, s[40:43], s56 offen offset:2048 sc1
    s_waitcnt vmcnt(9)
    v_mfma_f32_32x32x16_bf16 v[16:31], a[200:203], v[116:119], v[16:31]
    v_mfma_f32_32x32x16_bf16 v[32:47], a[204:207], v[116:119], v[32:47]
    buffer_load_dwordx4 v[156:159], v5, s[40:43], s56 offen offset:3072 sc1
    s_waitcnt vmcnt(9)
    v_mfma_f32_32x32x16_bf16 v[16:31], a[208:211], v[120:123], v[16:31]
    v_mfma_f32_32x32x16_bf16 v[32:47], a[212:215], v[120:123], v[32:47]
    s_waitcnt lgkmcnt(15)
    s_add_u32 m0, s70, 12288
    s_mul_i32 s73, s49, 64
    s_add_u32 s73, s73, 131072
    buffer_load_dwordx4 v214, s[24:27], s73 offen lds
    s_add_u32 m0, s70, 13312
    s_mul_i32 s73, s49, 64
    s_add_u32 s73, s73, 163840
    buffer_load_dwordx4 v214, s[24:27], s73 offen lds
    s_add_u32 s56, s71, s99
    buffer_load_dwordx4 v[160:163], v5, s[40:43], s56 offen offset:0 sc1
    s_waitcnt vmcnt(11)
    v_mfma_f32_32x32x16_bf16 v[16:31], a[216:219], v[124:127], v[16:31]
    v_mfma_f32_32x32x16_bf16 v[32:47], a[220:223], v[124:127], v[32:47]
    s_add_u32 m0, s70, 14336
    s_mul_i32 s73, s49, 64
    s_add_u32 s73, s73, 196608
    buffer_load_dwordx4 v214, s[24:27], s73 offen lds
    s_add_u32 m0, s70, 15360
    s_mul_i32 s73, s49, 64
    s_add_u32 s73, s73, 229376
    buffer_load_dwordx4 v214, s[24:27], s73 offen lds
    buffer_load_dwordx4 v[164:167], v5, s[40:43], s56 offen offset:1024 sc1
    s_waitcnt vmcnt(13)
    v_mfma_f32_32x32x16_bf16 v[16:31], a[224:227], v[128:131], v[16:31]
    v_mfma_f32_32x32x16_bf16 v[32:47], a[228:231], v[128:131], v[32:47]
    s_waitcnt lgkmcnt(12)
    s_add_u32 m0, s70, 16384
    s_mul_i32 s73, s50, 64
    s_add_u32 s73, s73, 0
    buffer_load_dwordx4 v214, s[24:27], s73 offen lds
    s_add_u32 m0, s70, 17408
    s_mul_i32 s73, s50, 64
    s_add_u32 s73, s73, 32768
    buffer_load_dwordx4 v214, s[24:27], s73 offen lds
    buffer_load_dwordx4 v[168:171], v5, s[40:43], s56 offen offset:2048 sc1
    s_waitcnt vmcnt(15)
    v_mfma_f32_32x32x16_bf16 v[16:31], a[232:235], v[132:135], v[16:31]
    v_mfma_f32_32x32x16_bf16 v[32:47], a[236:239], v[132:135], v[32:47]
    s_waitcnt lgkmcnt(8)
    s_add_u32 m0, s70, 18432
    s_mul_i32 s73, s50, 64
    s_add_u32 s73, s73, 65536
    buffer_load_dwordx4 v214, s[24:27], s73 offen lds
    s_add_u32 m0, s70, 19456
    s_mul_i32 s73, s50, 64
    s_add_u32 s73, s73, 98304
    buffer_load_dwordx4 v214, s[24:27], s73 offen lds
    buffer_load_dwordx4 v[172:175], v5, s[40:43], s56 offen offset:3072 sc1
    s_waitcnt vmcnt(17)
    v_mfma_f32_32x32x16_bf16 v[16:31], a[240:243], v[136:139], v[16:31]
    v_mfma_f32_32x32x16_bf16 v[32:47], a[244:247], v[136:139], v[32:47]
    s_waitcnt lgkmcnt(4)
    s_add_u32 m0, s70, 20480
    s_mul_i32 s73, s50, 64
    s_add_u32 s73, s73, 131072
    buffer_load_dwordx4 v214, s[24:27], s73 offen lds
    s_add_u32 m0, s70, 21504
    s_mul_i32 s73, s50, 64
    s_add_u32 s73, s73, 163840
    buffer_load_dwordx4 v214, s[24:27], s73 offen lds
    s_add_u32 s56, s71, s100
    buffer_load_dwordx4 v[176:179], v5, s[40:43], s56 offen offset:0 sc1
    s_waitcnt vmcnt(19)
    v_mfma_f32_32x32x16_bf16 v[16:31], a[248:251], v[140:143], v[16:31]
    v_mfma_f32_32x32x16_bf16 v[32:47], a[252:255], v[140:143], v[32:47]
    s_waitcnt lgkmcnt(0)
    s_add_u32 m0, s70, 22528
    s_mul_i32 s73, s50, 64
    s_add_u32 s73, s73, 196608
    buffer_load_dwordx4 v214, s[24:27], s73 offen lds
    s_add_u32 m0, s70, 23552
    s_mul_i32 s73, s50, 64
    s_add_u32 s73, s73, 229376
    buffer_load_dwordx4 v214, s[24:27], s73 offen lds
    buffer_load_dwordx4 v[180:183], v5, s[40:43], s56 offen offset:1024 sc1
    s_waitcnt vmcnt(21)
    v_mfma_f32_32x32x16_bf16 v[16:31], a[0:3], v[144:147], v[16:31]
    v_mfma_f32_32x32x16_bf16 v[32:47], a[4:7], v[144:147], v[32:47]
    s_barrier
    buffer_load_dwordx4 v[184:187], v5, s[40:43], s56 offen offset:2048 sc1
    s_waitcnt vmcnt(21)
    v_mfma_f32_32x32x16_bf16 v[16:31], a[8:11], v[148:151], v[16:31]
    v_mfma_f32_32x32x16_bf16 v[32:47], a[12:15], v[148:151], v[32:47]
    buffer_load_dwordx4 v[188:191], v5, s[40:43], s56 offen offset:3072 sc1
    s_waitcnt vmcnt(21)
    v_mfma_f32_32x32x16_bf16 v[16:31], a[16:19], v[152:155], v[16:31]
    v_mfma_f32_32x32x16_bf16 v[32:47], a[20:23], v[152:155], v[32:47]
    s_add_u32 s56, s71, s101
    buffer_load_dwordx4 v[192:195], v5, s[40:43], s56 offen offset:0 sc1
    s_waitcnt vmcnt(21)
    v_mfma_f32_32x32x16_bf16 v[16:31], a[24:27], v[156:159], v[16:31]
    v_mfma_f32_32x32x16_bf16 v[32:47], a[28:31], v[156:159], v[32:47]
    buffer_load_dwordx4 v[196:199], v5, s[40:43], s56 offen offset:1024 sc1
    s_waitcnt vmcnt(19)
    v_mfma_f32_32x32x16_bf16 v[16:31], a[32:35], v[160:163], v[16:31]
    v_mfma_f32_32x32x16_bf16 v[32:47], a[36:39], v[160:163], v[32:47]
    v_lshlrev_b32 v48, 16, v220
    v_and_b32 v49, s91, v220
    v_lshlrev_b32 v50, 16, v221
    v_and_b32 v51, s91, v221
    buffer_load_dwordx4 v[200:203], v5, s[40:43], s56 offen offset:2048 sc1
    s_waitcnt vmcnt(17)
    v_mfma_f32_32x32x16_bf16 v[16:31], a[40:43], v[164:167], v[16:31]
    v_mfma_f32_32x32x16_bf16 v[32:47], a[44:47], v[164:167], v[32:47]
    v_lshlrev_b32 v52, 16, v222
    v_and_b32 v53, s91, v222
    v_lshlrev_b32_e64 v54, 16, v223
    v_and_b32 v55, s91, v223
    buffer_load_dwordx4 v[204:207], v5, s[40:43], s56 offen offset:3072 sc1
    s_waitcnt vmcnt(15)
    v_mfma_f32_32x32x16_bf16 v[16:31], a[48:51], v[168:171], v[16:31]
    v_mfma_f32_32x32x16_bf16 v[32:47], a[52:55], v[168:171], v[32:47]
    v_mov_b64 v[56:57], 0
    v_mov_b64 v[58:59], 0
    v_mov_b64 v[60:61], 0
    v_mov_b64 v[62:63], 0
    s_add_u32 s56, s72, s94
    buffer_load_dwordx4 v[80:83], v5, s[40:43], s56 offen offset:0 sc1
    s_waitcnt vmcnt(13)
    v_mfma_f32_32x32x16_bf16 v[16:31], a[56:59], v[172:175], v[16:31]
    v_mfma_f32_32x32x16_bf16 v[32:47], a[60:63], v[172:175], v[32:47]
    buffer_load_dwordx4 v[84:87], v5, s[40:43], s56 offen offset:1024 sc1
    s_waitcnt vmcnt(11)
    v_mfma_f32_32x32x16_bf16 v[16:31], a[64:67], v[176:179], v[16:31]
    v_mfma_f32_32x32x16_bf16 v[32:47], a[68:71], v[176:179], v[32:47]
    buffer_load_dwordx4 v[88:91], v5, s[40:43], s56 offen offset:2048 sc1
    s_waitcnt vmcnt(9)
    v_mfma_f32_32x32x16_bf16 v[16:31], a[72:75], v[180:183], v[16:31]
    v_mfma_f32_32x32x16_bf16 v[32:47], a[76:79], v[180:183], v[32:47]
    buffer_load_dwordx4 v[92:95], v5, s[40:43], s56 offen offset:3072 sc1
    s_waitcnt vmcnt(9)
    v_mfma_f32_32x32x16_bf16 v[16:31], a[80:83], v[184:187], v[16:31]
    v_mfma_f32_32x32x16_bf16 v[32:47], a[84:87], v[184:187], v[32:47]
    s_add_u32 s56, s72, s95
    buffer_load_dwordx4 v[96:99], v5, s[40:43], s56 offen offset:0 sc1
    s_waitcnt vmcnt(9)
    v_mfma_f32_32x32x16_bf16 v[16:31], a[88:91], v[188:191], v[16:31]
    v_mfma_f32_32x32x16_bf16 v[32:47], a[92:95], v[188:191], v[32:47]
    buffer_load_dwordx4 v[100:103], v5, s[40:43], s56 offen offset:1024 sc1
    s_waitcnt vmcnt(9)
    v_mfma_f32_32x32x16_bf16 v[16:31], a[96:99], v[192:195], v[16:31]
    v_mfma_f32_32x32x16_bf16 v[32:47], a[100:103], v[192:195], v[32:47]
    buffer_load_dwordx4 v[104:107], v5, s[40:43], s56 offen offset:2048 sc1
    s_waitcnt vmcnt(9)
    v_mfma_f32_32x32x16_bf16 v[16:31], a[104:107], v[196:199], v[16:31]
    v_mfma_f32_32x32x16_bf16 v[32:47], a[108:111], v[196:199], v[32:47]
    buffer_load_dwordx4 v[108:111], v5, s[40:43], s56 offen offset:3072 sc1
    s_waitcnt vmcnt(9)
    v_mfma_f32_32x32x16_bf16 v[16:31], a[112:115], v[200:203], v[16:31]
    v_mfma_f32_32x32x16_bf16 v[32:47], a[116:119], v[200:203], v[32:47]
    s_add_u32 s56, s72, s96
    buffer_load_dwordx4 v[112:115], v5, s[40:43], s56 offen offset:0 sc1
    s_waitcnt vmcnt(9)
    v_mfma_f32_32x32x16_bf16 v[16:31], a[120:123], v[204:207], v[16:31]
    v_mfma_f32_32x32x16_bf16 v[32:47], a[124:127], v[204:207], v[32:47]
    buffer_load_dwordx4 v[116:119], v5, s[40:43], s56 offen offset:1024 sc1
    s_waitcnt vmcnt(9)
    v_mfma_f32_32x32x16_bf16 v[48:63], a[128:131], v[80:83], v[48:63]
    v_mfma_f32_32x32x16_bf16 v[64:79], a[132:135], v[80:83], 0
    s_nop 7
    ds_write_b128 v235, v[40:43] offset:0
    ds_write_b128 v235, v[44:47] offset:1024
    ds_write_b128 v234, v[32:35] offset:0
    buffer_load_dwordx4 v[120:123], v5, s[40:43], s56 offen offset:2048 sc1
    s_waitcnt vmcnt(9)
    v_mfma_f32_32x32x16_bf16 v[48:63], a[136:139], v[84:87], v[48:63]
    v_mfma_f32_32x32x16_bf16 v[64:79], a[140:143], v[84:87], v[64:79]
    ds_write_b128 v234, v[36:39] offset:1024
    ds_write_b128 v233, v[24:27] offset:0
    ds_write_b128 v233, v[28:31] offset:1024
    buffer_load_dwordx4 v[124:127], v5, s[40:43], s56 offen offset:3072 sc1
    s_waitcnt vmcnt(9)
    v_mfma_f32_32x32x16_bf16 v[48:63], a[144:147], v[88:91], v[48:63]
    v_mfma_f32_32x32x16_bf16 v[64:79], a[148:151], v[88:91], v[64:79]
    s_waitcnt lgkmcnt(0)
    s_barrier
    ds_read_b128 v[24:27], v232 offset:0
    ds_read_b128 v[32:35], v232 offset:2048
    ds_read_b128 v[40:43], v232 offset:4096
    ds_read_b128 v[28:31], v232 offset:1024
    ds_read_b128 v[36:39], v232 offset:3072
    ds_read_b128 v[44:47], v232 offset:5120
    s_add_u32 s56, s72, s97
    buffer_load_dwordx4 v[128:131], v5, s[40:43], s56 offen offset:0 sc1
    s_waitcnt vmcnt(9)
    v_mfma_f32_32x32x16_bf16 v[48:63], a[152:155], v[92:95], v[48:63]
    v_mfma_f32_32x32x16_bf16 v[64:79], a[156:159], v[92:95], v[64:79]
    buffer_load_dwordx4 v[132:135], v5, s[40:43], s56 offen offset:1024 sc1
    s_waitcnt vmcnt(9)
    v_mfma_f32_32x32x16_bf16 v[48:63], a[160:163], v[96:99], v[48:63]
    v_mfma_f32_32x32x16_bf16 v[64:79], a[164:167], v[96:99], v[64:79]
    v_mov_b32 v211, s88
    s_waitcnt lgkmcnt(4)
    v_add_f32 v24, v24, v32
    s_waitcnt lgkmcnt(3)
    v_add_f32 v16, v16, v40
    v_add_f32 v25, v25, v33
    v_add_f32 v17, v17, v41
    v_add_f32 v26, v26, v34
    v_add_f32 v18, v18, v42
    v_add_f32 v27, v27, v35
    v_add_f32 v19, v19, v43
    s_waitcnt lgkmcnt(1)
    v_add_f32 v28, v28, v36
    s_waitcnt lgkmcnt(0)
    v_add_f32 v20, v20, v44
    v_add_f32 v29, v29, v37
    v_add_f32 v21, v21, v45
    v_add_f32 v30, v30, v38
    v_add_f32 v22, v22, v46
    v_add_f32 v31, v31, v39
    buffer_load_dwordx4 v[136:139], v5, s[40:43], s56 offen offset:2048 sc1
    s_waitcnt vmcnt(9)
    v_mfma_f32_32x32x16_bf16 v[48:63], a[168:171], v[100:103], v[48:63]
    v_mfma_f32_32x32x16_bf16 v[64:79], a[172:175], v[100:103], v[64:79]
    v_add_f32 v23, v23, v47
    v_add_f32 v16, v16, v24
    v_add_f32 v17, v17, v25
    v_add_f32 v18, v18, v26
    v_add_f32 v19, v19, v27
    v_add_f32 v20, v20, v28
    v_add_f32 v21, v21, v29
    v_add_f32 v22, v22, v30
    v_add_f32 v23, v23, v31
    v_mul_f32 v24, v16, v16
    v_mul_f32 v25, v17, v17
    v_mul_f32 v26, v18, v18
    v_mul_f32 v27, v19, v19
    v_mul_f32 v28, v20, v20
    v_mul_f32_e64 v29, v21, v21
    v_mul_f32 v30, v22, v22
    buffer_load_dwordx4 v[140:143], v5, s[40:43], s56 offen offset:3072 sc1
    s_waitcnt vmcnt(9)
    v_mfma_f32_32x32x16_bf16 v[48:63], a[176:179], v[104:107], v[48:63]
    v_mfma_f32_32x32x16_bf16 v[64:79], a[180:183], v[104:107], v[64:79]
    v_mul_f32_e64 v31, v23, v23
    v_fma_f32 v24, v24, s90, v211
    v_fma_f32 v25, v25, s90, v211
    v_fma_f32 v26, v26, s90, v211
    v_fma_f32 v27, v27, s90, v211
    v_fma_f32 v28, v28, s90, v211
    v_fma_f32 v29, v29, s90, v211
    v_fma_f32 v30, v30, s90, v211
    v_fma_f32 v31, v31, s90, v211
    v_mul_f32 v24, v24, v16
    v_mul_f32 v25, v25, v17
    v_mul_f32 v26, v26, v18
    v_mul_f32 v27, v27, v19
    v_mul_f32 v28, v28, v20
    v_mul_f32 v29, v29, v21
    v_mul_f32_e64 v30, v30, v22
    s_add_u32 s56, s72, s98
    buffer_load_dwordx4 v[144:147], v5, s[40:43], s56 offen offset:0 sc1
    s_waitcnt vmcnt(9)
    v_mfma_f32_32x32x16_bf16 v[48:63], a[184:187], v[108:111], v[48:63]
    v_mfma_f32_32x32x16_bf16 v[64:79], a[188:191], v[108:111], v[64:79]
    v_mul_f32 v31, v31, v23
    v_exp_f32 v24, v24
    v_exp_f32 v25, v25
    v_exp_f32 v26, v26
    v_exp_f32 v27, v27
    v_exp_f32 v28, v28
    v_exp_f32 v29, v29
    v_exp_f32 v30, v30
    v_exp_f32 v31, v31
    v_add_f32 v24, 1.0, v24
    v_add_f32 v25, 1.0, v25
    v_add_f32 v26, 1.0, v26
    v_add_f32 v27, 1.0, v27
    v_add_f32 v28, 1.0, v28
    v_add_f32 v29, 1.0, v29
    v_add_f32 v30, 1.0, v30
    ds_read_b64_tr_b16 a[128:129], v217 offset:24576
    ds_read_b64_tr_b16 a[130:131], v217 offset:25600
    ds_read_b64_tr_b16 a[132:133], v218 offset:24576
    ds_read_b64_tr_b16 a[134:135], v218 offset:25600
    ds_read_b64_tr_b16 a[136:137], v217 offset:26624
    ds_read_b64_tr_b16 a[138:139], v217 offset:27648
    ds_read_b64_tr_b16 a[140:141], v218 offset:26624
    ds_read_b64_tr_b16 a[142:143], v218 offset:27648
    buffer_load_dwordx4 v[148:151], v5, s[40:43], s56 offen offset:1024 sc1
    s_waitcnt vmcnt(9)
    v_mfma_f32_32x32x16_bf16 v[48:63], a[192:195], v[112:115], v[48:63]
    v_mfma_f32_32x32x16_bf16 v[64:79], a[196:199], v[112:115], v[64:79]
    v_add_f32 v31, 1.0, v31
    v_rcp_f32 v24, v24
    v_rcp_f32 v25, v25
    v_rcp_f32 v26, v26
    v_rcp_f32 v27, v27
    v_rcp_f32 v28, v28
    v_rcp_f32 v29, v29
    v_rcp_f32 v30, v30
    v_rcp_f32 v31, v31
    v_mul_f32 v24, v24, v16
    v_mul_f32 v25, v25, v17
    v_mul_f32 v26, v26, v18
    v_mul_f32 v27, v27, v19
    v_mul_f32 v28, v28, v20
    v_mul_f32 v29, v29, v21
    v_mul_f32_e64 v30, v30, v22
    ds_read_b64_tr_b16 a[144:145], v217 offset:28672
    ds_read_b64_tr_b16 a[146:147], v217 offset:29696
    ds_read_b64_tr_b16 a[148:149], v218 offset:28672
    ds_read_b64_tr_b16 a[150:151], v218 offset:29696
    ds_read_b64_tr_b16 a[152:153], v217 offset:30720
    ds_read_b64_tr_b16 a[154:155], v217 offset:31744
    ds_read_b64_tr_b16 a[156:157], v218 offset:30720
    ds_read_b64_tr_b16 a[158:159], v218 offset:31744
    buffer_load_dwordx4 v[152:155], v5, s[40:43], s56 offen offset:2048 sc1
    s_waitcnt vmcnt(9)
    v_mfma_f32_32x32x16_bf16 v[48:63], a[200:203], v[116:119], v[48:63]
    v_mfma_f32_32x32x16_bf16 v[64:79], a[204:207], v[116:119], v[64:79]
    v_mul_f32 v31, v31, v23
    v_cvt_pk_bf16_f32 v32, v24, v25
    v_cvt_pk_bf16_f32 v33, v26, v27
    v_cvt_pk_bf16_f32 v34, v28, v29
    v_cvt_pk_bf16_f32 v35, v30, v31
    buffer_store_dwordx4 v[32:35], v5, s[40:43], s57 offen sc1
    ds_read_b64_tr_b16 a[160:161], v217 offset:32768
    ds_read_b64_tr_b16 a[162:163], v217 offset:33792
    ds_read_b64_tr_b16 a[164:165], v218 offset:32768
    ds_read_b64_tr_b16 a[166:167], v218 offset:33792
    ds_read_b64_tr_b16 a[168:169], v217 offset:34816
    ds_read_b64_tr_b16 a[170:171], v217 offset:35840
    ds_read_b64_tr_b16 a[172:173], v218 offset:34816
    ds_read_b64_tr_b16 a[174:175], v218 offset:35840
    buffer_load_dwordx4 v[156:159], v5, s[40:43], s56 offen offset:3072 sc1
    s_waitcnt vmcnt(10)
    v_mfma_f32_32x32x16_bf16 v[48:63], a[208:211], v[120:123], v[48:63]
    v_mfma_f32_32x32x16_bf16 v[64:79], a[212:215], v[120:123], v[64:79]
    ds_read_b64_tr_b16 a[176:177], v217 offset:12288
    ds_read_b64_tr_b16 a[178:179], v217 offset:13312
    ds_read_b64_tr_b16 a[180:181], v218 offset:12288
    ds_read_b64_tr_b16 a[182:183], v218 offset:13312
    ds_read_b64_tr_b16 a[184:185], v217 offset:14336
    ds_read_b64_tr_b16 a[186:187], v217 offset:15360
    ds_read_b64_tr_b16 a[188:189], v218 offset:14336
    ds_read_b64_tr_b16 a[190:191], v218 offset:15360
    s_and_b32 s60, s3, 1
    s_cmp_eq_u32 s60, 0
    s_cselect_b32 s60, 1.0, 0
    v_lshlrev_b32 v16, 16, v224
    v_and_b32 v17, s91, v224
    v_lshlrev_b32 v208, 16, v240
    v_and_b32 v209, s91, v240
    v_add_f32_e64 v16, v16, v208
    s_add_u32 s56, s72, s99
    buffer_load_dwordx4 v[160:163], v5, s[40:43], s56 offen offset:0 sc1
    s_waitcnt vmcnt(10)
    v_mfma_f32_32x32x16_bf16 v[48:63], a[216:219], v[124:127], v[48:63]
    v_mfma_f32_32x32x16_bf16 v[64:79], a[220:223], v[124:127], v[64:79]
    ds_read_b64_tr_b16 a[192:193], v217 offset:16384
    ds_read_b64_tr_b16 a[194:195], v217 offset:17408
    ds_read_b64_tr_b16 a[196:197], v218 offset:16384
    ds_read_b64_tr_b16 a[198:199], v218 offset:17408
    ds_read_b64_tr_b16 a[200:201], v217 offset:18432
    ds_read_b64_tr_b16 a[202:203], v217 offset:19456
    ds_read_b64_tr_b16 a[204:205], v218 offset:18432
    ds_read_b64_tr_b16 a[206:207], v218 offset:19456
    v_add_f32 v17, v17, v209
    v_mul_f32 v16, s60, v16
    v_mul_f32 v17, s60, v17
    v_lshlrev_b32 v18, 16, v225
    v_and_b32_e64 v19, s91, v225
    v_lshlrev_b32 v210, 16, v241
    buffer_load_dwordx4 v[164:167], v5, s[40:43], s56 offen offset:1024 sc1
    s_waitcnt vmcnt(10)
    v_mfma_f32_32x32x16_bf16 v[48:63], a[224:227], v[128:131], v[48:63]
    v_mfma_f32_32x32x16_bf16 v[64:79], a[228:231], v[128:131], v[64:79]
    ds_read_b64_tr_b16 a[208:209], v217 offset:20480
    ds_read_b64_tr_b16 a[210:211], v217 offset:21504
    ds_read_b64_tr_b16 a[212:213], v218 offset:20480
    ds_read_b64_tr_b16 a[214:215], v218 offset:21504
    ds_read_b64_tr_b16 a[216:217], v217 offset:22528
    ds_read_b64_tr_b16 a[218:219], v217 offset:23552
    ds_read_b64_tr_b16 a[220:221], v218 offset:22528
    ds_read_b64_tr_b16 a[222:223], v218 offset:23552
    s_waitcnt lgkmcnt(15)
    s_add_u32 m0, s70, 24576
    s_mul_i32 s73, s51, 64
    s_add_u32 s73, s73, 0
    buffer_load_dwordx4 v214, s[24:27], s73 offen lds
    s_add_u32 m0, s70, 25600
    s_mul_i32 s73, s51, 64
    s_add_u32 s73, s73, 32768
    buffer_load_dwordx4 v214, s[24:27], s73 offen lds
    v_and_b32 v211, s91, v241
    v_add_f32 v18, v18, v210
    v_add_f32 v19, v19, v211
    v_mul_f32 v18, s60, v18
    v_mul_f32 v19, s60, v19
    v_lshlrev_b32 v20, 16, v226
    buffer_load_dwordx4 v[168:171], v5, s[40:43], s56 offen offset:2048 sc1
    s_waitcnt vmcnt(12)
    v_mfma_f32_32x32x16_bf16 v[48:63], a[232:235], v[132:135], v[48:63]
    v_mfma_f32_32x32x16_bf16 v[64:79], a[236:239], v[132:135], v[64:79]
    s_waitcnt vmcnt(6)
    v_mov_b32 v8, s4
    s_mov_b64 exec, 1
    buffer_store_dword v8, v9, s[40:43], s82 offen sc1
    s_mov_b64 exec, -1
    s_add_u32 m0, s70, 26624
    s_mul_i32 s73, s51, 64
    s_add_u32 s73, s73, 65536
    buffer_load_dwordx4 v214, s[24:27], s73 offen lds
    s_add_u32 m0, s70, 27648
    s_mul_i32 s73, s51, 64
    s_add_u32 s73, s73, 98304
    buffer_load_dwordx4 v214, s[24:27], s73 offen lds
    v_and_b32 v21, s91, v226
    v_lshlrev_b32 v208, 16, v242
    v_and_b32 v209, s91, v242
    v_add_f32 v20, v20, v208
    v_add_f32 v21, v21, v209
    v_mul_f32_e64 v20, s60, v20
    buffer_load_dwordx4 v[172:175], v5, s[40:43], s56 offen offset:3072 sc1
    v_mfma_f32_32x32x16_bf16 v[48:63], a[240:243], v[136:139], v[48:63]
    v_mfma_f32_32x32x16_bf16 v[64:79], a[244:247], v[136:139], v[64:79]
    s_add_u32 m0, s70, 28672
    s_mul_i32 s73, s51, 64
    s_add_u32 s73, s73, 131072
    buffer_load_dwordx4 v214, s[24:27], s73 offen lds
    s_add_u32 m0, s70, 29696
    s_mul_i32 s73, s51, 64
    s_add_u32 s73, s73, 163840
    buffer_load_dwordx4 v214, s[24:27], s73 offen lds
    v_mul_f32 v21, s60, v21
    v_lshlrev_b32 v22, 16, v227
    v_and_b32 v23, s91, v227
    v_lshlrev_b32 v210, 16, v243
    v_and_b32_e64 v211, s91, v243
    v_add_f32 v22, v22, v210
    s_add_u32 s56, s72, s100
    buffer_load_dwordx4 v[176:179], v5, s[40:43], s56 offen offset:0 sc1
    v_mfma_f32_32x32x16_bf16 v[48:63], a[248:251], v[140:143], v[48:63]
    v_mfma_f32_32x32x16_bf16 v[64:79], a[252:255], v[140:143], v[64:79]
    s_add_u32 m0, s70, 30720
    s_mul_i32 s73, s51, 64
    s_add_u32 s73, s73, 196608
    buffer_load_dwordx4 v214, s[24:27], s73 offen lds
    s_add_u32 m0, s70, 31744
    s_mul_i32 s73, s51, 64
    s_add_u32 s73, s73, 229376
    buffer_load_dwordx4 v214, s[24:27], s73 offen lds
    v_add_f32 v23, v23, v211
    v_mul_f32 v22, s60, v22
    v_mul_f32 v23, s60, v23
    v_lshlrev_b32 v24, 16, v228
    v_and_b32 v25, s91, v228
    v_lshlrev_b32 v208, 16, v244
    buffer_load_dwordx4 v[180:183], v5, s[40:43], s56 offen offset:1024 sc1
    v_mfma_f32_32x32x16_bf16 v[48:63], a[0:3], v[144:147], v[48:63]
    v_mfma_f32_32x32x16_bf16 v[64:79], a[4:7], v[144:147], v[64:79]
    s_add_u32 m0, s70, 32768
    s_mul_i32 s73, s52, 64
    s_add_u32 s73, s73, 0
    buffer_load_dwordx4 v214, s[24:27], s73 offen lds
    s_add_u32 m0, s70, 33792
    s_mul_i32 s73, s52, 64
    s_add_u32 s73, s73, 32768
    buffer_load_dwordx4 v214, s[24:27], s73 offen lds
    v_and_b32 v209, s91, v244
    v_add_f32 v24, v24, v208
    v_add_f32 v25, v25, v209
    v_mul_f32 v24, s60, v24
    v_mul_f32 v25, s60, v25
    v_lshlrev_b32_e64 v26, 16, v229
    buffer_load_dwordx4 v[184:187], v5, s[40:43], s56 offen offset:2048 sc1
    v_mfma_f32_32x32x16_bf16 v[48:63], a[8:11], v[148:151], v[48:63]
    v_mfma_f32_32x32x16_bf16 v[64:79], a[12:15], v[148:151], v[64:79]
    s_add_u32 m0, s70, 34816
    s_mul_i32 s73, s52, 64
    s_add_u32 s73, s73, 65536
    buffer_load_dwordx4 v214, s[24:27], s73 offen lds
    s_add_u32 m0, s70, 35840
    s_mul_i32 s73, s52, 64
    s_add_u32 s73, s73, 98304
    buffer_load_dwordx4 v214, s[24:27], s73 offen lds
    v_and_b32 v27, s91, v229
    v_lshlrev_b32 v210, 16, v245
    v_and_b32 v211, s91, v245
    v_add_f32 v26, v26, v210
    v_add_f32 v27, v27, v211
    v_mul_f32 v26, s60, v26
    buffer_load_dwordx4 v[188:191], v5, s[40:43], s56 offen offset:3072 sc1
    v_mfma_f32_32x32x16_bf16 v[48:63], a[16:19], v[152:155], v[48:63]
    v_mfma_f32_32x32x16_bf16 v[64:79], a[20:23], v[152:155], v[64:79]
    s_add_u32 m0, s70, 12288
    s_mul_i32 s73, s52, 64
    s_add_u32 s73, s73, 131072
    buffer_load_dwordx4 v214, s[24:27], s73 offen lds
    s_add_u32 m0, s70, 13312
    s_mul_i32 s73, s52, 64
    s_add_u32 s73, s73, 163840
    buffer_load_dwordx4 v214, s[24:27], s73 offen lds
    v_mul_f32 v27, s60, v27
    v_lshlrev_b32 v28, 16, v230
    v_and_b32 v29, s91, v230
    v_lshlrev_b32 v208, 16, v246
    v_and_b32 v209, s91, v246
    v_add_f32 v28, v28, v208
    buffer_load_dword v248, v12, s[40:43], s85 offen offset:0 sc1
    s_add_u32 s56, s72, s101
    buffer_load_dwordx4 v[192:195], v5, s[40:43], s56 offen offset:0 sc1
    s_waitcnt vmcnt(25)
    v_mfma_f32_32x32x16_bf16 v[48:63], a[24:27], v[156:159], v[48:63]
    v_mfma_f32_32x32x16_bf16 v[64:79], a[28:31], v[156:159], v[64:79]
    s_add_u32 m0, s70, 14336
    s_mul_i32 s73, s52, 64
    s_add_u32 s73, s73, 196608
    buffer_load_dwordx4 v214, s[24:27], s73 offen lds
    s_add_u32 m0, s70, 15360
    s_mul_i32 s73, s52, 64
    s_add_u32 s73, s73, 229376
    buffer_load_dwordx4 v214, s[24:27], s73 offen lds
    v_add_f32 v29, v29, v209
    v_mul_f32 v28, s60, v28
    v_mul_f32 v29, s60, v29
    v_lshlrev_b32 v30, 16, v231
    v_and_b32 v31, s91, v231
    v_lshlrev_b32 v210, 16, v247
    buffer_load_dwordx4 v[196:199], v5, s[40:43], s56 offen offset:1024 sc1
    s_waitcnt vmcnt(27)
    v_mfma_f32_32x32x16_bf16 v[48:63], a[32:35], v[160:163], v[48:63]
    v_mfma_f32_32x32x16_bf16 v[64:79], a[36:39], v[160:163], v[64:79]
    s_waitcnt vmcnt(24)
    ds_read_b64_tr_b16 a[224:225], v217 offset:24576
    ds_read_b64_tr_b16 a[226:227], v217 offset:25600
    ds_read_b64_tr_b16 a[228:229], v218 offset:24576
    ds_read_b64_tr_b16 a[230:231], v218 offset:25600
    v_and_b32 v211, s91, v247
    v_add_f32 v30, v30, v210
    v_add_f32 v31, v31, v211
    v_mul_f32 v30, s60, v30
    v_mul_f32 v31, s60, v31
    buffer_load_dwordx4 v[200:203], v5, s[40:43], s56 offen offset:2048 sc1
    v_mfma_f32_32x32x16_bf16 v[48:63], a[40:43], v[164:167], v[48:63]
    v_mfma_f32_32x32x16_bf16 v[64:79], a[44:47], v[164:167], v[64:79]
    s_waitcnt vmcnt(21)
    ds_read_b64_tr_b16 a[232:233], v217 offset:26624
    ds_read_b64_tr_b16 a[234:235], v217 offset:27648
    ds_read_b64_tr_b16 a[236:237], v218 offset:26624
    ds_read_b64_tr_b16 a[238:239], v218 offset:27648
    buffer_load_dwordx4 v[204:207], v5, s[40:43], s56 offen offset:3072 sc1
    v_mfma_f32_32x32x16_bf16 v[48:63], a[48:51], v[168:171], v[48:63]
    v_mfma_f32_32x32x16_bf16 v[64:79], a[52:55], v[168:171], v[64:79]
    s_waitcnt vmcnt(19)
    ds_read_b64_tr_b16 a[240:241], v217 offset:28672
    ds_read_b64_tr_b16 a[242:243], v217 offset:29696
    ds_read_b64_tr_b16 a[244:245], v218 offset:28672
    ds_read_b64_tr_b16 a[246:247], v218 offset:29696
    s_waitcnt vmcnt(6)
    v_cmp_ne_u32_e64 vcc, s4, v248
    s_nop 1
    s_cbranch_vccz Lpcd_P_11
    s_nop 1
Lpc_P_10:
    s_sub_u32 s6, s6, 1
    s_cbranch_scc1 L_end_P
    buffer_load_dword v248, v12, s[40:43], s85 offen offset:0 sc1
    s_waitcnt vmcnt(0)
    v_cmp_ne_u32 vcc, s4, v248
    s_nop 1
    s_cbranch_vccnz Lpc_P_10
Lpcd_P_11:
    s_add_u32 s56, s58, s48
    buffer_load_dwordx4 v[80:83], v4, s[40:43], s56 offen offset:0 sc1
    v_mfma_f32_32x32x16_bf16 v[48:63], a[56:59], v[172:175], v[48:63]
    v_mfma_f32_32x32x16_bf16 v[64:79], a[60:63], v[172:175], v[64:79]
    ds_read_b64_tr_b16 a[248:249], v217 offset:30720
    ds_read_b64_tr_b16 a[250:251], v217 offset:31744
    ds_read_b64_tr_b16 a[252:253], v218 offset:30720
    ds_read_b64_tr_b16 a[254:255], v218 offset:31744
    buffer_load_dwordx4 v[84:87], v4, s[40:43], s56 offen offset:1024 sc1
    v_mfma_f32_32x32x16_bf16 v[48:63], a[64:67], v[176:179], v[48:63]
    v_mfma_f32_32x32x16_bf16 v[64:79], a[68:71], v[176:179], v[64:79]
    ds_read_b64_tr_b16 a[0:1], v217 offset:32768
    ds_read_b64_tr_b16 a[2:3], v217 offset:33792
    ds_read_b64_tr_b16 a[4:5], v218 offset:32768
    ds_read_b64_tr_b16 a[6:7], v218 offset:33792
    buffer_load_dwordx4 v[88:91], v4, s[40:43], s56 offen offset:2048 sc1
    v_mfma_f32_32x32x16_bf16 v[48:63], a[72:75], v[180:183], v[48:63]
    v_mfma_f32_32x32x16_bf16 v[64:79], a[76:79], v[180:183], v[64:79]
    ds_read_b64_tr_b16 a[8:9], v217 offset:34816
    ds_read_b64_tr_b16 a[10:11], v217 offset:35840
    ds_read_b64_tr_b16 a[12:13], v218 offset:34816
    ds_read_b64_tr_b16 a[14:15], v218 offset:35840
    buffer_load_dwordx4 v[92:95], v4, s[40:43], s56 offen offset:3072 sc1
    v_mfma_f32_32x32x16_bf16 v[48:63], a[80:83], v[184:187], v[48:63]
    v_mfma_f32_32x32x16_bf16 v[64:79], a[84:87], v[184:187], v[64:79]
    ds_read_b64_tr_b16 a[16:17], v217 offset:12288
    ds_read_b64_tr_b16 a[18:19], v217 offset:13312
    ds_read_b64_tr_b16 a[20:21], v218 offset:12288
    ds_read_b64_tr_b16 a[22:23], v218 offset:13312
    s_add_u32 s56, s58, s49
    buffer_load_dwordx4 v[96:99], v4, s[40:43], s56 offen offset:0 sc1
    v_mfma_f32_32x32x16_bf16 v[48:63], a[88:91], v[188:191], v[48:63]
    v_mfma_f32_32x32x16_bf16 v[64:79], a[92:95], v[188:191], v[64:79]
    s_waitcnt vmcnt(8)
    ds_read_b64_tr_b16 a[24:25], v217 offset:14336
    ds_read_b64_tr_b16 a[26:27], v217 offset:15360
    ds_read_b64_tr_b16 a[28:29], v218 offset:14336
    ds_read_b64_tr_b16 a[30:31], v218 offset:15360
    buffer_load_dwordx4 v[100:103], v4, s[40:43], s56 offen offset:1024 sc1
    buffer_load_dwordx4 v[104:107], v4, s[40:43], s56 offen offset:2048 sc1
    buffer_load_dwordx4 v[108:111], v4, s[40:43], s56 offen offset:3072 sc1
    s_add_u32 s56, s58, s50
    buffer_load_dwordx4 v[112:115], v4, s[40:43], s56 offen offset:0 sc1
    v_mfma_f32_32x32x16_bf16 v[64:79], a[100:103], v[192:195], v[64:79]
    s_waitcnt vmcnt(11)
    v_mfma_f32_32x32x16_bf16 v[64:79], a[108:111], v[196:199], v[64:79]
    s_waitcnt vmcnt(10)
    v_mfma_f32_32x32x16_bf16 v[64:79], a[116:119], v[200:203], v[64:79]
    s_waitcnt vmcnt(9)
    v_mfma_f32_32x32x16_bf16 v[64:79], a[124:127], v[204:207], v[64:79]
    v_mfma_f32_32x32x16_bf16 v[48:63], a[96:99], v[192:195], v[48:63]
    v_mfma_f32_32x32x16_bf16 v[48:63], a[104:107], v[196:199], v[48:63]
    s_nop 9
    ds_write_b128 v235, v[72:75] offset:6144
    ds_write_b128 v235, v[76:79] offset:7168
    v_mfma_f32_32x32x16_bf16 v[48:63], a[112:115], v[200:203], v[48:63]
    ds_write_b128 v234, v[64:67] offset:6144
    ds_write_b128 v234, v[68:71] offset:7168
    v_mfma_f32_32x32x16_bf16 v[48:63], a[120:123], v[204:207], v[48:63]
    s_nop 11
    ds_write_b128 v233, v[56:59] offset:6144
    ds_write_b128 v233, v[60:63] offset:7168
    s_waitcnt lgkmcnt(0)
    s_barrier
    ds_read_b128 v[56:59], v232 offset:6144
    ds_read_b128 v[64:67], v232 offset:8192
    ds_read_b128 v[72:75], v232 offset:10240
    ds_read_b128 v[60:63], v232 offset:7168
    ds_read_b128 v[68:71], v232 offset:9216
    ds_read_b128 v[76:79], v232 offset:11264
    v_mov_b32_e64 v211, s88
    s_waitcnt lgkmcnt(4)
    v_pk_add_f32 v[56:57], v[56:57], v[64:65]
    s_waitcnt lgkmcnt(3)
    v_pk_add_f32 v[48:49], v[48:49], v[72:73]
    v_pk_add_f32 v[58:59], v[58:59], v[66:67]
    v_pk_add_f32 v[50:51], v[50:51], v[74:75]
    s_waitcnt lgkmcnt(1)
    v_pk_add_f32 v[60:61], v[60:61], v[68:69]
    s_waitcnt lgkmcnt(0)
    v_pk_add_f32 v[52:53], v[52:53], v[76:77]
    v_pk_add_f32 v[62:63], v[62:63], v[70:71]
    v_pk_add_f32 v[54:55], v[54:55], v[78:79]
    v_pk_add_f32 v[48:49], v[48:49], v[56:57]
    v_pk_add_f32 v[50:51], v[50:51], v[58:59]
    v_pk_add_f32 v[52:53], v[52:53], v[60:61]
    v_pk_add_f32 v[54:55], v[54:55], v[62:63]
    v_pk_mul_f32 v[56:57], v[48:49], v[48:49]
    v_pk_mul_f32 v[58:59], v[50:51], v[50:51]
    v_pk_mul_f32 v[60:61], v[52:53], v[52:53]
    v_pk_mul_f32 v[62:63], v[54:55], v[54:55]
    v_fma_f32 v56, v56, s90, v211
    v_fma_f32 v57, v57, s90, v211
    v_fma_f32 v58, v58, s90, v211
    v_fma_f32 v59, v59, s90, v211
    v_fma_f32 v60, v60, s90, v211
    v_fma_f32 v61, v61, s90, v211
    v_fma_f32 v62, v62, s90, v211
    v_fma_f32 v63, v63, s90, v211
    v_pk_mul_f32 v[56:57], v[56:57], v[48:49]
    v_pk_mul_f32 v[58:59], v[58:59], v[50:51]
    v_pk_mul_f32 v[60:61], v[60:61], v[52:53]
    v_pk_mul_f32 v[62:63], v[62:63], v[54:55]
    v_exp_f32 v56, v56
    v_exp_f32 v57, v57
    v_exp_f32 v58, v58
    v_exp_f32 v59, v59
    v_exp_f32 v60, v60
    v_exp_f32 v61, v61
    v_exp_f32 v62, v62
    v_exp_f32 v63, v63
    v_add_f32 v56, 1.0, v56
    v_add_f32 v57, 1.0, v57
    v_add_f32 v58, 1.0, v58
    v_add_f32 v59, 1.0, v59
    v_add_f32 v60, 1.0, v60
    v_add_f32 v61, 1.0, v61
    v_add_f32 v62, 1.0, v62
    v_add_f32 v63, 1.0, v63
    v_rcp_f32 v56, v56
    v_rcp_f32 v57, v57
    v_rcp_f32 v58, v58
    v_rcp_f32 v59, v59
    v_rcp_f32 v60, v60
    v_rcp_f32 v61, v61
    v_rcp_f32 v62, v62
    v_rcp_f32 v63, v63
    v_mul_f32 v56, v56, v48
    v_mul_f32 v57, v57, v49
    v_mul_f32 v58, v58, v50
    v_mul_f32 v59, v59, v51
    v_mul_f32 v60, v60, v52
    v_mul_f32 v61, v61, v53
    v_mul_f32 v62, v62, v54
    v_mul_f32 v63, v63, v55
    v_cvt_pk_bf16_f32 v64, v56, v57
    v_cvt_pk_bf16_f32 v65, v58, v59
    v_cvt_pk_bf16_f32 v66, v60, v61
    v_cvt_pk_bf16_f32 v67, v62, v63
    s_add_u32 s57, s57, 114688
    buffer_store_dwordx4 v[64:67], v5, s[40:43], s57 offen sc1
    s_add_u32 s82, s82, 4096
    s_add_u32 s85, s85, 4096
    buffer_load_dwordx4 v[116:119], v4, s[40:43], s56 offen offset:1024 sc1
    s_waitcnt vmcnt(10)
    v_mfma_f32_32x32x16_bf16 v[16:31], a[128:131], v[80:83], v[16:31]
    v_mfma_f32_32x32x16_bf16 v[32:47], a[132:135], v[80:83], 0
    s_add_u32 m0, s70, 16384
    s_mul_i32 s73, s53, 64
    s_add_u32 s73, s73, 0
    buffer_load_dwordx4 v214, s[24:27], s73 offen lds
    s_add_u32 m0, s70, 17408
    s_mul_i32 s73, s53, 64
    s_add_u32 s73, s73, 32768
    buffer_load_dwordx4 v214, s[24:27], s73 offen lds
    buffer_load_dwordx4 v[120:123], v4, s[40:43], s56 offen offset:2048 sc1
    s_waitcnt vmcnt(12)
    v_mfma_f32_32x32x16_bf16 v[16:31], a[136:139], v[84:87], v[16:31]
    v_mfma_f32_32x32x16_bf16 v[32:47], a[140:143], v[84:87], v[32:47]
    s_add_u32 m0, s70, 18432
    s_mul_i32 s73, s53, 64
    s_add_u32 s73, s73, 65536
    buffer_load_dwordx4 v214, s[24:27], s73 offen lds
    s_add_u32 m0, s70, 19456
    s_mul_i32 s73, s53, 64
    s_add_u32 s73, s73, 98304
    buffer_load_dwordx4 v214, s[24:27], s73 offen lds
    buffer_load_dwordx4 v[124:127], v4, s[40:43], s56 offen offset:3072 sc1
    s_waitcnt vmcnt(14)
    v_mfma_f32_32x32x16_bf16 v[16:31], a[144:147], v[88:91], v[16:31]
    v_mfma_f32_32x32x16_bf16 v[32:47], a[148:151], v[88:91], v[32:47]
    s_add_u32 m0, s70, 20480
    s_mul_i32 s73, s53, 64
    s_add_u32 s73, s73, 131072
    buffer_load_dwordx4 v214, s[24:27], s73 offen lds
    s_add_u32 m0, s70, 21504
    s_mul_i32 s73, s53, 64
    s_add_u32 s73, s73, 163840
    buffer_load_dwordx4 v214, s[24:27], s73 offen lds
    s_add_u32 s56, s58, s51
    buffer_load_dwordx4 v[128:131], v4, s[40:43], s56 offen offset:0 sc1
    s_waitcnt vmcnt(16)
    v_mfma_f32_32x32x16_bf16 v[16:31], a[152:155], v[92:95], v[16:31]
    v_mfma_f32_32x32x16_bf16 v[32:47], a[156:159], v[92:95], v[32:47]
    s_add_u32 m0, s70, 22528
    s_mul_i32 s73, s53, 64
    s_add_u32 s73, s73, 196608
    buffer_load_dwordx4 v214, s[24:27], s73 offen lds
    s_add_u32 m0, s70, 23552
    s_mul_i32 s73, s53, 64
    s_add_u32 s73, s73, 229376
    buffer_load_dwordx4 v214, s[24:27], s73 offen lds
    buffer_load_dwordx4 v[132:135], v4, s[40:43], s56 offen offset:1024 sc1
    s_waitcnt vmcnt(18)
    v_mfma_f32_32x32x16_bf16 v[16:31], a[160:163], v[96:99], v[16:31]
    v_mfma_f32_32x32x16_bf16 v[32:47], a[164:167], v[96:99], v[32:47]
    s_add_u32 m0, s70, 24576
    s_mul_i32 s73, s54, 64
    s_add_u32 s73, s73, 0
    buffer_load_dwordx4 v214, s[24:27], s73 offen lds
    s_add_u32 m0, s70, 25600
    s_mul_i32 s73, s54, 64
    s_add_u32 s73, s73, 32768
    buffer_load_dwordx4 v214, s[24:27], s73 offen lds
    s_waitcnt vmcnt(15)
    v_mov_b32 v8, s4
    s_mov_b64 exec, 1
    buffer_store_dword v8, v9, s[40:43], s82 offen sc1
    s_mov_b64 exec, -1
    buffer_load_dwordx4 v[136:139], v4, s[40:43], s56 offen offset:2048 sc1
    v_mfma_f32_32x32x16_bf16 v[16:31], a[168:171], v[100:103], v[16:31]
    v_mfma_f32_32x32x16_bf16 v[32:47], a[172:175], v[100:103], v[32:47]
    s_add_u32 m0, s70, 26624
    s_mul_i32 s73, s54, 64
    s_add_u32 s73, s73, 65536
    buffer_load_dwordx4 v214, s[24:27], s73 offen lds
    s_add_u32 m0, s70, 27648
    s_mul_i32 s73, s54, 64
    s_add_u32 s73, s73, 98304
    buffer_load_dwordx4 v214, s[24:27], s73 offen lds
    buffer_load_dwordx4 v[140:143], v4, s[40:43], s56 offen offset:3072 sc1
    v_mfma_f32_32x32x16_bf16 v[16:31], a[176:179], v[104:107], v[16:31]
    v_mfma_f32_32x32x16_bf16 v[32:47], a[180:183], v[104:107], v[32:47]
    s_add_u32 m0, s70, 28672
    s_mul_i32 s73, s54, 64
    s_add_u32 s73, s73, 131072
    buffer_load_dwordx4 v214, s[24:27], s73 offen lds
    s_add_u32 m0, s70, 29696
    s_mul_i32 s73, s54, 64
    s_add_u32 s73, s73, 163840
    buffer_load_dwordx4 v214, s[24:27], s73 offen lds
    s_and_b32 s60, s3, 1
    s_cmp_eq_u32 s60, 1
    s_cselect_b32 s60, 1.0, 0
    v_lshlrev_b32 v48, 16, v224
    v_and_b32 v49, s91, v224
    v_lshlrev_b32 v208, 16, v240
    v_and_b32_e64 v209, s91, v240
    v_add_f32 v48, v48, v208
    s_add_u32 s56, s58, s52
    buffer_load_dwordx4 v[144:147], v4, s[40:43], s56 offen offset:0 sc1
    v_mfma_f32_32x32x16_bf16 v[16:31], a[184:187], v[108:111], v[16:31]
    v_mfma_f32_32x32x16_bf16 v[32:47], a[188:191], v[108:111], v[32:47]
    s_add_u32 m0, s70, 30720
    s_mul_i32 s73, s54, 64
    s_add_u32 s73, s73, 196608
    buffer_load_dwordx4 v214, s[24:27], s73 offen lds
    s_add_u32 m0, s70, 31744
    s_mul_i32 s73, s54, 64
    s_add_u32 s73, s73, 229376
    buffer_load_dwordx4 v214, s[24:27], s73 offen lds
    v_add_f32 v49, v49, v209
    v_mul_f32 v48, s60, v48
    v_mul_f32 v49, s60, v49
    v_lshlrev_b32 v50, 16, v225
    v_and_b32_e64 v51, s91, v225
    v_lshlrev_b32 v210, 16, v241
    buffer_load_dwordx4 v[148:151], v4, s[40:43], s56 offen offset:1024 sc1
    v_mfma_f32_32x32x16_bf16 v[16:31], a[192:195], v[112:115], v[16:31]
    v_mfma_f32_32x32x16_bf16 v[32:47], a[196:199], v[112:115], v[32:47]
    s_waitcnt vmcnt(23)
    ds_read_b64_tr_b16 a[32:33], v217 offset:16384
    ds_read_b64_tr_b16 a[34:35], v217 offset:17408
    ds_read_b64_tr_b16 a[36:37], v218 offset:16384
    ds_read_b64_tr_b16 a[38:39], v218 offset:17408
    v_and_b32 v211, s91, v241
    v_add_f32 v50, v50, v210
    v_add_f32 v51, v51, v211
    v_mul_f32 v50, s60, v50
    v_mul_f32_e64 v51, s60, v51
    v_lshlrev_b32 v52, 16, v226
    buffer_load_dwordx4 v[152:155], v4, s[40:43], s56 offen offset:2048 sc1
    v_mfma_f32_32x32x16_bf16 v[16:31], a[200:203], v[116:119], v[16:31]
    v_mfma_f32_32x32x16_bf16 v[32:47], a[204:207], v[116:119], v[32:47]
    s_waitcnt vmcnt(21)
    ds_read_b64_tr_b16 a[40:41], v217 offset:18432
    ds_read_b64_tr_b16 a[42:43], v217 offset:19456
    ds_read_b64_tr_b16 a[44:45], v218 offset:18432
    ds_read_b64_tr_b16 a[46:47], v218 offset:19456
    v_and_b32 v53, s91, v226
    v_lshlrev_b32 v208, 16, v242
    v_and_b32 v209, s91, v242
    v_add_f32 v52, v52, v208
    v_add_f32_e64 v53, v53, v209
    v_mul_f32 v52, s60, v52
    buffer_load_dwordx4 v[156:159], v4, s[40:43], s56 offen offset:3072 sc1
    v_mfma_f32_32x32x16_bf16 v[16:31], a[208:211], v[120:123], v[16:31]
    v_mfma_f32_32x32x16_bf16 v[32:47], a[212:215], v[120:123], v[32:47]
    s_waitcnt vmcnt(19)
    ds_read_b64_tr_b16 a[48:49], v217 offset:20480
    ds_read_b64_tr_b16 a[50:51], v217 offset:21504
    ds_read_b64_tr_b16 a[52:53], v218 offset:20480
    ds_read_b64_tr_b16 a[54:55], v218 offset:21504
    v_mul_f32 v53, s60, v53
    v_lshlrev_b32 v54, 16, v227
    v_and_b32 v55, s91, v227
    v_lshlrev_b32 v210, 16, v243
    v_and_b32 v211, s91, v243
    v_add_f32 v54, v54, v210
    s_add_u32 s56, s58, s53
    buffer_load_dwordx4 v[160:163], v4, s[40:43], s56 offen offset:0 sc1
    v_mfma_f32_32x32x16_bf16 v[16:31], a[216:219], v[124:127], v[16:31]
    v_mfma_f32_32x32x16_bf16 v[32:47], a[220:223], v[124:127], v[32:47]
    s_waitcnt vmcnt(17)
    ds_read_b64_tr_b16 a[56:57], v217 offset:22528
    ds_read_b64_tr_b16 a[58:59], v217 offset:23552
    ds_read_b64_tr_b16 a[60:61], v218 offset:22528
    ds_read_b64_tr_b16 a[62:63], v218 offset:23552
    v_add_f32 v55, v55, v211
    v_mul_f32 v54, s60, v54
    v_mul_f32 v55, s60, v55
    v_lshlrev_b32 v56, 16, v228
    v_and_b32_e64 v57, s91, v228
    v_lshlrev_b32 v208, 16, v244
    buffer_load_dwordx4 v[164:167], v4, s[40:43], s56 offen offset:1024 sc1
    v_mfma_f32_32x32x16_bf16 v[16:31], a[224:227], v[128:131], v[16:31]
    v_mfma_f32_32x32x16_bf16 v[32:47], a[228:231], v[128:131], v[32:47]
    s_waitcnt vmcnt(15)
    ds_read_b64_tr_b16 a[64:65], v217 offset:24576
    ds_read_b64_tr_b16 a[66:67], v217 offset:25600
    ds_read_b64_tr_b16 a[68:69], v218 offset:24576
    ds_read_b64_tr_b16 a[70:71], v218 offset:25600
    v_and_b32 v209, s91, v244
    v_add_f32 v56, v56, v208
    v_add_f32 v57, v57, v209
    v_mul_f32 v56, s60, v56
    v_mul_f32 v57, s60, v57
    v_lshlrev_b32 v58, 16, v229
    buffer_load_dword v248, v12, s[40:43], s85 offen offset:0 sc1
    buffer_load_dwordx4 v[168:171], v4, s[40:43], s56 offen offset:2048 sc1
    v_mfma_f32_32x32x16_bf16 v[16:31], a[232:235], v[132:135], v[16:31]
    v_mfma_f32_32x32x16_bf16 v[32:47], a[236:239], v[132:135], v[32:47]
    s_waitcnt vmcnt(13)
    ds_read_b64_tr_b16 a[72:73], v217 offset:26624
    ds_read_b64_tr_b16 a[74:75], v217 offset:27648
    ds_read_b64_tr_b16 a[76:77], v218 offset:26624
    ds_read_b64_tr_b16 a[78:79], v218 offset:27648
    v_and_b32 v59, s91, v229
    v_lshlrev_b32 v210, 16, v245
    v_and_b32 v211, s91, v245
    v_add_f32 v58, v58, v210
    v_add_f32 v59, v59, v211
    v_mul_f32 v58, s60, v58
    buffer_load_dwordx4 v[172:175], v4, s[40:43], s56 offen offset:3072 sc1
    v_mfma_f32_32x32x16_bf16 v[16:31], a[240:243], v[136:139], v[16:31]
    v_mfma_f32_32x32x16_bf16 v[32:47], a[244:247], v[136:139], v[32:47]
    s_waitcnt vmcnt(11)
    ds_read_b64_tr_b16 a[80:81], v217 offset:28672
    ds_read_b64_tr_b16 a[82:83], v217 offset:29696
    ds_read_b64_tr_b16 a[84:85], v218 offset:28672
    ds_read_b64_tr_b16 a[86:87], v218 offset:29696
    v_mul_f32 v59, s60, v59
    v_lshlrev_b32 v60, 16, v230
    v_and_b32 v61, s91, v230
    v_lshlrev_b32 v208, 16, v246
    v_and_b32 v209, s91, v246
    v_add_f32 v60, v60, v208
    s_add_u32 s56, s58, s54
    buffer_load_dwordx4 v[176:179], v4, s[40:43], s56 offen offset:0 sc1
    v_mfma_f32_32x32x16_bf16 v[16:31], a[248:251], v[140:143], v[16:31]
    v_mfma_f32_32x32x16_bf16 v[32:47], a[252:255], v[140:143], v[32:47]
    s_waitcnt vmcnt(9)
    ds_read_b64_tr_b16 a[88:89], v217 offset:30720
    ds_read_b64_tr_b16 a[90:91], v217 offset:31744
    ds_read_b64_tr_b16 a[92:93], v218 offset:30720
    ds_read_b64_tr_b16 a[94:95], v218 offset:31744
    v_add_f32 v61, v61, v209
    v_mul_f32 v60, s60, v60
    v_mul_f32 v61, s60, v61
    v_lshlrev_b32 v62, 16, v231
    v_and_b32 v63, s91, v231
    v_lshlrev_b32 v210, 16, v247
    buffer_load_dwordx4 v[180:183], v4, s[40:43], s56 offen offset:1024 sc1
    v_mfma_f32_32x32x16_bf16 v[16:31], a[0:3], v[144:147], v[16:31]
    v_mfma_f32_32x32x16_bf16 v[32:47], a[4:7], v[144:147], v[32:47]
    v_and_b32 v211, s91, v247
    v_add_f32 v62, v62, v210
    v_add_f32 v63, v63, v211
    v_mul_f32 v62, s60, v62
    v_mul_f32 v63, s60, v63
    s_waitcnt vmcnt(4)
    v_cmp_ne_u32 vcc, s4, v248
    s_nop 1
    s_cbranch_vccz Lpcd_P_13
    s_nop 1
Lpc_P_12:
    s_sub_u32 s6, s6, 1
    s_cbranch_scc1 L_end_P
    buffer_load_dword v248, v12, s[40:43], s85 offen offset:0 sc1
    s_waitcnt vmcnt(0)
    v_cmp_ne_u32 vcc, s4, v248
    s_nop 1
    s_cbranch_vccnz Lpc_P_12
Lpcd_P_13:
    buffer_load_dwordx4 v[184:187], v4, s[40:43], s56 offen offset:2048 sc1
    v_mfma_f32_32x32x16_bf16 v[16:31], a[8:11], v[148:151], v[16:31]
    v_mfma_f32_32x32x16_bf16 v[32:47], a[12:15], v[148:151], v[32:47]
    buffer_load_dwordx4 v[188:191], v4, s[40:43], s56 offen offset:3072 sc1
    v_mfma_f32_32x32x16_bf16 v[16:31], a[16:19], v[152:155], v[16:31]
    v_mfma_f32_32x32x16_bf16 v[32:47], a[20:23], v[152:155], v[32:47]
    s_add_u32 s56, s59, s48
    buffer_load_dwordx4 v[192:195], v4, s[40:43], s56 offen offset:0 sc1
    v_mfma_f32_32x32x16_bf16 v[16:31], a[24:27], v[156:159], v[16:31]
    v_mfma_f32_32x32x16_bf16 v[32:47], a[28:31], v[156:159], v[32:47]
    buffer_load_dwordx4 v[196:199], v4, s[40:43], s56 offen offset:1024 sc1
    s_waitcnt lgkmcnt(15)
    v_mfma_f32_32x32x16_bf16 v[16:31], a[32:35], v[160:163], v[16:31]
    v_mfma_f32_32x32x16_bf16 v[32:47], a[36:39], v[160:163], v[32:47]
    buffer_load_dwordx4 v[200:203], v4, s[40:43], s56 offen offset:2048 sc1
    v_mfma_f32_32x32x16_bf16 v[16:31], a[40:43], v[164:167], v[16:31]
    v_mfma_f32_32x32x16_bf16 v[32:47], a[44:47], v[164:167], v[32:47]
    buffer_load_dwordx4 v[204:207], v4, s[40:43], s56 offen offset:3072 sc1
    s_waitcnt vmcnt(9)
    v_mfma_f32_32x32x16_bf16 v[16:31], a[48:51], v[168:171], v[16:31]
    v_mfma_f32_32x32x16_bf16 v[32:47], a[52:55], v[168:171], v[32:47]
    s_add_u32 s56, s59, s49
    buffer_load_dwordx4 v[80:83], v4, s[40:43], s56 offen offset:0 sc1
    s_waitcnt vmcnt(9)
    v_mfma_f32_32x32x16_bf16 v[16:31], a[56:59], v[172:175], v[16:31]
    v_mfma_f32_32x32x16_bf16 v[32:47], a[60:63], v[172:175], v[32:47]
    buffer_load_dwordx4 v[84:87], v4, s[40:43], s56 offen offset:1024 sc1
    s_waitcnt vmcnt(9) lgkmcnt(14)
    v_mfma_f32_32x32x16_bf16 v[16:31], a[64:67], v[176:179], v[16:31]
    s_waitcnt lgkmcnt(12)
    v_mfma_f32_32x32x16_bf16 v[32:47], a[68:71], v[176:179], v[32:47]
    buffer_load_dwordx4 v[88:91], v4, s[40:43], s56 offen offset:2048 sc1
    s_waitcnt vmcnt(9) lgkmcnt(10)
    v_mfma_f32_32x32x16_bf16 v[16:31], a[72:75], v[180:183], v[16:31]
    s_waitcnt lgkmcnt(8)
    v_mfma_f32_32x32x16_bf16 v[32:47], a[76:79], v[180:183], v[32:47]
    buffer_load_dwordx4 v[92:95], v4, s[40:43], s56 offen offset:3072 sc1
    s_waitcnt vmcnt(9) lgkmcnt(6)
    v_mfma_f32_32x32x16_bf16 v[16:31], a[80:83], v[184:187], v[16:31]
    s_waitcnt lgkmcnt(4)
    v_mfma_f32_32x32x16_bf16 v[32:47], a[84:87], v[184:187], v[32:47]
    s_add_u32 s56, s59, s50
    buffer_load_dwordx4 v[96:99], v4, s[40:43], s56 offen offset:0 sc1
    s_waitcnt vmcnt(9) lgkmcnt(2)
    v_mfma_f32_32x32x16_bf16 v[16:31], a[88:91], v[188:191], v[16:31]
    s_waitcnt lgkmcnt(0)
    v_mfma_f32_32x32x16_bf16 v[32:47], a[92:95], v[188:191], v[32:47]
    buffer_load_dwordx4 v[100:103], v4, s[40:43], s56 offen offset:1024 sc1
    s_waitcnt vmcnt(9)
    v_mfma_f32_32x32x16_bf16 v[48:63], a[128:131], v[192:195], v[48:63]
    v_mfma_f32_32x32x16_bf16 v[64:79], a[132:135], v[192:195], 0
    s_nop 7
    ds_write_b32 v237, v32 offset:0
    ds_write_b32 v237, v34 offset:256
    ds_write_b32 v237, v33 offset:128
    ds_write_b32 v237, v35 offset:384
    ds_write_b32 v237, v36 offset:1024
    ds_write_b32 v237, v38 offset:1280
    buffer_load_dwordx4 v[104:107], v4, s[40:43], s56 offen offset:2048 sc1
    s_waitcnt vmcnt(9)
    v_mfma_f32_32x32x16_bf16 v[48:63], a[136:139], v[196:199], v[48:63]
    v_mfma_f32_32x32x16_bf16 v[64:79], a[140:143], v[196:199], v[64:79]
    ds_write_b32 v237, v37 offset:1152
    ds_write_b32 v237, v39 offset:1408
    ds_write_b32 v237, v40 offset:2048
    ds_write_b32 v237, v42 offset:2304
    ds_write_b32 v237, v41 offset:2176
    ds_write_b32 v237, v43 offset:2432
    buffer_load_dwordx4 v[108:111], v4, s[40:43], s56 offen offset:3072 sc1
    s_waitcnt vmcnt(9)
    v_mfma_f32_32x32x16_bf16 v[48:63], a[144:147], v[200:203], v[48:63]
    v_mfma_f32_32x32x16_bf16 v[64:79], a[148:151], v[200:203], v[64:79]
    ds_write_b32 v237, v44 offset:3072
    ds_write_b32 v237, v46 offset:3328
    ds_write_b32 v237, v45 offset:3200
    ds_write_b32 v237, v47 offset:3456
    ds_write_b32 v236, v16 offset:0
    ds_write_b32 v236, v18 offset:256
    s_add_u32 s56, s59, s51
    buffer_load_dwordx4 v[112:115], v4, s[40:43], s56 offen offset:0 sc1
    s_waitcnt vmcnt(9)
    v_mfma_f32_32x32x16_bf16 v[48:63], a[152:155], v[204:207], v[48:63]
    v_mfma_f32_32x32x16_bf16 v[64:79], a[156:159], v[204:207], v[64:79]
    ds_write_b32 v236, v17 offset:128
    ds_write_b32 v236, v19 offset:384
    ds_write_b32 v236, v20 offset:1024
    ds_write_b32 v236, v22 offset:1280
    ds_write_b32 v236, v21 offset:1152
    ds_write_b32 v236, v23 offset:1408
    buffer_load_dwordx4 v[116:119], v4, s[40:43], s56 offen offset:1024 sc1
    s_waitcnt vmcnt(9)
    v_mfma_f32_32x32x16_bf16 v[48:63], a[160:163], v[80:83], v[48:63]
    v_mfma_f32_32x32x16_bf16 v[64:79], a[164:167], v[80:83], v[64:79]
    ds_write_b32 v236, v24 offset:2048
    ds_write_b32 v236, v26 offset:2304
    ds_write_b32 v236, v25 offset:2176
    ds_write_b32 v236, v27 offset:2432
    ds_write_b32 v236, v28 offset:3072
    ds_write_b32 v236, v30 offset:3328
    buffer_load_dwordx4 v[120:123], v4, s[40:43], s56 offen offset:2048 sc1
    s_waitcnt vmcnt(9)
    v_mfma_f32_32x32x16_bf16 v[48:63], a[168:171], v[84:87], v[48:63]
    v_mfma_f32_32x32x16_bf16 v[64:79], a[172:175], v[84:87], v[64:79]
    ds_write_b32 v236, v29 offset:3200
    ds_write_b32 v236, v31 offset:3456
    buffer_load_dwordx4 v[124:127], v4, s[40:43], s56 offen offset:3072 sc1
    s_waitcnt vmcnt(9)
    v_mfma_f32_32x32x16_bf16 v[48:63], a[176:179], v[88:91], v[48:63]
    v_mfma_f32_32x32x16_bf16 v[64:79], a[180:183], v[88:91], v[64:79]
    s_add_u32 s56, s59, s52
    buffer_load_dwordx4 v[128:131], v4, s[40:43], s56 offen offset:0 sc1
    s_waitcnt vmcnt(9)
    v_mfma_f32_32x32x16_bf16 v[48:63], a[184:187], v[92:95], v[48:63]
    v_mfma_f32_32x32x16_bf16 v[64:79], a[188:191], v[92:95], v[64:79]
    s_waitcnt lgkmcnt(0)
    s_barrier
    ds_read_b128 v[16:19], v238 offset:0
    ds_read_b128 v[20:23], v238 offset:36864
    ds_read_b128 v[24:27], v239 offset:0
    ds_read_b128 v[28:31], v239 offset:36864
    ds_read_b128 v[32:35], v238 offset:1024
    ds_read_b128 v[36:39], v238 offset:37888
    ds_read_b128 v[40:43], v239 offset:1024
    ds_read_b128 v[44:47], v239 offset:37888
    buffer_load_dwordx4 v[132:135], v4, s[40:43], s56 offen offset:1024 sc1
    s_waitcnt vmcnt(9)
    v_mfma_f32_32x32x16_bf16 v[48:63], a[192:195], v[96:99], v[48:63]
    v_mfma_f32_32x32x16_bf16 v[64:79], a[196:199], v[96:99], v[64:79]
    buffer_load_dwordx4 v[136:139], v4, s[40:43], s56 offen offset:2048 sc1
    s_waitcnt vmcnt(9)
    v_mfma_f32_32x32x16_bf16 v[48:63], a[200:203], v[100:103], v[48:63]
    v_mfma_f32_32x32x16_bf16 v[64:79], a[204:207], v[100:103], v[64:79]
    s_waitcnt lgkmcnt(6)
    v_add_f32 v16, v16, v20
    s_waitcnt lgkmcnt(4)
    v_add_f32 v24, v24, v28
    v_add_f32 v17, v17, v21
    v_add_f32 v25, v25, v29
    v_add_f32 v18, v18, v22
    v_add_f32 v26, v26, v30
    buffer_load_dwordx4 v[140:143], v4, s[40:43], s56 offen offset:3072 sc1
    s_waitcnt vmcnt(9)
    v_mfma_f32_32x32x16_bf16 v[48:63], a[208:211], v[104:107], v[48:63]
    v_mfma_f32_32x32x16_bf16 v[64:79], a[212:215], v[104:107], v[64:79]
    v_add_f32 v19, v19, v23
    v_add_f32 v27, v27, v31
    v_add_f32 v16, v16, v24
    v_add_f32 v17, v17, v25
    v_add_f32 v18, v18, v26
    v_add_f32 v19, v19, v27
    s_add_u32 s56, s59, s53
    buffer_load_dwordx4 v[144:147], v4, s[40:43], s56 offen offset:0 sc1
    s_waitcnt vmcnt(9)
    v_mfma_f32_32x32x16_bf16 v[48:63], a[216:219], v[108:111], v[48:63]
    v_mfma_f32_32x32x16_bf16 v[64:79], a[220:223], v[108:111], v[64:79]
    v_cvt_pk_bf16_f32 v20, v16, v17
    v_cvt_pk_bf16_f32 v21, v18, v19
    buffer_store_dwordx2 v[20:21], v212, s[36:39], s68 offen offset:0
    s_waitcnt lgkmcnt(2)
    v_add_f32 v32, v32, v36
    s_waitcnt lgkmcnt(0)
    v_add_f32 v40, v40, v44
    v_add_f32 v33, v33, v37
    buffer_load_dwordx4 v[148:151], v4, s[40:43], s56 offen offset:1024 sc1
    s_waitcnt vmcnt(10)
    v_mfma_f32_32x32x16_bf16 v[48:63], a[224:227], v[112:115], v[48:63]
    v_mfma_f32_32x32x16_bf16 v[64:79], a[228:231], v[112:115], v[64:79]
    v_add_f32 v41, v41, v45
    v_add_f32 v34, v34, v38
    v_add_f32 v42, v42, v46
    v_add_f32 v35, v35, v39
    v_add_f32_e64 v43, v43, v47
    v_add_f32 v32, v32, v40
    buffer_load_dwordx4 v[152:155], v4, s[40:43], s56 offen offset:2048 sc1
    s_waitcnt vmcnt(10)
    v_mfma_f32_32x32x16_bf16 v[48:63], a[232:235], v[116:119], v[48:63]
    v_mfma_f32_32x32x16_bf16 v[64:79], a[236:239], v[116:119], v[64:79]
    v_add_f32 v33, v33, v41
    v_add_f32 v34, v34, v42
    v_add_f32 v35, v35, v43
    v_cvt_pk_bf16_f32 v36, v32, v33
    v_cvt_pk_bf16_f32 v37, v34, v35
    buffer_store_dwordx2 v[36:37], v212, s[36:39], s69 offen offset:0
    buffer_load_dwordx4 v[156:159], v4, s[40:43], s56 offen offset:3072 sc1
    s_waitcnt vmcnt(11)
    v_mfma_f32_32x32x16_bf16 v[48:63], a[240:243], v[120:123], v[48:63]
    v_mfma_f32_32x32x16_bf16 v[64:79], a[244:247], v[120:123], v[64:79]
    s_add_u32 s56, s59, s54
    buffer_load_dwordx4 v[160:163], v4, s[40:43], s56 offen offset:0 sc1
    s_waitcnt vmcnt(11)
    v_mfma_f32_32x32x16_bf16 v[48:63], a[248:251], v[124:127], v[48:63]
    v_mfma_f32_32x32x16_bf16 v[64:79], a[252:255], v[124:127], v[64:79]
    buffer_load_dwordx4 v[164:167], v4, s[40:43], s56 offen offset:1024 sc1
    s_waitcnt vmcnt(11)
    v_mfma_f32_32x32x16_bf16 v[48:63], a[0:3], v[128:131], v[48:63]
    v_mfma_f32_32x32x16_bf16 v[64:79], a[4:7], v[128:131], v[64:79]
    buffer_load_dwordx4 v[168:171], v4, s[40:43], s56 offen offset:2048 sc1
    s_waitcnt vmcnt(11)
    v_mfma_f32_32x32x16_bf16 v[48:63], a[8:11], v[132:135], v[48:63]
    v_mfma_f32_32x32x16_bf16 v[64:79], a[12:15], v[132:135], v[64:79]
    buffer_load_dwordx4 v[172:175], v4, s[40:43], s56 offen offset:3072 sc1
    s_waitcnt vmcnt(11)
    v_mfma_f32_32x32x16_bf16 v[48:63], a[16:19], v[136:139], v[48:63]
    v_mfma_f32_32x32x16_bf16 v[64:79], a[20:23], v[136:139], v[64:79]
    s_waitcnt vmcnt(10)
    v_mfma_f32_32x32x16_bf16 v[48:63], a[24:27], v[140:143], v[48:63]
    v_mfma_f32_32x32x16_bf16 v[64:79], a[28:31], v[140:143], v[64:79]
    s_waitcnt vmcnt(9)
    v_mfma_f32_32x32x16_bf16 v[48:63], a[32:35], v[144:147], v[48:63]
    v_mfma_f32_32x32x16_bf16 v[64:79], a[36:39], v[144:147], v[64:79]
    s_waitcnt vmcnt(7)
    v_mfma_f32_32x32x16_bf16 v[48:63], a[40:43], v[148:151], v[48:63]
    v_mfma_f32_32x32x16_bf16 v[64:79], a[44:47], v[148:151], v[64:79]
    s_waitcnt vmcnt(6)
    v_mfma_f32_32x32x16_bf16 v[48:63], a[48:51], v[152:155], v[48:63]
    v_mfma_f32_32x32x16_bf16 v[64:79], a[52:55], v[152:155], v[64:79]
    s_waitcnt vmcnt(4)
    v_mfma_f32_32x32x16_bf16 v[48:63], a[56:59], v[156:159], v[48:63]
    v_mfma_f32_32x32x16_bf16 v[64:79], a[60:63], v[156:159], v[64:79]
    s_waitcnt vmcnt(3)
    v_mfma_f32_32x32x16_bf16 v[64:79], a[68:71], v[160:163], v[64:79]
    s_waitcnt vmcnt(2)
    v_mfma_f32_32x32x16_bf16 v[64:79], a[76:79], v[164:167], v[64:79]
    s_waitcnt vmcnt(1)
    v_mfma_f32_32x32x16_bf16 v[64:79], a[84:87], v[168:171], v[64:79]
    s_waitcnt vmcnt(0)
    v_mfma_f32_32x32x16_bf16 v[64:79], a[92:95], v[172:175], v[64:79]
    v_mfma_f32_32x32x16_bf16 v[48:63], a[64:67], v[160:163], v[48:63]
    v_mfma_f32_32x32x16_bf16 v[48:63], a[72:75], v[164:167], v[48:63]
    s_nop 9
    ds_write_b32 v237, v64 offset:8192
    ds_write_b32 v237, v66 offset:8448
    ds_write_b32 v237, v65 offset:8320
    ds_write_b32 v237, v67 offset:8576
    ds_write_b32 v237, v68 offset:9216
    ds_write_b32 v237, v70 offset:9472
    v_mfma_f32_32x32x16_bf16 v[48:63], a[80:83], v[168:171], v[48:63]
    ds_write_b32 v237, v69 offset:9344
    ds_write_b32 v237, v71 offset:9600
    ds_write_b32 v237, v72 offset:10240
    ds_write_b32 v237, v74 offset:10496
    ds_write_b32 v237, v73 offset:10368
    ds_write_b32 v237, v75 offset:10624
    v_mfma_f32_32x32x16_bf16 v[48:63], a[88:91], v[172:175], v[48:63]
    ds_write_b32 v237, v76 offset:11264
    ds_write_b32 v237, v78 offset:11520
    ds_write_b32 v237, v77 offset:11392
    ds_write_b32 v237, v79 offset:11648
    s_nop 7
    ds_write_b32 v236, v48 offset:8192
    ds_write_b32 v236, v50 offset:8448
    ds_write_b32 v236, v49 offset:8320
    ds_write_b32 v236, v51 offset:8576
    ds_write_b32 v236, v52 offset:9216
    ds_write_b32 v236, v54 offset:9472
    ds_write_b32 v236, v53 offset:9344
    ds_write_b32 v236, v55 offset:9600
    ds_write_b32 v236, v56 offset:10240
    ds_write_b32 v236, v58 offset:10496
    ds_write_b32 v236, v57 offset:10368
    ds_write_b32 v236, v59 offset:10624
    ds_write_b32 v236, v60 offset:11264
    ds_write_b32 v236, v62 offset:11520
    ds_write_b32 v236, v61 offset:11392
    ds_write_b32 v236, v63 offset:11648
    s_waitcnt lgkmcnt(0)
    s_barrier
    ds_read_b128 v[48:51], v238 offset:8192
    ds_read_b128 v[52:55], v238 offset:45056
    ds_read_b128 v[56:59], v239 offset:8192
    ds_read_b128 v[60:63], v239 offset:45056
    ds_read_b128 v[64:67], v238 offset:9216
    ds_read_b128 v[68:71], v238 offset:46080
    ds_read_b128 v[72:75], v239 offset:9216
    ds_read_b128 v[76:79], v239 offset:46080
    s_waitcnt lgkmcnt(6)
    v_pk_add_f32 v[48:49], v[48:49], v[52:53]
    s_waitcnt lgkmcnt(4)
    v_pk_add_f32 v[56:57], v[56:57], v[60:61]
    v_pk_add_f32 v[50:51], v[50:51], v[54:55]
    v_pk_add_f32 v[58:59], v[58:59], v[62:63]
    v_pk_add_f32 v[48:49], v[48:49], v[56:57]
    v_pk_add_f32 v[50:51], v[50:51], v[58:59]
    v_cvt_pk_bf16_f32 v52, v48, v49
    v_cvt_pk_bf16_f32 v53, v50, v51
    buffer_store_dwordx2 v[52:53], v212, s[36:39], s68 offen offset:64
    s_waitcnt lgkmcnt(2)
    v_pk_add_f32 v[64:65], v[64:65], v[68:69]
    s_waitcnt lgkmcnt(0)
    v_pk_add_f32 v[72:73], v[72:73], v[76:77]
    v_pk_add_f32 v[66:67], v[66:67], v[70:71]
    v_pk_add_f32 v[74:75], v[74:75], v[78:79]
    v_pk_add_f32 v[64:65], v[64:65], v[72:73]
    v_pk_add_f32 v[66:67], v[66:67], v[74:75]
    v_cvt_pk_bf16_f32 v68, v64, v65
    v_cvt_pk_bf16_f32 v69, v66, v67
    buffer_store_dwordx2 v[68:69], v212, s[36:39], s69 offen offset:64
L_end_P:
    s_endpgm

.section .rodata,"a"
.p2align 6
.amdhsa_kernel sequential_preLN__sliding_local_dilated__mixer_token_mlp__prompt_kernel
  .amdhsa_next_free_vgpr 508
  .amdhsa_next_free_sgpr 102
  .amdhsa_accum_offset 252
  .amdhsa_group_segment_fixed_size 0
  .amdhsa_kernarg_size 88
  .amdhsa_user_sgpr_count 2
  .amdhsa_user_sgpr_kernarg_segment_ptr 1
  .amdhsa_system_sgpr_workgroup_id_x 1
.end_amdhsa_kernel
```

```asm
; @launch grid=(256,1,1) block=(256,1,1) lds=163840
.amdgcn_target "amdgcn-amd-amdhsa--gfx950"
.text
.globl sequential_preLN__sliding_local_dilated__mixer_token_mlp__prompt_kernel
.p2align 8
.type sequential_preLN__sliding_local_dilated__mixer_token_mlp__prompt_kernel,@function
sequential_preLN__sliding_local_dilated__mixer_token_mlp__prompt_kernel:
    s_cmp_ge_u32 s2, 256
    s_cbranch_scc1 L_end_P
    s_load_dwordx2 s[8:9], s[0:1], 0
    s_load_dwordx2 s[12:13], s[0:1], 8
    s_load_dwordx2 s[44:45], s[0:1], 72
    s_load_dwordx2 s[40:41], s[0:1], 80
    s_load_dwordx2 s[16:17], s[0:1], 16
    s_load_dwordx2 s[20:21], s[0:1], 32
    s_load_dwordx2 s[24:25], s[0:1], 48
    s_load_dwordx2 s[28:29], s[0:1], 40
    s_load_dwordx2 s[32:33], s[0:1], 56
    s_load_dwordx2 s[36:37], s[0:1], 64
    v_lshrrev_b32 v1, 6, v0
    s_nop 0
    v_readfirstlane_b32 s3, v1
    v_and_b32 v1, 63, v0
    v_and_b32 v2, 15, v0
    v_lshrrev_b32 v3, 4, v1
    v_lshlrev_b32 v4, 4, v1
    s_mov_b32 s10, 0x1c0000
    s_mov_b32 s11, 0x00020000
    s_mov_b32 s14, 0x126000
    s_mov_b32 s15, 0x00020000
    s_mov_b32 s46, 0x100
    s_mov_b32 s47, 0x00020000
    s_mov_b32 s42, 0x610000
    s_mov_b32 s43, 0x00020000
    s_mov_b32 s18, 0x62000
    s_mov_b32 s19, 0x00020000
    s_mov_b32 s22, 0x700000
    s_mov_b32 s23, 0x00020000
    s_mov_b32 s26, 0x700000
    s_mov_b32 s27, 0x00020000
    s_mov_b32 s30, 0xe00
    s_mov_b32 s31, 0x00020000
    s_mov_b32 s34, 0x1000
    s_mov_b32 s35, 0x00020000
    s_mov_b32 s38, 0x1c0000
    s_mov_b32 s39, 0x00020000
    s_mov_b32 s5, 0x3f803f80
    s_mov_b32 s6, 0x200000
    s_bfe_u32 s48, s2, 0x20001
    s_lshl_b32 s48, s48, 2
    s_lshr_b32 s53, s2, 6
    s_add_u32 s48, s48, s53
    s_bfe_u32 s49, s2, 0x30003
    s_and_b32 s53, s2, 1
    s_lshl_b32 s53, s53, 3
    s_add_u32 s49, s49, s53
    v_lshrrev_b32_e64 v237, 2, v1
    v_mul_u32_u24 v123, 2688, v237
    v_lshrrev_b32 v237, 5, v1
    v_lshlrev_b32 v237, 1, v237
    v_and_b32 v238, 3, v1
    v_xor_b32 v237, v237, v238
    v_lshl_add_u32 v123, v237, 4, v123
    s_mul_i32 s53, s49, 56
    s_min_u32 s53, s53, 832
    s_mul_i32 s51, s3, 43008
    s_add_u32 s53, s53, s51
    v_add_u32 v123, s53, v123
    s_lshr_b32 s53, s3, 1
    s_mul_i32 s51, s53, 6144
    s_and_b32 s53, s3, 1
    s_lshl_b32 s53, s53, 10
    s_add_u32 s51, s51, s53
    v_lshrrev_b32 v237, 3, v1
    v_mul_u32_u24 v122, 896, v237
    v_and_b32 v237, 7, v1
    v_xor_b32 v237, v237, v3
    v_lshl_add_u32 v120, v237, 4, v122
    s_lshl_b32 s50, s48, 7
    s_lshl_b32 s53, s3, 5
    s_add_u32 s53, s53, s50
    s_mul_i32 s53, s53, 896
    v_xor_b32 v121, 64, v120
    v_add_u32_e64 v120, s53, v120
    s_add_u32 s53, s53, 7168
    v_add_u32 v121, s53, v121
    s_lshl_b32 s53, s3, 1
    v_xor_b32 v237, s53, v237
    v_lshl_add_u32 v122, v237, 4, v122
    s_lshl_b32 s53, s3, 2
    s_add_u32 s53, s53, s50
    s_sub_u32 s53, s53, 16
    s_mul_i32 s53, s53, 896
    s_cmp_eq_u32 s48, 0
    s_cselect_b32 s53, 0x40000000, s53
    v_add_u32 v122, s53, v122
    s_lshl_b32 s52, s3, 12
    s_add_u32 s52, s52, 63488
    s_lshl_b32 s7, s3, 9
    s_cmp_eq_u32 s3, 0
    s_cselect_b32 s54, 0xffffff00, -1
    s_mov_b32 s55, 0
    s_memrealtime s[86:87]
    v_mov_b32 v7, 0
    s_waitcnt lgkmcnt(0)
    s_or_b32 s86, s86, 1
    v_mov_b32 v6, s86
    s_or_b32 s86, s2, s3
    s_cmp_eq_u32 s86, 0
    s_cselect_b64 exec, 1, 0
    buffer_store_dword v6, v7, s[44:47], 0 offen sc1
    s_mov_b64 exec, -1
    s_add_u32 m0, s51, 12288
    s_mov_b32 s73, 0
    buffer_load_dwordx4 v123, s[12:15], s73 offen lds
    s_add_u32 m0, s51, 14336
    s_mov_b32 s73, 896
    buffer_load_dwordx4 v123, s[12:15], s73 offen lds
    s_add_u32 m0, s51, 16384
    s_mov_b32 s73, 1792
    buffer_load_dwordx4 v123, s[12:15], s73 offen lds
    s_add_u32 m0, s52, 36864
    s_mov_b32 s73, 0
    buffer_load_dwordx4 v120, s[8:11], s73 offen lds
    s_add_u32 m0, s52, 37888
    s_mov_b32 s73, 0
    buffer_load_dwordx4 v121, s[8:11], s73 offen lds
    s_add_u32 m0, s52, 38912
    s_mov_b32 s73, 14336
    buffer_load_dwordx4 v120, s[8:11], s73 offen lds
    s_add_u32 m0, s52, 39936
    s_mov_b32 s73, 14336
    buffer_load_dwordx4 v121, s[8:11], s73 offen lds
    s_add_u32 m0, s7, 98304
    s_mov_b32 s73, 0
    s_mov_b64 exec, s[54:55]
    buffer_load_dwordx4 v122, s[8:11], s73 offen lds
    s_mov_b64 exec, -1
    s_bfe_u32 s53, s2, 0x30003
    s_add_u32 s86, s53, 1
    s_lshr_b32 s86, s86, 1
    s_lshr_b32 s87, s2, 6
    s_mul_i32 s87, s87, 5
    s_add_u32 s86, s86, s87
    s_lshl_b32 s86, s86, 2
    s_add_u32 s53, s86, s3
    s_mov_b32 s56, s53
    s_mov_b32 s86, 0x2a54
    s_bitcmp1_b32 s86, s49
    s_cselect_b32 s57, 0x40000000, 0
    s_mul_i32 s86, s53, 58
    v_add_u32_e64 v237, s86, v1
    v_mul_u32_u24 v238, 43691, v237
    v_lshrrev_b32 v238, 19, v238
    v_mul_u32_u24 v239, 12, v238
    v_sub_u32 v239, v237, v239
    v_lshrrev_b32 v239, 2, v239
    v_mul_u32_u24 v239, 896, v239
    v_mul_u32_u24 v238, 2688, v238
    v_and_b32 v237, 3, v237
    v_lshlrev_b32 v237, 7, v237
    v_add3_u32 v237, v237, v238, v239
    v_add_u32 v237, s57, v237
    s_and_b32 s87, s2, 1
    s_mul_i32 s87, s87, 384
    s_add_u32 s87, s87, 172032
    s_mov_b32 exec_lo, 0xffffffff
    s_mov_b32 exec_hi, 0x3ffffff
    buffer_load_dword v232, v237, s[12:15], s87 offen
    s_mov_b64 exec, -1
    v_lshlrev_b32 v237, 7, v1
    v_add_u32 v238, s57, v237
    s_mul_i32 s86, s53, 6016
    s_bfe_u32 s87, s2, 0x20001
    s_mul_i32 s87, s87, 458752
    s_add_u32 s86, s86, s87
    s_max_u32 s86, s86, 14336
    s_sub_u32 s86, s86, 14336
    s_mov_b32 exec_hi, 0x7fff
    buffer_load_dword v233, v238, s[8:11], s86 offen
    s_getpc_b64 s[86:87]
Lpc_P:
    s_mul_i32 s53, s53, 384
    v_add_u32_e64 v237, s53, v237
    v_min_u32 v237, L_end_P-Lpc_P, v237
    s_mov_b64 exec, 7
    global_load_dword v236, v237, s[86:87]
    s_mov_b64 exec, -1
    v_mul_u32_u24 v237, 18432, v3
    v_lshl_add_u32 v237, v2, 3, v237
    v_mov_b32_e64 v238, s5
    v_add_u32 v237, 61440, v237
    ds_write2_b32 v237, v238, v238 offset0:0 offset1:1
    s_lshr_b32 s68, s2, 3
    s_mul_i32 s69, s68, 37
    s_lshr_b32 s69, s69, 8
    s_mul_i32 s64, s69, 7
    s_sub_u32 s64, s68, s64
    s_mov_b32 s66, s64
    s_and_b32 s68, s2, 7
    s_lshl_b32 s67, s68, 2
    s_add_u32 s67, s67, s69
    s_cmp_ge_u32 s69, 4
    s_cselect_b32 s67, 99, s67
    s_mul_i32 s71, s68, 3
    s_add_u32 s71, s71, 4
    s_lshl_b32 s72, s68, 2
    s_cmp_lt_u32 s68, 4
    s_cselect_b32 s65, s72, s71
    s_cselect_b32 s71, 4, 3
    s_add_u32 s65, s65, s69
    s_cmp_ge_u32 s69, s71
    s_cselect_b32 s65, 99, s65
    v_lshrrev_b32_e64 v219, 3, v1
    v_mul_u32_u24 v208, 896, v219
    v_and_b32 v219, 1, v3
    v_lshlrev_b32 v219, 2, v219
    v_and_b32 v220, 7, v1
    v_xor_b32 v219, v219, v220
    v_lshl_add_u32 v208, v219, 4, v208
    s_lshl_b32 s58, s66, 7
    s_mul_i32 s60, s3, 100352
    s_add_u32 s58, s58, s60
    v_add_u32_e64 v208, s58, v208
    s_mul_i32 s59, s3, 36864
    s_add_u32 s59, s59, 12288
    v_lshrrev_b32 v219, 5, v1
    v_lshlrev_b32 v209, 9, v219
    v_bfe_u32 v219, v1, 2, 2
    v_lshl_add_u32 v209, v219, 7, v209
    v_lshrrev_b32 v219, 1, v219
    s_and_b32 s58, s3, 1
    v_xor_b32_e64 v219, s58, v219
    v_lshl_add_u32 v209, v219, 6, v209
    v_and_b32_e64 v219, 1, v3
    v_lshl_add_u32 v209, v219, 5, v209
    v_and_b32_e64 v219, 3, v1
    v_lshl_add_u32 v209, v219, 3, v209
    v_add_u32 v209, 12288, v209
    v_lshrrev_b32 v219, 5, v1
    v_lshlrev_b32 v219, 10, v219
    v_sub_u32_e64 v210, v209, v219
    s_mul_i32 s70, s3, 36864
    s_add_u32 s70, s70, 12288
    v_lshrrev_b32_e64 v219, 3, v1
    v_mul_u32_u24 v213, 3584, v219
    v_and_b32 v219, 1, v3
    v_lshlrev_b32 v219, 2, v219
    v_and_b32 v220, 7, v1
    v_xor_b32 v219, v219, v220
    v_lshl_add_u32 v213, v219, 4, v213
    s_mul_i32 s68, s3, 1835008
    s_lshl_b32 s69, s65, 7
    s_add_u32 s68, s68, s69
    s_cmp_ge_u32 s65, 99
    s_cselect_b32 s68, 0x40000000, s68
    v_add_u32 v213, s68, v213
    s_cselect_b32 s68, 0x40000000, 0
    v_add_u32 v5, s68, v4
    v_lshrrev_b32 v219, 5, v1
    v_lshlrev_b32 v215, 9, v219
    v_bfe_u32 v219, v1, 2, 2
    v_lshl_add_u32 v215, v219, 7, v215
    v_lshrrev_b32 v219, 1, v219
    s_lshr_b32 s68, s3, 1
    v_xor_b32_e64 v219, s68, v219
    v_lshl_add_u32 v215, v219, 6, v215
    v_and_b32_e64 v219, 1, v3
    v_lshl_add_u32 v215, v219, 5, v215
    v_and_b32_e64 v219, 3, v1
    v_lshl_add_u32 v215, v219, 3, v215
    s_and_b32 s68, s3, 1
    s_lshl_b32 s68, s68, 5
    v_xor_b32 v215, s68, v215
    v_add_u32 v215, s70, v215
    v_xor_b32_e64 v216, 64, v215
    s_mul_i32 s70, s3, 36864
    s_add_u32 s70, s70, 12288
    v_lshrrev_b32_e64 v219, 3, v1
    v_mul_u32_u24 v214, 4096, v219
    v_and_b32 v219, 1, v3
    v_lshlrev_b32 v219, 2, v219
    v_and_b32 v220, 7, v1
    v_xor_b32 v219, v219, v220
    v_lshl_add_u32 v214, v219, 4, v214
    s_mul_i32 s68, s3, 1835008
    s_lshl_b32 s69, s67, 7
    s_add_u32 s68, s68, s69
    s_cmp_ge_u32 s67, 99
    s_cselect_b32 s68, 0x40000000, s68
    v_add_u32 v214, s68, v214
    v_lshrrev_b32 v219, 5, v1
    v_lshlrev_b32 v217, 9, v219
    v_bfe_u32 v219, v1, 2, 2
    v_lshl_add_u32 v217, v219, 7, v217
    v_lshrrev_b32 v219, 1, v219
    s_lshr_b32 s68, s3, 1
    v_xor_b32_e64 v219, s68, v219
    v_lshl_add_u32 v217, v219, 6, v217
    v_and_b32_e64 v219, 1, v3
    v_lshl_add_u32 v217, v219, 5, v217
    v_and_b32_e64 v219, 3, v1
    v_lshl_add_u32 v217, v219, 3, v217
    v_add_u32_e64 v217, s70, v217
    v_xor_b32 v218, 64, v217
    s_and_b32 s68, s2, 7
    s_cmp_ge_u32 s68, 8
    s_cselect_b32 s94, 8, 0
    s_sub_u32 s68, s68, s94
    s_lshl_b32 s94, s68, 12
    s_add_u32 s68, s68, 1
    s_cmp_ge_u32 s68, 8
    s_cselect_b32 s95, 8, 0
    s_sub_u32 s68, s68, s95
    s_lshl_b32 s95, s68, 12
    s_add_u32 s68, s68, 1
    s_cmp_ge_u32 s68, 8
    s_cselect_b32 s96, 8, 0
    s_sub_u32 s68, s68, s96
    s_lshl_b32 s96, s68, 12
    s_add_u32 s68, s68, 1
    s_cmp_ge_u32 s68, 8
    s_cselect_b32 s97, 8, 0
    s_sub_u32 s68, s68, s97
    s_lshl_b32 s97, s68, 12
    s_add_u32 s68, s68, 1
    s_cmp_ge_u32 s68, 8
    s_cselect_b32 s98, 8, 0
    s_sub_u32 s68, s68, s98
    s_lshl_b32 s98, s68, 12
    s_add_u32 s68, s68, 1
    s_cmp_ge_u32 s68, 8
    s_cselect_b32 s99, 8, 0
    s_sub_u32 s68, s68, s99
    s_lshl_b32 s99, s68, 12
    s_add_u32 s68, s68, 1
    s_cmp_ge_u32 s68, 8
    s_cselect_b32 s100, 8, 0
    s_sub_u32 s68, s68, s100
    s_lshl_b32 s100, s68, 12
    s_add_u32 s68, s68, 1
    s_cmp_ge_u32 s68, 8
    s_cselect_b32 s101, 8, 0
    s_sub_u32 s68, s68, s101
    s_lshl_b32 s101, s68, 12
    s_lshl_b32 s80, s48, 2
    s_add_u32 s80, s80, s3
    s_lshl_b32 s80, s80, 11
    s_lshr_b32 s93, s49, 2
    s_lshl_b32 s93, s93, 7
    s_add_u32 s80, s80, s93
    s_and_b32 s93, s49, 3
    s_lshl_b32 s93, s93, 2
    s_add_u32 s80, s80, s93
    s_add_u32 s80, s80, 0x5c8000
    s_lshl_b32 s83, s67, 1
    s_lshr_b32 s93, s3, 1
    s_add_u32 s83, s83, s93
    s_lshl_b32 s83, s83, 11
    s_add_u32 s83, s83, 0x5c8000
    v_lshrrev_b32 v10, 2, v2
    v_lshlrev_b32 v10, 7, v10
    v_and_b32_e64 v219, 3, v2
    v_lshl_add_u32 v10, v219, 2, v10
    s_lshl_b32 s84, s64, 12
    s_lshl_b32 s85, s84, 1
    s_add_u32 s85, s85, 0x5f0000
    s_add_u32 s84, s84, 0x5e8000
    s_lshl_b32 s81, s67, 5
    s_add_u32 s81, s81, s3
    s_lshl_b32 s81, s81, 2
    s_add_u32 s81, s81, s84
    s_lshl_b32 s93, s3, 10
    s_add_u32 s84, s84, s93
    v_bfe_u32 v11, v1, 2, 3
    v_min_u32 v12, 6, v11
    v_and_b32 v219, 3, v1
    v_lshlrev_b32_e64 v219, 2, v219
    v_lshl_add_u32 v11, v11, 7, v219
    v_lshl_add_u32 v12, v12, 7, v219
    s_lshl_b32 s82, s65, 5
    s_add_u32 s82, s82, s3
    s_lshl_b32 s82, s82, 2
    s_add_u32 s82, s82, s85
    s_mul_i32 s93, s3, 896
    s_add_u32 s85, s85, s93
    v_mov_b32 v9, 0
    v_lshlrev_b32_e64 v124, 9, v3
    v_bfe_u32 v237, v1, 2, 2
    v_lshl_add_u32 v124, v237, 6, v124
    v_and_b32_e64 v237, 3, v1
    v_lshl_add_u32 v124, v237, 3, v124
    v_and_b32 v237, 1, v3
    v_lshlrev_b32 v237, 5, v237
    v_add_u32_e64 v124, v124, v237
    v_add_u32 v124, 12288, v124
    v_xor_b32 v125, 32, v124
    s_and_b32 s53, s3, 1
    s_lshl_b32 s53, s53, 5
    v_xor_b32 v127, s53, v124
    s_lshr_b32 s53, s3, 1
    s_lshl_b32 s53, s53, 11
    s_add_u32 s53, s53, 2048
    v_add_u32 v126, s53, v127
    v_lshrrev_b32 v237, 1, v2
    v_xor_b32 v237, v237, v3
    v_lshlrev_b32 v237, 4, v237
    v_lshl_add_u32 v237, v2, 7, v237
    v_add_u32 v130, 61440, v237
    v_xor_b32 v131, 64, v130
    v_add_u32 v128, s52, v237
    v_xor_b32 v129, 64, v128
    v_lshlrev_b32 v237, 2, v3
    v_sub_u32_e64 v237, v2, v237
    v_mov_b32 v239, 0xf149f2ca
    v_add_u32 v238, 16, v237
    v_and_b32 v238, 0xfffffff1, v238
    v_cmp_eq_u32 vcc, 0, v238
    s_nop 1
    v_cndmask_b32 v240, v239, 0, vcc
    v_add_u32 v238, 15, v237
    v_and_b32 v238, 0xfffffff1, v238
    v_cmp_eq_u32 vcc, 0, v238
    s_nop 1
    v_cndmask_b32 v241, v239, 0, vcc
    v_add_u32 v238, 14, v237
    v_and_b32 v238, 0xfffffff1, v238
    v_cmp_eq_u32 vcc, 0, v238
    s_nop 1
    v_cndmask_b32 v242, v239, 0, vcc
    v_add_u32 v238, 13, v237
    v_and_b32 v238, 0xfffffff1, v238
    v_cmp_eq_u32 vcc, 0, v238
    s_nop 1
    v_cndmask_b32 v243, v239, 0, vcc
    v_add_u32 v238, 0, v237
    v_and_b32 v238, 0xfffffff1, v238
    v_cmp_eq_u32 vcc, 0, v238
    s_nop 1
    v_cndmask_b32 v244, v239, 0, vcc
    v_add_u32 v238, -1, v237
    v_and_b32 v238, 0xfffffff1, v238
    v_cmp_eq_u32 vcc, 0, v238
    s_nop 1
    v_cndmask_b32 v245, v239, 0, vcc
    v_add_u32 v238, -2, v237
    v_and_b32 v238, 0xfffffff1, v238
    v_cmp_eq_u32 vcc, 0, v238
    s_nop 1
    v_cndmask_b32 v246, v239, 0, vcc
    v_add_u32 v238, -3, v237
    v_and_b32 v238, 0xfffffff1, v238
    v_cmp_eq_u32 vcc, 0, v238
    s_nop 1
    v_cndmask_b32 v247, v239, 0, vcc
    s_or_b32 s53, s48, s3
    s_cmp_eq_u32 s53, 0
    s_cselect_b64 vcc, -1, 0
    v_cndmask_b32 v248, v240, v239, vcc
    v_cndmask_b32 v249, v241, v239, vcc
    v_cndmask_b32 v250, v242, v239, vcc
    v_cndmask_b32 v251, v243, v239, vcc
    v_mov_b32 v40, s5
    v_mov_b32 v41, s5
    v_mov_b32 v42, s5
    v_mov_b32_e64 v43, s5
    s_mov_b32 s88, 0x22222222
    s_mov_b32 s89, 0x22222222
    s_mov_b32 s90, 0x44444444
    s_mov_b32 s91, 0x44444444
    s_mov_b32 s92, 0x88888888
    s_mov_b32 s93, 0x88888888
    v_lshlrev_b32 v72, 4, v3
    s_lshl_b32 s53, s3, 6
    v_add_u32 v73, s53, v72
    s_and_b32 s53, s53, 64
    v_add_u32_e64 v74, s53, v72
    s_mul_i32 s53, s3, 384
    v_lshl_add_u32 v75, v2, 2, s53
    v_add_u32 v76, s53, v72
    s_and_b32 s53, s3, 1
    s_lshl_b32 s53, s53, 3
    v_add_u32 v80, s53, v4
    v_lshrrev_b32 v81, 2, v2
    v_lshlrev_b32 v81, 8, v81
    v_lshl_add_u32 v81, v3, 6, v81
    v_and_b32_e64 v82, 3, v2
    v_lshl_add_u32 v81, v82, 1, v81
    v_add_u32_e64 v81, s53, v81
    v_add_u32 v81, 1024, v81
    s_cmp_lt_u32 s3, 2
    s_cselect_b64 vcc, -1, 0
    s_cselect_b32 s53, 2, 16
    v_cndmask_b32 v80, v81, v80, vcc
    v_add_u32 v81, s53, v80
    v_add_u32 v82, s53, v81
    v_add_u32 v83, s53, v82
    v_lshlrev_b32 v77, 2, v2
    s_lshl_b32 s53, s3, 11
    v_add_u32 v78, s53, v4
    s_lshl_b32 s62, s48, 3
    s_lshl_b32 s63, s3, 1
    s_add_u32 s62, s62, s63
    s_lshl_b32 s62, s62, 4
    s_add_u32 s62, s62, s49
    s_lshl_b32 s62, s62, 10
    s_add_u32 s63, s62, 16384
    s_add_u32 m0, s51, 24576
    s_mov_b32 s73, 172032
    buffer_load_dwordx4 v123, s[12:15], s73 offen lds
    s_add_u32 m0, s51, 26624
    s_mov_b32 s73, 172928
    buffer_load_dwordx4 v123, s[12:15], s73 offen lds
    s_add_u32 m0, s51, 28672
    s_mov_b32 s73, 173824
    buffer_load_dwordx4 v123, s[12:15], s73 offen lds
    s_add_u32 m0, s52, 18432
    s_mov_b32 s73, 128
    buffer_load_dwordx4 v120, s[8:11], s73 offen lds
    s_add_u32 m0, s52, 19456
    s_mov_b32 s73, 128
    buffer_load_dwordx4 v121, s[8:11], s73 offen lds
    s_add_u32 m0, s52, 20480
    s_mov_b32 s73, 14464
    buffer_load_dwordx4 v120, s[8:11], s73 offen lds
    s_add_u32 m0, s52, 21504
    s_mov_b32 s73, 14464
    buffer_load_dwordx4 v121, s[8:11], s73 offen lds
    s_add_u32 m0, s7, 79872
    s_mov_b32 s73, 128
    s_mov_b64 exec, s[54:55]
    buffer_load_dwordx4 v122, s[8:11], s73 offen lds
    s_mov_b64 exec, -1
    s_waitcnt vmcnt(11)
    s_waitcnt lgkmcnt(0)
    s_barrier
    ds_read_b128 v[16:19], v128 offset:36864
    ds_read_b128 v[20:23], v128 offset:38912
    ds_read_b128 v[24:27], v130 offset:36864
    ds_read_b64_tr_b16 v[88:89], v124 offset:0
    ds_read_b64_tr_b16 v[90:91], v124 offset:256
    ds_read_b64_tr_b16 v[92:93], v125 offset:0
    ds_read_b64_tr_b16 v[94:95], v125 offset:256
    ds_read_b64_tr_b16 v[96:97], v124 offset:2048
    ds_read_b64_tr_b16 v[98:99], v124 offset:2304
    ds_read_b64_tr_b16 v[100:101], v125 offset:2048
    ds_read_b64_tr_b16 v[102:103], v125 offset:2304
    ds_read_b64_tr_b16 v[104:105], v124 offset:4096
    ds_read_b64_tr_b16 v[106:107], v124 offset:4352
    ds_read_b64_tr_b16 v[108:109], v125 offset:4096
    ds_read_b64_tr_b16 v[110:111], v125 offset:4352
    ds_read_b64_tr_b16 v[112:113], v126 offset:0
    ds_read_b64_tr_b16 v[114:115], v126 offset:256
    ds_read_b64_tr_b16 v[116:117], v127 offset:0
    ds_read_b64_tr_b16 v[118:119], v127 offset:256
    s_waitcnt lgkmcnt(8)
    v_mfma_f32_16x16x32_bf16 v[136:139], v[88:91], v[16:19], 0
    ds_read_b128 v[28:31], v129 offset:36864
    v_mfma_f32_16x16x32_bf16 v[160:163], v[88:91], v[20:23], 0
    ds_read_b128 v[32:35], v129 offset:38912
    v_mfma_f32_16x16x32_bf16 v[140:143], v[92:95], v[16:19], 0
    ds_read_b128 v[36:39], v131 offset:36864
    v_mfma_f32_16x16x32_bf16 v[164:167], v[92:95], v[20:23], 0
    ds_read_b64_tr_b16 v[88:89], v124 offset:6144
    v_mfma_f32_16x16x32_bf16 v[144:147], v[96:99], v[16:19], 0
    ds_read_b64_tr_b16 v[90:91], v124 offset:6400
    s_add_u32 m0, s51, 36864
    s_mov_b32 s73, 344064
    buffer_load_dwordx4 v123, s[12:15], s73 offen lds
    v_mfma_f32_16x16x32_bf16 v[168:171], v[96:99], v[20:23], 0
    ds_read_b64_tr_b16 v[92:93], v125 offset:6144
    v_mfma_f32_16x16x32_bf16 v[148:151], v[100:103], v[16:19], 0
    ds_read_b64_tr_b16 v[94:95], v125 offset:6400
    v_mfma_f32_16x16x32_bf16 v[172:175], v[100:103], v[20:23], 0
    ds_read_b64_tr_b16 v[96:97], v124 offset:8192
    s_waitcnt lgkmcnt(8)
    v_mfma_f32_16x16x32_bf16 v[152:155], v[16:19], v[104:107], 0
    ds_read_b64_tr_b16 v[98:99], v124 offset:8448
    v_mfma_f32_16x16x32_bf16 v[176:179], v[20:23], v[104:107], 0
    ds_read_b64_tr_b16 v[100:101], v125 offset:8192
    s_add_u32 m0, s51, 38912
    s_mov_b32 s73, 344960
    buffer_load_dwordx4 v123, s[12:15], s73 offen lds
    v_mfma_f32_16x16x32_bf16 v[156:159], v[16:19], v[108:111], 0
    ds_read_b64_tr_b16 v[102:103], v125 offset:8448
    v_mfma_f32_16x16x32_bf16 v[180:183], v[20:23], v[108:111], 0
    ds_read_b64_tr_b16 v[104:105], v124 offset:10240
    v_mfma_f32_16x16x32_bf16 v[184:187], v[112:115], v[24:27], 0
    ds_read_b64_tr_b16 v[106:107], v124 offset:10496
    v_mfma_f32_16x16x32_bf16 v[188:191], v[116:119], v[24:27], 0
    ds_read_b64_tr_b16 v[108:109], v125 offset:10240
    v_mfma_f32_16x16x32_bf16 v[48:51], v[16:19], v[16:19], 0
    ds_read_b64_tr_b16 v[110:111], v125 offset:10496
    s_add_u32 m0, s51, 40960
    s_mov_b32 s73, 345856
    buffer_load_dwordx4 v123, s[12:15], s73 offen lds
    v_mfma_f32_16x16x32_bf16 v[52:55], v[20:23], v[20:23], 0
    ds_read_b64_tr_b16 v[112:113], v126 offset:6144
    v_mfma_f32_16x16x32_bf16 v[56:59], v[24:27], v[24:27], 0
    ds_read_b64_tr_b16 v[114:115], v126 offset:6400
    v_mfma_f32_16x16x32_bf16 v[60:63], v[40:43], v[16:19], 0
    ds_read_b64_tr_b16 v[116:117], v127 offset:6144
    v_mfma_f32_16x16x32_bf16 v[64:67], v[40:43], v[20:23], 0
    ds_read_b64_tr_b16 v[118:119], v127 offset:6400
    v_mfma_f32_16x16x32_bf16 v[68:71], v[40:43], v[24:27], 0
    s_add_u32 m0, s52, 0
    s_mov_b32 s73, 256
    buffer_load_dwordx4 v120, s[8:11], s73 offen lds
    s_add_u32 m0, s52, 1024
    s_mov_b32 s73, 256
    buffer_load_dwordx4 v121, s[8:11], s73 offen lds
    s_add_u32 m0, s52, 2048
    s_mov_b32 s73, 14592
    buffer_load_dwordx4 v120, s[8:11], s73 offen lds
    s_add_u32 m0, s52, 3072
    s_mov_b32 s73, 14592
    buffer_load_dwordx4 v121, s[8:11], s73 offen lds
    s_add_u32 m0, s7, 61440
    s_mov_b32 s73, 256
    s_mov_b64 exec, s[54:55]
    buffer_load_dwordx4 v122, s[8:11], s73 offen lds
    s_mov_b64 exec, -1
    s_waitcnt vmcnt(8)
    s_barrier
    s_waitcnt lgkmcnt(8)
    v_mfma_f32_16x16x32_bf16 v[136:139], v[88:91], v[28:31], v[136:139]
    ds_read_b128 v[16:19], v128 offset:18432
    v_mfma_f32_16x16x32_bf16 v[160:163], v[88:91], v[32:35], v[160:163]
    ds_read_b128 v[20:23], v128 offset:20480
    v_mfma_f32_16x16x32_bf16 v[140:143], v[92:95], v[28:31], v[140:143]
    ds_read_b128 v[24:27], v130 offset:18432
    v_mfma_f32_16x16x32_bf16 v[164:167], v[92:95], v[32:35], v[164:167]
    ds_read_b64_tr_b16 v[88:89], v124 offset:12288
    v_mfma_f32_16x16x32_bf16 v[144:147], v[96:99], v[28:31], v[144:147]
    ds_read_b64_tr_b16 v[90:91], v124 offset:12544
    s_add_u32 m0, s51, 49152
    s_mov_b32 s73, 516096
    buffer_load_dwordx4 v123, s[12:15], s73 offen lds
    v_mfma_f32_16x16x32_bf16 v[168:171], v[96:99], v[32:35], v[168:171]
    ds_read_b64_tr_b16 v[92:93], v125 offset:12288
    v_mfma_f32_16x16x32_bf16 v[148:151], v[100:103], v[28:31], v[148:151]
    ds_read_b64_tr_b16 v[94:95], v125 offset:12544
    v_mfma_f32_16x16x32_bf16 v[172:175], v[100:103], v[32:35], v[172:175]
    ds_read_b64_tr_b16 v[96:97], v124 offset:14336
    s_waitcnt lgkmcnt(8)
    v_mfma_f32_16x16x32_bf16 v[152:155], v[28:31], v[104:107], v[152:155]
    ds_read_b64_tr_b16 v[98:99], v124 offset:14592
    v_mfma_f32_16x16x32_bf16 v[176:179], v[32:35], v[104:107], v[176:179]
    ds_read_b64_tr_b16 v[100:101], v125 offset:14336
    s_add_u32 m0, s51, 51200
    s_mov_b32 s73, 516992
    buffer_load_dwordx4 v123, s[12:15], s73 offen lds
    v_mfma_f32_16x16x32_bf16 v[156:159], v[28:31], v[108:111], v[156:159]
    ds_read_b64_tr_b16 v[102:103], v125 offset:14592
    v_mfma_f32_16x16x32_bf16 v[180:183], v[32:35], v[108:111], v[180:183]
    ds_read_b64_tr_b16 v[104:105], v124 offset:16384
    v_mfma_f32_16x16x32_bf16 v[184:187], v[112:115], v[36:39], v[184:187]
    ds_read_b64_tr_b16 v[106:107], v124 offset:16640
    v_mfma_f32_16x16x32_bf16 v[188:191], v[116:119], v[36:39], v[188:191]
    ds_read_b64_tr_b16 v[108:109], v125 offset:16384
    v_mfma_f32_16x16x32_bf16 v[48:51], v[28:31], v[28:31], v[48:51]
    ds_read_b64_tr_b16 v[110:111], v125 offset:16640
    s_add_u32 m0, s51, 53248
    s_mov_b32 s73, 517888
    buffer_load_dwordx4 v123, s[12:15], s73 offen lds
    v_mfma_f32_16x16x32_bf16 v[52:55], v[32:35], v[32:35], v[52:55]
    ds_read_b64_tr_b16 v[112:113], v126 offset:12288
    v_mfma_f32_16x16x32_bf16 v[56:59], v[36:39], v[36:39], v[56:59]
    ds_read_b64_tr_b16 v[114:115], v126 offset:12544
    v_mfma_f32_16x16x32_bf16 v[60:63], v[40:43], v[28:31], v[60:63]
    ds_read_b64_tr_b16 v[116:117], v127 offset:12288
    v_mfma_f32_16x16x32_bf16 v[64:67], v[40:43], v[32:35], v[64:67]
    ds_read_b64_tr_b16 v[118:119], v127 offset:12544
    v_mfma_f32_16x16x32_bf16 v[68:71], v[40:43], v[36:39], v[68:71]
    s_add_u32 m0, s52, 55296
    s_mov_b32 s73, 384
    buffer_load_dwordx4 v120, s[8:11], s73 offen lds
    s_waitcnt lgkmcnt(8)
    v_mfma_f32_16x16x32_bf16 v[136:139], v[88:91], v[16:19], v[136:139]
    ds_read_b128 v[28:31], v129 offset:18432
    v_mfma_f32_16x16x32_bf16 v[160:163], v[88:91], v[20:23], v[160:163]
    ds_read_b128 v[32:35], v129 offset:20480
    v_mfma_f32_16x16x32_bf16 v[140:143], v[92:95], v[16:19], v[140:143]
    ds_read_b128 v[36:39], v131 offset:18432
    v_mfma_f32_16x16x32_bf16 v[164:167], v[92:95], v[20:23], v[164:167]
    ds_read_b64_tr_b16 v[88:89], v124 offset:18432
    v_mfma_f32_16x16x32_bf16 v[144:147], v[96:99], v[16:19], v[144:147]
    ds_read_b64_tr_b16 v[90:91], v124 offset:18688
    s_add_u32 m0, s52, 56320
    s_mov_b32 s73, 384
    buffer_load_dwordx4 v121, s[8:11], s73 offen lds
    v_mfma_f32_16x16x32_bf16 v[168:171], v[96:99], v[20:23], v[168:171]
    ds_read_b64_tr_b16 v[92:93], v125 offset:18432
    v_mfma_f32_16x16x32_bf16 v[148:151], v[100:103], v[16:19], v[148:151]
    ds_read_b64_tr_b16 v[94:95], v125 offset:18688
    v_mfma_f32_16x16x32_bf16 v[172:175], v[100:103], v[20:23], v[172:175]
    ds_read_b64_tr_b16 v[96:97], v124 offset:20480
    s_waitcnt lgkmcnt(8)
    v_mfma_f32_16x16x32_bf16 v[152:155], v[16:19], v[104:107], v[152:155]
    ds_read_b64_tr_b16 v[98:99], v124 offset:20736
    v_mfma_f32_16x16x32_bf16 v[176:179], v[20:23], v[104:107], v[176:179]
    ds_read_b64_tr_b16 v[100:101], v125 offset:20480
    s_add_u32 m0, s52, 57344
    s_mov_b32 s73, 14720
    buffer_load_dwordx4 v120, s[8:11], s73 offen lds
    v_mfma_f32_16x16x32_bf16 v[156:159], v[16:19], v[108:111], v[156:159]
    ds_read_b64_tr_b16 v[102:103], v125 offset:20736
    v_mfma_f32_16x16x32_bf16 v[180:183], v[20:23], v[108:111], v[180:183]
    ds_read_b64_tr_b16 v[104:105], v124 offset:22528
    v_mfma_f32_16x16x32_bf16 v[184:187], v[112:115], v[24:27], v[184:187]
    ds_read_b64_tr_b16 v[106:107], v124 offset:22784
    v_mfma_f32_16x16x32_bf16 v[188:191], v[116:119], v[24:27], v[188:191]
    ds_read_b64_tr_b16 v[108:109], v125 offset:22528
    v_mfma_f32_16x16x32_bf16 v[48:51], v[16:19], v[16:19], v[48:51]
    ds_read_b64_tr_b16 v[110:111], v125 offset:22784
    s_add_u32 m0, s52, 58368
    s_mov_b32 s73, 14720
    buffer_load_dwordx4 v121, s[8:11], s73 offen lds
    v_mfma_f32_16x16x32_bf16 v[52:55], v[20:23], v[20:23], v[52:55]
    ds_read_b64_tr_b16 v[112:113], v126 offset:18432
    v_mfma_f32_16x16x32_bf16 v[56:59], v[24:27], v[24:27], v[56:59]
    ds_read_b64_tr_b16 v[114:115], v126 offset:18688
    v_mfma_f32_16x16x32_bf16 v[60:63], v[40:43], v[16:19], v[60:63]
    ds_read_b64_tr_b16 v[116:117], v127 offset:18432
    v_mfma_f32_16x16x32_bf16 v[64:67], v[40:43], v[20:23], v[64:67]
    ds_read_b64_tr_b16 v[118:119], v127 offset:18688
    v_mfma_f32_16x16x32_bf16 v[68:71], v[40:43], v[24:27], v[68:71]
    s_add_u32 m0, s7, 116736
    s_mov_b32 s73, 384
    s_mov_b64 exec, s[54:55]
    buffer_load_dwordx4 v122, s[8:11], s73 offen lds
    s_mov_b64 exec, -1
    s_waitcnt vmcnt(8)
    s_barrier
    s_waitcnt lgkmcnt(8)
    v_mfma_f32_16x16x32_bf16 v[136:139], v[88:91], v[28:31], v[136:139]
    ds_read_b128 v[16:19], v128 offset:0
    v_mfma_f32_16x16x32_bf16 v[160:163], v[88:91], v[32:35], v[160:163]
    ds_read_b128 v[20:23], v128 offset:2048
    v_mfma_f32_16x16x32_bf16 v[140:143], v[92:95], v[28:31], v[140:143]
    ds_read_b128 v[24:27], v130 offset:0
    v_mfma_f32_16x16x32_bf16 v[164:167], v[92:95], v[32:35], v[164:167]
    ds_read_b64_tr_b16 v[88:89], v124 offset:24576
    v_mfma_f32_16x16x32_bf16 v[144:147], v[96:99], v[28:31], v[144:147]
    ds_read_b64_tr_b16 v[90:91], v124 offset:24832
    s_add_u32 m0, s51, 12288
    s_mov_b32 s73, 688128
    buffer_load_dwordx4 v123, s[12:15], s73 offen lds
    v_mfma_f32_16x16x32_bf16 v[168:171], v[96:99], v[32:35], v[168:171]
    ds_read_b64_tr_b16 v[92:93], v125 offset:24576
    v_mfma_f32_16x16x32_bf16 v[148:151], v[100:103], v[28:31], v[148:151]
    ds_read_b64_tr_b16 v[94:95], v125 offset:24832
    v_mfma_f32_16x16x32_bf16 v[172:175], v[100:103], v[32:35], v[172:175]
    ds_read_b64_tr_b16 v[96:97], v124 offset:26624
    s_waitcnt lgkmcnt(8)
    v_mfma_f32_16x16x32_bf16 v[152:155], v[28:31], v[104:107], v[152:155]
    ds_read_b64_tr_b16 v[98:99], v124 offset:26880
    v_mfma_f32_16x16x32_bf16 v[176:179], v[32:35], v[104:107], v[176:179]
    ds_read_b64_tr_b16 v[100:101], v125 offset:26624
    s_add_u32 m0, s51, 14336
    s_mov_b32 s73, 689024
    buffer_load_dwordx4 v123, s[12:15], s73 offen lds
    v_mfma_f32_16x16x32_bf16 v[156:159], v[28:31], v[108:111], v[156:159]
    ds_read_b64_tr_b16 v[102:103], v125 offset:26880
    v_mfma_f32_16x16x32_bf16 v[180:183], v[32:35], v[108:111], v[180:183]
    ds_read_b64_tr_b16 v[104:105], v124 offset:28672
    v_mfma_f32_16x16x32_bf16 v[184:187], v[112:115], v[36:39], v[184:187]
    ds_read_b64_tr_b16 v[106:107], v124 offset:28928
    v_mfma_f32_16x16x32_bf16 v[188:191], v[116:119], v[36:39], v[188:191]
    ds_read_b64_tr_b16 v[108:109], v125 offset:28672
    v_mfma_f32_16x16x32_bf16 v[48:51], v[28:31], v[28:31], v[48:51]
    ds_read_b64_tr_b16 v[110:111], v125 offset:28928
    s_add_u32 m0, s51, 16384
    s_mov_b32 s73, 689920
    buffer_load_dwordx4 v123, s[12:15], s73 offen lds
    v_mfma_f32_16x16x32_bf16 v[52:55], v[32:35], v[32:35], v[52:55]
    ds_read_b64_tr_b16 v[112:113], v126 offset:24576
    v_mfma_f32_16x16x32_bf16 v[56:59], v[36:39], v[36:39], v[56:59]
    ds_read_b64_tr_b16 v[114:115], v126 offset:24832
    v_mfma_f32_16x16x32_bf16 v[60:63], v[40:43], v[28:31], v[60:63]
    ds_read_b64_tr_b16 v[116:117], v127 offset:24576
    v_mfma_f32_16x16x32_bf16 v[64:67], v[40:43], v[32:35], v[64:67]
    ds_read_b64_tr_b16 v[118:119], v127 offset:24832
    v_mfma_f32_16x16x32_bf16 v[68:71], v[40:43], v[36:39], v[68:71]
    s_add_u32 m0, s52, 36864
    s_mov_b32 s73, 512
    buffer_load_dwordx4 v120, s[8:11], s73 offen lds
    s_waitcnt lgkmcnt(8)
    v_mfma_f32_16x16x32_bf16 v[136:139], v[88:91], v[16:19], v[136:139]
    ds_read_b128 v[28:31], v129 offset:0
    v_mfma_f32_16x16x32_bf16 v[160:163], v[88:91], v[20:23], v[160:163]
    ds_read_b128 v[32:35], v129 offset:2048
    v_mfma_f32_16x16x32_bf16 v[140:143], v[92:95], v[16:19], v[140:143]
    ds_read_b128 v[36:39], v131 offset:0
    v_mfma_f32_16x16x32_bf16 v[164:167], v[92:95], v[20:23], v[164:167]
    ds_read_b64_tr_b16 v[88:89], v124 offset:30720
    v_mfma_f32_16x16x32_bf16 v[144:147], v[96:99], v[16:19], v[144:147]
    ds_read_b64_tr_b16 v[90:91], v124 offset:30976
    s_add_u32 m0, s52, 37888
    s_mov_b32 s73, 512
    buffer_load_dwordx4 v121, s[8:11], s73 offen lds
    v_mfma_f32_16x16x32_bf16 v[168:171], v[96:99], v[20:23], v[168:171]
    ds_read_b64_tr_b16 v[92:93], v125 offset:30720
    v_mfma_f32_16x16x32_bf16 v[148:151], v[100:103], v[16:19], v[148:151]
    ds_read_b64_tr_b16 v[94:95], v125 offset:30976
    v_mfma_f32_16x16x32_bf16 v[172:175], v[100:103], v[20:23], v[172:175]
    ds_read_b64_tr_b16 v[96:97], v124 offset:32768
    s_waitcnt lgkmcnt(8)
    v_mfma_f32_16x16x32_bf16 v[152:155], v[16:19], v[104:107], v[152:155]
    ds_read_b64_tr_b16 v[98:99], v124 offset:33024
    v_mfma_f32_16x16x32_bf16 v[176:179], v[20:23], v[104:107], v[176:179]
    ds_read_b64_tr_b16 v[100:101], v125 offset:32768
    s_add_u32 m0, s52, 38912
    s_mov_b32 s73, 14848
    buffer_load_dwordx4 v120, s[8:11], s73 offen lds
    v_mfma_f32_16x16x32_bf16 v[156:159], v[16:19], v[108:111], v[156:159]
    ds_read_b64_tr_b16 v[102:103], v125 offset:33024
    v_mfma_f32_16x16x32_bf16 v[180:183], v[20:23], v[108:111], v[180:183]
    ds_read_b64_tr_b16 v[104:105], v124 offset:34816
    v_mfma_f32_16x16x32_bf16 v[184:187], v[112:115], v[24:27], v[184:187]
    ds_read_b64_tr_b16 v[106:107], v124 offset:35072
    v_mfma_f32_16x16x32_bf16 v[188:191], v[116:119], v[24:27], v[188:191]
    ds_read_b64_tr_b16 v[108:109], v125 offset:34816
    v_mfma_f32_16x16x32_bf16 v[48:51], v[16:19], v[16:19], v[48:51]
    ds_read_b64_tr_b16 v[110:111], v125 offset:35072
    s_add_u32 m0, s52, 39936
    s_mov_b32 s73, 14848
    buffer_load_dwordx4 v121, s[8:11], s73 offen lds
    v_mfma_f32_16x16x32_bf16 v[52:55], v[20:23], v[20:23], v[52:55]
    ds_read_b64_tr_b16 v[112:113], v126 offset:30720
    v_mfma_f32_16x16x32_bf16 v[56:59], v[24:27], v[24:27], v[56:59]
    ds_read_b64_tr_b16 v[114:115], v126 offset:30976
    v_mfma_f32_16x16x32_bf16 v[60:63], v[40:43], v[16:19], v[60:63]
    ds_read_b64_tr_b16 v[116:117], v127 offset:30720
    v_mfma_f32_16x16x32_bf16 v[64:67], v[40:43], v[20:23], v[64:67]
    ds_read_b64_tr_b16 v[118:119], v127 offset:30976
    v_mfma_f32_16x16x32_bf16 v[68:71], v[40:43], v[24:27], v[68:71]
    s_add_u32 m0, s7, 98304
    s_mov_b32 s73, 512
    s_mov_b64 exec, s[54:55]
    buffer_load_dwordx4 v122, s[8:11], s73 offen lds
    s_mov_b64 exec, -1
    s_waitcnt vmcnt(8)
    s_barrier
    s_waitcnt lgkmcnt(8)
    v_mfma_f32_16x16x32_bf16 v[136:139], v[88:91], v[28:31], v[136:139]
    ds_read_b128 v[16:19], v128 offset:55296
    v_mfma_f32_16x16x32_bf16 v[160:163], v[88:91], v[32:35], v[160:163]
    ds_read_b128 v[20:23], v128 offset:57344
    v_mfma_f32_16x16x32_bf16 v[140:143], v[92:95], v[28:31], v[140:143]
    ds_read_b128 v[24:27], v130 offset:55296
    v_mfma_f32_16x16x32_bf16 v[164:167], v[92:95], v[32:35], v[164:167]
    ds_read_b64_tr_b16 v[88:89], v124 offset:36864
    v_mfma_f32_16x16x32_bf16 v[144:147], v[96:99], v[28:31], v[144:147]
    ds_read_b64_tr_b16 v[90:91], v124 offset:37120
    s_add_u32 m0, s51, 24576
    s_mov_b32 s73, 860160
    buffer_load_dwordx4 v123, s[12:15], s73 offen lds
    v_mfma_f32_16x16x32_bf16 v[168:171], v[96:99], v[32:35], v[168:171]
    ds_read_b64_tr_b16 v[92:93], v125 offset:36864
    v_mfma_f32_16x16x32_bf16 v[148:151], v[100:103], v[28:31], v[148:151]
    ds_read_b64_tr_b16 v[94:95], v125 offset:37120
    v_mfma_f32_16x16x32_bf16 v[172:175], v[100:103], v[32:35], v[172:175]
    ds_read_b64_tr_b16 v[96:97], v124 offset:38912
    s_waitcnt lgkmcnt(8)
    v_mfma_f32_16x16x32_bf16 v[152:155], v[28:31], v[104:107], v[152:155]
    ds_read_b64_tr_b16 v[98:99], v124 offset:39168
    v_mfma_f32_16x16x32_bf16 v[176:179], v[32:35], v[104:107], v[176:179]
    ds_read_b64_tr_b16 v[100:101], v125 offset:38912
    s_add_u32 m0, s51, 26624
    s_mov_b32 s73, 861056
    buffer_load_dwordx4 v123, s[12:15], s73 offen lds
    v_mfma_f32_16x16x32_bf16 v[156:159], v[28:31], v[108:111], v[156:159]
    ds_read_b64_tr_b16 v[102:103], v125 offset:39168
    v_mfma_f32_16x16x32_bf16 v[180:183], v[32:35], v[108:111], v[180:183]
    ds_read_b64_tr_b16 v[104:105], v124 offset:40960
    v_mfma_f32_16x16x32_bf16 v[184:187], v[112:115], v[36:39], v[184:187]
    ds_read_b64_tr_b16 v[106:107], v124 offset:41216
    v_mfma_f32_16x16x32_bf16 v[188:191], v[116:119], v[36:39], v[188:191]
    ds_read_b64_tr_b16 v[108:109], v125 offset:40960
    v_mfma_f32_16x16x32_bf16 v[48:51], v[28:31], v[28:31], v[48:51]
    ds_read_b64_tr_b16 v[110:111], v125 offset:41216
    s_add_u32 m0, s51, 28672
    s_mov_b32 s73, 861952
    buffer_load_dwordx4 v123, s[12:15], s73 offen lds
    v_mfma_f32_16x16x32_bf16 v[52:55], v[32:35], v[32:35], v[52:55]
    ds_read_b64_tr_b16 v[112:113], v126 offset:36864
    v_mfma_f32_16x16x32_bf16 v[56:59], v[36:39], v[36:39], v[56:59]
    ds_read_b64_tr_b16 v[114:115], v126 offset:37120
    v_mfma_f32_16x16x32_bf16 v[60:63], v[40:43], v[28:31], v[60:63]
    ds_read_b64_tr_b16 v[116:117], v127 offset:36864
    v_mfma_f32_16x16x32_bf16 v[64:67], v[40:43], v[32:35], v[64:67]
    ds_read_b64_tr_b16 v[118:119], v127 offset:37120
    v_mfma_f32_16x16x32_bf16 v[68:71], v[40:43], v[36:39], v[68:71]
    s_add_u32 m0, s52, 18432
    s_mov_b32 s73, 640
    buffer_load_dwordx4 v120, s[8:11], s73 offen lds
    s_waitcnt lgkmcnt(8)
    v_mfma_f32_16x16x32_bf16 v[136:139], v[88:91], v[16:19], v[136:139]
    ds_read_b128 v[28:31], v129 offset:55296
    v_mfma_f32_16x16x32_bf16 v[160:163], v[88:91], v[20:23], v[160:163]
    ds_read_b128 v[32:35], v129 offset:57344
    v_mfma_f32_16x16x32_bf16 v[140:143], v[92:95], v[16:19], v[140:143]
    ds_read_b128 v[36:39], v131 offset:55296
    v_mfma_f32_16x16x32_bf16 v[164:167], v[92:95], v[20:23], v[164:167]
    ds_read_b64_tr_b16 v[88:89], v124 offset:43008
    v_mfma_f32_16x16x32_bf16 v[144:147], v[96:99], v[16:19], v[144:147]
    ds_read_b64_tr_b16 v[90:91], v124 offset:43264
    s_add_u32 m0, s52, 19456
    s_mov_b32 s73, 640
    buffer_load_dwordx4 v121, s[8:11], s73 offen lds
    v_mfma_f32_16x16x32_bf16 v[168:171], v[96:99], v[20:23], v[168:171]
    ds_read_b64_tr_b16 v[92:93], v125 offset:43008
    v_mfma_f32_16x16x32_bf16 v[148:151], v[100:103], v[16:19], v[148:151]
    ds_read_b64_tr_b16 v[94:95], v125 offset:43264
    v_mfma_f32_16x16x32_bf16 v[172:175], v[100:103], v[20:23], v[172:175]
    ds_read_b64_tr_b16 v[96:97], v124 offset:45056
    s_waitcnt lgkmcnt(8)
    v_mfma_f32_16x16x32_bf16 v[152:155], v[16:19], v[104:107], v[152:155]
    ds_read_b64_tr_b16 v[98:99], v124 offset:45312
    v_mfma_f32_16x16x32_bf16 v[176:179], v[20:23], v[104:107], v[176:179]
    ds_read_b64_tr_b16 v[100:101], v125 offset:45056
    s_add_u32 m0, s52, 20480
    s_mov_b32 s73, 14976
    buffer_load_dwordx4 v120, s[8:11], s73 offen lds
    v_mfma_f32_16x16x32_bf16 v[156:159], v[16:19], v[108:111], v[156:159]
    ds_read_b64_tr_b16 v[102:103], v125 offset:45312
    v_mfma_f32_16x16x32_bf16 v[180:183], v[20:23], v[108:111], v[180:183]
    ds_read_b64_tr_b16 v[104:105], v124 offset:47104
    v_mfma_f32_16x16x32_bf16 v[184:187], v[112:115], v[24:27], v[184:187]
    ds_read_b64_tr_b16 v[106:107], v124 offset:47360
    v_mfma_f32_16x16x32_bf16 v[188:191], v[116:119], v[24:27], v[188:191]
    ds_read_b64_tr_b16 v[108:109], v125 offset:47104
    v_mfma_f32_16x16x32_bf16 v[48:51], v[16:19], v[16:19], v[48:51]
    ds_read_b64_tr_b16 v[110:111], v125 offset:47360
    s_add_u32 m0, s52, 21504
    s_mov_b32 s73, 14976
    buffer_load_dwordx4 v121, s[8:11], s73 offen lds
    v_mfma_f32_16x16x32_bf16 v[52:55], v[20:23], v[20:23], v[52:55]
    ds_read_b64_tr_b16 v[112:113], v126 offset:43008
    v_mfma_f32_16x16x32_bf16 v[56:59], v[24:27], v[24:27], v[56:59]
    ds_read_b64_tr_b16 v[114:115], v126 offset:43264
    v_mfma_f32_16x16x32_bf16 v[60:63], v[40:43], v[16:19], v[60:63]
    ds_read_b64_tr_b16 v[116:117], v127 offset:43008
    v_mfma_f32_16x16x32_bf16 v[64:67], v[40:43], v[20:23], v[64:67]
    ds_read_b64_tr_b16 v[118:119], v127 offset:43264
    v_mfma_f32_16x16x32_bf16 v[68:71], v[40:43], v[24:27], v[68:71]
    s_add_u32 m0, s7, 79872
    s_mov_b32 s73, 640
    s_mov_b64 exec, s[54:55]
    buffer_load_dwordx4 v122, s[8:11], s73 offen lds
    s_mov_b64 exec, -1
    s_waitcnt vmcnt(8)
    s_barrier
    s_waitcnt lgkmcnt(8)
    v_mfma_f32_16x16x32_bf16 v[136:139], v[88:91], v[28:31], v[136:139]
    ds_read_b128 v[16:19], v128 offset:36864
    v_mfma_f32_16x16x32_bf16 v[160:163], v[88:91], v[32:35], v[160:163]
    ds_read_b128 v[20:23], v128 offset:38912
    v_mfma_f32_16x16x32_bf16 v[140:143], v[92:95], v[28:31], v[140:143]
    ds_read_b128 v[24:27], v130 offset:36864
    v_mfma_f32_16x16x32_bf16 v[164:167], v[92:95], v[32:35], v[164:167]
    ds_read_b64_tr_b16 v[88:89], v124 offset:0
    v_mfma_f32_16x16x32_bf16 v[144:147], v[96:99], v[28:31], v[144:147]
    ds_read_b64_tr_b16 v[90:91], v124 offset:256
    s_add_u32 m0, s51, 36864
    s_mov_b32 s73, 1032192
    buffer_load_dwordx4 v123, s[12:15], s73 offen lds
    v_mfma_f32_16x16x32_bf16 v[168:171], v[96:99], v[32:35], v[168:171]
    ds_read_b64_tr_b16 v[92:93], v125 offset:0
    v_mfma_f32_16x16x32_bf16 v[148:151], v[100:103], v[28:31], v[148:151]
    ds_read_b64_tr_b16 v[94:95], v125 offset:256
    v_mfma_f32_16x16x32_bf16 v[172:175], v[100:103], v[32:35], v[172:175]
    ds_read_b64_tr_b16 v[96:97], v124 offset:2048
    s_waitcnt lgkmcnt(8)
    v_mfma_f32_16x16x32_bf16 v[152:155], v[28:31], v[104:107], v[152:155]
    ds_read_b64_tr_b16 v[98:99], v124 offset:2304
    v_mfma_f32_16x16x32_bf16 v[176:179], v[32:35], v[104:107], v[176:179]
    ds_read_b64_tr_b16 v[100:101], v125 offset:2048
    s_add_u32 m0, s51, 38912
    s_mov_b32 s73, 1033088
    buffer_load_dwordx4 v123, s[12:15], s73 offen lds
    v_mfma_f32_16x16x32_bf16 v[156:159], v[28:31], v[108:111], v[156:159]
    ds_read_b64_tr_b16 v[102:103], v125 offset:2304
    v_mfma_f32_16x16x32_bf16 v[180:183], v[32:35], v[108:111], v[180:183]
    ds_read_b64_tr_b16 v[104:105], v124 offset:4096
    v_mfma_f32_16x16x32_bf16 v[184:187], v[112:115], v[36:39], v[184:187]
    ds_read_b64_tr_b16 v[106:107], v124 offset:4352
    v_mfma_f32_16x16x32_bf16 v[188:191], v[116:119], v[36:39], v[188:191]
    ds_read_b64_tr_b16 v[108:109], v125 offset:4096
    v_mfma_f32_16x16x32_bf16 v[48:51], v[28:31], v[28:31], v[48:51]
    ds_read_b64_tr_b16 v[110:111], v125 offset:4352
    s_add_u32 m0, s51, 40960
    s_mov_b32 s73, 1033984
    buffer_load_dwordx4 v123, s[12:15], s73 offen lds
    v_mfma_f32_16x16x32_bf16 v[52:55], v[32:35], v[32:35], v[52:55]
    ds_read_b64_tr_b16 v[112:113], v126 offset:0
    v_mfma_f32_16x16x32_bf16 v[56:59], v[36:39], v[36:39], v[56:59]
    ds_read_b64_tr_b16 v[114:115], v126 offset:256
    v_mfma_f32_16x16x32_bf16 v[60:63], v[40:43], v[28:31], v[60:63]
    ds_read_b64_tr_b16 v[116:117], v127 offset:0
    v_mfma_f32_16x16x32_bf16 v[64:67], v[40:43], v[32:35], v[64:67]
    ds_read_b64_tr_b16 v[118:119], v127 offset:256
    v_mfma_f32_16x16x32_bf16 v[68:71], v[40:43], v[36:39], v[68:71]
    s_add_u32 m0, s52, 0
    s_mov_b32 s73, 768
    buffer_load_dwordx4 v120, s[8:11], s73 offen lds
    s_waitcnt lgkmcnt(8)
    v_mfma_f32_16x16x32_bf16 v[136:139], v[88:91], v[16:19], v[136:139]
    ds_read_b128 v[28:31], v129 offset:36864
    v_mfma_f32_16x16x32_bf16 v[160:163], v[88:91], v[20:23], v[160:163]
    ds_read_b128 v[32:35], v129 offset:38912
    v_mfma_f32_16x16x32_bf16 v[140:143], v[92:95], v[16:19], v[140:143]
    ds_read_b128 v[36:39], v131 offset:36864
    v_mfma_f32_16x16x32_bf16 v[164:167], v[92:95], v[20:23], v[164:167]
    ds_read_b64_tr_b16 v[88:89], v124 offset:6144
    v_mfma_f32_16x16x32_bf16 v[144:147], v[96:99], v[16:19], v[144:147]
    ds_read_b64_tr_b16 v[90:91], v124 offset:6400
    s_add_u32 m0, s52, 1024
    s_mov_b32 s73, 768
    buffer_load_dwordx4 v121, s[8:11], s73 offen lds
    v_mfma_f32_16x16x32_bf16 v[168:171], v[96:99], v[20:23], v[168:171]
    ds_read_b64_tr_b16 v[92:93], v125 offset:6144
    v_mfma_f32_16x16x32_bf16 v[148:151], v[100:103], v[16:19], v[148:151]
    ds_read_b64_tr_b16 v[94:95], v125 offset:6400
    v_mfma_f32_16x16x32_bf16 v[172:175], v[100:103], v[20:23], v[172:175]
    ds_read_b64_tr_b16 v[96:97], v124 offset:8192
    s_waitcnt lgkmcnt(8)
    v_mfma_f32_16x16x32_bf16 v[152:155], v[16:19], v[104:107], v[152:155]
    ds_read_b64_tr_b16 v[98:99], v124 offset:8448
    v_mfma_f32_16x16x32_bf16 v[176:179], v[20:23], v[104:107], v[176:179]
    ds_read_b64_tr_b16 v[100:101], v125 offset:8192
    s_add_u32 m0, s52, 2048
    s_mov_b32 s73, 15104
    buffer_load_dwordx4 v120, s[8:11], s73 offen lds
    v_mfma_f32_16x16x32_bf16 v[156:159], v[16:19], v[108:111], v[156:159]
    ds_read_b64_tr_b16 v[102:103], v125 offset:8448
    v_mfma_f32_16x16x32_bf16 v[180:183], v[20:23], v[108:111], v[180:183]
    ds_read_b64_tr_b16 v[104:105], v124 offset:10240
    v_mfma_f32_16x16x32_bf16 v[184:187], v[112:115], v[24:27], v[184:187]
    ds_read_b64_tr_b16 v[106:107], v124 offset:10496
    v_mfma_f32_16x16x32_bf16 v[188:191], v[116:119], v[24:27], v[188:191]
    ds_read_b64_tr_b16 v[108:109], v125 offset:10240
    v_mfma_f32_16x16x32_bf16 v[48:51], v[16:19], v[16:19], v[48:51]
    ds_read_b64_tr_b16 v[110:111], v125 offset:10496
    s_add_u32 m0, s52, 3072
    s_mov_b32 s73, 15104
    buffer_load_dwordx4 v121, s[8:11], s73 offen lds
    v_mfma_f32_16x16x32_bf16 v[52:55], v[20:23], v[20:23], v[52:55]
    ds_read_b64_tr_b16 v[112:113], v126 offset:6144
    v_mfma_f32_16x16x32_bf16 v[56:59], v[24:27], v[24:27], v[56:59]
    ds_read_b64_tr_b16 v[114:115], v126 offset:6400
    v_mfma_f32_16x16x32_bf16 v[60:63], v[40:43], v[16:19], v[60:63]
    ds_read_b64_tr_b16 v[116:117], v127 offset:6144
    v_mfma_f32_16x16x32_bf16 v[64:67], v[40:43], v[20:23], v[64:67]
    ds_read_b64_tr_b16 v[118:119], v127 offset:6400
    v_mfma_f32_16x16x32_bf16 v[68:71], v[40:43], v[24:27], v[68:71]
    s_add_u32 m0, s7, 61440
    s_mov_b32 s73, 768
    s_mov_b64 exec, s[54:55]
    buffer_load_dwordx4 v122, s[8:11], s73 offen lds
    s_mov_b64 exec, -1
    v_mov_b32 v7, 0
    buffer_load_dword v6, v7, s[44:47], 0 offen sc1
    s_lshr_b32 s68, s2, 3
    s_lshl_b32 s68, s68, 2
    s_add_u32 s68, s68, s3
    v_lshlrev_b32 v219, 7, v1
    s_mul_i32 s86, s68, 3200
    s_mov_b64 exec, 0x1ffffff
    buffer_load_dword v234, v219, s[16:19], s86 offen
    s_mov_b64 exec, -1
    v_lshrrev_b32 v219, 2, v1
    v_mul_u32_u24 v219, 3584, v219
    v_and_b32 v220, 3, v1
    v_lshl_add_u32 v219, v220, 7, v219
    s_mul_i32 s68, s68, 57344
    s_and_b32 s69, s2, 7
    s_mul_i32 s86, s69, 3
    s_add_u32 s86, s86, 4
    s_lshl_b32 s87, s69, 2
    s_min_u32 s86, s86, s87
    s_lshl_b32 s86, s86, 7
    s_add_u32 s86, s86, s68
    s_cmp_lt_u32 s69, 4
    s_cselect_b32 exec_lo, -1, 0x77777777
    s_cselect_b32 exec_hi, -1, 0x77777777
    buffer_load_dword v235, v219, s[20:23], s86 offen
    s_mov_b64 exec, -1
    s_waitcnt vmcnt(11)
    s_barrier
    s_waitcnt lgkmcnt(8)
    v_mfma_f32_16x16x32_bf16 v[136:139], v[88:91], v[28:31], v[136:139]
    ds_read_b128 v[16:19], v128 offset:18432
    v_mfma_f32_16x16x32_bf16 v[160:163], v[88:91], v[32:35], v[160:163]
    ds_read_b128 v[20:23], v128 offset:20480
    v_mfma_f32_16x16x32_bf16 v[140:143], v[92:95], v[28:31], v[140:143]
    ds_read_b128 v[24:27], v130 offset:18432
    v_mfma_f32_16x16x32_bf16 v[164:167], v[92:95], v[32:35], v[164:167]
    ds_read_b64_tr_b16 v[88:89], v124 offset:12288
    v_mfma_f32_16x16x32_bf16 v[144:147], v[96:99], v[28:31], v[144:147]
    ds_read_b64_tr_b16 v[90:91], v124 offset:12544
    v_mfma_f32_16x16x32_bf16 v[168:171], v[96:99], v[32:35], v[168:171]
    ds_read_b64_tr_b16 v[92:93], v125 offset:12288
    v_mfma_f32_16x16x32_bf16 v[148:151], v[100:103], v[28:31], v[148:151]
    ds_read_b64_tr_b16 v[94:95], v125 offset:12544
    v_mfma_f32_16x16x32_bf16 v[172:175], v[100:103], v[32:35], v[172:175]
    ds_read_b64_tr_b16 v[96:97], v124 offset:14336
    s_waitcnt lgkmcnt(8)
    v_mfma_f32_16x16x32_bf16 v[152:155], v[28:31], v[104:107], v[152:155]
    ds_read_b64_tr_b16 v[98:99], v124 offset:14592
    v_mfma_f32_16x16x32_bf16 v[176:179], v[32:35], v[104:107], v[176:179]
    ds_read_b64_tr_b16 v[100:101], v125 offset:14336
    v_mfma_f32_16x16x32_bf16 v[156:159], v[28:31], v[108:111], v[156:159]
    ds_read_b64_tr_b16 v[102:103], v125 offset:14592
    v_mfma_f32_16x16x32_bf16 v[180:183], v[32:35], v[108:111], v[180:183]
    ds_read_b64_tr_b16 v[104:105], v124 offset:16384
    v_mfma_f32_16x16x32_bf16 v[184:187], v[112:115], v[36:39], v[184:187]
    ds_read_b64_tr_b16 v[106:107], v124 offset:16640
    v_mfma_f32_16x16x32_bf16 v[188:191], v[116:119], v[36:39], v[188:191]
    ds_read_b64_tr_b16 v[108:109], v125 offset:16384
    v_mfma_f32_16x16x32_bf16 v[48:51], v[28:31], v[28:31], v[48:51]
    ds_read_b64_tr_b16 v[110:111], v125 offset:16640
    v_mfma_f32_16x16x32_bf16 v[52:55], v[32:35], v[32:35], v[52:55]
    ds_read_b64_tr_b16 v[112:113], v126 offset:12288
    v_mfma_f32_16x16x32_bf16 v[56:59], v[36:39], v[36:39], v[56:59]
    ds_read_b64_tr_b16 v[114:115], v126 offset:12544
    v_mfma_f32_16x16x32_bf16 v[60:63], v[40:43], v[28:31], v[60:63]
    ds_read_b64_tr_b16 v[116:117], v127 offset:12288
    v_mfma_f32_16x16x32_bf16 v[64:67], v[40:43], v[32:35], v[64:67]
    ds_read_b64_tr_b16 v[118:119], v127 offset:12544
    v_mfma_f32_16x16x32_bf16 v[68:71], v[40:43], v[36:39], v[68:71]
    s_waitcnt lgkmcnt(8)
    v_mfma_f32_16x16x32_bf16 v[136:139], v[88:91], v[16:19], v[136:139]
    ds_read_b128 v[28:31], v129 offset:18432
    v_mfma_f32_16x16x32_bf16 v[160:163], v[88:91], v[20:23], v[160:163]
    ds_read_b128 v[32:35], v129 offset:20480
    v_mfma_f32_16x16x32_bf16 v[140:143], v[92:95], v[16:19], v[140:143]
    ds_read_b128 v[36:39], v131 offset:18432
    v_mfma_f32_16x16x32_bf16 v[164:167], v[92:95], v[20:23], v[164:167]
    ds_read_b64_tr_b16 v[88:89], v124 offset:18432
    v_mfma_f32_16x16x32_bf16 v[144:147], v[96:99], v[16:19], v[144:147]
    ds_read_b64_tr_b16 v[90:91], v124 offset:18688
    v_mfma_f32_16x16x32_bf16 v[168:171], v[96:99], v[20:23], v[168:171]
    ds_read_b64_tr_b16 v[92:93], v125 offset:18432
    v_mfma_f32_16x16x32_bf16 v[148:151], v[100:103], v[16:19], v[148:151]
    ds_read_b64_tr_b16 v[94:95], v125 offset:18688
    v_mfma_f32_16x16x32_bf16 v[172:175], v[100:103], v[20:23], v[172:175]
    ds_read_b64_tr_b16 v[96:97], v124 offset:20480
    s_waitcnt lgkmcnt(8)
    v_mfma_f32_16x16x32_bf16 v[152:155], v[16:19], v[104:107], v[152:155]
    ds_read_b64_tr_b16 v[98:99], v124 offset:20736
    v_mfma_f32_16x16x32_bf16 v[176:179], v[20:23], v[104:107], v[176:179]
    ds_read_b64_tr_b16 v[100:101], v125 offset:20480
    v_mfma_f32_16x16x32_bf16 v[156:159], v[16:19], v[108:111], v[156:159]
    ds_read_b64_tr_b16 v[102:103], v125 offset:20736
    v_mfma_f32_16x16x32_bf16 v[180:183], v[20:23], v[108:111], v[180:183]
    ds_read_b64_tr_b16 v[104:105], v124 offset:22528
    v_mfma_f32_16x16x32_bf16 v[184:187], v[112:115], v[24:27], v[184:187]
    ds_read_b64_tr_b16 v[106:107], v124 offset:22784
    v_mfma_f32_16x16x32_bf16 v[188:191], v[116:119], v[24:27], v[188:191]
    ds_read_b64_tr_b16 v[108:109], v125 offset:22528
    v_mfma_f32_16x16x32_bf16 v[48:51], v[16:19], v[16:19], v[48:51]
    ds_read_b64_tr_b16 v[110:111], v125 offset:22784
    v_mfma_f32_16x16x32_bf16 v[52:55], v[20:23], v[20:23], v[52:55]
    ds_read_b64_tr_b16 v[112:113], v126 offset:18432
    v_mfma_f32_16x16x32_bf16 v[56:59], v[24:27], v[24:27], v[56:59]
    ds_read_b64_tr_b16 v[114:115], v126 offset:18688
    v_mfma_f32_16x16x32_bf16 v[60:63], v[40:43], v[16:19], v[60:63]
    ds_read_b64_tr_b16 v[116:117], v127 offset:18432
    v_mfma_f32_16x16x32_bf16 v[64:67], v[40:43], v[20:23], v[64:67]
    ds_read_b64_tr_b16 v[118:119], v127 offset:18688
    v_mfma_f32_16x16x32_bf16 v[68:71], v[40:43], v[24:27], v[68:71]
    s_waitcnt vmcnt(3)
    s_barrier
    s_waitcnt lgkmcnt(8)
    v_mfma_f32_16x16x32_bf16 v[136:139], v[88:91], v[28:31], v[136:139]
    ds_read_b128 v[16:19], v128 offset:0
    v_mfma_f32_16x16x32_bf16 v[160:163], v[88:91], v[32:35], v[160:163]
    ds_read_b128 v[20:23], v128 offset:2048
    v_mfma_f32_16x16x32_bf16 v[140:143], v[92:95], v[28:31], v[140:143]
    ds_read_b128 v[24:27], v130 offset:0
    v_mfma_f32_16x16x32_bf16 v[164:167], v[92:95], v[32:35], v[164:167]
    ds_read_b64_tr_b16 v[88:89], v124 offset:24576
    v_mfma_f32_16x16x32_bf16 v[144:147], v[96:99], v[28:31], v[144:147]
    ds_read_b64_tr_b16 v[90:91], v124 offset:24832
    v_mfma_f32_16x16x32_bf16 v[168:171], v[96:99], v[32:35], v[168:171]
    ds_read_b64_tr_b16 v[92:93], v125 offset:24576
    v_mfma_f32_16x16x32_bf16 v[148:151], v[100:103], v[28:31], v[148:151]
    ds_read_b64_tr_b16 v[94:95], v125 offset:24832
    v_mfma_f32_16x16x32_bf16 v[172:175], v[100:103], v[32:35], v[172:175]
    ds_read_b64_tr_b16 v[96:97], v124 offset:26624
    s_waitcnt lgkmcnt(8)
    v_mfma_f32_16x16x32_bf16 v[152:155], v[28:31], v[104:107], v[152:155]
    ds_read_b64_tr_b16 v[98:99], v124 offset:26880
    v_mfma_f32_16x16x32_bf16 v[176:179], v[32:35], v[104:107], v[176:179]
    ds_read_b64_tr_b16 v[100:101], v125 offset:26624
    v_mfma_f32_16x16x32_bf16 v[156:159], v[28:31], v[108:111], v[156:159]
    ds_read_b64_tr_b16 v[102:103], v125 offset:26880
    v_mfma_f32_16x16x32_bf16 v[180:183], v[32:35], v[108:111], v[180:183]
    ds_read_b64_tr_b16 v[104:105], v124 offset:28672
    v_mfma_f32_16x16x32_bf16 v[184:187], v[112:115], v[36:39], v[184:187]
    ds_read_b64_tr_b16 v[106:107], v124 offset:28928
    v_mfma_f32_16x16x32_bf16 v[188:191], v[116:119], v[36:39], v[188:191]
    ds_read_b64_tr_b16 v[108:109], v125 offset:28672
    v_mfma_f32_16x16x32_bf16 v[48:51], v[28:31], v[28:31], v[48:51]
    ds_read_b64_tr_b16 v[110:111], v125 offset:28928
    v_mfma_f32_16x16x32_bf16 v[52:55], v[32:35], v[32:35], v[52:55]
    ds_read_b64_tr_b16 v[112:113], v126 offset:24576
    v_mfma_f32_16x16x32_bf16 v[56:59], v[36:39], v[36:39], v[56:59]
    ds_read_b64_tr_b16 v[114:115], v126 offset:24832
    v_mfma_f32_16x16x32_bf16 v[60:63], v[40:43], v[28:31], v[60:63]
    ds_read_b64_tr_b16 v[116:117], v127 offset:24576
    v_mfma_f32_16x16x32_bf16 v[64:67], v[40:43], v[32:35], v[64:67]
    ds_read_b64_tr_b16 v[118:119], v127 offset:24832
    v_mfma_f32_16x16x32_bf16 v[68:71], v[40:43], v[36:39], v[68:71]
    s_waitcnt lgkmcnt(8)
    v_mfma_f32_16x16x32_bf16 v[136:139], v[88:91], v[16:19], v[136:139]
    ds_read_b128 v[28:31], v129 offset:0
    v_mfma_f32_16x16x32_bf16 v[160:163], v[88:91], v[20:23], v[160:163]
    ds_read_b128 v[32:35], v129 offset:2048
    v_mfma_f32_16x16x32_bf16 v[140:143], v[92:95], v[16:19], v[140:143]
    ds_read_b128 v[36:39], v131 offset:0
    v_mfma_f32_16x16x32_bf16 v[164:167], v[92:95], v[20:23], v[164:167]
    ds_read_b64_tr_b16 v[88:89], v124 offset:30720
    v_mfma_f32_16x16x32_bf16 v[144:147], v[96:99], v[16:19], v[144:147]
    ds_read_b64_tr_b16 v[90:91], v124 offset:30976
    v_mfma_f32_16x16x32_bf16 v[168:171], v[96:99], v[20:23], v[168:171]
    ds_read_b64_tr_b16 v[92:93], v125 offset:30720
    v_mfma_f32_16x16x32_bf16 v[148:151], v[100:103], v[16:19], v[148:151]
    ds_read_b64_tr_b16 v[94:95], v125 offset:30976
    v_mfma_f32_16x16x32_bf16 v[172:175], v[100:103], v[20:23], v[172:175]
    ds_read_b64_tr_b16 v[96:97], v124 offset:32768
    s_waitcnt lgkmcnt(8)
    v_mfma_f32_16x16x32_bf16 v[152:155], v[16:19], v[104:107], v[152:155]
    ds_read_b64_tr_b16 v[98:99], v124 offset:33024
    v_mfma_f32_16x16x32_bf16 v[176:179], v[20:23], v[104:107], v[176:179]
    ds_read_b64_tr_b16 v[100:101], v125 offset:32768
    v_mfma_f32_16x16x32_bf16 v[156:159], v[16:19], v[108:111], v[156:159]
    ds_read_b64_tr_b16 v[102:103], v125 offset:33024
    v_mfma_f32_16x16x32_bf16 v[180:183], v[20:23], v[108:111], v[180:183]
    ds_read_b64_tr_b16 v[104:105], v124 offset:34816
    v_mfma_f32_16x16x32_bf16 v[184:187], v[112:115], v[24:27], v[184:187]
    ds_read_b64_tr_b16 v[106:107], v124 offset:35072
    v_mfma_f32_16x16x32_bf16 v[188:191], v[116:119], v[24:27], v[188:191]
    ds_read_b64_tr_b16 v[108:109], v125 offset:34816
    v_mfma_f32_16x16x32_bf16 v[48:51], v[16:19], v[16:19], v[48:51]
    ds_read_b64_tr_b16 v[110:111], v125 offset:35072
    v_mfma_f32_16x16x32_bf16 v[52:55], v[20:23], v[20:23], v[52:55]
    ds_read_b64_tr_b16 v[112:113], v126 offset:30720
    v_mfma_f32_16x16x32_bf16 v[56:59], v[24:27], v[24:27], v[56:59]
    ds_read_b64_tr_b16 v[114:115], v126 offset:30976
    v_mfma_f32_16x16x32_bf16 v[60:63], v[40:43], v[16:19], v[60:63]
    ds_read_b64_tr_b16 v[116:117], v127 offset:30720
    v_mfma_f32_16x16x32_bf16 v[64:67], v[40:43], v[20:23], v[64:67]
    ds_read_b64_tr_b16 v[118:119], v127 offset:30976
    v_mfma_f32_16x16x32_bf16 v[68:71], v[40:43], v[24:27], v[68:71]
    s_waitcnt lgkmcnt(9)
    v_mfma_f32_16x16x32_bf16 v[48:51], v[28:31], v[28:31], v[48:51]
    v_mfma_f32_16x16x32_bf16 v[52:55], v[32:35], v[32:35], v[52:55]
    v_mfma_f32_16x16x32_bf16 v[56:59], v[36:39], v[36:39], v[56:59]
    v_mfma_f32_16x16x32_bf16 v[60:63], v[40:43], v[28:31], v[60:63]
    v_mfma_f32_16x16x32_bf16 v[64:67], v[40:43], v[32:35], v[64:67]
    v_mfma_f32_16x16x32_bf16 v[68:71], v[40:43], v[36:39], v[68:71]
    s_waitcnt lgkmcnt(2)
    v_mfma_f32_16x16x32_bf16 v[184:187], v[112:115], v[36:39], v[184:187]
    s_waitcnt lgkmcnt(0)
    v_mfma_f32_16x16x32_bf16 v[188:191], v[116:119], v[36:39], v[188:191]
    v_mfma_f32_16x16x32_bf16 v[144:147], v[96:99], v[28:31], v[144:147]
    v_cndmask_b32 v48, v48, v49, s[88:89]
    v_cndmask_b32 v52, v52, v53, s[88:89]
    v_cndmask_b32 v56, v56, v57, s[88:89]
    v_mfma_f32_16x16x32_bf16 v[168:171], v[96:99], v[32:35], v[168:171]
    v_cndmask_b32 v48, v48, v50, s[90:91]
    v_cndmask_b32 v52, v52, v54, s[90:91]
    v_cndmask_b32 v56, v56, v58, s[90:91]
    v_mfma_f32_16x16x32_bf16 v[148:151], v[100:103], v[28:31], v[148:151]
    v_cndmask_b32 v48, v48, v51, s[92:93]
    v_cndmask_b32 v52, v52, v55, s[92:93]
    v_cndmask_b32 v56, v56, v59, s[92:93]
    v_mfma_f32_16x16x32_bf16 v[172:175], v[100:103], v[32:35], v[172:175]
    v_mul_f32 v133, 0x3b124925, v60
    v_mul_f32 v135, 0x3b124925, v64
    v_mul_f32 v85, 0x3b124925, v68
    v_mfma_f32_16x16x32_bf16 v[152:155], v[28:31], v[104:107], v[152:155]
    v_mul_f32 v132, v133, v133
    v_mul_f32 v134, v135, v135
    v_mul_f32 v84, v85, v85
    v_mfma_f32_16x16x32_bf16 v[176:179], v[32:35], v[104:107], v[176:179]
    v_mul_f32 v48, 0x3b124925, v48
    v_mul_f32 v52, 0x3b124925, v52
    v_mul_f32 v56, 0x3b124925, v56
    v_mfma_f32_16x16x32_bf16 v[156:159], v[28:31], v[108:111], v[156:159]
    s_mov_b32 exec_lo, 0x00010001
    s_mov_b32 exec_hi, 0x00010001
    ds_write_b128 v73, v[184:187] offset:128
    ds_write_b128 v74, v[188:191] offset:0
    s_mov_b64 exec, -1
    v_sub_f32 v132, v48, v132
    v_sub_f32_e64 v134, v52, v134
    v_mfma_f32_16x16x32_bf16 v[180:183], v[32:35], v[108:111], v[180:183]
    v_sub_f32 v84, v56, v84
    v_max_f32 v132, 0, v132
    v_max_f32_e64 v134, 0, v134
    v_mfma_f32_16x16x32_bf16 v[136:139], v[88:91], v[28:31], v[136:139]
    v_max_f32_e64 v84, 0, v84
    v_add_f32 v132, 0x3727c5ac, v132
    v_add_f32 v134, 0x3727c5ac, v134
    v_mfma_f32_16x16x32_bf16 v[160:163], v[88:91], v[32:35], v[160:163]
    v_add_f32 v84, 0x3727c5ac, v84
    v_rsq_f32 v132, v132
    v_rsq_f32 v134, v134
    v_mfma_f32_16x16x32_bf16 v[140:143], v[92:95], v[28:31], v[140:143]
    v_rsq_f32_e64 v84, v84
    s_mov_b32 exec_lo, 0x00f0000f
    s_mov_b32 exec_hi, 0xf0000f00
    ds_write2_b32 v75, v132, v133 offset0:128 offset1:144
    ds_write2_b32 v75, v134, v135 offset0:160 offset1:176
    ds_write2_b32 v75, v84, v85 offset0:192 offset1:208
    s_mov_b64 exec, -1
    v_mov_b32_dpp v224, v184 row_newbcast:0 row_mask:0xf bank_mask:0xf
    v_mfma_f32_16x16x32_bf16 v[164:167], v[92:95], v[32:35], v[164:167]
    v_mov_b32_dpp v225, v185 row_newbcast:0 row_mask:0xf bank_mask:0xf
    v_mov_b32_dpp v226, v186 row_newbcast:0 row_mask:0xf bank_mask:0xf
    v_mov_b32_dpp v227, v187 row_newbcast:0 row_mask:0xf bank_mask:0xf
    v_fma_f32 v224, -v224, v85, v184
    v_fma_f32 v225, -v225, v85, v185
    v_fma_f32 v226, -v226, v85, v186
    v_fma_f32 v227, -v227, v85, v187
    s_cmp_eq_u32 s49, 15
    s_cselect_b32 s88, 0xffff0000, -1
    s_mov_b32 s89, -1
    s_mov_b32 s90, -1
    s_cselect_b32 s91, -1, 0xffff
    s_waitcnt lgkmcnt(0)
    s_barrier
    ds_read_b32 v134, v75 offset:640
    ds_read_b32 v84, v75 offset:768
    ds_read_b32 v132, v75 offset:512
    ds_read_b128 v[56:59], v72 offset:128
    ds_read_b128 v[60:63], v72 offset:192
    ds_read_b32 v64, v77 offset:256
    ds_read_b32 v65, v77 offset:320
    ds_read_b128 v[44:47], v76 offset:704
    ds_read_b128 v[40:43], v76 offset:640
    ds_read_b128 v[36:39], v76 offset:576
    ds_read_b128 v[32:35], v76 offset:512
    ds_read_b128 v[48:51], v72 offset:0
    ds_read_b128 v[52:55], v72 offset:64
    s_waitcnt lgkmcnt(9)
    v_pk_fma_f32 v[168:169], v[56:57], v[134:135], v[168:169] op_sel:[0,1,0] op_sel_hi:[1,1,1] neg_lo:[0,1,0] neg_hi:[0,1,0]
    v_pk_fma_f32 v[170:171], v[58:59], v[134:135], v[170:171] op_sel:[0,1,0] op_sel_hi:[1,1,1] neg_lo:[0,1,0] neg_hi:[0,1,0]
    v_pk_mul_f32 v[168:169], v[168:169], v[134:135] op_sel:[0,0] op_sel_hi:[1,0]
    v_pk_mul_f32 v[170:171], v[170:171], v[134:135] op_sel:[0,0] op_sel_hi:[1,0]
    v_cvt_pk_bf16_f32 v104, v168, v169
    v_cvt_pk_bf16_f32 v105, v170, v171
    s_waitcnt lgkmcnt(8)
    v_pk_fma_f32 v[172:173], v[60:61], v[134:135], v[172:173] op_sel:[0,1,0] op_sel_hi:[1,1,1] neg_lo:[0,1,0] neg_hi:[0,1,0]
    v_pk_fma_f32 v[174:175], v[62:63], v[134:135], v[174:175] op_sel:[0,1,0] op_sel_hi:[1,1,1] neg_lo:[0,1,0] neg_hi:[0,1,0]
    v_pk_mul_f32 v[172:173], v[172:173], v[134:135] op_sel:[0,0] op_sel_hi:[1,0]
    v_pk_mul_f32 v[174:175], v[174:175], v[134:135] op_sel:[0,0] op_sel_hi:[1,0]
    v_cvt_pk_bf16_f32 v106, v172, v173
    v_cvt_pk_bf16_f32 v107, v174, v175
    ds_write_b128 v78, v[104:107] offset:4096
    v_pk_mul_f32 v[224:225], v[224:225], v[84:85] op_sel_hi:[1,0]
    v_pk_mul_f32 v[226:227], v[226:227], v[84:85] op_sel_hi:[1,0]
    v_cvt_pk_bf16_f32 v224, v224, v225
    v_cvt_pk_bf16_f32 v226, v226, v227
    ds_write_b16 v80, v224 offset:2048
    ds_write_b16_d16_hi v81, v224 offset:2048
    ds_write_b16 v82, v226 offset:2048
    ds_write_b16_d16_hi v83, v226 offset:2048
    s_waitcnt lgkmcnt(10)
    v_pk_fma_f32 v[176:177], v[44:45], v[64:65], v[176:177] op_sel:[0,0,0] op_sel_hi:[1,0,1] neg_lo:[0,1,0] neg_hi:[0,1,0]
    v_pk_fma_f32 v[178:179], v[46:47], v[64:65], v[178:179] op_sel:[0,0,0] op_sel_hi:[1,0,1] neg_lo:[0,1,0] neg_hi:[0,1,0]
    s_waitcnt lgkmcnt(9)
    v_pk_mul_f32 v[176:177], v[176:177], v[40:41]
    v_pk_mul_f32 v[178:179], v[178:179], v[42:43]
    v_cvt_pk_bf16_f32 v112, v176, v177
    v_cvt_pk_bf16_f32 v113, v178, v179
    v_pk_fma_f32 v[180:181], v[44:45], v[64:65], v[180:181] op_sel:[0,1,0] op_sel_hi:[1,1,1] neg_lo:[0,1,0] neg_hi:[0,1,0]
    v_pk_fma_f32 v[182:183], v[46:47], v[64:65], v[182:183] op_sel:[0,1,0] op_sel_hi:[1,1,1] neg_lo:[0,1,0] neg_hi:[0,1,0]
    v_pk_mul_f32 v[180:181], v[180:181], v[40:41]
    v_pk_mul_f32 v[182:183], v[182:183], v[42:43]
    v_cvt_pk_bf16_f32 v118, v180, v181
    v_cvt_pk_bf16_f32 v119, v182, v183
    ds_write_b64 v78, v[112:113] offset:5120
    ds_write_b64 v78, v[118:119] offset:5128
    v_mul_f32 v68, 0x3e8b97f6, v132
    v_mul_f32 v70, 0x3e8b97f6, v134
    v_cndmask_b32 v69, 0, v68, s[90:91]
    v_cndmask_b32 v68, 0, v68, s[88:89]
    v_cndmask_b32 v71, 0, v70, s[90:91]
    v_cndmask_b32 v70, 0, v70, s[88:89]
    v_pk_fma_f32 v[144:145], v[56:57], v[132:133], v[144:145] op_sel:[0,1,0] op_sel_hi:[1,1,1] neg_lo:[0,1,0] neg_hi:[0,1,0]
    v_pk_fma_f32 v[146:147], v[58:59], v[132:133], v[146:147] op_sel:[0,1,0] op_sel_hi:[1,1,1] neg_lo:[0,1,0] neg_hi:[0,1,0]
    v_pk_mul_f32 v[144:145], v[144:145], v[132:133] op_sel:[0,0] op_sel_hi:[1,0]
    v_pk_mul_f32 v[146:147], v[146:147], v[132:133] op_sel:[0,0] op_sel_hi:[1,0]
    v_cvt_pk_bf16_f32 v100, v144, v145
    v_cvt_pk_bf16_f32 v101, v146, v147
    v_pk_fma_f32 v[148:149], v[60:61], v[132:133], v[148:149] op_sel:[0,1,0] op_sel_hi:[1,1,1] neg_lo:[0,1,0] neg_hi:[0,1,0]
    v_pk_fma_f32 v[150:151], v[62:63], v[132:133], v[150:151] op_sel:[0,1,0] op_sel_hi:[1,1,1] neg_lo:[0,1,0] neg_hi:[0,1,0]
    v_pk_mul_f32 v[148:149], v[148:149], v[132:133] op_sel:[0,0] op_sel_hi:[1,0]
    v_pk_mul_f32 v[150:151], v[150:151], v[132:133] op_sel:[0,0] op_sel_hi:[1,0]
    v_cvt_pk_bf16_f32 v102, v148, v149
    v_cvt_pk_bf16_f32 v103, v150, v151
    s_waitcnt lgkmcnt(0)
    s_barrier
    ds_read_b128 v[96:99], v78 offset:2048
    ds_read_b64 v[108:109], v78 offset:3072
    ds_read_b64 v[114:115], v78 offset:3080
    v_pk_fma_f32 v[160:161], v[48:49], v[134:135], v[160:161] op_sel:[0,1,0] op_sel_hi:[1,1,1] neg_lo:[0,1,0] neg_hi:[0,1,0]
    v_pk_fma_f32 v[162:163], v[50:51], v[134:135], v[162:163] op_sel:[0,1,0] op_sel_hi:[1,1,1] neg_lo:[0,1,0] neg_hi:[0,1,0]
    v_pk_mul_f32 v[160:161], v[160:161], v[70:71] op_sel:[0,0] op_sel_hi:[1,0]
    v_pk_mul_f32 v[162:163], v[162:163], v[70:71] op_sel:[0,0] op_sel_hi:[1,0]
    v_cvt_pk_bf16_f32 v92, v160, v161
    v_cvt_pk_bf16_f32 v93, v162, v163
    v_pk_fma_f32 v[164:165], v[52:53], v[134:135], v[164:165] op_sel:[0,1,0] op_sel_hi:[1,1,1] neg_lo:[0,1,0] neg_hi:[0,1,0]
    v_pk_fma_f32 v[166:167], v[54:55], v[134:135], v[166:167] op_sel:[0,1,0] op_sel_hi:[1,1,1] neg_lo:[0,1,0] neg_hi:[0,1,0]
    v_pk_mul_f32 v[164:165], v[164:165], v[70:71] op_sel:[0,1] op_sel_hi:[1,1]
    v_pk_mul_f32 v[166:167], v[166:167], v[70:71] op_sel:[0,1] op_sel_hi:[1,1]
    v_cvt_pk_bf16_f32 v94, v164, v165
    v_cvt_pk_bf16_f32 v95, v166, v167
    s_nop 1
    v_mfma_f32_16x16x32_bf16 v[24:27], v[100:103], v[92:95], v[240:243]
    v_mfma_f32_16x16x32_bf16 v[28:31], v[104:107], v[92:95], v[244:247]
    v_pk_fma_f32 v[136:137], v[48:49], v[132:133], v[136:137] op_sel:[0,1,0] op_sel_hi:[1,1,1] neg_lo:[0,1,0] neg_hi:[0,1,0]
    v_pk_fma_f32 v[138:139], v[50:51], v[132:133], v[138:139] op_sel:[0,1,0] op_sel_hi:[1,1,1] neg_lo:[0,1,0] neg_hi:[0,1,0]
    v_pk_mul_f32 v[136:137], v[136:137], v[68:69] op_sel:[0,0] op_sel_hi:[1,0]
    v_pk_mul_f32 v[138:139], v[138:139], v[68:69] op_sel:[0,0] op_sel_hi:[1,0]
    v_cvt_pk_bf16_f32 v88, v136, v137
    v_cvt_pk_bf16_f32 v89, v138, v139
    v_pk_fma_f32 v[140:141], v[52:53], v[132:133], v[140:141] op_sel:[0,1,0] op_sel_hi:[1,1,1] neg_lo:[0,1,0] neg_hi:[0,1,0]
    v_pk_fma_f32 v[142:143], v[54:55], v[132:133], v[142:143] op_sel:[0,1,0] op_sel_hi:[1,1,1] neg_lo:[0,1,0] neg_hi:[0,1,0]
    v_pk_mul_f32 v[140:141], v[140:141], v[68:69] op_sel:[0,1] op_sel_hi:[1,1]
    v_pk_mul_f32 v[142:143], v[142:143], v[68:69] op_sel:[0,1] op_sel_hi:[1,1]
    v_cvt_pk_bf16_f32 v90, v140, v141
    v_cvt_pk_bf16_f32 v91, v142, v143
    s_waitcnt lgkmcnt(2)
    s_nop 0
    v_mfma_f32_16x16x32_bf16 v[16:19], v[96:99], v[88:91], v[248:251]
    v_mfma_f32_16x16x32_bf16 v[20:23], v[100:103], v[88:91], v[244:247]
    v_pk_fma_f32 v[152:153], v[36:37], v[64:65], v[152:153] op_sel:[0,0,0] op_sel_hi:[1,0,1] neg_lo:[0,1,0] neg_hi:[0,1,0]
    v_pk_fma_f32 v[154:155], v[38:39], v[64:65], v[154:155] op_sel:[0,0,0] op_sel_hi:[1,0,1] neg_lo:[0,1,0] neg_hi:[0,1,0]
    v_pk_mul_f32 v[152:153], v[152:153], v[32:33]
    v_pk_mul_f32 v[154:155], v[154:155], v[34:35]
    v_cvt_pk_bf16_f32 v110, v152, v153
    v_cvt_pk_bf16_f32 v111, v154, v155
    v_pk_fma_f32 v[156:157], v[36:37], v[64:65], v[156:157] op_sel:[0,1,0] op_sel_hi:[1,1,1] neg_lo:[0,1,0] neg_hi:[0,1,0]
    v_pk_fma_f32 v[158:159], v[38:39], v[64:65], v[158:159] op_sel:[0,1,0] op_sel_hi:[1,1,1] neg_lo:[0,1,0] neg_hi:[0,1,0]
    v_pk_mul_f32 v[156:157], v[156:157], v[32:33]
    v_pk_mul_f32 v[158:159], v[158:159], v[34:35]
    v_cvt_pk_bf16_f32 v116, v156, v157
    v_cvt_pk_bf16_f32 v117, v158, v159
    v_max3_f32 v137, v24, v25, v26
    v_max3_f32 v139, v27, v28, v29
    v_max3_f32 v137, v137, v30, v31
    v_max_f32 v137, v137, v139
    v_max3_f32 v136, v16, v17, v18
    v_max3_f32 v138, v19, v20, v21
    v_max3_f32 v136, v136, v22, v23
    v_max_f32 v136, v136, v138
    v_mov_b32 v138, v136
    v_mov_b32 v139, v137
    s_nop 0
    v_permlane32_swap_b32 v136, v138
    v_permlane32_swap_b32 v137, v139
    v_max_f32 v136, v136, v138
    v_max_f32 v137, v137, v139
    v_mov_b32 v138, v136
    v_mov_b32 v139, v137
    s_nop 0
    v_permlane16_swap_b32 v136, v138
    v_permlane16_swap_b32 v137, v139
    v_max_f32 v136, v136, v138
    v_max_f32_e64 v137, v137, v139
    v_pk_add_f32 v[24:25], v[24:25], v[136:137] op_sel:[0,1] op_sel_hi:[1,1] neg_lo:[0,1] neg_hi:[0,1]
    v_pk_add_f32 v[26:27], v[26:27], v[136:137] op_sel:[0,1] op_sel_hi:[1,1] neg_lo:[0,1] neg_hi:[0,1]
    v_pk_add_f32 v[28:29], v[28:29], v[136:137] op_sel:[0,1] op_sel_hi:[1,1] neg_lo:[0,1] neg_hi:[0,1]
    v_pk_add_f32 v[30:31], v[30:31], v[136:137] op_sel:[0,1] op_sel_hi:[1,1] neg_lo:[0,1] neg_hi:[0,1]
    v_exp_f32 v24, v24
    v_exp_f32 v25, v25
    v_exp_f32 v26, v26
    v_exp_f32 v27, v27
    v_exp_f32 v28, v28
    v_exp_f32 v29, v29
    v_exp_f32_e64 v30, v30
    v_exp_f32 v31, v31
    v_cvt_pk_bf16_f32 v148, v24, v25
    v_cvt_pk_bf16_f32 v149, v26, v27
    v_cvt_pk_bf16_f32 v150, v28, v29
    v_cvt_pk_bf16_f32 v151, v30, v31
    s_nop 1
    v_mfma_f32_16x16x32_bf16 v[160:163], v[110:113], v[148:151], 0
    v_mfma_f32_16x16x32_bf16 v[164:167], v[116:119], v[148:151], 0
    v_pk_add_f32 v[16:17], v[16:17], v[136:137] op_sel:[0,0] op_sel_hi:[1,0] neg_lo:[0,1] neg_hi:[0,1]
    v_pk_add_f32 v[18:19], v[18:19], v[136:137] op_sel:[0,0] op_sel_hi:[1,0] neg_lo:[0,1] neg_hi:[0,1]
    v_pk_add_f32 v[20:21], v[20:21], v[136:137] op_sel:[0,0] op_sel_hi:[1,0] neg_lo:[0,1] neg_hi:[0,1]
    v_pk_add_f32 v[22:23], v[22:23], v[136:137] op_sel:[0,0] op_sel_hi:[1,0] neg_lo:[0,1] neg_hi:[0,1]
    v_exp_f32 v16, v16
    v_exp_f32 v17, v17
    v_exp_f32 v18, v18
    v_exp_f32 v19, v19
    v_exp_f32 v20, v20
    v_exp_f32 v21, v21
    v_exp_f32_e64 v22, v22
    v_exp_f32 v23, v23
    v_cvt_pk_bf16_f32 v144, v16, v17
    v_cvt_pk_bf16_f32 v145, v18, v19
    v_cvt_pk_bf16_f32 v146, v20, v21
    v_cvt_pk_bf16_f32 v147, v22, v23
    s_waitcnt lgkmcnt(1)
    s_nop 0
    v_mfma_f32_16x16x32_bf16 v[152:155], v[108:111], v[144:147], 0
    s_waitcnt lgkmcnt(0)
    v_mfma_f32_16x16x32_bf16 v[156:159], v[114:117], v[144:147], 0
    v_pk_add_f32 v[16:17], v[16:17], v[18:19]
    v_pk_add_f32 v[20:21], v[20:21], v[22:23]
    v_pk_add_f32 v[24:25], v[24:25], v[26:27]
    v_pk_add_f32 v[28:29], v[28:29], v[30:31]
    v_pk_add_f32 v[16:17], v[16:17], v[20:21]
    v_pk_add_f32 v[24:25], v[24:25], v[28:29]
    v_add_f32 v140, v16, v17
    v_add_f32 v142, v24, v25
    v_mov_b32 v138, v140
    v_mov_b32 v139, v142
    s_nop 0
    v_permlane32_swap_b32 v140, v138
    v_permlane32_swap_b32 v142, v139
    v_add_f32 v140, v140, v138
    v_add_f32 v142, v142, v139
    v_mov_b32 v138, v140
    v_mov_b32 v139, v142
    s_nop 0
    v_permlane16_swap_b32 v140, v138
    v_permlane16_swap_b32 v142, v139
    v_add_f32 v140, v140, v138
    v_add_f32 v142, v142, v139
    v_rcp_f32 v140, v140
    v_rcp_f32 v142, v142
    v_cndmask_b32 v141, 0, v140, s[90:91]
    v_cndmask_b32 v140, 0, v140, s[88:89]
    v_cndmask_b32 v143, 0, v142, s[90:91]
    v_cndmask_b32 v142, 0, v142, s[88:89]
    v_pk_mul_f32 v[152:153], v[152:153], v[140:141] op_sel_hi:[1,0]
    v_pk_mul_f32 v[154:155], v[154:155], v[140:141] op_sel_hi:[1,0]
    v_pk_mul_f32 v[156:157], v[156:157], v[140:141] op_sel:[0,1] op_sel_hi:[1,1]
    v_pk_mul_f32 v[158:159], v[158:159], v[140:141] op_sel:[0,1] op_sel_hi:[1,1]
    v_cvt_pk_bf16_f32 v144, v152, v153
    v_cvt_pk_bf16_f32 v145, v154, v155
    v_cvt_pk_bf16_f32 v146, v156, v157
    v_cvt_pk_bf16_f32 v147, v158, v159
    buffer_store_dwordx4 v[144:147], v4, s[40:43], s62 offen sc1
    v_pk_mul_f32 v[160:161], v[160:161], v[142:143] op_sel_hi:[1,0]
    v_pk_mul_f32 v[162:163], v[162:163], v[142:143] op_sel_hi:[1,0]
    v_pk_mul_f32 v[164:165], v[164:165], v[142:143] op_sel:[0,1] op_sel_hi:[1,1]
    v_pk_mul_f32 v[166:167], v[166:167], v[142:143] op_sel:[0,1] op_sel_hi:[1,1]
    v_cvt_pk_bf16_f32 v148, v160, v161
    v_cvt_pk_bf16_f32 v149, v162, v163
    v_cvt_pk_bf16_f32 v150, v164, v165
    v_cvt_pk_bf16_f32 v151, v166, v167
    buffer_store_dwordx4 v[148:151], v4, s[40:43], s63 offen sc1
    s_add_u32 m0, s59, 0
    s_mov_b32 s73, 0
    buffer_load_dwordx4 v208, s[16:19], s73 offen lds
    s_add_u32 m0, s59, 1024
    s_mov_b32 s73, 7168
    buffer_load_dwordx4 v208, s[16:19], s73 offen lds
    s_add_u32 m0, s59, 2048
    s_mov_b32 s73, 14336
    buffer_load_dwordx4 v208, s[16:19], s73 offen lds
    s_add_u32 m0, s59, 3072
    s_mov_b32 s73, 21504
    buffer_load_dwordx4 v208, s[16:19], s73 offen lds
    s_add_u32 m0, s59, 4096
    s_mov_b32 s73, 28672
    buffer_load_dwordx4 v208, s[16:19], s73 offen lds
    s_add_u32 m0, s59, 5120
    s_mov_b32 s73, 35840
    buffer_load_dwordx4 v208, s[16:19], s73 offen lds
    s_add_u32 m0, s59, 6144
    s_mov_b32 s73, 43008
    buffer_load_dwordx4 v208, s[16:19], s73 offen lds
    s_add_u32 m0, s59, 7168
    s_mov_b32 s73, 50176
    buffer_load_dwordx4 v208, s[16:19], s73 offen lds
    s_add_u32 m0, s59, 8192
    s_mov_b32 s73, 57344
    buffer_load_dwordx4 v208, s[16:19], s73 offen lds
    s_add_u32 m0, s59, 9216
    s_mov_b32 s73, 64512
    buffer_load_dwordx4 v208, s[16:19], s73 offen lds
    s_add_u32 m0, s59, 10240
    s_mov_b32 s73, 71680
    buffer_load_dwordx4 v208, s[16:19], s73 offen lds
    s_add_u32 m0, s59, 11264
    s_mov_b32 s73, 78848
    buffer_load_dwordx4 v208, s[16:19], s73 offen lds
    s_add_u32 m0, s59, 12288
    s_mov_b32 s73, 86016
    buffer_load_dwordx4 v208, s[16:19], s73 offen lds
    s_add_u32 m0, s59, 13312
    s_mov_b32 s73, 93184
    buffer_load_dwordx4 v208, s[16:19], s73 offen lds
    s_waitcnt vmcnt(18)
    v_readfirstlane_b32 s4, v6
    s_nop 1
    s_cmp_lg_u32 s4, 0
    s_cbranch_scc1 Lepd_P_2
    s_nop 0
Lepg_P_1:
    s_sub_u32 s6, s6, 1
    s_cbranch_scc1 L_end_P
    buffer_load_dword v6, v7, s[44:47], 0 offen sc1
    s_waitcnt vmcnt(0)
    v_readfirstlane_b32 s4, v6
    s_nop 1
    s_cmp_eq_u32 s4, 0
    s_cbranch_scc1 Lepg_P_1
Lepd_P_2:
    s_waitcnt vmcnt(14)
    v_mov_b32 v8, s4
    s_mov_b64 exec, 1
    buffer_store_dword v8, v9, s[40:43], s80 offen sc1
    s_mov_b64 exec, -1
    s_cmp_lt_u32 s67, 99
    s_cbranch_scc1 Lnotag_P_3
    s_lshr_b32 s68, s2, 3
    s_sub_u32 s68, s68, 28
    s_lshl_b32 s68, s68, 2
    s_add_u32 s68, s68, s3
    s_lshl_b32 s68, s68, 16
    s_and_b32 s69, s2, 7
    s_lshl_b32 s69, s69, 9
    s_add_u32 s68, s68, s69
    v_lshrrev_b32 v16, 2, v1
    v_lshlrev_b32 v16, 12, v16
    v_and_b32_e64 v17, 3, v1
    v_lshl_add_u32 v16, v17, 7, v16
    buffer_load_dword v18, v16, s[24:27], s68 offen
    s_add_u32 s68, s68, 0x100000
    s_waitcnt vmcnt(1)
    buffer_load_dword v19, v16, s[24:27], s68 offen
    s_add_u32 s68, s68, 0x100000
    s_waitcnt vmcnt(1)
    buffer_load_dword v20, v16, s[24:27], s68 offen
    s_add_u32 s68, s68, 0x100000
    s_waitcnt vmcnt(1)
    buffer_load_dword v21, v16, s[24:27], s68 offen
    s_add_u32 s68, s68, 0x100000
    s_waitcnt vmcnt(1)
    buffer_load_dword v22, v16, s[24:27], s68 offen
    s_add_u32 s68, s68, 0x100000
    s_waitcnt vmcnt(1)
    buffer_load_dword v23, v16, s[24:27], s68 offen
    s_add_u32 s68, s68, 0x100000
    s_waitcnt vmcnt(1)
    buffer_load_dword v24, v16, s[24:27], s68 offen
    s_add_u32 s68, s68, 0x100000
    s_waitcnt vmcnt(1)
    s_waitcnt vmcnt(0)
    s_branch L_end_P
Lnotag_P_3:
    v_lshrrev_b32 v221, 5, v1
    v_mul_u32_u24 v221, 3584, v221
    v_and_b32_e64 v222, 31, v1
    v_lshl_add_u32 v221, v222, 1, v221
    s_lshl_b32 s58, s67, 1
    s_lshr_b32 s60, s3, 1
    s_add_u32 s58, s58, s60
    s_mul_i32 s58, s58, 28672
    s_lshl_b32 s60, s66, 7
    s_add_u32 s58, s58, s60
    s_and_b32 s60, s3, 1
    s_lshl_b32 s60, s60, 6
    s_add_u32 s58, s58, s60
    buffer_load_ushort v192, v221, s[8:11], s58 offen offset:0
    buffer_load_ushort v193, v221, s[8:11], s58 offen offset:896
    buffer_load_ushort v194, v221, s[8:11], s58 offen offset:1792
    buffer_load_ushort v195, v221, s[8:11], s58 offen offset:2688
    s_add_u32 s58, s58, 7168
    buffer_load_ushort v196, v221, s[8:11], s58 offen offset:0
    buffer_load_ushort v197, v221, s[8:11], s58 offen offset:896
    buffer_load_ushort v198, v221, s[8:11], s58 offen offset:1792
    buffer_load_ushort v199, v221, s[8:11], s58 offen offset:2688
    s_add_u32 s58, s58, 7168
    buffer_load_ushort v200, v221, s[8:11], s58 offen offset:0
    buffer_load_ushort v201, v221, s[8:11], s58 offen offset:896
    buffer_load_ushort v202, v221, s[8:11], s58 offen offset:1792
    buffer_load_ushort v203, v221, s[8:11], s58 offen offset:2688
    s_add_u32 s58, s58, 7168
    buffer_load_ushort v204, v221, s[8:11], s58 offen offset:0
    buffer_load_ushort v205, v221, s[8:11], s58 offen offset:896
    buffer_load_ushort v206, v221, s[8:11], s58 offen offset:1792
    buffer_load_ushort v207, v221, s[8:11], s58 offen offset:2688
    s_and_b32 s68, s2, 7
    s_cmp_ge_u32 s68, 7
    s_cselect_b32 s48, 7, 0
    s_sub_u32 s68, s68, s48
    s_lshl_b32 s48, s68, 12
    s_add_u32 s68, s68, 1
    s_cmp_ge_u32 s68, 7
    s_cselect_b32 s49, 7, 0
    s_sub_u32 s68, s68, s49
    s_lshl_b32 s49, s68, 12
    s_add_u32 s68, s68, 1
    s_cmp_ge_u32 s68, 7
    s_cselect_b32 s50, 7, 0
    s_sub_u32 s68, s68, s50
    s_lshl_b32 s50, s68, 12
    s_add_u32 s68, s68, 1
    s_cmp_ge_u32 s68, 7
    s_cselect_b32 s51, 7, 0
    s_sub_u32 s68, s68, s51
    s_lshl_b32 s51, s68, 12
    s_add_u32 s68, s68, 1
    s_cmp_ge_u32 s68, 7
    s_cselect_b32 s52, 7, 0
    s_sub_u32 s68, s68, s52
    s_lshl_b32 s52, s68, 12
    s_add_u32 s68, s68, 1
    s_cmp_ge_u32 s68, 7
    s_cselect_b32 s53, 7, 0
    s_sub_u32 s68, s68, s53
    s_lshl_b32 s53, s68, 12
    s_add_u32 s68, s68, 1
    s_cmp_ge_u32 s68, 7
    s_cselect_b32 s54, 7, 0
    s_sub_u32 s68, s68, s54
    s_lshl_b32 s54, s68, 12
    s_add_u32 m0, s70, 16384
    s_mul_i32 s73, s94, 56
    s_add_u32 s73, s73, 0
    buffer_load_dwordx4 v213, s[20:23], s73 offen lds
    s_add_u32 m0, s70, 17408
    s_mul_i32 s73, s94, 56
    s_add_u32 s73, s73, 28672
    buffer_load_dwordx4 v213, s[20:23], s73 offen lds
    s_add_u32 m0, s70, 18432
    s_mul_i32 s73, s94, 56
    s_add_u32 s73, s73, 57344
    buffer_load_dwordx4 v213, s[20:23], s73 offen lds
    s_add_u32 m0, s70, 19456
    s_mul_i32 s73, s94, 56
    s_add_u32 s73, s73, 86016
    buffer_load_dwordx4 v213, s[20:23], s73 offen lds
    s_add_u32 m0, s70, 20480
    s_mul_i32 s73, s94, 56
    s_add_u32 s73, s73, 114688
    buffer_load_dwordx4 v213, s[20:23], s73 offen lds
    s_add_u32 m0, s70, 21504
    s_mul_i32 s73, s94, 56
    s_add_u32 s73, s73, 143360
    buffer_load_dwordx4 v213, s[20:23], s73 offen lds
    s_add_u32 m0, s70, 22528
    s_mul_i32 s73, s94, 56
    s_add_u32 s73, s73, 172032
    buffer_load_dwordx4 v213, s[20:23], s73 offen lds
    s_add_u32 m0, s70, 23552
    s_mul_i32 s73, s94, 56
    s_add_u32 s73, s73, 200704
    buffer_load_dwordx4 v213, s[20:23], s73 offen lds
    s_waitcnt vmcnt(25)
    s_barrier
    ds_read_b64_tr_b16 a[0:1], v209 offset:0
    ds_read_b64_tr_b16 a[2:3], v209 offset:2048
    s_add_u32 m0, s70, 24576
    s_mul_i32 s73, s95, 56
    s_add_u32 s73, s73, 0
    buffer_load_dwordx4 v213, s[20:23], s73 offen lds
    ds_read_b64_tr_b16 a[4:5], v209 offset:1024
    ds_read_b64_tr_b16 a[6:7], v209 offset:3072
    s_add_u32 m0, s70, 25600
    s_mul_i32 s73, s95, 56
    s_add_u32 s73, s73, 28672
    buffer_load_dwordx4 v213, s[20:23], s73 offen lds
    ds_read_b64_tr_b16 a[8:9], v209 offset:3584
    ds_read_b64_tr_b16 a[10:11], v209 offset:5632
    ds_read_b64_tr_b16 a[12:13], v209 offset:4608
    ds_read_b64_tr_b16 a[14:15], v209 offset:6656
    s_add_u32 m0, s70, 26624
    s_mul_i32 s73, s95, 56
    s_add_u32 s73, s73, 57344
    buffer_load_dwordx4 v213, s[20:23], s73 offen lds
    ds_read_b64_tr_b16 a[16:17], v209 offset:7168
    ds_read_b64_tr_b16 a[18:19], v209 offset:9216
    s_add_u32 m0, s70, 27648
    s_mul_i32 s73, s95, 56
    s_add_u32 s73, s73, 86016
    buffer_load_dwordx4 v213, s[20:23], s73 offen lds
    ds_read_b64_tr_b16 a[20:21], v209 offset:8192
    ds_read_b64_tr_b16 a[22:23], v209 offset:10240
    ds_read_b64_tr_b16 a[24:25], v209 offset:10752
    ds_read_b64_tr_b16 a[26:27], v209 offset:12800
    s_add_u32 m0, s70, 28672
    s_mul_i32 s73, s95, 56
    s_add_u32 s73, s73, 114688
    buffer_load_dwordx4 v213, s[20:23], s73 offen lds
    ds_read_b64_tr_b16 a[28:29], v209 offset:11776
    ds_read_b64_tr_b16 a[30:31], v210 offset:13824
    s_add_u32 m0, s70, 29696
    s_mul_i32 s73, s95, 56
    s_add_u32 s73, s73, 143360
    buffer_load_dwordx4 v213, s[20:23], s73 offen lds
    ds_read_b64_tr_b16 a[32:33], v209 offset:36864
    ds_read_b64_tr_b16 a[34:35], v209 offset:38912
    ds_read_b64_tr_b16 a[36:37], v209 offset:37888
    ds_read_b64_tr_b16 a[38:39], v209 offset:39936
    s_add_u32 m0, s70, 30720
    s_mul_i32 s73, s95, 56
    s_add_u32 s73, s73, 172032
    buffer_load_dwordx4 v213, s[20:23], s73 offen lds
    ds_read_b64_tr_b16 a[40:41], v209 offset:40448
    ds_read_b64_tr_b16 a[42:43], v209 offset:42496
    s_add_u32 m0, s70, 31744
    s_mul_i32 s73, s95, 56
    s_add_u32 s73, s73, 200704
    buffer_load_dwordx4 v213, s[20:23], s73 offen lds
    ds_read_b64_tr_b16 a[44:45], v209 offset:41472
    ds_read_b64_tr_b16 a[46:47], v209 offset:43520
    ds_read_b64_tr_b16 a[48:49], v209 offset:44032
    ds_read_b64_tr_b16 a[50:51], v209 offset:46080
    s_add_u32 m0, s70, 32768
    s_mul_i32 s73, s96, 56
    s_add_u32 s73, s73, 0
    buffer_load_dwordx4 v213, s[20:23], s73 offen lds
    ds_read_b64_tr_b16 a[52:53], v209 offset:45056
    ds_read_b64_tr_b16 a[54:55], v209 offset:47104
    s_add_u32 m0, s70, 33792
    s_mul_i32 s73, s96, 56
    s_add_u32 s73, s73, 28672
    buffer_load_dwordx4 v213, s[20:23], s73 offen lds
    ds_read_b64_tr_b16 a[56:57], v209 offset:47616
    ds_read_b64_tr_b16 a[58:59], v209 offset:49664
    ds_read_b64_tr_b16 a[60:61], v209 offset:48640
    ds_read_b64_tr_b16 a[62:63], v210 offset:50688
    s_add_u32 m0, s70, 34816
    s_mul_i32 s73, s96, 56
    s_add_u32 s73, s73, 57344
    buffer_load_dwordx4 v213, s[20:23], s73 offen lds
    v_add_u32 v209, 73728, v209
    v_add_u32 v210, 73728, v210
    ds_read_b64_tr_b16 a[64:65], v209 offset:0
    ds_read_b64_tr_b16 a[66:67], v209 offset:2048
    s_add_u32 m0, s70, 35840
    s_mul_i32 s73, s96, 56
    s_add_u32 s73, s73, 86016
    buffer_load_dwordx4 v213, s[20:23], s73 offen lds
    ds_read_b64_tr_b16 a[68:69], v209 offset:1024
    ds_read_b64_tr_b16 a[70:71], v209 offset:3072
    ds_read_b64_tr_b16 a[72:73], v209 offset:3584
    ds_read_b64_tr_b16 a[74:75], v209 offset:5632
    ds_read_b64_tr_b16 a[76:77], v209 offset:4608
    ds_read_b64_tr_b16 a[78:79], v209 offset:6656
    ds_read_b64_tr_b16 a[80:81], v209 offset:7168
    ds_read_b64_tr_b16 a[82:83], v209 offset:9216
    ds_read_b64_tr_b16 a[84:85], v209 offset:8192
    ds_read_b64_tr_b16 a[86:87], v209 offset:10240
    ds_read_b64_tr_b16 a[88:89], v209 offset:10752
    ds_read_b64_tr_b16 a[90:91], v209 offset:12800
    ds_read_b64_tr_b16 a[92:93], v209 offset:11776
    ds_read_b64_tr_b16 a[94:95], v210 offset:13824
    ds_read_b64_tr_b16 a[96:97], v209 offset:36864
    ds_read_b64_tr_b16 a[98:99], v209 offset:38912
    ds_read_b64_tr_b16 a[100:101], v209 offset:37888
    ds_read_b64_tr_b16 a[102:103], v209 offset:39936
    ds_read_b64_tr_b16 a[104:105], v209 offset:40448
    ds_read_b64_tr_b16 a[106:107], v209 offset:42496
    ds_read_b64_tr_b16 a[108:109], v209 offset:41472
    ds_read_b64_tr_b16 a[110:111], v209 offset:43520
    ds_read_b64_tr_b16 a[112:113], v209 offset:44032
    ds_read_b64_tr_b16 a[114:115], v209 offset:46080
    ds_read_b64_tr_b16 a[116:117], v209 offset:45056
    ds_read_b64_tr_b16 a[118:119], v209 offset:47104
    ds_read_b64_tr_b16 a[120:121], v209 offset:47104
    ds_read_b64_tr_b16 a[122:123], v209 offset:49152
    ds_read_b64_tr_b16 a[124:125], v209 offset:48128
    ds_read_b64_tr_b16 a[126:127], v209 offset:50176
    s_waitcnt lgkmcnt(0)
    s_barrier
    buffer_load_dword v249, v10, s[40:43], s83 offen sc1
    s_sleep 3
    buffer_load_dword v250, v10, s[40:43], s83 offen sc1
    s_sleep 3
    s_nop 0
Lpoll_P_4:
    s_sub_u32 s6, s6, 1
    s_cbranch_scc1 L_end_P
    buffer_load_dword v251, v10, s[40:43], s83 offen sc1
    s_waitcnt vmcnt(2)
    v_cmp_ne_u32_e64 vcc, s4, v249
    s_nop 1
    s_cbranch_vccz Lpd_P_5
    buffer_load_dword v249, v10, s[40:43], s83 offen sc1
    s_waitcnt vmcnt(2)
    v_cmp_ne_u32 vcc, s4, v250
    s_nop 1
    s_cbranch_vccz Lpd_P_5
    buffer_load_dword v250, v10, s[40:43], s83 offen sc1
    s_waitcnt vmcnt(2)
    v_cmp_ne_u32 vcc, s4, v251
    s_nop 1
    s_cbranch_vccnz Lpoll_P_4
    s_nop 1
Lpd_P_5:
    s_lshl_b32 s58, s67, 16
    s_lshl_b32 s60, s3, 14
    s_add_u32 s58, s58, s60
    s_add_u32 m0, s70, 0
    s_nop 0
    buffer_load_dwordx4 v4, s[40:43], s58 offen offset:0 sc1 lds
    buffer_load_dwordx4 v4, s[40:43], s58 offen offset:1024 sc1 lds
    buffer_load_dwordx4 v4, s[40:43], s58 offen offset:2048 sc1 lds
    buffer_load_dwordx4 v4, s[40:43], s58 offen offset:3072 sc1 lds
    s_add_u32 m0, s70, 4096
    s_add_u32 s58, s58, 4096
    buffer_load_dwordx4 v4, s[40:43], s58 offen offset:0 sc1 lds
    buffer_load_dwordx4 v4, s[40:43], s58 offen offset:1024 sc1 lds
    buffer_load_dwordx4 v4, s[40:43], s58 offen offset:2048 sc1 lds
    buffer_load_dwordx4 v4, s[40:43], s58 offen offset:3072 sc1 lds
    s_add_u32 m0, s70, 8192
    s_add_u32 s58, s58, 4096
    buffer_load_dwordx4 v4, s[40:43], s58 offen offset:0 sc1 lds
    buffer_load_dwordx4 v4, s[40:43], s58 offen offset:1024 sc1 lds
    buffer_load_dwordx4 v4, s[40:43], s58 offen offset:2048 sc1 lds
    buffer_load_dwordx4 v4, s[40:43], s58 offen offset:3072 sc1 lds
    s_add_u32 m0, s70, 12288
    s_add_u32 s58, s58, 4096
    buffer_load_dwordx4 v4, s[40:43], s58 offen offset:0 sc1 lds
    buffer_load_dwordx4 v4, s[40:43], s58 offen offset:1024 sc1 lds
    buffer_load_dwordx4 v4, s[40:43], s58 offen offset:2048 sc1 lds
    buffer_load_dwordx4 v4, s[40:43], s58 offen offset:3072 sc1 lds
    v_and_b32_e64 v64, 1, v3
    v_mul_u32_u24 v64, 36864, v64
    v_lshl_add_u32 v64, v2, 4, v64
    v_lshrrev_b32 v65, 5, v1
    v_lshl_add_u32 v64, v65, 8, v64
    s_lshr_b32 s60, s3, 1
    s_mul_i32 s60, s60, 73728
    s_add_u32 s60, s60, 12288
    v_add_u32_e64 v64, s60, v64
    ds_read_b64_tr_b16 a[128:129], v215 offset:16384
    ds_read_b64_tr_b16 a[130:131], v215 offset:17408
    ds_read_b64_tr_b16 a[132:133], v216 offset:16384
    ds_read_b64_tr_b16 a[134:135], v216 offset:17408
    ds_read_b64_tr_b16 a[136:137], v215 offset:18432
    ds_read_b64_tr_b16 a[138:139], v215 offset:19456
    ds_read_b64_tr_b16 a[140:141], v216 offset:18432
    ds_read_b64_tr_b16 a[142:143], v216 offset:19456
    ds_read_b64_tr_b16 a[144:145], v215 offset:20480
    ds_read_b64_tr_b16 a[146:147], v215 offset:21504
    ds_read_b64_tr_b16 a[148:149], v216 offset:20480
    ds_read_b64_tr_b16 a[150:151], v216 offset:21504
    ds_read_b64_tr_b16 a[152:153], v215 offset:22528
    ds_read_b64_tr_b16 a[154:155], v215 offset:23552
    ds_read_b64_tr_b16 a[156:157], v216 offset:22528
    ds_read_b64_tr_b16 a[158:159], v216 offset:23552
    ds_read_b64_tr_b16 a[160:161], v215 offset:24576
    ds_read_b64_tr_b16 a[162:163], v215 offset:25600
    ds_read_b64_tr_b16 a[164:165], v216 offset:24576
    ds_read_b64_tr_b16 a[166:167], v216 offset:25600
    ds_read_b64_tr_b16 a[168:169], v215 offset:26624
    ds_read_b64_tr_b16 a[170:171], v215 offset:27648
    ds_read_b64_tr_b16 a[172:173], v216 offset:26624
    ds_read_b64_tr_b16 a[174:175], v216 offset:27648
    ds_read_b64_tr_b16 a[176:177], v215 offset:28672
    ds_read_b64_tr_b16 a[178:179], v215 offset:29696
    ds_read_b64_tr_b16 a[180:181], v216 offset:28672
    ds_read_b64_tr_b16 a[182:183], v216 offset:29696
    ds_read_b64_tr_b16 a[184:185], v215 offset:30720
    ds_read_b64_tr_b16 a[186:187], v215 offset:31744
    ds_read_b64_tr_b16 a[188:189], v216 offset:30720
    ds_read_b64_tr_b16 a[190:191], v216 offset:31744
    ds_read_b64_tr_b16 a[192:193], v215 offset:32768
    ds_read_b64_tr_b16 a[194:195], v215 offset:33792
    ds_read_b64_tr_b16 a[196:197], v216 offset:32768
    ds_read_b64_tr_b16 a[198:199], v216 offset:33792
    ds_read_b64_tr_b16 a[200:201], v215 offset:34816
    ds_read_b64_tr_b16 a[202:203], v215 offset:35840
    ds_read_b64_tr_b16 a[204:205], v216 offset:34816
    ds_read_b64_tr_b16 a[206:207], v216 offset:35840
    v_lshlrev_b32 v192, 16, v192
    v_lshlrev_b32 v193, 16, v193
    v_lshlrev_b32 v194, 16, v194
    v_lshlrev_b32 v195, 16, v195
    v_lshlrev_b32 v196, 16, v196
    v_lshlrev_b32 v197, 16, v197
    v_lshlrev_b32 v198, 16, v198
    v_lshlrev_b32 v199, 16, v199
    v_lshlrev_b32 v200, 16, v200
    v_lshlrev_b32 v201, 16, v201
    v_lshlrev_b32 v202, 16, v202
    v_lshlrev_b32 v203, 16, v203
    v_lshlrev_b32 v204, 16, v204
    v_lshlrev_b32 v205, 16, v205
    v_lshlrev_b32_e64 v206, 16, v206
    v_lshlrev_b32 v207, 16, v207
    s_waitcnt vmcnt(8)
    s_barrier
    ds_read_b128 v[32:35], v64 offset:0
    ds_read_b128 v[36:39], v64 offset:512
    ds_read_b128 v[40:43], v64 offset:1024
    ds_read_b128 v[44:47], v64 offset:1536
    ds_read_b128 v[48:51], v64 offset:2048
    ds_read_b128 v[52:55], v64 offset:2560
    s_waitcnt lgkmcnt(5)
    v_mfma_f32_32x32x16_bf16 v[192:207], v[32:35], a[0:3], v[192:207]
    ds_read_b128 v[56:59], v64 offset:3072
    s_add_u32 m0, s70, 16384
    s_mul_i32 s73, s96, 56
    s_add_u32 s73, s73, 114688
    buffer_load_dwordx4 v213, s[20:23], s73 offen lds
    s_waitcnt lgkmcnt(5)
    v_mfma_f32_32x32x16_bf16 v[192:207], v[36:39], a[4:7], v[192:207]
    ds_read_b128 v[60:63], v64 offset:3584
    s_waitcnt lgkmcnt(5)
    v_mfma_f32_32x32x16_bf16 v[192:207], v[40:43], a[8:11], v[192:207]
    ds_read_b128 v[32:35], v64 offset:4096
    s_waitcnt lgkmcnt(5)
    v_mfma_f32_32x32x16_bf16 v[192:207], v[44:47], a[12:15], v[192:207]
    ds_read_b128 v[36:39], v64 offset:4608
    s_add_u32 m0, s70, 17408
    s_mul_i32 s73, s96, 56
    s_add_u32 s73, s73, 143360
    buffer_load_dwordx4 v213, s[20:23], s73 offen lds
    s_waitcnt lgkmcnt(5)
    v_mfma_f32_32x32x16_bf16 v[192:207], v[48:51], a[16:19], v[192:207]
    ds_read_b128 v[40:43], v64 offset:5120
    s_waitcnt lgkmcnt(5)
    v_mfma_f32_32x32x16_bf16 v[192:207], v[52:55], a[20:23], v[192:207]
    ds_read_b128 v[44:47], v64 offset:5632
    s_waitcnt lgkmcnt(5)
    v_mfma_f32_32x32x16_bf16 v[192:207], v[56:59], a[24:27], v[192:207]
    ds_read_b128 v[48:51], v64 offset:6144
    s_add_u32 m0, s70, 18432
    s_mul_i32 s73, s96, 56
    s_add_u32 s73, s73, 172032
    buffer_load_dwordx4 v213, s[20:23], s73 offen lds
    s_waitcnt lgkmcnt(5)
    v_mfma_f32_32x32x16_bf16 v[192:207], v[60:63], a[28:31], v[192:207]
    ds_read_b128 v[52:55], v64 offset:6656
    s_waitcnt lgkmcnt(5)
    v_mfma_f32_32x32x16_bf16 v[192:207], v[32:35], a[32:35], v[192:207]
    ds_read_b128 v[56:59], v64 offset:7168
    s_waitcnt lgkmcnt(5)
    v_mfma_f32_32x32x16_bf16 v[192:207], v[36:39], a[36:39], v[192:207]
    ds_read_b128 v[60:63], v64 offset:7680
    s_add_u32 m0, s70, 19456
    s_mul_i32 s73, s96, 56
    s_add_u32 s73, s73, 200704
    buffer_load_dwordx4 v213, s[20:23], s73 offen lds
    s_waitcnt lgkmcnt(5)
    v_mfma_f32_32x32x16_bf16 v[192:207], v[40:43], a[40:43], v[192:207]
    s_waitcnt lgkmcnt(4)
    v_mfma_f32_32x32x16_bf16 v[192:207], v[44:47], a[44:47], v[192:207]
    s_waitcnt vmcnt(4)
    s_barrier
    ds_read_b128 v[32:35], v64 offset:8192
    ds_read_b128 v[36:39], v64 offset:8704
    s_waitcnt lgkmcnt(5)
    v_mfma_f32_32x32x16_bf16 v[192:207], v[48:51], a[48:51], v[192:207]
    ds_read_b128 v[40:43], v64 offset:9216
    s_add_u32 m0, s70, 20480
    s_mul_i32 s73, s97, 56
    s_add_u32 s73, s73, 0
    buffer_load_dwordx4 v213, s[20:23], s73 offen lds
    s_waitcnt lgkmcnt(5)
    v_mfma_f32_32x32x16_bf16 v[192:207], v[52:55], a[52:55], v[192:207]
    ds_read_b128 v[44:47], v64 offset:9728
    s_waitcnt lgkmcnt(5)
    v_mfma_f32_32x32x16_bf16 v[192:207], v[56:59], a[56:59], v[192:207]
    ds_read_b128 v[48:51], v64 offset:10240
    s_waitcnt lgkmcnt(5)
    v_mfma_f32_32x32x16_bf16 v[192:207], v[60:63], a[60:63], v[192:207]
    ds_read_b128 v[52:55], v64 offset:10752
    s_add_u32 m0, s70, 21504
    s_mul_i32 s73, s97, 56
    s_add_u32 s73, s73, 28672
    buffer_load_dwordx4 v213, s[20:23], s73 offen lds
    s_waitcnt lgkmcnt(5)
    v_mfma_f32_32x32x16_bf16 v[192:207], v[32:35], a[64:67], v[192:207]
    ds_read_b128 v[56:59], v64 offset:11264
    s_waitcnt lgkmcnt(5)
    v_mfma_f32_32x32x16_bf16 v[192:207], v[36:39], a[68:71], v[192:207]
    ds_read_b128 v[60:63], v64 offset:11776
    s_waitcnt lgkmcnt(5)
    v_mfma_f32_32x32x16_bf16 v[192:207], v[40:43], a[72:75], v[192:207]
    ds_read_b128 v[32:35], v64 offset:12288
    s_add_u32 m0, s70, 22528
    s_mul_i32 s73, s97, 56
    s_add_u32 s73, s73, 57344
    buffer_load_dwordx4 v213, s[20:23], s73 offen lds
    s_waitcnt lgkmcnt(5)
    v_mfma_f32_32x32x16_bf16 v[192:207], v[44:47], a[76:79], v[192:207]
    ds_read_b128 v[36:39], v64 offset:12800
    s_waitcnt lgkmcnt(5)
    v_mfma_f32_32x32x16_bf16 v[192:207], v[48:51], a[80:83], v[192:207]
    ds_read_b128 v[40:43], v64 offset:13312
    s_waitcnt lgkmcnt(5)
    v_mfma_f32_32x32x16_bf16 v[192:207], v[52:55], a[84:87], v[192:207]
    ds_read_b128 v[44:47], v64 offset:13824
    s_add_u32 m0, s70, 23552
    s_mul_i32 s73, s97, 56
    s_add_u32 s73, s73, 86016
    buffer_load_dwordx4 v213, s[20:23], s73 offen lds
    s_waitcnt lgkmcnt(5)
    v_mfma_f32_32x32x16_bf16 v[192:207], v[56:59], a[88:91], v[192:207]
    ds_read_b128 v[48:51], v64 offset:14336
    s_waitcnt lgkmcnt(5)
    v_mfma_f32_32x32x16_bf16 v[192:207], v[60:63], a[92:95], v[192:207]
    ds_read_b128 v[52:55], v64 offset:14848
    s_waitcnt lgkmcnt(5)
    v_mfma_f32_32x32x16_bf16 v[192:207], v[32:35], a[96:99], v[192:207]
    ds_read_b128 v[56:59], v64 offset:15360
    s_add_u32 m0, s70, 24576
    s_mul_i32 s73, s97, 56
    s_add_u32 s73, s73, 114688
    buffer_load_dwordx4 v213, s[20:23], s73 offen lds
    s_waitcnt lgkmcnt(5)
    v_mfma_f32_32x32x16_bf16 v[192:207], v[36:39], a[100:103], v[192:207]
    ds_read_b128 v[60:63], v64 offset:15872
    s_waitcnt lgkmcnt(5)
    v_mfma_f32_32x32x16_bf16 v[192:207], v[40:43], a[104:107], v[192:207]
    s_waitcnt lgkmcnt(4)
    v_mfma_f32_32x32x16_bf16 v[192:207], v[44:47], a[108:111], v[192:207]
    s_add_u32 m0, s70, 25600
    s_mul_i32 s73, s97, 56
    s_add_u32 s73, s73, 143360
    buffer_load_dwordx4 v213, s[20:23], s73 offen lds
    s_waitcnt lgkmcnt(3)
    v_mfma_f32_32x32x16_bf16 v[192:207], v[48:51], a[112:115], v[192:207]
    s_waitcnt lgkmcnt(2)
    v_mfma_f32_32x32x16_bf16 v[192:207], v[52:55], a[116:119], v[192:207]
    s_waitcnt lgkmcnt(1)
    v_mfma_f32_32x32x16_bf16 v[192:207], v[56:59], a[120:123], v[192:207]
    s_add_u32 m0, s70, 26624
    s_mul_i32 s73, s97, 56
    s_add_u32 s73, s73, 172032
    buffer_load_dwordx4 v213, s[20:23], s73 offen lds
    s_waitcnt lgkmcnt(0)
    v_mfma_f32_32x32x16_bf16 v[192:207], v[60:63], a[124:127], v[192:207]
    s_nop 11
    v_pk_mul_f32 v[68:69], v[192:193], v[192:193]
    v_pk_mul_f32 v[70:71], v[194:195], v[194:195]
    v_pk_mul_f32 v[72:73], v[196:197], v[196:197]
    v_pk_mul_f32 v[74:75], v[198:199], v[198:199]
    v_pk_mul_f32 v[76:77], v[200:201], v[200:201]
    v_pk_mul_f32 v[78:79], v[202:203], v[202:203]
    v_pk_mul_f32 v[80:81], v[204:205], v[204:205]
    v_pk_mul_f32 v[82:83], v[206:207], v[206:207]
    s_add_u32 m0, s70, 27648
    s_mul_i32 s73, s97, 56
    s_add_u32 s73, s73, 200704
    buffer_load_dwordx4 v213, s[20:23], s73 offen lds
    v_add_f32_dpp v84, v192, v192 row_mirror row_mask:0xf bank_mask:0x3
    v_add_f32_dpp v85, v193, v193 row_mirror row_mask:0xf bank_mask:0x3
    v_add_f32_dpp v86, v196, v196 row_mirror row_mask:0xf bank_mask:0x3
    v_add_f32_dpp v87, v197, v197 row_mirror row_mask:0xf bank_mask:0x3
    v_add_f32_dpp v88, v200, v200 row_mirror row_mask:0xf bank_mask:0x3
    v_add_f32_dpp v89, v201, v201 row_mirror row_mask:0xf bank_mask:0x3
    v_add_f32_dpp v90, v204, v204 row_mirror row_mask:0xf bank_mask:0x3
    v_add_f32_dpp v91, v205, v205 row_mirror row_mask:0xf bank_mask:0x3
    s_add_u32 m0, s70, 28672
    s_mul_i32 s73, s98, 56
    s_add_u32 s73, s73, 0
    buffer_load_dwordx4 v213, s[20:23], s73 offen lds
    v_add_f32_dpp v92, v68, v68 row_mirror row_mask:0xf bank_mask:0x3
    v_add_f32_dpp v93, v69, v69 row_mirror row_mask:0xf bank_mask:0x3
    v_add_f32_dpp v94, v72, v72 row_mirror row_mask:0xf bank_mask:0x3
    v_add_f32_dpp v95, v73, v73 row_mirror row_mask:0xf bank_mask:0x3
    v_add_f32_dpp v96, v76, v76 row_mirror row_mask:0xf bank_mask:0x3
    v_add_f32_dpp v97, v77, v77 row_mirror row_mask:0xf bank_mask:0x3
    v_add_f32_dpp v98, v80, v80 row_mirror row_mask:0xf bank_mask:0x3
    v_add_f32_dpp v99, v81, v81 row_mirror row_mask:0xf bank_mask:0x3
    s_add_u32 m0, s70, 29696
    s_mul_i32 s73, s98, 56
    s_add_u32 s73, s73, 28672
    buffer_load_dwordx4 v213, s[20:23], s73 offen lds
    v_add_f32_dpp v84, v194, v194 row_mirror row_mask:0xf bank_mask:0xc
    v_add_f32_dpp v85, v195, v195 row_mirror row_mask:0xf bank_mask:0xc
    v_add_f32_dpp v86, v198, v198 row_mirror row_mask:0xf bank_mask:0xc
    v_add_f32_dpp v87, v199, v199 row_mirror row_mask:0xf bank_mask:0xc
    v_add_f32_dpp v88, v202, v202 row_mirror row_mask:0xf bank_mask:0xc
    v_add_f32_dpp v89, v203, v203 row_mirror row_mask:0xf bank_mask:0xc
    v_add_f32_dpp v90, v206, v206 row_mirror row_mask:0xf bank_mask:0xc
    v_add_f32_dpp v91, v207, v207 row_mirror row_mask:0xf bank_mask:0xc
    s_add_u32 m0, s70, 30720
    s_mul_i32 s73, s98, 56
    s_add_u32 s73, s73, 57344
    buffer_load_dwordx4 v213, s[20:23], s73 offen lds
    v_add_f32_dpp v92, v70, v70 row_mirror row_mask:0xf bank_mask:0xc
    v_add_f32_dpp v93, v71, v71 row_mirror row_mask:0xf bank_mask:0xc
    v_add_f32_dpp v94, v74, v74 row_mirror row_mask:0xf bank_mask:0xc
    v_add_f32_dpp v95, v75, v75 row_mirror row_mask:0xf bank_mask:0xc
    v_add_f32_dpp v96, v78, v78 row_mirror row_mask:0xf bank_mask:0xc
    v_add_f32_dpp v97, v79, v79 row_mirror row_mask:0xf bank_mask:0xc
    v_add_f32_dpp v98, v82, v82 row_mirror row_mask:0xf bank_mask:0xc
    v_add_f32_dpp v99, v83, v83 row_mirror row_mask:0xf bank_mask:0xc
    s_add_u32 m0, s70, 31744
    s_mul_i32 s73, s98, 56
    s_add_u32 s73, s73, 86016
    buffer_load_dwordx4 v213, s[20:23], s73 offen lds
    v_add_f32_dpp v84, v84, v84 row_half_mirror row_mask:0xf bank_mask:0x5
    v_add_f32_dpp v86, v86, v86 row_half_mirror row_mask:0xf bank_mask:0x5
    v_add_f32_dpp v88, v88, v88 row_half_mirror row_mask:0xf bank_mask:0x5
    v_add_f32_dpp v90, v90, v90 row_half_mirror row_mask:0xf bank_mask:0x5
    v_add_f32_dpp v92, v92, v92 row_half_mirror row_mask:0xf bank_mask:0x5
    v_add_f32_dpp v94, v94, v94 row_half_mirror row_mask:0xf bank_mask:0x5
    v_add_f32_dpp v96, v96, v96 row_half_mirror row_mask:0xf bank_mask:0x5
    v_add_f32_dpp v98, v98, v98 row_half_mirror row_mask:0xf bank_mask:0x5
    v_add_f32_dpp v84, v85, v85 row_half_mirror row_mask:0xf bank_mask:0xa
    v_add_f32_dpp v86, v87, v87 row_half_mirror row_mask:0xf bank_mask:0xa
    v_add_f32_dpp v88, v89, v89 row_half_mirror row_mask:0xf bank_mask:0xa
    v_add_f32_dpp v90, v91, v91 row_half_mirror row_mask:0xf bank_mask:0xa
    v_add_f32_dpp v92, v93, v93 row_half_mirror row_mask:0xf bank_mask:0xa
    v_add_f32_dpp v94, v95, v95 row_half_mirror row_mask:0xf bank_mask:0xa
    v_add_f32_dpp v96, v97, v97 row_half_mirror row_mask:0xf bank_mask:0xa
    v_add_f32_dpp v98, v99, v99 row_half_mirror row_mask:0xf bank_mask:0xa
    v_add_f32_dpp v85, v84, v84 quad_perm:[1,0,3,2] row_mask:0xf bank_mask:0xf
    v_add_f32_dpp v87, v86, v86 quad_perm:[1,0,3,2] row_mask:0xf bank_mask:0xf
    v_add_f32_dpp v89, v88, v88 quad_perm:[1,0,3,2] row_mask:0xf bank_mask:0xf
    v_add_f32_dpp v91, v90, v90 quad_perm:[1,0,3,2] row_mask:0xf bank_mask:0xf
    v_add_f32_dpp v93, v92, v92 quad_perm:[1,0,3,2] row_mask:0xf bank_mask:0xf
    v_add_f32_dpp v95, v94, v94 quad_perm:[1,0,3,2] row_mask:0xf bank_mask:0xf
    v_add_f32_dpp v97, v96, v96 quad_perm:[1,0,3,2] row_mask:0xf bank_mask:0xf
    v_add_f32_dpp v99, v98, v98 quad_perm:[1,0,3,2] row_mask:0xf bank_mask:0xf
    v_add_f32_dpp v68, v85, v85 quad_perm:[2,3,0,1] row_mask:0xf bank_mask:0xf
    v_add_f32_dpp v69, v87, v87 quad_perm:[2,3,0,1] row_mask:0xf bank_mask:0xf
    v_add_f32_dpp v70, v89, v89 quad_perm:[2,3,0,1] row_mask:0xf bank_mask:0xf
    v_add_f32_dpp v71, v91, v91 quad_perm:[2,3,0,1] row_mask:0xf bank_mask:0xf
    v_add_f32_dpp v72, v93, v93 quad_perm:[2,3,0,1] row_mask:0xf bank_mask:0xf
    v_add_f32_dpp v73, v95, v95 quad_perm:[2,3,0,1] row_mask:0xf bank_mask:0xf
    v_add_f32_dpp v74, v97, v97 quad_perm:[2,3,0,1] row_mask:0xf bank_mask:0xf
    v_add_f32_dpp v75, v99, v99 quad_perm:[2,3,0,1] row_mask:0xf bank_mask:0xf
    v_permlane16_swap_b32 v68, v69
    v_permlane16_swap_b32 v70, v71
    v_permlane16_swap_b32 v72, v73
    v_permlane16_swap_b32 v74, v75
    v_add_f32 v84, v68, v69
    v_add_f32 v85, v72, v73
    v_add_f32 v86, v70, v71
    v_add_f32 v87, v74, v75
    v_and_b32 v65, 1, v3
    v_lshlrev_b32 v65, 6, v65
    v_lshrrev_b32_e64 v66, 5, v1
    v_lshl_add_u32 v65, v66, 5, v65
    v_bfe_u32 v67, v1, 2, 2
    v_lshl_add_u32 v65, v67, 3, v65
    s_lshl_b32 s58, s3, 8
    v_add_u32 v65, s58, v65
    ds_write_b64 v65, v[84:85] offset:0
    ds_write_b64 v65, v[86:87] offset:128
    v_and_b32 v67, 31, v1
    v_lshlrev_b32 v65, 9, v66
    v_lshl_add_u32 v65, v67, 4, v65
    v_lshlrev_b32_e64 v66, 8, v66
    v_lshl_add_u32 v66, v67, 3, v66
    s_and_b32 s58, s58, 512
    v_add_u32_e64 v66, s58, v66
    s_lshl_b32 s58, s67, 1
    s_lshr_b32 s60, s3, 1
    s_add_u32 s58, s58, s60
    s_lshl_b32 s58, s58, 12
    s_add_u32 s58, s58, 0x548000
    s_lshl_b32 s60, s66, 9
    s_add_u32 s60, s60, s58
    s_waitcnt lgkmcnt(0)
    s_barrier
    ds_read_b64 v[84:85], v66 offset:0
    v_mov_b32 v89, s4
    v_mov_b32 v91, s4
    s_waitcnt lgkmcnt(0)
    v_mov_b32 v88, v84
    v_mov_b32 v90, v85
    s_nop 0
    v_permlane32_swap_b32 v88, v84
    v_permlane32_swap_b32 v90, v85
    v_add_f32 v88, v88, v84
    v_add_f32 v90, v90, v85
    s_bitcmp0_b32 s3, 0
    s_cselect_b32 exec_lo, -1, 0
    s_mov_b32 exec_hi, 0
    buffer_store_dwordx4 v[88:91], v65, s[40:43], s60 offen sc1
    s_mov_b64 exec, -1
    v_cvt_pk_bf16_f32 v240, v192, v193
    v_cvt_pk_bf16_f32 v241, v194, v195
    v_cvt_pk_bf16_f32 v242, v196, v197
    v_cvt_pk_bf16_f32 v243, v198, v199
    v_cvt_pk_bf16_f32 v244, v200, v201
    v_cvt_pk_bf16_f32 v245, v202, v203
    v_cvt_pk_bf16_f32 v246, v204, v205
    v_cvt_pk_bf16_f32 v247, v206, v207
    s_lshl_b32 s61, s66, 1
    s_and_b32 s60, s3, 1
    s_add_u32 s61, s61, s60
    s_lshl_b32 s61, s61, 7
    s_lshl_b32 s60, s67, 2
    s_add_u32 s61, s61, s60
    s_and_b32 s60, s3, 2
    s_add_u32 s61, s61, s60
    s_lshl_b32 s61, s61, 10
    s_add_u32 s61, s61, 0x200000
    v_lshlrev_b32_e64 v66, 4, v67
    v_cmp_gt_u32 s[86:87], 32, v1
    s_add_u32 m0, s70, 0
    s_mul_i32 s73, s98, 56
    s_add_u32 s73, s73, 114688
    buffer_load_dwordx4 v213, s[20:23], s73 offen lds
    s_add_u32 m0, s70, 1024
    s_mul_i32 s73, s98, 56
    s_add_u32 s73, s73, 143360
    buffer_load_dwordx4 v213, s[20:23], s73 offen lds
    s_add_u32 m0, s70, 2048
    s_mul_i32 s73, s98, 56
    s_add_u32 s73, s73, 172032
    buffer_load_dwordx4 v213, s[20:23], s73 offen lds
    s_add_u32 m0, s70, 3072
    s_mul_i32 s73, s98, 56
    s_add_u32 s73, s73, 200704
    buffer_load_dwordx4 v213, s[20:23], s73 offen lds
    s_add_u32 m0, s70, 4096
    s_mul_i32 s73, s99, 56
    s_add_u32 s73, s73, 0
    buffer_load_dwordx4 v213, s[20:23], s73 offen lds
    s_add_u32 m0, s70, 5120
    s_mul_i32 s73, s99, 56
    s_add_u32 s73, s73, 28672
    buffer_load_dwordx4 v213, s[20:23], s73 offen lds
    s_add_u32 m0, s70, 6144
    s_mul_i32 s73, s99, 56
    s_add_u32 s73, s73, 57344
    buffer_load_dwordx4 v213, s[20:23], s73 offen lds
    s_add_u32 m0, s70, 7168
    s_mul_i32 s73, s99, 56
    s_add_u32 s73, s73, 86016
    buffer_load_dwordx4 v213, s[20:23], s73 offen lds
    s_add_u32 m0, s70, 8192
    s_mul_i32 s73, s99, 56
    s_add_u32 s73, s73, 114688
    buffer_load_dwordx4 v213, s[20:23], s73 offen lds
    s_add_u32 m0, s70, 9216
    s_mul_i32 s73, s99, 56
    s_add_u32 s73, s73, 143360
    buffer_load_dwordx4 v213, s[20:23], s73 offen lds
    s_add_u32 m0, s70, 10240
    s_mul_i32 s73, s99, 56
    s_add_u32 s73, s73, 172032
    buffer_load_dwordx4 v213, s[20:23], s73 offen lds
    s_add_u32 m0, s70, 11264
    s_mul_i32 s73, s99, 56
    s_add_u32 s73, s73, 200704
    buffer_load_dwordx4 v213, s[20:23], s73 offen lds
    s_add_u32 m0, s70, 12288
    s_mul_i32 s73, s100, 56
    s_add_u32 s73, s73, 0
    buffer_load_dwordx4 v213, s[20:23], s73 offen lds
    s_add_u32 m0, s70, 13312
    s_mul_i32 s73, s100, 56
    s_add_u32 s73, s73, 28672
    buffer_load_dwordx4 v213, s[20:23], s73 offen lds
    s_add_u32 m0, s70, 14336
    s_mul_i32 s73, s100, 56
    s_add_u32 s73, s73, 57344
    buffer_load_dwordx4 v213, s[20:23], s73 offen lds
    s_add_u32 m0, s70, 15360
    s_mul_i32 s73, s100, 56
    s_add_u32 s73, s73, 86016
    buffer_load_dwordx4 v213, s[20:23], s73 offen lds
    buffer_load_dwordx4 v[96:99], v65, s[40:43], s58 offen offset:0 sc1
    buffer_load_dwordx4 v[100:103], v65, s[40:43], s58 offen offset:1024 sc1
    buffer_load_dwordx4 v[104:107], v65, s[40:43], s58 offen offset:2048 sc1
    buffer_load_dwordx4 v[108:111], v66, s[40:43], s58 offen offset:3072 sc1
    s_sleep 5
    s_nop 0
Lst_P_6:
    s_sub_u32 s6, s6, 1
    s_cbranch_scc1 L_end_P
    buffer_load_dwordx4 v[112:115], v65, s[40:43], s58 offen offset:0 sc1
    buffer_load_dwordx4 v[116:119], v65, s[40:43], s58 offen offset:1024 sc1
    buffer_load_dwordx4 v[120:123], v65, s[40:43], s58 offen offset:2048 sc1
    buffer_load_dwordx4 v[124:127], v66, s[40:43], s58 offen offset:3072 sc1
    s_waitcnt vmcnt(4)
    v_xor_b32 v97, s4, v97
    v_xor_b32 v99, s4, v99
    v_xor_b32 v101, s4, v101
    v_xor_b32 v103, s4, v103
    v_xor_b32 v105, s4, v105
    v_xor_b32 v107, s4, v107
    v_xor_b32 v109, s4, v109
    v_xor_b32_e64 v111, s4, v111
    v_cndmask_b32 v108, 0, v108, s[86:87]
    v_cndmask_b32 v110, 0, v110, s[86:87]
    v_or3_b32 v97, v97, v99, v101
    v_or3_b32 v103, v103, v105, v107
    v_or3_b32 v97, v97, v109, v111
    v_or_b32 v97, v97, v103
    v_cmp_ne_u32 vcc, 0, v97
    v_add_f32 v128, v96, v100
    v_add_f32 v129, v104, v108
    v_add_f32_e64 v130, v98, v102
    v_add_f32 v131, v106, v110
    s_cbranch_vccz Lstd_P_7
    buffer_load_dwordx4 v[96:99], v65, s[40:43], s58 offen offset:0 sc1
    buffer_load_dwordx4 v[100:103], v65, s[40:43], s58 offen offset:1024 sc1
    buffer_load_dwordx4 v[104:107], v65, s[40:43], s58 offen offset:2048 sc1
    buffer_load_dwordx4 v[108:111], v66, s[40:43], s58 offen offset:3072 sc1
    s_waitcnt vmcnt(4)
    v_xor_b32 v113, s4, v113
    v_xor_b32 v115, s4, v115
    v_xor_b32 v117, s4, v117
    v_xor_b32 v119, s4, v119
    v_xor_b32 v121, s4, v121
    v_xor_b32 v123, s4, v123
    v_xor_b32 v125, s4, v125
    v_xor_b32_e64 v127, s4, v127
    v_cndmask_b32 v124, 0, v124, s[86:87]
    v_cndmask_b32 v126, 0, v126, s[86:87]
    v_or3_b32 v113, v113, v115, v117
    v_or3_b32 v119, v119, v121, v123
    v_or3_b32 v113, v113, v125, v127
    v_or_b32 v113, v113, v119
    v_cmp_ne_u32 vcc, 0, v113
    v_add_f32 v128, v112, v116
    v_add_f32 v129, v120, v124
    v_add_f32 v130, v114, v118
    v_add_f32 v131, v122, v126
    s_cbranch_vccnz Lst_P_6
    s_nop 3
Lstd_P_7:
    v_add_f32 v128, v128, v129
    v_add_f32 v130, v130, v131
    v_mov_b32 v136, v128
    v_mov_b32 v138, v130
    s_nop 0
    v_permlane32_swap_b32 v128, v136
    v_permlane32_swap_b32 v130, v138
    v_add_f32 v128, v128, v136
    v_add_f32_e64 v130, v130, v138
    v_mul_f32 v133, 0x3b124925, v128
    v_mul_f32 v130, 0x3b124925, v130
    v_fma_f32 v130, -v133, v133, v130
    v_max_f32_e64 v130, 0, v130
    v_add_f32 v135, 0x3727c5ac, v130
    v_rsq_f32 v135, v135
    s_nop 0
    v_mul_f32_e64 v130, v130, v135
    v_fmaak_f32 v130, v130, v135, 0x3727c5ac
    v_rsq_f32 v130, v130
    s_nop 0
    v_mul_f32 v135, v135, v130
    s_lshl_b32 s60, s3, 8
    v_lshl_add_u32 v66, v67, 2, s60
    ds_write_b32 v66, v133 offset:1024
    ds_write_b32 v66, v135 offset:1152
    v_lshrrev_b32 v66, 5, v1
    v_lshl_add_u32 v66, v66, 4, s60
    s_waitcnt lgkmcnt(0)
    ds_read_b128 v[140:143], v66 offset:1024
    ds_read_b128 v[156:159], v66 offset:1152
    ds_read_b128 v[144:147], v66 offset:1056
    ds_read_b128 v[160:163], v66 offset:1184
    ds_read_b128 v[148:151], v66 offset:1088
    ds_read_b128 v[164:167], v66 offset:1216
    ds_read_b128 v[152:155], v66 offset:1120
    ds_read_b128 v[168:171], v66 offset:1248
    s_waitcnt lgkmcnt(7)
    v_pk_add_f32 v[192:193], v[192:193], v[140:141] neg_lo:[0,1] neg_hi:[0,1]
    v_pk_add_f32 v[194:195], v[194:195], v[142:143] neg_lo:[0,1] neg_hi:[0,1]
    s_waitcnt lgkmcnt(5)
    v_pk_add_f32 v[196:197], v[196:197], v[144:145] neg_lo:[0,1] neg_hi:[0,1]
    v_pk_add_f32 v[198:199], v[198:199], v[146:147] neg_lo:[0,1] neg_hi:[0,1]
    v_pk_mul_f32 v[192:193], v[192:193], v[156:157]
    v_pk_mul_f32 v[194:195], v[194:195], v[158:159]
    s_waitcnt lgkmcnt(4)
    v_pk_mul_f32 v[196:197], v[196:197], v[160:161]
    v_pk_mul_f32 v[198:199], v[198:199], v[162:163]
    v_cvt_pk_bf16_f32 v84, v192, v193
    v_cvt_pk_bf16_f32 v85, v194, v195
    v_cvt_pk_bf16_f32 v86, v196, v197
    v_cvt_pk_bf16_f32 v87, v198, v199
    buffer_store_dwordx4 v[84:87], v4, s[40:43], s61 offen offset:0 sc1
    s_waitcnt lgkmcnt(3)
    v_pk_add_f32 v[200:201], v[200:201], v[148:149] neg_lo:[0,1] neg_hi:[0,1]
    v_pk_add_f32 v[202:203], v[202:203], v[150:151] neg_lo:[0,1] neg_hi:[0,1]
    s_waitcnt lgkmcnt(1)
    v_pk_add_f32 v[204:205], v[204:205], v[152:153] neg_lo:[0,1] neg_hi:[0,1]
    v_pk_add_f32 v[206:207], v[206:207], v[154:155] neg_lo:[0,1] neg_hi:[0,1]
    v_pk_mul_f32 v[200:201], v[200:201], v[164:165]
    v_pk_mul_f32 v[202:203], v[202:203], v[166:167]
    s_waitcnt lgkmcnt(0)
    v_pk_mul_f32 v[204:205], v[204:205], v[168:169]
    v_pk_mul_f32 v[206:207], v[206:207], v[170:171]
    v_cvt_pk_bf16_f32 v88, v200, v201
    v_cvt_pk_bf16_f32 v89, v202, v203
    v_cvt_pk_bf16_f32 v90, v204, v205
    v_cvt_pk_bf16_f32 v91, v206, v207
    buffer_store_dwordx4 v[88:91], v4, s[40:43], s61 offen offset:1024 sc1
    ds_read_b64_tr_b16 a[208:209], v215 offset:16384
    ds_read_b64_tr_b16 a[210:211], v215 offset:17408
    ds_read_b64_tr_b16 a[212:213], v216 offset:16384
    ds_read_b64_tr_b16 a[214:215], v216 offset:17408
    ds_read_b64_tr_b16 a[216:217], v215 offset:18432
    ds_read_b64_tr_b16 a[218:219], v215 offset:19456
    ds_read_b64_tr_b16 a[220:221], v216 offset:18432
    ds_read_b64_tr_b16 a[222:223], v216 offset:19456
    ds_read_b64_tr_b16 a[224:225], v215 offset:20480
    ds_read_b64_tr_b16 a[226:227], v215 offset:21504
    ds_read_b64_tr_b16 a[228:229], v216 offset:20480
    ds_read_b64_tr_b16 a[230:231], v216 offset:21504
    ds_read_b64_tr_b16 a[232:233], v215 offset:22528
    ds_read_b64_tr_b16 a[234:235], v215 offset:23552
    ds_read_b64_tr_b16 a[236:237], v216 offset:22528
    ds_read_b64_tr_b16 a[238:239], v216 offset:23552
    ds_read_b64_tr_b16 a[240:241], v215 offset:24576
    ds_read_b64_tr_b16 a[242:243], v215 offset:25600
    ds_read_b64_tr_b16 a[244:245], v216 offset:24576
    ds_read_b64_tr_b16 a[246:247], v216 offset:25600
    ds_read_b64_tr_b16 a[248:249], v215 offset:26624
    ds_read_b64_tr_b16 a[250:251], v215 offset:27648
    ds_read_b64_tr_b16 a[252:253], v216 offset:26624
    ds_read_b64_tr_b16 a[254:255], v216 offset:27648
    ds_read_b64_tr_b16 a[0:1], v215 offset:28672
    ds_read_b64_tr_b16 a[2:3], v215 offset:29696
    ds_read_b64_tr_b16 a[4:5], v216 offset:28672
    ds_read_b64_tr_b16 a[6:7], v216 offset:29696
    ds_read_b64_tr_b16 a[8:9], v215 offset:30720
    ds_read_b64_tr_b16 a[10:11], v215 offset:31744
    ds_read_b64_tr_b16 a[12:13], v216 offset:30720
    ds_read_b64_tr_b16 a[14:15], v216 offset:31744
    ds_read_b64_tr_b16 a[16:17], v215 offset:0
    ds_read_b64_tr_b16 a[18:19], v215 offset:1024
    ds_read_b64_tr_b16 a[20:21], v216 offset:0
    ds_read_b64_tr_b16 a[22:23], v216 offset:1024
    ds_read_b64_tr_b16 a[24:25], v215 offset:2048
    ds_read_b64_tr_b16 a[26:27], v215 offset:3072
    ds_read_b64_tr_b16 a[28:29], v216 offset:2048
    ds_read_b64_tr_b16 a[30:31], v216 offset:3072
    ds_read_b64_tr_b16 a[32:33], v215 offset:4096
    ds_read_b64_tr_b16 a[34:35], v215 offset:5120
    ds_read_b64_tr_b16 a[36:37], v216 offset:4096
    ds_read_b64_tr_b16 a[38:39], v216 offset:5120
    ds_read_b64_tr_b16 a[40:41], v215 offset:6144
    ds_read_b64_tr_b16 a[42:43], v215 offset:7168
    ds_read_b64_tr_b16 a[44:45], v216 offset:6144
    ds_read_b64_tr_b16 a[46:47], v216 offset:7168
    ds_read_b64_tr_b16 a[48:49], v215 offset:8192
    ds_read_b64_tr_b16 a[50:51], v215 offset:9216
    ds_read_b64_tr_b16 a[52:53], v216 offset:8192
    ds_read_b64_tr_b16 a[54:55], v216 offset:9216
    ds_read_b64_tr_b16 a[56:57], v215 offset:10240
    ds_read_b64_tr_b16 a[58:59], v215 offset:11264
    ds_read_b64_tr_b16 a[60:61], v216 offset:10240
    ds_read_b64_tr_b16 a[62:63], v216 offset:11264
    ds_read_b64_tr_b16 a[64:65], v215 offset:12288
    ds_read_b64_tr_b16 a[66:67], v215 offset:13312
    ds_read_b64_tr_b16 a[68:69], v216 offset:12288
    ds_read_b64_tr_b16 a[70:71], v216 offset:13312
    ds_read_b64_tr_b16 a[72:73], v215 offset:14336
    ds_read_b64_tr_b16 a[74:75], v215 offset:15360
    ds_read_b64_tr_b16 a[76:77], v216 offset:14336
    ds_read_b64_tr_b16 a[78:79], v216 offset:15360
    s_waitcnt vmcnt(0)
    v_mov_b32 v8, s4
    s_mov_b64 exec, 1
    buffer_store_dword v8, v9, s[40:43], s81 offen sc1
    s_mov_b64 exec, -1
    s_waitcnt lgkmcnt(4)
    s_add_u32 m0, s70, 12288
    s_mul_i32 s73, s100, 56
    s_add_u32 s73, s73, 114688
    buffer_load_dwordx4 v213, s[20:23], s73 offen lds
    s_add_u32 m0, s70, 13312
    s_mul_i32 s73, s100, 56
    s_add_u32 s73, s73, 143360
    buffer_load_dwordx4 v213, s[20:23], s73 offen lds
    s_waitcnt lgkmcnt(0)
    s_add_u32 m0, s70, 14336
    s_mul_i32 s73, s100, 56
    s_add_u32 s73, s73, 172032
    buffer_load_dwordx4 v213, s[20:23], s73 offen lds
    s_add_u32 m0, s70, 15360
    s_mul_i32 s73, s100, 56
    s_add_u32 s73, s73, 200704
    buffer_load_dwordx4 v213, s[20:23], s73 offen lds
    s_add_u32 m0, s70, 16384
    s_mul_i32 s73, s101, 56
    s_add_u32 s73, s73, 0
    buffer_load_dwordx4 v213, s[20:23], s73 offen lds
    s_add_u32 m0, s70, 17408
    s_mul_i32 s73, s101, 56
    s_add_u32 s73, s73, 28672
    buffer_load_dwordx4 v213, s[20:23], s73 offen lds
    s_add_u32 m0, s70, 18432
    s_mul_i32 s73, s101, 56
    s_add_u32 s73, s73, 57344
    buffer_load_dwordx4 v213, s[20:23], s73 offen lds
    s_add_u32 m0, s70, 19456
    s_mul_i32 s73, s101, 56
    s_add_u32 s73, s73, 86016
    buffer_load_dwordx4 v213, s[20:23], s73 offen lds
    s_add_u32 m0, s70, 20480
    s_mul_i32 s73, s101, 56
    s_add_u32 s73, s73, 114688
    buffer_load_dwordx4 v213, s[20:23], s73 offen lds
    s_add_u32 m0, s70, 21504
    s_mul_i32 s73, s101, 56
    s_add_u32 s73, s73, 143360
    buffer_load_dwordx4 v213, s[20:23], s73 offen lds
    s_add_u32 m0, s70, 22528
    s_mul_i32 s73, s101, 56
    s_add_u32 s73, s73, 172032
    buffer_load_dwordx4 v213, s[20:23], s73 offen lds
    s_add_u32 m0, s70, 23552
    s_mul_i32 s73, s101, 56
    s_add_u32 s73, s73, 200704
    buffer_load_dwordx4 v213, s[20:23], s73 offen lds
    s_add_u32 m0, s70, 24576
    s_mul_i32 s73, s48, 64
    s_add_u32 s73, s73, 0
    buffer_load_dwordx4 v214, s[24:27], s73 offen lds
    s_add_u32 m0, s70, 25600
    s_mul_i32 s73, s48, 64
    s_add_u32 s73, s73, 32768
    buffer_load_dwordx4 v214, s[24:27], s73 offen lds
    s_add_u32 m0, s70, 26624
    s_mul_i32 s73, s48, 64
    s_add_u32 s73, s73, 65536
    buffer_load_dwordx4 v214, s[24:27], s73 offen lds
    s_add_u32 m0, s70, 27648
    s_mul_i32 s73, s48, 64
    s_add_u32 s73, s73, 98304
    buffer_load_dwordx4 v214, s[24:27], s73 offen lds
    s_add_u32 m0, s70, 28672
    s_mul_i32 s73, s48, 64
    s_add_u32 s73, s73, 131072
    buffer_load_dwordx4 v214, s[24:27], s73 offen lds
    s_add_u32 m0, s70, 29696
    s_mul_i32 s73, s48, 64
    s_add_u32 s73, s73, 163840
    buffer_load_dwordx4 v214, s[24:27], s73 offen lds
    s_add_u32 m0, s70, 30720
    s_mul_i32 s73, s48, 64
    s_add_u32 s73, s73, 196608
    buffer_load_dwordx4 v214, s[24:27], s73 offen lds
    s_add_u32 m0, s70, 31744
    s_mul_i32 s73, s48, 64
    s_add_u32 s73, s73, 229376
    buffer_load_dwordx4 v214, s[24:27], s73 offen lds
    s_add_u32 m0, s70, 32768
    s_mul_i32 s73, s49, 64
    s_add_u32 s73, s73, 0
    buffer_load_dwordx4 v214, s[24:27], s73 offen lds
    s_add_u32 m0, s70, 33792
    s_mul_i32 s73, s49, 64
    s_add_u32 s73, s73, 32768
    buffer_load_dwordx4 v214, s[24:27], s73 offen lds
    s_add_u32 m0, s70, 34816
    s_mul_i32 s73, s49, 64
    s_add_u32 s73, s73, 65536
    buffer_load_dwordx4 v214, s[24:27], s73 offen lds
    s_add_u32 m0, s70, 35840
    s_mul_i32 s73, s49, 64
    s_add_u32 s73, s73, 98304
    buffer_load_dwordx4 v214, s[24:27], s73 offen lds
    s_lshl_b32 s71, s64, 18
    s_lshl_b32 s86, s3, 15
    s_add_u32 s71, s71, s86
    s_add_u32 s71, s71, 0x200000
    s_add_u32 s72, s71, 0x20000
    s_mul_i32 s58, s66, 229376
    s_add_u32 s58, s58, 0x3c0000
    s_lshl_b32 s86, s65, 2
    s_add_u32 s86, s86, s3
    s_lshl_b32 s86, s86, 10
    s_add_u32 s57, s58, s86
    s_mul_i32 s86, s3, 28672
    s_add_u32 s58, s58, s86
    s_add_u32 s59, s58, 114688
    v_lshrrev_b32 v208, 5, v1
    v_lshlrev_b32 v208, 3, v208
    s_lshl_b32 s86, s65, 7
    s_lshl_b32 s87, s3, 5
    s_add_u32 s86, s86, s87
    buffer_load_dwordx2 v[220:221], v208, s[28:31], s86 offen offset:0
    buffer_load_dwordx2 v[222:223], v208, s[28:31], s86 offen offset:16
    s_lshl_b32 s86, s67, 7
    s_lshr_b32 s87, s3, 1
    s_lshl_b32 s87, s87, 6
    s_add_u32 s86, s86, s87
    buffer_load_dwordx2 v[224:225], v208, s[32:35], s86 offen offset:0
    buffer_load_dwordx2 v[226:227], v208, s[32:35], s86 offen offset:16
    buffer_load_dwordx2 v[228:229], v208, s[32:35], s86 offen offset:32
    buffer_load_dwordx2 v[230:231], v208, s[32:35], s86 offen offset:48
    v_add_u32 v232, s70, v4
    s_xor_b32 s86, s3, 1
    s_mul_i32 s86, s86, 36864
    s_add_u32 s86, s86, 12288
    v_add_u32 v233, s86, v4
    s_xor_b32 s86, s3, 2
    s_mul_i32 s86, s86, 36864
    s_add_u32 s86, s86, 14336
    v_add_u32 v234, s86, v4
    s_xor_b32 s86, s3, 3
    s_mul_i32 s86, s86, 36864
    s_add_u32 s86, s86, 16384
    v_add_u32 v235, s86, v4
    v_lshrrev_b32 v208, 5, v1
    v_lshlrev_b32 v208, 9, v208
    v_and_b32 v209, 31, v1
    v_lshl_add_u32 v208, v209, 2, v208
    s_lshr_b32 s86, s3, 1
    s_lshl_b32 s86, s86, 12
    v_add_u32_e64 v208, s86, v208
    v_xor_b32 v209, 0x1000, v208
    v_add_u32_e64 v236, s70, v208
    v_add_u32 v237, s70, v209
    s_lshl_b32 s86, s3, 11
    s_add_u32 s86, s86, 12288
    v_add_u32_e64 v238, s86, v4
    v_add_u32 v239, 73728, v238
    v_lshrrev_b32_e64 v208, 3, v1
    v_mul_u32_u24 v212, 896, v208
    v_and_b32_e64 v208, 7, v1
    v_lshl_add_u32 v212, v208, 3, v212
    s_lshl_b32 s68, s67, 2
    s_add_u32 s68, s68, s3
    s_mul_i32 s68, s68, 14336
    s_lshl_b32 s86, s66, 7
    s_add_u32 s68, s68, s86
    s_add_u32 s69, s68, 7168
    s_mov_b32 s88, 0xc0135761
    s_mov_b32 s89, 0xc0135761
    s_mov_b32 s90, 0xbdd2d3e8
    s_mov_b32 s91, 0xffff0000
    buffer_load_dword v249, v11, s[40:43], s84 offen sc1
    s_sleep 3
    buffer_load_dword v250, v11, s[40:43], s84 offen sc1
    s_sleep 3
    s_nop 0
Lpoll_P_8:
    s_sub_u32 s6, s6, 1
    s_cbranch_scc1 L_end_P
    buffer_load_dword v251, v11, s[40:43], s84 offen sc1
    s_waitcnt vmcnt(2)
    v_cmp_ne_u32_e64 vcc, s4, v249
    s_nop 1
    s_cbranch_vccz Lpd_P_9
    buffer_load_dword v249, v11, s[40:43], s84 offen sc1
    s_waitcnt vmcnt(2)
    v_cmp_ne_u32 vcc, s4, v250
    s_nop 1
    s_cbranch_vccz Lpd_P_9
    buffer_load_dword v250, v11, s[40:43], s84 offen sc1
    s_waitcnt vmcnt(2)
    v_cmp_ne_u32 vcc, s4, v251
    s_nop 1
    s_cbranch_vccnz Lpoll_P_8
    s_nop 1
Lpd_P_9:
    s_add_u32 s56, s71, s94
    buffer_load_dwordx4 v[80:83], v5, s[40:43], s56 offen offset:0 sc1
    buffer_load_dwordx4 v[84:87], v5, s[40:43], s56 offen offset:1024 sc1
    buffer_load_dwordx4 v[88:91], v5, s[40:43], s56 offen offset:2048 sc1
    buffer_load_dwordx4 v[92:95], v5, s[40:43], s56 offen offset:3072 sc1
    s_add_u32 s56, s71, s95
    buffer_load_dwordx4 v[96:99], v5, s[40:43], s56 offen offset:0 sc1
    buffer_load_dwordx4 v[100:103], v5, s[40:43], s56 offen offset:1024 sc1
    buffer_load_dwordx4 v[104:107], v5, s[40:43], s56 offen offset:2048 sc1
    buffer_load_dwordx4 v[108:111], v5, s[40:43], s56 offen offset:3072 sc1
    v_lshlrev_b32 v16, 16, v220
    v_and_b32 v17, s91, v220
    v_lshlrev_b32 v18, 16, v221
    v_and_b32 v19, s91, v221
    v_lshlrev_b32 v20, 16, v222
    v_and_b32 v21, s91, v222
    v_lshlrev_b32 v22, 16, v223
    v_and_b32_e64 v23, s91, v223
    v_mov_b64 v[24:25], 0
    v_mov_b64 v[26:27], 0
    v_mov_b64 v[28:29], 0
    v_mov_b64 v[30:31], 0
    ds_read_b64_tr_b16 a[80:81], v215 offset:12288
    ds_read_b64_tr_b16 a[82:83], v215 offset:13312
    ds_read_b64_tr_b16 a[84:85], v216 offset:12288
    ds_read_b64_tr_b16 a[86:87], v216 offset:13312
    ds_read_b64_tr_b16 a[88:89], v215 offset:14336
    ds_read_b64_tr_b16 a[90:91], v215 offset:15360
    ds_read_b64_tr_b16 a[92:93], v216 offset:14336
    ds_read_b64_tr_b16 a[94:95], v216 offset:15360
    ds_read_b64_tr_b16 a[96:97], v215 offset:16384
    ds_read_b64_tr_b16 a[98:99], v215 offset:17408
    ds_read_b64_tr_b16 a[100:101], v216 offset:16384
    ds_read_b64_tr_b16 a[102:103], v216 offset:17408
    ds_read_b64_tr_b16 a[104:105], v215 offset:18432
    ds_read_b64_tr_b16 a[106:107], v215 offset:19456
    ds_read_b64_tr_b16 a[108:109], v216 offset:18432
    ds_read_b64_tr_b16 a[110:111], v216 offset:19456
    ds_read_b64_tr_b16 a[112:113], v215 offset:20480
    ds_read_b64_tr_b16 a[114:115], v215 offset:21504
    ds_read_b64_tr_b16 a[116:117], v216 offset:20480
    ds_read_b64_tr_b16 a[118:119], v216 offset:21504
    ds_read_b64_tr_b16 a[120:121], v215 offset:22528
    ds_read_b64_tr_b16 a[122:123], v215 offset:23552
    ds_read_b64_tr_b16 a[124:125], v216 offset:22528
    ds_read_b64_tr_b16 a[126:127], v216 offset:23552
    v_mov_b32 v9, v5
    s_add_u32 s56, s71, s96
    buffer_load_dwordx4 v[112:115], v5, s[40:43], s56 offen offset:0 sc1
    buffer_load_dwordx4 v[116:119], v5, s[40:43], s56 offen offset:1024 sc1
    s_waitcnt vmcnt(9)
    v_mfma_f32_32x32x16_bf16 v[16:31], a[128:131], v[80:83], v[16:31]
    v_mfma_f32_32x32x16_bf16 v[32:47], a[132:135], v[80:83], 0
    buffer_load_dwordx4 v[120:123], v5, s[40:43], s56 offen offset:2048 sc1
    s_waitcnt vmcnt(9)
    v_mfma_f32_32x32x16_bf16 v[16:31], a[136:139], v[84:87], v[16:31]
    v_mfma_f32_32x32x16_bf16 v[32:47], a[140:143], v[84:87], v[32:47]
    buffer_load_dwordx4 v[124:127], v5, s[40:43], s56 offen offset:3072 sc1
    s_waitcnt vmcnt(9)
    v_mfma_f32_32x32x16_bf16 v[16:31], a[144:147], v[88:91], v[16:31]
    v_mfma_f32_32x32x16_bf16 v[32:47], a[148:151], v[88:91], v[32:47]
    s_add_u32 s56, s71, s97
    buffer_load_dwordx4 v[128:131], v5, s[40:43], s56 offen offset:0 sc1
    s_waitcnt vmcnt(9)
    v_mfma_f32_32x32x16_bf16 v[16:31], a[152:155], v[92:95], v[16:31]
    v_mfma_f32_32x32x16_bf16 v[32:47], a[156:159], v[92:95], v[32:47]
    buffer_load_dwordx4 v[132:135], v5, s[40:43], s56 offen offset:1024 sc1
    s_waitcnt vmcnt(9)
    v_mfma_f32_32x32x16_bf16 v[16:31], a[160:163], v[96:99], v[16:31]
    v_mfma_f32_32x32x16_bf16 v[32:47], a[164:167], v[96:99], v[32:47]
    buffer_load_dwordx4 v[136:139], v5, s[40:43], s56 offen offset:2048 sc1
    s_waitcnt vmcnt(9)
    v_mfma_f32_32x32x16_bf16 v[16:31], a[168:171], v[100:103], v[16:31]
    v_mfma_f32_32x32x16_bf16 v[32:47], a[172:175], v[100:103], v[32:47]
    buffer_load_dwordx4 v[140:143], v5, s[40:43], s56 offen offset:3072 sc1
    s_waitcnt vmcnt(9)
    v_mfma_f32_32x32x16_bf16 v[16:31], a[176:179], v[104:107], v[16:31]
    v_mfma_f32_32x32x16_bf16 v[32:47], a[180:183], v[104:107], v[32:47]
    s_add_u32 s56, s71, s98
    buffer_load_dwordx4 v[144:147], v5, s[40:43], s56 offen offset:0 sc1
    s_waitcnt vmcnt(9)
    v_mfma_f32_32x32x16_bf16 v[16:31], a[184:187], v[108:111], v[16:31]
    v_mfma_f32_32x32x16_bf16 v[32:47], a[188:191], v[108:111], v[32:47]
    buffer_load_dwordx4 v[148:151], v5, s[40:43], s56 offen offset:1024 sc1
    s_waitcnt vmcnt(9)
    v_mfma_f32_32x32x16_bf16 v[16:31], a[192:195], v[112:115], v[16:31]
    v_mfma_f32_32x32x16_bf16 v[32:47], a[196:199], v[112:115], v[32:47]
    buffer_load_dwordx4 v[152:155], v5, s[40:43], s56 offen offset:2048 sc1
    s_waitcnt vmcnt(9)
    v_mfma_f32_32x32x16_bf16 v[16:31], a[200:203], v[116:119], v[16:31]
    v_mfma_f32_32x32x16_bf16 v[32:47], a[204:207], v[116:119], v[32:47]
    buffer_load_dwordx4 v[156:159], v5, s[40:43], s56 offen offset:3072 sc1
    s_waitcnt vmcnt(9)
    v_mfma_f32_32x32x16_bf16 v[16:31], a[208:211], v[120:123], v[16:31]
    v_mfma_f32_32x32x16_bf16 v[32:47], a[212:215], v[120:123], v[32:47]
    s_waitcnt lgkmcnt(15)
    s_add_u32 m0, s70, 12288
    s_mul_i32 s73, s49, 64
    s_add_u32 s73, s73, 131072
    buffer_load_dwordx4 v214, s[24:27], s73 offen lds
    s_add_u32 m0, s70, 13312
    s_mul_i32 s73, s49, 64
    s_add_u32 s73, s73, 163840
    buffer_load_dwordx4 v214, s[24:27], s73 offen lds
    s_add_u32 s56, s71, s99
    buffer_load_dwordx4 v[160:163], v5, s[40:43], s56 offen offset:0 sc1
    s_waitcnt vmcnt(11)
    v_mfma_f32_32x32x16_bf16 v[16:31], a[216:219], v[124:127], v[16:31]
    v_mfma_f32_32x32x16_bf16 v[32:47], a[220:223], v[124:127], v[32:47]
    s_add_u32 m0, s70, 14336
    s_mul_i32 s73, s49, 64
    s_add_u32 s73, s73, 196608
    buffer_load_dwordx4 v214, s[24:27], s73 offen lds
    s_add_u32 m0, s70, 15360
    s_mul_i32 s73, s49, 64
    s_add_u32 s73, s73, 229376
    buffer_load_dwordx4 v214, s[24:27], s73 offen lds
    buffer_load_dwordx4 v[164:167], v5, s[40:43], s56 offen offset:1024 sc1
    s_waitcnt vmcnt(13)
    v_mfma_f32_32x32x16_bf16 v[16:31], a[224:227], v[128:131], v[16:31]
    v_mfma_f32_32x32x16_bf16 v[32:47], a[228:231], v[128:131], v[32:47]
    s_waitcnt lgkmcnt(12)
    s_add_u32 m0, s70, 16384
    s_mul_i32 s73, s50, 64
    s_add_u32 s73, s73, 0
    buffer_load_dwordx4 v214, s[24:27], s73 offen lds
    s_add_u32 m0, s70, 17408
    s_mul_i32 s73, s50, 64
    s_add_u32 s73, s73, 32768
    buffer_load_dwordx4 v214, s[24:27], s73 offen lds
    buffer_load_dwordx4 v[168:171], v5, s[40:43], s56 offen offset:2048 sc1
    s_waitcnt vmcnt(15)
    v_mfma_f32_32x32x16_bf16 v[16:31], a[232:235], v[132:135], v[16:31]
    v_mfma_f32_32x32x16_bf16 v[32:47], a[236:239], v[132:135], v[32:47]
    s_waitcnt lgkmcnt(8)
    s_add_u32 m0, s70, 18432
    s_mul_i32 s73, s50, 64
    s_add_u32 s73, s73, 65536
    buffer_load_dwordx4 v214, s[24:27], s73 offen lds
    s_add_u32 m0, s70, 19456
    s_mul_i32 s73, s50, 64
    s_add_u32 s73, s73, 98304
    buffer_load_dwordx4 v214, s[24:27], s73 offen lds
    buffer_load_dwordx4 v[172:175], v5, s[40:43], s56 offen offset:3072 sc1
    s_waitcnt vmcnt(17)
    v_mfma_f32_32x32x16_bf16 v[16:31], a[240:243], v[136:139], v[16:31]
    v_mfma_f32_32x32x16_bf16 v[32:47], a[244:247], v[136:139], v[32:47]
    s_waitcnt lgkmcnt(4)
    s_add_u32 m0, s70, 20480
    s_mul_i32 s73, s50, 64
    s_add_u32 s73, s73, 131072
    buffer_load_dwordx4 v214, s[24:27], s73 offen lds
    s_add_u32 m0, s70, 21504
    s_mul_i32 s73, s50, 64
    s_add_u32 s73, s73, 163840
    buffer_load_dwordx4 v214, s[24:27], s73 offen lds
    s_add_u32 s56, s71, s100
    buffer_load_dwordx4 v[176:179], v5, s[40:43], s56 offen offset:0 sc1
    s_waitcnt vmcnt(19)
    v_mfma_f32_32x32x16_bf16 v[16:31], a[248:251], v[140:143], v[16:31]
    v_mfma_f32_32x32x16_bf16 v[32:47], a[252:255], v[140:143], v[32:47]
    s_waitcnt lgkmcnt(0)
    s_add_u32 m0, s70, 22528
    s_mul_i32 s73, s50, 64
    s_add_u32 s73, s73, 196608
    buffer_load_dwordx4 v214, s[24:27], s73 offen lds
    s_add_u32 m0, s70, 23552
    s_mul_i32 s73, s50, 64
    s_add_u32 s73, s73, 229376
    buffer_load_dwordx4 v214, s[24:27], s73 offen lds
    buffer_load_dwordx4 v[180:183], v5, s[40:43], s56 offen offset:1024 sc1
    s_waitcnt vmcnt(21)
    v_mfma_f32_32x32x16_bf16 v[16:31], a[0:3], v[144:147], v[16:31]
    v_mfma_f32_32x32x16_bf16 v[32:47], a[4:7], v[144:147], v[32:47]
    s_barrier
    buffer_load_dwordx4 v[184:187], v5, s[40:43], s56 offen offset:2048 sc1
    s_waitcnt vmcnt(21)
    v_mfma_f32_32x32x16_bf16 v[16:31], a[8:11], v[148:151], v[16:31]
    v_mfma_f32_32x32x16_bf16 v[32:47], a[12:15], v[148:151], v[32:47]
    buffer_load_dwordx4 v[188:191], v5, s[40:43], s56 offen offset:3072 sc1
    s_waitcnt vmcnt(21)
    v_mfma_f32_32x32x16_bf16 v[16:31], a[16:19], v[152:155], v[16:31]
    v_mfma_f32_32x32x16_bf16 v[32:47], a[20:23], v[152:155], v[32:47]
    s_add_u32 s56, s71, s101
    buffer_load_dwordx4 v[192:195], v5, s[40:43], s56 offen offset:0 sc1
    s_waitcnt vmcnt(21)
    v_mfma_f32_32x32x16_bf16 v[16:31], a[24:27], v[156:159], v[16:31]
    v_mfma_f32_32x32x16_bf16 v[32:47], a[28:31], v[156:159], v[32:47]
    buffer_load_dwordx4 v[196:199], v5, s[40:43], s56 offen offset:1024 sc1
    s_waitcnt vmcnt(19)
    v_mfma_f32_32x32x16_bf16 v[16:31], a[32:35], v[160:163], v[16:31]
    v_mfma_f32_32x32x16_bf16 v[32:47], a[36:39], v[160:163], v[32:47]
    v_lshlrev_b32 v48, 16, v220
    v_and_b32 v49, s91, v220
    v_lshlrev_b32 v50, 16, v221
    v_and_b32 v51, s91, v221
    buffer_load_dwordx4 v[200:203], v5, s[40:43], s56 offen offset:2048 sc1
    s_waitcnt vmcnt(17)
    v_mfma_f32_32x32x16_bf16 v[16:31], a[40:43], v[164:167], v[16:31]
    v_mfma_f32_32x32x16_bf16 v[32:47], a[44:47], v[164:167], v[32:47]
    v_lshlrev_b32 v52, 16, v222
    v_and_b32 v53, s91, v222
    v_lshlrev_b32_e64 v54, 16, v223
    v_and_b32 v55, s91, v223
    buffer_load_dwordx4 v[204:207], v5, s[40:43], s56 offen offset:3072 sc1
    s_waitcnt vmcnt(15)
    v_mfma_f32_32x32x16_bf16 v[16:31], a[48:51], v[168:171], v[16:31]
    v_mfma_f32_32x32x16_bf16 v[32:47], a[52:55], v[168:171], v[32:47]
    v_mov_b64 v[56:57], 0
    v_mov_b64 v[58:59], 0
    v_mov_b64 v[60:61], 0
    v_mov_b64 v[62:63], 0
    s_add_u32 s56, s72, s94
    buffer_load_dwordx4 v[80:83], v5, s[40:43], s56 offen offset:0 sc1
    s_waitcnt vmcnt(13)
    v_mfma_f32_32x32x16_bf16 v[16:31], a[56:59], v[172:175], v[16:31]
    v_mfma_f32_32x32x16_bf16 v[32:47], a[60:63], v[172:175], v[32:47]
    buffer_load_dwordx4 v[84:87], v5, s[40:43], s56 offen offset:1024 sc1
    s_waitcnt vmcnt(11)
    v_mfma_f32_32x32x16_bf16 v[16:31], a[64:67], v[176:179], v[16:31]
    v_mfma_f32_32x32x16_bf16 v[32:47], a[68:71], v[176:179], v[32:47]
    buffer_load_dwordx4 v[88:91], v5, s[40:43], s56 offen offset:2048 sc1
    s_waitcnt vmcnt(9)
    v_mfma_f32_32x32x16_bf16 v[16:31], a[72:75], v[180:183], v[16:31]
    v_mfma_f32_32x32x16_bf16 v[32:47], a[76:79], v[180:183], v[32:47]
    buffer_load_dwordx4 v[92:95], v5, s[40:43], s56 offen offset:3072 sc1
    s_waitcnt vmcnt(9)
    v_mfma_f32_32x32x16_bf16 v[16:31], a[80:83], v[184:187], v[16:31]
    v_mfma_f32_32x32x16_bf16 v[32:47], a[84:87], v[184:187], v[32:47]
    s_add_u32 s56, s72, s95
    buffer_load_dwordx4 v[96:99], v5, s[40:43], s56 offen offset:0 sc1
    s_waitcnt vmcnt(9)
    v_mfma_f32_32x32x16_bf16 v[16:31], a[88:91], v[188:191], v[16:31]
    v_mfma_f32_32x32x16_bf16 v[32:47], a[92:95], v[188:191], v[32:47]
    buffer_load_dwordx4 v[100:103], v5, s[40:43], s56 offen offset:1024 sc1
    s_waitcnt vmcnt(9)
    v_mfma_f32_32x32x16_bf16 v[16:31], a[96:99], v[192:195], v[16:31]
    v_mfma_f32_32x32x16_bf16 v[32:47], a[100:103], v[192:195], v[32:47]
    buffer_load_dwordx4 v[104:107], v5, s[40:43], s56 offen offset:2048 sc1
    s_waitcnt vmcnt(9)
    v_mfma_f32_32x32x16_bf16 v[16:31], a[104:107], v[196:199], v[16:31]
    v_mfma_f32_32x32x16_bf16 v[32:47], a[108:111], v[196:199], v[32:47]
    buffer_load_dwordx4 v[108:111], v5, s[40:43], s56 offen offset:3072 sc1
    s_waitcnt vmcnt(9)
    v_mfma_f32_32x32x16_bf16 v[16:31], a[112:115], v[200:203], v[16:31]
    v_mfma_f32_32x32x16_bf16 v[32:47], a[116:119], v[200:203], v[32:47]
    s_add_u32 s56, s72, s96
    buffer_load_dwordx4 v[112:115], v5, s[40:43], s56 offen offset:0 sc1
    s_waitcnt vmcnt(9)
    v_mfma_f32_32x32x16_bf16 v[16:31], a[120:123], v[204:207], v[16:31]
    v_mfma_f32_32x32x16_bf16 v[32:47], a[124:127], v[204:207], v[32:47]
    buffer_load_dwordx4 v[116:119], v5, s[40:43], s56 offen offset:1024 sc1
    s_waitcnt vmcnt(9)
    v_mfma_f32_32x32x16_bf16 v[48:63], a[128:131], v[80:83], v[48:63]
    v_mfma_f32_32x32x16_bf16 v[64:79], a[132:135], v[80:83], 0
    s_nop 7
    ds_write_b128 v235, v[40:43] offset:0
    ds_write_b128 v235, v[44:47] offset:1024
    ds_write_b128 v234, v[32:35] offset:0
    buffer_load_dwordx4 v[120:123], v5, s[40:43], s56 offen offset:2048 sc1
    s_waitcnt vmcnt(9)
    v_mfma_f32_32x32x16_bf16 v[48:63], a[136:139], v[84:87], v[48:63]
    v_mfma_f32_32x32x16_bf16 v[64:79], a[140:143], v[84:87], v[64:79]
    ds_write_b128 v234, v[36:39] offset:1024
    ds_write_b128 v233, v[24:27] offset:0
    ds_write_b128 v233, v[28:31] offset:1024
    buffer_load_dwordx4 v[124:127], v5, s[40:43], s56 offen offset:3072 sc1
    s_waitcnt vmcnt(9)
    v_mfma_f32_32x32x16_bf16 v[48:63], a[144:147], v[88:91], v[48:63]
    v_mfma_f32_32x32x16_bf16 v[64:79], a[148:151], v[88:91], v[64:79]
    s_waitcnt lgkmcnt(0)
    s_barrier
    ds_read_b128 v[24:27], v232 offset:0
    ds_read_b128 v[32:35], v232 offset:2048
    ds_read_b128 v[40:43], v232 offset:4096
    ds_read_b128 v[28:31], v232 offset:1024
    ds_read_b128 v[36:39], v232 offset:3072
    ds_read_b128 v[44:47], v232 offset:5120
    s_add_u32 s56, s72, s97
    buffer_load_dwordx4 v[128:131], v5, s[40:43], s56 offen offset:0 sc1
    s_waitcnt vmcnt(9)
    v_mfma_f32_32x32x16_bf16 v[48:63], a[152:155], v[92:95], v[48:63]
    v_mfma_f32_32x32x16_bf16 v[64:79], a[156:159], v[92:95], v[64:79]
    buffer_load_dwordx4 v[132:135], v5, s[40:43], s56 offen offset:1024 sc1
    s_waitcnt vmcnt(9)
    v_mfma_f32_32x32x16_bf16 v[48:63], a[160:163], v[96:99], v[48:63]
    v_mfma_f32_32x32x16_bf16 v[64:79], a[164:167], v[96:99], v[64:79]
    v_mov_b32 v211, s88
    s_waitcnt lgkmcnt(4)
    v_add_f32 v24, v24, v32
    s_waitcnt lgkmcnt(3)
    v_add_f32 v16, v16, v40
    v_add_f32 v25, v25, v33
    v_add_f32 v17, v17, v41
    v_add_f32 v26, v26, v34
    v_add_f32 v18, v18, v42
    v_add_f32 v27, v27, v35
    v_add_f32 v19, v19, v43
    s_waitcnt lgkmcnt(1)
    v_add_f32 v28, v28, v36
    s_waitcnt lgkmcnt(0)
    v_add_f32 v20, v20, v44
    v_add_f32 v29, v29, v37
    v_add_f32 v21, v21, v45
    v_add_f32 v30, v30, v38
    v_add_f32 v22, v22, v46
    v_add_f32 v31, v31, v39
    buffer_load_dwordx4 v[136:139], v5, s[40:43], s56 offen offset:2048 sc1
    s_waitcnt vmcnt(9)
    v_mfma_f32_32x32x16_bf16 v[48:63], a[168:171], v[100:103], v[48:63]
    v_mfma_f32_32x32x16_bf16 v[64:79], a[172:175], v[100:103], v[64:79]
    v_add_f32 v23, v23, v47
    v_add_f32 v16, v16, v24
    v_add_f32 v17, v17, v25
    v_add_f32 v18, v18, v26
    v_add_f32 v19, v19, v27
    v_add_f32 v20, v20, v28
    v_add_f32 v21, v21, v29
    v_add_f32 v22, v22, v30
    v_add_f32 v23, v23, v31
    v_mul_f32 v24, v16, v16
    v_mul_f32 v25, v17, v17
    v_mul_f32 v26, v18, v18
    v_mul_f32 v27, v19, v19
    v_mul_f32 v28, v20, v20
    v_mul_f32_e64 v29, v21, v21
    v_mul_f32 v30, v22, v22
    buffer_load_dwordx4 v[140:143], v5, s[40:43], s56 offen offset:3072 sc1
    s_waitcnt vmcnt(9)
    v_mfma_f32_32x32x16_bf16 v[48:63], a[176:179], v[104:107], v[48:63]
    v_mfma_f32_32x32x16_bf16 v[64:79], a[180:183], v[104:107], v[64:79]
    v_mul_f32_e64 v31, v23, v23
    v_fma_f32 v24, v24, s90, v211
    v_fma_f32 v25, v25, s90, v211
    v_fma_f32 v26, v26, s90, v211
    v_fma_f32 v27, v27, s90, v211
    v_fma_f32 v28, v28, s90, v211
    v_fma_f32 v29, v29, s90, v211
    v_fma_f32 v30, v30, s90, v211
    v_fma_f32 v31, v31, s90, v211
    v_mul_f32 v24, v24, v16
    v_mul_f32 v25, v25, v17
    v_mul_f32 v26, v26, v18
    v_mul_f32 v27, v27, v19
    v_mul_f32 v28, v28, v20
    v_mul_f32 v29, v29, v21
    v_mul_f32_e64 v30, v30, v22
    s_add_u32 s56, s72, s98
    buffer_load_dwordx4 v[144:147], v5, s[40:43], s56 offen offset:0 sc1
    s_waitcnt vmcnt(9)
    v_mfma_f32_32x32x16_bf16 v[48:63], a[184:187], v[108:111], v[48:63]
    v_mfma_f32_32x32x16_bf16 v[64:79], a[188:191], v[108:111], v[64:79]
    v_mul_f32 v31, v31, v23
    v_exp_f32 v24, v24
    v_exp_f32 v25, v25
    v_exp_f32 v26, v26
    v_exp_f32 v27, v27
    v_exp_f32 v28, v28
    v_exp_f32 v29, v29
    v_exp_f32 v30, v30
    v_exp_f32 v31, v31
    v_add_f32 v24, 1.0, v24
    v_add_f32 v25, 1.0, v25
    v_add_f32 v26, 1.0, v26
    v_add_f32 v27, 1.0, v27
    v_add_f32 v28, 1.0, v28
    v_add_f32 v29, 1.0, v29
    v_add_f32 v30, 1.0, v30
    ds_read_b64_tr_b16 a[128:129], v217 offset:24576
    ds_read_b64_tr_b16 a[130:131], v217 offset:25600
    ds_read_b64_tr_b16 a[132:133], v218 offset:24576
    ds_read_b64_tr_b16 a[134:135], v218 offset:25600
    ds_read_b64_tr_b16 a[136:137], v217 offset:26624
    ds_read_b64_tr_b16 a[138:139], v217 offset:27648
    ds_read_b64_tr_b16 a[140:141], v218 offset:26624
    ds_read_b64_tr_b16 a[142:143], v218 offset:27648
    buffer_load_dwordx4 v[148:151], v5, s[40:43], s56 offen offset:1024 sc1
    s_waitcnt vmcnt(9)
    v_mfma_f32_32x32x16_bf16 v[48:63], a[192:195], v[112:115], v[48:63]
    v_mfma_f32_32x32x16_bf16 v[64:79], a[196:199], v[112:115], v[64:79]
    v_add_f32 v31, 1.0, v31
    v_rcp_f32 v24, v24
    v_rcp_f32 v25, v25
    v_rcp_f32 v26, v26
    v_rcp_f32 v27, v27
    v_rcp_f32 v28, v28
    v_rcp_f32 v29, v29
    v_rcp_f32 v30, v30
    v_rcp_f32 v31, v31
    v_mul_f32 v24, v24, v16
    v_mul_f32 v25, v25, v17
    v_mul_f32 v26, v26, v18
    v_mul_f32 v27, v27, v19
    v_mul_f32 v28, v28, v20
    v_mul_f32 v29, v29, v21
    v_mul_f32_e64 v30, v30, v22
    ds_read_b64_tr_b16 a[144:145], v217 offset:28672
    ds_read_b64_tr_b16 a[146:147], v217 offset:29696
    ds_read_b64_tr_b16 a[148:149], v218 offset:28672
    ds_read_b64_tr_b16 a[150:151], v218 offset:29696
    ds_read_b64_tr_b16 a[152:153], v217 offset:30720
    ds_read_b64_tr_b16 a[154:155], v217 offset:31744
    ds_read_b64_tr_b16 a[156:157], v218 offset:30720
    ds_read_b64_tr_b16 a[158:159], v218 offset:31744
    buffer_load_dwordx4 v[152:155], v5, s[40:43], s56 offen offset:2048 sc1
    s_waitcnt vmcnt(9)
    v_mfma_f32_32x32x16_bf16 v[48:63], a[200:203], v[116:119], v[48:63]
    v_mfma_f32_32x32x16_bf16 v[64:79], a[204:207], v[116:119], v[64:79]
    v_mul_f32 v31, v31, v23
    v_cvt_pk_bf16_f32 v32, v24, v25
    v_cvt_pk_bf16_f32 v33, v26, v27
    v_cvt_pk_bf16_f32 v34, v28, v29
    v_cvt_pk_bf16_f32 v35, v30, v31
    buffer_store_dwordx4 v[32:35], v5, s[40:43], s57 offen sc1
    ds_read_b64_tr_b16 a[160:161], v217 offset:32768
    ds_read_b64_tr_b16 a[162:163], v217 offset:33792
    ds_read_b64_tr_b16 a[164:165], v218 offset:32768
    ds_read_b64_tr_b16 a[166:167], v218 offset:33792
    ds_read_b64_tr_b16 a[168:169], v217 offset:34816
    ds_read_b64_tr_b16 a[170:171], v217 offset:35840
    ds_read_b64_tr_b16 a[172:173], v218 offset:34816
    ds_read_b64_tr_b16 a[174:175], v218 offset:35840
    buffer_load_dwordx4 v[156:159], v5, s[40:43], s56 offen offset:3072 sc1
    s_waitcnt vmcnt(10)
    v_mfma_f32_32x32x16_bf16 v[48:63], a[208:211], v[120:123], v[48:63]
    v_mfma_f32_32x32x16_bf16 v[64:79], a[212:215], v[120:123], v[64:79]
    ds_read_b64_tr_b16 a[176:177], v217 offset:12288
    ds_read_b64_tr_b16 a[178:179], v217 offset:13312
    ds_read_b64_tr_b16 a[180:181], v218 offset:12288
    ds_read_b64_tr_b16 a[182:183], v218 offset:13312
    ds_read_b64_tr_b16 a[184:185], v217 offset:14336
    ds_read_b64_tr_b16 a[186:187], v217 offset:15360
    ds_read_b64_tr_b16 a[188:189], v218 offset:14336
    ds_read_b64_tr_b16 a[190:191], v218 offset:15360
    s_and_b32 s60, s3, 1
    s_cmp_eq_u32 s60, 0
    s_cselect_b32 s60, 1.0, 0
    v_lshlrev_b32 v16, 16, v224
    v_and_b32 v17, s91, v224
    v_lshlrev_b32 v208, 16, v240
    v_and_b32 v209, s91, v240
    v_add_f32_e64 v16, v16, v208
    s_add_u32 s56, s72, s99
    buffer_load_dwordx4 v[160:163], v5, s[40:43], s56 offen offset:0 sc1
    s_waitcnt vmcnt(10)
    v_mfma_f32_32x32x16_bf16 v[48:63], a[216:219], v[124:127], v[48:63]
    v_mfma_f32_32x32x16_bf16 v[64:79], a[220:223], v[124:127], v[64:79]
    ds_read_b64_tr_b16 a[192:193], v217 offset:16384
    ds_read_b64_tr_b16 a[194:195], v217 offset:17408
    ds_read_b64_tr_b16 a[196:197], v218 offset:16384
    ds_read_b64_tr_b16 a[198:199], v218 offset:17408
    ds_read_b64_tr_b16 a[200:201], v217 offset:18432
    ds_read_b64_tr_b16 a[202:203], v217 offset:19456
    ds_read_b64_tr_b16 a[204:205], v218 offset:18432
    ds_read_b64_tr_b16 a[206:207], v218 offset:19456
    v_add_f32 v17, v17, v209
    v_mul_f32 v16, s60, v16
    v_mul_f32 v17, s60, v17
    v_lshlrev_b32 v18, 16, v225
    v_and_b32_e64 v19, s91, v225
    v_lshlrev_b32 v210, 16, v241
    buffer_load_dwordx4 v[164:167], v5, s[40:43], s56 offen offset:1024 sc1
    s_waitcnt vmcnt(10)
    v_mfma_f32_32x32x16_bf16 v[48:63], a[224:227], v[128:131], v[48:63]
    v_mfma_f32_32x32x16_bf16 v[64:79], a[228:231], v[128:131], v[64:79]
    ds_read_b64_tr_b16 a[208:209], v217 offset:20480
    ds_read_b64_tr_b16 a[210:211], v217 offset:21504
    ds_read_b64_tr_b16 a[212:213], v218 offset:20480
    ds_read_b64_tr_b16 a[214:215], v218 offset:21504
    ds_read_b64_tr_b16 a[216:217], v217 offset:22528
    ds_read_b64_tr_b16 a[218:219], v217 offset:23552
    ds_read_b64_tr_b16 a[220:221], v218 offset:22528
    ds_read_b64_tr_b16 a[222:223], v218 offset:23552
    s_waitcnt lgkmcnt(15)
    s_add_u32 m0, s70, 24576
    s_mul_i32 s73, s51, 64
    s_add_u32 s73, s73, 0
    buffer_load_dwordx4 v214, s[24:27], s73 offen lds
    s_add_u32 m0, s70, 25600
    s_mul_i32 s73, s51, 64
    s_add_u32 s73, s73, 32768
    buffer_load_dwordx4 v214, s[24:27], s73 offen lds
    v_and_b32 v211, s91, v241
    v_add_f32 v18, v18, v210
    v_add_f32 v19, v19, v211
    v_mul_f32 v18, s60, v18
    v_mul_f32 v19, s60, v19
    v_lshlrev_b32 v20, 16, v226
    buffer_load_dwordx4 v[168:171], v5, s[40:43], s56 offen offset:2048 sc1
    s_waitcnt vmcnt(12)
    v_mfma_f32_32x32x16_bf16 v[48:63], a[232:235], v[132:135], v[48:63]
    v_mfma_f32_32x32x16_bf16 v[64:79], a[236:239], v[132:135], v[64:79]
    s_waitcnt vmcnt(6)
    v_mov_b32 v8, s4
    s_mov_b64 exec, 1
    buffer_store_dword v8, v9, s[40:43], s82 offen sc1
    s_mov_b64 exec, -1
    s_add_u32 m0, s70, 26624
    s_mul_i32 s73, s51, 64
    s_add_u32 s73, s73, 65536
    buffer_load_dwordx4 v214, s[24:27], s73 offen lds
    s_add_u32 m0, s70, 27648
    s_mul_i32 s73, s51, 64
    s_add_u32 s73, s73, 98304
    buffer_load_dwordx4 v214, s[24:27], s73 offen lds
    v_and_b32 v21, s91, v226
    v_lshlrev_b32 v208, 16, v242
    v_and_b32 v209, s91, v242
    v_add_f32 v20, v20, v208
    v_add_f32 v21, v21, v209
    v_mul_f32_e64 v20, s60, v20
    buffer_load_dwordx4 v[172:175], v5, s[40:43], s56 offen offset:3072 sc1
    v_mfma_f32_32x32x16_bf16 v[48:63], a[240:243], v[136:139], v[48:63]
    v_mfma_f32_32x32x16_bf16 v[64:79], a[244:247], v[136:139], v[64:79]
    s_add_u32 m0, s70, 28672
    s_mul_i32 s73, s51, 64
    s_add_u32 s73, s73, 131072
    buffer_load_dwordx4 v214, s[24:27], s73 offen lds
    s_add_u32 m0, s70, 29696
    s_mul_i32 s73, s51, 64
    s_add_u32 s73, s73, 163840
    buffer_load_dwordx4 v214, s[24:27], s73 offen lds
    v_mul_f32 v21, s60, v21
    v_lshlrev_b32 v22, 16, v227
    v_and_b32 v23, s91, v227
    v_lshlrev_b32 v210, 16, v243
    v_and_b32_e64 v211, s91, v243
    v_add_f32 v22, v22, v210
    s_add_u32 s56, s72, s100
    buffer_load_dwordx4 v[176:179], v5, s[40:43], s56 offen offset:0 sc1
    v_mfma_f32_32x32x16_bf16 v[48:63], a[248:251], v[140:143], v[48:63]
    v_mfma_f32_32x32x16_bf16 v[64:79], a[252:255], v[140:143], v[64:79]
    s_add_u32 m0, s70, 30720
    s_mul_i32 s73, s51, 64
    s_add_u32 s73, s73, 196608
    buffer_load_dwordx4 v214, s[24:27], s73 offen lds
    s_add_u32 m0, s70, 31744
    s_mul_i32 s73, s51, 64
    s_add_u32 s73, s73, 229376
    buffer_load_dwordx4 v214, s[24:27], s73 offen lds
    v_add_f32 v23, v23, v211
    v_mul_f32 v22, s60, v22
    v_mul_f32 v23, s60, v23
    v_lshlrev_b32 v24, 16, v228
    v_and_b32 v25, s91, v228
    v_lshlrev_b32 v208, 16, v244
    buffer_load_dwordx4 v[180:183], v5, s[40:43], s56 offen offset:1024 sc1
    v_mfma_f32_32x32x16_bf16 v[48:63], a[0:3], v[144:147], v[48:63]
    v_mfma_f32_32x32x16_bf16 v[64:79], a[4:7], v[144:147], v[64:79]
    s_add_u32 m0, s70, 32768
    s_mul_i32 s73, s52, 64
    s_add_u32 s73, s73, 0
    buffer_load_dwordx4 v214, s[24:27], s73 offen lds
    s_add_u32 m0, s70, 33792
    s_mul_i32 s73, s52, 64
    s_add_u32 s73, s73, 32768
    buffer_load_dwordx4 v214, s[24:27], s73 offen lds
    v_and_b32 v209, s91, v244
    v_add_f32 v24, v24, v208
    v_add_f32 v25, v25, v209
    v_mul_f32 v24, s60, v24
    v_mul_f32 v25, s60, v25
    v_lshlrev_b32_e64 v26, 16, v229
    buffer_load_dwordx4 v[184:187], v5, s[40:43], s56 offen offset:2048 sc1
    v_mfma_f32_32x32x16_bf16 v[48:63], a[8:11], v[148:151], v[48:63]
    v_mfma_f32_32x32x16_bf16 v[64:79], a[12:15], v[148:151], v[64:79]
    s_add_u32 m0, s70, 34816
    s_mul_i32 s73, s52, 64
    s_add_u32 s73, s73, 65536
    buffer_load_dwordx4 v214, s[24:27], s73 offen lds
    s_add_u32 m0, s70, 35840
    s_mul_i32 s73, s52, 64
    s_add_u32 s73, s73, 98304
    buffer_load_dwordx4 v214, s[24:27], s73 offen lds
    v_and_b32 v27, s91, v229
    v_lshlrev_b32 v210, 16, v245
    v_and_b32 v211, s91, v245
    v_add_f32 v26, v26, v210
    v_add_f32 v27, v27, v211
    v_mul_f32 v26, s60, v26
    buffer_load_dwordx4 v[188:191], v5, s[40:43], s56 offen offset:3072 sc1
    v_mfma_f32_32x32x16_bf16 v[48:63], a[16:19], v[152:155], v[48:63]
    v_mfma_f32_32x32x16_bf16 v[64:79], a[20:23], v[152:155], v[64:79]
    s_add_u32 m0, s70, 12288
    s_mul_i32 s73, s52, 64
    s_add_u32 s73, s73, 131072
    buffer_load_dwordx4 v214, s[24:27], s73 offen lds
    s_add_u32 m0, s70, 13312
    s_mul_i32 s73, s52, 64
    s_add_u32 s73, s73, 163840
    buffer_load_dwordx4 v214, s[24:27], s73 offen lds
    v_mul_f32 v27, s60, v27
    v_lshlrev_b32 v28, 16, v230
    v_and_b32 v29, s91, v230
    v_lshlrev_b32 v208, 16, v246
    v_and_b32 v209, s91, v246
    v_add_f32 v28, v28, v208
    buffer_load_dword v248, v12, s[40:43], s85 offen offset:0 sc1
    s_add_u32 s56, s72, s101
    buffer_load_dwordx4 v[192:195], v5, s[40:43], s56 offen offset:0 sc1
    s_waitcnt vmcnt(25)
    v_mfma_f32_32x32x16_bf16 v[48:63], a[24:27], v[156:159], v[48:63]
    v_mfma_f32_32x32x16_bf16 v[64:79], a[28:31], v[156:159], v[64:79]
    s_add_u32 m0, s70, 14336
    s_mul_i32 s73, s52, 64
    s_add_u32 s73, s73, 196608
    buffer_load_dwordx4 v214, s[24:27], s73 offen lds
    s_add_u32 m0, s70, 15360
    s_mul_i32 s73, s52, 64
    s_add_u32 s73, s73, 229376
    buffer_load_dwordx4 v214, s[24:27], s73 offen lds
    v_add_f32 v29, v29, v209
    v_mul_f32 v28, s60, v28
    v_mul_f32 v29, s60, v29
    v_lshlrev_b32 v30, 16, v231
    v_and_b32 v31, s91, v231
    v_lshlrev_b32 v210, 16, v247
    buffer_load_dwordx4 v[196:199], v5, s[40:43], s56 offen offset:1024 sc1
    s_waitcnt vmcnt(27)
    v_mfma_f32_32x32x16_bf16 v[48:63], a[32:35], v[160:163], v[48:63]
    v_mfma_f32_32x32x16_bf16 v[64:79], a[36:39], v[160:163], v[64:79]
    s_waitcnt vmcnt(24)
    ds_read_b64_tr_b16 a[224:225], v217 offset:24576
    ds_read_b64_tr_b16 a[226:227], v217 offset:25600
    ds_read_b64_tr_b16 a[228:229], v218 offset:24576
    ds_read_b64_tr_b16 a[230:231], v218 offset:25600
    v_and_b32 v211, s91, v247
    v_add_f32 v30, v30, v210
    v_add_f32 v31, v31, v211
    v_mul_f32 v30, s60, v30
    v_mul_f32 v31, s60, v31
    buffer_load_dwordx4 v[200:203], v5, s[40:43], s56 offen offset:2048 sc1
    v_mfma_f32_32x32x16_bf16 v[48:63], a[40:43], v[164:167], v[48:63]
    v_mfma_f32_32x32x16_bf16 v[64:79], a[44:47], v[164:167], v[64:79]
    s_waitcnt vmcnt(21)
    ds_read_b64_tr_b16 a[232:233], v217 offset:26624
    ds_read_b64_tr_b16 a[234:235], v217 offset:27648
    ds_read_b64_tr_b16 a[236:237], v218 offset:26624
    ds_read_b64_tr_b16 a[238:239], v218 offset:27648
    buffer_load_dwordx4 v[204:207], v5, s[40:43], s56 offen offset:3072 sc1
    v_mfma_f32_32x32x16_bf16 v[48:63], a[48:51], v[168:171], v[48:63]
    v_mfma_f32_32x32x16_bf16 v[64:79], a[52:55], v[168:171], v[64:79]
    s_waitcnt vmcnt(19)
    ds_read_b64_tr_b16 a[240:241], v217 offset:28672
    ds_read_b64_tr_b16 a[242:243], v217 offset:29696
    ds_read_b64_tr_b16 a[244:245], v218 offset:28672
    ds_read_b64_tr_b16 a[246:247], v218 offset:29696
    s_waitcnt vmcnt(6)
    v_cmp_ne_u32_e64 vcc, s4, v248
    s_nop 1
    s_cbranch_vccz Lpcd_P_11
    s_nop 1
Lpc_P_10:
    s_sub_u32 s6, s6, 1
    s_cbranch_scc1 L_end_P
    buffer_load_dword v248, v12, s[40:43], s85 offen offset:0 sc1
    s_waitcnt vmcnt(0)
    v_cmp_ne_u32 vcc, s4, v248
    s_nop 1
    s_cbranch_vccnz Lpc_P_10
Lpcd_P_11:
    s_add_u32 s56, s58, s48
    buffer_load_dwordx4 v[80:83], v4, s[40:43], s56 offen offset:0 sc1
    v_mfma_f32_32x32x16_bf16 v[48:63], a[56:59], v[172:175], v[48:63]
    v_mfma_f32_32x32x16_bf16 v[64:79], a[60:63], v[172:175], v[64:79]
    ds_read_b64_tr_b16 a[248:249], v217 offset:30720
    ds_read_b64_tr_b16 a[250:251], v217 offset:31744
    ds_read_b64_tr_b16 a[252:253], v218 offset:30720
    ds_read_b64_tr_b16 a[254:255], v218 offset:31744
    buffer_load_dwordx4 v[84:87], v4, s[40:43], s56 offen offset:1024 sc1
    v_mfma_f32_32x32x16_bf16 v[48:63], a[64:67], v[176:179], v[48:63]
    v_mfma_f32_32x32x16_bf16 v[64:79], a[68:71], v[176:179], v[64:79]
    ds_read_b64_tr_b16 a[0:1], v217 offset:32768
    ds_read_b64_tr_b16 a[2:3], v217 offset:33792
    ds_read_b64_tr_b16 a[4:5], v218 offset:32768
    ds_read_b64_tr_b16 a[6:7], v218 offset:33792
    buffer_load_dwordx4 v[88:91], v4, s[40:43], s56 offen offset:2048 sc1
    v_mfma_f32_32x32x16_bf16 v[48:63], a[72:75], v[180:183], v[48:63]
    v_mfma_f32_32x32x16_bf16 v[64:79], a[76:79], v[180:183], v[64:79]
    ds_read_b64_tr_b16 a[8:9], v217 offset:34816
    ds_read_b64_tr_b16 a[10:11], v217 offset:35840
    ds_read_b64_tr_b16 a[12:13], v218 offset:34816
    ds_read_b64_tr_b16 a[14:15], v218 offset:35840
    buffer_load_dwordx4 v[92:95], v4, s[40:43], s56 offen offset:3072 sc1
    v_mfma_f32_32x32x16_bf16 v[48:63], a[80:83], v[184:187], v[48:63]
    v_mfma_f32_32x32x16_bf16 v[64:79], a[84:87], v[184:187], v[64:79]
    ds_read_b64_tr_b16 a[16:17], v217 offset:12288
    ds_read_b64_tr_b16 a[18:19], v217 offset:13312
    ds_read_b64_tr_b16 a[20:21], v218 offset:12288
    ds_read_b64_tr_b16 a[22:23], v218 offset:13312
    s_add_u32 s56, s58, s49
    buffer_load_dwordx4 v[96:99], v4, s[40:43], s56 offen offset:0 sc1
    v_mfma_f32_32x32x16_bf16 v[48:63], a[88:91], v[188:191], v[48:63]
    v_mfma_f32_32x32x16_bf16 v[64:79], a[92:95], v[188:191], v[64:79]
    s_waitcnt vmcnt(8)
    ds_read_b64_tr_b16 a[24:25], v217 offset:14336
    ds_read_b64_tr_b16 a[26:27], v217 offset:15360
    ds_read_b64_tr_b16 a[28:29], v218 offset:14336
    ds_read_b64_tr_b16 a[30:31], v218 offset:15360
    buffer_load_dwordx4 v[100:103], v4, s[40:43], s56 offen offset:1024 sc1
    buffer_load_dwordx4 v[104:107], v4, s[40:43], s56 offen offset:2048 sc1
    buffer_load_dwordx4 v[108:111], v4, s[40:43], s56 offen offset:3072 sc1
    s_add_u32 s56, s58, s50
    buffer_load_dwordx4 v[112:115], v4, s[40:43], s56 offen offset:0 sc1
    v_mfma_f32_32x32x16_bf16 v[64:79], a[100:103], v[192:195], v[64:79]
    s_waitcnt vmcnt(11)
    v_mfma_f32_32x32x16_bf16 v[64:79], a[108:111], v[196:199], v[64:79]
    s_waitcnt vmcnt(10)
    v_mfma_f32_32x32x16_bf16 v[64:79], a[116:119], v[200:203], v[64:79]
    s_waitcnt vmcnt(9)
    v_mfma_f32_32x32x16_bf16 v[64:79], a[124:127], v[204:207], v[64:79]
    v_mfma_f32_32x32x16_bf16 v[48:63], a[96:99], v[192:195], v[48:63]
    v_mfma_f32_32x32x16_bf16 v[48:63], a[104:107], v[196:199], v[48:63]
    s_nop 9
    ds_write_b128 v235, v[72:75] offset:6144
    ds_write_b128 v235, v[76:79] offset:7168
    v_mfma_f32_32x32x16_bf16 v[48:63], a[112:115], v[200:203], v[48:63]
    ds_write_b128 v234, v[64:67] offset:6144
    ds_write_b128 v234, v[68:71] offset:7168
    v_mfma_f32_32x32x16_bf16 v[48:63], a[120:123], v[204:207], v[48:63]
    s_nop 11
    ds_write_b128 v233, v[56:59] offset:6144
    ds_write_b128 v233, v[60:63] offset:7168
    s_waitcnt lgkmcnt(0)
    s_barrier
    ds_read_b128 v[56:59], v232 offset:6144
    ds_read_b128 v[64:67], v232 offset:8192
    ds_read_b128 v[72:75], v232 offset:10240
    ds_read_b128 v[60:63], v232 offset:7168
    ds_read_b128 v[68:71], v232 offset:9216
    ds_read_b128 v[76:79], v232 offset:11264
    v_mov_b32_e64 v211, s88
    s_waitcnt lgkmcnt(4)
    v_pk_add_f32 v[56:57], v[56:57], v[64:65]
    s_waitcnt lgkmcnt(3)
    v_pk_add_f32 v[48:49], v[48:49], v[72:73]
    v_pk_add_f32 v[58:59], v[58:59], v[66:67]
    v_pk_add_f32 v[50:51], v[50:51], v[74:75]
    s_waitcnt lgkmcnt(1)
    v_pk_add_f32 v[60:61], v[60:61], v[68:69]
    s_waitcnt lgkmcnt(0)
    v_pk_add_f32 v[52:53], v[52:53], v[76:77]
    v_pk_add_f32 v[62:63], v[62:63], v[70:71]
    v_pk_add_f32 v[54:55], v[54:55], v[78:79]
    v_pk_add_f32 v[48:49], v[48:49], v[56:57]
    v_pk_add_f32 v[50:51], v[50:51], v[58:59]
    v_pk_add_f32 v[52:53], v[52:53], v[60:61]
    v_pk_add_f32 v[54:55], v[54:55], v[62:63]
    v_pk_mul_f32 v[56:57], v[48:49], v[48:49]
    v_pk_mul_f32 v[58:59], v[50:51], v[50:51]
    v_pk_mul_f32 v[60:61], v[52:53], v[52:53]
    v_pk_mul_f32 v[62:63], v[54:55], v[54:55]
    v_fma_f32 v56, v56, s90, v211
    v_fma_f32 v57, v57, s90, v211
    v_fma_f32 v58, v58, s90, v211
    v_fma_f32 v59, v59, s90, v211
    v_fma_f32 v60, v60, s90, v211
    v_fma_f32 v61, v61, s90, v211
    v_fma_f32 v62, v62, s90, v211
    v_fma_f32 v63, v63, s90, v211
    v_pk_mul_f32 v[56:57], v[56:57], v[48:49]
    v_pk_mul_f32 v[58:59], v[58:59], v[50:51]
    v_pk_mul_f32 v[60:61], v[60:61], v[52:53]
    v_pk_mul_f32 v[62:63], v[62:63], v[54:55]
    v_exp_f32 v56, v56
    v_exp_f32 v57, v57
    v_exp_f32 v58, v58
    v_exp_f32 v59, v59
    v_exp_f32 v60, v60
    v_exp_f32 v61, v61
    v_exp_f32 v62, v62
    v_exp_f32 v63, v63
    v_add_f32 v56, 1.0, v56
    v_add_f32 v57, 1.0, v57
    v_add_f32 v58, 1.0, v58
    v_add_f32 v59, 1.0, v59
    v_add_f32 v60, 1.0, v60
    v_add_f32 v61, 1.0, v61
    v_add_f32 v62, 1.0, v62
    v_add_f32 v63, 1.0, v63
    v_rcp_f32 v56, v56
    v_rcp_f32 v57, v57
    v_rcp_f32 v58, v58
    v_rcp_f32 v59, v59
    v_rcp_f32 v60, v60
    v_rcp_f32 v61, v61
    v_rcp_f32 v62, v62
    v_rcp_f32 v63, v63
    v_mul_f32 v56, v56, v48
    v_mul_f32 v57, v57, v49
    v_mul_f32 v58, v58, v50
    v_mul_f32 v59, v59, v51
    v_mul_f32 v60, v60, v52
    v_mul_f32 v61, v61, v53
    v_mul_f32 v62, v62, v54
    v_mul_f32 v63, v63, v55
    v_cvt_pk_bf16_f32 v64, v56, v57
    v_cvt_pk_bf16_f32 v65, v58, v59
    v_cvt_pk_bf16_f32 v66, v60, v61
    v_cvt_pk_bf16_f32 v67, v62, v63
    s_add_u32 s57, s57, 114688
    buffer_store_dwordx4 v[64:67], v5, s[40:43], s57 offen sc1
    s_add_u32 s82, s82, 4096
    s_add_u32 s85, s85, 4096
    buffer_load_dwordx4 v[116:119], v4, s[40:43], s56 offen offset:1024 sc1
    s_waitcnt vmcnt(10)
    v_mfma_f32_32x32x16_bf16 v[16:31], a[128:131], v[80:83], v[16:31]
    v_mfma_f32_32x32x16_bf16 v[32:47], a[132:135], v[80:83], 0
    s_add_u32 m0, s70, 16384
    s_mul_i32 s73, s53, 64
    s_add_u32 s73, s73, 0
    buffer_load_dwordx4 v214, s[24:27], s73 offen lds
    s_add_u32 m0, s70, 17408
    s_mul_i32 s73, s53, 64
    s_add_u32 s73, s73, 32768
    buffer_load_dwordx4 v214, s[24:27], s73 offen lds
    buffer_load_dwordx4 v[120:123], v4, s[40:43], s56 offen offset:2048 sc1
    s_waitcnt vmcnt(12)
    v_mfma_f32_32x32x16_bf16 v[16:31], a[136:139], v[84:87], v[16:31]
    v_mfma_f32_32x32x16_bf16 v[32:47], a[140:143], v[84:87], v[32:47]
    s_add_u32 m0, s70, 18432
    s_mul_i32 s73, s53, 64
    s_add_u32 s73, s73, 65536
    buffer_load_dwordx4 v214, s[24:27], s73 offen lds
    s_add_u32 m0, s70, 19456
    s_mul_i32 s73, s53, 64
    s_add_u32 s73, s73, 98304
    buffer_load_dwordx4 v214, s[24:27], s73 offen lds
    buffer_load_dwordx4 v[124:127], v4, s[40:43], s56 offen offset:3072 sc1
    s_waitcnt vmcnt(14)
    v_mfma_f32_32x32x16_bf16 v[16:31], a[144:147], v[88:91], v[16:31]
    v_mfma_f32_32x32x16_bf16 v[32:47], a[148:151], v[88:91], v[32:47]
    s_add_u32 m0, s70, 20480
    s_mul_i32 s73, s53, 64
    s_add_u32 s73, s73, 131072
    buffer_load_dwordx4 v214, s[24:27], s73 offen lds
    s_add_u32 m0, s70, 21504
    s_mul_i32 s73, s53, 64
    s_add_u32 s73, s73, 163840
    buffer_load_dwordx4 v214, s[24:27], s73 offen lds
    s_add_u32 s56, s58, s51
    buffer_load_dwordx4 v[128:131], v4, s[40:43], s56 offen offset:0 sc1
    s_waitcnt vmcnt(16)
    v_mfma_f32_32x32x16_bf16 v[16:31], a[152:155], v[92:95], v[16:31]
    v_mfma_f32_32x32x16_bf16 v[32:47], a[156:159], v[92:95], v[32:47]
    s_add_u32 m0, s70, 22528
    s_mul_i32 s73, s53, 64
    s_add_u32 s73, s73, 196608
    buffer_load_dwordx4 v214, s[24:27], s73 offen lds
    s_add_u32 m0, s70, 23552
    s_mul_i32 s73, s53, 64
    s_add_u32 s73, s73, 229376
    buffer_load_dwordx4 v214, s[24:27], s73 offen lds
    buffer_load_dwordx4 v[132:135], v4, s[40:43], s56 offen offset:1024 sc1
    s_waitcnt vmcnt(18)
    v_mfma_f32_32x32x16_bf16 v[16:31], a[160:163], v[96:99], v[16:31]
    v_mfma_f32_32x32x16_bf16 v[32:47], a[164:167], v[96:99], v[32:47]
    s_add_u32 m0, s70, 24576
    s_mul_i32 s73, s54, 64
    s_add_u32 s73, s73, 0
    buffer_load_dwordx4 v214, s[24:27], s73 offen lds
    s_add_u32 m0, s70, 25600
    s_mul_i32 s73, s54, 64
    s_add_u32 s73, s73, 32768
    buffer_load_dwordx4 v214, s[24:27], s73 offen lds
    s_waitcnt vmcnt(15)
    v_mov_b32 v8, s4
    s_mov_b64 exec, 1
    buffer_store_dword v8, v9, s[40:43], s82 offen sc1
    s_mov_b64 exec, -1
    buffer_load_dwordx4 v[136:139], v4, s[40:43], s56 offen offset:2048 sc1
    v_mfma_f32_32x32x16_bf16 v[16:31], a[168:171], v[100:103], v[16:31]
    v_mfma_f32_32x32x16_bf16 v[32:47], a[172:175], v[100:103], v[32:47]
    s_add_u32 m0, s70, 26624
    s_mul_i32 s73, s54, 64
    s_add_u32 s73, s73, 65536
    buffer_load_dwordx4 v214, s[24:27], s73 offen lds
    s_add_u32 m0, s70, 27648
    s_mul_i32 s73, s54, 64
    s_add_u32 s73, s73, 98304
    buffer_load_dwordx4 v214, s[24:27], s73 offen lds
    buffer_load_dwordx4 v[140:143], v4, s[40:43], s56 offen offset:3072 sc1
    v_mfma_f32_32x32x16_bf16 v[16:31], a[176:179], v[104:107], v[16:31]
    v_mfma_f32_32x32x16_bf16 v[32:47], a[180:183], v[104:107], v[32:47]
    s_add_u32 m0, s70, 28672
    s_mul_i32 s73, s54, 64
    s_add_u32 s73, s73, 131072
    buffer_load_dwordx4 v214, s[24:27], s73 offen lds
    s_add_u32 m0, s70, 29696
    s_mul_i32 s73, s54, 64
    s_add_u32 s73, s73, 163840
    buffer_load_dwordx4 v214, s[24:27], s73 offen lds
    s_and_b32 s60, s3, 1
    s_cmp_eq_u32 s60, 1
    s_cselect_b32 s60, 1.0, 0
    v_lshlrev_b32 v48, 16, v224
    v_and_b32 v49, s91, v224
    v_lshlrev_b32 v208, 16, v240
    v_and_b32_e64 v209, s91, v240
    v_add_f32 v48, v48, v208
    s_add_u32 s56, s58, s52
    buffer_load_dwordx4 v[144:147], v4, s[40:43], s56 offen offset:0 sc1
    v_mfma_f32_32x32x16_bf16 v[16:31], a[184:187], v[108:111], v[16:31]
    v_mfma_f32_32x32x16_bf16 v[32:47], a[188:191], v[108:111], v[32:47]
    s_add_u32 m0, s70, 30720
    s_mul_i32 s73, s54, 64
    s_add_u32 s73, s73, 196608
    buffer_load_dwordx4 v214, s[24:27], s73 offen lds
    s_add_u32 m0, s70, 31744
    s_mul_i32 s73, s54, 64
    s_add_u32 s73, s73, 229376
    buffer_load_dwordx4 v214, s[24:27], s73 offen lds
    v_add_f32 v49, v49, v209
    v_mul_f32 v48, s60, v48
    v_mul_f32 v49, s60, v49
    v_lshlrev_b32 v50, 16, v225
    v_and_b32_e64 v51, s91, v225
    v_lshlrev_b32 v210, 16, v241
    buffer_load_dwordx4 v[148:151], v4, s[40:43], s56 offen offset:1024 sc1
    v_mfma_f32_32x32x16_bf16 v[16:31], a[192:195], v[112:115], v[16:31]
    v_mfma_f32_32x32x16_bf16 v[32:47], a[196:199], v[112:115], v[32:47]
    s_waitcnt vmcnt(23)
    ds_read_b64_tr_b16 a[32:33], v217 offset:16384
    ds_read_b64_tr_b16 a[34:35], v217 offset:17408
    ds_read_b64_tr_b16 a[36:37], v218 offset:16384
    ds_read_b64_tr_b16 a[38:39], v218 offset:17408
    v_and_b32 v211, s91, v241
    v_add_f32 v50, v50, v210
    v_add_f32 v51, v51, v211
    v_mul_f32 v50, s60, v50
    v_mul_f32_e64 v51, s60, v51
    v_lshlrev_b32 v52, 16, v226
    buffer_load_dwordx4 v[152:155], v4, s[40:43], s56 offen offset:2048 sc1
    v_mfma_f32_32x32x16_bf16 v[16:31], a[200:203], v[116:119], v[16:31]
    v_mfma_f32_32x32x16_bf16 v[32:47], a[204:207], v[116:119], v[32:47]
    s_waitcnt vmcnt(21)
    ds_read_b64_tr_b16 a[40:41], v217 offset:18432
    ds_read_b64_tr_b16 a[42:43], v217 offset:19456
    ds_read_b64_tr_b16 a[44:45], v218 offset:18432
    ds_read_b64_tr_b16 a[46:47], v218 offset:19456
    v_and_b32 v53, s91, v226
    v_lshlrev_b32 v208, 16, v242
    v_and_b32 v209, s91, v242
    v_add_f32 v52, v52, v208
    v_add_f32_e64 v53, v53, v209
    v_mul_f32 v52, s60, v52
    buffer_load_dwordx4 v[156:159], v4, s[40:43], s56 offen offset:3072 sc1
    v_mfma_f32_32x32x16_bf16 v[16:31], a[208:211], v[120:123], v[16:31]
    v_mfma_f32_32x32x16_bf16 v[32:47], a[212:215], v[120:123], v[32:47]
    s_waitcnt vmcnt(19)
    ds_read_b64_tr_b16 a[48:49], v217 offset:20480
    ds_read_b64_tr_b16 a[50:51], v217 offset:21504
    ds_read_b64_tr_b16 a[52:53], v218 offset:20480
    ds_read_b64_tr_b16 a[54:55], v218 offset:21504
    v_mul_f32 v53, s60, v53
    v_lshlrev_b32 v54, 16, v227
    v_and_b32 v55, s91, v227
    v_lshlrev_b32 v210, 16, v243
    v_and_b32 v211, s91, v243
    v_add_f32 v54, v54, v210
    s_add_u32 s56, s58, s53
    buffer_load_dwordx4 v[160:163], v4, s[40:43], s56 offen offset:0 sc1
    v_mfma_f32_32x32x16_bf16 v[16:31], a[216:219], v[124:127], v[16:31]
    v_mfma_f32_32x32x16_bf16 v[32:47], a[220:223], v[124:127], v[32:47]
    s_waitcnt vmcnt(17)
    ds_read_b64_tr_b16 a[56:57], v217 offset:22528
    ds_read_b64_tr_b16 a[58:59], v217 offset:23552
    ds_read_b64_tr_b16 a[60:61], v218 offset:22528
    ds_read_b64_tr_b16 a[62:63], v218 offset:23552
    v_add_f32 v55, v55, v211
    v_mul_f32 v54, s60, v54
    v_mul_f32 v55, s60, v55
    v_lshlrev_b32 v56, 16, v228
    v_and_b32_e64 v57, s91, v228
    v_lshlrev_b32 v208, 16, v244
    buffer_load_dwordx4 v[164:167], v4, s[40:43], s56 offen offset:1024 sc1
    v_mfma_f32_32x32x16_bf16 v[16:31], a[224:227], v[128:131], v[16:31]
    v_mfma_f32_32x32x16_bf16 v[32:47], a[228:231], v[128:131], v[32:47]
    s_waitcnt vmcnt(15)
    ds_read_b64_tr_b16 a[64:65], v217 offset:24576
    ds_read_b64_tr_b16 a[66:67], v217 offset:25600
    ds_read_b64_tr_b16 a[68:69], v218 offset:24576
    ds_read_b64_tr_b16 a[70:71], v218 offset:25600
    v_and_b32 v209, s91, v244
    v_add_f32 v56, v56, v208
    v_add_f32 v57, v57, v209
    v_mul_f32 v56, s60, v56
    v_mul_f32 v57, s60, v57
    v_lshlrev_b32 v58, 16, v229
    buffer_load_dword v248, v12, s[40:43], s85 offen offset:0 sc1
    buffer_load_dwordx4 v[168:171], v4, s[40:43], s56 offen offset:2048 sc1
    v_mfma_f32_32x32x16_bf16 v[16:31], a[232:235], v[132:135], v[16:31]
    v_mfma_f32_32x32x16_bf16 v[32:47], a[236:239], v[132:135], v[32:47]
    s_waitcnt vmcnt(13)
    ds_read_b64_tr_b16 a[72:73], v217 offset:26624
    ds_read_b64_tr_b16 a[74:75], v217 offset:27648
    ds_read_b64_tr_b16 a[76:77], v218 offset:26624
    ds_read_b64_tr_b16 a[78:79], v218 offset:27648
    v_and_b32 v59, s91, v229
    v_lshlrev_b32 v210, 16, v245
    v_and_b32 v211, s91, v245
    v_add_f32 v58, v58, v210
    v_add_f32 v59, v59, v211
    v_mul_f32 v58, s60, v58
    buffer_load_dwordx4 v[172:175], v4, s[40:43], s56 offen offset:3072 sc1
    v_mfma_f32_32x32x16_bf16 v[16:31], a[240:243], v[136:139], v[16:31]
    v_mfma_f32_32x32x16_bf16 v[32:47], a[244:247], v[136:139], v[32:47]
    s_waitcnt vmcnt(11)
    ds_read_b64_tr_b16 a[80:81], v217 offset:28672
    ds_read_b64_tr_b16 a[82:83], v217 offset:29696
    ds_read_b64_tr_b16 a[84:85], v218 offset:28672
    ds_read_b64_tr_b16 a[86:87], v218 offset:29696
    v_mul_f32 v59, s60, v59
    v_lshlrev_b32 v60, 16, v230
    v_and_b32 v61, s91, v230
    v_lshlrev_b32 v208, 16, v246
    v_and_b32 v209, s91, v246
    v_add_f32 v60, v60, v208
    s_add_u32 s56, s58, s54
    buffer_load_dwordx4 v[176:179], v4, s[40:43], s56 offen offset:0 sc1
    v_mfma_f32_32x32x16_bf16 v[16:31], a[248:251], v[140:143], v[16:31]
    v_mfma_f32_32x32x16_bf16 v[32:47], a[252:255], v[140:143], v[32:47]
    s_waitcnt vmcnt(9)
    ds_read_b64_tr_b16 a[88:89], v217 offset:30720
    ds_read_b64_tr_b16 a[90:91], v217 offset:31744
    ds_read_b64_tr_b16 a[92:93], v218 offset:30720
    ds_read_b64_tr_b16 a[94:95], v218 offset:31744
    v_add_f32 v61, v61, v209
    v_mul_f32 v60, s60, v60
    v_mul_f32 v61, s60, v61
    v_lshlrev_b32 v62, 16, v231
    v_and_b32 v63, s91, v231
    v_lshlrev_b32 v210, 16, v247
    buffer_load_dwordx4 v[180:183], v4, s[40:43], s56 offen offset:1024 sc1
    v_mfma_f32_32x32x16_bf16 v[16:31], a[0:3], v[144:147], v[16:31]
    v_mfma_f32_32x32x16_bf16 v[32:47], a[4:7], v[144:147], v[32:47]
    v_and_b32 v211, s91, v247
    v_add_f32 v62, v62, v210
    v_add_f32 v63, v63, v211
    v_mul_f32 v62, s60, v62
    v_mul_f32 v63, s60, v63
    s_waitcnt vmcnt(4)
    v_cmp_ne_u32 vcc, s4, v248
    s_nop 1
    s_cbranch_vccz Lpcd_P_13
    s_nop 1
Lpc_P_12:
    s_sub_u32 s6, s6, 1
    s_cbranch_scc1 L_end_P
    buffer_load_dword v248, v12, s[40:43], s85 offen offset:0 sc1
    s_waitcnt vmcnt(0)
    v_cmp_ne_u32 vcc, s4, v248
    s_nop 1
    s_cbranch_vccnz Lpc_P_12
Lpcd_P_13:
    buffer_load_dwordx4 v[184:187], v4, s[40:43], s56 offen offset:2048 sc1
    v_mfma_f32_32x32x16_bf16 v[16:31], a[8:11], v[148:151], v[16:31]
    v_mfma_f32_32x32x16_bf16 v[32:47], a[12:15], v[148:151], v[32:47]
    buffer_load_dwordx4 v[188:191], v4, s[40:43], s56 offen offset:3072 sc1
    v_mfma_f32_32x32x16_bf16 v[16:31], a[16:19], v[152:155], v[16:31]
    v_mfma_f32_32x32x16_bf16 v[32:47], a[20:23], v[152:155], v[32:47]
    s_add_u32 s56, s59, s48
    buffer_load_dwordx4 v[192:195], v4, s[40:43], s56 offen offset:0 sc1
    v_mfma_f32_32x32x16_bf16 v[16:31], a[24:27], v[156:159], v[16:31]
    v_mfma_f32_32x32x16_bf16 v[32:47], a[28:31], v[156:159], v[32:47]
    buffer_load_dwordx4 v[196:199], v4, s[40:43], s56 offen offset:1024 sc1
    s_waitcnt lgkmcnt(15)
    v_mfma_f32_32x32x16_bf16 v[16:31], a[32:35], v[160:163], v[16:31]
    v_mfma_f32_32x32x16_bf16 v[32:47], a[36:39], v[160:163], v[32:47]
    buffer_load_dwordx4 v[200:203], v4, s[40:43], s56 offen offset:2048 sc1
    v_mfma_f32_32x32x16_bf16 v[16:31], a[40:43], v[164:167], v[16:31]
    v_mfma_f32_32x32x16_bf16 v[32:47], a[44:47], v[164:167], v[32:47]
    buffer_load_dwordx4 v[204:207], v4, s[40:43], s56 offen offset:3072 sc1
    s_waitcnt vmcnt(9)
    v_mfma_f32_32x32x16_bf16 v[16:31], a[48:51], v[168:171], v[16:31]
    v_mfma_f32_32x32x16_bf16 v[32:47], a[52:55], v[168:171], v[32:47]
    s_add_u32 s56, s59, s49
    buffer_load_dwordx4 v[80:83], v4, s[40:43], s56 offen offset:0 sc1
    s_waitcnt vmcnt(9)
    v_mfma_f32_32x32x16_bf16 v[16:31], a[56:59], v[172:175], v[16:31]
    v_mfma_f32_32x32x16_bf16 v[32:47], a[60:63], v[172:175], v[32:47]
    buffer_load_dwordx4 v[84:87], v4, s[40:43], s56 offen offset:1024 sc1
    s_waitcnt vmcnt(9) lgkmcnt(14)
    v_mfma_f32_32x32x16_bf16 v[16:31], a[64:67], v[176:179], v[16:31]
    s_waitcnt lgkmcnt(12)
    v_mfma_f32_32x32x16_bf16 v[32:47], a[68:71], v[176:179], v[32:47]
    buffer_load_dwordx4 v[88:91], v4, s[40:43], s56 offen offset:2048 sc1
    s_waitcnt vmcnt(9) lgkmcnt(10)
    v_mfma_f32_32x32x16_bf16 v[16:31], a[72:75], v[180:183], v[16:31]
    s_waitcnt lgkmcnt(8)
    v_mfma_f32_32x32x16_bf16 v[32:47], a[76:79], v[180:183], v[32:47]
    buffer_load_dwordx4 v[92:95], v4, s[40:43], s56 offen offset:3072 sc1
    s_waitcnt vmcnt(9) lgkmcnt(6)
    v_mfma_f32_32x32x16_bf16 v[16:31], a[80:83], v[184:187], v[16:31]
    s_waitcnt lgkmcnt(4)
    v_mfma_f32_32x32x16_bf16 v[32:47], a[84:87], v[184:187], v[32:47]
    s_add_u32 s56, s59, s50
    buffer_load_dwordx4 v[96:99], v4, s[40:43], s56 offen offset:0 sc1
    s_waitcnt vmcnt(9) lgkmcnt(2)
    v_mfma_f32_32x32x16_bf16 v[16:31], a[88:91], v[188:191], v[16:31]
    s_waitcnt lgkmcnt(0)
    v_mfma_f32_32x32x16_bf16 v[32:47], a[92:95], v[188:191], v[32:47]
    buffer_load_dwordx4 v[100:103], v4, s[40:43], s56 offen offset:1024 sc1
    s_waitcnt vmcnt(9)
    v_mfma_f32_32x32x16_bf16 v[48:63], a[128:131], v[192:195], v[48:63]
    v_mfma_f32_32x32x16_bf16 v[64:79], a[132:135], v[192:195], 0
    s_nop 7
    ds_write_b32 v237, v32 offset:0
    ds_write_b32 v237, v34 offset:256
    ds_write_b32 v237, v33 offset:128
    ds_write_b32 v237, v35 offset:384
    ds_write_b32 v237, v36 offset:1024
    ds_write_b32 v237, v38 offset:1280
    buffer_load_dwordx4 v[104:107], v4, s[40:43], s56 offen offset:2048 sc1
    s_waitcnt vmcnt(9)
    v_mfma_f32_32x32x16_bf16 v[48:63], a[136:139], v[196:199], v[48:63]
    v_mfma_f32_32x32x16_bf16 v[64:79], a[140:143], v[196:199], v[64:79]
    ds_write_b32 v237, v37 offset:1152
    ds_write_b32 v237, v39 offset:1408
    ds_write_b32 v237, v40 offset:2048
    ds_write_b32 v237, v42 offset:2304
    ds_write_b32 v237, v41 offset:2176
    ds_write_b32 v237, v43 offset:2432
    buffer_load_dwordx4 v[108:111], v4, s[40:43], s56 offen offset:3072 sc1
    s_waitcnt vmcnt(9)
    v_mfma_f32_32x32x16_bf16 v[48:63], a[144:147], v[200:203], v[48:63]
    v_mfma_f32_32x32x16_bf16 v[64:79], a[148:151], v[200:203], v[64:79]
    ds_write_b32 v237, v44 offset:3072
    ds_write_b32 v237, v46 offset:3328
    ds_write_b32 v237, v45 offset:3200
    ds_write_b32 v237, v47 offset:3456
    ds_write_b32 v236, v16 offset:0
    ds_write_b32 v236, v18 offset:256
    s_add_u32 s56, s59, s51
    buffer_load_dwordx4 v[112:115], v4, s[40:43], s56 offen offset:0 sc1
    s_waitcnt vmcnt(9)
    v_mfma_f32_32x32x16_bf16 v[48:63], a[152:155], v[204:207], v[48:63]
    v_mfma_f32_32x32x16_bf16 v[64:79], a[156:159], v[204:207], v[64:79]
    ds_write_b32 v236, v17 offset:128
    ds_write_b32 v236, v19 offset:384
    ds_write_b32 v236, v20 offset:1024
    ds_write_b32 v236, v22 offset:1280
    ds_write_b32 v236, v21 offset:1152
    ds_write_b32 v236, v23 offset:1408
    buffer_load_dwordx4 v[116:119], v4, s[40:43], s56 offen offset:1024 sc1
    s_waitcnt vmcnt(9)
    v_mfma_f32_32x32x16_bf16 v[48:63], a[160:163], v[80:83], v[48:63]
    v_mfma_f32_32x32x16_bf16 v[64:79], a[164:167], v[80:83], v[64:79]
    ds_write_b32 v236, v24 offset:2048
    ds_write_b32 v236, v26 offset:2304
    ds_write_b32 v236, v25 offset:2176
    ds_write_b32 v236, v27 offset:2432
    ds_write_b32 v236, v28 offset:3072
    ds_write_b32 v236, v30 offset:3328
    buffer_load_dwordx4 v[120:123], v4, s[40:43], s56 offen offset:2048 sc1
    s_waitcnt vmcnt(9)
    v_mfma_f32_32x32x16_bf16 v[48:63], a[168:171], v[84:87], v[48:63]
    v_mfma_f32_32x32x16_bf16 v[64:79], a[172:175], v[84:87], v[64:79]
    ds_write_b32 v236, v29 offset:3200
    ds_write_b32 v236, v31 offset:3456
    buffer_load_dwordx4 v[124:127], v4, s[40:43], s56 offen offset:3072 sc1
    s_waitcnt vmcnt(9)
    v_mfma_f32_32x32x16_bf16 v[48:63], a[176:179], v[88:91], v[48:63]
    v_mfma_f32_32x32x16_bf16 v[64:79], a[180:183], v[88:91], v[64:79]
    s_add_u32 s56, s59, s52
    buffer_load_dwordx4 v[128:131], v4, s[40:43], s56 offen offset:0 sc1
    s_waitcnt vmcnt(9)
    v_mfma_f32_32x32x16_bf16 v[48:63], a[184:187], v[92:95], v[48:63]
    v_mfma_f32_32x32x16_bf16 v[64:79], a[188:191], v[92:95], v[64:79]
    s_waitcnt lgkmcnt(0)
    s_barrier
    ds_read_b128 v[16:19], v238 offset:0
    ds_read_b128 v[20:23], v238 offset:36864
    ds_read_b128 v[24:27], v239 offset:0
    ds_read_b128 v[28:31], v239 offset:36864
    ds_read_b128 v[32:35], v238 offset:1024
    ds_read_b128 v[36:39], v238 offset:37888
    ds_read_b128 v[40:43], v239 offset:1024
    ds_read_b128 v[44:47], v239 offset:37888
    buffer_load_dwordx4 v[132:135], v4, s[40:43], s56 offen offset:1024 sc1
    s_waitcnt vmcnt(9)
    v_mfma_f32_32x32x16_bf16 v[48:63], a[192:195], v[96:99], v[48:63]
    v_mfma_f32_32x32x16_bf16 v[64:79], a[196:199], v[96:99], v[64:79]
    buffer_load_dwordx4 v[136:139], v4, s[40:43], s56 offen offset:2048 sc1
    s_waitcnt vmcnt(9)
    v_mfma_f32_32x32x16_bf16 v[48:63], a[200:203], v[100:103], v[48:63]
    v_mfma_f32_32x32x16_bf16 v[64:79], a[204:207], v[100:103], v[64:79]
    s_waitcnt lgkmcnt(6)
    v_add_f32 v16, v16, v20
    s_waitcnt lgkmcnt(4)
    v_add_f32 v24, v24, v28
    v_add_f32 v17, v17, v21
    v_add_f32 v25, v25, v29
    v_add_f32 v18, v18, v22
    v_add_f32 v26, v26, v30
    buffer_load_dwordx4 v[140:143], v4, s[40:43], s56 offen offset:3072 sc1
    s_waitcnt vmcnt(9)
    v_mfma_f32_32x32x16_bf16 v[48:63], a[208:211], v[104:107], v[48:63]
    v_mfma_f32_32x32x16_bf16 v[64:79], a[212:215], v[104:107], v[64:79]
    v_add_f32 v19, v19, v23
    v_add_f32 v27, v27, v31
    v_add_f32 v16, v16, v24
    v_add_f32 v17, v17, v25
    v_add_f32 v18, v18, v26
    v_add_f32 v19, v19, v27
    s_add_u32 s56, s59, s53
    buffer_load_dwordx4 v[144:147], v4, s[40:43], s56 offen offset:0 sc1
    s_waitcnt vmcnt(9)
    v_mfma_f32_32x32x16_bf16 v[48:63], a[216:219], v[108:111], v[48:63]
    v_mfma_f32_32x32x16_bf16 v[64:79], a[220:223], v[108:111], v[64:79]
    v_cvt_pk_bf16_f32 v20, v16, v17
    v_cvt_pk_bf16_f32 v21, v18, v19
    buffer_store_dwordx2 v[20:21], v212, s[36:39], s68 offen offset:0
    s_waitcnt lgkmcnt(2)
    v_add_f32 v32, v32, v36
    s_waitcnt lgkmcnt(0)
    v_add_f32 v40, v40, v44
    v_add_f32 v33, v33, v37
    buffer_load_dwordx4 v[148:151], v4, s[40:43], s56 offen offset:1024 sc1
    s_waitcnt vmcnt(10)
    v_mfma_f32_32x32x16_bf16 v[48:63], a[224:227], v[112:115], v[48:63]
    v_mfma_f32_32x32x16_bf16 v[64:79], a[228:231], v[112:115], v[64:79]
    v_add_f32 v41, v41, v45
    v_add_f32 v34, v34, v38
    v_add_f32 v42, v42, v46
    v_add_f32 v35, v35, v39
    v_add_f32_e64 v43, v43, v47
    v_add_f32 v32, v32, v40
    buffer_load_dwordx4 v[152:155], v4, s[40:43], s56 offen offset:2048 sc1
    s_waitcnt vmcnt(10)
    v_mfma_f32_32x32x16_bf16 v[48:63], a[232:235], v[116:119], v[48:63]
    v_mfma_f32_32x32x16_bf16 v[64:79], a[236:239], v[116:119], v[64:79]
    v_add_f32 v33, v33, v41
    v_add_f32 v34, v34, v42
    v_add_f32 v35, v35, v43
    v_cvt_pk_bf16_f32 v36, v32, v33
    v_cvt_pk_bf16_f32 v37, v34, v35
    buffer_store_dwordx2 v[36:37], v212, s[36:39], s69 offen offset:0
    buffer_load_dwordx4 v[156:159], v4, s[40:43], s56 offen offset:3072 sc1
    s_waitcnt vmcnt(11)
    v_mfma_f32_32x32x16_bf16 v[48:63], a[240:243], v[120:123], v[48:63]
    v_mfma_f32_32x32x16_bf16 v[64:79], a[244:247], v[120:123], v[64:79]
    s_add_u32 s56, s59, s54
    buffer_load_dwordx4 v[160:163], v4, s[40:43], s56 offen offset:0 sc1
    s_waitcnt vmcnt(11)
    v_mfma_f32_32x32x16_bf16 v[48:63], a[248:251], v[124:127], v[48:63]
    v_mfma_f32_32x32x16_bf16 v[64:79], a[252:255], v[124:127], v[64:79]
    buffer_load_dwordx4 v[164:167], v4, s[40:43], s56 offen offset:1024 sc1
    s_waitcnt vmcnt(11)
    v_mfma_f32_32x32x16_bf16 v[48:63], a[0:3], v[128:131], v[48:63]
    v_mfma_f32_32x32x16_bf16 v[64:79], a[4:7], v[128:131], v[64:79]
    buffer_load_dwordx4 v[168:171], v4, s[40:43], s56 offen offset:2048 sc1
    s_waitcnt vmcnt(11)
    v_mfma_f32_32x32x16_bf16 v[48:63], a[8:11], v[132:135], v[48:63]
    v_mfma_f32_32x32x16_bf16 v[64:79], a[12:15], v[132:135], v[64:79]
    buffer_load_dwordx4 v[172:175], v4, s[40:43], s56 offen offset:3072 sc1
    s_waitcnt vmcnt(11)
    v_mfma_f32_32x32x16_bf16 v[48:63], a[16:19], v[136:139], v[48:63]
    v_mfma_f32_32x32x16_bf16 v[64:79], a[20:23], v[136:139], v[64:79]
    s_waitcnt vmcnt(10)
    v_mfma_f32_32x32x16_bf16 v[48:63], a[24:27], v[140:143], v[48:63]
    v_mfma_f32_32x32x16_bf16 v[64:79], a[28:31], v[140:143], v[64:79]
    s_waitcnt vmcnt(9)
    v_mfma_f32_32x32x16_bf16 v[48:63], a[32:35], v[144:147], v[48:63]
    v_mfma_f32_32x32x16_bf16 v[64:79], a[36:39], v[144:147], v[64:79]
    s_waitcnt vmcnt(7)
    v_mfma_f32_32x32x16_bf16 v[48:63], a[40:43], v[148:151], v[48:63]
    v_mfma_f32_32x32x16_bf16 v[64:79], a[44:47], v[148:151], v[64:79]
    s_waitcnt vmcnt(6)
    v_mfma_f32_32x32x16_bf16 v[48:63], a[48:51], v[152:155], v[48:63]
    v_mfma_f32_32x32x16_bf16 v[64:79], a[52:55], v[152:155], v[64:79]
    s_waitcnt vmcnt(4)
    v_mfma_f32_32x32x16_bf16 v[48:63], a[56:59], v[156:159], v[48:63]
    v_mfma_f32_32x32x16_bf16 v[64:79], a[60:63], v[156:159], v[64:79]
    s_waitcnt vmcnt(3)
    v_mfma_f32_32x32x16_bf16 v[64:79], a[68:71], v[160:163], v[64:79]
    s_waitcnt vmcnt(2)
    v_mfma_f32_32x32x16_bf16 v[64:79], a[76:79], v[164:167], v[64:79]
    s_waitcnt vmcnt(1)
    v_mfma_f32_32x32x16_bf16 v[64:79], a[84:87], v[168:171], v[64:79]
    s_waitcnt vmcnt(0)
    v_mfma_f32_32x32x16_bf16 v[64:79], a[92:95], v[172:175], v[64:79]
    v_mfma_f32_32x32x16_bf16 v[48:63], a[64:67], v[160:163], v[48:63]
    v_mfma_f32_32x32x16_bf16 v[48:63], a[72:75], v[164:167], v[48:63]
    s_nop 9
    ds_write_b32 v237, v64 offset:8192
    ds_write_b32 v237, v66 offset:8448
    ds_write_b32 v237, v65 offset:8320
    ds_write_b32 v237, v67 offset:8576
    ds_write_b32 v237, v68 offset:9216
    ds_write_b32 v237, v70 offset:9472
    v_mfma_f32_32x32x16_bf16 v[48:63], a[80:83], v[168:171], v[48:63]
    ds_write_b32 v237, v69 offset:9344
    ds_write_b32 v237, v71 offset:9600
    ds_write_b32 v237, v72 offset:10240
    ds_write_b32 v237, v74 offset:10496
    ds_write_b32 v237, v73 offset:10368
    ds_write_b32 v237, v75 offset:10624
    v_mfma_f32_32x32x16_bf16 v[48:63], a[88:91], v[172:175], v[48:63]
    ds_write_b32 v237, v76 offset:11264
    ds_write_b32 v237, v78 offset:11520
    ds_write_b32 v237, v77 offset:11392
    ds_write_b32 v237, v79 offset:11648
    s_nop 7
    ds_write_b32 v236, v48 offset:8192
    ds_write_b32 v236, v50 offset:8448
    ds_write_b32 v236, v49 offset:8320
    ds_write_b32 v236, v51 offset:8576
    ds_write_b32 v236, v52 offset:9216
    ds_write_b32 v236, v54 offset:9472
    ds_write_b32 v236, v53 offset:9344
    ds_write_b32 v236, v55 offset:9600
    ds_write_b32 v236, v56 offset:10240
    ds_write_b32 v236, v58 offset:10496
    ds_write_b32 v236, v57 offset:10368
    ds_write_b32 v236, v59 offset:10624
    ds_write_b32 v236, v60 offset:11264
    ds_write_b32 v236, v62 offset:11520
    ds_write_b32 v236, v61 offset:11392
    ds_write_b32 v236, v63 offset:11648
    s_waitcnt lgkmcnt(0)
    s_barrier
    ds_read_b128 v[48:51], v238 offset:8192
    ds_read_b128 v[52:55], v238 offset:45056
    ds_read_b128 v[56:59], v239 offset:8192
    ds_read_b128 v[60:63], v239 offset:45056
    ds_read_b128 v[64:67], v238 offset:9216
    ds_read_b128 v[68:71], v238 offset:46080
    ds_read_b128 v[72:75], v239 offset:9216
    ds_read_b128 v[76:79], v239 offset:46080
    s_waitcnt lgkmcnt(6)
    v_pk_add_f32 v[48:49], v[48:49], v[52:53]
    s_waitcnt lgkmcnt(4)
    v_pk_add_f32 v[56:57], v[56:57], v[60:61]
    v_pk_add_f32 v[50:51], v[50:51], v[54:55]
    v_pk_add_f32 v[58:59], v[58:59], v[62:63]
    v_pk_add_f32 v[48:49], v[48:49], v[56:57]
    v_pk_add_f32 v[50:51], v[50:51], v[58:59]
    v_cvt_pk_bf16_f32 v52, v48, v49
    v_cvt_pk_bf16_f32 v53, v50, v51
    buffer_store_dwordx2 v[52:53], v212, s[36:39], s68 offen offset:64
    s_waitcnt lgkmcnt(2)
    v_pk_add_f32 v[64:65], v[64:65], v[68:69]
    s_waitcnt lgkmcnt(0)
    v_pk_add_f32 v[72:73], v[72:73], v[76:77]
    v_pk_add_f32 v[66:67], v[66:67], v[70:71]
    v_pk_add_f32 v[74:75], v[74:75], v[78:79]
    v_pk_add_f32 v[64:65], v[64:65], v[72:73]
    v_pk_add_f32 v[66:67], v[66:67], v[74:75]
    v_cvt_pk_bf16_f32 v68, v64, v65
    v_cvt_pk_bf16_f32 v69, v66, v67
    buffer_store_dwordx2 v[68:69], v212, s[36:39], s69 offen offset:64
L_end_P:
    s_endpgm

.section .rodata,"a"
.p2align 6
.amdhsa_kernel sequential_preLN__sliding_local_dilated__mixer_token_mlp__prompt_kernel
  .amdhsa_next_free_vgpr 508
  .amdhsa_next_free_sgpr 102
  .amdhsa_accum_offset 252
  .amdhsa_group_segment_fixed_size 0
  .amdhsa_kernarg_size 88
  .amdhsa_user_sgpr_count 2
  .amdhsa_user_sgpr_kernarg_segment_ptr 1
  .amdhsa_system_sgpr_workgroup_id_x 1
.end_amdhsa_kernel
```

```asm
; @launch grid=(256,1,1) block=(256,1,1) lds=163840
.amdgcn_target "amdgcn-amd-amdhsa--gfx950"
.text
.globl sequential_preLN__sliding_local_dilated__mixer_token_mlp__prompt_kernel
.p2align 8
.type sequential_preLN__sliding_local_dilated__mixer_token_mlp__prompt_kernel,@function
sequential_preLN__sliding_local_dilated__mixer_token_mlp__prompt_kernel:
    s_cmp_ge_u32 s2, 256
    s_cbranch_scc1 L_end_P
    s_load_dwordx2 s[8:9], s[0:1], 0
    s_load_dwordx2 s[12:13], s[0:1], 8
    s_load_dwordx2 s[44:45], s[0:1], 72
    s_load_dwordx2 s[40:41], s[0:1], 80
    s_load_dwordx2 s[16:17], s[0:1], 16
    s_load_dwordx2 s[20:21], s[0:1], 32
    s_load_dwordx2 s[24:25], s[0:1], 48
    s_load_dwordx2 s[28:29], s[0:1], 40
    s_load_dwordx2 s[32:33], s[0:1], 56
    s_load_dwordx2 s[36:37], s[0:1], 64
    v_lshrrev_b32 v1, 6, v0
    s_nop 0
    v_readfirstlane_b32 s3, v1
    v_and_b32 v1, 63, v0
    v_and_b32 v2, 15, v0
    v_lshrrev_b32 v3, 4, v1
    v_lshlrev_b32 v4, 4, v1
    s_mov_b32 s10, 0x1c0000
    s_mov_b32 s11, 0x00020000
    s_mov_b32 s14, 0x126000
    s_mov_b32 s15, 0x00020000
    s_mov_b32 s46, 0x100
    s_mov_b32 s47, 0x00020000
    s_mov_b32 s42, 0x610000
    s_mov_b32 s43, 0x00020000
    s_mov_b32 s18, 0x62000
    s_mov_b32 s19, 0x00020000
    s_mov_b32 s22, 0x700000
    s_mov_b32 s23, 0x00020000
    s_mov_b32 s26, 0x700000
    s_mov_b32 s27, 0x00020000
    s_mov_b32 s30, 0xe00
    s_mov_b32 s31, 0x00020000
    s_mov_b32 s34, 0x1000
    s_mov_b32 s35, 0x00020000
    s_mov_b32 s38, 0x1c0000
    s_mov_b32 s39, 0x00020000
    s_mov_b32 s5, 0x3f803f80
    s_mov_b32 s6, 0x200000
    s_bfe_u32 s48, s2, 0x20001
    s_lshl_b32 s48, s48, 2
    s_lshr_b32 s53, s2, 6
    s_add_u32 s48, s48, s53
    s_bfe_u32 s49, s2, 0x30003
    s_and_b32 s53, s2, 1
    s_lshl_b32 s53, s53, 3
    s_add_u32 s49, s49, s53
    v_lshrrev_b32_e64 v237, 2, v1
    v_mul_u32_u24 v123, 2688, v237
    v_lshrrev_b32 v237, 5, v1
    v_lshlrev_b32 v237, 1, v237
    v_and_b32 v238, 3, v1
    v_xor_b32 v237, v237, v238
    v_lshl_add_u32 v123, v237, 4, v123
    s_mul_i32 s53, s49, 56
    s_min_u32 s53, s53, 832
    s_mul_i32 s51, s3, 43008
    s_add_u32 s53, s53, s51
    v_add_u32 v123, s53, v123
    s_lshr_b32 s53, s3, 1
    s_mul_i32 s51, s53, 6144
    s_and_b32 s53, s3, 1
    s_lshl_b32 s53, s53, 10
    s_add_u32 s51, s51, s53
    v_lshrrev_b32 v237, 3, v1
    v_mul_u32_u24 v122, 896, v237
    v_and_b32 v237, 7, v1
    v_xor_b32 v237, v237, v3
    v_lshl_add_u32 v120, v237, 4, v122
    s_lshl_b32 s50, s48, 7
    s_lshl_b32 s53, s3, 5
    s_add_u32 s53, s53, s50
    s_mul_i32 s53, s53, 896
    v_xor_b32 v121, 64, v120
    v_add_u32_e64 v120, s53, v120
    s_add_u32 s53, s53, 7168
    v_add_u32 v121, s53, v121
    s_lshl_b32 s53, s3, 1
    v_xor_b32 v237, s53, v237
    v_lshl_add_u32 v122, v237, 4, v122
    s_lshl_b32 s53, s3, 2
    s_add_u32 s53, s53, s50
    s_sub_u32 s53, s53, 16
    s_mul_i32 s53, s53, 896
    s_cmp_eq_u32 s48, 0
    s_cselect_b32 s53, 0x40000000, s53
    v_add_u32 v122, s53, v122
    s_lshl_b32 s52, s3, 12
    s_add_u32 s52, s52, 63488
    s_lshl_b32 s7, s3, 9
    s_cmp_eq_u32 s3, 0
    s_cselect_b32 s54, 0xffffff00, -1
    s_mov_b32 s55, 0
    s_memrealtime s[86:87]
    v_mov_b32 v7, 0
    s_waitcnt lgkmcnt(0)
    s_or_b32 s86, s86, 1
    v_mov_b32 v6, s86
    s_or_b32 s86, s2, s3
    s_cmp_eq_u32 s86, 0
    s_cselect_b64 exec, 1, 0
    buffer_store_dword v6, v7, s[44:47], 0 offen sc1
    s_mov_b64 exec, -1
    s_add_u32 m0, s51, 12288
    s_mov_b32 s73, 0
    buffer_load_dwordx4 v123, s[12:15], s73 offen lds
    s_add_u32 m0, s51, 14336
    s_mov_b32 s73, 896
    buffer_load_dwordx4 v123, s[12:15], s73 offen lds
    s_add_u32 m0, s51, 16384
    s_mov_b32 s73, 1792
    buffer_load_dwordx4 v123, s[12:15], s73 offen lds
    s_add_u32 m0, s52, 36864
    s_mov_b32 s73, 0
    buffer_load_dwordx4 v120, s[8:11], s73 offen lds
    s_add_u32 m0, s52, 37888
    s_mov_b32 s73, 0
    buffer_load_dwordx4 v121, s[8:11], s73 offen lds
    s_add_u32 m0, s52, 38912
    s_mov_b32 s73, 14336
    buffer_load_dwordx4 v120, s[8:11], s73 offen lds
    s_add_u32 m0, s52, 39936
    s_mov_b32 s73, 14336
    buffer_load_dwordx4 v121, s[8:11], s73 offen lds
    s_add_u32 m0, s7, 98304
    s_mov_b32 s73, 0
    s_mov_b64 exec, s[54:55]
    buffer_load_dwordx4 v122, s[8:11], s73 offen lds
    s_mov_b64 exec, -1
    s_bfe_u32 s53, s2, 0x30003
    s_add_u32 s86, s53, 1
    s_lshr_b32 s86, s86, 1
    s_lshr_b32 s87, s2, 6
    s_mul_i32 s87, s87, 5
    s_add_u32 s86, s86, s87
    s_lshl_b32 s86, s86, 2
    s_add_u32 s53, s86, s3
    s_mov_b32 s56, s53
    s_mov_b32 s86, 0x2a54
    s_bitcmp1_b32 s86, s49
    s_cselect_b32 s57, 0x40000000, 0
    s_mul_i32 s86, s53, 58
    v_add_u32_e64 v237, s86, v1
    v_mul_u32_u24 v238, 43691, v237
    v_lshrrev_b32 v238, 19, v238
    v_mul_u32_u24 v239, 12, v238
    v_sub_u32 v239, v237, v239
    v_lshrrev_b32 v239, 2, v239
    v_mul_u32_u24 v239, 896, v239
    v_mul_u32_u24 v238, 2688, v238
    v_and_b32 v237, 3, v237
    v_lshlrev_b32 v237, 7, v237
    v_add3_u32 v237, v237, v238, v239
    v_add_u32 v237, s57, v237
    s_and_b32 s87, s2, 1
    s_mul_i32 s87, s87, 384
    s_add_u32 s87, s87, 172032
    s_mov_b32 exec_lo, 0xffffffff
    s_mov_b32 exec_hi, 0x3ffffff
    buffer_load_dword v232, v237, s[12:15], s87 offen
    s_mov_b64 exec, -1
    v_lshlrev_b32 v237, 7, v1
    v_add_u32 v238, s57, v237
    s_mul_i32 s86, s53, 6016
    s_bfe_u32 s87, s2, 0x20001
    s_mul_i32 s87, s87, 458752
    s_add_u32 s86, s86, s87
    s_max_u32 s86, s86, 14336
    s_sub_u32 s86, s86, 14336
    s_mov_b32 exec_hi, 0x7fff
    buffer_load_dword v233, v238, s[8:11], s86 offen
    s_getpc_b64 s[86:87]
Lpc_P:
    s_mul_i32 s53, s53, 384
    v_add_u32_e64 v237, s53, v237
    v_min_u32 v237, L_end_P-Lpc_P, v237
    s_mov_b64 exec, 7
    global_load_dword v236, v237, s[86:87]
    s_mov_b64 exec, -1
    v_mul_u32_u24 v237, 18432, v3
    v_lshl_add_u32 v237, v2, 3, v237
    v_mov_b32_e64 v238, s5
    v_add_u32 v237, 61440, v237
    ds_write2_b32 v237, v238, v238 offset0:0 offset1:1
    s_lshr_b32 s68, s2, 3
    s_mul_i32 s69, s68, 37
    s_lshr_b32 s69, s69, 8
    s_mul_i32 s64, s69, 7
    s_sub_u32 s64, s68, s64
    s_mov_b32 s66, s64
    s_and_b32 s68, s2, 7
    s_lshl_b32 s67, s68, 2
    s_add_u32 s67, s67, s69
    s_cmp_ge_u32 s69, 4
    s_cselect_b32 s67, 99, s67
    s_mul_i32 s71, s68, 3
    s_add_u32 s71, s71, 4
    s_lshl_b32 s72, s68, 2
    s_cmp_lt_u32 s68, 4
    s_cselect_b32 s65, s72, s71
    s_cselect_b32 s71, 4, 3
    s_add_u32 s65, s65, s69
    s_cmp_ge_u32 s69, s71
    s_cselect_b32 s65, 99, s65
    v_lshrrev_b32_e64 v219, 3, v1
    v_mul_u32_u24 v208, 896, v219
    v_and_b32 v219, 1, v3
    v_lshlrev_b32 v219, 2, v219
    v_and_b32 v220, 7, v1
    v_xor_b32 v219, v219, v220
    v_lshl_add_u32 v208, v219, 4, v208
    s_lshl_b32 s58, s66, 7
    s_mul_i32 s60, s3, 100352
    s_add_u32 s58, s58, s60
    v_add_u32_e64 v208, s58, v208
    s_mul_i32 s59, s3, 36864
    s_add_u32 s59, s59, 12288
    v_lshrrev_b32 v219, 5, v1
    v_lshlrev_b32 v209, 9, v219
    v_bfe_u32 v219, v1, 2, 2
    v_lshl_add_u32 v209, v219, 7, v209
    v_lshrrev_b32 v219, 1, v219
    s_and_b32 s58, s3, 1
    v_xor_b32_e64 v219, s58, v219
    v_lshl_add_u32 v209, v219, 6, v209
    v_and_b32_e64 v219, 1, v3
    v_lshl_add_u32 v209, v219, 5, v209
    v_and_b32_e64 v219, 3, v1
    v_lshl_add_u32 v209, v219, 3, v209
    v_add_u32 v209, 12288, v209
    v_lshrrev_b32 v219, 5, v1
    v_lshlrev_b32 v219, 10, v219
    v_sub_u32_e64 v210, v209, v219
    s_mul_i32 s70, s3, 36864
    s_add_u32 s70, s70, 12288
    v_lshrrev_b32_e64 v219, 3, v1
    v_mul_u32_u24 v213, 3584, v219
    v_and_b32 v219, 1, v3
    v_lshlrev_b32 v219, 2, v219
    v_and_b32 v220, 7, v1
    v_xor_b32 v219, v219, v220
    v_lshl_add_u32 v213, v219, 4, v213
    s_mul_i32 s68, s3, 1835008
    s_lshl_b32 s69, s65, 7
    s_add_u32 s68, s68, s69
    s_cmp_ge_u32 s65, 99
    s_cselect_b32 s68, 0x40000000, s68
    v_add_u32 v213, s68, v213
    s_cselect_b32 s68, 0x40000000, 0
    v_add_u32 v5, s68, v4
    v_lshrrev_b32 v219, 5, v1
    v_lshlrev_b32 v215, 9, v219
    v_bfe_u32 v219, v1, 2, 2
    v_lshl_add_u32 v215, v219, 7, v215
    v_lshrrev_b32 v219, 1, v219
    s_lshr_b32 s68, s3, 1
    v_xor_b32_e64 v219, s68, v219
    v_lshl_add_u32 v215, v219, 6, v215
    v_and_b32_e64 v219, 1, v3
    v_lshl_add_u32 v215, v219, 5, v215
    v_and_b32_e64 v219, 3, v1
    v_lshl_add_u32 v215, v219, 3, v215
    s_and_b32 s68, s3, 1
    s_lshl_b32 s68, s68, 5
    v_xor_b32 v215, s68, v215
    v_add_u32 v215, s70, v215
    v_xor_b32_e64 v216, 64, v215
    s_mul_i32 s70, s3, 36864
    s_add_u32 s70, s70, 12288
    v_lshrrev_b32_e64 v219, 3, v1
    v_mul_u32_u24 v214, 4096, v219
    v_and_b32 v219, 1, v3
    v_lshlrev_b32 v219, 2, v219
    v_and_b32 v220, 7, v1
    v_xor_b32 v219, v219, v220
    v_lshl_add_u32 v214, v219, 4, v214
    s_mul_i32 s68, s3, 1835008
    s_lshl_b32 s69, s67, 7
    s_add_u32 s68, s68, s69
    s_cmp_ge_u32 s67, 99
    s_cselect_b32 s68, 0x40000000, s68
    v_add_u32 v214, s68, v214
    v_lshrrev_b32 v219, 5, v1
    v_lshlrev_b32 v217, 9, v219
    v_bfe_u32 v219, v1, 2, 2
    v_lshl_add_u32 v217, v219, 7, v217
    v_lshrrev_b32 v219, 1, v219
    s_lshr_b32 s68, s3, 1
    v_xor_b32_e64 v219, s68, v219
    v_lshl_add_u32 v217, v219, 6, v217
    v_and_b32_e64 v219, 1, v3
    v_lshl_add_u32 v217, v219, 5, v217
    v_and_b32_e64 v219, 3, v1
    v_lshl_add_u32 v217, v219, 3, v217
    v_add_u32_e64 v217, s70, v217
    v_xor_b32 v218, 64, v217
    s_and_b32 s68, s2, 7
    s_cmp_ge_u32 s68, 8
    s_cselect_b32 s94, 8, 0
    s_sub_u32 s68, s68, s94
    s_lshl_b32 s94, s68, 12
    s_add_u32 s68, s68, 1
    s_cmp_ge_u32 s68, 8
    s_cselect_b32 s95, 8, 0
    s_sub_u32 s68, s68, s95
    s_lshl_b32 s95, s68, 12
    s_add_u32 s68, s68, 1
    s_cmp_ge_u32 s68, 8
    s_cselect_b32 s96, 8, 0
    s_sub_u32 s68, s68, s96
    s_lshl_b32 s96, s68, 12
    s_add_u32 s68, s68, 1
    s_cmp_ge_u32 s68, 8
    s_cselect_b32 s97, 8, 0
    s_sub_u32 s68, s68, s97
    s_lshl_b32 s97, s68, 12
    s_add_u32 s68, s68, 1
    s_cmp_ge_u32 s68, 8
    s_cselect_b32 s98, 8, 0
    s_sub_u32 s68, s68, s98
    s_lshl_b32 s98, s68, 12
    s_add_u32 s68, s68, 1
    s_cmp_ge_u32 s68, 8
    s_cselect_b32 s99, 8, 0
    s_sub_u32 s68, s68, s99
    s_lshl_b32 s99, s68, 12
    s_add_u32 s68, s68, 1
    s_cmp_ge_u32 s68, 8
    s_cselect_b32 s100, 8, 0
    s_sub_u32 s68, s68, s100
    s_lshl_b32 s100, s68, 12
    s_add_u32 s68, s68, 1
    s_cmp_ge_u32 s68, 8
    s_cselect_b32 s101, 8, 0
    s_sub_u32 s68, s68, s101
    s_lshl_b32 s101, s68, 12
    s_lshl_b32 s80, s48, 2
    s_add_u32 s80, s80, s3
    s_lshl_b32 s80, s80, 11
    s_lshr_b32 s93, s49, 2
    s_lshl_b32 s93, s93, 7
    s_add_u32 s80, s80, s93
    s_and_b32 s93, s49, 3
    s_lshl_b32 s93, s93, 2
    s_add_u32 s80, s80, s93
    s_add_u32 s80, s80, 0x5c8000
    s_lshl_b32 s83, s67, 1
    s_lshr_b32 s93, s3, 1
    s_add_u32 s83, s83, s93
    s_lshl_b32 s83, s83, 11
    s_add_u32 s83, s83, 0x5c8000
    v_lshrrev_b32 v10, 2, v2
    v_lshlrev_b32 v10, 7, v10
    v_and_b32_e64 v219, 3, v2
    v_lshl_add_u32 v10, v219, 2, v10
    s_lshl_b32 s84, s64, 12
    s_lshl_b32 s85, s84, 1
    s_add_u32 s85, s85, 0x5f0000
    s_add_u32 s84, s84, 0x5e8000
    s_lshl_b32 s81, s67, 5
    s_add_u32 s81, s81, s3
    s_lshl_b32 s81, s81, 2
    s_add_u32 s81, s81, s84
    s_lshl_b32 s93, s3, 10
    s_add_u32 s84, s84, s93
    v_bfe_u32 v11, v1, 2, 3
    v_min_u32 v12, 6, v11
    v_and_b32 v219, 3, v1
    v_lshlrev_b32_e64 v219, 2, v219
    v_lshl_add_u32 v11, v11, 7, v219
    v_lshl_add_u32 v12, v12, 7, v219
    s_lshl_b32 s82, s65, 5
    s_add_u32 s82, s82, s3
    s_lshl_b32 s82, s82, 2
    s_add_u32 s82, s82, s85
    s_mul_i32 s93, s3, 896
    s_add_u32 s85, s85, s93
    v_mov_b32 v9, 0
    v_lshlrev_b32_e64 v124, 9, v3
    v_bfe_u32 v237, v1, 2, 2
    v_lshl_add_u32 v124, v237, 6, v124
    v_and_b32_e64 v237, 3, v1
    v_lshl_add_u32 v124, v237, 3, v124
    v_and_b32 v237, 1, v3
    v_lshlrev_b32 v237, 5, v237
    v_add_u32_e64 v124, v124, v237
    v_add_u32 v124, 12288, v124
    v_xor_b32 v125, 32, v124
    s_and_b32 s53, s3, 1
    s_lshl_b32 s53, s53, 5
    v_xor_b32 v127, s53, v124
    s_lshr_b32 s53, s3, 1
    s_lshl_b32 s53, s53, 11
    s_add_u32 s53, s53, 2048
    v_add_u32 v126, s53, v127
    v_lshrrev_b32 v237, 1, v2
    v_xor_b32 v237, v237, v3
    v_lshlrev_b32 v237, 4, v237
    v_lshl_add_u32 v237, v2, 7, v237
    v_add_u32 v130, 61440, v237
    v_xor_b32 v131, 64, v130
    v_add_u32 v128, s52, v237
    v_xor_b32 v129, 64, v128
    v_lshlrev_b32 v237, 2, v3
    v_sub_u32_e64 v237, v2, v237
    v_mov_b32 v239, 0xf149f2ca
    v_add_u32 v238, 16, v237
    v_and_b32 v238, 0xfffffff1, v238
    v_cmp_eq_u32 vcc, 0, v238
    s_nop 1
    v_cndmask_b32 v240, v239, 0, vcc
    v_add_u32 v238, 15, v237
    v_and_b32 v238, 0xfffffff1, v238
    v_cmp_eq_u32 vcc, 0, v238
    s_nop 1
    v_cndmask_b32 v241, v239, 0, vcc
    v_add_u32 v238, 14, v237
    v_and_b32 v238, 0xfffffff1, v238
    v_cmp_eq_u32 vcc, 0, v238
    s_nop 1
    v_cndmask_b32 v242, v239, 0, vcc
    v_add_u32 v238, 13, v237
    v_and_b32 v238, 0xfffffff1, v238
    v_cmp_eq_u32 vcc, 0, v238
    s_nop 1
    v_cndmask_b32 v243, v239, 0, vcc
    v_add_u32 v238, 0, v237
    v_and_b32 v238, 0xfffffff1, v238
    v_cmp_eq_u32 vcc, 0, v238
    s_nop 1
    v_cndmask_b32 v244, v239, 0, vcc
    v_add_u32 v238, -1, v237
    v_and_b32 v238, 0xfffffff1, v238
    v_cmp_eq_u32 vcc, 0, v238
    s_nop 1
    v_cndmask_b32 v245, v239, 0, vcc
    v_add_u32 v238, -2, v237
    v_and_b32 v238, 0xfffffff1, v238
    v_cmp_eq_u32 vcc, 0, v238
    s_nop 1
    v_cndmask_b32 v246, v239, 0, vcc
    v_add_u32 v238, -3, v237
    v_and_b32 v238, 0xfffffff1, v238
    v_cmp_eq_u32 vcc, 0, v238
    s_nop 1
    v_cndmask_b32 v247, v239, 0, vcc
    s_or_b32 s53, s48, s3
    s_cmp_eq_u32 s53, 0
    s_cselect_b64 vcc, -1, 0
    v_cndmask_b32 v248, v240, v239, vcc
    v_cndmask_b32 v249, v241, v239, vcc
    v_cndmask_b32 v250, v242, v239, vcc
    v_cndmask_b32 v251, v243, v239, vcc
    v_mov_b32 v40, s5
    v_mov_b32 v41, s5
    v_mov_b32 v42, s5
    v_mov_b32_e64 v43, s5
    s_mov_b32 s88, 0x22222222
    s_mov_b32 s89, 0x22222222
    s_mov_b32 s90, 0x44444444
    s_mov_b32 s91, 0x44444444
    s_mov_b32 s92, 0x88888888
    s_mov_b32 s93, 0x88888888
    v_lshlrev_b32 v72, 4, v3
    s_lshl_b32 s53, s3, 6
    v_add_u32 v73, s53, v72
    s_and_b32 s53, s53, 64
    v_add_u32_e64 v74, s53, v72
    s_mul_i32 s53, s3, 384
    v_lshl_add_u32 v75, v2, 2, s53
    v_add_u32 v76, s53, v72
    s_and_b32 s53, s3, 1
    s_lshl_b32 s53, s53, 3
    v_add_u32 v80, s53, v4
    v_lshrrev_b32 v81, 2, v2
    v_lshlrev_b32 v81, 8, v81
    v_lshl_add_u32 v81, v3, 6, v81
    v_and_b32_e64 v82, 3, v2
    v_lshl_add_u32 v81, v82, 1, v81
    v_add_u32_e64 v81, s53, v81
    v_add_u32 v81, 1024, v81
    s_cmp_lt_u32 s3, 2
    s_cselect_b64 vcc, -1, 0
    s_cselect_b32 s53, 2, 16
    v_cndmask_b32 v80, v81, v80, vcc
    v_add_u32 v81, s53, v80
    v_add_u32 v82, s53, v81
    v_add_u32 v83, s53, v82
    v_lshlrev_b32 v77, 2, v2
    s_lshl_b32 s53, s3, 11
    v_add_u32 v78, s53, v4
    s_lshl_b32 s62, s48, 3
    s_lshl_b32 s63, s3, 1
    s_add_u32 s62, s62, s63
    s_lshl_b32 s62, s62, 4
    s_add_u32 s62, s62, s49
    s_lshl_b32 s62, s62, 10
    s_add_u32 s63, s62, 16384
    s_add_u32 m0, s51, 24576
    s_mov_b32 s73, 172032
    buffer_load_dwordx4 v123, s[12:15], s73 offen lds
    s_add_u32 m0, s51, 26624
    s_mov_b32 s73, 172928
    buffer_load_dwordx4 v123, s[12:15], s73 offen lds
    s_add_u32 m0, s51, 28672
    s_mov_b32 s73, 173824
    buffer_load_dwordx4 v123, s[12:15], s73 offen lds
    s_add_u32 m0, s52, 18432
    s_mov_b32 s73, 128
    buffer_load_dwordx4 v120, s[8:11], s73 offen lds
    s_add_u32 m0, s52, 19456
    s_mov_b32 s73, 128
    buffer_load_dwordx4 v121, s[8:11], s73 offen lds
    s_add_u32 m0, s52, 20480
    s_mov_b32 s73, 14464
    buffer_load_dwordx4 v120, s[8:11], s73 offen lds
    s_add_u32 m0, s52, 21504
    s_mov_b32 s73, 14464
    buffer_load_dwordx4 v121, s[8:11], s73 offen lds
    s_add_u32 m0, s7, 79872
    s_mov_b32 s73, 128
    s_mov_b64 exec, s[54:55]
    buffer_load_dwordx4 v122, s[8:11], s73 offen lds
    s_mov_b64 exec, -1
    s_waitcnt vmcnt(11)
    s_waitcnt lgkmcnt(0)
    s_barrier
    ds_read_b128 v[16:19], v128 offset:36864
    ds_read_b128 v[20:23], v128 offset:38912
    ds_read_b128 v[24:27], v130 offset:36864
    ds_read_b64_tr_b16 v[88:89], v124 offset:0
    ds_read_b64_tr_b16 v[90:91], v124 offset:256
    ds_read_b64_tr_b16 v[92:93], v125 offset:0
    ds_read_b64_tr_b16 v[94:95], v125 offset:256
    ds_read_b64_tr_b16 v[96:97], v124 offset:2048
    ds_read_b64_tr_b16 v[98:99], v124 offset:2304
    ds_read_b64_tr_b16 v[100:101], v125 offset:2048
    ds_read_b64_tr_b16 v[102:103], v125 offset:2304
    ds_read_b64_tr_b16 v[104:105], v124 offset:4096
    ds_read_b64_tr_b16 v[106:107], v124 offset:4352
    ds_read_b64_tr_b16 v[108:109], v125 offset:4096
    ds_read_b64_tr_b16 v[110:111], v125 offset:4352
    ds_read_b64_tr_b16 v[112:113], v126 offset:0
    ds_read_b64_tr_b16 v[114:115], v126 offset:256
    ds_read_b64_tr_b16 v[116:117], v127 offset:0
    ds_read_b64_tr_b16 v[118:119], v127 offset:256
    s_waitcnt lgkmcnt(8)
    v_mfma_f32_16x16x32_bf16 v[136:139], v[88:91], v[16:19], 0
    ds_read_b128 v[28:31], v129 offset:36864
    v_mfma_f32_16x16x32_bf16 v[160:163], v[88:91], v[20:23], 0
    ds_read_b128 v[32:35], v129 offset:38912
    v_mfma_f32_16x16x32_bf16 v[140:143], v[92:95], v[16:19], 0
    ds_read_b128 v[36:39], v131 offset:36864
    v_mfma_f32_16x16x32_bf16 v[164:167], v[92:95], v[20:23], 0
    ds_read_b64_tr_b16 v[88:89], v124 offset:6144
    v_mfma_f32_16x16x32_bf16 v[144:147], v[96:99], v[16:19], 0
    ds_read_b64_tr_b16 v[90:91], v124 offset:6400
    s_add_u32 m0, s51, 36864
    s_mov_b32 s73, 344064
    buffer_load_dwordx4 v123, s[12:15], s73 offen lds
    v_mfma_f32_16x16x32_bf16 v[168:171], v[96:99], v[20:23], 0
    ds_read_b64_tr_b16 v[92:93], v125 offset:6144
    v_mfma_f32_16x16x32_bf16 v[148:151], v[100:103], v[16:19], 0
    ds_read_b64_tr_b16 v[94:95], v125 offset:6400
    v_mfma_f32_16x16x32_bf16 v[172:175], v[100:103], v[20:23], 0
    ds_read_b64_tr_b16 v[96:97], v124 offset:8192
    s_waitcnt lgkmcnt(8)
    v_mfma_f32_16x16x32_bf16 v[152:155], v[16:19], v[104:107], 0
    ds_read_b64_tr_b16 v[98:99], v124 offset:8448
    v_mfma_f32_16x16x32_bf16 v[176:179], v[20:23], v[104:107], 0
    ds_read_b64_tr_b16 v[100:101], v125 offset:8192
    s_add_u32 m0, s51, 38912
    s_mov_b32 s73, 344960
    buffer_load_dwordx4 v123, s[12:15], s73 offen lds
    v_mfma_f32_16x16x32_bf16 v[156:159], v[16:19], v[108:111], 0
    ds_read_b64_tr_b16 v[102:103], v125 offset:8448
    v_mfma_f32_16x16x32_bf16 v[180:183], v[20:23], v[108:111], 0
    ds_read_b64_tr_b16 v[104:105], v124 offset:10240
    v_mfma_f32_16x16x32_bf16 v[184:187], v[112:115], v[24:27], 0
    ds_read_b64_tr_b16 v[106:107], v124 offset:10496
    v_mfma_f32_16x16x32_bf16 v[188:191], v[116:119], v[24:27], 0
    ds_read_b64_tr_b16 v[108:109], v125 offset:10240
    v_mfma_f32_16x16x32_bf16 v[48:51], v[16:19], v[16:19], 0
    ds_read_b64_tr_b16 v[110:111], v125 offset:10496
    s_add_u32 m0, s51, 40960
    s_mov_b32 s73, 345856
    buffer_load_dwordx4 v123, s[12:15], s73 offen lds
    v_mfma_f32_16x16x32_bf16 v[52:55], v[20:23], v[20:23], 0
    ds_read_b64_tr_b16 v[112:113], v126 offset:6144
    v_mfma_f32_16x16x32_bf16 v[56:59], v[24:27], v[24:27], 0
    ds_read_b64_tr_b16 v[114:115], v126 offset:6400
    v_mfma_f32_16x16x32_bf16 v[60:63], v[40:43], v[16:19], 0
    ds_read_b64_tr_b16 v[116:117], v127 offset:6144
    v_mfma_f32_16x16x32_bf16 v[64:67], v[40:43], v[20:23], 0
    ds_read_b64_tr_b16 v[118:119], v127 offset:6400
    v_mfma_f32_16x16x32_bf16 v[68:71], v[40:43], v[24:27], 0
    s_add_u32 m0, s52, 0
    s_mov_b32 s73, 256
    buffer_load_dwordx4 v120, s[8:11], s73 offen lds
    s_add_u32 m0, s52, 1024
    s_mov_b32 s73, 256
    buffer_load_dwordx4 v121, s[8:11], s73 offen lds
    s_add_u32 m0, s52, 2048
    s_mov_b32 s73, 14592
    buffer_load_dwordx4 v120, s[8:11], s73 offen lds
    s_add_u32 m0, s52, 3072
    s_mov_b32 s73, 14592
    buffer_load_dwordx4 v121, s[8:11], s73 offen lds
    s_add_u32 m0, s7, 61440
    s_mov_b32 s73, 256
    s_mov_b64 exec, s[54:55]
    buffer_load_dwordx4 v122, s[8:11], s73 offen lds
    s_mov_b64 exec, -1
    s_waitcnt vmcnt(8)
    s_barrier
    s_waitcnt lgkmcnt(8)
    v_mfma_f32_16x16x32_bf16 v[136:139], v[88:91], v[28:31], v[136:139]
    ds_read_b128 v[16:19], v128 offset:18432
    v_mfma_f32_16x16x32_bf16 v[160:163], v[88:91], v[32:35], v[160:163]
    ds_read_b128 v[20:23], v128 offset:20480
    v_mfma_f32_16x16x32_bf16 v[140:143], v[92:95], v[28:31], v[140:143]
    ds_read_b128 v[24:27], v130 offset:18432
    v_mfma_f32_16x16x32_bf16 v[164:167], v[92:95], v[32:35], v[164:167]
    ds_read_b64_tr_b16 v[88:89], v124 offset:12288
    v_mfma_f32_16x16x32_bf16 v[144:147], v[96:99], v[28:31], v[144:147]
    ds_read_b64_tr_b16 v[90:91], v124 offset:12544
    s_add_u32 m0, s51, 49152
    s_mov_b32 s73, 516096
    buffer_load_dwordx4 v123, s[12:15], s73 offen lds
    v_mfma_f32_16x16x32_bf16 v[168:171], v[96:99], v[32:35], v[168:171]
    ds_read_b64_tr_b16 v[92:93], v125 offset:12288
    v_mfma_f32_16x16x32_bf16 v[148:151], v[100:103], v[28:31], v[148:151]
    ds_read_b64_tr_b16 v[94:95], v125 offset:12544
    v_mfma_f32_16x16x32_bf16 v[172:175], v[100:103], v[32:35], v[172:175]
    ds_read_b64_tr_b16 v[96:97], v124 offset:14336
    s_waitcnt lgkmcnt(8)
    v_mfma_f32_16x16x32_bf16 v[152:155], v[28:31], v[104:107], v[152:155]
    ds_read_b64_tr_b16 v[98:99], v124 offset:14592
    v_mfma_f32_16x16x32_bf16 v[176:179], v[32:35], v[104:107], v[176:179]
    ds_read_b64_tr_b16 v[100:101], v125 offset:14336
    s_add_u32 m0, s51, 51200
    s_mov_b32 s73, 516992
    buffer_load_dwordx4 v123, s[12:15], s73 offen lds
    v_mfma_f32_16x16x32_bf16 v[156:159], v[28:31], v[108:111], v[156:159]
    ds_read_b64_tr_b16 v[102:103], v125 offset:14592
    v_mfma_f32_16x16x32_bf16 v[180:183], v[32:35], v[108:111], v[180:183]
    ds_read_b64_tr_b16 v[104:105], v124 offset:16384
    v_mfma_f32_16x16x32_bf16 v[184:187], v[112:115], v[36:39], v[184:187]
    ds_read_b64_tr_b16 v[106:107], v124 offset:16640
    v_mfma_f32_16x16x32_bf16 v[188:191], v[116:119], v[36:39], v[188:191]
    ds_read_b64_tr_b16 v[108:109], v125 offset:16384
    v_mfma_f32_16x16x32_bf16 v[48:51], v[28:31], v[28:31], v[48:51]
    ds_read_b64_tr_b16 v[110:111], v125 offset:16640
    s_add_u32 m0, s51, 53248
    s_mov_b32 s73, 517888
    buffer_load_dwordx4 v123, s[12:15], s73 offen lds
    v_mfma_f32_16x16x32_bf16 v[52:55], v[32:35], v[32:35], v[52:55]
    ds_read_b64_tr_b16 v[112:113], v126 offset:12288
    v_mfma_f32_16x16x32_bf16 v[56:59], v[36:39], v[36:39], v[56:59]
    ds_read_b64_tr_b16 v[114:115], v126 offset:12544
    v_mfma_f32_16x16x32_bf16 v[60:63], v[40:43], v[28:31], v[60:63]
    ds_read_b64_tr_b16 v[116:117], v127 offset:12288
    v_mfma_f32_16x16x32_bf16 v[64:67], v[40:43], v[32:35], v[64:67]
    ds_read_b64_tr_b16 v[118:119], v127 offset:12544
    v_mfma_f32_16x16x32_bf16 v[68:71], v[40:43], v[36:39], v[68:71]
    s_add_u32 m0, s52, 55296
    s_mov_b32 s73, 384
    buffer_load_dwordx4 v120, s[8:11], s73 offen lds
    s_waitcnt lgkmcnt(8)
    v_mfma_f32_16x16x32_bf16 v[136:139], v[88:91], v[16:19], v[136:139]
    ds_read_b128 v[28:31], v129 offset:18432
    v_mfma_f32_16x16x32_bf16 v[160:163], v[88:91], v[20:23], v[160:163]
    ds_read_b128 v[32:35], v129 offset:20480
    v_mfma_f32_16x16x32_bf16 v[140:143], v[92:95], v[16:19], v[140:143]
    ds_read_b128 v[36:39], v131 offset:18432
    v_mfma_f32_16x16x32_bf16 v[164:167], v[92:95], v[20:23], v[164:167]
    ds_read_b64_tr_b16 v[88:89], v124 offset:18432
    v_mfma_f32_16x16x32_bf16 v[144:147], v[96:99], v[16:19], v[144:147]
    ds_read_b64_tr_b16 v[90:91], v124 offset:18688
    s_add_u32 m0, s52, 56320
    s_mov_b32 s73, 384
    buffer_load_dwordx4 v121, s[8:11], s73 offen lds
    v_mfma_f32_16x16x32_bf16 v[168:171], v[96:99], v[20:23], v[168:171]
    ds_read_b64_tr_b16 v[92:93], v125 offset:18432
    v_mfma_f32_16x16x32_bf16 v[148:151], v[100:103], v[16:19], v[148:151]
    ds_read_b64_tr_b16 v[94:95], v125 offset:18688
    v_mfma_f32_16x16x32_bf16 v[172:175], v[100:103], v[20:23], v[172:175]
    ds_read_b64_tr_b16 v[96:97], v124 offset:20480
    s_waitcnt lgkmcnt(8)
    v_mfma_f32_16x16x32_bf16 v[152:155], v[16:19], v[104:107], v[152:155]
    ds_read_b64_tr_b16 v[98:99], v124 offset:20736
    v_mfma_f32_16x16x32_bf16 v[176:179], v[20:23], v[104:107], v[176:179]
    ds_read_b64_tr_b16 v[100:101], v125 offset:20480
    s_add_u32 m0, s52, 57344
    s_mov_b32 s73, 14720
    buffer_load_dwordx4 v120, s[8:11], s73 offen lds
    v_mfma_f32_16x16x32_bf16 v[156:159], v[16:19], v[108:111], v[156:159]
    ds_read_b64_tr_b16 v[102:103], v125 offset:20736
    v_mfma_f32_16x16x32_bf16 v[180:183], v[20:23], v[108:111], v[180:183]
    ds_read_b64_tr_b16 v[104:105], v124 offset:22528
    v_mfma_f32_16x16x32_bf16 v[184:187], v[112:115], v[24:27], v[184:187]
    ds_read_b64_tr_b16 v[106:107], v124 offset:22784
    v_mfma_f32_16x16x32_bf16 v[188:191], v[116:119], v[24:27], v[188:191]
    ds_read_b64_tr_b16 v[108:109], v125 offset:22528
    v_mfma_f32_16x16x32_bf16 v[48:51], v[16:19], v[16:19], v[48:51]
    ds_read_b64_tr_b16 v[110:111], v125 offset:22784
    s_add_u32 m0, s52, 58368
    s_mov_b32 s73, 14720
    buffer_load_dwordx4 v121, s[8:11], s73 offen lds
    v_mfma_f32_16x16x32_bf16 v[52:55], v[20:23], v[20:23], v[52:55]
    ds_read_b64_tr_b16 v[112:113], v126 offset:18432
    v_mfma_f32_16x16x32_bf16 v[56:59], v[24:27], v[24:27], v[56:59]
    ds_read_b64_tr_b16 v[114:115], v126 offset:18688
    v_mfma_f32_16x16x32_bf16 v[60:63], v[40:43], v[16:19], v[60:63]
    ds_read_b64_tr_b16 v[116:117], v127 offset:18432
    v_mfma_f32_16x16x32_bf16 v[64:67], v[40:43], v[20:23], v[64:67]
    ds_read_b64_tr_b16 v[118:119], v127 offset:18688
    v_mfma_f32_16x16x32_bf16 v[68:71], v[40:43], v[24:27], v[68:71]
    s_add_u32 m0, s7, 116736
    s_mov_b32 s73, 384
    s_mov_b64 exec, s[54:55]
    buffer_load_dwordx4 v122, s[8:11], s73 offen lds
    s_mov_b64 exec, -1
    s_waitcnt vmcnt(8)
    s_barrier
    s_waitcnt lgkmcnt(8)
    v_mfma_f32_16x16x32_bf16 v[136:139], v[88:91], v[28:31], v[136:139]
    ds_read_b128 v[16:19], v128 offset:0
    v_mfma_f32_16x16x32_bf16 v[160:163], v[88:91], v[32:35], v[160:163]
    ds_read_b128 v[20:23], v128 offset:2048
    v_mfma_f32_16x16x32_bf16 v[140:143], v[92:95], v[28:31], v[140:143]
    ds_read_b128 v[24:27], v130 offset:0
    v_mfma_f32_16x16x32_bf16 v[164:167], v[92:95], v[32:35], v[164:167]
    ds_read_b64_tr_b16 v[88:89], v124 offset:24576
    v_mfma_f32_16x16x32_bf16 v[144:147], v[96:99], v[28:31], v[144:147]
    ds_read_b64_tr_b16 v[90:91], v124 offset:24832
    s_add_u32 m0, s51, 12288
    s_mov_b32 s73, 688128
    buffer_load_dwordx4 v123, s[12:15], s73 offen lds
    v_mfma_f32_16x16x32_bf16 v[168:171], v[96:99], v[32:35], v[168:171]
    ds_read_b64_tr_b16 v[92:93], v125 offset:24576
    v_mfma_f32_16x16x32_bf16 v[148:151], v[100:103], v[28:31], v[148:151]
    ds_read_b64_tr_b16 v[94:95], v125 offset:24832
    v_mfma_f32_16x16x32_bf16 v[172:175], v[100:103], v[32:35], v[172:175]
    ds_read_b64_tr_b16 v[96:97], v124 offset:26624
    s_waitcnt lgkmcnt(8)
    v_mfma_f32_16x16x32_bf16 v[152:155], v[28:31], v[104:107], v[152:155]
    ds_read_b64_tr_b16 v[98:99], v124 offset:26880
    v_mfma_f32_16x16x32_bf16 v[176:179], v[32:35], v[104:107], v[176:179]
    ds_read_b64_tr_b16 v[100:101], v125 offset:26624
    s_add_u32 m0, s51, 14336
    s_mov_b32 s73, 689024
    buffer_load_dwordx4 v123, s[12:15], s73 offen lds
    v_mfma_f32_16x16x32_bf16 v[156:159], v[28:31], v[108:111], v[156:159]
    ds_read_b64_tr_b16 v[102:103], v125 offset:26880
    v_mfma_f32_16x16x32_bf16 v[180:183], v[32:35], v[108:111], v[180:183]
    ds_read_b64_tr_b16 v[104:105], v124 offset:28672
    v_mfma_f32_16x16x32_bf16 v[184:187], v[112:115], v[36:39], v[184:187]
    ds_read_b64_tr_b16 v[106:107], v124 offset:28928
    v_mfma_f32_16x16x32_bf16 v[188:191], v[116:119], v[36:39], v[188:191]
    ds_read_b64_tr_b16 v[108:109], v125 offset:28672
    v_mfma_f32_16x16x32_bf16 v[48:51], v[28:31], v[28:31], v[48:51]
    ds_read_b64_tr_b16 v[110:111], v125 offset:28928
    s_add_u32 m0, s51, 16384
    s_mov_b32 s73, 689920
    buffer_load_dwordx4 v123, s[12:15], s73 offen lds
    v_mfma_f32_16x16x32_bf16 v[52:55], v[32:35], v[32:35], v[52:55]
    ds_read_b64_tr_b16 v[112:113], v126 offset:24576
    v_mfma_f32_16x16x32_bf16 v[56:59], v[36:39], v[36:39], v[56:59]
    ds_read_b64_tr_b16 v[114:115], v126 offset:24832
    v_mfma_f32_16x16x32_bf16 v[60:63], v[40:43], v[28:31], v[60:63]
    ds_read_b64_tr_b16 v[116:117], v127 offset:24576
    v_mfma_f32_16x16x32_bf16 v[64:67], v[40:43], v[32:35], v[64:67]
    ds_read_b64_tr_b16 v[118:119], v127 offset:24832
    v_mfma_f32_16x16x32_bf16 v[68:71], v[40:43], v[36:39], v[68:71]
    s_add_u32 m0, s52, 36864
    s_mov_b32 s73, 512
    buffer_load_dwordx4 v120, s[8:11], s73 offen lds
    s_waitcnt lgkmcnt(8)
    v_mfma_f32_16x16x32_bf16 v[136:139], v[88:91], v[16:19], v[136:139]
    ds_read_b128 v[28:31], v129 offset:0
    v_mfma_f32_16x16x32_bf16 v[160:163], v[88:91], v[20:23], v[160:163]
    ds_read_b128 v[32:35], v129 offset:2048
    v_mfma_f32_16x16x32_bf16 v[140:143], v[92:95], v[16:19], v[140:143]
    ds_read_b128 v[36:39], v131 offset:0
    v_mfma_f32_16x16x32_bf16 v[164:167], v[92:95], v[20:23], v[164:167]
    ds_read_b64_tr_b16 v[88:89], v124 offset:30720
    v_mfma_f32_16x16x32_bf16 v[144:147], v[96:99], v[16:19], v[144:147]
    ds_read_b64_tr_b16 v[90:91], v124 offset:30976
    s_add_u32 m0, s52, 37888
    s_mov_b32 s73, 512
    buffer_load_dwordx4 v121, s[8:11], s73 offen lds
    v_mfma_f32_16x16x32_bf16 v[168:171], v[96:99], v[20:23], v[168:171]
    ds_read_b64_tr_b16 v[92:93], v125 offset:30720
    v_mfma_f32_16x16x32_bf16 v[148:151], v[100:103], v[16:19], v[148:151]
    ds_read_b64_tr_b16 v[94:95], v125 offset:30976
    v_mfma_f32_16x16x32_bf16 v[172:175], v[100:103], v[20:23], v[172:175]
    ds_read_b64_tr_b16 v[96:97], v124 offset:32768
    s_waitcnt lgkmcnt(8)
    v_mfma_f32_16x16x32_bf16 v[152:155], v[16:19], v[104:107], v[152:155]
    ds_read_b64_tr_b16 v[98:99], v124 offset:33024
    v_mfma_f32_16x16x32_bf16 v[176:179], v[20:23], v[104:107], v[176:179]
    ds_read_b64_tr_b16 v[100:101], v125 offset:32768
    s_add_u32 m0, s52, 38912
    s_mov_b32 s73, 14848
    buffer_load_dwordx4 v120, s[8:11], s73 offen lds
    v_mfma_f32_16x16x32_bf16 v[156:159], v[16:19], v[108:111], v[156:159]
    ds_read_b64_tr_b16 v[102:103], v125 offset:33024
    v_mfma_f32_16x16x32_bf16 v[180:183], v[20:23], v[108:111], v[180:183]
    ds_read_b64_tr_b16 v[104:105], v124 offset:34816
    v_mfma_f32_16x16x32_bf16 v[184:187], v[112:115], v[24:27], v[184:187]
    ds_read_b64_tr_b16 v[106:107], v124 offset:35072
    v_mfma_f32_16x16x32_bf16 v[188:191], v[116:119], v[24:27], v[188:191]
    ds_read_b64_tr_b16 v[108:109], v125 offset:34816
    v_mfma_f32_16x16x32_bf16 v[48:51], v[16:19], v[16:19], v[48:51]
    ds_read_b64_tr_b16 v[110:111], v125 offset:35072
    s_add_u32 m0, s52, 39936
    s_mov_b32 s73, 14848
    buffer_load_dwordx4 v121, s[8:11], s73 offen lds
    v_mfma_f32_16x16x32_bf16 v[52:55], v[20:23], v[20:23], v[52:55]
    ds_read_b64_tr_b16 v[112:113], v126 offset:30720
    v_mfma_f32_16x16x32_bf16 v[56:59], v[24:27], v[24:27], v[56:59]
    ds_read_b64_tr_b16 v[114:115], v126 offset:30976
    v_mfma_f32_16x16x32_bf16 v[60:63], v[40:43], v[16:19], v[60:63]
    ds_read_b64_tr_b16 v[116:117], v127 offset:30720
    v_mfma_f32_16x16x32_bf16 v[64:67], v[40:43], v[20:23], v[64:67]
    ds_read_b64_tr_b16 v[118:119], v127 offset:30976
    v_mfma_f32_16x16x32_bf16 v[68:71], v[40:43], v[24:27], v[68:71]
    s_add_u32 m0, s7, 98304
    s_mov_b32 s73, 512
    s_mov_b64 exec, s[54:55]
    buffer_load_dwordx4 v122, s[8:11], s73 offen lds
    s_mov_b64 exec, -1
    s_waitcnt vmcnt(8)
    s_barrier
    s_waitcnt lgkmcnt(8)
    v_mfma_f32_16x16x32_bf16 v[136:139], v[88:91], v[28:31], v[136:139]
    ds_read_b128 v[16:19], v128 offset:55296
    v_mfma_f32_16x16x32_bf16 v[160:163], v[88:91], v[32:35], v[160:163]
    ds_read_b128 v[20:23], v128 offset:57344
    v_mfma_f32_16x16x32_bf16 v[140:143], v[92:95], v[28:31], v[140:143]
    ds_read_b128 v[24:27], v130 offset:55296
    v_mfma_f32_16x16x32_bf16 v[164:167], v[92:95], v[32:35], v[164:167]
    ds_read_b64_tr_b16 v[88:89], v124 offset:36864
    v_mfma_f32_16x16x32_bf16 v[144:147], v[96:99], v[28:31], v[144:147]
    ds_read_b64_tr_b16 v[90:91], v124 offset:37120
    s_add_u32 m0, s51, 24576
    s_mov_b32 s73, 860160
    buffer_load_dwordx4 v123, s[12:15], s73 offen lds
    v_mfma_f32_16x16x32_bf16 v[168:171], v[96:99], v[32:35], v[168:171]
    ds_read_b64_tr_b16 v[92:93], v125 offset:36864
    v_mfma_f32_16x16x32_bf16 v[148:151], v[100:103], v[28:31], v[148:151]
    ds_read_b64_tr_b16 v[94:95], v125 offset:37120
    v_mfma_f32_16x16x32_bf16 v[172:175], v[100:103], v[32:35], v[172:175]
    ds_read_b64_tr_b16 v[96:97], v124 offset:38912
    s_waitcnt lgkmcnt(8)
    v_mfma_f32_16x16x32_bf16 v[152:155], v[28:31], v[104:107], v[152:155]
    ds_read_b64_tr_b16 v[98:99], v124 offset:39168
    v_mfma_f32_16x16x32_bf16 v[176:179], v[32:35], v[104:107], v[176:179]
    ds_read_b64_tr_b16 v[100:101], v125 offset:38912
    s_add_u32 m0, s51, 26624
    s_mov_b32 s73, 861056
    buffer_load_dwordx4 v123, s[12:15], s73 offen lds
    v_mfma_f32_16x16x32_bf16 v[156:159], v[28:31], v[108:111], v[156:159]
    ds_read_b64_tr_b16 v[102:103], v125 offset:39168
    v_mfma_f32_16x16x32_bf16 v[180:183], v[32:35], v[108:111], v[180:183]
    ds_read_b64_tr_b16 v[104:105], v124 offset:40960
    v_mfma_f32_16x16x32_bf16 v[184:187], v[112:115], v[36:39], v[184:187]
    ds_read_b64_tr_b16 v[106:107], v124 offset:41216
    v_mfma_f32_16x16x32_bf16 v[188:191], v[116:119], v[36:39], v[188:191]
    ds_read_b64_tr_b16 v[108:109], v125 offset:40960
    v_mfma_f32_16x16x32_bf16 v[48:51], v[28:31], v[28:31], v[48:51]
    ds_read_b64_tr_b16 v[110:111], v125 offset:41216
    s_add_u32 m0, s51, 28672
    s_mov_b32 s73, 861952
    buffer_load_dwordx4 v123, s[12:15], s73 offen lds
    v_mfma_f32_16x16x32_bf16 v[52:55], v[32:35], v[32:35], v[52:55]
    ds_read_b64_tr_b16 v[112:113], v126 offset:36864
    v_mfma_f32_16x16x32_bf16 v[56:59], v[36:39], v[36:39], v[56:59]
    ds_read_b64_tr_b16 v[114:115], v126 offset:37120
    v_mfma_f32_16x16x32_bf16 v[60:63], v[40:43], v[28:31], v[60:63]
    ds_read_b64_tr_b16 v[116:117], v127 offset:36864
    v_mfma_f32_16x16x32_bf16 v[64:67], v[40:43], v[32:35], v[64:67]
    ds_read_b64_tr_b16 v[118:119], v127 offset:37120
    v_mfma_f32_16x16x32_bf16 v[68:71], v[40:43], v[36:39], v[68:71]
    s_add_u32 m0, s52, 18432
    s_mov_b32 s73, 640
    buffer_load_dwordx4 v120, s[8:11], s73 offen lds
    s_waitcnt lgkmcnt(8)
    v_mfma_f32_16x16x32_bf16 v[136:139], v[88:91], v[16:19], v[136:139]
    ds_read_b128 v[28:31], v129 offset:55296
    v_mfma_f32_16x16x32_bf16 v[160:163], v[88:91], v[20:23], v[160:163]
    ds_read_b128 v[32:35], v129 offset:57344
    v_mfma_f32_16x16x32_bf16 v[140:143], v[92:95], v[16:19], v[140:143]
    ds_read_b128 v[36:39], v131 offset:55296
    v_mfma_f32_16x16x32_bf16 v[164:167], v[92:95], v[20:23], v[164:167]
    ds_read_b64_tr_b16 v[88:89], v124 offset:43008
    v_mfma_f32_16x16x32_bf16 v[144:147], v[96:99], v[16:19], v[144:147]
    ds_read_b64_tr_b16 v[90:91], v124 offset:43264
    s_add_u32 m0, s52, 19456
    s_mov_b32 s73, 640
    buffer_load_dwordx4 v121, s[8:11], s73 offen lds
    v_mfma_f32_16x16x32_bf16 v[168:171], v[96:99], v[20:23], v[168:171]
    ds_read_b64_tr_b16 v[92:93], v125 offset:43008
    v_mfma_f32_16x16x32_bf16 v[148:151], v[100:103], v[16:19], v[148:151]
    ds_read_b64_tr_b16 v[94:95], v125 offset:43264
    v_mfma_f32_16x16x32_bf16 v[172:175], v[100:103], v[20:23], v[172:175]
    ds_read_b64_tr_b16 v[96:97], v124 offset:45056
    s_waitcnt lgkmcnt(8)
    v_mfma_f32_16x16x32_bf16 v[152:155], v[16:19], v[104:107], v[152:155]
    ds_read_b64_tr_b16 v[98:99], v124 offset:45312
    v_mfma_f32_16x16x32_bf16 v[176:179], v[20:23], v[104:107], v[176:179]
    ds_read_b64_tr_b16 v[100:101], v125 offset:45056
    s_add_u32 m0, s52, 20480
    s_mov_b32 s73, 14976
    buffer_load_dwordx4 v120, s[8:11], s73 offen lds
    v_mfma_f32_16x16x32_bf16 v[156:159], v[16:19], v[108:111], v[156:159]
    ds_read_b64_tr_b16 v[102:103], v125 offset:45312
    v_mfma_f32_16x16x32_bf16 v[180:183], v[20:23], v[108:111], v[180:183]
    ds_read_b64_tr_b16 v[104:105], v124 offset:47104
    v_mfma_f32_16x16x32_bf16 v[184:187], v[112:115], v[24:27], v[184:187]
    ds_read_b64_tr_b16 v[106:107], v124 offset:47360
    v_mfma_f32_16x16x32_bf16 v[188:191], v[116:119], v[24:27], v[188:191]
    ds_read_b64_tr_b16 v[108:109], v125 offset:47104
    v_mfma_f32_16x16x32_bf16 v[48:51], v[16:19], v[16:19], v[48:51]
    ds_read_b64_tr_b16 v[110:111], v125 offset:47360
    s_add_u32 m0, s52, 21504
    s_mov_b32 s73, 14976
    buffer_load_dwordx4 v121, s[8:11], s73 offen lds
    v_mfma_f32_16x16x32_bf16 v[52:55], v[20:23], v[20:23], v[52:55]
    ds_read_b64_tr_b16 v[112:113], v126 offset:43008
    v_mfma_f32_16x16x32_bf16 v[56:59], v[24:27], v[24:27], v[56:59]
    ds_read_b64_tr_b16 v[114:115], v126 offset:43264
    v_mfma_f32_16x16x32_bf16 v[60:63], v[40:43], v[16:19], v[60:63]
    ds_read_b64_tr_b16 v[116:117], v127 offset:43008
    v_mfma_f32_16x16x32_bf16 v[64:67], v[40:43], v[20:23], v[64:67]
    ds_read_b64_tr_b16 v[118:119], v127 offset:43264
    v_mfma_f32_16x16x32_bf16 v[68:71], v[40:43], v[24:27], v[68:71]
    s_add_u32 m0, s7, 79872
    s_mov_b32 s73, 640
    s_mov_b64 exec, s[54:55]
    buffer_load_dwordx4 v122, s[8:11], s73 offen lds
    s_mov_b64 exec, -1
    s_waitcnt vmcnt(8)
    s_barrier
    s_waitcnt lgkmcnt(8)
    v_mfma_f32_16x16x32_bf16 v[136:139], v[88:91], v[28:31], v[136:139]
    ds_read_b128 v[16:19], v128 offset:36864
    v_mfma_f32_16x16x32_bf16 v[160:163], v[88:91], v[32:35], v[160:163]
    ds_read_b128 v[20:23], v128 offset:38912
    v_mfma_f32_16x16x32_bf16 v[140:143], v[92:95], v[28:31], v[140:143]
    ds_read_b128 v[24:27], v130 offset:36864
    v_mfma_f32_16x16x32_bf16 v[164:167], v[92:95], v[32:35], v[164:167]
    ds_read_b64_tr_b16 v[88:89], v124 offset:0
    v_mfma_f32_16x16x32_bf16 v[144:147], v[96:99], v[28:31], v[144:147]
    ds_read_b64_tr_b16 v[90:91], v124 offset:256
    s_add_u32 m0, s51, 36864
    s_mov_b32 s73, 1032192
    buffer_load_dwordx4 v123, s[12:15], s73 offen lds
    v_mfma_f32_16x16x32_bf16 v[168:171], v[96:99], v[32:35], v[168:171]
    ds_read_b64_tr_b16 v[92:93], v125 offset:0
    v_mfma_f32_16x16x32_bf16 v[148:151], v[100:103], v[28:31], v[148:151]
    ds_read_b64_tr_b16 v[94:95], v125 offset:256
    v_mfma_f32_16x16x32_bf16 v[172:175], v[100:103], v[32:35], v[172:175]
    ds_read_b64_tr_b16 v[96:97], v124 offset:2048
    s_waitcnt lgkmcnt(8)
    v_mfma_f32_16x16x32_bf16 v[152:155], v[28:31], v[104:107], v[152:155]
    ds_read_b64_tr_b16 v[98:99], v124 offset:2304
    v_mfma_f32_16x16x32_bf16 v[176:179], v[32:35], v[104:107], v[176:179]
    ds_read_b64_tr_b16 v[100:101], v125 offset:2048
    s_add_u32 m0, s51, 38912
    s_mov_b32 s73, 1033088
    buffer_load_dwordx4 v123, s[12:15], s73 offen lds
    v_mfma_f32_16x16x32_bf16 v[156:159], v[28:31], v[108:111], v[156:159]
    ds_read_b64_tr_b16 v[102:103], v125 offset:2304
    v_mfma_f32_16x16x32_bf16 v[180:183], v[32:35], v[108:111], v[180:183]
    ds_read_b64_tr_b16 v[104:105], v124 offset:4096
    v_mfma_f32_16x16x32_bf16 v[184:187], v[112:115], v[36:39], v[184:187]
    ds_read_b64_tr_b16 v[106:107], v124 offset:4352
    v_mfma_f32_16x16x32_bf16 v[188:191], v[116:119], v[36:39], v[188:191]
    ds_read_b64_tr_b16 v[108:109], v125 offset:4096
    v_mfma_f32_16x16x32_bf16 v[48:51], v[28:31], v[28:31], v[48:51]
    ds_read_b64_tr_b16 v[110:111], v125 offset:4352
    s_add_u32 m0, s51, 40960
    s_mov_b32 s73, 1033984
    buffer_load_dwordx4 v123, s[12:15], s73 offen lds
    v_mfma_f32_16x16x32_bf16 v[52:55], v[32:35], v[32:35], v[52:55]
    ds_read_b64_tr_b16 v[112:113], v126 offset:0
    v_mfma_f32_16x16x32_bf16 v[56:59], v[36:39], v[36:39], v[56:59]
    ds_read_b64_tr_b16 v[114:115], v126 offset:256
    v_mfma_f32_16x16x32_bf16 v[60:63], v[40:43], v[28:31], v[60:63]
    ds_read_b64_tr_b16 v[116:117], v127 offset:0
    v_mfma_f32_16x16x32_bf16 v[64:67], v[40:43], v[32:35], v[64:67]
    ds_read_b64_tr_b16 v[118:119], v127 offset:256
    v_mfma_f32_16x16x32_bf16 v[68:71], v[40:43], v[36:39], v[68:71]
    s_add_u32 m0, s52, 0
    s_mov_b32 s73, 768
    buffer_load_dwordx4 v120, s[8:11], s73 offen lds
    s_waitcnt lgkmcnt(8)
    v_mfma_f32_16x16x32_bf16 v[136:139], v[88:91], v[16:19], v[136:139]
    ds_read_b128 v[28:31], v129 offset:36864
    v_mfma_f32_16x16x32_bf16 v[160:163], v[88:91], v[20:23], v[160:163]
    ds_read_b128 v[32:35], v129 offset:38912
    v_mfma_f32_16x16x32_bf16 v[140:143], v[92:95], v[16:19], v[140:143]
    ds_read_b128 v[36:39], v131 offset:36864
    v_mfma_f32_16x16x32_bf16 v[164:167], v[92:95], v[20:23], v[164:167]
    ds_read_b64_tr_b16 v[88:89], v124 offset:6144
    v_mfma_f32_16x16x32_bf16 v[144:147], v[96:99], v[16:19], v[144:147]
    ds_read_b64_tr_b16 v[90:91], v124 offset:6400
    s_add_u32 m0, s52, 1024
    s_mov_b32 s73, 768
    buffer_load_dwordx4 v121, s[8:11], s73 offen lds
    v_mfma_f32_16x16x32_bf16 v[168:171], v[96:99], v[20:23], v[168:171]
    ds_read_b64_tr_b16 v[92:93], v125 offset:6144
    v_mfma_f32_16x16x32_bf16 v[148:151], v[100:103], v[16:19], v[148:151]
    ds_read_b64_tr_b16 v[94:95], v125 offset:6400
    v_mfma_f32_16x16x32_bf16 v[172:175], v[100:103], v[20:23], v[172:175]
    ds_read_b64_tr_b16 v[96:97], v124 offset:8192
    s_waitcnt lgkmcnt(8)
    v_mfma_f32_16x16x32_bf16 v[152:155], v[16:19], v[104:107], v[152:155]
    ds_read_b64_tr_b16 v[98:99], v124 offset:8448
    v_mfma_f32_16x16x32_bf16 v[176:179], v[20:23], v[104:107], v[176:179]
    ds_read_b64_tr_b16 v[100:101], v125 offset:8192
    s_add_u32 m0, s52, 2048
    s_mov_b32 s73, 15104
    buffer_load_dwordx4 v120, s[8:11], s73 offen lds
    v_mfma_f32_16x16x32_bf16 v[156:159], v[16:19], v[108:111], v[156:159]
    ds_read_b64_tr_b16 v[102:103], v125 offset:8448
    v_mfma_f32_16x16x32_bf16 v[180:183], v[20:23], v[108:111], v[180:183]
    ds_read_b64_tr_b16 v[104:105], v124 offset:10240
    v_mfma_f32_16x16x32_bf16 v[184:187], v[112:115], v[24:27], v[184:187]
    ds_read_b64_tr_b16 v[106:107], v124 offset:10496
    v_mfma_f32_16x16x32_bf16 v[188:191], v[116:119], v[24:27], v[188:191]
    ds_read_b64_tr_b16 v[108:109], v125 offset:10240
    v_mfma_f32_16x16x32_bf16 v[48:51], v[16:19], v[16:19], v[48:51]
    ds_read_b64_tr_b16 v[110:111], v125 offset:10496
    s_add_u32 m0, s52, 3072
    s_mov_b32 s73, 15104
    buffer_load_dwordx4 v121, s[8:11], s73 offen lds
    v_mfma_f32_16x16x32_bf16 v[52:55], v[20:23], v[20:23], v[52:55]
    ds_read_b64_tr_b16 v[112:113], v126 offset:6144
    v_mfma_f32_16x16x32_bf16 v[56:59], v[24:27], v[24:27], v[56:59]
    ds_read_b64_tr_b16 v[114:115], v126 offset:6400
    v_mfma_f32_16x16x32_bf16 v[60:63], v[40:43], v[16:19], v[60:63]
    ds_read_b64_tr_b16 v[116:117], v127 offset:6144
    v_mfma_f32_16x16x32_bf16 v[64:67], v[40:43], v[20:23], v[64:67]
    ds_read_b64_tr_b16 v[118:119], v127 offset:6400
    v_mfma_f32_16x16x32_bf16 v[68:71], v[40:43], v[24:27], v[68:71]
    s_add_u32 m0, s7, 61440
    s_mov_b32 s73, 768
    s_mov_b64 exec, s[54:55]
    buffer_load_dwordx4 v122, s[8:11], s73 offen lds
    s_mov_b64 exec, -1
    v_mov_b32 v7, 0
    buffer_load_dword v6, v7, s[44:47], 0 offen sc1
    s_lshr_b32 s68, s2, 3
    s_lshl_b32 s68, s68, 2
    s_add_u32 s68, s68, s3
    v_lshlrev_b32 v219, 7, v1
    s_mul_i32 s86, s68, 3200
    s_mov_b64 exec, 0x1ffffff
    buffer_load_dword v234, v219, s[16:19], s86 offen
    s_mov_b64 exec, -1
    v_lshrrev_b32 v219, 2, v1
    v_mul_u32_u24 v219, 3584, v219
    v_and_b32_e64 v220, 3, v1
    v_lshl_add_u32 v219, v220, 7, v219
    s_mul_i32 s68, s68, 57344
    s_and_b32 s69, s2, 7
    s_mul_i32 s86, s69, 3
    s_add_u32 s86, s86, 4
    s_lshl_b32 s87, s69, 2
    s_min_u32 s86, s86, s87
    s_lshl_b32 s86, s86, 7
    s_add_u32 s86, s86, s68
    s_cmp_lt_u32 s69, 4
    s_cselect_b32 exec_lo, -1, 0x77777777
    s_cselect_b32 exec_hi, -1, 0x77777777
    s_lshr_b32 s68, s2, 3
    s_sub_u32 s68, s68, s69
    s_and_b32 s68, s68, 7
    s_cmp_lt_u32 s68, 4
    s_cselect_b64 exec, exec, 0
    buffer_load_dword v235, v219, s[20:23], s86 offen
    s_mov_b64 exec, -1
    s_waitcnt vmcnt(11)
    s_barrier
    s_waitcnt lgkmcnt(8)
    v_mfma_f32_16x16x32_bf16 v[136:139], v[88:91], v[28:31], v[136:139]
    ds_read_b128 v[16:19], v128 offset:18432
    v_mfma_f32_16x16x32_bf16 v[160:163], v[88:91], v[32:35], v[160:163]
    ds_read_b128 v[20:23], v128 offset:20480
    v_mfma_f32_16x16x32_bf16 v[140:143], v[92:95], v[28:31], v[140:143]
    ds_read_b128 v[24:27], v130 offset:18432
    v_mfma_f32_16x16x32_bf16 v[164:167], v[92:95], v[32:35], v[164:167]
    ds_read_b64_tr_b16 v[88:89], v124 offset:12288
    v_mfma_f32_16x16x32_bf16 v[144:147], v[96:99], v[28:31], v[144:147]
    ds_read_b64_tr_b16 v[90:91], v124 offset:12544
    v_mfma_f32_16x16x32_bf16 v[168:171], v[96:99], v[32:35], v[168:171]
    ds_read_b64_tr_b16 v[92:93], v125 offset:12288
    v_mfma_f32_16x16x32_bf16 v[148:151], v[100:103], v[28:31], v[148:151]
    ds_read_b64_tr_b16 v[94:95], v125 offset:12544
    v_mfma_f32_16x16x32_bf16 v[172:175], v[100:103], v[32:35], v[172:175]
    ds_read_b64_tr_b16 v[96:97], v124 offset:14336
    s_waitcnt lgkmcnt(8)
    v_mfma_f32_16x16x32_bf16 v[152:155], v[28:31], v[104:107], v[152:155]
    ds_read_b64_tr_b16 v[98:99], v124 offset:14592
    v_mfma_f32_16x16x32_bf16 v[176:179], v[32:35], v[104:107], v[176:179]
    ds_read_b64_tr_b16 v[100:101], v125 offset:14336
    v_mfma_f32_16x16x32_bf16 v[156:159], v[28:31], v[108:111], v[156:159]
    ds_read_b64_tr_b16 v[102:103], v125 offset:14592
    v_mfma_f32_16x16x32_bf16 v[180:183], v[32:35], v[108:111], v[180:183]
    ds_read_b64_tr_b16 v[104:105], v124 offset:16384
    v_mfma_f32_16x16x32_bf16 v[184:187], v[112:115], v[36:39], v[184:187]
    ds_read_b64_tr_b16 v[106:107], v124 offset:16640
    v_mfma_f32_16x16x32_bf16 v[188:191], v[116:119], v[36:39], v[188:191]
    ds_read_b64_tr_b16 v[108:109], v125 offset:16384
    v_mfma_f32_16x16x32_bf16 v[48:51], v[28:31], v[28:31], v[48:51]
    ds_read_b64_tr_b16 v[110:111], v125 offset:16640
    v_mfma_f32_16x16x32_bf16 v[52:55], v[32:35], v[32:35], v[52:55]
    ds_read_b64_tr_b16 v[112:113], v126 offset:12288
    v_mfma_f32_16x16x32_bf16 v[56:59], v[36:39], v[36:39], v[56:59]
    ds_read_b64_tr_b16 v[114:115], v126 offset:12544
    v_mfma_f32_16x16x32_bf16 v[60:63], v[40:43], v[28:31], v[60:63]
    ds_read_b64_tr_b16 v[116:117], v127 offset:12288
    v_mfma_f32_16x16x32_bf16 v[64:67], v[40:43], v[32:35], v[64:67]
    ds_read_b64_tr_b16 v[118:119], v127 offset:12544
    v_mfma_f32_16x16x32_bf16 v[68:71], v[40:43], v[36:39], v[68:71]
    s_waitcnt lgkmcnt(8)
    v_mfma_f32_16x16x32_bf16 v[136:139], v[88:91], v[16:19], v[136:139]
    ds_read_b128 v[28:31], v129 offset:18432
    v_mfma_f32_16x16x32_bf16 v[160:163], v[88:91], v[20:23], v[160:163]
    ds_read_b128 v[32:35], v129 offset:20480
    v_mfma_f32_16x16x32_bf16 v[140:143], v[92:95], v[16:19], v[140:143]
    ds_read_b128 v[36:39], v131 offset:18432
    v_mfma_f32_16x16x32_bf16 v[164:167], v[92:95], v[20:23], v[164:167]
    ds_read_b64_tr_b16 v[88:89], v124 offset:18432
    v_mfma_f32_16x16x32_bf16 v[144:147], v[96:99], v[16:19], v[144:147]
    ds_read_b64_tr_b16 v[90:91], v124 offset:18688
    v_mfma_f32_16x16x32_bf16 v[168:171], v[96:99], v[20:23], v[168:171]
    ds_read_b64_tr_b16 v[92:93], v125 offset:18432
    v_mfma_f32_16x16x32_bf16 v[148:151], v[100:103], v[16:19], v[148:151]
    ds_read_b64_tr_b16 v[94:95], v125 offset:18688
    v_mfma_f32_16x16x32_bf16 v[172:175], v[100:103], v[20:23], v[172:175]
    ds_read_b64_tr_b16 v[96:97], v124 offset:20480
    s_waitcnt lgkmcnt(8)
    v_mfma_f32_16x16x32_bf16 v[152:155], v[16:19], v[104:107], v[152:155]
    ds_read_b64_tr_b16 v[98:99], v124 offset:20736
    v_mfma_f32_16x16x32_bf16 v[176:179], v[20:23], v[104:107], v[176:179]
    ds_read_b64_tr_b16 v[100:101], v125 offset:20480
    v_mfma_f32_16x16x32_bf16 v[156:159], v[16:19], v[108:111], v[156:159]
    ds_read_b64_tr_b16 v[102:103], v125 offset:20736
    v_mfma_f32_16x16x32_bf16 v[180:183], v[20:23], v[108:111], v[180:183]
    ds_read_b64_tr_b16 v[104:105], v124 offset:22528
    v_mfma_f32_16x16x32_bf16 v[184:187], v[112:115], v[24:27], v[184:187]
    ds_read_b64_tr_b16 v[106:107], v124 offset:22784
    v_mfma_f32_16x16x32_bf16 v[188:191], v[116:119], v[24:27], v[188:191]
    ds_read_b64_tr_b16 v[108:109], v125 offset:22528
    v_mfma_f32_16x16x32_bf16 v[48:51], v[16:19], v[16:19], v[48:51]
    ds_read_b64_tr_b16 v[110:111], v125 offset:22784
    v_mfma_f32_16x16x32_bf16 v[52:55], v[20:23], v[20:23], v[52:55]
    ds_read_b64_tr_b16 v[112:113], v126 offset:18432
    v_mfma_f32_16x16x32_bf16 v[56:59], v[24:27], v[24:27], v[56:59]
    ds_read_b64_tr_b16 v[114:115], v126 offset:18688
    v_mfma_f32_16x16x32_bf16 v[60:63], v[40:43], v[16:19], v[60:63]
    ds_read_b64_tr_b16 v[116:117], v127 offset:18432
    v_mfma_f32_16x16x32_bf16 v[64:67], v[40:43], v[20:23], v[64:67]
    ds_read_b64_tr_b16 v[118:119], v127 offset:18688
    v_mfma_f32_16x16x32_bf16 v[68:71], v[40:43], v[24:27], v[68:71]
    s_waitcnt vmcnt(3)
    s_barrier
    s_waitcnt lgkmcnt(8)
    v_mfma_f32_16x16x32_bf16 v[136:139], v[88:91], v[28:31], v[136:139]
    ds_read_b128 v[16:19], v128 offset:0
    v_mfma_f32_16x16x32_bf16 v[160:163], v[88:91], v[32:35], v[160:163]
    ds_read_b128 v[20:23], v128 offset:2048
    v_mfma_f32_16x16x32_bf16 v[140:143], v[92:95], v[28:31], v[140:143]
    ds_read_b128 v[24:27], v130 offset:0
    v_mfma_f32_16x16x32_bf16 v[164:167], v[92:95], v[32:35], v[164:167]
    ds_read_b64_tr_b16 v[88:89], v124 offset:24576
    v_mfma_f32_16x16x32_bf16 v[144:147], v[96:99], v[28:31], v[144:147]
    ds_read_b64_tr_b16 v[90:91], v124 offset:24832
    v_mfma_f32_16x16x32_bf16 v[168:171], v[96:99], v[32:35], v[168:171]
    ds_read_b64_tr_b16 v[92:93], v125 offset:24576
    v_mfma_f32_16x16x32_bf16 v[148:151], v[100:103], v[28:31], v[148:151]
    ds_read_b64_tr_b16 v[94:95], v125 offset:24832
    v_mfma_f32_16x16x32_bf16 v[172:175], v[100:103], v[32:35], v[172:175]
    ds_read_b64_tr_b16 v[96:97], v124 offset:26624
    s_waitcnt lgkmcnt(8)
    v_mfma_f32_16x16x32_bf16 v[152:155], v[28:31], v[104:107], v[152:155]
    ds_read_b64_tr_b16 v[98:99], v124 offset:26880
    v_mfma_f32_16x16x32_bf16 v[176:179], v[32:35], v[104:107], v[176:179]
    ds_read_b64_tr_b16 v[100:101], v125 offset:26624
    v_mfma_f32_16x16x32_bf16 v[156:159], v[28:31], v[108:111], v[156:159]
    ds_read_b64_tr_b16 v[102:103], v125 offset:26880
    v_mfma_f32_16x16x32_bf16 v[180:183], v[32:35], v[108:111], v[180:183]
    ds_read_b64_tr_b16 v[104:105], v124 offset:28672
    v_mfma_f32_16x16x32_bf16 v[184:187], v[112:115], v[36:39], v[184:187]
    ds_read_b64_tr_b16 v[106:107], v124 offset:28928
    v_mfma_f32_16x16x32_bf16 v[188:191], v[116:119], v[36:39], v[188:191]
    ds_read_b64_tr_b16 v[108:109], v125 offset:28672
    v_mfma_f32_16x16x32_bf16 v[48:51], v[28:31], v[28:31], v[48:51]
    ds_read_b64_tr_b16 v[110:111], v125 offset:28928
    v_mfma_f32_16x16x32_bf16 v[52:55], v[32:35], v[32:35], v[52:55]
    ds_read_b64_tr_b16 v[112:113], v126 offset:24576
    v_mfma_f32_16x16x32_bf16 v[56:59], v[36:39], v[36:39], v[56:59]
    ds_read_b64_tr_b16 v[114:115], v126 offset:24832
    v_mfma_f32_16x16x32_bf16 v[60:63], v[40:43], v[28:31], v[60:63]
    ds_read_b64_tr_b16 v[116:117], v127 offset:24576
    v_mfma_f32_16x16x32_bf16 v[64:67], v[40:43], v[32:35], v[64:67]
    ds_read_b64_tr_b16 v[118:119], v127 offset:24832
    v_mfma_f32_16x16x32_bf16 v[68:71], v[40:43], v[36:39], v[68:71]
    s_waitcnt lgkmcnt(8)
    v_mfma_f32_16x16x32_bf16 v[136:139], v[88:91], v[16:19], v[136:139]
    ds_read_b128 v[28:31], v129 offset:0
    v_mfma_f32_16x16x32_bf16 v[160:163], v[88:91], v[20:23], v[160:163]
    ds_read_b128 v[32:35], v129 offset:2048
    v_mfma_f32_16x16x32_bf16 v[140:143], v[92:95], v[16:19], v[140:143]
    ds_read_b128 v[36:39], v131 offset:0
    v_mfma_f32_16x16x32_bf16 v[164:167], v[92:95], v[20:23], v[164:167]
    ds_read_b64_tr_b16 v[88:89], v124 offset:30720
    v_mfma_f32_16x16x32_bf16 v[144:147], v[96:99], v[16:19], v[144:147]
    ds_read_b64_tr_b16 v[90:91], v124 offset:30976
    v_mfma_f32_16x16x32_bf16 v[168:171], v[96:99], v[20:23], v[168:171]
    ds_read_b64_tr_b16 v[92:93], v125 offset:30720
    v_mfma_f32_16x16x32_bf16 v[148:151], v[100:103], v[16:19], v[148:151]
    ds_read_b64_tr_b16 v[94:95], v125 offset:30976
    v_mfma_f32_16x16x32_bf16 v[172:175], v[100:103], v[20:23], v[172:175]
    ds_read_b64_tr_b16 v[96:97], v124 offset:32768
    s_waitcnt lgkmcnt(8)
    v_mfma_f32_16x16x32_bf16 v[152:155], v[16:19], v[104:107], v[152:155]
    ds_read_b64_tr_b16 v[98:99], v124 offset:33024
    v_mfma_f32_16x16x32_bf16 v[176:179], v[20:23], v[104:107], v[176:179]
    ds_read_b64_tr_b16 v[100:101], v125 offset:32768
    v_mfma_f32_16x16x32_bf16 v[156:159], v[16:19], v[108:111], v[156:159]
    ds_read_b64_tr_b16 v[102:103], v125 offset:33024
    v_mfma_f32_16x16x32_bf16 v[180:183], v[20:23], v[108:111], v[180:183]
    ds_read_b64_tr_b16 v[104:105], v124 offset:34816
    v_mfma_f32_16x16x32_bf16 v[184:187], v[112:115], v[24:27], v[184:187]
    ds_read_b64_tr_b16 v[106:107], v124 offset:35072
    v_mfma_f32_16x16x32_bf16 v[188:191], v[116:119], v[24:27], v[188:191]
    ds_read_b64_tr_b16 v[108:109], v125 offset:34816
    v_mfma_f32_16x16x32_bf16 v[48:51], v[16:19], v[16:19], v[48:51]
    ds_read_b64_tr_b16 v[110:111], v125 offset:35072
    v_mfma_f32_16x16x32_bf16 v[52:55], v[20:23], v[20:23], v[52:55]
    ds_read_b64_tr_b16 v[112:113], v126 offset:30720
    v_mfma_f32_16x16x32_bf16 v[56:59], v[24:27], v[24:27], v[56:59]
    ds_read_b64_tr_b16 v[114:115], v126 offset:30976
    v_mfma_f32_16x16x32_bf16 v[60:63], v[40:43], v[16:19], v[60:63]
    ds_read_b64_tr_b16 v[116:117], v127 offset:30720
    v_mfma_f32_16x16x32_bf16 v[64:67], v[40:43], v[20:23], v[64:67]
    ds_read_b64_tr_b16 v[118:119], v127 offset:30976
    v_mfma_f32_16x16x32_bf16 v[68:71], v[40:43], v[24:27], v[68:71]
    s_waitcnt lgkmcnt(9)
    v_mfma_f32_16x16x32_bf16 v[48:51], v[28:31], v[28:31], v[48:51]
    v_mfma_f32_16x16x32_bf16 v[52:55], v[32:35], v[32:35], v[52:55]
    v_mfma_f32_16x16x32_bf16 v[56:59], v[36:39], v[36:39], v[56:59]
    v_mfma_f32_16x16x32_bf16 v[60:63], v[40:43], v[28:31], v[60:63]
    v_mfma_f32_16x16x32_bf16 v[64:67], v[40:43], v[32:35], v[64:67]
    v_mfma_f32_16x16x32_bf16 v[68:71], v[40:43], v[36:39], v[68:71]
    s_waitcnt lgkmcnt(2)
    v_mfma_f32_16x16x32_bf16 v[184:187], v[112:115], v[36:39], v[184:187]
    s_waitcnt lgkmcnt(0)
    v_mfma_f32_16x16x32_bf16 v[188:191], v[116:119], v[36:39], v[188:191]
    v_mfma_f32_16x16x32_bf16 v[144:147], v[96:99], v[28:31], v[144:147]
    v_cndmask_b32 v48, v48, v49, s[88:89]
    v_cndmask_b32 v52, v52, v53, s[88:89]
    v_cndmask_b32 v56, v56, v57, s[88:89]
    v_mfma_f32_16x16x32_bf16 v[168:171], v[96:99], v[32:35], v[168:171]
    v_cndmask_b32 v48, v48, v50, s[90:91]
    v_cndmask_b32 v52, v52, v54, s[90:91]
    v_cndmask_b32 v56, v56, v58, s[90:91]
    v_mfma_f32_16x16x32_bf16 v[148:151], v[100:103], v[28:31], v[148:151]
    v_cndmask_b32 v48, v48, v51, s[92:93]
    v_cndmask_b32 v52, v52, v55, s[92:93]
    v_cndmask_b32 v56, v56, v59, s[92:93]
    v_mfma_f32_16x16x32_bf16 v[172:175], v[100:103], v[32:35], v[172:175]
    v_mul_f32 v133, 0x3b124925, v60
    v_mul_f32 v135, 0x3b124925, v64
    v_mul_f32 v85, 0x3b124925, v68
    v_mfma_f32_16x16x32_bf16 v[152:155], v[28:31], v[104:107], v[152:155]
    v_mul_f32 v132, v133, v133
    v_mul_f32 v134, v135, v135
    v_mul_f32 v84, v85, v85
    v_mfma_f32_16x16x32_bf16 v[176:179], v[32:35], v[104:107], v[176:179]
    v_mul_f32 v48, 0x3b124925, v48
    v_mul_f32 v52, 0x3b124925, v52
    v_mul_f32 v56, 0x3b124925, v56
    v_mfma_f32_16x16x32_bf16 v[156:159], v[28:31], v[108:111], v[156:159]
    s_mov_b32 exec_lo, 0x00010001
    s_mov_b32 exec_hi, 0x00010001
    ds_write_b128 v73, v[184:187] offset:128
    ds_write_b128 v74, v[188:191] offset:0
    s_mov_b64 exec, -1
    v_sub_f32 v132, v48, v132
    v_sub_f32_e64 v134, v52, v134
    v_mfma_f32_16x16x32_bf16 v[180:183], v[32:35], v[108:111], v[180:183]
    v_sub_f32 v84, v56, v84
    v_max_f32 v132, 0, v132
    v_max_f32_e64 v134, 0, v134
    v_mfma_f32_16x16x32_bf16 v[136:139], v[88:91], v[28:31], v[136:139]
    v_max_f32_e64 v84, 0, v84
    v_add_f32 v132, 0x3727c5ac, v132
    v_add_f32 v134, 0x3727c5ac, v134
    v_mfma_f32_16x16x32_bf16 v[160:163], v[88:91], v[32:35], v[160:163]
    v_add_f32 v84, 0x3727c5ac, v84
    v_rsq_f32 v132, v132
    v_rsq_f32 v134, v134
    v_mfma_f32_16x16x32_bf16 v[140:143], v[92:95], v[28:31], v[140:143]
    v_rsq_f32_e64 v84, v84
    s_mov_b32 exec_lo, 0x00f0000f
    s_mov_b32 exec_hi, 0xf0000f00
    ds_write2_b32 v75, v132, v133 offset0:128 offset1:144
    ds_write2_b32 v75, v134, v135 offset0:160 offset1:176
    ds_write2_b32 v75, v84, v85 offset0:192 offset1:208
    s_mov_b64 exec, -1
    v_mov_b32_dpp v224, v184 row_newbcast:0 row_mask:0xf bank_mask:0xf
    v_mfma_f32_16x16x32_bf16 v[164:167], v[92:95], v[32:35], v[164:167]
    v_mov_b32_dpp v225, v185 row_newbcast:0 row_mask:0xf bank_mask:0xf
    v_mov_b32_dpp v226, v186 row_newbcast:0 row_mask:0xf bank_mask:0xf
    v_mov_b32_dpp v227, v187 row_newbcast:0 row_mask:0xf bank_mask:0xf
    v_fma_f32 v224, -v224, v85, v184
    v_fma_f32 v225, -v225, v85, v185
    v_fma_f32 v226, -v226, v85, v186
    v_fma_f32 v227, -v227, v85, v187
    s_cmp_eq_u32 s49, 15
    s_cselect_b32 s88, 0xffff0000, -1
    s_mov_b32 s89, -1
    s_mov_b32 s90, -1
    s_cselect_b32 s91, -1, 0xffff
    s_waitcnt lgkmcnt(0)
    s_barrier
    ds_read_b32 v134, v75 offset:640
    ds_read_b32 v84, v75 offset:768
    ds_read_b32 v132, v75 offset:512
    ds_read_b128 v[56:59], v72 offset:128
    ds_read_b128 v[60:63], v72 offset:192
    ds_read_b32 v64, v77 offset:256
    ds_read_b32 v65, v77 offset:320
    ds_read_b128 v[44:47], v76 offset:704
    ds_read_b128 v[40:43], v76 offset:640
    ds_read_b128 v[36:39], v76 offset:576
    ds_read_b128 v[32:35], v76 offset:512
    ds_read_b128 v[48:51], v72 offset:0
    ds_read_b128 v[52:55], v72 offset:64
    s_waitcnt lgkmcnt(9)
    v_pk_fma_f32 v[168:169], v[56:57], v[134:135], v[168:169] op_sel:[0,1,0] op_sel_hi:[1,1,1] neg_lo:[0,1,0] neg_hi:[0,1,0]
    v_pk_fma_f32 v[170:171], v[58:59], v[134:135], v[170:171] op_sel:[0,1,0] op_sel_hi:[1,1,1] neg_lo:[0,1,0] neg_hi:[0,1,0]
    v_pk_mul_f32 v[168:169], v[168:169], v[134:135] op_sel:[0,0] op_sel_hi:[1,0]
    v_pk_mul_f32 v[170:171], v[170:171], v[134:135] op_sel:[0,0] op_sel_hi:[1,0]
    v_cvt_pk_bf16_f32 v104, v168, v169
    v_cvt_pk_bf16_f32 v105, v170, v171
    s_waitcnt lgkmcnt(8)
    v_pk_fma_f32 v[172:173], v[60:61], v[134:135], v[172:173] op_sel:[0,1,0] op_sel_hi:[1,1,1] neg_lo:[0,1,0] neg_hi:[0,1,0]
    v_pk_fma_f32 v[174:175], v[62:63], v[134:135], v[174:175] op_sel:[0,1,0] op_sel_hi:[1,1,1] neg_lo:[0,1,0] neg_hi:[0,1,0]
    v_pk_mul_f32 v[172:173], v[172:173], v[134:135] op_sel:[0,0] op_sel_hi:[1,0]
    v_pk_mul_f32 v[174:175], v[174:175], v[134:135] op_sel:[0,0] op_sel_hi:[1,0]
    v_cvt_pk_bf16_f32 v106, v172, v173
    v_cvt_pk_bf16_f32 v107, v174, v175
    ds_write_b128 v78, v[104:107] offset:4096
    v_pk_mul_f32 v[224:225], v[224:225], v[84:85] op_sel_hi:[1,0]
    v_pk_mul_f32 v[226:227], v[226:227], v[84:85] op_sel_hi:[1,0]
    v_cvt_pk_bf16_f32 v224, v224, v225
    v_cvt_pk_bf16_f32 v226, v226, v227
    ds_write_b16 v80, v224 offset:2048
    ds_write_b16_d16_hi v81, v224 offset:2048
    ds_write_b16 v82, v226 offset:2048
    ds_write_b16_d16_hi v83, v226 offset:2048
    s_waitcnt lgkmcnt(10)
    v_pk_fma_f32 v[176:177], v[44:45], v[64:65], v[176:177] op_sel:[0,0,0] op_sel_hi:[1,0,1] neg_lo:[0,1,0] neg_hi:[0,1,0]
    v_pk_fma_f32 v[178:179], v[46:47], v[64:65], v[178:179] op_sel:[0,0,0] op_sel_hi:[1,0,1] neg_lo:[0,1,0] neg_hi:[0,1,0]
    s_waitcnt lgkmcnt(9)
    v_pk_mul_f32 v[176:177], v[176:177], v[40:41]
    v_pk_mul_f32 v[178:179], v[178:179], v[42:43]
    v_cvt_pk_bf16_f32 v112, v176, v177
    v_cvt_pk_bf16_f32 v113, v178, v179
    v_pk_fma_f32 v[180:181], v[44:45], v[64:65], v[180:181] op_sel:[0,1,0] op_sel_hi:[1,1,1] neg_lo:[0,1,0] neg_hi:[0,1,0]
    v_pk_fma_f32 v[182:183], v[46:47], v[64:65], v[182:183] op_sel:[0,1,0] op_sel_hi:[1,1,1] neg_lo:[0,1,0] neg_hi:[0,1,0]
    v_pk_mul_f32 v[180:181], v[180:181], v[40:41]
    v_pk_mul_f32 v[182:183], v[182:183], v[42:43]
    v_cvt_pk_bf16_f32 v118, v180, v181
    v_cvt_pk_bf16_f32 v119, v182, v183
    ds_write_b64 v78, v[112:113] offset:5120
    ds_write_b64 v78, v[118:119] offset:5128
    v_mul_f32 v68, 0x3e8b97f6, v132
    v_mul_f32 v70, 0x3e8b97f6, v134
    v_cndmask_b32 v69, 0, v68, s[90:91]
    v_cndmask_b32 v68, 0, v68, s[88:89]
    v_cndmask_b32 v71, 0, v70, s[90:91]
    v_cndmask_b32 v70, 0, v70, s[88:89]
    v_pk_fma_f32 v[144:145], v[56:57], v[132:133], v[144:145] op_sel:[0,1,0] op_sel_hi:[1,1,1] neg_lo:[0,1,0] neg_hi:[0,1,0]
    v_pk_fma_f32 v[146:147], v[58:59], v[132:133], v[146:147] op_sel:[0,1,0] op_sel_hi:[1,1,1] neg_lo:[0,1,0] neg_hi:[0,1,0]
    v_pk_mul_f32 v[144:145], v[144:145], v[132:133] op_sel:[0,0] op_sel_hi:[1,0]
    v_pk_mul_f32 v[146:147], v[146:147], v[132:133] op_sel:[0,0] op_sel_hi:[1,0]
    v_cvt_pk_bf16_f32 v100, v144, v145
    v_cvt_pk_bf16_f32 v101, v146, v147
    v_pk_fma_f32 v[148:149], v[60:61], v[132:133], v[148:149] op_sel:[0,1,0] op_sel_hi:[1,1,1] neg_lo:[0,1,0] neg_hi:[0,1,0]
    v_pk_fma_f32 v[150:151], v[62:63], v[132:133], v[150:151] op_sel:[0,1,0] op_sel_hi:[1,1,1] neg_lo:[0,1,0] neg_hi:[0,1,0]
    v_pk_mul_f32 v[148:149], v[148:149], v[132:133] op_sel:[0,0] op_sel_hi:[1,0]
    v_pk_mul_f32 v[150:151], v[150:151], v[132:133] op_sel:[0,0] op_sel_hi:[1,0]
    v_cvt_pk_bf16_f32 v102, v148, v149
    v_cvt_pk_bf16_f32 v103, v150, v151
    s_waitcnt lgkmcnt(0)
    s_barrier
    ds_read_b128 v[96:99], v78 offset:2048
    ds_read_b64 v[108:109], v78 offset:3072
    ds_read_b64 v[114:115], v78 offset:3080
    v_pk_fma_f32 v[160:161], v[48:49], v[134:135], v[160:161] op_sel:[0,1,0] op_sel_hi:[1,1,1] neg_lo:[0,1,0] neg_hi:[0,1,0]
    v_pk_fma_f32 v[162:163], v[50:51], v[134:135], v[162:163] op_sel:[0,1,0] op_sel_hi:[1,1,1] neg_lo:[0,1,0] neg_hi:[0,1,0]
    v_pk_mul_f32 v[160:161], v[160:161], v[70:71] op_sel:[0,0] op_sel_hi:[1,0]
    v_pk_mul_f32 v[162:163], v[162:163], v[70:71] op_sel:[0,0] op_sel_hi:[1,0]
    v_cvt_pk_bf16_f32 v92, v160, v161
    v_cvt_pk_bf16_f32 v93, v162, v163
    v_pk_fma_f32 v[164:165], v[52:53], v[134:135], v[164:165] op_sel:[0,1,0] op_sel_hi:[1,1,1] neg_lo:[0,1,0] neg_hi:[0,1,0]
    v_pk_fma_f32 v[166:167], v[54:55], v[134:135], v[166:167] op_sel:[0,1,0] op_sel_hi:[1,1,1] neg_lo:[0,1,0] neg_hi:[0,1,0]
    v_pk_mul_f32 v[164:165], v[164:165], v[70:71] op_sel:[0,1] op_sel_hi:[1,1]
    v_pk_mul_f32 v[166:167], v[166:167], v[70:71] op_sel:[0,1] op_sel_hi:[1,1]
    v_cvt_pk_bf16_f32 v94, v164, v165
    v_cvt_pk_bf16_f32 v95, v166, v167
    s_nop 1
    v_mfma_f32_16x16x32_bf16 v[24:27], v[100:103], v[92:95], v[240:243]
    v_mfma_f32_16x16x32_bf16 v[28:31], v[104:107], v[92:95], v[244:247]
    v_pk_fma_f32 v[136:137], v[48:49], v[132:133], v[136:137] op_sel:[0,1,0] op_sel_hi:[1,1,1] neg_lo:[0,1,0] neg_hi:[0,1,0]
    v_pk_fma_f32 v[138:139], v[50:51], v[132:133], v[138:139] op_sel:[0,1,0] op_sel_hi:[1,1,1] neg_lo:[0,1,0] neg_hi:[0,1,0]
    v_pk_mul_f32 v[136:137], v[136:137], v[68:69] op_sel:[0,0] op_sel_hi:[1,0]
    v_pk_mul_f32 v[138:139], v[138:139], v[68:69] op_sel:[0,0] op_sel_hi:[1,0]
    v_cvt_pk_bf16_f32 v88, v136, v137
    v_cvt_pk_bf16_f32 v89, v138, v139
    v_pk_fma_f32 v[140:141], v[52:53], v[132:133], v[140:141] op_sel:[0,1,0] op_sel_hi:[1,1,1] neg_lo:[0,1,0] neg_hi:[0,1,0]
    v_pk_fma_f32 v[142:143], v[54:55], v[132:133], v[142:143] op_sel:[0,1,0] op_sel_hi:[1,1,1] neg_lo:[0,1,0] neg_hi:[0,1,0]
    v_pk_mul_f32 v[140:141], v[140:141], v[68:69] op_sel:[0,1] op_sel_hi:[1,1]
    v_pk_mul_f32 v[142:143], v[142:143], v[68:69] op_sel:[0,1] op_sel_hi:[1,1]
    v_cvt_pk_bf16_f32 v90, v140, v141
    v_cvt_pk_bf16_f32 v91, v142, v143
    s_waitcnt lgkmcnt(2)
    s_nop 0
    v_mfma_f32_16x16x32_bf16 v[16:19], v[96:99], v[88:91], v[248:251]
    v_mfma_f32_16x16x32_bf16 v[20:23], v[100:103], v[88:91], v[244:247]
    v_pk_fma_f32 v[152:153], v[36:37], v[64:65], v[152:153] op_sel:[0,0,0] op_sel_hi:[1,0,1] neg_lo:[0,1,0] neg_hi:[0,1,0]
    v_pk_fma_f32 v[154:155], v[38:39], v[64:65], v[154:155] op_sel:[0,0,0] op_sel_hi:[1,0,1] neg_lo:[0,1,0] neg_hi:[0,1,0]
    v_pk_mul_f32 v[152:153], v[152:153], v[32:33]
    v_pk_mul_f32 v[154:155], v[154:155], v[34:35]
    v_cvt_pk_bf16_f32 v110, v152, v153
    v_cvt_pk_bf16_f32 v111, v154, v155
    v_pk_fma_f32 v[156:157], v[36:37], v[64:65], v[156:157] op_sel:[0,1,0] op_sel_hi:[1,1,1] neg_lo:[0,1,0] neg_hi:[0,1,0]
    v_pk_fma_f32 v[158:159], v[38:39], v[64:65], v[158:159] op_sel:[0,1,0] op_sel_hi:[1,1,1] neg_lo:[0,1,0] neg_hi:[0,1,0]
    v_pk_mul_f32 v[156:157], v[156:157], v[32:33]
    v_pk_mul_f32 v[158:159], v[158:159], v[34:35]
    v_cvt_pk_bf16_f32 v116, v156, v157
    v_cvt_pk_bf16_f32 v117, v158, v159
    v_max3_f32 v137, v24, v25, v26
    v_max3_f32 v139, v27, v28, v29
    v_max3_f32 v137, v137, v30, v31
    v_max_f32 v137, v137, v139
    v_max3_f32 v136, v16, v17, v18
    v_max3_f32 v138, v19, v20, v21
    v_max3_f32 v136, v136, v22, v23
    v_max_f32 v136, v136, v138
    v_mov_b32 v138, v136
    v_mov_b32 v139, v137
    s_nop 0
    v_permlane32_swap_b32 v136, v138
    v_permlane32_swap_b32 v137, v139
    v_max_f32 v136, v136, v138
    v_max_f32 v137, v137, v139
    v_mov_b32 v138, v136
    v_mov_b32 v139, v137
    s_nop 0
    v_permlane16_swap_b32 v136, v138
    v_permlane16_swap_b32 v137, v139
    v_max_f32 v136, v136, v138
    v_max_f32_e64 v137, v137, v139
    v_pk_add_f32 v[24:25], v[24:25], v[136:137] op_sel:[0,1] op_sel_hi:[1,1] neg_lo:[0,1] neg_hi:[0,1]
    v_pk_add_f32 v[26:27], v[26:27], v[136:137] op_sel:[0,1] op_sel_hi:[1,1] neg_lo:[0,1] neg_hi:[0,1]
    v_pk_add_f32 v[28:29], v[28:29], v[136:137] op_sel:[0,1] op_sel_hi:[1,1] neg_lo:[0,1] neg_hi:[0,1]
    v_pk_add_f32 v[30:31], v[30:31], v[136:137] op_sel:[0,1] op_sel_hi:[1,1] neg_lo:[0,1] neg_hi:[0,1]
    v_exp_f32 v24, v24
    v_exp_f32 v25, v25
    v_exp_f32 v26, v26
    v_exp_f32 v27, v27
    v_exp_f32 v28, v28
    v_exp_f32 v29, v29
    v_exp_f32_e64 v30, v30
    v_exp_f32 v31, v31
    v_cvt_pk_bf16_f32 v148, v24, v25
    v_cvt_pk_bf16_f32 v149, v26, v27
    v_cvt_pk_bf16_f32 v150, v28, v29
    v_cvt_pk_bf16_f32 v151, v30, v31
    s_nop 1
    v_mfma_f32_16x16x32_bf16 v[160:163], v[110:113], v[148:151], 0
    v_mfma_f32_16x16x32_bf16 v[164:167], v[116:119], v[148:151], 0
    v_pk_add_f32 v[16:17], v[16:17], v[136:137] op_sel:[0,0] op_sel_hi:[1,0] neg_lo:[0,1] neg_hi:[0,1]
    v_pk_add_f32 v[18:19], v[18:19], v[136:137] op_sel:[0,0] op_sel_hi:[1,0] neg_lo:[0,1] neg_hi:[0,1]
    v_pk_add_f32 v[20:21], v[20:21], v[136:137] op_sel:[0,0] op_sel_hi:[1,0] neg_lo:[0,1] neg_hi:[0,1]
    v_pk_add_f32 v[22:23], v[22:23], v[136:137] op_sel:[0,0] op_sel_hi:[1,0] neg_lo:[0,1] neg_hi:[0,1]
    v_exp_f32 v16, v16
    v_exp_f32 v17, v17
    v_exp_f32 v18, v18
    v_exp_f32 v19, v19
    v_exp_f32 v20, v20
    v_exp_f32 v21, v21
    v_exp_f32_e64 v22, v22
    v_exp_f32 v23, v23
    v_cvt_pk_bf16_f32 v144, v16, v17
    v_cvt_pk_bf16_f32 v145, v18, v19
    v_cvt_pk_bf16_f32 v146, v20, v21
    v_cvt_pk_bf16_f32 v147, v22, v23
    s_waitcnt lgkmcnt(1)
    s_nop 0
    v_mfma_f32_16x16x32_bf16 v[152:155], v[108:111], v[144:147], 0
    s_waitcnt lgkmcnt(0)
    v_mfma_f32_16x16x32_bf16 v[156:159], v[114:117], v[144:147], 0
    v_pk_add_f32 v[16:17], v[16:17], v[18:19]
    v_pk_add_f32 v[20:21], v[20:21], v[22:23]
    v_pk_add_f32 v[24:25], v[24:25], v[26:27]
    v_pk_add_f32 v[28:29], v[28:29], v[30:31]
    v_pk_add_f32 v[16:17], v[16:17], v[20:21]
    v_pk_add_f32 v[24:25], v[24:25], v[28:29]
    v_add_f32 v140, v16, v17
    v_add_f32 v142, v24, v25
    v_mov_b32 v138, v140
    v_mov_b32 v139, v142
    s_nop 0
    v_permlane32_swap_b32 v140, v138
    v_permlane32_swap_b32 v142, v139
    v_add_f32 v140, v140, v138
    v_add_f32 v142, v142, v139
    v_mov_b32 v138, v140
    v_mov_b32 v139, v142
    s_nop 0
    v_permlane16_swap_b32 v140, v138
    v_permlane16_swap_b32 v142, v139
    v_add_f32 v140, v140, v138
    v_add_f32 v142, v142, v139
    v_rcp_f32 v140, v140
    v_rcp_f32 v142, v142
    v_cndmask_b32 v141, 0, v140, s[90:91]
    v_cndmask_b32 v140, 0, v140, s[88:89]
    v_cndmask_b32 v143, 0, v142, s[90:91]
    v_cndmask_b32 v142, 0, v142, s[88:89]
    v_pk_mul_f32 v[152:153], v[152:153], v[140:141] op_sel_hi:[1,0]
    v_pk_mul_f32 v[154:155], v[154:155], v[140:141] op_sel_hi:[1,0]
    v_pk_mul_f32 v[156:157], v[156:157], v[140:141] op_sel:[0,1] op_sel_hi:[1,1]
    v_pk_mul_f32 v[158:159], v[158:159], v[140:141] op_sel:[0,1] op_sel_hi:[1,1]
    v_cvt_pk_bf16_f32 v144, v152, v153
    v_cvt_pk_bf16_f32 v145, v154, v155
    v_cvt_pk_bf16_f32 v146, v156, v157
    v_cvt_pk_bf16_f32 v147, v158, v159
    buffer_store_dwordx4 v[144:147], v4, s[40:43], s62 offen sc1
    v_pk_mul_f32 v[160:161], v[160:161], v[142:143] op_sel_hi:[1,0]
    v_pk_mul_f32 v[162:163], v[162:163], v[142:143] op_sel_hi:[1,0]
    v_pk_mul_f32 v[164:165], v[164:165], v[142:143] op_sel:[0,1] op_sel_hi:[1,1]
    v_pk_mul_f32 v[166:167], v[166:167], v[142:143] op_sel:[0,1] op_sel_hi:[1,1]
    v_cvt_pk_bf16_f32 v148, v160, v161
    v_cvt_pk_bf16_f32 v149, v162, v163
    v_cvt_pk_bf16_f32 v150, v164, v165
    v_cvt_pk_bf16_f32 v151, v166, v167
    buffer_store_dwordx4 v[148:151], v4, s[40:43], s63 offen sc1
    s_add_u32 m0, s59, 0
    s_mov_b32 s73, 0
    buffer_load_dwordx4 v208, s[16:19], s73 offen lds
    s_add_u32 m0, s59, 1024
    s_mov_b32 s73, 7168
    buffer_load_dwordx4 v208, s[16:19], s73 offen lds
    s_add_u32 m0, s59, 2048
    s_mov_b32 s73, 14336
    buffer_load_dwordx4 v208, s[16:19], s73 offen lds
    s_add_u32 m0, s59, 3072
    s_mov_b32 s73, 21504
    buffer_load_dwordx4 v208, s[16:19], s73 offen lds
    s_add_u32 m0, s59, 4096
    s_mov_b32 s73, 28672
    buffer_load_dwordx4 v208, s[16:19], s73 offen lds
    s_add_u32 m0, s59, 5120
    s_mov_b32 s73, 35840
    buffer_load_dwordx4 v208, s[16:19], s73 offen lds
    s_add_u32 m0, s59, 6144
    s_mov_b32 s73, 43008
    buffer_load_dwordx4 v208, s[16:19], s73 offen lds
    s_add_u32 m0, s59, 7168
    s_mov_b32 s73, 50176
    buffer_load_dwordx4 v208, s[16:19], s73 offen lds
    s_add_u32 m0, s59, 8192
    s_mov_b32 s73, 57344
    buffer_load_dwordx4 v208, s[16:19], s73 offen lds
    s_add_u32 m0, s59, 9216
    s_mov_b32 s73, 64512
    buffer_load_dwordx4 v208, s[16:19], s73 offen lds
    s_add_u32 m0, s59, 10240
    s_mov_b32 s73, 71680
    buffer_load_dwordx4 v208, s[16:19], s73 offen lds
    s_add_u32 m0, s59, 11264
    s_mov_b32 s73, 78848
    buffer_load_dwordx4 v208, s[16:19], s73 offen lds
    s_add_u32 m0, s59, 12288
    s_mov_b32 s73, 86016
    buffer_load_dwordx4 v208, s[16:19], s73 offen lds
    s_add_u32 m0, s59, 13312
    s_mov_b32 s73, 93184
    buffer_load_dwordx4 v208, s[16:19], s73 offen lds
    s_waitcnt vmcnt(18)
    v_readfirstlane_b32 s4, v6
    s_nop 1
    s_cmp_lg_u32 s4, 0
    s_cbranch_scc1 Lepd_P_2
    s_nop 0
Lepg_P_1:
    s_sub_u32 s6, s6, 1
    s_cbranch_scc1 L_end_P
    buffer_load_dword v6, v7, s[44:47], 0 offen sc1
    s_waitcnt vmcnt(0)
    v_readfirstlane_b32 s4, v6
    s_nop 1
    s_cmp_eq_u32 s4, 0
    s_cbranch_scc1 Lepg_P_1
Lepd_P_2:
    s_waitcnt vmcnt(14)
    v_mov_b32 v8, s4
    s_mov_b64 exec, 1
    buffer_store_dword v8, v9, s[40:43], s80 offen sc1
    s_mov_b64 exec, -1
    s_and_b32 s68, s2, 7
    s_cmp_ge_u32 s68, 7
    s_cselect_b32 s48, 7, 0
    s_sub_u32 s68, s68, s48
    s_lshl_b32 s48, s68, 12
    s_add_u32 s68, s68, 1
    s_cmp_ge_u32 s68, 7
    s_cselect_b32 s49, 7, 0
    s_sub_u32 s68, s68, s49
    s_lshl_b32 s49, s68, 12
    s_add_u32 s68, s68, 1
    s_cmp_ge_u32 s68, 7
    s_cselect_b32 s50, 7, 0
    s_sub_u32 s68, s68, s50
    s_lshl_b32 s50, s68, 12
    s_add_u32 s68, s68, 1
    s_cmp_ge_u32 s68, 7
    s_cselect_b32 s51, 7, 0
    s_sub_u32 s68, s68, s51
    s_lshl_b32 s51, s68, 12
    s_add_u32 s68, s68, 1
    s_cmp_ge_u32 s68, 7
    s_cselect_b32 s52, 7, 0
    s_sub_u32 s68, s68, s52
    s_lshl_b32 s52, s68, 12
    s_add_u32 s68, s68, 1
    s_cmp_ge_u32 s68, 7
    s_cselect_b32 s53, 7, 0
    s_sub_u32 s68, s68, s53
    s_lshl_b32 s53, s68, 12
    s_add_u32 s68, s68, 1
    s_cmp_ge_u32 s68, 7
    s_cselect_b32 s54, 7, 0
    s_sub_u32 s68, s68, s54
    s_lshl_b32 s54, s68, 12
    s_cmp_lt_u32 s67, 99
    s_cbranch_scc1 Lnotag_P_3
    s_lshr_b32 s68, s2, 3
    s_sub_u32 s68, s68, 28
    s_mul_i32 s68, s68, 1835008
    s_mul_i32 s69, s3, 57344
    s_add_u32 s68, s68, s69
    s_and_b32 s69, s2, 7
    s_mul_i32 s86, s69, 3
    s_add_u32 s86, s86, 4
    s_lshl_b32 s87, s69, 2
    s_min_u32 s86, s86, s87
    s_lshl_b32 s86, s86, 7
    s_add_u32 s68, s68, s86
    v_lshrrev_b32 v16, 2, v1
    v_mul_u32_u24 v16, 3584, v16
    v_and_b32_e64 v17, 3, v1
    v_lshl_add_u32 v16, v17, 7, v16
    s_mul_i32 s86, s98, 56
    s_add_u32 s86, s86, s68
    buffer_load_dword v30, v16, s[20:23], s86 offen
    s_mul_i32 s86, s99, 56
    s_add_u32 s86, s86, s68
    buffer_load_dword v31, v16, s[20:23], s86 offen
    s_mul_i32 s86, s100, 56
    s_add_u32 s86, s86, s68
    buffer_load_dword v32, v16, s[20:23], s86 offen
    s_mul_i32 s86, s101, 56
    s_add_u32 s86, s86, s68
    buffer_load_dword v33, v16, s[20:23], s86 offen
    s_lshr_b32 s68, s2, 3
    s_sub_u32 s68, s68, 28
    s_mul_i32 s68, s68, 28
    s_add_u32 s68, s68, s3
    s_lshl_b32 s68, s68, 16
    s_and_b32 s69, s2, 7
    s_lshl_b32 s69, s69, 9
    s_add_u32 s68, s68, s69
    v_lshrrev_b32 v16, 2, v1
    v_lshlrev_b32 v16, 12, v16
    v_and_b32_e64 v17, 3, v1
    v_lshl_add_u32 v16, v17, 7, v16
    s_lshl_b32 s86, s48, 6
    s_add_u32 s86, s86, s68
    buffer_load_dword v18, v16, s[24:27], s86 offen
    s_waitcnt vmcnt(1)
    s_lshl_b32 s86, s49, 6
    s_add_u32 s86, s86, s68
    buffer_load_dword v19, v16, s[24:27], s86 offen
    s_waitcnt vmcnt(1)
    s_lshl_b32 s86, s50, 6
    s_add_u32 s86, s86, s68
    buffer_load_dword v20, v16, s[24:27], s86 offen
    s_waitcnt vmcnt(1)
    s_lshl_b32 s86, s51, 6
    s_add_u32 s86, s86, s68
    buffer_load_dword v21, v16, s[24:27], s86 offen
    s_waitcnt vmcnt(1)
    s_lshl_b32 s86, s52, 6
    s_add_u32 s86, s86, s68
    buffer_load_dword v22, v16, s[24:27], s86 offen
    s_waitcnt vmcnt(1)
    s_lshl_b32 s86, s53, 6
    s_add_u32 s86, s86, s68
    buffer_load_dword v23, v16, s[24:27], s86 offen
    s_waitcnt vmcnt(1)
    s_lshl_b32 s86, s54, 6
    s_add_u32 s86, s86, s68
    buffer_load_dword v24, v16, s[24:27], s86 offen
    s_waitcnt vmcnt(1)
    s_waitcnt vmcnt(0)
    s_branch L_end_P
Lnotag_P_3:
    v_lshrrev_b32 v221, 5, v1
    v_mul_u32_u24 v221, 3584, v221
    v_and_b32 v222, 31, v1
    v_lshl_add_u32 v221, v222, 1, v221
    s_lshl_b32 s58, s67, 1
    s_lshr_b32 s60, s3, 1
    s_add_u32 s58, s58, s60
    s_mul_i32 s58, s58, 28672
    s_lshl_b32 s60, s66, 7
    s_add_u32 s58, s58, s60
    s_and_b32 s60, s3, 1
    s_lshl_b32 s60, s60, 6
    s_add_u32 s58, s58, s60
    buffer_load_ushort v192, v221, s[8:11], s58 offen offset:0
    buffer_load_ushort v193, v221, s[8:11], s58 offen offset:896
    buffer_load_ushort v194, v221, s[8:11], s58 offen offset:1792
    buffer_load_ushort v195, v221, s[8:11], s58 offen offset:2688
    s_add_u32 s58, s58, 7168
    buffer_load_ushort v196, v221, s[8:11], s58 offen offset:0
    buffer_load_ushort v197, v221, s[8:11], s58 offen offset:896
    buffer_load_ushort v198, v221, s[8:11], s58 offen offset:1792
    buffer_load_ushort v199, v221, s[8:11], s58 offen offset:2688
    s_add_u32 s58, s58, 7168
    buffer_load_ushort v200, v221, s[8:11], s58 offen offset:0
    buffer_load_ushort v201, v221, s[8:11], s58 offen offset:896
    buffer_load_ushort v202, v221, s[8:11], s58 offen offset:1792
    buffer_load_ushort v203, v221, s[8:11], s58 offen offset:2688
    s_add_u32 s58, s58, 7168
    buffer_load_ushort v204, v221, s[8:11], s58 offen offset:0
    buffer_load_ushort v205, v221, s[8:11], s58 offen offset:896
    buffer_load_ushort v206, v221, s[8:11], s58 offen offset:1792
    buffer_load_ushort v207, v221, s[8:11], s58 offen offset:2688
    s_add_u32 m0, s70, 16384
    s_mul_i32 s73, s94, 56
    s_add_u32 s73, s73, 0
    buffer_load_dwordx4 v213, s[20:23], s73 offen lds
    s_add_u32 m0, s70, 17408
    s_mul_i32 s73, s94, 56
    s_add_u32 s73, s73, 28672
    buffer_load_dwordx4 v213, s[20:23], s73 offen lds
    s_add_u32 m0, s70, 18432
    s_mul_i32 s73, s94, 56
    s_add_u32 s73, s73, 57344
    buffer_load_dwordx4 v213, s[20:23], s73 offen lds
    s_add_u32 m0, s70, 19456
    s_mul_i32 s73, s94, 56
    s_add_u32 s73, s73, 86016
    buffer_load_dwordx4 v213, s[20:23], s73 offen lds
    s_add_u32 m0, s70, 20480
    s_mul_i32 s73, s94, 56
    s_add_u32 s73, s73, 114688
    buffer_load_dwordx4 v213, s[20:23], s73 offen lds
    s_add_u32 m0, s70, 21504
    s_mul_i32 s73, s94, 56
    s_add_u32 s73, s73, 143360
    buffer_load_dwordx4 v213, s[20:23], s73 offen lds
    s_add_u32 m0, s70, 22528
    s_mul_i32 s73, s94, 56
    s_add_u32 s73, s73, 172032
    buffer_load_dwordx4 v213, s[20:23], s73 offen lds
    s_add_u32 m0, s70, 23552
    s_mul_i32 s73, s94, 56
    s_add_u32 s73, s73, 200704
    buffer_load_dwordx4 v213, s[20:23], s73 offen lds
    s_waitcnt vmcnt(25)
    s_barrier
    ds_read_b64_tr_b16 a[0:1], v209 offset:0
    ds_read_b64_tr_b16 a[2:3], v209 offset:2048
    s_add_u32 m0, s70, 24576
    s_mul_i32 s73, s95, 56
    s_add_u32 s73, s73, 0
    buffer_load_dwordx4 v213, s[20:23], s73 offen lds
    ds_read_b64_tr_b16 a[4:5], v209 offset:1024
    ds_read_b64_tr_b16 a[6:7], v209 offset:3072
    s_add_u32 m0, s70, 25600
    s_mul_i32 s73, s95, 56
    s_add_u32 s73, s73, 28672
    buffer_load_dwordx4 v213, s[20:23], s73 offen lds
    ds_read_b64_tr_b16 a[8:9], v209 offset:3584
    ds_read_b64_tr_b16 a[10:11], v209 offset:5632
    ds_read_b64_tr_b16 a[12:13], v209 offset:4608
    ds_read_b64_tr_b16 a[14:15], v209 offset:6656
    s_add_u32 m0, s70, 26624
    s_mul_i32 s73, s95, 56
    s_add_u32 s73, s73, 57344
    buffer_load_dwordx4 v213, s[20:23], s73 offen lds
    ds_read_b64_tr_b16 a[16:17], v209 offset:7168
    ds_read_b64_tr_b16 a[18:19], v209 offset:9216
    s_add_u32 m0, s70, 27648
    s_mul_i32 s73, s95, 56
    s_add_u32 s73, s73, 86016
    buffer_load_dwordx4 v213, s[20:23], s73 offen lds
    ds_read_b64_tr_b16 a[20:21], v209 offset:8192
    ds_read_b64_tr_b16 a[22:23], v209 offset:10240
    ds_read_b64_tr_b16 a[24:25], v209 offset:10752
    ds_read_b64_tr_b16 a[26:27], v209 offset:12800
    s_add_u32 m0, s70, 28672
    s_mul_i32 s73, s95, 56
    s_add_u32 s73, s73, 114688
    buffer_load_dwordx4 v213, s[20:23], s73 offen lds
    ds_read_b64_tr_b16 a[28:29], v209 offset:11776
    ds_read_b64_tr_b16 a[30:31], v210 offset:13824
    s_add_u32 m0, s70, 29696
    s_mul_i32 s73, s95, 56
    s_add_u32 s73, s73, 143360
    buffer_load_dwordx4 v213, s[20:23], s73 offen lds
    ds_read_b64_tr_b16 a[32:33], v209 offset:36864
    ds_read_b64_tr_b16 a[34:35], v209 offset:38912
    ds_read_b64_tr_b16 a[36:37], v209 offset:37888
    ds_read_b64_tr_b16 a[38:39], v209 offset:39936
    s_add_u32 m0, s70, 30720
    s_mul_i32 s73, s95, 56
    s_add_u32 s73, s73, 172032
    buffer_load_dwordx4 v213, s[20:23], s73 offen lds
    ds_read_b64_tr_b16 a[40:41], v209 offset:40448
    ds_read_b64_tr_b16 a[42:43], v209 offset:42496
    s_add_u32 m0, s70, 31744
    s_mul_i32 s73, s95, 56
    s_add_u32 s73, s73, 200704
    buffer_load_dwordx4 v213, s[20:23], s73 offen lds
    ds_read_b64_tr_b16 a[44:45], v209 offset:41472
    ds_read_b64_tr_b16 a[46:47], v209 offset:43520
    ds_read_b64_tr_b16 a[48:49], v209 offset:44032
    ds_read_b64_tr_b16 a[50:51], v209 offset:46080
    s_add_u32 m0, s70, 32768
    s_mul_i32 s73, s96, 56
    s_add_u32 s73, s73, 0
    buffer_load_dwordx4 v213, s[20:23], s73 offen lds
    ds_read_b64_tr_b16 a[52:53], v209 offset:45056
    ds_read_b64_tr_b16 a[54:55], v209 offset:47104
    s_add_u32 m0, s70, 33792
    s_mul_i32 s73, s96, 56
    s_add_u32 s73, s73, 28672
    buffer_load_dwordx4 v213, s[20:23], s73 offen lds
    ds_read_b64_tr_b16 a[56:57], v209 offset:47616
    ds_read_b64_tr_b16 a[58:59], v209 offset:49664
    ds_read_b64_tr_b16 a[60:61], v209 offset:48640
    ds_read_b64_tr_b16 a[62:63], v210 offset:50688
    s_add_u32 m0, s70, 34816
    s_mul_i32 s73, s96, 56
    s_add_u32 s73, s73, 57344
    buffer_load_dwordx4 v213, s[20:23], s73 offen lds
    v_add_u32 v209, 73728, v209
    v_add_u32 v210, 73728, v210
    ds_read_b64_tr_b16 a[64:65], v209 offset:0
    ds_read_b64_tr_b16 a[66:67], v209 offset:2048
    s_add_u32 m0, s70, 35840
    s_mul_i32 s73, s96, 56
    s_add_u32 s73, s73, 86016
    buffer_load_dwordx4 v213, s[20:23], s73 offen lds
    ds_read_b64_tr_b16 a[68:69], v209 offset:1024
    ds_read_b64_tr_b16 a[70:71], v209 offset:3072
    ds_read_b64_tr_b16 a[72:73], v209 offset:3584
    ds_read_b64_tr_b16 a[74:75], v209 offset:5632
    ds_read_b64_tr_b16 a[76:77], v209 offset:4608
    ds_read_b64_tr_b16 a[78:79], v209 offset:6656
    ds_read_b64_tr_b16 a[80:81], v209 offset:7168
    ds_read_b64_tr_b16 a[82:83], v209 offset:9216
    ds_read_b64_tr_b16 a[84:85], v209 offset:8192
    ds_read_b64_tr_b16 a[86:87], v209 offset:10240
    ds_read_b64_tr_b16 a[88:89], v209 offset:10752
    ds_read_b64_tr_b16 a[90:91], v209 offset:12800
    ds_read_b64_tr_b16 a[92:93], v209 offset:11776
    ds_read_b64_tr_b16 a[94:95], v210 offset:13824
    ds_read_b64_tr_b16 a[96:97], v209 offset:36864
    ds_read_b64_tr_b16 a[98:99], v209 offset:38912
    ds_read_b64_tr_b16 a[100:101], v209 offset:37888
    ds_read_b64_tr_b16 a[102:103], v209 offset:39936
    ds_read_b64_tr_b16 a[104:105], v209 offset:40448
    ds_read_b64_tr_b16 a[106:107], v209 offset:42496
    ds_read_b64_tr_b16 a[108:109], v209 offset:41472
    ds_read_b64_tr_b16 a[110:111], v209 offset:43520
    ds_read_b64_tr_b16 a[112:113], v209 offset:44032
    ds_read_b64_tr_b16 a[114:115], v209 offset:46080
    ds_read_b64_tr_b16 a[116:117], v209 offset:45056
    ds_read_b64_tr_b16 a[118:119], v209 offset:47104
    ds_read_b64_tr_b16 a[120:121], v209 offset:47104
    ds_read_b64_tr_b16 a[122:123], v209 offset:49152
    ds_read_b64_tr_b16 a[124:125], v209 offset:48128
    ds_read_b64_tr_b16 a[126:127], v209 offset:50176
    s_waitcnt lgkmcnt(0)
    s_barrier
    buffer_load_dword v249, v10, s[40:43], s83 offen sc1
    s_sleep 3
    buffer_load_dword v250, v10, s[40:43], s83 offen sc1
    s_sleep 3
    s_nop 0
Lpoll_P_4:
    s_sub_u32 s6, s6, 1
    s_cbranch_scc1 L_end_P
    buffer_load_dword v251, v10, s[40:43], s83 offen sc1
    s_waitcnt vmcnt(2)
    v_cmp_ne_u32_e64 vcc, s4, v249
    s_nop 1
    s_cbranch_vccz Lpd_P_5
    buffer_load_dword v249, v10, s[40:43], s83 offen sc1
    s_waitcnt vmcnt(2)
    v_cmp_ne_u32 vcc, s4, v250
    s_nop 1
    s_cbranch_vccz Lpd_P_5
    buffer_load_dword v250, v10, s[40:43], s83 offen sc1
    s_waitcnt vmcnt(2)
    v_cmp_ne_u32 vcc, s4, v251
    s_nop 1
    s_cbranch_vccnz Lpoll_P_4
    s_nop 1
Lpd_P_5:
    s_lshl_b32 s58, s67, 16
    s_lshl_b32 s60, s3, 14
    s_add_u32 s58, s58, s60
    s_add_u32 m0, s70, 0
    s_nop 0
    buffer_load_dwordx4 v4, s[40:43], s58 offen offset:0 sc1 lds
    buffer_load_dwordx4 v4, s[40:43], s58 offen offset:1024 sc1 lds
    buffer_load_dwordx4 v4, s[40:43], s58 offen offset:2048 sc1 lds
    buffer_load_dwordx4 v4, s[40:43], s58 offen offset:3072 sc1 lds
    s_add_u32 m0, s70, 4096
    s_add_u32 s58, s58, 4096
    buffer_load_dwordx4 v4, s[40:43], s58 offen offset:0 sc1 lds
    buffer_load_dwordx4 v4, s[40:43], s58 offen offset:1024 sc1 lds
    buffer_load_dwordx4 v4, s[40:43], s58 offen offset:2048 sc1 lds
    buffer_load_dwordx4 v4, s[40:43], s58 offen offset:3072 sc1 lds
    s_add_u32 m0, s70, 8192
    s_add_u32 s58, s58, 4096
    buffer_load_dwordx4 v4, s[40:43], s58 offen offset:0 sc1 lds
    buffer_load_dwordx4 v4, s[40:43], s58 offen offset:1024 sc1 lds
    buffer_load_dwordx4 v4, s[40:43], s58 offen offset:2048 sc1 lds
    buffer_load_dwordx4 v4, s[40:43], s58 offen offset:3072 sc1 lds
    s_add_u32 m0, s70, 12288
    s_add_u32 s58, s58, 4096
    buffer_load_dwordx4 v4, s[40:43], s58 offen offset:0 sc1 lds
    buffer_load_dwordx4 v4, s[40:43], s58 offen offset:1024 sc1 lds
    buffer_load_dwordx4 v4, s[40:43], s58 offen offset:2048 sc1 lds
    buffer_load_dwordx4 v4, s[40:43], s58 offen offset:3072 sc1 lds
    v_and_b32_e64 v64, 1, v3
    v_mul_u32_u24 v64, 36864, v64
    v_lshl_add_u32 v64, v2, 4, v64
    v_lshrrev_b32 v65, 5, v1
    v_lshl_add_u32 v64, v65, 8, v64
    s_lshr_b32 s60, s3, 1
    s_mul_i32 s60, s60, 73728
    s_add_u32 s60, s60, 12288
    v_add_u32_e64 v64, s60, v64
    ds_read_b64_tr_b16 a[128:129], v215 offset:16384
    ds_read_b64_tr_b16 a[130:131], v215 offset:17408
    ds_read_b64_tr_b16 a[132:133], v216 offset:16384
    ds_read_b64_tr_b16 a[134:135], v216 offset:17408
    ds_read_b64_tr_b16 a[136:137], v215 offset:18432
    ds_read_b64_tr_b16 a[138:139], v215 offset:19456
    ds_read_b64_tr_b16 a[140:141], v216 offset:18432
    ds_read_b64_tr_b16 a[142:143], v216 offset:19456
    ds_read_b64_tr_b16 a[144:145], v215 offset:20480
    ds_read_b64_tr_b16 a[146:147], v215 offset:21504
    ds_read_b64_tr_b16 a[148:149], v216 offset:20480
    ds_read_b64_tr_b16 a[150:151], v216 offset:21504
    ds_read_b64_tr_b16 a[152:153], v215 offset:22528
    ds_read_b64_tr_b16 a[154:155], v215 offset:23552
    ds_read_b64_tr_b16 a[156:157], v216 offset:22528
    ds_read_b64_tr_b16 a[158:159], v216 offset:23552
    ds_read_b64_tr_b16 a[160:161], v215 offset:24576
    ds_read_b64_tr_b16 a[162:163], v215 offset:25600
    ds_read_b64_tr_b16 a[164:165], v216 offset:24576
    ds_read_b64_tr_b16 a[166:167], v216 offset:25600
    ds_read_b64_tr_b16 a[168:169], v215 offset:26624
    ds_read_b64_tr_b16 a[170:171], v215 offset:27648
    ds_read_b64_tr_b16 a[172:173], v216 offset:26624
    ds_read_b64_tr_b16 a[174:175], v216 offset:27648
    ds_read_b64_tr_b16 a[176:177], v215 offset:28672
    ds_read_b64_tr_b16 a[178:179], v215 offset:29696
    ds_read_b64_tr_b16 a[180:181], v216 offset:28672
    ds_read_b64_tr_b16 a[182:183], v216 offset:29696
    ds_read_b64_tr_b16 a[184:185], v215 offset:30720
    ds_read_b64_tr_b16 a[186:187], v215 offset:31744
    ds_read_b64_tr_b16 a[188:189], v216 offset:30720
    ds_read_b64_tr_b16 a[190:191], v216 offset:31744
    ds_read_b64_tr_b16 a[192:193], v215 offset:32768
    ds_read_b64_tr_b16 a[194:195], v215 offset:33792
    ds_read_b64_tr_b16 a[196:197], v216 offset:32768
    ds_read_b64_tr_b16 a[198:199], v216 offset:33792
    ds_read_b64_tr_b16 a[200:201], v215 offset:34816
    ds_read_b64_tr_b16 a[202:203], v215 offset:35840
    ds_read_b64_tr_b16 a[204:205], v216 offset:34816
    ds_read_b64_tr_b16 a[206:207], v216 offset:35840
    v_lshlrev_b32 v192, 16, v192
    v_lshlrev_b32 v193, 16, v193
    v_lshlrev_b32 v194, 16, v194
    v_lshlrev_b32 v195, 16, v195
    v_lshlrev_b32 v196, 16, v196
    v_lshlrev_b32 v197, 16, v197
    v_lshlrev_b32 v198, 16, v198
    v_lshlrev_b32 v199, 16, v199
    v_lshlrev_b32 v200, 16, v200
    v_lshlrev_b32 v201, 16, v201
    v_lshlrev_b32 v202, 16, v202
    v_lshlrev_b32 v203, 16, v203
    v_lshlrev_b32 v204, 16, v204
    v_lshlrev_b32 v205, 16, v205
    v_lshlrev_b32_e64 v206, 16, v206
    v_lshlrev_b32 v207, 16, v207
    s_waitcnt vmcnt(8)
    s_barrier
    ds_read_b128 v[32:35], v64 offset:0
    ds_read_b128 v[36:39], v64 offset:512
    ds_read_b128 v[40:43], v64 offset:1024
    ds_read_b128 v[44:47], v64 offset:1536
    ds_read_b128 v[48:51], v64 offset:2048
    ds_read_b128 v[52:55], v64 offset:2560
    s_waitcnt lgkmcnt(5)
    v_mfma_f32_32x32x16_bf16 v[192:207], v[32:35], a[0:3], v[192:207]
    ds_read_b128 v[56:59], v64 offset:3072
    s_add_u32 m0, s70, 16384
    s_mul_i32 s73, s96, 56
    s_add_u32 s73, s73, 114688
    buffer_load_dwordx4 v213, s[20:23], s73 offen lds
    s_waitcnt lgkmcnt(5)
    v_mfma_f32_32x32x16_bf16 v[192:207], v[36:39], a[4:7], v[192:207]
    ds_read_b128 v[60:63], v64 offset:3584
    s_waitcnt lgkmcnt(5)
    v_mfma_f32_32x32x16_bf16 v[192:207], v[40:43], a[8:11], v[192:207]
    ds_read_b128 v[32:35], v64 offset:4096
    s_waitcnt lgkmcnt(5)
    v_mfma_f32_32x32x16_bf16 v[192:207], v[44:47], a[12:15], v[192:207]
    ds_read_b128 v[36:39], v64 offset:4608
    s_add_u32 m0, s70, 17408
    s_mul_i32 s73, s96, 56
    s_add_u32 s73, s73, 143360
    buffer_load_dwordx4 v213, s[20:23], s73 offen lds
    s_waitcnt lgkmcnt(5)
    v_mfma_f32_32x32x16_bf16 v[192:207], v[48:51], a[16:19], v[192:207]
    ds_read_b128 v[40:43], v64 offset:5120
    s_waitcnt lgkmcnt(5)
    v_mfma_f32_32x32x16_bf16 v[192:207], v[52:55], a[20:23], v[192:207]
    ds_read_b128 v[44:47], v64 offset:5632
    s_waitcnt lgkmcnt(5)
    v_mfma_f32_32x32x16_bf16 v[192:207], v[56:59], a[24:27], v[192:207]
    ds_read_b128 v[48:51], v64 offset:6144
    s_add_u32 m0, s70, 18432
    s_mul_i32 s73, s96, 56
    s_add_u32 s73, s73, 172032
    buffer_load_dwordx4 v213, s[20:23], s73 offen lds
    s_waitcnt lgkmcnt(5)
    v_mfma_f32_32x32x16_bf16 v[192:207], v[60:63], a[28:31], v[192:207]
    ds_read_b128 v[52:55], v64 offset:6656
    s_waitcnt lgkmcnt(5)
    v_mfma_f32_32x32x16_bf16 v[192:207], v[32:35], a[32:35], v[192:207]
    ds_read_b128 v[56:59], v64 offset:7168
    s_waitcnt lgkmcnt(5)
    v_mfma_f32_32x32x16_bf16 v[192:207], v[36:39], a[36:39], v[192:207]
    ds_read_b128 v[60:63], v64 offset:7680
    s_add_u32 m0, s70, 19456
    s_mul_i32 s73, s96, 56
    s_add_u32 s73, s73, 200704
    buffer_load_dwordx4 v213, s[20:23], s73 offen lds
    s_waitcnt lgkmcnt(5)
    v_mfma_f32_32x32x16_bf16 v[192:207], v[40:43], a[40:43], v[192:207]
    s_waitcnt lgkmcnt(4)
    v_mfma_f32_32x32x16_bf16 v[192:207], v[44:47], a[44:47], v[192:207]
    s_waitcnt vmcnt(4)
    s_barrier
    ds_read_b128 v[32:35], v64 offset:8192
    ds_read_b128 v[36:39], v64 offset:8704
    s_waitcnt lgkmcnt(5)
    v_mfma_f32_32x32x16_bf16 v[192:207], v[48:51], a[48:51], v[192:207]
    ds_read_b128 v[40:43], v64 offset:9216
    s_add_u32 m0, s70, 20480
    s_mul_i32 s73, s97, 56
    s_add_u32 s73, s73, 0
    buffer_load_dwordx4 v213, s[20:23], s73 offen lds
    s_waitcnt lgkmcnt(5)
    v_mfma_f32_32x32x16_bf16 v[192:207], v[52:55], a[52:55], v[192:207]
    ds_read_b128 v[44:47], v64 offset:9728
    s_waitcnt lgkmcnt(5)
    v_mfma_f32_32x32x16_bf16 v[192:207], v[56:59], a[56:59], v[192:207]
    ds_read_b128 v[48:51], v64 offset:10240
    s_waitcnt lgkmcnt(5)
    v_mfma_f32_32x32x16_bf16 v[192:207], v[60:63], a[60:63], v[192:207]
    ds_read_b128 v[52:55], v64 offset:10752
    s_add_u32 m0, s70, 21504
    s_mul_i32 s73, s97, 56
    s_add_u32 s73, s73, 28672
    buffer_load_dwordx4 v213, s[20:23], s73 offen lds
    s_waitcnt lgkmcnt(5)
    v_mfma_f32_32x32x16_bf16 v[192:207], v[32:35], a[64:67], v[192:207]
    ds_read_b128 v[56:59], v64 offset:11264
    s_waitcnt lgkmcnt(5)
    v_mfma_f32_32x32x16_bf16 v[192:207], v[36:39], a[68:71], v[192:207]
    ds_read_b128 v[60:63], v64 offset:11776
    s_waitcnt lgkmcnt(5)
    v_mfma_f32_32x32x16_bf16 v[192:207], v[40:43], a[72:75], v[192:207]
    ds_read_b128 v[32:35], v64 offset:12288
    s_add_u32 m0, s70, 22528
    s_mul_i32 s73, s97, 56
    s_add_u32 s73, s73, 57344
    buffer_load_dwordx4 v213, s[20:23], s73 offen lds
    s_waitcnt lgkmcnt(5)
    v_mfma_f32_32x32x16_bf16 v[192:207], v[44:47], a[76:79], v[192:207]
    ds_read_b128 v[36:39], v64 offset:12800
    s_waitcnt lgkmcnt(5)
    v_mfma_f32_32x32x16_bf16 v[192:207], v[48:51], a[80:83], v[192:207]
    ds_read_b128 v[40:43], v64 offset:13312
    s_waitcnt lgkmcnt(5)
    v_mfma_f32_32x32x16_bf16 v[192:207], v[52:55], a[84:87], v[192:207]
    ds_read_b128 v[44:47], v64 offset:13824
    s_add_u32 m0, s70, 23552
    s_mul_i32 s73, s97, 56
    s_add_u32 s73, s73, 86016
    buffer_load_dwordx4 v213, s[20:23], s73 offen lds
    s_waitcnt lgkmcnt(5)
    v_mfma_f32_32x32x16_bf16 v[192:207], v[56:59], a[88:91], v[192:207]
    ds_read_b128 v[48:51], v64 offset:14336
    s_waitcnt lgkmcnt(5)
    v_mfma_f32_32x32x16_bf16 v[192:207], v[60:63], a[92:95], v[192:207]
    ds_read_b128 v[52:55], v64 offset:14848
    s_waitcnt lgkmcnt(5)
    v_mfma_f32_32x32x16_bf16 v[192:207], v[32:35], a[96:99], v[192:207]
    ds_read_b128 v[56:59], v64 offset:15360
    s_add_u32 m0, s70, 24576
    s_mul_i32 s73, s97, 56
    s_add_u32 s73, s73, 114688
    buffer_load_dwordx4 v213, s[20:23], s73 offen lds
    s_waitcnt lgkmcnt(5)
    v_mfma_f32_32x32x16_bf16 v[192:207], v[36:39], a[100:103], v[192:207]
    ds_read_b128 v[60:63], v64 offset:15872
    s_waitcnt lgkmcnt(5)
    v_mfma_f32_32x32x16_bf16 v[192:207], v[40:43], a[104:107], v[192:207]
    s_waitcnt lgkmcnt(4)
    v_mfma_f32_32x32x16_bf16 v[192:207], v[44:47], a[108:111], v[192:207]
    s_add_u32 m0, s70, 25600
    s_mul_i32 s73, s97, 56
    s_add_u32 s73, s73, 143360
    buffer_load_dwordx4 v213, s[20:23], s73 offen lds
    s_waitcnt lgkmcnt(3)
    v_mfma_f32_32x32x16_bf16 v[192:207], v[48:51], a[112:115], v[192:207]
    s_waitcnt lgkmcnt(2)
    v_mfma_f32_32x32x16_bf16 v[192:207], v[52:55], a[116:119], v[192:207]
    s_waitcnt lgkmcnt(1)
    v_mfma_f32_32x32x16_bf16 v[192:207], v[56:59], a[120:123], v[192:207]
    s_add_u32 m0, s70, 26624
    s_mul_i32 s73, s97, 56
    s_add_u32 s73, s73, 172032
    buffer_load_dwordx4 v213, s[20:23], s73 offen lds
    s_waitcnt lgkmcnt(0)
    v_mfma_f32_32x32x16_bf16 v[192:207], v[60:63], a[124:127], v[192:207]
    s_nop 11
    v_pk_mul_f32 v[68:69], v[192:193], v[192:193]
    v_pk_mul_f32 v[70:71], v[194:195], v[194:195]
    v_pk_mul_f32 v[72:73], v[196:197], v[196:197]
    v_pk_mul_f32 v[74:75], v[198:199], v[198:199]
    v_pk_mul_f32 v[76:77], v[200:201], v[200:201]
    v_pk_mul_f32 v[78:79], v[202:203], v[202:203]
    v_pk_mul_f32 v[80:81], v[204:205], v[204:205]
    v_pk_mul_f32 v[82:83], v[206:207], v[206:207]
    s_add_u32 m0, s70, 27648
    s_mul_i32 s73, s97, 56
    s_add_u32 s73, s73, 200704
    buffer_load_dwordx4 v213, s[20:23], s73 offen lds
    v_add_f32_dpp v84, v192, v192 row_mirror row_mask:0xf bank_mask:0x3
    v_add_f32_dpp v85, v193, v193 row_mirror row_mask:0xf bank_mask:0x3
    v_add_f32_dpp v86, v196, v196 row_mirror row_mask:0xf bank_mask:0x3
    v_add_f32_dpp v87, v197, v197 row_mirror row_mask:0xf bank_mask:0x3
    v_add_f32_dpp v88, v200, v200 row_mirror row_mask:0xf bank_mask:0x3
    v_add_f32_dpp v89, v201, v201 row_mirror row_mask:0xf bank_mask:0x3
    v_add_f32_dpp v90, v204, v204 row_mirror row_mask:0xf bank_mask:0x3
    v_add_f32_dpp v91, v205, v205 row_mirror row_mask:0xf bank_mask:0x3
    s_add_u32 m0, s70, 28672
    s_mul_i32 s73, s98, 56
    s_add_u32 s73, s73, 0
    buffer_load_dwordx4 v213, s[20:23], s73 offen lds
    v_add_f32_dpp v92, v68, v68 row_mirror row_mask:0xf bank_mask:0x3
    v_add_f32_dpp v93, v69, v69 row_mirror row_mask:0xf bank_mask:0x3
    v_add_f32_dpp v94, v72, v72 row_mirror row_mask:0xf bank_mask:0x3
    v_add_f32_dpp v95, v73, v73 row_mirror row_mask:0xf bank_mask:0x3
    v_add_f32_dpp v96, v76, v76 row_mirror row_mask:0xf bank_mask:0x3
    v_add_f32_dpp v97, v77, v77 row_mirror row_mask:0xf bank_mask:0x3
    v_add_f32_dpp v98, v80, v80 row_mirror row_mask:0xf bank_mask:0x3
    v_add_f32_dpp v99, v81, v81 row_mirror row_mask:0xf bank_mask:0x3
    s_add_u32 m0, s70, 29696
    s_mul_i32 s73, s98, 56
    s_add_u32 s73, s73, 28672
    buffer_load_dwordx4 v213, s[20:23], s73 offen lds
    v_add_f32_dpp v84, v194, v194 row_mirror row_mask:0xf bank_mask:0xc
    v_add_f32_dpp v85, v195, v195 row_mirror row_mask:0xf bank_mask:0xc
    v_add_f32_dpp v86, v198, v198 row_mirror row_mask:0xf bank_mask:0xc
    v_add_f32_dpp v87, v199, v199 row_mirror row_mask:0xf bank_mask:0xc
    v_add_f32_dpp v88, v202, v202 row_mirror row_mask:0xf bank_mask:0xc
    v_add_f32_dpp v89, v203, v203 row_mirror row_mask:0xf bank_mask:0xc
    v_add_f32_dpp v90, v206, v206 row_mirror row_mask:0xf bank_mask:0xc
    v_add_f32_dpp v91, v207, v207 row_mirror row_mask:0xf bank_mask:0xc
    s_add_u32 m0, s70, 30720
    s_mul_i32 s73, s98, 56
    s_add_u32 s73, s73, 57344
    buffer_load_dwordx4 v213, s[20:23], s73 offen lds
    v_add_f32_dpp v92, v70, v70 row_mirror row_mask:0xf bank_mask:0xc
    v_add_f32_dpp v93, v71, v71 row_mirror row_mask:0xf bank_mask:0xc
    v_add_f32_dpp v94, v74, v74 row_mirror row_mask:0xf bank_mask:0xc
    v_add_f32_dpp v95, v75, v75 row_mirror row_mask:0xf bank_mask:0xc
    v_add_f32_dpp v96, v78, v78 row_mirror row_mask:0xf bank_mask:0xc
    v_add_f32_dpp v97, v79, v79 row_mirror row_mask:0xf bank_mask:0xc
    v_add_f32_dpp v98, v82, v82 row_mirror row_mask:0xf bank_mask:0xc
    v_add_f32_dpp v99, v83, v83 row_mirror row_mask:0xf bank_mask:0xc
    s_add_u32 m0, s70, 31744
    s_mul_i32 s73, s98, 56
    s_add_u32 s73, s73, 86016
    buffer_load_dwordx4 v213, s[20:23], s73 offen lds
    v_add_f32_dpp v84, v84, v84 row_half_mirror row_mask:0xf bank_mask:0x5
    v_add_f32_dpp v86, v86, v86 row_half_mirror row_mask:0xf bank_mask:0x5
    v_add_f32_dpp v88, v88, v88 row_half_mirror row_mask:0xf bank_mask:0x5
    v_add_f32_dpp v90, v90, v90 row_half_mirror row_mask:0xf bank_mask:0x5
    v_add_f32_dpp v92, v92, v92 row_half_mirror row_mask:0xf bank_mask:0x5
    v_add_f32_dpp v94, v94, v94 row_half_mirror row_mask:0xf bank_mask:0x5
    v_add_f32_dpp v96, v96, v96 row_half_mirror row_mask:0xf bank_mask:0x5
    v_add_f32_dpp v98, v98, v98 row_half_mirror row_mask:0xf bank_mask:0x5
    v_add_f32_dpp v84, v85, v85 row_half_mirror row_mask:0xf bank_mask:0xa
    v_add_f32_dpp v86, v87, v87 row_half_mirror row_mask:0xf bank_mask:0xa
    v_add_f32_dpp v88, v89, v89 row_half_mirror row_mask:0xf bank_mask:0xa
    v_add_f32_dpp v90, v91, v91 row_half_mirror row_mask:0xf bank_mask:0xa
    v_add_f32_dpp v92, v93, v93 row_half_mirror row_mask:0xf bank_mask:0xa
    v_add_f32_dpp v94, v95, v95 row_half_mirror row_mask:0xf bank_mask:0xa
    v_add_f32_dpp v96, v97, v97 row_half_mirror row_mask:0xf bank_mask:0xa
    v_add_f32_dpp v98, v99, v99 row_half_mirror row_mask:0xf bank_mask:0xa
    v_add_f32_dpp v85, v84, v84 quad_perm:[1,0,3,2] row_mask:0xf bank_mask:0xf
    v_add_f32_dpp v87, v86, v86 quad_perm:[1,0,3,2] row_mask:0xf bank_mask:0xf
    v_add_f32_dpp v89, v88, v88 quad_perm:[1,0,3,2] row_mask:0xf bank_mask:0xf
    v_add_f32_dpp v91, v90, v90 quad_perm:[1,0,3,2] row_mask:0xf bank_mask:0xf
    v_add_f32_dpp v93, v92, v92 quad_perm:[1,0,3,2] row_mask:0xf bank_mask:0xf
    v_add_f32_dpp v95, v94, v94 quad_perm:[1,0,3,2] row_mask:0xf bank_mask:0xf
    v_add_f32_dpp v97, v96, v96 quad_perm:[1,0,3,2] row_mask:0xf bank_mask:0xf
    v_add_f32_dpp v99, v98, v98 quad_perm:[1,0,3,2] row_mask:0xf bank_mask:0xf
    v_add_f32_dpp v68, v85, v85 quad_perm:[2,3,0,1] row_mask:0xf bank_mask:0xf
    v_add_f32_dpp v69, v87, v87 quad_perm:[2,3,0,1] row_mask:0xf bank_mask:0xf
    v_add_f32_dpp v70, v89, v89 quad_perm:[2,3,0,1] row_mask:0xf bank_mask:0xf
    v_add_f32_dpp v71, v91, v91 quad_perm:[2,3,0,1] row_mask:0xf bank_mask:0xf
    v_add_f32_dpp v72, v93, v93 quad_perm:[2,3,0,1] row_mask:0xf bank_mask:0xf
    v_add_f32_dpp v73, v95, v95 quad_perm:[2,3,0,1] row_mask:0xf bank_mask:0xf
    v_add_f32_dpp v74, v97, v97 quad_perm:[2,3,0,1] row_mask:0xf bank_mask:0xf
    v_add_f32_dpp v75, v99, v99 quad_perm:[2,3,0,1] row_mask:0xf bank_mask:0xf
    v_permlane16_swap_b32 v68, v69
    v_permlane16_swap_b32 v70, v71
    v_permlane16_swap_b32 v72, v73
    v_permlane16_swap_b32 v74, v75
    v_add_f32 v84, v68, v69
    v_add_f32 v85, v72, v73
    v_add_f32 v86, v70, v71
    v_add_f32 v87, v74, v75
    v_and_b32 v65, 1, v3
    v_lshlrev_b32 v65, 6, v65
    v_lshrrev_b32_e64 v66, 5, v1
    v_lshl_add_u32 v65, v66, 5, v65
    v_bfe_u32 v67, v1, 2, 2
    v_lshl_add_u32 v65, v67, 3, v65
    s_lshl_b32 s58, s3, 8
    v_add_u32 v65, s58, v65
    ds_write_b64 v65, v[84:85] offset:0
    ds_write_b64 v65, v[86:87] offset:128
    v_and_b32 v67, 31, v1
    v_lshlrev_b32 v65, 9, v66
    v_lshl_add_u32 v65, v67, 4, v65
    v_lshlrev_b32_e64 v66, 8, v66
    v_lshl_add_u32 v66, v67, 3, v66
    s_and_b32 s58, s58, 512
    v_add_u32_e64 v66, s58, v66
    s_lshl_b32 s58, s67, 1
    s_lshr_b32 s60, s3, 1
    s_add_u32 s58, s58, s60
    s_lshl_b32 s58, s58, 12
    s_add_u32 s58, s58, 0x548000
    s_lshl_b32 s60, s66, 9
    s_add_u32 s60, s60, s58
    s_waitcnt lgkmcnt(0)
    s_barrier
    ds_read_b64 v[84:85], v66 offset:0
    v_mov_b32 v89, s4
    v_mov_b32 v91, s4
    s_waitcnt lgkmcnt(0)
    v_mov_b32 v88, v84
    v_mov_b32 v90, v85
    s_nop 0
    v_permlane32_swap_b32 v88, v84
    v_permlane32_swap_b32 v90, v85
    v_add_f32 v88, v88, v84
    v_add_f32 v90, v90, v85
    s_bitcmp0_b32 s3, 0
    s_cselect_b32 exec_lo, -1, 0
    s_mov_b32 exec_hi, 0
    buffer_store_dwordx4 v[88:91], v65, s[40:43], s60 offen sc1
    s_mov_b64 exec, -1
    v_cvt_pk_bf16_f32 v240, v192, v193
    v_cvt_pk_bf16_f32 v241, v194, v195
    v_cvt_pk_bf16_f32 v242, v196, v197
    v_cvt_pk_bf16_f32 v243, v198, v199
    v_cvt_pk_bf16_f32 v244, v200, v201
    v_cvt_pk_bf16_f32 v245, v202, v203
    v_cvt_pk_bf16_f32 v246, v204, v205
    v_cvt_pk_bf16_f32 v247, v206, v207
    s_lshl_b32 s61, s66, 1
    s_and_b32 s60, s3, 1
    s_add_u32 s61, s61, s60
    s_lshl_b32 s61, s61, 7
    s_lshl_b32 s60, s67, 2
    s_add_u32 s61, s61, s60
    s_and_b32 s60, s3, 2
    s_add_u32 s61, s61, s60
    s_lshl_b32 s61, s61, 10
    s_add_u32 s61, s61, 0x200000
    v_lshlrev_b32_e64 v66, 4, v67
    v_cmp_gt_u32 s[86:87], 32, v1
    s_add_u32 m0, s70, 0
    s_mul_i32 s73, s98, 56
    s_add_u32 s73, s73, 114688
    buffer_load_dwordx4 v213, s[20:23], s73 offen lds
    s_add_u32 m0, s70, 1024
    s_mul_i32 s73, s98, 56
    s_add_u32 s73, s73, 143360
    buffer_load_dwordx4 v213, s[20:23], s73 offen lds
    s_add_u32 m0, s70, 2048
    s_mul_i32 s73, s98, 56
    s_add_u32 s73, s73, 172032
    buffer_load_dwordx4 v213, s[20:23], s73 offen lds
    s_add_u32 m0, s70, 3072
    s_mul_i32 s73, s98, 56
    s_add_u32 s73, s73, 200704
    buffer_load_dwordx4 v213, s[20:23], s73 offen lds
    s_add_u32 m0, s70, 4096
    s_mul_i32 s73, s99, 56
    s_add_u32 s73, s73, 0
    buffer_load_dwordx4 v213, s[20:23], s73 offen lds
    s_add_u32 m0, s70, 5120
    s_mul_i32 s73, s99, 56
    s_add_u32 s73, s73, 28672
    buffer_load_dwordx4 v213, s[20:23], s73 offen lds
    s_add_u32 m0, s70, 6144
    s_mul_i32 s73, s99, 56
    s_add_u32 s73, s73, 57344
    buffer_load_dwordx4 v213, s[20:23], s73 offen lds
    s_add_u32 m0, s70, 7168
    s_mul_i32 s73, s99, 56
    s_add_u32 s73, s73, 86016
    buffer_load_dwordx4 v213, s[20:23], s73 offen lds
    s_add_u32 m0, s70, 8192
    s_mul_i32 s73, s99, 56
    s_add_u32 s73, s73, 114688
    buffer_load_dwordx4 v213, s[20:23], s73 offen lds
    s_add_u32 m0, s70, 9216
    s_mul_i32 s73, s99, 56
    s_add_u32 s73, s73, 143360
    buffer_load_dwordx4 v213, s[20:23], s73 offen lds
    s_add_u32 m0, s70, 10240
    s_mul_i32 s73, s99, 56
    s_add_u32 s73, s73, 172032
    buffer_load_dwordx4 v213, s[20:23], s73 offen lds
    s_add_u32 m0, s70, 11264
    s_mul_i32 s73, s99, 56
    s_add_u32 s73, s73, 200704
    buffer_load_dwordx4 v213, s[20:23], s73 offen lds
    s_add_u32 m0, s70, 12288
    s_mul_i32 s73, s100, 56
    s_add_u32 s73, s73, 0
    buffer_load_dwordx4 v213, s[20:23], s73 offen lds
    s_add_u32 m0, s70, 13312
    s_mul_i32 s73, s100, 56
    s_add_u32 s73, s73, 28672
    buffer_load_dwordx4 v213, s[20:23], s73 offen lds
    s_add_u32 m0, s70, 14336
    s_mul_i32 s73, s100, 56
    s_add_u32 s73, s73, 57344
    buffer_load_dwordx4 v213, s[20:23], s73 offen lds
    s_add_u32 m0, s70, 15360
    s_mul_i32 s73, s100, 56
    s_add_u32 s73, s73, 86016
    buffer_load_dwordx4 v213, s[20:23], s73 offen lds
    buffer_load_dwordx4 v[96:99], v65, s[40:43], s58 offen offset:0 sc1
    buffer_load_dwordx4 v[100:103], v65, s[40:43], s58 offen offset:1024 sc1
    buffer_load_dwordx4 v[104:107], v65, s[40:43], s58 offen offset:2048 sc1
    buffer_load_dwordx4 v[108:111], v66, s[40:43], s58 offen offset:3072 sc1
    s_sleep 5
    s_nop 0
Lst_P_6:
    s_sub_u32 s6, s6, 1
    s_cbranch_scc1 L_end_P
    buffer_load_dwordx4 v[112:115], v65, s[40:43], s58 offen offset:0 sc1
    buffer_load_dwordx4 v[116:119], v65, s[40:43], s58 offen offset:1024 sc1
    buffer_load_dwordx4 v[120:123], v65, s[40:43], s58 offen offset:2048 sc1
    buffer_load_dwordx4 v[124:127], v66, s[40:43], s58 offen offset:3072 sc1
    s_waitcnt vmcnt(4)
    v_xor_b32 v97, s4, v97
    v_xor_b32 v99, s4, v99
    v_xor_b32 v101, s4, v101
    v_xor_b32 v103, s4, v103
    v_xor_b32 v105, s4, v105
    v_xor_b32 v107, s4, v107
    v_xor_b32 v109, s4, v109
    v_xor_b32_e64 v111, s4, v111
    v_cndmask_b32 v108, 0, v108, s[86:87]
    v_cndmask_b32 v110, 0, v110, s[86:87]
    v_or3_b32 v97, v97, v99, v101
    v_or3_b32 v103, v103, v105, v107
    v_or3_b32 v97, v97, v109, v111
    v_or_b32 v97, v97, v103
    v_cmp_ne_u32 vcc, 0, v97
    v_add_f32 v128, v96, v100
    v_add_f32 v129, v104, v108
    v_add_f32_e64 v130, v98, v102
    v_add_f32 v131, v106, v110
    s_cbranch_vccz Lstd_P_7
    buffer_load_dwordx4 v[96:99], v65, s[40:43], s58 offen offset:0 sc1
    buffer_load_dwordx4 v[100:103], v65, s[40:43], s58 offen offset:1024 sc1
    buffer_load_dwordx4 v[104:107], v65, s[40:43], s58 offen offset:2048 sc1
    buffer_load_dwordx4 v[108:111], v66, s[40:43], s58 offen offset:3072 sc1
    s_waitcnt vmcnt(4)
    v_xor_b32 v113, s4, v113
    v_xor_b32 v115, s4, v115
    v_xor_b32 v117, s4, v117
    v_xor_b32 v119, s4, v119
    v_xor_b32 v121, s4, v121
    v_xor_b32 v123, s4, v123
    v_xor_b32 v125, s4, v125
    v_xor_b32_e64 v127, s4, v127
    v_cndmask_b32 v124, 0, v124, s[86:87]
    v_cndmask_b32 v126, 0, v126, s[86:87]
    v_or3_b32 v113, v113, v115, v117
    v_or3_b32 v119, v119, v121, v123
    v_or3_b32 v113, v113, v125, v127
    v_or_b32 v113, v113, v119
    v_cmp_ne_u32 vcc, 0, v113
    v_add_f32 v128, v112, v116
    v_add_f32 v129, v120, v124
    v_add_f32 v130, v114, v118
    v_add_f32 v131, v122, v126
    s_cbranch_vccnz Lst_P_6
    s_nop 3
Lstd_P_7:
    v_add_f32 v128, v128, v129
    v_add_f32 v130, v130, v131
    v_mov_b32 v136, v128
    v_mov_b32 v138, v130
    s_nop 0
    v_permlane32_swap_b32 v128, v136
    v_permlane32_swap_b32 v130, v138
    v_add_f32 v128, v128, v136
    v_add_f32_e64 v130, v130, v138
    v_mul_f32 v133, 0x3b124925, v128
    v_mul_f32 v130, 0x3b124925, v130
    v_fma_f32 v130, -v133, v133, v130
    v_max_f32_e64 v130, 0, v130
    v_add_f32 v135, 0x3727c5ac, v130
    v_rsq_f32 v135, v135
    s_nop 0
    v_mul_f32_e64 v130, v130, v135
    v_fmaak_f32 v130, v130, v135, 0x3727c5ac
    v_rsq_f32 v130, v130
    s_nop 0
    v_mul_f32 v135, v135, v130
    s_lshl_b32 s60, s3, 8
    v_lshl_add_u32 v66, v67, 2, s60
    ds_write_b32 v66, v133 offset:1024
    ds_write_b32 v66, v135 offset:1152
    v_lshrrev_b32 v66, 5, v1
    v_lshl_add_u32 v66, v66, 4, s60
    s_waitcnt lgkmcnt(0)
    ds_read_b128 v[140:143], v66 offset:1024
    ds_read_b128 v[156:159], v66 offset:1152
    ds_read_b128 v[144:147], v66 offset:1056
    ds_read_b128 v[160:163], v66 offset:1184
    ds_read_b128 v[148:151], v66 offset:1088
    ds_read_b128 v[164:167], v66 offset:1216
    ds_read_b128 v[152:155], v66 offset:1120
    ds_read_b128 v[168:171], v66 offset:1248
    s_waitcnt lgkmcnt(7)
    v_pk_add_f32 v[192:193], v[192:193], v[140:141] neg_lo:[0,1] neg_hi:[0,1]
    v_pk_add_f32 v[194:195], v[194:195], v[142:143] neg_lo:[0,1] neg_hi:[0,1]
    s_waitcnt lgkmcnt(5)
    v_pk_add_f32 v[196:197], v[196:197], v[144:145] neg_lo:[0,1] neg_hi:[0,1]
    v_pk_add_f32 v[198:199], v[198:199], v[146:147] neg_lo:[0,1] neg_hi:[0,1]
    v_pk_mul_f32 v[192:193], v[192:193], v[156:157]
    v_pk_mul_f32 v[194:195], v[194:195], v[158:159]
    s_waitcnt lgkmcnt(4)
    v_pk_mul_f32 v[196:197], v[196:197], v[160:161]
    v_pk_mul_f32 v[198:199], v[198:199], v[162:163]
    v_cvt_pk_bf16_f32 v84, v192, v193
    v_cvt_pk_bf16_f32 v85, v194, v195
    v_cvt_pk_bf16_f32 v86, v196, v197
    v_cvt_pk_bf16_f32 v87, v198, v199
    buffer_store_dwordx4 v[84:87], v4, s[40:43], s61 offen offset:0 sc1
    s_waitcnt lgkmcnt(3)
    v_pk_add_f32 v[200:201], v[200:201], v[148:149] neg_lo:[0,1] neg_hi:[0,1]
    v_pk_add_f32 v[202:203], v[202:203], v[150:151] neg_lo:[0,1] neg_hi:[0,1]
    s_waitcnt lgkmcnt(1)
    v_pk_add_f32 v[204:205], v[204:205], v[152:153] neg_lo:[0,1] neg_hi:[0,1]
    v_pk_add_f32 v[206:207], v[206:207], v[154:155] neg_lo:[0,1] neg_hi:[0,1]
    v_pk_mul_f32 v[200:201], v[200:201], v[164:165]
    v_pk_mul_f32 v[202:203], v[202:203], v[166:167]
    s_waitcnt lgkmcnt(0)
    v_pk_mul_f32 v[204:205], v[204:205], v[168:169]
    v_pk_mul_f32 v[206:207], v[206:207], v[170:171]
    v_cvt_pk_bf16_f32 v88, v200, v201
    v_cvt_pk_bf16_f32 v89, v202, v203
    v_cvt_pk_bf16_f32 v90, v204, v205
    v_cvt_pk_bf16_f32 v91, v206, v207
    buffer_store_dwordx4 v[88:91], v4, s[40:43], s61 offen offset:1024 sc1
    ds_read_b64_tr_b16 a[208:209], v215 offset:16384
    ds_read_b64_tr_b16 a[210:211], v215 offset:17408
    ds_read_b64_tr_b16 a[212:213], v216 offset:16384
    ds_read_b64_tr_b16 a[214:215], v216 offset:17408
    ds_read_b64_tr_b16 a[216:217], v215 offset:18432
    ds_read_b64_tr_b16 a[218:219], v215 offset:19456
    ds_read_b64_tr_b16 a[220:221], v216 offset:18432
    ds_read_b64_tr_b16 a[222:223], v216 offset:19456
    ds_read_b64_tr_b16 a[224:225], v215 offset:20480
    ds_read_b64_tr_b16 a[226:227], v215 offset:21504
    ds_read_b64_tr_b16 a[228:229], v216 offset:20480
    ds_read_b64_tr_b16 a[230:231], v216 offset:21504
    ds_read_b64_tr_b16 a[232:233], v215 offset:22528
    ds_read_b64_tr_b16 a[234:235], v215 offset:23552
    ds_read_b64_tr_b16 a[236:237], v216 offset:22528
    ds_read_b64_tr_b16 a[238:239], v216 offset:23552
    ds_read_b64_tr_b16 a[240:241], v215 offset:24576
    ds_read_b64_tr_b16 a[242:243], v215 offset:25600
    ds_read_b64_tr_b16 a[244:245], v216 offset:24576
    ds_read_b64_tr_b16 a[246:247], v216 offset:25600
    ds_read_b64_tr_b16 a[248:249], v215 offset:26624
    ds_read_b64_tr_b16 a[250:251], v215 offset:27648
    ds_read_b64_tr_b16 a[252:253], v216 offset:26624
    ds_read_b64_tr_b16 a[254:255], v216 offset:27648
    ds_read_b64_tr_b16 a[0:1], v215 offset:28672
    ds_read_b64_tr_b16 a[2:3], v215 offset:29696
    ds_read_b64_tr_b16 a[4:5], v216 offset:28672
    ds_read_b64_tr_b16 a[6:7], v216 offset:29696
    ds_read_b64_tr_b16 a[8:9], v215 offset:30720
    ds_read_b64_tr_b16 a[10:11], v215 offset:31744
    ds_read_b64_tr_b16 a[12:13], v216 offset:30720
    ds_read_b64_tr_b16 a[14:15], v216 offset:31744
    ds_read_b64_tr_b16 a[16:17], v215 offset:0
    ds_read_b64_tr_b16 a[18:19], v215 offset:1024
    ds_read_b64_tr_b16 a[20:21], v216 offset:0
    ds_read_b64_tr_b16 a[22:23], v216 offset:1024
    ds_read_b64_tr_b16 a[24:25], v215 offset:2048
    ds_read_b64_tr_b16 a[26:27], v215 offset:3072
    ds_read_b64_tr_b16 a[28:29], v216 offset:2048
    ds_read_b64_tr_b16 a[30:31], v216 offset:3072
    ds_read_b64_tr_b16 a[32:33], v215 offset:4096
    ds_read_b64_tr_b16 a[34:35], v215 offset:5120
    ds_read_b64_tr_b16 a[36:37], v216 offset:4096
    ds_read_b64_tr_b16 a[38:39], v216 offset:5120
    ds_read_b64_tr_b16 a[40:41], v215 offset:6144
    ds_read_b64_tr_b16 a[42:43], v215 offset:7168
    ds_read_b64_tr_b16 a[44:45], v216 offset:6144
    ds_read_b64_tr_b16 a[46:47], v216 offset:7168
    ds_read_b64_tr_b16 a[48:49], v215 offset:8192
    ds_read_b64_tr_b16 a[50:51], v215 offset:9216
    ds_read_b64_tr_b16 a[52:53], v216 offset:8192
    ds_read_b64_tr_b16 a[54:55], v216 offset:9216
    ds_read_b64_tr_b16 a[56:57], v215 offset:10240
    ds_read_b64_tr_b16 a[58:59], v215 offset:11264
    ds_read_b64_tr_b16 a[60:61], v216 offset:10240
    ds_read_b64_tr_b16 a[62:63], v216 offset:11264
    ds_read_b64_tr_b16 a[64:65], v215 offset:12288
    ds_read_b64_tr_b16 a[66:67], v215 offset:13312
    ds_read_b64_tr_b16 a[68:69], v216 offset:12288
    ds_read_b64_tr_b16 a[70:71], v216 offset:13312
    ds_read_b64_tr_b16 a[72:73], v215 offset:14336
    ds_read_b64_tr_b16 a[74:75], v215 offset:15360
    ds_read_b64_tr_b16 a[76:77], v216 offset:14336
    ds_read_b64_tr_b16 a[78:79], v216 offset:15360
    s_waitcnt vmcnt(0)
    v_mov_b32 v8, s4
    s_mov_b64 exec, 1
    buffer_store_dword v8, v9, s[40:43], s81 offen sc1
    s_mov_b64 exec, -1
    s_waitcnt lgkmcnt(4)
    s_add_u32 m0, s70, 12288
    s_mul_i32 s73, s100, 56
    s_add_u32 s73, s73, 114688
    buffer_load_dwordx4 v213, s[20:23], s73 offen lds
    s_add_u32 m0, s70, 13312
    s_mul_i32 s73, s100, 56
    s_add_u32 s73, s73, 143360
    buffer_load_dwordx4 v213, s[20:23], s73 offen lds
    s_waitcnt lgkmcnt(0)
    s_add_u32 m0, s70, 14336
    s_mul_i32 s73, s100, 56
    s_add_u32 s73, s73, 172032
    buffer_load_dwordx4 v213, s[20:23], s73 offen lds
    s_add_u32 m0, s70, 15360
    s_mul_i32 s73, s100, 56
    s_add_u32 s73, s73, 200704
    buffer_load_dwordx4 v213, s[20:23], s73 offen lds
    s_add_u32 m0, s70, 16384
    s_mul_i32 s73, s101, 56
    s_add_u32 s73, s73, 0
    buffer_load_dwordx4 v213, s[20:23], s73 offen lds
    s_add_u32 m0, s70, 17408
    s_mul_i32 s73, s101, 56
    s_add_u32 s73, s73, 28672
    buffer_load_dwordx4 v213, s[20:23], s73 offen lds
    s_add_u32 m0, s70, 18432
    s_mul_i32 s73, s101, 56
    s_add_u32 s73, s73, 57344
    buffer_load_dwordx4 v213, s[20:23], s73 offen lds
    s_add_u32 m0, s70, 19456
    s_mul_i32 s73, s101, 56
    s_add_u32 s73, s73, 86016
    buffer_load_dwordx4 v213, s[20:23], s73 offen lds
    s_add_u32 m0, s70, 20480
    s_mul_i32 s73, s101, 56
    s_add_u32 s73, s73, 114688
    buffer_load_dwordx4 v213, s[20:23], s73 offen lds
    s_add_u32 m0, s70, 21504
    s_mul_i32 s73, s101, 56
    s_add_u32 s73, s73, 143360
    buffer_load_dwordx4 v213, s[20:23], s73 offen lds
    s_add_u32 m0, s70, 22528
    s_mul_i32 s73, s101, 56
    s_add_u32 s73, s73, 172032
    buffer_load_dwordx4 v213, s[20:23], s73 offen lds
    s_add_u32 m0, s70, 23552
    s_mul_i32 s73, s101, 56
    s_add_u32 s73, s73, 200704
    buffer_load_dwordx4 v213, s[20:23], s73 offen lds
    s_add_u32 m0, s70, 24576
    s_mul_i32 s73, s48, 64
    s_add_u32 s73, s73, 0
    buffer_load_dwordx4 v214, s[24:27], s73 offen lds
    s_add_u32 m0, s70, 25600
    s_mul_i32 s73, s48, 64
    s_add_u32 s73, s73, 32768
    buffer_load_dwordx4 v214, s[24:27], s73 offen lds
    s_add_u32 m0, s70, 26624
    s_mul_i32 s73, s48, 64
    s_add_u32 s73, s73, 65536
    buffer_load_dwordx4 v214, s[24:27], s73 offen lds
    s_add_u32 m0, s70, 27648
    s_mul_i32 s73, s48, 64
    s_add_u32 s73, s73, 98304
    buffer_load_dwordx4 v214, s[24:27], s73 offen lds
    s_add_u32 m0, s70, 28672
    s_mul_i32 s73, s48, 64
    s_add_u32 s73, s73, 131072
    buffer_load_dwordx4 v214, s[24:27], s73 offen lds
    s_add_u32 m0, s70, 29696
    s_mul_i32 s73, s48, 64
    s_add_u32 s73, s73, 163840
    buffer_load_dwordx4 v214, s[24:27], s73 offen lds
    s_add_u32 m0, s70, 30720
    s_mul_i32 s73, s48, 64
    s_add_u32 s73, s73, 196608
    buffer_load_dwordx4 v214, s[24:27], s73 offen lds
    s_add_u32 m0, s70, 31744
    s_mul_i32 s73, s48, 64
    s_add_u32 s73, s73, 229376
    buffer_load_dwordx4 v214, s[24:27], s73 offen lds
    s_add_u32 m0, s70, 32768
    s_mul_i32 s73, s49, 64
    s_add_u32 s73, s73, 0
    buffer_load_dwordx4 v214, s[24:27], s73 offen lds
    s_add_u32 m0, s70, 33792
    s_mul_i32 s73, s49, 64
    s_add_u32 s73, s73, 32768
    buffer_load_dwordx4 v214, s[24:27], s73 offen lds
    s_add_u32 m0, s70, 34816
    s_mul_i32 s73, s49, 64
    s_add_u32 s73, s73, 65536
    buffer_load_dwordx4 v214, s[24:27], s73 offen lds
    s_add_u32 m0, s70, 35840
    s_mul_i32 s73, s49, 64
    s_add_u32 s73, s73, 98304
    buffer_load_dwordx4 v214, s[24:27], s73 offen lds
    s_lshl_b32 s71, s64, 18
    s_lshl_b32 s86, s3, 15
    s_add_u32 s71, s71, s86
    s_add_u32 s71, s71, 0x200000
    s_add_u32 s72, s71, 0x20000
    s_mul_i32 s58, s66, 229376
    s_add_u32 s58, s58, 0x3c0000
    s_lshl_b32 s86, s65, 2
    s_add_u32 s86, s86, s3
    s_lshl_b32 s86, s86, 10
    s_add_u32 s57, s58, s86
    s_mul_i32 s86, s3, 28672
    s_add_u32 s58, s58, s86
    s_add_u32 s59, s58, 114688
    v_lshrrev_b32 v208, 5, v1
    v_lshlrev_b32 v208, 3, v208
    s_lshl_b32 s86, s65, 7
    s_lshl_b32 s87, s3, 5
    s_add_u32 s86, s86, s87
    buffer_load_dwordx2 v[220:221], v208, s[28:31], s86 offen offset:0
    buffer_load_dwordx2 v[222:223], v208, s[28:31], s86 offen offset:16
    s_lshl_b32 s86, s67, 7
    s_lshr_b32 s87, s3, 1
    s_lshl_b32 s87, s87, 6
    s_add_u32 s86, s86, s87
    buffer_load_dwordx2 v[224:225], v208, s[32:35], s86 offen offset:0
    buffer_load_dwordx2 v[226:227], v208, s[32:35], s86 offen offset:16
    buffer_load_dwordx2 v[228:229], v208, s[32:35], s86 offen offset:32
    buffer_load_dwordx2 v[230:231], v208, s[32:35], s86 offen offset:48
    v_add_u32 v232, s70, v4
    s_xor_b32 s86, s3, 1
    s_mul_i32 s86, s86, 36864
    s_add_u32 s86, s86, 12288
    v_add_u32 v233, s86, v4
    s_xor_b32 s86, s3, 2
    s_mul_i32 s86, s86, 36864
    s_add_u32 s86, s86, 14336
    v_add_u32 v234, s86, v4
    s_xor_b32 s86, s3, 3
    s_mul_i32 s86, s86, 36864
    s_add_u32 s86, s86, 16384
    v_add_u32 v235, s86, v4
    v_lshrrev_b32 v208, 5, v1
    v_lshlrev_b32 v208, 9, v208
    v_and_b32 v209, 31, v1
    v_lshl_add_u32 v208, v209, 2, v208
    s_lshr_b32 s86, s3, 1
    s_lshl_b32 s86, s86, 12
    v_add_u32_e64 v208, s86, v208
    v_xor_b32 v209, 0x1000, v208
    v_add_u32_e64 v236, s70, v208
    v_add_u32 v237, s70, v209
    s_lshl_b32 s86, s3, 11
    s_add_u32 s86, s86, 12288
    v_add_u32_e64 v238, s86, v4
    v_add_u32 v239, 73728, v238
    v_lshrrev_b32_e64 v208, 3, v1
    v_mul_u32_u24 v212, 896, v208
    v_and_b32_e64 v208, 7, v1
    v_lshl_add_u32 v212, v208, 3, v212
    s_lshl_b32 s68, s67, 2
    s_add_u32 s68, s68, s3
    s_mul_i32 s68, s68, 14336
    s_lshl_b32 s86, s66, 7
    s_add_u32 s68, s68, s86
    s_add_u32 s69, s68, 7168
    s_mov_b32 s88, 0xc0135761
    s_mov_b32 s89, 0xc0135761
    s_mov_b32 s90, 0xbdd2d3e8
    s_mov_b32 s91, 0xffff0000
    buffer_load_dword v249, v11, s[40:43], s84 offen sc1
    s_sleep 3
    buffer_load_dword v250, v11, s[40:43], s84 offen sc1
    s_sleep 3
    s_nop 0
Lpoll_P_8:
    s_sub_u32 s6, s6, 1
    s_cbranch_scc1 L_end_P
    buffer_load_dword v251, v11, s[40:43], s84 offen sc1
    s_waitcnt vmcnt(2)
    v_cmp_ne_u32_e64 vcc, s4, v249
    s_nop 1
    s_cbranch_vccz Lpd_P_9
    buffer_load_dword v249, v11, s[40:43], s84 offen sc1
    s_waitcnt vmcnt(2)
    v_cmp_ne_u32 vcc, s4, v250
    s_nop 1
    s_cbranch_vccz Lpd_P_9
    buffer_load_dword v250, v11, s[40:43], s84 offen sc1
    s_waitcnt vmcnt(2)
    v_cmp_ne_u32 vcc, s4, v251
    s_nop 1
    s_cbranch_vccnz Lpoll_P_8
    s_nop 1
Lpd_P_9:
    s_add_u32 s56, s71, s94
    buffer_load_dwordx4 v[80:83], v5, s[40:43], s56 offen offset:0 sc1
    buffer_load_dwordx4 v[84:87], v5, s[40:43], s56 offen offset:1024 sc1
    buffer_load_dwordx4 v[88:91], v5, s[40:43], s56 offen offset:2048 sc1
    buffer_load_dwordx4 v[92:95], v5, s[40:43], s56 offen offset:3072 sc1
    s_add_u32 s56, s71, s95
    buffer_load_dwordx4 v[96:99], v5, s[40:43], s56 offen offset:0 sc1
    buffer_load_dwordx4 v[100:103], v5, s[40:43], s56 offen offset:1024 sc1
    buffer_load_dwordx4 v[104:107], v5, s[40:43], s56 offen offset:2048 sc1
    buffer_load_dwordx4 v[108:111], v5, s[40:43], s56 offen offset:3072 sc1
    v_lshlrev_b32 v16, 16, v220
    v_and_b32 v17, s91, v220
    v_lshlrev_b32 v18, 16, v221
    v_and_b32 v19, s91, v221
    v_lshlrev_b32 v20, 16, v222
    v_and_b32 v21, s91, v222
    v_lshlrev_b32 v22, 16, v223
    v_and_b32_e64 v23, s91, v223
    v_mov_b64 v[24:25], 0
    v_mov_b64 v[26:27], 0
    v_mov_b64 v[28:29], 0
    v_mov_b64 v[30:31], 0
    ds_read_b64_tr_b16 a[80:81], v215 offset:12288
    ds_read_b64_tr_b16 a[82:83], v215 offset:13312
    ds_read_b64_tr_b16 a[84:85], v216 offset:12288
    ds_read_b64_tr_b16 a[86:87], v216 offset:13312
    ds_read_b64_tr_b16 a[88:89], v215 offset:14336
    ds_read_b64_tr_b16 a[90:91], v215 offset:15360
    ds_read_b64_tr_b16 a[92:93], v216 offset:14336
    ds_read_b64_tr_b16 a[94:95], v216 offset:15360
    ds_read_b64_tr_b16 a[96:97], v215 offset:16384
    ds_read_b64_tr_b16 a[98:99], v215 offset:17408
    ds_read_b64_tr_b16 a[100:101], v216 offset:16384
    ds_read_b64_tr_b16 a[102:103], v216 offset:17408
    ds_read_b64_tr_b16 a[104:105], v215 offset:18432
    ds_read_b64_tr_b16 a[106:107], v215 offset:19456
    ds_read_b64_tr_b16 a[108:109], v216 offset:18432
    ds_read_b64_tr_b16 a[110:111], v216 offset:19456
    ds_read_b64_tr_b16 a[112:113], v215 offset:20480
    ds_read_b64_tr_b16 a[114:115], v215 offset:21504
    ds_read_b64_tr_b16 a[116:117], v216 offset:20480
    ds_read_b64_tr_b16 a[118:119], v216 offset:21504
    ds_read_b64_tr_b16 a[120:121], v215 offset:22528
    ds_read_b64_tr_b16 a[122:123], v215 offset:23552
    ds_read_b64_tr_b16 a[124:125], v216 offset:22528
    ds_read_b64_tr_b16 a[126:127], v216 offset:23552
    v_mov_b32 v9, v5
    s_add_u32 s56, s71, s96
    buffer_load_dwordx4 v[112:115], v5, s[40:43], s56 offen offset:0 sc1
    buffer_load_dwordx4 v[116:119], v5, s[40:43], s56 offen offset:1024 sc1
    s_waitcnt vmcnt(9)
    v_mfma_f32_32x32x16_bf16 v[16:31], a[128:131], v[80:83], v[16:31]
    v_mfma_f32_32x32x16_bf16 v[32:47], a[132:135], v[80:83], 0
    buffer_load_dwordx4 v[120:123], v5, s[40:43], s56 offen offset:2048 sc1
    s_waitcnt vmcnt(9)
    v_mfma_f32_32x32x16_bf16 v[16:31], a[136:139], v[84:87], v[16:31]
    v_mfma_f32_32x32x16_bf16 v[32:47], a[140:143], v[84:87], v[32:47]
    buffer_load_dwordx4 v[124:127], v5, s[40:43], s56 offen offset:3072 sc1
    s_waitcnt vmcnt(9)
    v_mfma_f32_32x32x16_bf16 v[16:31], a[144:147], v[88:91], v[16:31]
    v_mfma_f32_32x32x16_bf16 v[32:47], a[148:151], v[88:91], v[32:47]
    s_add_u32 s56, s71, s97
    buffer_load_dwordx4 v[128:131], v5, s[40:43], s56 offen offset:0 sc1
    s_waitcnt vmcnt(9)
    v_mfma_f32_32x32x16_bf16 v[16:31], a[152:155], v[92:95], v[16:31]
    v_mfma_f32_32x32x16_bf16 v[32:47], a[156:159], v[92:95], v[32:47]
    buffer_load_dwordx4 v[132:135], v5, s[40:43], s56 offen offset:1024 sc1
    s_waitcnt vmcnt(9)
    v_mfma_f32_32x32x16_bf16 v[16:31], a[160:163], v[96:99], v[16:31]
    v_mfma_f32_32x32x16_bf16 v[32:47], a[164:167], v[96:99], v[32:47]
    buffer_load_dwordx4 v[136:139], v5, s[40:43], s56 offen offset:2048 sc1
    s_waitcnt vmcnt(9)
    v_mfma_f32_32x32x16_bf16 v[16:31], a[168:171], v[100:103], v[16:31]
    v_mfma_f32_32x32x16_bf16 v[32:47], a[172:175], v[100:103], v[32:47]
    buffer_load_dwordx4 v[140:143], v5, s[40:43], s56 offen offset:3072 sc1
    s_waitcnt vmcnt(9)
    v_mfma_f32_32x32x16_bf16 v[16:31], a[176:179], v[104:107], v[16:31]
    v_mfma_f32_32x32x16_bf16 v[32:47], a[180:183], v[104:107], v[32:47]
    s_add_u32 s56, s71, s98
    buffer_load_dwordx4 v[144:147], v5, s[40:43], s56 offen offset:0 sc1
    s_waitcnt vmcnt(9)
    v_mfma_f32_32x32x16_bf16 v[16:31], a[184:187], v[108:111], v[16:31]
    v_mfma_f32_32x32x16_bf16 v[32:47], a[188:191], v[108:111], v[32:47]
    buffer_load_dwordx4 v[148:151], v5, s[40:43], s56 offen offset:1024 sc1
    s_waitcnt vmcnt(9)
    v_mfma_f32_32x32x16_bf16 v[16:31], a[192:195], v[112:115], v[16:31]
    v_mfma_f32_32x32x16_bf16 v[32:47], a[196:199], v[112:115], v[32:47]
    buffer_load_dwordx4 v[152:155], v5, s[40:43], s56 offen offset:2048 sc1
    s_waitcnt vmcnt(9)
    v_mfma_f32_32x32x16_bf16 v[16:31], a[200:203], v[116:119], v[16:31]
    v_mfma_f32_32x32x16_bf16 v[32:47], a[204:207], v[116:119], v[32:47]
    buffer_load_dwordx4 v[156:159], v5, s[40:43], s56 offen offset:3072 sc1
    s_waitcnt vmcnt(9)
    v_mfma_f32_32x32x16_bf16 v[16:31], a[208:211], v[120:123], v[16:31]
    v_mfma_f32_32x32x16_bf16 v[32:47], a[212:215], v[120:123], v[32:47]
    s_waitcnt lgkmcnt(15)
    s_add_u32 m0, s70, 12288
    s_mul_i32 s73, s49, 64
    s_add_u32 s73, s73, 131072
    buffer_load_dwordx4 v214, s[24:27], s73 offen lds
    s_add_u32 m0, s70, 13312
    s_mul_i32 s73, s49, 64
    s_add_u32 s73, s73, 163840
    buffer_load_dwordx4 v214, s[24:27], s73 offen lds
    s_add_u32 s56, s71, s99
    buffer_load_dwordx4 v[160:163], v5, s[40:43], s56 offen offset:0 sc1
    s_waitcnt vmcnt(11)
    v_mfma_f32_32x32x16_bf16 v[16:31], a[216:219], v[124:127], v[16:31]
    v_mfma_f32_32x32x16_bf16 v[32:47], a[220:223], v[124:127], v[32:47]
    s_add_u32 m0, s70, 14336
    s_mul_i32 s73, s49, 64
    s_add_u32 s73, s73, 196608
    buffer_load_dwordx4 v214, s[24:27], s73 offen lds
    s_add_u32 m0, s70, 15360
    s_mul_i32 s73, s49, 64
    s_add_u32 s73, s73, 229376
    buffer_load_dwordx4 v214, s[24:27], s73 offen lds
    buffer_load_dwordx4 v[164:167], v5, s[40:43], s56 offen offset:1024 sc1
    s_waitcnt vmcnt(13)
    v_mfma_f32_32x32x16_bf16 v[16:31], a[224:227], v[128:131], v[16:31]
    v_mfma_f32_32x32x16_bf16 v[32:47], a[228:231], v[128:131], v[32:47]
    s_waitcnt lgkmcnt(12)
    s_add_u32 m0, s70, 16384
    s_mul_i32 s73, s50, 64
    s_add_u32 s73, s73, 0
    buffer_load_dwordx4 v214, s[24:27], s73 offen lds
    s_add_u32 m0, s70, 17408
    s_mul_i32 s73, s50, 64
    s_add_u32 s73, s73, 32768
    buffer_load_dwordx4 v214, s[24:27], s73 offen lds
    buffer_load_dwordx4 v[168:171], v5, s[40:43], s56 offen offset:2048 sc1
    s_waitcnt vmcnt(15)
    v_mfma_f32_32x32x16_bf16 v[16:31], a[232:235], v[132:135], v[16:31]
    v_mfma_f32_32x32x16_bf16 v[32:47], a[236:239], v[132:135], v[32:47]
    s_waitcnt lgkmcnt(8)
    s_add_u32 m0, s70, 18432
    s_mul_i32 s73, s50, 64
    s_add_u32 s73, s73, 65536
    buffer_load_dwordx4 v214, s[24:27], s73 offen lds
    s_add_u32 m0, s70, 19456
    s_mul_i32 s73, s50, 64
    s_add_u32 s73, s73, 98304
    buffer_load_dwordx4 v214, s[24:27], s73 offen lds
    buffer_load_dwordx4 v[172:175], v5, s[40:43], s56 offen offset:3072 sc1
    s_waitcnt vmcnt(17)
    v_mfma_f32_32x32x16_bf16 v[16:31], a[240:243], v[136:139], v[16:31]
    v_mfma_f32_32x32x16_bf16 v[32:47], a[244:247], v[136:139], v[32:47]
    s_waitcnt lgkmcnt(4)
    s_add_u32 m0, s70, 20480
    s_mul_i32 s73, s50, 64
    s_add_u32 s73, s73, 131072
    buffer_load_dwordx4 v214, s[24:27], s73 offen lds
    s_add_u32 m0, s70, 21504
    s_mul_i32 s73, s50, 64
    s_add_u32 s73, s73, 163840
    buffer_load_dwordx4 v214, s[24:27], s73 offen lds
    s_add_u32 s56, s71, s100
    buffer_load_dwordx4 v[176:179], v5, s[40:43], s56 offen offset:0 sc1
    s_waitcnt vmcnt(19)
    v_mfma_f32_32x32x16_bf16 v[16:31], a[248:251], v[140:143], v[16:31]
    v_mfma_f32_32x32x16_bf16 v[32:47], a[252:255], v[140:143], v[32:47]
    s_waitcnt lgkmcnt(0)
    s_add_u32 m0, s70, 22528
    s_mul_i32 s73, s50, 64
    s_add_u32 s73, s73, 196608
    buffer_load_dwordx4 v214, s[24:27], s73 offen lds
    s_add_u32 m0, s70, 23552
    s_mul_i32 s73, s50, 64
    s_add_u32 s73, s73, 229376
    buffer_load_dwordx4 v214, s[24:27], s73 offen lds
    buffer_load_dwordx4 v[180:183], v5, s[40:43], s56 offen offset:1024 sc1
    s_waitcnt vmcnt(21)
    v_mfma_f32_32x32x16_bf16 v[16:31], a[0:3], v[144:147], v[16:31]
    v_mfma_f32_32x32x16_bf16 v[32:47], a[4:7], v[144:147], v[32:47]
    s_barrier
    buffer_load_dwordx4 v[184:187], v5, s[40:43], s56 offen offset:2048 sc1
    s_waitcnt vmcnt(21)
    v_mfma_f32_32x32x16_bf16 v[16:31], a[8:11], v[148:151], v[16:31]
    v_mfma_f32_32x32x16_bf16 v[32:47], a[12:15], v[148:151], v[32:47]
    buffer_load_dwordx4 v[188:191], v5, s[40:43], s56 offen offset:3072 sc1
    s_waitcnt vmcnt(21)
    v_mfma_f32_32x32x16_bf16 v[16:31], a[16:19], v[152:155], v[16:31]
    v_mfma_f32_32x32x16_bf16 v[32:47], a[20:23], v[152:155], v[32:47]
    s_add_u32 s56, s71, s101
    buffer_load_dwordx4 v[192:195], v5, s[40:43], s56 offen offset:0 sc1
    s_waitcnt vmcnt(21)
    v_mfma_f32_32x32x16_bf16 v[16:31], a[24:27], v[156:159], v[16:31]
    v_mfma_f32_32x32x16_bf16 v[32:47], a[28:31], v[156:159], v[32:47]
    buffer_load_dwordx4 v[196:199], v5, s[40:43], s56 offen offset:1024 sc1
    s_waitcnt vmcnt(19)
    v_mfma_f32_32x32x16_bf16 v[16:31], a[32:35], v[160:163], v[16:31]
    v_mfma_f32_32x32x16_bf16 v[32:47], a[36:39], v[160:163], v[32:47]
    v_lshlrev_b32 v48, 16, v220
    v_and_b32 v49, s91, v220
    v_lshlrev_b32 v50, 16, v221
    v_and_b32 v51, s91, v221
    buffer_load_dwordx4 v[200:203], v5, s[40:43], s56 offen offset:2048 sc1
    s_waitcnt vmcnt(17)
    v_mfma_f32_32x32x16_bf16 v[16:31], a[40:43], v[164:167], v[16:31]
    v_mfma_f32_32x32x16_bf16 v[32:47], a[44:47], v[164:167], v[32:47]
    v_lshlrev_b32 v52, 16, v222
    v_and_b32 v53, s91, v222
    v_lshlrev_b32_e64 v54, 16, v223
    v_and_b32 v55, s91, v223
    buffer_load_dwordx4 v[204:207], v5, s[40:43], s56 offen offset:3072 sc1
    s_waitcnt vmcnt(15)
    v_mfma_f32_32x32x16_bf16 v[16:31], a[48:51], v[168:171], v[16:31]
    v_mfma_f32_32x32x16_bf16 v[32:47], a[52:55], v[168:171], v[32:47]
    v_mov_b64 v[56:57], 0
    v_mov_b64 v[58:59], 0
    v_mov_b64 v[60:61], 0
    v_mov_b64 v[62:63], 0
    s_add_u32 s56, s72, s94
    buffer_load_dwordx4 v[80:83], v5, s[40:43], s56 offen offset:0 sc1
    s_waitcnt vmcnt(13)
    v_mfma_f32_32x32x16_bf16 v[16:31], a[56:59], v[172:175], v[16:31]
    v_mfma_f32_32x32x16_bf16 v[32:47], a[60:63], v[172:175], v[32:47]
    buffer_load_dwordx4 v[84:87], v5, s[40:43], s56 offen offset:1024 sc1
    s_waitcnt vmcnt(11)
    v_mfma_f32_32x32x16_bf16 v[16:31], a[64:67], v[176:179], v[16:31]
    v_mfma_f32_32x32x16_bf16 v[32:47], a[68:71], v[176:179], v[32:47]
    buffer_load_dwordx4 v[88:91], v5, s[40:43], s56 offen offset:2048 sc1
    s_waitcnt vmcnt(9)
    v_mfma_f32_32x32x16_bf16 v[16:31], a[72:75], v[180:183], v[16:31]
    v_mfma_f32_32x32x16_bf16 v[32:47], a[76:79], v[180:183], v[32:47]
    buffer_load_dwordx4 v[92:95], v5, s[40:43], s56 offen offset:3072 sc1
    s_waitcnt vmcnt(9)
    v_mfma_f32_32x32x16_bf16 v[16:31], a[80:83], v[184:187], v[16:31]
    v_mfma_f32_32x32x16_bf16 v[32:47], a[84:87], v[184:187], v[32:47]
    s_add_u32 s56, s72, s95
    buffer_load_dwordx4 v[96:99], v5, s[40:43], s56 offen offset:0 sc1
    s_waitcnt vmcnt(9)
    v_mfma_f32_32x32x16_bf16 v[16:31], a[88:91], v[188:191], v[16:31]
    v_mfma_f32_32x32x16_bf16 v[32:47], a[92:95], v[188:191], v[32:47]
    buffer_load_dwordx4 v[100:103], v5, s[40:43], s56 offen offset:1024 sc1
    s_waitcnt vmcnt(9)
    v_mfma_f32_32x32x16_bf16 v[16:31], a[96:99], v[192:195], v[16:31]
    v_mfma_f32_32x32x16_bf16 v[32:47], a[100:103], v[192:195], v[32:47]
    buffer_load_dwordx4 v[104:107], v5, s[40:43], s56 offen offset:2048 sc1
    s_waitcnt vmcnt(9)
    v_mfma_f32_32x32x16_bf16 v[16:31], a[104:107], v[196:199], v[16:31]
    v_mfma_f32_32x32x16_bf16 v[32:47], a[108:111], v[196:199], v[32:47]
    buffer_load_dwordx4 v[108:111], v5, s[40:43], s56 offen offset:3072 sc1
    s_waitcnt vmcnt(9)
    v_mfma_f32_32x32x16_bf16 v[16:31], a[112:115], v[200:203], v[16:31]
    v_mfma_f32_32x32x16_bf16 v[32:47], a[116:119], v[200:203], v[32:47]
    s_add_u32 s56, s72, s96
    buffer_load_dwordx4 v[112:115], v5, s[40:43], s56 offen offset:0 sc1
    s_waitcnt vmcnt(9)
    v_mfma_f32_32x32x16_bf16 v[16:31], a[120:123], v[204:207], v[16:31]
    v_mfma_f32_32x32x16_bf16 v[32:47], a[124:127], v[204:207], v[32:47]
    buffer_load_dwordx4 v[116:119], v5, s[40:43], s56 offen offset:1024 sc1
    s_waitcnt vmcnt(9)
    v_mfma_f32_32x32x16_bf16 v[48:63], a[128:131], v[80:83], v[48:63]
    v_mfma_f32_32x32x16_bf16 v[64:79], a[132:135], v[80:83], 0
    s_nop 7
    ds_write_b128 v235, v[40:43] offset:0
    ds_write_b128 v235, v[44:47] offset:1024
    ds_write_b128 v234, v[32:35] offset:0
    buffer_load_dwordx4 v[120:123], v5, s[40:43], s56 offen offset:2048 sc1
    s_waitcnt vmcnt(9)
    v_mfma_f32_32x32x16_bf16 v[48:63], a[136:139], v[84:87], v[48:63]
    v_mfma_f32_32x32x16_bf16 v[64:79], a[140:143], v[84:87], v[64:79]
    ds_write_b128 v234, v[36:39] offset:1024
    ds_write_b128 v233, v[24:27] offset:0
    ds_write_b128 v233, v[28:31] offset:1024
    buffer_load_dwordx4 v[124:127], v5, s[40:43], s56 offen offset:3072 sc1
    s_waitcnt vmcnt(9)
    v_mfma_f32_32x32x16_bf16 v[48:63], a[144:147], v[88:91], v[48:63]
    v_mfma_f32_32x32x16_bf16 v[64:79], a[148:151], v[88:91], v[64:79]
    s_waitcnt lgkmcnt(0)
    s_barrier
    ds_read_b128 v[24:27], v232 offset:0
    ds_read_b128 v[32:35], v232 offset:2048
    ds_read_b128 v[40:43], v232 offset:4096
    ds_read_b128 v[28:31], v232 offset:1024
    ds_read_b128 v[36:39], v232 offset:3072
    ds_read_b128 v[44:47], v232 offset:5120
    s_add_u32 s56, s72, s97
    buffer_load_dwordx4 v[128:131], v5, s[40:43], s56 offen offset:0 sc1
    s_waitcnt vmcnt(9)
    v_mfma_f32_32x32x16_bf16 v[48:63], a[152:155], v[92:95], v[48:63]
    v_mfma_f32_32x32x16_bf16 v[64:79], a[156:159], v[92:95], v[64:79]
    buffer_load_dwordx4 v[132:135], v5, s[40:43], s56 offen offset:1024 sc1
    s_waitcnt vmcnt(9)
    v_mfma_f32_32x32x16_bf16 v[48:63], a[160:163], v[96:99], v[48:63]
    v_mfma_f32_32x32x16_bf16 v[64:79], a[164:167], v[96:99], v[64:79]
    v_mov_b32 v211, s88
    s_waitcnt lgkmcnt(4)
    v_add_f32 v24, v24, v32
    s_waitcnt lgkmcnt(3)
    v_add_f32 v16, v16, v40
    v_add_f32 v25, v25, v33
    v_add_f32 v17, v17, v41
    v_add_f32 v26, v26, v34
    v_add_f32 v18, v18, v42
    v_add_f32 v27, v27, v35
    v_add_f32 v19, v19, v43
    s_waitcnt lgkmcnt(1)
    v_add_f32 v28, v28, v36
    s_waitcnt lgkmcnt(0)
    v_add_f32 v20, v20, v44
    v_add_f32 v29, v29, v37
    v_add_f32 v21, v21, v45
    v_add_f32 v30, v30, v38
    v_add_f32 v22, v22, v46
    v_add_f32 v31, v31, v39
    buffer_load_dwordx4 v[136:139], v5, s[40:43], s56 offen offset:2048 sc1
    s_waitcnt vmcnt(9)
    v_mfma_f32_32x32x16_bf16 v[48:63], a[168:171], v[100:103], v[48:63]
    v_mfma_f32_32x32x16_bf16 v[64:79], a[172:175], v[100:103], v[64:79]
    v_add_f32 v23, v23, v47
    v_add_f32 v16, v16, v24
    v_add_f32 v17, v17, v25
    v_add_f32 v18, v18, v26
    v_add_f32 v19, v19, v27
    v_add_f32 v20, v20, v28
    v_add_f32 v21, v21, v29
    v_add_f32 v22, v22, v30
    v_add_f32 v23, v23, v31
    v_mul_f32 v24, v16, v16
    v_mul_f32 v25, v17, v17
    v_mul_f32 v26, v18, v18
    v_mul_f32 v27, v19, v19
    v_mul_f32 v28, v20, v20
    v_mul_f32_e64 v29, v21, v21
    v_mul_f32 v30, v22, v22
    buffer_load_dwordx4 v[140:143], v5, s[40:43], s56 offen offset:3072 sc1
    s_waitcnt vmcnt(9)
    v_mfma_f32_32x32x16_bf16 v[48:63], a[176:179], v[104:107], v[48:63]
    v_mfma_f32_32x32x16_bf16 v[64:79], a[180:183], v[104:107], v[64:79]
    v_mul_f32_e64 v31, v23, v23
    v_fma_f32 v24, v24, s90, v211
    v_fma_f32 v25, v25, s90, v211
    v_fma_f32 v26, v26, s90, v211
    v_fma_f32 v27, v27, s90, v211
    v_fma_f32 v28, v28, s90, v211
    v_fma_f32 v29, v29, s90, v211
    v_fma_f32 v30, v30, s90, v211
    v_fma_f32 v31, v31, s90, v211
    v_mul_f32 v24, v24, v16
    v_mul_f32 v25, v25, v17
    v_mul_f32 v26, v26, v18
    v_mul_f32 v27, v27, v19
    v_mul_f32 v28, v28, v20
    v_mul_f32 v29, v29, v21
    v_mul_f32_e64 v30, v30, v22
    s_add_u32 s56, s72, s98
    buffer_load_dwordx4 v[144:147], v5, s[40:43], s56 offen offset:0 sc1
    s_waitcnt vmcnt(9)
    v_mfma_f32_32x32x16_bf16 v[48:63], a[184:187], v[108:111], v[48:63]
    v_mfma_f32_32x32x16_bf16 v[64:79], a[188:191], v[108:111], v[64:79]
    v_mul_f32 v31, v31, v23
    v_exp_f32 v24, v24
    v_exp_f32 v25, v25
    v_exp_f32 v26, v26
    v_exp_f32 v27, v27
    v_exp_f32 v28, v28
    v_exp_f32 v29, v29
    v_exp_f32 v30, v30
    v_exp_f32 v31, v31
    v_add_f32 v24, 1.0, v24
    v_add_f32 v25, 1.0, v25
    v_add_f32 v26, 1.0, v26
    v_add_f32 v27, 1.0, v27
    v_add_f32 v28, 1.0, v28
    v_add_f32 v29, 1.0, v29
    v_add_f32 v30, 1.0, v30
    ds_read_b64_tr_b16 a[128:129], v217 offset:24576
    ds_read_b64_tr_b16 a[130:131], v217 offset:25600
    ds_read_b64_tr_b16 a[132:133], v218 offset:24576
    ds_read_b64_tr_b16 a[134:135], v218 offset:25600
    ds_read_b64_tr_b16 a[136:137], v217 offset:26624
    ds_read_b64_tr_b16 a[138:139], v217 offset:27648
    ds_read_b64_tr_b16 a[140:141], v218 offset:26624
    ds_read_b64_tr_b16 a[142:143], v218 offset:27648
    buffer_load_dwordx4 v[148:151], v5, s[40:43], s56 offen offset:1024 sc1
    s_waitcnt vmcnt(9)
    v_mfma_f32_32x32x16_bf16 v[48:63], a[192:195], v[112:115], v[48:63]
    v_mfma_f32_32x32x16_bf16 v[64:79], a[196:199], v[112:115], v[64:79]
    v_add_f32 v31, 1.0, v31
    v_rcp_f32 v24, v24
    v_rcp_f32 v25, v25
    v_rcp_f32 v26, v26
    v_rcp_f32 v27, v27
    v_rcp_f32 v28, v28
    v_rcp_f32 v29, v29
    v_rcp_f32 v30, v30
    v_rcp_f32 v31, v31
    v_mul_f32 v24, v24, v16
    v_mul_f32 v25, v25, v17
    v_mul_f32 v26, v26, v18
    v_mul_f32 v27, v27, v19
    v_mul_f32 v28, v28, v20
    v_mul_f32 v29, v29, v21
    v_mul_f32_e64 v30, v30, v22
    ds_read_b64_tr_b16 a[144:145], v217 offset:28672
    ds_read_b64_tr_b16 a[146:147], v217 offset:29696
    ds_read_b64_tr_b16 a[148:149], v218 offset:28672
    ds_read_b64_tr_b16 a[150:151], v218 offset:29696
    ds_read_b64_tr_b16 a[152:153], v217 offset:30720
    ds_read_b64_tr_b16 a[154:155], v217 offset:31744
    ds_read_b64_tr_b16 a[156:157], v218 offset:30720
    ds_read_b64_tr_b16 a[158:159], v218 offset:31744
    buffer_load_dwordx4 v[152:155], v5, s[40:43], s56 offen offset:2048 sc1
    s_waitcnt vmcnt(9)
    v_mfma_f32_32x32x16_bf16 v[48:63], a[200:203], v[116:119], v[48:63]
    v_mfma_f32_32x32x16_bf16 v[64:79], a[204:207], v[116:119], v[64:79]
    v_mul_f32 v31, v31, v23
    v_cvt_pk_bf16_f32 v32, v24, v25
    v_cvt_pk_bf16_f32 v33, v26, v27
    v_cvt_pk_bf16_f32 v34, v28, v29
    v_cvt_pk_bf16_f32 v35, v30, v31
    buffer_store_dwordx4 v[32:35], v5, s[40:43], s57 offen sc1
    ds_read_b64_tr_b16 a[160:161], v217 offset:32768
    ds_read_b64_tr_b16 a[162:163], v217 offset:33792
    ds_read_b64_tr_b16 a[164:165], v218 offset:32768
    ds_read_b64_tr_b16 a[166:167], v218 offset:33792
    ds_read_b64_tr_b16 a[168:169], v217 offset:34816
    ds_read_b64_tr_b16 a[170:171], v217 offset:35840
    ds_read_b64_tr_b16 a[172:173], v218 offset:34816
    ds_read_b64_tr_b16 a[174:175], v218 offset:35840
    buffer_load_dwordx4 v[156:159], v5, s[40:43], s56 offen offset:3072 sc1
    s_waitcnt vmcnt(10)
    v_mfma_f32_32x32x16_bf16 v[48:63], a[208:211], v[120:123], v[48:63]
    v_mfma_f32_32x32x16_bf16 v[64:79], a[212:215], v[120:123], v[64:79]
    ds_read_b64_tr_b16 a[176:177], v217 offset:12288
    ds_read_b64_tr_b16 a[178:179], v217 offset:13312
    ds_read_b64_tr_b16 a[180:181], v218 offset:12288
    ds_read_b64_tr_b16 a[182:183], v218 offset:13312
    ds_read_b64_tr_b16 a[184:185], v217 offset:14336
    ds_read_b64_tr_b16 a[186:187], v217 offset:15360
    ds_read_b64_tr_b16 a[188:189], v218 offset:14336
    ds_read_b64_tr_b16 a[190:191], v218 offset:15360
    s_and_b32 s60, s3, 1
    s_cmp_eq_u32 s60, 0
    s_cselect_b32 s60, 1.0, 0
    v_lshlrev_b32 v16, 16, v224
    v_and_b32 v17, s91, v224
    v_lshlrev_b32 v208, 16, v240
    v_and_b32 v209, s91, v240
    v_add_f32_e64 v16, v16, v208
    s_add_u32 s56, s72, s99
    buffer_load_dwordx4 v[160:163], v5, s[40:43], s56 offen offset:0 sc1
    s_waitcnt vmcnt(10)
    v_mfma_f32_32x32x16_bf16 v[48:63], a[216:219], v[124:127], v[48:63]
    v_mfma_f32_32x32x16_bf16 v[64:79], a[220:223], v[124:127], v[64:79]
    ds_read_b64_tr_b16 a[192:193], v217 offset:16384
    ds_read_b64_tr_b16 a[194:195], v217 offset:17408
    ds_read_b64_tr_b16 a[196:197], v218 offset:16384
    ds_read_b64_tr_b16 a[198:199], v218 offset:17408
    ds_read_b64_tr_b16 a[200:201], v217 offset:18432
    ds_read_b64_tr_b16 a[202:203], v217 offset:19456
    ds_read_b64_tr_b16 a[204:205], v218 offset:18432
    ds_read_b64_tr_b16 a[206:207], v218 offset:19456
    v_add_f32 v17, v17, v209
    v_mul_f32 v16, s60, v16
    v_mul_f32 v17, s60, v17
    v_lshlrev_b32 v18, 16, v225
    v_and_b32_e64 v19, s91, v225
    v_lshlrev_b32 v210, 16, v241
    buffer_load_dwordx4 v[164:167], v5, s[40:43], s56 offen offset:1024 sc1
    s_waitcnt vmcnt(10)
    v_mfma_f32_32x32x16_bf16 v[48:63], a[224:227], v[128:131], v[48:63]
    v_mfma_f32_32x32x16_bf16 v[64:79], a[228:231], v[128:131], v[64:79]
    ds_read_b64_tr_b16 a[208:209], v217 offset:20480
    ds_read_b64_tr_b16 a[210:211], v217 offset:21504
    ds_read_b64_tr_b16 a[212:213], v218 offset:20480
    ds_read_b64_tr_b16 a[214:215], v218 offset:21504
    ds_read_b64_tr_b16 a[216:217], v217 offset:22528
    ds_read_b64_tr_b16 a[218:219], v217 offset:23552
    ds_read_b64_tr_b16 a[220:221], v218 offset:22528
    ds_read_b64_tr_b16 a[222:223], v218 offset:23552
    s_waitcnt lgkmcnt(15)
    s_add_u32 m0, s70, 24576
    s_mul_i32 s73, s51, 64
    s_add_u32 s73, s73, 0
    buffer_load_dwordx4 v214, s[24:27], s73 offen lds
    s_add_u32 m0, s70, 25600
    s_mul_i32 s73, s51, 64
    s_add_u32 s73, s73, 32768
    buffer_load_dwordx4 v214, s[24:27], s73 offen lds
    v_and_b32 v211, s91, v241
    v_add_f32 v18, v18, v210
    v_add_f32 v19, v19, v211
    v_mul_f32 v18, s60, v18
    v_mul_f32 v19, s60, v19
    v_lshlrev_b32 v20, 16, v226
    buffer_load_dwordx4 v[168:171], v5, s[40:43], s56 offen offset:2048 sc1
    s_waitcnt vmcnt(12)
    v_mfma_f32_32x32x16_bf16 v[48:63], a[232:235], v[132:135], v[48:63]
    v_mfma_f32_32x32x16_bf16 v[64:79], a[236:239], v[132:135], v[64:79]
    s_waitcnt vmcnt(6)
    v_mov_b32 v8, s4
    s_mov_b64 exec, 1
    buffer_store_dword v8, v9, s[40:43], s82 offen sc1
    s_mov_b64 exec, -1
    s_add_u32 m0, s70, 26624
    s_mul_i32 s73, s51, 64
    s_add_u32 s73, s73, 65536
    buffer_load_dwordx4 v214, s[24:27], s73 offen lds
    s_add_u32 m0, s70, 27648
    s_mul_i32 s73, s51, 64
    s_add_u32 s73, s73, 98304
    buffer_load_dwordx4 v214, s[24:27], s73 offen lds
    v_and_b32 v21, s91, v226
    v_lshlrev_b32 v208, 16, v242
    v_and_b32 v209, s91, v242
    v_add_f32 v20, v20, v208
    v_add_f32 v21, v21, v209
    v_mul_f32_e64 v20, s60, v20
    buffer_load_dwordx4 v[172:175], v5, s[40:43], s56 offen offset:3072 sc1
    v_mfma_f32_32x32x16_bf16 v[48:63], a[240:243], v[136:139], v[48:63]
    v_mfma_f32_32x32x16_bf16 v[64:79], a[244:247], v[136:139], v[64:79]
    s_add_u32 m0, s70, 28672
    s_mul_i32 s73, s51, 64
    s_add_u32 s73, s73, 131072
    buffer_load_dwordx4 v214, s[24:27], s73 offen lds
    s_add_u32 m0, s70, 29696
    s_mul_i32 s73, s51, 64
    s_add_u32 s73, s73, 163840
    buffer_load_dwordx4 v214, s[24:27], s73 offen lds
    v_mul_f32 v21, s60, v21
    v_lshlrev_b32 v22, 16, v227
    v_and_b32 v23, s91, v227
    v_lshlrev_b32 v210, 16, v243
    v_and_b32_e64 v211, s91, v243
    v_add_f32 v22, v22, v210
    s_add_u32 s56, s72, s100
    buffer_load_dwordx4 v[176:179], v5, s[40:43], s56 offen offset:0 sc1
    v_mfma_f32_32x32x16_bf16 v[48:63], a[248:251], v[140:143], v[48:63]
    v_mfma_f32_32x32x16_bf16 v[64:79], a[252:255], v[140:143], v[64:79]
    s_add_u32 m0, s70, 30720
    s_mul_i32 s73, s51, 64
    s_add_u32 s73, s73, 196608
    buffer_load_dwordx4 v214, s[24:27], s73 offen lds
    s_add_u32 m0, s70, 31744
    s_mul_i32 s73, s51, 64
    s_add_u32 s73, s73, 229376
    buffer_load_dwordx4 v214, s[24:27], s73 offen lds
    v_add_f32 v23, v23, v211
    v_mul_f32 v22, s60, v22
    v_mul_f32 v23, s60, v23
    v_lshlrev_b32 v24, 16, v228
    v_and_b32 v25, s91, v228
    v_lshlrev_b32 v208, 16, v244
    buffer_load_dwordx4 v[180:183], v5, s[40:43], s56 offen offset:1024 sc1
    v_mfma_f32_32x32x16_bf16 v[48:63], a[0:3], v[144:147], v[48:63]
    v_mfma_f32_32x32x16_bf16 v[64:79], a[4:7], v[144:147], v[64:79]
    s_add_u32 m0, s70, 32768
    s_mul_i32 s73, s52, 64
    s_add_u32 s73, s73, 0
    buffer_load_dwordx4 v214, s[24:27], s73 offen lds
    s_add_u32 m0, s70, 33792
    s_mul_i32 s73, s52, 64
    s_add_u32 s73, s73, 32768
    buffer_load_dwordx4 v214, s[24:27], s73 offen lds
    v_and_b32 v209, s91, v244
    v_add_f32 v24, v24, v208
    v_add_f32 v25, v25, v209
    v_mul_f32 v24, s60, v24
    v_mul_f32 v25, s60, v25
    v_lshlrev_b32_e64 v26, 16, v229
    buffer_load_dwordx4 v[184:187], v5, s[40:43], s56 offen offset:2048 sc1
    v_mfma_f32_32x32x16_bf16 v[48:63], a[8:11], v[148:151], v[48:63]
    v_mfma_f32_32x32x16_bf16 v[64:79], a[12:15], v[148:151], v[64:79]
    s_add_u32 m0, s70, 34816
    s_mul_i32 s73, s52, 64
    s_add_u32 s73, s73, 65536
    buffer_load_dwordx4 v214, s[24:27], s73 offen lds
    s_add_u32 m0, s70, 35840
    s_mul_i32 s73, s52, 64
    s_add_u32 s73, s73, 98304
    buffer_load_dwordx4 v214, s[24:27], s73 offen lds
    v_and_b32 v27, s91, v229
    v_lshlrev_b32 v210, 16, v245
    v_and_b32 v211, s91, v245
    v_add_f32 v26, v26, v210
    v_add_f32 v27, v27, v211
    v_mul_f32 v26, s60, v26
    buffer_load_dwordx4 v[188:191], v5, s[40:43], s56 offen offset:3072 sc1
    v_mfma_f32_32x32x16_bf16 v[48:63], a[16:19], v[152:155], v[48:63]
    v_mfma_f32_32x32x16_bf16 v[64:79], a[20:23], v[152:155], v[64:79]
    s_add_u32 m0, s70, 12288
    s_mul_i32 s73, s52, 64
    s_add_u32 s73, s73, 131072
    buffer_load_dwordx4 v214, s[24:27], s73 offen lds
    s_add_u32 m0, s70, 13312
    s_mul_i32 s73, s52, 64
    s_add_u32 s73, s73, 163840
    buffer_load_dwordx4 v214, s[24:27], s73 offen lds
    v_mul_f32 v27, s60, v27
    v_lshlrev_b32 v28, 16, v230
    v_and_b32 v29, s91, v230
    v_lshlrev_b32 v208, 16, v246
    v_and_b32 v209, s91, v246
    v_add_f32 v28, v28, v208
    buffer_load_dword v248, v12, s[40:43], s85 offen offset:0 sc1
    s_add_u32 s56, s72, s101
    buffer_load_dwordx4 v[192:195], v5, s[40:43], s56 offen offset:0 sc1
    s_waitcnt vmcnt(25)
    v_mfma_f32_32x32x16_bf16 v[48:63], a[24:27], v[156:159], v[48:63]
    v_mfma_f32_32x32x16_bf16 v[64:79], a[28:31], v[156:159], v[64:79]
    s_add_u32 m0, s70, 14336
    s_mul_i32 s73, s52, 64
    s_add_u32 s73, s73, 196608
    buffer_load_dwordx4 v214, s[24:27], s73 offen lds
    s_add_u32 m0, s70, 15360
    s_mul_i32 s73, s52, 64
    s_add_u32 s73, s73, 229376
    buffer_load_dwordx4 v214, s[24:27], s73 offen lds
    v_add_f32 v29, v29, v209
    v_mul_f32 v28, s60, v28
    v_mul_f32 v29, s60, v29
    v_lshlrev_b32 v30, 16, v231
    v_and_b32 v31, s91, v231
    v_lshlrev_b32 v210, 16, v247
    buffer_load_dwordx4 v[196:199], v5, s[40:43], s56 offen offset:1024 sc1
    s_waitcnt vmcnt(27)
    v_mfma_f32_32x32x16_bf16 v[48:63], a[32:35], v[160:163], v[48:63]
    v_mfma_f32_32x32x16_bf16 v[64:79], a[36:39], v[160:163], v[64:79]
    s_waitcnt vmcnt(24)
    ds_read_b64_tr_b16 a[224:225], v217 offset:24576
    ds_read_b64_tr_b16 a[226:227], v217 offset:25600
    ds_read_b64_tr_b16 a[228:229], v218 offset:24576
    ds_read_b64_tr_b16 a[230:231], v218 offset:25600
    v_and_b32 v211, s91, v247
    v_add_f32 v30, v30, v210
    v_add_f32 v31, v31, v211
    v_mul_f32 v30, s60, v30
    v_mul_f32 v31, s60, v31
    buffer_load_dwordx4 v[200:203], v5, s[40:43], s56 offen offset:2048 sc1
    v_mfma_f32_32x32x16_bf16 v[48:63], a[40:43], v[164:167], v[48:63]
    v_mfma_f32_32x32x16_bf16 v[64:79], a[44:47], v[164:167], v[64:79]
    s_waitcnt vmcnt(21)
    ds_read_b64_tr_b16 a[232:233], v217 offset:26624
    ds_read_b64_tr_b16 a[234:235], v217 offset:27648
    ds_read_b64_tr_b16 a[236:237], v218 offset:26624
    ds_read_b64_tr_b16 a[238:239], v218 offset:27648
    buffer_load_dwordx4 v[204:207], v5, s[40:43], s56 offen offset:3072 sc1
    v_mfma_f32_32x32x16_bf16 v[48:63], a[48:51], v[168:171], v[48:63]
    v_mfma_f32_32x32x16_bf16 v[64:79], a[52:55], v[168:171], v[64:79]
    s_waitcnt vmcnt(19)
    ds_read_b64_tr_b16 a[240:241], v217 offset:28672
    ds_read_b64_tr_b16 a[242:243], v217 offset:29696
    ds_read_b64_tr_b16 a[244:245], v218 offset:28672
    ds_read_b64_tr_b16 a[246:247], v218 offset:29696
    s_waitcnt vmcnt(6)
    v_cmp_ne_u32_e64 vcc, s4, v248
    s_nop 1
    s_cbranch_vccz Lpcd_P_11
    s_nop 1
Lpc_P_10:
    s_sub_u32 s6, s6, 1
    s_cbranch_scc1 L_end_P
    buffer_load_dword v248, v12, s[40:43], s85 offen offset:0 sc1
    s_waitcnt vmcnt(0)
    v_cmp_ne_u32 vcc, s4, v248
    s_nop 1
    s_cbranch_vccnz Lpc_P_10
Lpcd_P_11:
    s_add_u32 s56, s58, s48
    buffer_load_dwordx4 v[80:83], v4, s[40:43], s56 offen offset:0 sc1
    v_mfma_f32_32x32x16_bf16 v[48:63], a[56:59], v[172:175], v[48:63]
    v_mfma_f32_32x32x16_bf16 v[64:79], a[60:63], v[172:175], v[64:79]
    ds_read_b64_tr_b16 a[248:249], v217 offset:30720
    ds_read_b64_tr_b16 a[250:251], v217 offset:31744
    ds_read_b64_tr_b16 a[252:253], v218 offset:30720
    ds_read_b64_tr_b16 a[254:255], v218 offset:31744
    buffer_load_dwordx4 v[84:87], v4, s[40:43], s56 offen offset:1024 sc1
    v_mfma_f32_32x32x16_bf16 v[48:63], a[64:67], v[176:179], v[48:63]
    v_mfma_f32_32x32x16_bf16 v[64:79], a[68:71], v[176:179], v[64:79]
    ds_read_b64_tr_b16 a[0:1], v217 offset:32768
    ds_read_b64_tr_b16 a[2:3], v217 offset:33792
    ds_read_b64_tr_b16 a[4:5], v218 offset:32768
    ds_read_b64_tr_b16 a[6:7], v218 offset:33792
    buffer_load_dwordx4 v[88:91], v4, s[40:43], s56 offen offset:2048 sc1
    v_mfma_f32_32x32x16_bf16 v[48:63], a[72:75], v[180:183], v[48:63]
    v_mfma_f32_32x32x16_bf16 v[64:79], a[76:79], v[180:183], v[64:79]
    ds_read_b64_tr_b16 a[8:9], v217 offset:34816
    ds_read_b64_tr_b16 a[10:11], v217 offset:35840
    ds_read_b64_tr_b16 a[12:13], v218 offset:34816
    ds_read_b64_tr_b16 a[14:15], v218 offset:35840
    buffer_load_dwordx4 v[92:95], v4, s[40:43], s56 offen offset:3072 sc1
    v_mfma_f32_32x32x16_bf16 v[48:63], a[80:83], v[184:187], v[48:63]
    v_mfma_f32_32x32x16_bf16 v[64:79], a[84:87], v[184:187], v[64:79]
    ds_read_b64_tr_b16 a[16:17], v217 offset:12288
    ds_read_b64_tr_b16 a[18:19], v217 offset:13312
    ds_read_b64_tr_b16 a[20:21], v218 offset:12288
    ds_read_b64_tr_b16 a[22:23], v218 offset:13312
    s_add_u32 s56, s58, s49
    buffer_load_dwordx4 v[96:99], v4, s[40:43], s56 offen offset:0 sc1
    v_mfma_f32_32x32x16_bf16 v[48:63], a[88:91], v[188:191], v[48:63]
    v_mfma_f32_32x32x16_bf16 v[64:79], a[92:95], v[188:191], v[64:79]
    s_waitcnt vmcnt(8)
    ds_read_b64_tr_b16 a[24:25], v217 offset:14336
    ds_read_b64_tr_b16 a[26:27], v217 offset:15360
    ds_read_b64_tr_b16 a[28:29], v218 offset:14336
    ds_read_b64_tr_b16 a[30:31], v218 offset:15360
    buffer_load_dwordx4 v[100:103], v4, s[40:43], s56 offen offset:1024 sc1
    buffer_load_dwordx4 v[104:107], v4, s[40:43], s56 offen offset:2048 sc1
    buffer_load_dwordx4 v[108:111], v4, s[40:43], s56 offen offset:3072 sc1
    s_add_u32 s56, s58, s50
    buffer_load_dwordx4 v[112:115], v4, s[40:43], s56 offen offset:0 sc1
    v_mfma_f32_32x32x16_bf16 v[64:79], a[100:103], v[192:195], v[64:79]
    s_waitcnt vmcnt(11)
    v_mfma_f32_32x32x16_bf16 v[64:79], a[108:111], v[196:199], v[64:79]
    s_waitcnt vmcnt(10)
    v_mfma_f32_32x32x16_bf16 v[64:79], a[116:119], v[200:203], v[64:79]
    s_waitcnt vmcnt(9)
    v_mfma_f32_32x32x16_bf16 v[64:79], a[124:127], v[204:207], v[64:79]
    v_mfma_f32_32x32x16_bf16 v[48:63], a[96:99], v[192:195], v[48:63]
    v_mfma_f32_32x32x16_bf16 v[48:63], a[104:107], v[196:199], v[48:63]
    s_nop 9
    ds_write_b128 v235, v[72:75] offset:6144
    ds_write_b128 v235, v[76:79] offset:7168
    v_mfma_f32_32x32x16_bf16 v[48:63], a[112:115], v[200:203], v[48:63]
    ds_write_b128 v234, v[64:67] offset:6144
    ds_write_b128 v234, v[68:71] offset:7168
    v_mfma_f32_32x32x16_bf16 v[48:63], a[120:123], v[204:207], v[48:63]
    s_nop 11
    ds_write_b128 v233, v[56:59] offset:6144
    ds_write_b128 v233, v[60:63] offset:7168
    s_waitcnt lgkmcnt(0)
    s_barrier
    ds_read_b128 v[56:59], v232 offset:6144
    ds_read_b128 v[64:67], v232 offset:8192
    ds_read_b128 v[72:75], v232 offset:10240
    ds_read_b128 v[60:63], v232 offset:7168
    ds_read_b128 v[68:71], v232 offset:9216
    ds_read_b128 v[76:79], v232 offset:11264
    v_mov_b32_e64 v211, s88
    s_waitcnt lgkmcnt(4)
    v_pk_add_f32 v[56:57], v[56:57], v[64:65]
    s_waitcnt lgkmcnt(3)
    v_pk_add_f32 v[48:49], v[48:49], v[72:73]
    v_pk_add_f32 v[58:59], v[58:59], v[66:67]
    v_pk_add_f32 v[50:51], v[50:51], v[74:75]
    s_waitcnt lgkmcnt(1)
    v_pk_add_f32 v[60:61], v[60:61], v[68:69]
    s_waitcnt lgkmcnt(0)
    v_pk_add_f32 v[52:53], v[52:53], v[76:77]
    v_pk_add_f32 v[62:63], v[62:63], v[70:71]
    v_pk_add_f32 v[54:55], v[54:55], v[78:79]
    v_pk_add_f32 v[48:49], v[48:49], v[56:57]
    v_pk_add_f32 v[50:51], v[50:51], v[58:59]
    v_pk_add_f32 v[52:53], v[52:53], v[60:61]
    v_pk_add_f32 v[54:55], v[54:55], v[62:63]
    v_pk_mul_f32 v[56:57], v[48:49], v[48:49]
    v_pk_mul_f32 v[58:59], v[50:51], v[50:51]
    v_pk_mul_f32 v[60:61], v[52:53], v[52:53]
    v_pk_mul_f32 v[62:63], v[54:55], v[54:55]
    v_fma_f32 v56, v56, s90, v211
    v_fma_f32 v57, v57, s90, v211
    v_fma_f32 v58, v58, s90, v211
    v_fma_f32 v59, v59, s90, v211
    v_fma_f32 v60, v60, s90, v211
    v_fma_f32 v61, v61, s90, v211
    v_fma_f32 v62, v62, s90, v211
    v_fma_f32 v63, v63, s90, v211
    v_pk_mul_f32 v[56:57], v[56:57], v[48:49]
    v_pk_mul_f32 v[58:59], v[58:59], v[50:51]
    v_pk_mul_f32 v[60:61], v[60:61], v[52:53]
    v_pk_mul_f32 v[62:63], v[62:63], v[54:55]
    v_exp_f32 v56, v56
    v_exp_f32 v57, v57
    v_exp_f32 v58, v58
    v_exp_f32 v59, v59
    v_exp_f32 v60, v60
    v_exp_f32 v61, v61
    v_exp_f32 v62, v62
    v_exp_f32 v63, v63
    v_add_f32 v56, 1.0, v56
    v_add_f32 v57, 1.0, v57
    v_add_f32 v58, 1.0, v58
    v_add_f32 v59, 1.0, v59
    v_add_f32 v60, 1.0, v60
    v_add_f32 v61, 1.0, v61
    v_add_f32 v62, 1.0, v62
    v_add_f32 v63, 1.0, v63
    v_rcp_f32 v56, v56
    v_rcp_f32 v57, v57
    v_rcp_f32 v58, v58
    v_rcp_f32 v59, v59
    v_rcp_f32 v60, v60
    v_rcp_f32 v61, v61
    v_rcp_f32 v62, v62
    v_rcp_f32 v63, v63
    v_mul_f32 v56, v56, v48
    v_mul_f32 v57, v57, v49
    v_mul_f32 v58, v58, v50
    v_mul_f32 v59, v59, v51
    v_mul_f32 v60, v60, v52
    v_mul_f32 v61, v61, v53
    v_mul_f32 v62, v62, v54
    v_mul_f32 v63, v63, v55
    v_cvt_pk_bf16_f32 v64, v56, v57
    v_cvt_pk_bf16_f32 v65, v58, v59
    v_cvt_pk_bf16_f32 v66, v60, v61
    v_cvt_pk_bf16_f32 v67, v62, v63
    s_add_u32 s57, s57, 114688
    buffer_store_dwordx4 v[64:67], v5, s[40:43], s57 offen sc1
    s_add_u32 s82, s82, 4096
    s_add_u32 s85, s85, 4096
    buffer_load_dwordx4 v[116:119], v4, s[40:43], s56 offen offset:1024 sc1
    s_waitcnt vmcnt(10)
    v_mfma_f32_32x32x16_bf16 v[16:31], a[128:131], v[80:83], v[16:31]
    v_mfma_f32_32x32x16_bf16 v[32:47], a[132:135], v[80:83], 0
    s_add_u32 m0, s70, 16384
    s_mul_i32 s73, s53, 64
    s_add_u32 s73, s73, 0
    buffer_load_dwordx4 v214, s[24:27], s73 offen lds
    s_add_u32 m0, s70, 17408
    s_mul_i32 s73, s53, 64
    s_add_u32 s73, s73, 32768
    buffer_load_dwordx4 v214, s[24:27], s73 offen lds
    buffer_load_dwordx4 v[120:123], v4, s[40:43], s56 offen offset:2048 sc1
    s_waitcnt vmcnt(12)
    v_mfma_f32_32x32x16_bf16 v[16:31], a[136:139], v[84:87], v[16:31]
    v_mfma_f32_32x32x16_bf16 v[32:47], a[140:143], v[84:87], v[32:47]
    s_add_u32 m0, s70, 18432
    s_mul_i32 s73, s53, 64
    s_add_u32 s73, s73, 65536
    buffer_load_dwordx4 v214, s[24:27], s73 offen lds
    s_add_u32 m0, s70, 19456
    s_mul_i32 s73, s53, 64
    s_add_u32 s73, s73, 98304
    buffer_load_dwordx4 v214, s[24:27], s73 offen lds
    buffer_load_dwordx4 v[124:127], v4, s[40:43], s56 offen offset:3072 sc1
    s_waitcnt vmcnt(14)
    v_mfma_f32_32x32x16_bf16 v[16:31], a[144:147], v[88:91], v[16:31]
    v_mfma_f32_32x32x16_bf16 v[32:47], a[148:151], v[88:91], v[32:47]
    s_add_u32 m0, s70, 20480
    s_mul_i32 s73, s53, 64
    s_add_u32 s73, s73, 131072
    buffer_load_dwordx4 v214, s[24:27], s73 offen lds
    s_add_u32 m0, s70, 21504
    s_mul_i32 s73, s53, 64
    s_add_u32 s73, s73, 163840
    buffer_load_dwordx4 v214, s[24:27], s73 offen lds
    s_add_u32 s56, s58, s51
    buffer_load_dwordx4 v[128:131], v4, s[40:43], s56 offen offset:0 sc1
    s_waitcnt vmcnt(16)
    v_mfma_f32_32x32x16_bf16 v[16:31], a[152:155], v[92:95], v[16:31]
    v_mfma_f32_32x32x16_bf16 v[32:47], a[156:159], v[92:95], v[32:47]
    s_add_u32 m0, s70, 22528
    s_mul_i32 s73, s53, 64
    s_add_u32 s73, s73, 196608
    buffer_load_dwordx4 v214, s[24:27], s73 offen lds
    s_add_u32 m0, s70, 23552
    s_mul_i32 s73, s53, 64
    s_add_u32 s73, s73, 229376
    buffer_load_dwordx4 v214, s[24:27], s73 offen lds
    buffer_load_dwordx4 v[132:135], v4, s[40:43], s56 offen offset:1024 sc1
    s_waitcnt vmcnt(18)
    v_mfma_f32_32x32x16_bf16 v[16:31], a[160:163], v[96:99], v[16:31]
    v_mfma_f32_32x32x16_bf16 v[32:47], a[164:167], v[96:99], v[32:47]
    s_add_u32 m0, s70, 24576
    s_mul_i32 s73, s54, 64
    s_add_u32 s73, s73, 0
    buffer_load_dwordx4 v214, s[24:27], s73 offen lds
    s_add_u32 m0, s70, 25600
    s_mul_i32 s73, s54, 64
    s_add_u32 s73, s73, 32768
    buffer_load_dwordx4 v214, s[24:27], s73 offen lds
    s_waitcnt vmcnt(15)
    v_mov_b32 v8, s4
    s_mov_b64 exec, 1
    buffer_store_dword v8, v9, s[40:43], s82 offen sc1
    s_mov_b64 exec, -1
    buffer_load_dwordx4 v[136:139], v4, s[40:43], s56 offen offset:2048 sc1
    v_mfma_f32_32x32x16_bf16 v[16:31], a[168:171], v[100:103], v[16:31]
    v_mfma_f32_32x32x16_bf16 v[32:47], a[172:175], v[100:103], v[32:47]
    s_add_u32 m0, s70, 26624
    s_mul_i32 s73, s54, 64
    s_add_u32 s73, s73, 65536
    buffer_load_dwordx4 v214, s[24:27], s73 offen lds
    s_add_u32 m0, s70, 27648
    s_mul_i32 s73, s54, 64
    s_add_u32 s73, s73, 98304
    buffer_load_dwordx4 v214, s[24:27], s73 offen lds
    buffer_load_dwordx4 v[140:143], v4, s[40:43], s56 offen offset:3072 sc1
    v_mfma_f32_32x32x16_bf16 v[16:31], a[176:179], v[104:107], v[16:31]
    v_mfma_f32_32x32x16_bf16 v[32:47], a[180:183], v[104:107], v[32:47]
    s_add_u32 m0, s70, 28672
    s_mul_i32 s73, s54, 64
    s_add_u32 s73, s73, 131072
    buffer_load_dwordx4 v214, s[24:27], s73 offen lds
    s_add_u32 m0, s70, 29696
    s_mul_i32 s73, s54, 64
    s_add_u32 s73, s73, 163840
    buffer_load_dwordx4 v214, s[24:27], s73 offen lds
    s_and_b32 s60, s3, 1
    s_cmp_eq_u32 s60, 1
    s_cselect_b32 s60, 1.0, 0
    v_lshlrev_b32 v48, 16, v224
    v_and_b32 v49, s91, v224
    v_lshlrev_b32 v208, 16, v240
    v_and_b32_e64 v209, s91, v240
    v_add_f32 v48, v48, v208
    s_add_u32 s56, s58, s52
    buffer_load_dwordx4 v[144:147], v4, s[40:43], s56 offen offset:0 sc1
    v_mfma_f32_32x32x16_bf16 v[16:31], a[184:187], v[108:111], v[16:31]
    v_mfma_f32_32x32x16_bf16 v[32:47], a[188:191], v[108:111], v[32:47]
    s_add_u32 m0, s70, 30720
    s_mul_i32 s73, s54, 64
    s_add_u32 s73, s73, 196608
    buffer_load_dwordx4 v214, s[24:27], s73 offen lds
    s_add_u32 m0, s70, 31744
    s_mul_i32 s73, s54, 64
    s_add_u32 s73, s73, 229376
    buffer_load_dwordx4 v214, s[24:27], s73 offen lds
    v_add_f32 v49, v49, v209
    v_mul_f32 v48, s60, v48
    v_mul_f32 v49, s60, v49
    v_lshlrev_b32 v50, 16, v225
    v_and_b32_e64 v51, s91, v225
    v_lshlrev_b32 v210, 16, v241
    buffer_load_dwordx4 v[148:151], v4, s[40:43], s56 offen offset:1024 sc1
    v_mfma_f32_32x32x16_bf16 v[16:31], a[192:195], v[112:115], v[16:31]
    v_mfma_f32_32x32x16_bf16 v[32:47], a[196:199], v[112:115], v[32:47]
    s_waitcnt vmcnt(23)
    ds_read_b64_tr_b16 a[32:33], v217 offset:16384
    ds_read_b64_tr_b16 a[34:35], v217 offset:17408
    ds_read_b64_tr_b16 a[36:37], v218 offset:16384
    ds_read_b64_tr_b16 a[38:39], v218 offset:17408
    v_and_b32 v211, s91, v241
    v_add_f32 v50, v50, v210
    v_add_f32 v51, v51, v211
    v_mul_f32 v50, s60, v50
    v_mul_f32_e64 v51, s60, v51
    v_lshlrev_b32 v52, 16, v226
    buffer_load_dwordx4 v[152:155], v4, s[40:43], s56 offen offset:2048 sc1
    v_mfma_f32_32x32x16_bf16 v[16:31], a[200:203], v[116:119], v[16:31]
    v_mfma_f32_32x32x16_bf16 v[32:47], a[204:207], v[116:119], v[32:47]
    s_waitcnt vmcnt(21)
    ds_read_b64_tr_b16 a[40:41], v217 offset:18432
    ds_read_b64_tr_b16 a[42:43], v217 offset:19456
    ds_read_b64_tr_b16 a[44:45], v218 offset:18432
    ds_read_b64_tr_b16 a[46:47], v218 offset:19456
    v_and_b32 v53, s91, v226
    v_lshlrev_b32 v208, 16, v242
    v_and_b32 v209, s91, v242
    v_add_f32 v52, v52, v208
    v_add_f32_e64 v53, v53, v209
    v_mul_f32 v52, s60, v52
    buffer_load_dwordx4 v[156:159], v4, s[40:43], s56 offen offset:3072 sc1
    v_mfma_f32_32x32x16_bf16 v[16:31], a[208:211], v[120:123], v[16:31]
    v_mfma_f32_32x32x16_bf16 v[32:47], a[212:215], v[120:123], v[32:47]
    s_waitcnt vmcnt(19)
    ds_read_b64_tr_b16 a[48:49], v217 offset:20480
    ds_read_b64_tr_b16 a[50:51], v217 offset:21504
    ds_read_b64_tr_b16 a[52:53], v218 offset:20480
    ds_read_b64_tr_b16 a[54:55], v218 offset:21504
    v_mul_f32 v53, s60, v53
    v_lshlrev_b32 v54, 16, v227
    v_and_b32 v55, s91, v227
    v_lshlrev_b32 v210, 16, v243
    v_and_b32 v211, s91, v243
    v_add_f32 v54, v54, v210
    s_add_u32 s56, s58, s53
    buffer_load_dwordx4 v[160:163], v4, s[40:43], s56 offen offset:0 sc1
    v_mfma_f32_32x32x16_bf16 v[16:31], a[216:219], v[124:127], v[16:31]
    v_mfma_f32_32x32x16_bf16 v[32:47], a[220:223], v[124:127], v[32:47]
    s_waitcnt vmcnt(17)
    ds_read_b64_tr_b16 a[56:57], v217 offset:22528
    ds_read_b64_tr_b16 a[58:59], v217 offset:23552
    ds_read_b64_tr_b16 a[60:61], v218 offset:22528
    ds_read_b64_tr_b16 a[62:63], v218 offset:23552
    v_add_f32 v55, v55, v211
    v_mul_f32 v54, s60, v54
    v_mul_f32 v55, s60, v55
    v_lshlrev_b32 v56, 16, v228
    v_and_b32_e64 v57, s91, v228
    v_lshlrev_b32 v208, 16, v244
    buffer_load_dwordx4 v[164:167], v4, s[40:43], s56 offen offset:1024 sc1
    v_mfma_f32_32x32x16_bf16 v[16:31], a[224:227], v[128:131], v[16:31]
    v_mfma_f32_32x32x16_bf16 v[32:47], a[228:231], v[128:131], v[32:47]
    s_waitcnt vmcnt(15)
    ds_read_b64_tr_b16 a[64:65], v217 offset:24576
    ds_read_b64_tr_b16 a[66:67], v217 offset:25600
    ds_read_b64_tr_b16 a[68:69], v218 offset:24576
    ds_read_b64_tr_b16 a[70:71], v218 offset:25600
    v_and_b32 v209, s91, v244
    v_add_f32 v56, v56, v208
    v_add_f32 v57, v57, v209
    v_mul_f32 v56, s60, v56
    v_mul_f32 v57, s60, v57
    v_lshlrev_b32 v58, 16, v229
    buffer_load_dword v248, v12, s[40:43], s85 offen offset:0 sc1
    buffer_load_dwordx4 v[168:171], v4, s[40:43], s56 offen offset:2048 sc1
    v_mfma_f32_32x32x16_bf16 v[16:31], a[232:235], v[132:135], v[16:31]
    v_mfma_f32_32x32x16_bf16 v[32:47], a[236:239], v[132:135], v[32:47]
    s_waitcnt vmcnt(13)
    ds_read_b64_tr_b16 a[72:73], v217 offset:26624
    ds_read_b64_tr_b16 a[74:75], v217 offset:27648
    ds_read_b64_tr_b16 a[76:77], v218 offset:26624
    ds_read_b64_tr_b16 a[78:79], v218 offset:27648
    v_and_b32 v59, s91, v229
    v_lshlrev_b32 v210, 16, v245
    v_and_b32 v211, s91, v245
    v_add_f32 v58, v58, v210
    v_add_f32 v59, v59, v211
    v_mul_f32 v58, s60, v58
    buffer_load_dwordx4 v[172:175], v4, s[40:43], s56 offen offset:3072 sc1
    v_mfma_f32_32x32x16_bf16 v[16:31], a[240:243], v[136:139], v[16:31]
    v_mfma_f32_32x32x16_bf16 v[32:47], a[244:247], v[136:139], v[32:47]
    s_waitcnt vmcnt(11)
    ds_read_b64_tr_b16 a[80:81], v217 offset:28672
    ds_read_b64_tr_b16 a[82:83], v217 offset:29696
    ds_read_b64_tr_b16 a[84:85], v218 offset:28672
    ds_read_b64_tr_b16 a[86:87], v218 offset:29696
    v_mul_f32 v59, s60, v59
    v_lshlrev_b32 v60, 16, v230
    v_and_b32 v61, s91, v230
    v_lshlrev_b32 v208, 16, v246
    v_and_b32 v209, s91, v246
    v_add_f32 v60, v60, v208
    s_add_u32 s56, s58, s54
    buffer_load_dwordx4 v[176:179], v4, s[40:43], s56 offen offset:0 sc1
    v_mfma_f32_32x32x16_bf16 v[16:31], a[248:251], v[140:143], v[16:31]
    v_mfma_f32_32x32x16_bf16 v[32:47], a[252:255], v[140:143], v[32:47]
    s_waitcnt vmcnt(9)
    ds_read_b64_tr_b16 a[88:89], v217 offset:30720
    ds_read_b64_tr_b16 a[90:91], v217 offset:31744
    ds_read_b64_tr_b16 a[92:93], v218 offset:30720
    ds_read_b64_tr_b16 a[94:95], v218 offset:31744
    v_add_f32 v61, v61, v209
    v_mul_f32 v60, s60, v60
    v_mul_f32 v61, s60, v61
    v_lshlrev_b32 v62, 16, v231
    v_and_b32 v63, s91, v231
    v_lshlrev_b32 v210, 16, v247
    buffer_load_dwordx4 v[180:183], v4, s[40:43], s56 offen offset:1024 sc1
    v_mfma_f32_32x32x16_bf16 v[16:31], a[0:3], v[144:147], v[16:31]
    v_mfma_f32_32x32x16_bf16 v[32:47], a[4:7], v[144:147], v[32:47]
    v_and_b32 v211, s91, v247
    v_add_f32 v62, v62, v210
    v_add_f32 v63, v63, v211
    v_mul_f32 v62, s60, v62
    v_mul_f32 v63, s60, v63
    s_waitcnt vmcnt(4)
    v_cmp_ne_u32 vcc, s4, v248
    s_nop 1
    s_cbranch_vccz Lpcd_P_13
    s_nop 1
Lpc_P_12:
    s_sub_u32 s6, s6, 1
    s_cbranch_scc1 L_end_P
    buffer_load_dword v248, v12, s[40:43], s85 offen offset:0 sc1
    s_waitcnt vmcnt(0)
    v_cmp_ne_u32 vcc, s4, v248
    s_nop 1
    s_cbranch_vccnz Lpc_P_12
Lpcd_P_13:
    buffer_load_dwordx4 v[184:187], v4, s[40:43], s56 offen offset:2048 sc1
    v_mfma_f32_32x32x16_bf16 v[16:31], a[8:11], v[148:151], v[16:31]
    v_mfma_f32_32x32x16_bf16 v[32:47], a[12:15], v[148:151], v[32:47]
    buffer_load_dwordx4 v[188:191], v4, s[40:43], s56 offen offset:3072 sc1
    v_mfma_f32_32x32x16_bf16 v[16:31], a[16:19], v[152:155], v[16:31]
    v_mfma_f32_32x32x16_bf16 v[32:47], a[20:23], v[152:155], v[32:47]
    s_add_u32 s56, s59, s48
    buffer_load_dwordx4 v[192:195], v4, s[40:43], s56 offen offset:0 sc1
    v_mfma_f32_32x32x16_bf16 v[16:31], a[24:27], v[156:159], v[16:31]
    v_mfma_f32_32x32x16_bf16 v[32:47], a[28:31], v[156:159], v[32:47]
    buffer_load_dwordx4 v[196:199], v4, s[40:43], s56 offen offset:1024 sc1
    s_waitcnt lgkmcnt(15)
    v_mfma_f32_32x32x16_bf16 v[16:31], a[32:35], v[160:163], v[16:31]
    v_mfma_f32_32x32x16_bf16 v[32:47], a[36:39], v[160:163], v[32:47]
    buffer_load_dwordx4 v[200:203], v4, s[40:43], s56 offen offset:2048 sc1
    v_mfma_f32_32x32x16_bf16 v[16:31], a[40:43], v[164:167], v[16:31]
    v_mfma_f32_32x32x16_bf16 v[32:47], a[44:47], v[164:167], v[32:47]
    buffer_load_dwordx4 v[204:207], v4, s[40:43], s56 offen offset:3072 sc1
    s_waitcnt vmcnt(9)
    v_mfma_f32_32x32x16_bf16 v[16:31], a[48:51], v[168:171], v[16:31]
    v_mfma_f32_32x32x16_bf16 v[32:47], a[52:55], v[168:171], v[32:47]
    s_add_u32 s56, s59, s49
    buffer_load_dwordx4 v[80:83], v4, s[40:43], s56 offen offset:0 sc1
    s_waitcnt vmcnt(9)
    v_mfma_f32_32x32x16_bf16 v[16:31], a[56:59], v[172:175], v[16:31]
    v_mfma_f32_32x32x16_bf16 v[32:47], a[60:63], v[172:175], v[32:47]
    buffer_load_dwordx4 v[84:87], v4, s[40:43], s56 offen offset:1024 sc1
    s_waitcnt vmcnt(9) lgkmcnt(14)
    v_mfma_f32_32x32x16_bf16 v[16:31], a[64:67], v[176:179], v[16:31]
    s_waitcnt lgkmcnt(12)
    v_mfma_f32_32x32x16_bf16 v[32:47], a[68:71], v[176:179], v[32:47]
    buffer_load_dwordx4 v[88:91], v4, s[40:43], s56 offen offset:2048 sc1
    s_waitcnt vmcnt(9) lgkmcnt(10)
    v_mfma_f32_32x32x16_bf16 v[16:31], a[72:75], v[180:183], v[16:31]
    s_waitcnt lgkmcnt(8)
    v_mfma_f32_32x32x16_bf16 v[32:47], a[76:79], v[180:183], v[32:47]
    buffer_load_dwordx4 v[92:95], v4, s[40:43], s56 offen offset:3072 sc1
    s_waitcnt vmcnt(9) lgkmcnt(6)
    v_mfma_f32_32x32x16_bf16 v[16:31], a[80:83], v[184:187], v[16:31]
    s_waitcnt lgkmcnt(4)
    v_mfma_f32_32x32x16_bf16 v[32:47], a[84:87], v[184:187], v[32:47]
    s_add_u32 s56, s59, s50
    buffer_load_dwordx4 v[96:99], v4, s[40:43], s56 offen offset:0 sc1
    s_waitcnt vmcnt(9) lgkmcnt(2)
    v_mfma_f32_32x32x16_bf16 v[16:31], a[88:91], v[188:191], v[16:31]
    s_waitcnt lgkmcnt(0)
    v_mfma_f32_32x32x16_bf16 v[32:47], a[92:95], v[188:191], v[32:47]
    buffer_load_dwordx4 v[100:103], v4, s[40:43], s56 offen offset:1024 sc1
    s_waitcnt vmcnt(9)
    v_mfma_f32_32x32x16_bf16 v[48:63], a[128:131], v[192:195], v[48:63]
    v_mfma_f32_32x32x16_bf16 v[64:79], a[132:135], v[192:195], 0
    s_nop 7
    ds_write_b32 v237, v32 offset:0
    ds_write_b32 v237, v34 offset:256
    ds_write_b32 v237, v33 offset:128
    ds_write_b32 v237, v35 offset:384
    ds_write_b32 v237, v36 offset:1024
    ds_write_b32 v237, v38 offset:1280
    buffer_load_dwordx4 v[104:107], v4, s[40:43], s56 offen offset:2048 sc1
    s_waitcnt vmcnt(9)
    v_mfma_f32_32x32x16_bf16 v[48:63], a[136:139], v[196:199], v[48:63]
    v_mfma_f32_32x32x16_bf16 v[64:79], a[140:143], v[196:199], v[64:79]
    ds_write_b32 v237, v37 offset:1152
    ds_write_b32 v237, v39 offset:1408
    ds_write_b32 v237, v40 offset:2048
    ds_write_b32 v237, v42 offset:2304
    ds_write_b32 v237, v41 offset:2176
    ds_write_b32 v237, v43 offset:2432
    buffer_load_dwordx4 v[108:111], v4, s[40:43], s56 offen offset:3072 sc1
    s_waitcnt vmcnt(9)
    v_mfma_f32_32x32x16_bf16 v[48:63], a[144:147], v[200:203], v[48:63]
    v_mfma_f32_32x32x16_bf16 v[64:79], a[148:151], v[200:203], v[64:79]
    ds_write_b32 v237, v44 offset:3072
    ds_write_b32 v237, v46 offset:3328
    ds_write_b32 v237, v45 offset:3200
    ds_write_b32 v237, v47 offset:3456
    ds_write_b32 v236, v16 offset:0
    ds_write_b32 v236, v18 offset:256
    s_add_u32 s56, s59, s51
    buffer_load_dwordx4 v[112:115], v4, s[40:43], s56 offen offset:0 sc1
    s_waitcnt vmcnt(9)
    v_mfma_f32_32x32x16_bf16 v[48:63], a[152:155], v[204:207], v[48:63]
    v_mfma_f32_32x32x16_bf16 v[64:79], a[156:159], v[204:207], v[64:79]
    ds_write_b32 v236, v17 offset:128
    ds_write_b32 v236, v19 offset:384
    ds_write_b32 v236, v20 offset:1024
    ds_write_b32 v236, v22 offset:1280
    ds_write_b32 v236, v21 offset:1152
    ds_write_b32 v236, v23 offset:1408
    buffer_load_dwordx4 v[116:119], v4, s[40:43], s56 offen offset:1024 sc1
    s_waitcnt vmcnt(9)
    v_mfma_f32_32x32x16_bf16 v[48:63], a[160:163], v[80:83], v[48:63]
    v_mfma_f32_32x32x16_bf16 v[64:79], a[164:167], v[80:83], v[64:79]
    ds_write_b32 v236, v24 offset:2048
    ds_write_b32 v236, v26 offset:2304
    ds_write_b32 v236, v25 offset:2176
    ds_write_b32 v236, v27 offset:2432
    ds_write_b32 v236, v28 offset:3072
    ds_write_b32 v236, v30 offset:3328
    buffer_load_dwordx4 v[120:123], v4, s[40:43], s56 offen offset:2048 sc1
    s_waitcnt vmcnt(9)
    v_mfma_f32_32x32x16_bf16 v[48:63], a[168:171], v[84:87], v[48:63]
    v_mfma_f32_32x32x16_bf16 v[64:79], a[172:175], v[84:87], v[64:79]
    ds_write_b32 v236, v29 offset:3200
    ds_write_b32 v236, v31 offset:3456
    buffer_load_dwordx4 v[124:127], v4, s[40:43], s56 offen offset:3072 sc1
    s_waitcnt vmcnt(9)
    v_mfma_f32_32x32x16_bf16 v[48:63], a[176:179], v[88:91], v[48:63]
    v_mfma_f32_32x32x16_bf16 v[64:79], a[180:183], v[88:91], v[64:79]
    s_add_u32 s56, s59, s52
    buffer_load_dwordx4 v[128:131], v4, s[40:43], s56 offen offset:0 sc1
    s_waitcnt vmcnt(9)
    v_mfma_f32_32x32x16_bf16 v[48:63], a[184:187], v[92:95], v[48:63]
    v_mfma_f32_32x32x16_bf16 v[64:79], a[188:191], v[92:95], v[64:79]
    s_waitcnt lgkmcnt(0)
    s_barrier
    ds_read_b128 v[16:19], v238 offset:0
    ds_read_b128 v[20:23], v238 offset:36864
    ds_read_b128 v[24:27], v239 offset:0
    ds_read_b128 v[28:31], v239 offset:36864
    ds_read_b128 v[32:35], v238 offset:1024
    ds_read_b128 v[36:39], v238 offset:37888
    ds_read_b128 v[40:43], v239 offset:1024
    ds_read_b128 v[44:47], v239 offset:37888
    buffer_load_dwordx4 v[132:135], v4, s[40:43], s56 offen offset:1024 sc1
    s_waitcnt vmcnt(9)
    v_mfma_f32_32x32x16_bf16 v[48:63], a[192:195], v[96:99], v[48:63]
    v_mfma_f32_32x32x16_bf16 v[64:79], a[196:199], v[96:99], v[64:79]
    buffer_load_dwordx4 v[136:139], v4, s[40:43], s56 offen offset:2048 sc1
    s_waitcnt vmcnt(9)
    v_mfma_f32_32x32x16_bf16 v[48:63], a[200:203], v[100:103], v[48:63]
    v_mfma_f32_32x32x16_bf16 v[64:79], a[204:207], v[100:103], v[64:79]
    s_waitcnt lgkmcnt(6)
    v_add_f32 v16, v16, v20
    s_waitcnt lgkmcnt(4)
    v_add_f32 v24, v24, v28
    v_add_f32 v17, v17, v21
    v_add_f32 v25, v25, v29
    v_add_f32 v18, v18, v22
    v_add_f32 v26, v26, v30
    buffer_load_dwordx4 v[140:143], v4, s[40:43], s56 offen offset:3072 sc1
    s_waitcnt vmcnt(9)
    v_mfma_f32_32x32x16_bf16 v[48:63], a[208:211], v[104:107], v[48:63]
    v_mfma_f32_32x32x16_bf16 v[64:79], a[212:215], v[104:107], v[64:79]
    v_add_f32 v19, v19, v23
    v_add_f32 v27, v27, v31
    v_add_f32 v16, v16, v24
    v_add_f32 v17, v17, v25
    v_add_f32 v18, v18, v26
    v_add_f32 v19, v19, v27
    s_add_u32 s56, s59, s53
    buffer_load_dwordx4 v[144:147], v4, s[40:43], s56 offen offset:0 sc1
    s_waitcnt vmcnt(9)
    v_mfma_f32_32x32x16_bf16 v[48:63], a[216:219], v[108:111], v[48:63]
    v_mfma_f32_32x32x16_bf16 v[64:79], a[220:223], v[108:111], v[64:79]
    v_cvt_pk_bf16_f32 v20, v16, v17
    v_cvt_pk_bf16_f32 v21, v18, v19
    buffer_store_dwordx2 v[20:21], v212, s[36:39], s68 offen offset:0
    s_waitcnt lgkmcnt(2)
    v_add_f32 v32, v32, v36
    s_waitcnt lgkmcnt(0)
    v_add_f32 v40, v40, v44
    v_add_f32 v33, v33, v37
    buffer_load_dwordx4 v[148:151], v4, s[40:43], s56 offen offset:1024 sc1
    s_waitcnt vmcnt(10)
    v_mfma_f32_32x32x16_bf16 v[48:63], a[224:227], v[112:115], v[48:63]
    v_mfma_f32_32x32x16_bf16 v[64:79], a[228:231], v[112:115], v[64:79]
    v_add_f32 v41, v41, v45
    v_add_f32 v34, v34, v38
    v_add_f32 v42, v42, v46
    v_add_f32 v35, v35, v39
    v_add_f32_e64 v43, v43, v47
    v_add_f32 v32, v32, v40
    buffer_load_dwordx4 v[152:155], v4, s[40:43], s56 offen offset:2048 sc1
    s_waitcnt vmcnt(10)
    v_mfma_f32_32x32x16_bf16 v[48:63], a[232:235], v[116:119], v[48:63]
    v_mfma_f32_32x32x16_bf16 v[64:79], a[236:239], v[116:119], v[64:79]
    v_add_f32 v33, v33, v41
    v_add_f32 v34, v34, v42
    v_add_f32 v35, v35, v43
    v_cvt_pk_bf16_f32 v36, v32, v33
    v_cvt_pk_bf16_f32 v37, v34, v35
    buffer_store_dwordx2 v[36:37], v212, s[36:39], s69 offen offset:0
    buffer_load_dwordx4 v[156:159], v4, s[40:43], s56 offen offset:3072 sc1
    s_waitcnt vmcnt(11)
    v_mfma_f32_32x32x16_bf16 v[48:63], a[240:243], v[120:123], v[48:63]
    v_mfma_f32_32x32x16_bf16 v[64:79], a[244:247], v[120:123], v[64:79]
    s_add_u32 s56, s59, s54
    buffer_load_dwordx4 v[160:163], v4, s[40:43], s56 offen offset:0 sc1
    s_waitcnt vmcnt(11)
    v_mfma_f32_32x32x16_bf16 v[48:63], a[248:251], v[124:127], v[48:63]
    v_mfma_f32_32x32x16_bf16 v[64:79], a[252:255], v[124:127], v[64:79]
    buffer_load_dwordx4 v[164:167], v4, s[40:43], s56 offen offset:1024 sc1
    s_waitcnt vmcnt(11)
    v_mfma_f32_32x32x16_bf16 v[48:63], a[0:3], v[128:131], v[48:63]
    v_mfma_f32_32x32x16_bf16 v[64:79], a[4:7], v[128:131], v[64:79]
    buffer_load_dwordx4 v[168:171], v4, s[40:43], s56 offen offset:2048 sc1
    s_waitcnt vmcnt(11)
    v_mfma_f32_32x32x16_bf16 v[48:63], a[8:11], v[132:135], v[48:63]
    v_mfma_f32_32x32x16_bf16 v[64:79], a[12:15], v[132:135], v[64:79]
    buffer_load_dwordx4 v[172:175], v4, s[40:43], s56 offen offset:3072 sc1
    s_waitcnt vmcnt(11)
    v_mfma_f32_32x32x16_bf16 v[48:63], a[16:19], v[136:139], v[48:63]
    v_mfma_f32_32x32x16_bf16 v[64:79], a[20:23], v[136:139], v[64:79]
    s_waitcnt vmcnt(10)
    v_mfma_f32_32x32x16_bf16 v[48:63], a[24:27], v[140:143], v[48:63]
    v_mfma_f32_32x32x16_bf16 v[64:79], a[28:31], v[140:143], v[64:79]
    s_waitcnt vmcnt(9)
    v_mfma_f32_32x32x16_bf16 v[48:63], a[32:35], v[144:147], v[48:63]
    v_mfma_f32_32x32x16_bf16 v[64:79], a[36:39], v[144:147], v[64:79]
    s_waitcnt vmcnt(7)
    v_mfma_f32_32x32x16_bf16 v[48:63], a[40:43], v[148:151], v[48:63]
    v_mfma_f32_32x32x16_bf16 v[64:79], a[44:47], v[148:151], v[64:79]
    s_waitcnt vmcnt(6)
    v_mfma_f32_32x32x16_bf16 v[48:63], a[48:51], v[152:155], v[48:63]
    v_mfma_f32_32x32x16_bf16 v[64:79], a[52:55], v[152:155], v[64:79]
    s_waitcnt vmcnt(4)
    v_mfma_f32_32x32x16_bf16 v[48:63], a[56:59], v[156:159], v[48:63]
    v_mfma_f32_32x32x16_bf16 v[64:79], a[60:63], v[156:159], v[64:79]
    s_waitcnt vmcnt(3)
    v_mfma_f32_32x32x16_bf16 v[64:79], a[68:71], v[160:163], v[64:79]
    s_waitcnt vmcnt(2)
    v_mfma_f32_32x32x16_bf16 v[64:79], a[76:79], v[164:167], v[64:79]
    s_waitcnt vmcnt(1)
    v_mfma_f32_32x32x16_bf16 v[64:79], a[84:87], v[168:171], v[64:79]
    s_waitcnt vmcnt(0)
    v_mfma_f32_32x32x16_bf16 v[64:79], a[92:95], v[172:175], v[64:79]
    v_mfma_f32_32x32x16_bf16 v[48:63], a[64:67], v[160:163], v[48:63]
    v_mfma_f32_32x32x16_bf16 v[48:63], a[72:75], v[164:167], v[48:63]
    s_nop 9
    ds_write_b32 v237, v64 offset:8192
    ds_write_b32 v237, v66 offset:8448
    ds_write_b32 v237, v65 offset:8320
    ds_write_b32 v237, v67 offset:8576
    ds_write_b32 v237, v68 offset:9216
    ds_write_b32 v237, v70 offset:9472
    v_mfma_f32_32x32x16_bf16 v[48:63], a[80:83], v[168:171], v[48:63]
    ds_write_b32 v237, v69 offset:9344
    ds_write_b32 v237, v71 offset:9600
    ds_write_b32 v237, v72 offset:10240
    ds_write_b32 v237, v74 offset:10496
    ds_write_b32 v237, v73 offset:10368
    ds_write_b32 v237, v75 offset:10624
    v_mfma_f32_32x32x16_bf16 v[48:63], a[88:91], v[172:175], v[48:63]
    ds_write_b32 v237, v76 offset:11264
    ds_write_b32 v237, v78 offset:11520
    ds_write_b32 v237, v77 offset:11392
    ds_write_b32 v237, v79 offset:11648
    s_nop 7
    ds_write_b32 v236, v48 offset:8192
    ds_write_b32 v236, v50 offset:8448
    ds_write_b32 v236, v49 offset:8320
    ds_write_b32 v236, v51 offset:8576
    ds_write_b32 v236, v52 offset:9216
    ds_write_b32 v236, v54 offset:9472
    ds_write_b32 v236, v53 offset:9344
    ds_write_b32 v236, v55 offset:9600
    ds_write_b32 v236, v56 offset:10240
    ds_write_b32 v236, v58 offset:10496
    ds_write_b32 v236, v57 offset:10368
    ds_write_b32 v236, v59 offset:10624
    ds_write_b32 v236, v60 offset:11264
    ds_write_b32 v236, v62 offset:11520
    ds_write_b32 v236, v61 offset:11392
    ds_write_b32 v236, v63 offset:11648
    s_waitcnt lgkmcnt(0)
    s_barrier
    ds_read_b128 v[48:51], v238 offset:8192
    ds_read_b128 v[52:55], v238 offset:45056
    ds_read_b128 v[56:59], v239 offset:8192
    ds_read_b128 v[60:63], v239 offset:45056
    ds_read_b128 v[64:67], v238 offset:9216
    ds_read_b128 v[68:71], v238 offset:46080
    ds_read_b128 v[72:75], v239 offset:9216
    ds_read_b128 v[76:79], v239 offset:46080
    s_waitcnt lgkmcnt(6)
    v_pk_add_f32 v[48:49], v[48:49], v[52:53]
    s_waitcnt lgkmcnt(4)
    v_pk_add_f32 v[56:57], v[56:57], v[60:61]
    v_pk_add_f32 v[50:51], v[50:51], v[54:55]
    v_pk_add_f32 v[58:59], v[58:59], v[62:63]
    v_pk_add_f32 v[48:49], v[48:49], v[56:57]
    v_pk_add_f32 v[50:51], v[50:51], v[58:59]
    v_cvt_pk_bf16_f32 v52, v48, v49
    v_cvt_pk_bf16_f32 v53, v50, v51
    buffer_store_dwordx2 v[52:53], v212, s[36:39], s68 offen offset:64
    s_waitcnt lgkmcnt(2)
    v_pk_add_f32 v[64:65], v[64:65], v[68:69]
    s_waitcnt lgkmcnt(0)
    v_pk_add_f32 v[72:73], v[72:73], v[76:77]
    v_pk_add_f32 v[66:67], v[66:67], v[70:71]
    v_pk_add_f32 v[74:75], v[74:75], v[78:79]
    v_pk_add_f32 v[64:65], v[64:65], v[72:73]
    v_pk_add_f32 v[66:67], v[66:67], v[74:75]
    v_cvt_pk_bf16_f32 v68, v64, v65
    v_cvt_pk_bf16_f32 v69, v66, v67
    buffer_store_dwordx2 v[68:69], v212, s[36:39], s69 offen offset:64
L_end_P:
    s_endpgm

.section .rodata,"a"
.p2align 6
.amdhsa_kernel sequential_preLN__sliding_local_dilated__mixer_token_mlp__prompt_kernel
  .amdhsa_next_free_vgpr 508
  .amdhsa_next_free_sgpr 102
  .amdhsa_accum_offset 252
  .amdhsa_group_segment_fixed_size 0
  .amdhsa_kernarg_size 88
  .amdhsa_user_sgpr_count 2
  .amdhsa_user_sgpr_kernarg_segment_ptr 1
  .amdhsa_system_sgpr_workgroup_id_x 1
.end_amdhsa_kernel
```

```asm
; @launch grid=(256,1,1) block=(256,1,1) lds=163840
.amdgcn_target "amdgcn-amd-amdhsa--gfx950"
.text
.globl sequential_preLN__sliding_local_dilated__mixer_token_mlp__prompt_kernel
.p2align 8
.type sequential_preLN__sliding_local_dilated__mixer_token_mlp__prompt_kernel,@function
sequential_preLN__sliding_local_dilated__mixer_token_mlp__prompt_kernel:
    s_cmp_ge_u32 s2, 256
    s_cbranch_scc1 L_end_P
    s_load_dwordx2 s[8:9], s[0:1], 0
    s_load_dwordx2 s[12:13], s[0:1], 8
    s_load_dwordx2 s[44:45], s[0:1], 72
    s_load_dwordx2 s[40:41], s[0:1], 80
    s_load_dwordx2 s[16:17], s[0:1], 16
    s_load_dwordx2 s[20:21], s[0:1], 32
    s_load_dwordx2 s[24:25], s[0:1], 48
    s_load_dwordx2 s[28:29], s[0:1], 40
    s_load_dwordx2 s[32:33], s[0:1], 56
    s_load_dwordx2 s[36:37], s[0:1], 64
    v_lshrrev_b32 v1, 6, v0
    s_nop 0
    v_readfirstlane_b32 s3, v1
    v_and_b32 v1, 63, v0
    v_and_b32 v2, 15, v0
    v_lshrrev_b32 v3, 4, v1
    v_lshlrev_b32 v4, 4, v1
    s_mov_b32 s10, 0x1c0000
    s_mov_b32 s11, 0x00020000
    s_mov_b32 s14, 0x126000
    s_mov_b32 s15, 0x00020000
    s_mov_b32 s46, 0x100
    s_mov_b32 s47, 0x00020000
    s_mov_b32 s42, 0x610000
    s_mov_b32 s43, 0x00020000
    s_mov_b32 s18, 0x62000
    s_mov_b32 s19, 0x00020000
    s_mov_b32 s22, 0x700000
    s_mov_b32 s23, 0x00020000
    s_mov_b32 s26, 0x700000
    s_mov_b32 s27, 0x00020000
    s_mov_b32 s30, 0xe00
    s_mov_b32 s31, 0x00020000
    s_mov_b32 s34, 0x1000
    s_mov_b32 s35, 0x00020000
    s_mov_b32 s38, 0x1c0000
    s_mov_b32 s39, 0x00020000
    s_mov_b32 s5, 0x3f803f80
    s_mov_b32 s6, 0x200000
    s_bfe_u32 s48, s2, 0x20001
    s_lshl_b32 s48, s48, 2
    s_lshr_b32 s53, s2, 6
    s_add_u32 s48, s48, s53
    s_bfe_u32 s49, s2, 0x30003
    s_and_b32 s53, s2, 1
    s_lshl_b32 s53, s53, 3
    s_add_u32 s49, s49, s53
    v_lshrrev_b32_e64 v237, 2, v1
    v_mul_u32_u24 v123, 2688, v237
    v_lshrrev_b32 v237, 5, v1
    v_lshlrev_b32 v237, 1, v237
    v_and_b32 v238, 3, v1
    v_xor_b32 v237, v237, v238
    v_lshl_add_u32 v123, v237, 4, v123
    s_mul_i32 s53, s49, 56
    s_min_u32 s53, s53, 832
    s_mul_i32 s51, s3, 43008
    s_add_u32 s53, s53, s51
    v_add_u32 v123, s53, v123
    s_lshr_b32 s53, s3, 1
    s_mul_i32 s51, s53, 6144
    s_and_b32 s53, s3, 1
    s_lshl_b32 s53, s53, 10
    s_add_u32 s51, s51, s53
    v_lshrrev_b32 v237, 3, v1
    v_mul_u32_u24 v122, 896, v237
    v_and_b32 v237, 7, v1
    v_xor_b32 v237, v237, v3
    v_lshl_add_u32 v120, v237, 4, v122
    s_lshl_b32 s50, s48, 7
    s_lshl_b32 s53, s3, 5
    s_add_u32 s53, s53, s50
    s_mul_i32 s53, s53, 896
    v_xor_b32 v121, 64, v120
    v_add_u32_e64 v120, s53, v120
    s_add_u32 s53, s53, 7168
    v_add_u32 v121, s53, v121
    s_lshl_b32 s53, s3, 1
    v_xor_b32 v237, s53, v237
    v_lshl_add_u32 v122, v237, 4, v122
    s_lshl_b32 s53, s3, 2
    s_add_u32 s53, s53, s50
    s_sub_u32 s53, s53, 16
    s_mul_i32 s53, s53, 896
    s_cmp_eq_u32 s48, 0
    s_cselect_b32 s53, 0x40000000, s53
    v_add_u32 v122, s53, v122
    s_lshl_b32 s52, s3, 12
    s_add_u32 s52, s52, 63488
    s_lshl_b32 s7, s3, 9
    s_cmp_eq_u32 s3, 0
    s_cselect_b32 s54, 0xffffff00, -1
    s_mov_b32 s55, 0
    s_memrealtime s[86:87]
    v_mov_b32 v7, 0
    s_waitcnt lgkmcnt(0)
    s_or_b32 s86, s86, 1
    v_mov_b32 v6, s86
    s_or_b32 s86, s2, s3
    s_cmp_eq_u32 s86, 0
    s_cselect_b64 exec, 1, 0
    buffer_store_dword v6, v7, s[44:47], 0 offen sc1
    s_mov_b64 exec, -1
    s_add_u32 m0, s51, 12288
    s_mov_b32 s73, 0
    buffer_load_dwordx4 v123, s[12:15], s73 offen lds
    s_add_u32 m0, s51, 14336
    s_mov_b32 s73, 896
    buffer_load_dwordx4 v123, s[12:15], s73 offen lds
    s_add_u32 m0, s51, 16384
    s_mov_b32 s73, 1792
    buffer_load_dwordx4 v123, s[12:15], s73 offen lds
    s_add_u32 m0, s52, 36864
    s_mov_b32 s73, 0
    buffer_load_dwordx4 v120, s[8:11], s73 offen lds
    s_add_u32 m0, s52, 37888
    s_mov_b32 s73, 0
    buffer_load_dwordx4 v121, s[8:11], s73 offen lds
    s_add_u32 m0, s52, 38912
    s_mov_b32 s73, 14336
    buffer_load_dwordx4 v120, s[8:11], s73 offen lds
    s_add_u32 m0, s52, 39936
    s_mov_b32 s73, 14336
    buffer_load_dwordx4 v121, s[8:11], s73 offen lds
    s_add_u32 m0, s7, 98304
    s_mov_b32 s73, 0
    s_mov_b64 exec, s[54:55]
    buffer_load_dwordx4 v122, s[8:11], s73 offen lds
    s_mov_b64 exec, -1
    s_bfe_u32 s53, s2, 0x30003
    s_add_u32 s86, s53, 1
    s_lshr_b32 s86, s86, 1
    s_lshr_b32 s87, s2, 6
    s_mul_i32 s87, s87, 5
    s_add_u32 s86, s86, s87
    s_lshl_b32 s86, s86, 2
    s_add_u32 s53, s86, s3
    s_mov_b32 s56, s53
    s_mov_b32 s86, 0x2a54
    s_bitcmp1_b32 s86, s49
    s_cselect_b32 s57, 0x40000000, 0
    s_mul_i32 s86, s53, 58
    v_add_u32_e64 v237, s86, v1
    v_mul_u32_u24 v238, 43691, v237
    v_lshrrev_b32 v238, 19, v238
    v_mul_u32_u24 v239, 12, v238
    v_sub_u32 v239, v237, v239
    v_lshrrev_b32 v239, 2, v239
    v_mul_u32_u24 v239, 896, v239
    v_mul_u32_u24 v238, 2688, v238
    v_and_b32 v237, 3, v237
    v_lshlrev_b32 v237, 7, v237
    v_add3_u32 v237, v237, v238, v239
    v_add_u32 v237, s57, v237
    s_and_b32 s87, s2, 1
    s_mul_i32 s87, s87, 384
    s_add_u32 s87, s87, 172032
    s_mov_b32 exec_lo, 0xffffffff
    s_mov_b32 exec_hi, 0x3ffffff
    buffer_load_dword v232, v237, s[12:15], s87 offen
    s_mov_b64 exec, -1
    v_lshlrev_b32 v237, 7, v1
    v_add_u32 v238, s57, v237
    s_mul_i32 s86, s53, 6016
    s_bfe_u32 s87, s2, 0x20001
    s_mul_i32 s87, s87, 458752
    s_add_u32 s86, s86, s87
    s_max_u32 s86, s86, 14336
    s_sub_u32 s86, s86, 14336
    s_mov_b32 exec_hi, 0x7fff
    buffer_load_dword v233, v238, s[8:11], s86 offen
    s_getpc_b64 s[86:87]
Lpc_P:
    s_mul_i32 s53, s53, 384
    v_add_u32_e64 v237, s53, v237
    v_min_u32 v237, L_end_P-Lpc_P, v237
    s_mov_b64 exec, 7
    global_load_dword v236, v237, s[86:87]
    s_mov_b64 exec, -1
    v_mul_u32_u24 v237, 18432, v3
    v_lshl_add_u32 v237, v2, 3, v237
    v_mov_b32_e64 v238, s5
    v_add_u32 v237, 61440, v237
    ds_write2_b32 v237, v238, v238 offset0:0 offset1:1
    s_lshr_b32 s68, s2, 3
    s_mul_i32 s69, s68, 37
    s_lshr_b32 s69, s69, 8
    s_mul_i32 s64, s69, 7
    s_sub_u32 s64, s68, s64
    s_mov_b32 s66, s64
    s_and_b32 s68, s2, 7
    s_lshl_b32 s67, s68, 2
    s_add_u32 s67, s67, s69
    s_cmp_ge_u32 s69, 4
    s_cselect_b32 s67, 99, s67
    s_mul_i32 s71, s68, 3
    s_add_u32 s71, s71, 4
    s_lshl_b32 s72, s68, 2
    s_cmp_lt_u32 s68, 4
    s_cselect_b32 s65, s72, s71
    s_cselect_b32 s71, 4, 3
    s_add_u32 s65, s65, s69
    s_cmp_ge_u32 s69, s71
    s_cselect_b32 s65, 99, s65
    v_lshrrev_b32_e64 v219, 3, v1
    v_mul_u32_u24 v208, 896, v219
    v_and_b32 v219, 1, v3
    v_lshlrev_b32 v219, 2, v219
    v_and_b32 v220, 7, v1
    v_xor_b32 v219, v219, v220
    v_lshl_add_u32 v208, v219, 4, v208
    s_lshl_b32 s58, s66, 7
    s_mul_i32 s60, s3, 100352
    s_add_u32 s58, s58, s60
    v_add_u32_e64 v208, s58, v208
    s_mul_i32 s59, s3, 36864
    s_add_u32 s59, s59, 12288
    v_lshrrev_b32 v219, 5, v1
    v_lshlrev_b32 v209, 9, v219
    v_bfe_u32 v219, v1, 2, 2
    v_lshl_add_u32 v209, v219, 7, v209
    v_lshrrev_b32 v219, 1, v219
    s_and_b32 s58, s3, 1
    v_xor_b32_e64 v219, s58, v219
    v_lshl_add_u32 v209, v219, 6, v209
    v_and_b32_e64 v219, 1, v3
    v_lshl_add_u32 v209, v219, 5, v209
    v_and_b32_e64 v219, 3, v1
    v_lshl_add_u32 v209, v219, 3, v209
    v_add_u32 v209, 12288, v209
    v_lshrrev_b32 v219, 5, v1
    v_lshlrev_b32 v219, 10, v219
    v_sub_u32_e64 v210, v209, v219
    s_mul_i32 s70, s3, 36864
    s_add_u32 s70, s70, 12288
    v_lshrrev_b32_e64 v219, 3, v1
    v_mul_u32_u24 v213, 3584, v219
    v_and_b32 v219, 1, v3
    v_lshlrev_b32 v219, 2, v219
    v_and_b32 v220, 7, v1
    v_xor_b32 v219, v219, v220
    v_lshl_add_u32 v213, v219, 4, v213
    s_mul_i32 s68, s3, 1835008
    s_lshl_b32 s69, s65, 7
    s_add_u32 s68, s68, s69
    s_cmp_ge_u32 s65, 99
    s_cselect_b32 s68, 0x40000000, s68
    v_add_u32 v213, s68, v213
    s_cselect_b32 s68, 0x40000000, 0
    v_add_u32 v5, s68, v4
    v_lshrrev_b32 v219, 5, v1
    v_lshlrev_b32 v215, 9, v219
    v_bfe_u32 v219, v1, 2, 2
    v_lshl_add_u32 v215, v219, 7, v215
    v_lshrrev_b32 v219, 1, v219
    s_lshr_b32 s68, s3, 1
    v_xor_b32_e64 v219, s68, v219
    v_lshl_add_u32 v215, v219, 6, v215
    v_and_b32_e64 v219, 1, v3
    v_lshl_add_u32 v215, v219, 5, v215
    v_and_b32_e64 v219, 3, v1
    v_lshl_add_u32 v215, v219, 3, v215
    s_and_b32 s68, s3, 1
    s_lshl_b32 s68, s68, 5
    v_xor_b32 v215, s68, v215
    v_add_u32 v215, s70, v215
    v_xor_b32_e64 v216, 64, v215
    s_mul_i32 s70, s3, 36864
    s_add_u32 s70, s70, 12288
    v_lshrrev_b32_e64 v219, 3, v1
    v_mul_u32_u24 v214, 4096, v219
    v_and_b32 v219, 1, v3
    v_lshlrev_b32 v219, 2, v219
    v_and_b32 v220, 7, v1
    v_xor_b32 v219, v219, v220
    v_lshl_add_u32 v214, v219, 4, v214
    s_mul_i32 s68, s3, 1835008
    s_lshl_b32 s69, s67, 7
    s_add_u32 s68, s68, s69
    s_cmp_ge_u32 s67, 99
    s_cselect_b32 s68, 0x40000000, s68
    v_add_u32 v214, s68, v214
    v_lshrrev_b32 v219, 5, v1
    v_lshlrev_b32 v217, 9, v219
    v_bfe_u32 v219, v1, 2, 2
    v_lshl_add_u32 v217, v219, 7, v217
    v_lshrrev_b32 v219, 1, v219
    s_lshr_b32 s68, s3, 1
    v_xor_b32_e64 v219, s68, v219
    v_lshl_add_u32 v217, v219, 6, v217
    v_and_b32_e64 v219, 1, v3
    v_lshl_add_u32 v217, v219, 5, v217
    v_and_b32_e64 v219, 3, v1
    v_lshl_add_u32 v217, v219, 3, v217
    v_add_u32_e64 v217, s70, v217
    v_xor_b32 v218, 64, v217
    s_and_b32 s68, s2, 7
    s_cmp_ge_u32 s68, 8
    s_cselect_b32 s94, 8, 0
    s_sub_u32 s68, s68, s94
    s_lshl_b32 s94, s68, 12
    s_add_u32 s68, s68, 1
    s_cmp_ge_u32 s68, 8
    s_cselect_b32 s95, 8, 0
    s_sub_u32 s68, s68, s95
    s_lshl_b32 s95, s68, 12
    s_add_u32 s68, s68, 1
    s_cmp_ge_u32 s68, 8
    s_cselect_b32 s96, 8, 0
    s_sub_u32 s68, s68, s96
    s_lshl_b32 s96, s68, 12
    s_add_u32 s68, s68, 1
    s_cmp_ge_u32 s68, 8
    s_cselect_b32 s97, 8, 0
    s_sub_u32 s68, s68, s97
    s_lshl_b32 s97, s68, 12
    s_add_u32 s68, s68, 1
    s_cmp_ge_u32 s68, 8
    s_cselect_b32 s98, 8, 0
    s_sub_u32 s68, s68, s98
    s_lshl_b32 s98, s68, 12
    s_add_u32 s68, s68, 1
    s_cmp_ge_u32 s68, 8
    s_cselect_b32 s99, 8, 0
    s_sub_u32 s68, s68, s99
    s_lshl_b32 s99, s68, 12
    s_add_u32 s68, s68, 1
    s_cmp_ge_u32 s68, 8
    s_cselect_b32 s100, 8, 0
    s_sub_u32 s68, s68, s100
    s_lshl_b32 s100, s68, 12
    s_add_u32 s68, s68, 1
    s_cmp_ge_u32 s68, 8
    s_cselect_b32 s101, 8, 0
    s_sub_u32 s68, s68, s101
    s_lshl_b32 s101, s68, 12
    s_lshl_b32 s80, s48, 2
    s_add_u32 s80, s80, s3
    s_lshl_b32 s80, s80, 11
    s_lshr_b32 s93, s49, 2
    s_lshl_b32 s93, s93, 7
    s_add_u32 s80, s80, s93
    s_and_b32 s93, s49, 3
    s_lshl_b32 s93, s93, 2
    s_add_u32 s80, s80, s93
    s_add_u32 s80, s80, 0x5c8000
    s_lshl_b32 s83, s67, 1
    s_lshr_b32 s93, s3, 1
    s_add_u32 s83, s83, s93
    s_lshl_b32 s83, s83, 11
    s_add_u32 s83, s83, 0x5c8000
    v_lshrrev_b32 v10, 2, v2
    v_lshlrev_b32 v10, 7, v10
    v_and_b32_e64 v219, 3, v2
    v_lshl_add_u32 v10, v219, 2, v10
    s_lshl_b32 s84, s64, 12
    s_lshl_b32 s85, s84, 1
    s_add_u32 s85, s85, 0x5f0000
    s_add_u32 s84, s84, 0x5e8000
    s_lshl_b32 s81, s67, 5
    s_add_u32 s81, s81, s3
    s_lshl_b32 s81, s81, 2
    s_add_u32 s81, s81, s84
    s_lshl_b32 s93, s3, 10
    s_add_u32 s84, s84, s93
    v_bfe_u32 v11, v1, 2, 3
    v_min_u32 v12, 6, v11
    v_and_b32 v219, 3, v1
    v_lshlrev_b32_e64 v219, 2, v219
    v_lshl_add_u32 v11, v11, 7, v219
    v_lshl_add_u32 v12, v12, 7, v219
    s_lshl_b32 s82, s65, 5
    s_add_u32 s82, s82, s3
    s_lshl_b32 s82, s82, 2
    s_add_u32 s82, s82, s85
    s_mul_i32 s93, s3, 896
    s_add_u32 s85, s85, s93
    v_mov_b32 v9, 0
    v_lshlrev_b32_e64 v124, 9, v3
    v_bfe_u32 v237, v1, 2, 2
    v_lshl_add_u32 v124, v237, 6, v124
    v_and_b32_e64 v237, 3, v1
    v_lshl_add_u32 v124, v237, 3, v124
    v_and_b32 v237, 1, v3
    v_lshlrev_b32 v237, 5, v237
    v_add_u32_e64 v124, v124, v237
    v_add_u32 v124, 12288, v124
    v_xor_b32 v125, 32, v124
    s_and_b32 s53, s3, 1
    s_lshl_b32 s53, s53, 5
    v_xor_b32 v127, s53, v124
    s_lshr_b32 s53, s3, 1
    s_lshl_b32 s53, s53, 11
    s_add_u32 s53, s53, 2048
    v_add_u32 v126, s53, v127
    v_lshrrev_b32 v237, 1, v2
    v_xor_b32 v237, v237, v3
    v_lshlrev_b32 v237, 4, v237
    v_lshl_add_u32 v237, v2, 7, v237
    v_add_u32 v130, 61440, v237
    v_xor_b32 v131, 64, v130
    v_add_u32 v128, s52, v237
    v_xor_b32 v129, 64, v128
    v_lshlrev_b32 v237, 2, v3
    v_sub_u32_e64 v237, v2, v237
    v_mov_b32 v239, 0xf149f2ca
    v_add_u32 v238, 16, v237
    v_and_b32 v238, 0xfffffff1, v238
    v_cmp_eq_u32 vcc, 0, v238
    s_nop 1
    v_cndmask_b32 v240, v239, 0, vcc
    v_add_u32 v238, 15, v237
    v_and_b32 v238, 0xfffffff1, v238
    v_cmp_eq_u32 vcc, 0, v238
    s_nop 1
    v_cndmask_b32 v241, v239, 0, vcc
    v_add_u32 v238, 14, v237
    v_and_b32 v238, 0xfffffff1, v238
    v_cmp_eq_u32 vcc, 0, v238
    s_nop 1
    v_cndmask_b32 v242, v239, 0, vcc
    v_add_u32 v238, 13, v237
    v_and_b32 v238, 0xfffffff1, v238
    v_cmp_eq_u32 vcc, 0, v238
    s_nop 1
    v_cndmask_b32 v243, v239, 0, vcc
    v_add_u32 v238, 0, v237
    v_and_b32 v238, 0xfffffff1, v238
    v_cmp_eq_u32 vcc, 0, v238
    s_nop 1
    v_cndmask_b32 v244, v239, 0, vcc
    v_add_u32 v238, -1, v237
    v_and_b32 v238, 0xfffffff1, v238
    v_cmp_eq_u32 vcc, 0, v238
    s_nop 1
    v_cndmask_b32 v245, v239, 0, vcc
    v_add_u32 v238, -2, v237
    v_and_b32 v238, 0xfffffff1, v238
    v_cmp_eq_u32 vcc, 0, v238
    s_nop 1
    v_cndmask_b32 v246, v239, 0, vcc
    v_add_u32 v238, -3, v237
    v_and_b32 v238, 0xfffffff1, v238
    v_cmp_eq_u32 vcc, 0, v238
    s_nop 1
    v_cndmask_b32 v247, v239, 0, vcc
    s_or_b32 s53, s48, s3
    s_cmp_eq_u32 s53, 0
    s_cselect_b64 vcc, -1, 0
    v_cndmask_b32 v248, v240, v239, vcc
    v_cndmask_b32 v249, v241, v239, vcc
    v_cndmask_b32 v250, v242, v239, vcc
    v_cndmask_b32 v251, v243, v239, vcc
    v_mov_b32 v40, s5
    v_mov_b32 v41, s5
    v_mov_b32 v42, s5
    v_mov_b32_e64 v43, s5
    s_mov_b32 s88, 0x22222222
    s_mov_b32 s89, 0x22222222
    s_mov_b32 s90, 0x44444444
    s_mov_b32 s91, 0x44444444
    s_mov_b32 s92, 0x88888888
    s_mov_b32 s93, 0x88888888
    v_lshlrev_b32 v72, 4, v3
    s_lshl_b32 s53, s3, 6
    v_add_u32 v73, s53, v72
    s_and_b32 s53, s53, 64
    v_add_u32_e64 v74, s53, v72
    s_mul_i32 s53, s3, 384
    v_lshl_add_u32 v75, v2, 2, s53
    v_add_u32 v76, s53, v72
    s_and_b32 s53, s3, 1
    s_lshl_b32 s53, s53, 3
    v_add_u32 v80, s53, v4
    v_lshrrev_b32 v81, 2, v2
    v_lshlrev_b32 v81, 8, v81
    v_lshl_add_u32 v81, v3, 6, v81
    v_and_b32_e64 v82, 3, v2
    v_lshl_add_u32 v81, v82, 1, v81
    v_add_u32_e64 v81, s53, v81
    v_add_u32 v81, 1024, v81
    s_cmp_lt_u32 s3, 2
    s_cselect_b64 vcc, -1, 0
    s_cselect_b32 s53, 2, 16
    v_cndmask_b32 v80, v81, v80, vcc
    v_add_u32 v81, s53, v80
    v_add_u32 v82, s53, v81
    v_add_u32 v83, s53, v82
    v_lshlrev_b32 v77, 2, v2
    s_lshl_b32 s53, s3, 11
    v_add_u32 v78, s53, v4
    s_lshl_b32 s62, s48, 3
    s_lshl_b32 s63, s3, 1
    s_add_u32 s62, s62, s63
    s_lshl_b32 s62, s62, 4
    s_add_u32 s62, s62, s49
    s_lshl_b32 s62, s62, 10
    s_add_u32 s63, s62, 16384
    s_add_u32 m0, s51, 24576
    s_mov_b32 s73, 172032
    buffer_load_dwordx4 v123, s[12:15], s73 offen lds
    s_add_u32 m0, s51, 26624
    s_mov_b32 s73, 172928
    buffer_load_dwordx4 v123, s[12:15], s73 offen lds
    s_add_u32 m0, s51, 28672
    s_mov_b32 s73, 173824
    buffer_load_dwordx4 v123, s[12:15], s73 offen lds
    s_add_u32 m0, s52, 18432
    s_mov_b32 s73, 128
    buffer_load_dwordx4 v120, s[8:11], s73 offen lds
    s_add_u32 m0, s52, 19456
    s_mov_b32 s73, 128
    buffer_load_dwordx4 v121, s[8:11], s73 offen lds
    s_add_u32 m0, s52, 20480
    s_mov_b32 s73, 14464
    buffer_load_dwordx4 v120, s[8:11], s73 offen lds
    s_add_u32 m0, s52, 21504
    s_mov_b32 s73, 14464
    buffer_load_dwordx4 v121, s[8:11], s73 offen lds
    s_add_u32 m0, s7, 79872
    s_mov_b32 s73, 128
    s_mov_b64 exec, s[54:55]
    buffer_load_dwordx4 v122, s[8:11], s73 offen lds
    s_mov_b64 exec, -1
    s_waitcnt vmcnt(11)
    s_waitcnt lgkmcnt(0)
    s_barrier
    ds_read_b128 v[16:19], v128 offset:36864
    ds_read_b128 v[20:23], v128 offset:38912
    ds_read_b128 v[24:27], v130 offset:36864
    ds_read_b64_tr_b16 v[88:89], v124 offset:0
    ds_read_b64_tr_b16 v[90:91], v124 offset:256
    ds_read_b64_tr_b16 v[92:93], v125 offset:0
    ds_read_b64_tr_b16 v[94:95], v125 offset:256
    ds_read_b64_tr_b16 v[96:97], v124 offset:2048
    ds_read_b64_tr_b16 v[98:99], v124 offset:2304
    ds_read_b64_tr_b16 v[100:101], v125 offset:2048
    ds_read_b64_tr_b16 v[102:103], v125 offset:2304
    ds_read_b64_tr_b16 v[104:105], v124 offset:4096
    ds_read_b64_tr_b16 v[106:107], v124 offset:4352
    ds_read_b64_tr_b16 v[108:109], v125 offset:4096
    ds_read_b64_tr_b16 v[110:111], v125 offset:4352
    ds_read_b64_tr_b16 v[112:113], v126 offset:0
    ds_read_b64_tr_b16 v[114:115], v126 offset:256
    ds_read_b64_tr_b16 v[116:117], v127 offset:0
    ds_read_b64_tr_b16 v[118:119], v127 offset:256
    s_waitcnt lgkmcnt(8)
    v_mfma_f32_16x16x32_bf16 v[136:139], v[88:91], v[16:19], 0
    ds_read_b128 v[28:31], v129 offset:36864
    v_mfma_f32_16x16x32_bf16 v[160:163], v[88:91], v[20:23], 0
    ds_read_b128 v[32:35], v129 offset:38912
    v_mfma_f32_16x16x32_bf16 v[140:143], v[92:95], v[16:19], 0
    ds_read_b128 v[36:39], v131 offset:36864
    v_mfma_f32_16x16x32_bf16 v[164:167], v[92:95], v[20:23], 0
    ds_read_b64_tr_b16 v[88:89], v124 offset:6144
    v_mfma_f32_16x16x32_bf16 v[144:147], v[96:99], v[16:19], 0
    ds_read_b64_tr_b16 v[90:91], v124 offset:6400
    s_add_u32 m0, s51, 36864
    s_mov_b32 s73, 344064
    buffer_load_dwordx4 v123, s[12:15], s73 offen lds
    v_mfma_f32_16x16x32_bf16 v[168:171], v[96:99], v[20:23], 0
    ds_read_b64_tr_b16 v[92:93], v125 offset:6144
    v_mfma_f32_16x16x32_bf16 v[148:151], v[100:103], v[16:19], 0
    ds_read_b64_tr_b16 v[94:95], v125 offset:6400
    v_mfma_f32_16x16x32_bf16 v[172:175], v[100:103], v[20:23], 0
    ds_read_b64_tr_b16 v[96:97], v124 offset:8192
    s_waitcnt lgkmcnt(8)
    v_mfma_f32_16x16x32_bf16 v[152:155], v[16:19], v[104:107], 0
    ds_read_b64_tr_b16 v[98:99], v124 offset:8448
    v_mfma_f32_16x16x32_bf16 v[176:179], v[20:23], v[104:107], 0
    ds_read_b64_tr_b16 v[100:101], v125 offset:8192
    s_add_u32 m0, s51, 38912
    s_mov_b32 s73, 344960
    buffer_load_dwordx4 v123, s[12:15], s73 offen lds
    v_mfma_f32_16x16x32_bf16 v[156:159], v[16:19], v[108:111], 0
    ds_read_b64_tr_b16 v[102:103], v125 offset:8448
    v_mfma_f32_16x16x32_bf16 v[180:183], v[20:23], v[108:111], 0
    ds_read_b64_tr_b16 v[104:105], v124 offset:10240
    v_mfma_f32_16x16x32_bf16 v[184:187], v[112:115], v[24:27], 0
    ds_read_b64_tr_b16 v[106:107], v124 offset:10496
    v_mfma_f32_16x16x32_bf16 v[188:191], v[116:119], v[24:27], 0
    ds_read_b64_tr_b16 v[108:109], v125 offset:10240
    v_mfma_f32_16x16x32_bf16 v[48:51], v[16:19], v[16:19], 0
    ds_read_b64_tr_b16 v[110:111], v125 offset:10496
    s_add_u32 m0, s51, 40960
    s_mov_b32 s73, 345856
    buffer_load_dwordx4 v123, s[12:15], s73 offen lds
    v_mfma_f32_16x16x32_bf16 v[52:55], v[20:23], v[20:23], 0
    ds_read_b64_tr_b16 v[112:113], v126 offset:6144
    v_mfma_f32_16x16x32_bf16 v[56:59], v[24:27], v[24:27], 0
    ds_read_b64_tr_b16 v[114:115], v126 offset:6400
    v_mfma_f32_16x16x32_bf16 v[60:63], v[40:43], v[16:19], 0
    ds_read_b64_tr_b16 v[116:117], v127 offset:6144
    v_mfma_f32_16x16x32_bf16 v[64:67], v[40:43], v[20:23], 0
    ds_read_b64_tr_b16 v[118:119], v127 offset:6400
    v_mfma_f32_16x16x32_bf16 v[68:71], v[40:43], v[24:27], 0
    s_add_u32 m0, s52, 0
    s_mov_b32 s73, 256
    buffer_load_dwordx4 v120, s[8:11], s73 offen lds
    s_add_u32 m0, s52, 1024
    s_mov_b32 s73, 256
    buffer_load_dwordx4 v121, s[8:11], s73 offen lds
    s_add_u32 m0, s52, 2048
    s_mov_b32 s73, 14592
    buffer_load_dwordx4 v120, s[8:11], s73 offen lds
    s_add_u32 m0, s52, 3072
    s_mov_b32 s73, 14592
    buffer_load_dwordx4 v121, s[8:11], s73 offen lds
    s_add_u32 m0, s7, 61440
    s_mov_b32 s73, 256
    s_mov_b64 exec, s[54:55]
    buffer_load_dwordx4 v122, s[8:11], s73 offen lds
    s_mov_b64 exec, -1
    s_waitcnt vmcnt(8)
    s_barrier
    s_waitcnt lgkmcnt(8)
    v_mfma_f32_16x16x32_bf16 v[136:139], v[88:91], v[28:31], v[136:139]
    ds_read_b128 v[16:19], v128 offset:18432
    v_mfma_f32_16x16x32_bf16 v[160:163], v[88:91], v[32:35], v[160:163]
    ds_read_b128 v[20:23], v128 offset:20480
    v_mfma_f32_16x16x32_bf16 v[140:143], v[92:95], v[28:31], v[140:143]
    ds_read_b128 v[24:27], v130 offset:18432
    v_mfma_f32_16x16x32_bf16 v[164:167], v[92:95], v[32:35], v[164:167]
    ds_read_b64_tr_b16 v[88:89], v124 offset:12288
    v_mfma_f32_16x16x32_bf16 v[144:147], v[96:99], v[28:31], v[144:147]
    ds_read_b64_tr_b16 v[90:91], v124 offset:12544
    s_add_u32 m0, s51, 49152
    s_mov_b32 s73, 516096
    buffer_load_dwordx4 v123, s[12:15], s73 offen lds
    v_mfma_f32_16x16x32_bf16 v[168:171], v[96:99], v[32:35], v[168:171]
    ds_read_b64_tr_b16 v[92:93], v125 offset:12288
    v_mfma_f32_16x16x32_bf16 v[148:151], v[100:103], v[28:31], v[148:151]
    ds_read_b64_tr_b16 v[94:95], v125 offset:12544
    v_mfma_f32_16x16x32_bf16 v[172:175], v[100:103], v[32:35], v[172:175]
    ds_read_b64_tr_b16 v[96:97], v124 offset:14336
    s_waitcnt lgkmcnt(8)
    v_mfma_f32_16x16x32_bf16 v[152:155], v[28:31], v[104:107], v[152:155]
    ds_read_b64_tr_b16 v[98:99], v124 offset:14592
    v_mfma_f32_16x16x32_bf16 v[176:179], v[32:35], v[104:107], v[176:179]
    ds_read_b64_tr_b16 v[100:101], v125 offset:14336
    s_add_u32 m0, s51, 51200
    s_mov_b32 s73, 516992
    buffer_load_dwordx4 v123, s[12:15], s73 offen lds
    v_mfma_f32_16x16x32_bf16 v[156:159], v[28:31], v[108:111], v[156:159]
    ds_read_b64_tr_b16 v[102:103], v125 offset:14592
    v_mfma_f32_16x16x32_bf16 v[180:183], v[32:35], v[108:111], v[180:183]
    ds_read_b64_tr_b16 v[104:105], v124 offset:16384
    v_mfma_f32_16x16x32_bf16 v[184:187], v[112:115], v[36:39], v[184:187]
    ds_read_b64_tr_b16 v[106:107], v124 offset:16640
    v_mfma_f32_16x16x32_bf16 v[188:191], v[116:119], v[36:39], v[188:191]
    ds_read_b64_tr_b16 v[108:109], v125 offset:16384
    v_mfma_f32_16x16x32_bf16 v[48:51], v[28:31], v[28:31], v[48:51]
    ds_read_b64_tr_b16 v[110:111], v125 offset:16640
    s_add_u32 m0, s51, 53248
    s_mov_b32 s73, 517888
    buffer_load_dwordx4 v123, s[12:15], s73 offen lds
    v_mfma_f32_16x16x32_bf16 v[52:55], v[32:35], v[32:35], v[52:55]
    ds_read_b64_tr_b16 v[112:113], v126 offset:12288
    v_mfma_f32_16x16x32_bf16 v[56:59], v[36:39], v[36:39], v[56:59]
    ds_read_b64_tr_b16 v[114:115], v126 offset:12544
    v_mfma_f32_16x16x32_bf16 v[60:63], v[40:43], v[28:31], v[60:63]
    ds_read_b64_tr_b16 v[116:117], v127 offset:12288
    v_mfma_f32_16x16x32_bf16 v[64:67], v[40:43], v[32:35], v[64:67]
    ds_read_b64_tr_b16 v[118:119], v127 offset:12544
    v_mfma_f32_16x16x32_bf16 v[68:71], v[40:43], v[36:39], v[68:71]
    s_add_u32 m0, s52, 55296
    s_mov_b32 s73, 384
    buffer_load_dwordx4 v120, s[8:11], s73 offen lds
    s_waitcnt lgkmcnt(8)
    v_mfma_f32_16x16x32_bf16 v[136:139], v[88:91], v[16:19], v[136:139]
    ds_read_b128 v[28:31], v129 offset:18432
    v_mfma_f32_16x16x32_bf16 v[160:163], v[88:91], v[20:23], v[160:163]
    ds_read_b128 v[32:35], v129 offset:20480
    v_mfma_f32_16x16x32_bf16 v[140:143], v[92:95], v[16:19], v[140:143]
    ds_read_b128 v[36:39], v131 offset:18432
    v_mfma_f32_16x16x32_bf16 v[164:167], v[92:95], v[20:23], v[164:167]
    ds_read_b64_tr_b16 v[88:89], v124 offset:18432
    v_mfma_f32_16x16x32_bf16 v[144:147], v[96:99], v[16:19], v[144:147]
    ds_read_b64_tr_b16 v[90:91], v124 offset:18688
    s_add_u32 m0, s52, 56320
    s_mov_b32 s73, 384
    buffer_load_dwordx4 v121, s[8:11], s73 offen lds
    v_mfma_f32_16x16x32_bf16 v[168:171], v[96:99], v[20:23], v[168:171]
    ds_read_b64_tr_b16 v[92:93], v125 offset:18432
    v_mfma_f32_16x16x32_bf16 v[148:151], v[100:103], v[16:19], v[148:151]
    ds_read_b64_tr_b16 v[94:95], v125 offset:18688
    v_mfma_f32_16x16x32_bf16 v[172:175], v[100:103], v[20:23], v[172:175]
    ds_read_b64_tr_b16 v[96:97], v124 offset:20480
    s_waitcnt lgkmcnt(8)
    v_mfma_f32_16x16x32_bf16 v[152:155], v[16:19], v[104:107], v[152:155]
    ds_read_b64_tr_b16 v[98:99], v124 offset:20736
    v_mfma_f32_16x16x32_bf16 v[176:179], v[20:23], v[104:107], v[176:179]
    ds_read_b64_tr_b16 v[100:101], v125 offset:20480
    s_add_u32 m0, s52, 57344
    s_mov_b32 s73, 14720
    buffer_load_dwordx4 v120, s[8:11], s73 offen lds
    v_mfma_f32_16x16x32_bf16 v[156:159], v[16:19], v[108:111], v[156:159]
    ds_read_b64_tr_b16 v[102:103], v125 offset:20736
    v_mfma_f32_16x16x32_bf16 v[180:183], v[20:23], v[108:111], v[180:183]
    ds_read_b64_tr_b16 v[104:105], v124 offset:22528
    v_mfma_f32_16x16x32_bf16 v[184:187], v[112:115], v[24:27], v[184:187]
    ds_read_b64_tr_b16 v[106:107], v124 offset:22784
    v_mfma_f32_16x16x32_bf16 v[188:191], v[116:119], v[24:27], v[188:191]
    ds_read_b64_tr_b16 v[108:109], v125 offset:22528
    v_mfma_f32_16x16x32_bf16 v[48:51], v[16:19], v[16:19], v[48:51]
    ds_read_b64_tr_b16 v[110:111], v125 offset:22784
    s_add_u32 m0, s52, 58368
    s_mov_b32 s73, 14720
    buffer_load_dwordx4 v121, s[8:11], s73 offen lds
    v_mfma_f32_16x16x32_bf16 v[52:55], v[20:23], v[20:23], v[52:55]
    ds_read_b64_tr_b16 v[112:113], v126 offset:18432
    v_mfma_f32_16x16x32_bf16 v[56:59], v[24:27], v[24:27], v[56:59]
    ds_read_b64_tr_b16 v[114:115], v126 offset:18688
    v_mfma_f32_16x16x32_bf16 v[60:63], v[40:43], v[16:19], v[60:63]
    ds_read_b64_tr_b16 v[116:117], v127 offset:18432
    v_mfma_f32_16x16x32_bf16 v[64:67], v[40:43], v[20:23], v[64:67]
    ds_read_b64_tr_b16 v[118:119], v127 offset:18688
    v_mfma_f32_16x16x32_bf16 v[68:71], v[40:43], v[24:27], v[68:71]
    s_add_u32 m0, s7, 116736
    s_mov_b32 s73, 384
    s_mov_b64 exec, s[54:55]
    buffer_load_dwordx4 v122, s[8:11], s73 offen lds
    s_mov_b64 exec, -1
    s_waitcnt vmcnt(8)
    s_barrier
    s_waitcnt lgkmcnt(8)
    v_mfma_f32_16x16x32_bf16 v[136:139], v[88:91], v[28:31], v[136:139]
    ds_read_b128 v[16:19], v128 offset:0
    v_mfma_f32_16x16x32_bf16 v[160:163], v[88:91], v[32:35], v[160:163]
    ds_read_b128 v[20:23], v128 offset:2048
    v_mfma_f32_16x16x32_bf16 v[140:143], v[92:95], v[28:31], v[140:143]
    ds_read_b128 v[24:27], v130 offset:0
    v_mfma_f32_16x16x32_bf16 v[164:167], v[92:95], v[32:35], v[164:167]
    ds_read_b64_tr_b16 v[88:89], v124 offset:24576
    v_mfma_f32_16x16x32_bf16 v[144:147], v[96:99], v[28:31], v[144:147]
    ds_read_b64_tr_b16 v[90:91], v124 offset:24832
    s_add_u32 m0, s51, 12288
    s_mov_b32 s73, 688128
    buffer_load_dwordx4 v123, s[12:15], s73 offen lds
    v_mfma_f32_16x16x32_bf16 v[168:171], v[96:99], v[32:35], v[168:171]
    ds_read_b64_tr_b16 v[92:93], v125 offset:24576
    v_mfma_f32_16x16x32_bf16 v[148:151], v[100:103], v[28:31], v[148:151]
    ds_read_b64_tr_b16 v[94:95], v125 offset:24832
    v_mfma_f32_16x16x32_bf16 v[172:175], v[100:103], v[32:35], v[172:175]
    ds_read_b64_tr_b16 v[96:97], v124 offset:26624
    s_waitcnt lgkmcnt(8)
    v_mfma_f32_16x16x32_bf16 v[152:155], v[28:31], v[104:107], v[152:155]
    ds_read_b64_tr_b16 v[98:99], v124 offset:26880
    v_mfma_f32_16x16x32_bf16 v[176:179], v[32:35], v[104:107], v[176:179]
    ds_read_b64_tr_b16 v[100:101], v125 offset:26624
    s_add_u32 m0, s51, 14336
    s_mov_b32 s73, 689024
    buffer_load_dwordx4 v123, s[12:15], s73 offen lds
    v_mfma_f32_16x16x32_bf16 v[156:159], v[28:31], v[108:111], v[156:159]
    ds_read_b64_tr_b16 v[102:103], v125 offset:26880
    v_mfma_f32_16x16x32_bf16 v[180:183], v[32:35], v[108:111], v[180:183]
    ds_read_b64_tr_b16 v[104:105], v124 offset:28672
    v_mfma_f32_16x16x32_bf16 v[184:187], v[112:115], v[36:39], v[184:187]
    ds_read_b64_tr_b16 v[106:107], v124 offset:28928
    v_mfma_f32_16x16x32_bf16 v[188:191], v[116:119], v[36:39], v[188:191]
    ds_read_b64_tr_b16 v[108:109], v125 offset:28672
    v_mfma_f32_16x16x32_bf16 v[48:51], v[28:31], v[28:31], v[48:51]
    ds_read_b64_tr_b16 v[110:111], v125 offset:28928
    s_add_u32 m0, s51, 16384
    s_mov_b32 s73, 689920
    buffer_load_dwordx4 v123, s[12:15], s73 offen lds
    v_mfma_f32_16x16x32_bf16 v[52:55], v[32:35], v[32:35], v[52:55]
    ds_read_b64_tr_b16 v[112:113], v126 offset:24576
    v_mfma_f32_16x16x32_bf16 v[56:59], v[36:39], v[36:39], v[56:59]
    ds_read_b64_tr_b16 v[114:115], v126 offset:24832
    v_mfma_f32_16x16x32_bf16 v[60:63], v[40:43], v[28:31], v[60:63]
    ds_read_b64_tr_b16 v[116:117], v127 offset:24576
    v_mfma_f32_16x16x32_bf16 v[64:67], v[40:43], v[32:35], v[64:67]
    ds_read_b64_tr_b16 v[118:119], v127 offset:24832
    v_mfma_f32_16x16x32_bf16 v[68:71], v[40:43], v[36:39], v[68:71]
    s_add_u32 m0, s52, 36864
    s_mov_b32 s73, 512
    buffer_load_dwordx4 v120, s[8:11], s73 offen lds
    s_waitcnt lgkmcnt(8)
    v_mfma_f32_16x16x32_bf16 v[136:139], v[88:91], v[16:19], v[136:139]
    ds_read_b128 v[28:31], v129 offset:0
    v_mfma_f32_16x16x32_bf16 v[160:163], v[88:91], v[20:23], v[160:163]
    ds_read_b128 v[32:35], v129 offset:2048
    v_mfma_f32_16x16x32_bf16 v[140:143], v[92:95], v[16:19], v[140:143]
    ds_read_b128 v[36:39], v131 offset:0
    v_mfma_f32_16x16x32_bf16 v[164:167], v[92:95], v[20:23], v[164:167]
    ds_read_b64_tr_b16 v[88:89], v124 offset:30720
    v_mfma_f32_16x16x32_bf16 v[144:147], v[96:99], v[16:19], v[144:147]
    ds_read_b64_tr_b16 v[90:91], v124 offset:30976
    s_add_u32 m0, s52, 37888
    s_mov_b32 s73, 512
    buffer_load_dwordx4 v121, s[8:11], s73 offen lds
    v_mfma_f32_16x16x32_bf16 v[168:171], v[96:99], v[20:23], v[168:171]
    ds_read_b64_tr_b16 v[92:93], v125 offset:30720
    v_mfma_f32_16x16x32_bf16 v[148:151], v[100:103], v[16:19], v[148:151]
    ds_read_b64_tr_b16 v[94:95], v125 offset:30976
    v_mfma_f32_16x16x32_bf16 v[172:175], v[100:103], v[20:23], v[172:175]
    ds_read_b64_tr_b16 v[96:97], v124 offset:32768
    s_waitcnt lgkmcnt(8)
    v_mfma_f32_16x16x32_bf16 v[152:155], v[16:19], v[104:107], v[152:155]
    ds_read_b64_tr_b16 v[98:99], v124 offset:33024
    v_mfma_f32_16x16x32_bf16 v[176:179], v[20:23], v[104:107], v[176:179]
    ds_read_b64_tr_b16 v[100:101], v125 offset:32768
    s_add_u32 m0, s52, 38912
    s_mov_b32 s73, 14848
    buffer_load_dwordx4 v120, s[8:11], s73 offen lds
    v_mfma_f32_16x16x32_bf16 v[156:159], v[16:19], v[108:111], v[156:159]
    ds_read_b64_tr_b16 v[102:103], v125 offset:33024
    v_mfma_f32_16x16x32_bf16 v[180:183], v[20:23], v[108:111], v[180:183]
    ds_read_b64_tr_b16 v[104:105], v124 offset:34816
    v_mfma_f32_16x16x32_bf16 v[184:187], v[112:115], v[24:27], v[184:187]
    ds_read_b64_tr_b16 v[106:107], v124 offset:35072
    v_mfma_f32_16x16x32_bf16 v[188:191], v[116:119], v[24:27], v[188:191]
    ds_read_b64_tr_b16 v[108:109], v125 offset:34816
    v_mfma_f32_16x16x32_bf16 v[48:51], v[16:19], v[16:19], v[48:51]
    ds_read_b64_tr_b16 v[110:111], v125 offset:35072
    s_add_u32 m0, s52, 39936
    s_mov_b32 s73, 14848
    buffer_load_dwordx4 v121, s[8:11], s73 offen lds
    v_mfma_f32_16x16x32_bf16 v[52:55], v[20:23], v[20:23], v[52:55]
    ds_read_b64_tr_b16 v[112:113], v126 offset:30720
    v_mfma_f32_16x16x32_bf16 v[56:59], v[24:27], v[24:27], v[56:59]
    ds_read_b64_tr_b16 v[114:115], v126 offset:30976
    v_mfma_f32_16x16x32_bf16 v[60:63], v[40:43], v[16:19], v[60:63]
    ds_read_b64_tr_b16 v[116:117], v127 offset:30720
    v_mfma_f32_16x16x32_bf16 v[64:67], v[40:43], v[20:23], v[64:67]
    ds_read_b64_tr_b16 v[118:119], v127 offset:30976
    v_mfma_f32_16x16x32_bf16 v[68:71], v[40:43], v[24:27], v[68:71]
    s_add_u32 m0, s7, 98304
    s_mov_b32 s73, 512
    s_mov_b64 exec, s[54:55]
    buffer_load_dwordx4 v122, s[8:11], s73 offen lds
    s_mov_b64 exec, -1
    s_waitcnt vmcnt(8)
    s_barrier
    s_waitcnt lgkmcnt(8)
    v_mfma_f32_16x16x32_bf16 v[136:139], v[88:91], v[28:31], v[136:139]
    ds_read_b128 v[16:19], v128 offset:55296
    v_mfma_f32_16x16x32_bf16 v[160:163], v[88:91], v[32:35], v[160:163]
    ds_read_b128 v[20:23], v128 offset:57344
    v_mfma_f32_16x16x32_bf16 v[140:143], v[92:95], v[28:31], v[140:143]
    ds_read_b128 v[24:27], v130 offset:55296
    v_mfma_f32_16x16x32_bf16 v[164:167], v[92:95], v[32:35], v[164:167]
    ds_read_b64_tr_b16 v[88:89], v124 offset:36864
    v_mfma_f32_16x16x32_bf16 v[144:147], v[96:99], v[28:31], v[144:147]
    ds_read_b64_tr_b16 v[90:91], v124 offset:37120
    s_add_u32 m0, s51, 24576
    s_mov_b32 s73, 860160
    buffer_load_dwordx4 v123, s[12:15], s73 offen lds
    v_mfma_f32_16x16x32_bf16 v[168:171], v[96:99], v[32:35], v[168:171]
    ds_read_b64_tr_b16 v[92:93], v125 offset:36864
    v_mfma_f32_16x16x32_bf16 v[148:151], v[100:103], v[28:31], v[148:151]
    ds_read_b64_tr_b16 v[94:95], v125 offset:37120
    v_mfma_f32_16x16x32_bf16 v[172:175], v[100:103], v[32:35], v[172:175]
    ds_read_b64_tr_b16 v[96:97], v124 offset:38912
    s_waitcnt lgkmcnt(8)
    v_mfma_f32_16x16x32_bf16 v[152:155], v[28:31], v[104:107], v[152:155]
    ds_read_b64_tr_b16 v[98:99], v124 offset:39168
    v_mfma_f32_16x16x32_bf16 v[176:179], v[32:35], v[104:107], v[176:179]
    ds_read_b64_tr_b16 v[100:101], v125 offset:38912
    s_add_u32 m0, s51, 26624
    s_mov_b32 s73, 861056
    buffer_load_dwordx4 v123, s[12:15], s73 offen lds
    v_mfma_f32_16x16x32_bf16 v[156:159], v[28:31], v[108:111], v[156:159]
    ds_read_b64_tr_b16 v[102:103], v125 offset:39168
    v_mfma_f32_16x16x32_bf16 v[180:183], v[32:35], v[108:111], v[180:183]
    ds_read_b64_tr_b16 v[104:105], v124 offset:40960
    v_mfma_f32_16x16x32_bf16 v[184:187], v[112:115], v[36:39], v[184:187]
    ds_read_b64_tr_b16 v[106:107], v124 offset:41216
    v_mfma_f32_16x16x32_bf16 v[188:191], v[116:119], v[36:39], v[188:191]
    ds_read_b64_tr_b16 v[108:109], v125 offset:40960
    v_mfma_f32_16x16x32_bf16 v[48:51], v[28:31], v[28:31], v[48:51]
    ds_read_b64_tr_b16 v[110:111], v125 offset:41216
    s_add_u32 m0, s51, 28672
    s_mov_b32 s73, 861952
    buffer_load_dwordx4 v123, s[12:15], s73 offen lds
    v_mfma_f32_16x16x32_bf16 v[52:55], v[32:35], v[32:35], v[52:55]
    ds_read_b64_tr_b16 v[112:113], v126 offset:36864
    v_mfma_f32_16x16x32_bf16 v[56:59], v[36:39], v[36:39], v[56:59]
    ds_read_b64_tr_b16 v[114:115], v126 offset:37120
    v_mfma_f32_16x16x32_bf16 v[60:63], v[40:43], v[28:31], v[60:63]
    ds_read_b64_tr_b16 v[116:117], v127 offset:36864
    v_mfma_f32_16x16x32_bf16 v[64:67], v[40:43], v[32:35], v[64:67]
    ds_read_b64_tr_b16 v[118:119], v127 offset:37120
    v_mfma_f32_16x16x32_bf16 v[68:71], v[40:43], v[36:39], v[68:71]
    s_add_u32 m0, s52, 18432
    s_mov_b32 s73, 640
    buffer_load_dwordx4 v120, s[8:11], s73 offen lds
    s_waitcnt lgkmcnt(8)
    v_mfma_f32_16x16x32_bf16 v[136:139], v[88:91], v[16:19], v[136:139]
    ds_read_b128 v[28:31], v129 offset:55296
    v_mfma_f32_16x16x32_bf16 v[160:163], v[88:91], v[20:23], v[160:163]
    ds_read_b128 v[32:35], v129 offset:57344
    v_mfma_f32_16x16x32_bf16 v[140:143], v[92:95], v[16:19], v[140:143]
    ds_read_b128 v[36:39], v131 offset:55296
    v_mfma_f32_16x16x32_bf16 v[164:167], v[92:95], v[20:23], v[164:167]
    ds_read_b64_tr_b16 v[88:89], v124 offset:43008
    v_mfma_f32_16x16x32_bf16 v[144:147], v[96:99], v[16:19], v[144:147]
    ds_read_b64_tr_b16 v[90:91], v124 offset:43264
    s_add_u32 m0, s52, 19456
    s_mov_b32 s73, 640
    buffer_load_dwordx4 v121, s[8:11], s73 offen lds
    v_mfma_f32_16x16x32_bf16 v[168:171], v[96:99], v[20:23], v[168:171]
    ds_read_b64_tr_b16 v[92:93], v125 offset:43008
    v_mfma_f32_16x16x32_bf16 v[148:151], v[100:103], v[16:19], v[148:151]
    ds_read_b64_tr_b16 v[94:95], v125 offset:43264
    v_mfma_f32_16x16x32_bf16 v[172:175], v[100:103], v[20:23], v[172:175]
    ds_read_b64_tr_b16 v[96:97], v124 offset:45056
    s_waitcnt lgkmcnt(8)
    v_mfma_f32_16x16x32_bf16 v[152:155], v[16:19], v[104:107], v[152:155]
    ds_read_b64_tr_b16 v[98:99], v124 offset:45312
    v_mfma_f32_16x16x32_bf16 v[176:179], v[20:23], v[104:107], v[176:179]
    ds_read_b64_tr_b16 v[100:101], v125 offset:45056
    s_add_u32 m0, s52, 20480
    s_mov_b32 s73, 14976
    buffer_load_dwordx4 v120, s[8:11], s73 offen lds
    v_mfma_f32_16x16x32_bf16 v[156:159], v[16:19], v[108:111], v[156:159]
    ds_read_b64_tr_b16 v[102:103], v125 offset:45312
    v_mfma_f32_16x16x32_bf16 v[180:183], v[20:23], v[108:111], v[180:183]
    ds_read_b64_tr_b16 v[104:105], v124 offset:47104
    v_mfma_f32_16x16x32_bf16 v[184:187], v[112:115], v[24:27], v[184:187]
    ds_read_b64_tr_b16 v[106:107], v124 offset:47360
    v_mfma_f32_16x16x32_bf16 v[188:191], v[116:119], v[24:27], v[188:191]
    ds_read_b64_tr_b16 v[108:109], v125 offset:47104
    v_mfma_f32_16x16x32_bf16 v[48:51], v[16:19], v[16:19], v[48:51]
    ds_read_b64_tr_b16 v[110:111], v125 offset:47360
    s_add_u32 m0, s52, 21504
    s_mov_b32 s73, 14976
    buffer_load_dwordx4 v121, s[8:11], s73 offen lds
    v_mfma_f32_16x16x32_bf16 v[52:55], v[20:23], v[20:23], v[52:55]
    ds_read_b64_tr_b16 v[112:113], v126 offset:43008
    v_mfma_f32_16x16x32_bf16 v[56:59], v[24:27], v[24:27], v[56:59]
    ds_read_b64_tr_b16 v[114:115], v126 offset:43264
    v_mfma_f32_16x16x32_bf16 v[60:63], v[40:43], v[16:19], v[60:63]
    ds_read_b64_tr_b16 v[116:117], v127 offset:43008
    v_mfma_f32_16x16x32_bf16 v[64:67], v[40:43], v[20:23], v[64:67]
    ds_read_b64_tr_b16 v[118:119], v127 offset:43264
    v_mfma_f32_16x16x32_bf16 v[68:71], v[40:43], v[24:27], v[68:71]
    s_add_u32 m0, s7, 79872
    s_mov_b32 s73, 640
    s_mov_b64 exec, s[54:55]
    buffer_load_dwordx4 v122, s[8:11], s73 offen lds
    s_mov_b64 exec, -1
    s_waitcnt vmcnt(8)
    s_barrier
    s_waitcnt lgkmcnt(8)
    v_mfma_f32_16x16x32_bf16 v[136:139], v[88:91], v[28:31], v[136:139]
    ds_read_b128 v[16:19], v128 offset:36864
    v_mfma_f32_16x16x32_bf16 v[160:163], v[88:91], v[32:35], v[160:163]
    ds_read_b128 v[20:23], v128 offset:38912
    v_mfma_f32_16x16x32_bf16 v[140:143], v[92:95], v[28:31], v[140:143]
    ds_read_b128 v[24:27], v130 offset:36864
    v_mfma_f32_16x16x32_bf16 v[164:167], v[92:95], v[32:35], v[164:167]
    ds_read_b64_tr_b16 v[88:89], v124 offset:0
    v_mfma_f32_16x16x32_bf16 v[144:147], v[96:99], v[28:31], v[144:147]
    ds_read_b64_tr_b16 v[90:91], v124 offset:256
    s_add_u32 m0, s51, 36864
    s_mov_b32 s73, 1032192
    buffer_load_dwordx4 v123, s[12:15], s73 offen lds
    v_mfma_f32_16x16x32_bf16 v[168:171], v[96:99], v[32:35], v[168:171]
    ds_read_b64_tr_b16 v[92:93], v125 offset:0
    v_mfma_f32_16x16x32_bf16 v[148:151], v[100:103], v[28:31], v[148:151]
    ds_read_b64_tr_b16 v[94:95], v125 offset:256
    v_mfma_f32_16x16x32_bf16 v[172:175], v[100:103], v[32:35], v[172:175]
    ds_read_b64_tr_b16 v[96:97], v124 offset:2048
    s_waitcnt lgkmcnt(8)
    v_mfma_f32_16x16x32_bf16 v[152:155], v[28:31], v[104:107], v[152:155]
    ds_read_b64_tr_b16 v[98:99], v124 offset:2304
    v_mfma_f32_16x16x32_bf16 v[176:179], v[32:35], v[104:107], v[176:179]
    ds_read_b64_tr_b16 v[100:101], v125 offset:2048
    s_add_u32 m0, s51, 38912
    s_mov_b32 s73, 1033088
    buffer_load_dwordx4 v123, s[12:15], s73 offen lds
    v_mfma_f32_16x16x32_bf16 v[156:159], v[28:31], v[108:111], v[156:159]
    ds_read_b64_tr_b16 v[102:103], v125 offset:2304
    v_mfma_f32_16x16x32_bf16 v[180:183], v[32:35], v[108:111], v[180:183]
    ds_read_b64_tr_b16 v[104:105], v124 offset:4096
    v_mfma_f32_16x16x32_bf16 v[184:187], v[112:115], v[36:39], v[184:187]
    ds_read_b64_tr_b16 v[106:107], v124 offset:4352
    v_mfma_f32_16x16x32_bf16 v[188:191], v[116:119], v[36:39], v[188:191]
    ds_read_b64_tr_b16 v[108:109], v125 offset:4096
    v_mfma_f32_16x16x32_bf16 v[48:51], v[28:31], v[28:31], v[48:51]
    ds_read_b64_tr_b16 v[110:111], v125 offset:4352
    s_add_u32 m0, s51, 40960
    s_mov_b32 s73, 1033984
    buffer_load_dwordx4 v123, s[12:15], s73 offen lds
    v_mfma_f32_16x16x32_bf16 v[52:55], v[32:35], v[32:35], v[52:55]
    ds_read_b64_tr_b16 v[112:113], v126 offset:0
    v_mfma_f32_16x16x32_bf16 v[56:59], v[36:39], v[36:39], v[56:59]
    ds_read_b64_tr_b16 v[114:115], v126 offset:256
    v_mfma_f32_16x16x32_bf16 v[60:63], v[40:43], v[28:31], v[60:63]
    ds_read_b64_tr_b16 v[116:117], v127 offset:0
    v_mfma_f32_16x16x32_bf16 v[64:67], v[40:43], v[32:35], v[64:67]
    ds_read_b64_tr_b16 v[118:119], v127 offset:256
    v_mfma_f32_16x16x32_bf16 v[68:71], v[40:43], v[36:39], v[68:71]
    s_add_u32 m0, s52, 0
    s_mov_b32 s73, 768
    buffer_load_dwordx4 v120, s[8:11], s73 offen lds
    s_waitcnt lgkmcnt(8)
    v_mfma_f32_16x16x32_bf16 v[136:139], v[88:91], v[16:19], v[136:139]
    ds_read_b128 v[28:31], v129 offset:36864
    v_mfma_f32_16x16x32_bf16 v[160:163], v[88:91], v[20:23], v[160:163]
    ds_read_b128 v[32:35], v129 offset:38912
    v_mfma_f32_16x16x32_bf16 v[140:143], v[92:95], v[16:19], v[140:143]
    ds_read_b128 v[36:39], v131 offset:36864
    v_mfma_f32_16x16x32_bf16 v[164:167], v[92:95], v[20:23], v[164:167]
    ds_read_b64_tr_b16 v[88:89], v124 offset:6144
    v_mfma_f32_16x16x32_bf16 v[144:147], v[96:99], v[16:19], v[144:147]
    ds_read_b64_tr_b16 v[90:91], v124 offset:6400
    s_add_u32 m0, s52, 1024
    s_mov_b32 s73, 768
    buffer_load_dwordx4 v121, s[8:11], s73 offen lds
    v_mfma_f32_16x16x32_bf16 v[168:171], v[96:99], v[20:23], v[168:171]
    ds_read_b64_tr_b16 v[92:93], v125 offset:6144
    v_mfma_f32_16x16x32_bf16 v[148:151], v[100:103], v[16:19], v[148:151]
    ds_read_b64_tr_b16 v[94:95], v125 offset:6400
    v_mfma_f32_16x16x32_bf16 v[172:175], v[100:103], v[20:23], v[172:175]
    ds_read_b64_tr_b16 v[96:97], v124 offset:8192
    s_waitcnt lgkmcnt(8)
    v_mfma_f32_16x16x32_bf16 v[152:155], v[16:19], v[104:107], v[152:155]
    ds_read_b64_tr_b16 v[98:99], v124 offset:8448
    v_mfma_f32_16x16x32_bf16 v[176:179], v[20:23], v[104:107], v[176:179]
    ds_read_b64_tr_b16 v[100:101], v125 offset:8192
    s_add_u32 m0, s52, 2048
    s_mov_b32 s73, 15104
    buffer_load_dwordx4 v120, s[8:11], s73 offen lds
    v_mfma_f32_16x16x32_bf16 v[156:159], v[16:19], v[108:111], v[156:159]
    ds_read_b64_tr_b16 v[102:103], v125 offset:8448
    v_mfma_f32_16x16x32_bf16 v[180:183], v[20:23], v[108:111], v[180:183]
    ds_read_b64_tr_b16 v[104:105], v124 offset:10240
    v_mfma_f32_16x16x32_bf16 v[184:187], v[112:115], v[24:27], v[184:187]
    ds_read_b64_tr_b16 v[106:107], v124 offset:10496
    v_mfma_f32_16x16x32_bf16 v[188:191], v[116:119], v[24:27], v[188:191]
    ds_read_b64_tr_b16 v[108:109], v125 offset:10240
    v_mfma_f32_16x16x32_bf16 v[48:51], v[16:19], v[16:19], v[48:51]
    ds_read_b64_tr_b16 v[110:111], v125 offset:10496
    s_add_u32 m0, s52, 3072
    s_mov_b32 s73, 15104
    buffer_load_dwordx4 v121, s[8:11], s73 offen lds
    v_mfma_f32_16x16x32_bf16 v[52:55], v[20:23], v[20:23], v[52:55]
    ds_read_b64_tr_b16 v[112:113], v126 offset:6144
    v_mfma_f32_16x16x32_bf16 v[56:59], v[24:27], v[24:27], v[56:59]
    ds_read_b64_tr_b16 v[114:115], v126 offset:6400
    v_mfma_f32_16x16x32_bf16 v[60:63], v[40:43], v[16:19], v[60:63]
    ds_read_b64_tr_b16 v[116:117], v127 offset:6144
    v_mfma_f32_16x16x32_bf16 v[64:67], v[40:43], v[20:23], v[64:67]
    ds_read_b64_tr_b16 v[118:119], v127 offset:6400
    v_mfma_f32_16x16x32_bf16 v[68:71], v[40:43], v[24:27], v[68:71]
    s_add_u32 m0, s7, 61440
    s_mov_b32 s73, 768
    s_mov_b64 exec, s[54:55]
    buffer_load_dwordx4 v122, s[8:11], s73 offen lds
    s_mov_b64 exec, -1
    s_waitcnt vmcnt(8)
    s_barrier
    s_waitcnt lgkmcnt(8)
    v_mfma_f32_16x16x32_bf16 v[136:139], v[88:91], v[28:31], v[136:139]
    ds_read_b128 v[16:19], v128 offset:18432
    v_mfma_f32_16x16x32_bf16 v[160:163], v[88:91], v[32:35], v[160:163]
    ds_read_b128 v[20:23], v128 offset:20480
    v_mfma_f32_16x16x32_bf16 v[140:143], v[92:95], v[28:31], v[140:143]
    ds_read_b128 v[24:27], v130 offset:18432
    v_mfma_f32_16x16x32_bf16 v[164:167], v[92:95], v[32:35], v[164:167]
    ds_read_b64_tr_b16 v[88:89], v124 offset:12288
    v_mfma_f32_16x16x32_bf16 v[144:147], v[96:99], v[28:31], v[144:147]
    ds_read_b64_tr_b16 v[90:91], v124 offset:12544
    v_mfma_f32_16x16x32_bf16 v[168:171], v[96:99], v[32:35], v[168:171]
    ds_read_b64_tr_b16 v[92:93], v125 offset:12288
    v_mfma_f32_16x16x32_bf16 v[148:151], v[100:103], v[28:31], v[148:151]
    ds_read_b64_tr_b16 v[94:95], v125 offset:12544
    v_mfma_f32_16x16x32_bf16 v[172:175], v[100:103], v[32:35], v[172:175]
    ds_read_b64_tr_b16 v[96:97], v124 offset:14336
    s_waitcnt lgkmcnt(8)
    v_mfma_f32_16x16x32_bf16 v[152:155], v[28:31], v[104:107], v[152:155]
    ds_read_b64_tr_b16 v[98:99], v124 offset:14592
    v_mfma_f32_16x16x32_bf16 v[176:179], v[32:35], v[104:107], v[176:179]
    ds_read_b64_tr_b16 v[100:101], v125 offset:14336
    v_mfma_f32_16x16x32_bf16 v[156:159], v[28:31], v[108:111], v[156:159]
    ds_read_b64_tr_b16 v[102:103], v125 offset:14592
    v_mfma_f32_16x16x32_bf16 v[180:183], v[32:35], v[108:111], v[180:183]
    ds_read_b64_tr_b16 v[104:105], v124 offset:16384
    v_mfma_f32_16x16x32_bf16 v[184:187], v[112:115], v[36:39], v[184:187]
    ds_read_b64_tr_b16 v[106:107], v124 offset:16640
    v_mfma_f32_16x16x32_bf16 v[188:191], v[116:119], v[36:39], v[188:191]
    ds_read_b64_tr_b16 v[108:109], v125 offset:16384
    v_mfma_f32_16x16x32_bf16 v[48:51], v[28:31], v[28:31], v[48:51]
    ds_read_b64_tr_b16 v[110:111], v125 offset:16640
    v_mfma_f32_16x16x32_bf16 v[52:55], v[32:35], v[32:35], v[52:55]
    ds_read_b64_tr_b16 v[112:113], v126 offset:12288
    v_mfma_f32_16x16x32_bf16 v[56:59], v[36:39], v[36:39], v[56:59]
    ds_read_b64_tr_b16 v[114:115], v126 offset:12544
    v_mfma_f32_16x16x32_bf16 v[60:63], v[40:43], v[28:31], v[60:63]
    ds_read_b64_tr_b16 v[116:117], v127 offset:12288
    v_mfma_f32_16x16x32_bf16 v[64:67], v[40:43], v[32:35], v[64:67]
    ds_read_b64_tr_b16 v[118:119], v127 offset:12544
    v_mfma_f32_16x16x32_bf16 v[68:71], v[40:43], v[36:39], v[68:71]
    s_waitcnt lgkmcnt(8)
    v_mfma_f32_16x16x32_bf16 v[136:139], v[88:91], v[16:19], v[136:139]
    ds_read_b128 v[28:31], v129 offset:18432
    v_mfma_f32_16x16x32_bf16 v[160:163], v[88:91], v[20:23], v[160:163]
    ds_read_b128 v[32:35], v129 offset:20480
    v_mfma_f32_16x16x32_bf16 v[140:143], v[92:95], v[16:19], v[140:143]
    ds_read_b128 v[36:39], v131 offset:18432
    v_mfma_f32_16x16x32_bf16 v[164:167], v[92:95], v[20:23], v[164:167]
    ds_read_b64_tr_b16 v[88:89], v124 offset:18432
    v_mfma_f32_16x16x32_bf16 v[144:147], v[96:99], v[16:19], v[144:147]
    ds_read_b64_tr_b16 v[90:91], v124 offset:18688
    v_mfma_f32_16x16x32_bf16 v[168:171], v[96:99], v[20:23], v[168:171]
    ds_read_b64_tr_b16 v[92:93], v125 offset:18432
    v_mfma_f32_16x16x32_bf16 v[148:151], v[100:103], v[16:19], v[148:151]
    ds_read_b64_tr_b16 v[94:95], v125 offset:18688
    v_mfma_f32_16x16x32_bf16 v[172:175], v[100:103], v[20:23], v[172:175]
    ds_read_b64_tr_b16 v[96:97], v124 offset:20480
    s_waitcnt lgkmcnt(8)
    v_mfma_f32_16x16x32_bf16 v[152:155], v[16:19], v[104:107], v[152:155]
    ds_read_b64_tr_b16 v[98:99], v124 offset:20736
    v_mfma_f32_16x16x32_bf16 v[176:179], v[20:23], v[104:107], v[176:179]
    ds_read_b64_tr_b16 v[100:101], v125 offset:20480
    v_mfma_f32_16x16x32_bf16 v[156:159], v[16:19], v[108:111], v[156:159]
    ds_read_b64_tr_b16 v[102:103], v125 offset:20736
    v_mfma_f32_16x16x32_bf16 v[180:183], v[20:23], v[108:111], v[180:183]
    ds_read_b64_tr_b16 v[104:105], v124 offset:22528
    v_mfma_f32_16x16x32_bf16 v[184:187], v[112:115], v[24:27], v[184:187]
    ds_read_b64_tr_b16 v[106:107], v124 offset:22784
    v_mfma_f32_16x16x32_bf16 v[188:191], v[116:119], v[24:27], v[188:191]
    ds_read_b64_tr_b16 v[108:109], v125 offset:22528
    v_mfma_f32_16x16x32_bf16 v[48:51], v[16:19], v[16:19], v[48:51]
    ds_read_b64_tr_b16 v[110:111], v125 offset:22784
    v_mfma_f32_16x16x32_bf16 v[52:55], v[20:23], v[20:23], v[52:55]
    ds_read_b64_tr_b16 v[112:113], v126 offset:18432
    v_mfma_f32_16x16x32_bf16 v[56:59], v[24:27], v[24:27], v[56:59]
    ds_read_b64_tr_b16 v[114:115], v126 offset:18688
    v_mfma_f32_16x16x32_bf16 v[60:63], v[40:43], v[16:19], v[60:63]
    ds_read_b64_tr_b16 v[116:117], v127 offset:18432
    v_mfma_f32_16x16x32_bf16 v[64:67], v[40:43], v[20:23], v[64:67]
    ds_read_b64_tr_b16 v[118:119], v127 offset:18688
    v_mfma_f32_16x16x32_bf16 v[68:71], v[40:43], v[24:27], v[68:71]
    s_waitcnt vmcnt(0)
    s_barrier
    s_waitcnt lgkmcnt(8)
    v_mfma_f32_16x16x32_bf16 v[136:139], v[88:91], v[28:31], v[136:139]
    ds_read_b128 v[16:19], v128 offset:0
    v_mfma_f32_16x16x32_bf16 v[160:163], v[88:91], v[32:35], v[160:163]
    ds_read_b128 v[20:23], v128 offset:2048
    v_mfma_f32_16x16x32_bf16 v[140:143], v[92:95], v[28:31], v[140:143]
    ds_read_b128 v[24:27], v130 offset:0
    v_mfma_f32_16x16x32_bf16 v[164:167], v[92:95], v[32:35], v[164:167]
    ds_read_b64_tr_b16 v[88:89], v124 offset:24576
    v_mfma_f32_16x16x32_bf16 v[144:147], v[96:99], v[28:31], v[144:147]
    ds_read_b64_tr_b16 v[90:91], v124 offset:24832
    v_mfma_f32_16x16x32_bf16 v[168:171], v[96:99], v[32:35], v[168:171]
    ds_read_b64_tr_b16 v[92:93], v125 offset:24576
    v_mfma_f32_16x16x32_bf16 v[148:151], v[100:103], v[28:31], v[148:151]
    ds_read_b64_tr_b16 v[94:95], v125 offset:24832
    v_mfma_f32_16x16x32_bf16 v[172:175], v[100:103], v[32:35], v[172:175]
    ds_read_b64_tr_b16 v[96:97], v124 offset:26624
    s_waitcnt lgkmcnt(8)
    v_mfma_f32_16x16x32_bf16 v[152:155], v[28:31], v[104:107], v[152:155]
    ds_read_b64_tr_b16 v[98:99], v124 offset:26880
    v_mfma_f32_16x16x32_bf16 v[176:179], v[32:35], v[104:107], v[176:179]
    ds_read_b64_tr_b16 v[100:101], v125 offset:26624
    v_mfma_f32_16x16x32_bf16 v[156:159], v[28:31], v[108:111], v[156:159]
    ds_read_b64_tr_b16 v[102:103], v125 offset:26880
    v_mfma_f32_16x16x32_bf16 v[180:183], v[32:35], v[108:111], v[180:183]
    ds_read_b64_tr_b16 v[104:105], v124 offset:28672
    v_mfma_f32_16x16x32_bf16 v[184:187], v[112:115], v[36:39], v[184:187]
    ds_read_b64_tr_b16 v[106:107], v124 offset:28928
    v_mfma_f32_16x16x32_bf16 v[188:191], v[116:119], v[36:39], v[188:191]
    ds_read_b64_tr_b16 v[108:109], v125 offset:28672
    v_mfma_f32_16x16x32_bf16 v[48:51], v[28:31], v[28:31], v[48:51]
    ds_read_b64_tr_b16 v[110:111], v125 offset:28928
    v_mfma_f32_16x16x32_bf16 v[52:55], v[32:35], v[32:35], v[52:55]
    ds_read_b64_tr_b16 v[112:113], v126 offset:24576
    v_mfma_f32_16x16x32_bf16 v[56:59], v[36:39], v[36:39], v[56:59]
    ds_read_b64_tr_b16 v[114:115], v126 offset:24832
    v_mfma_f32_16x16x32_bf16 v[60:63], v[40:43], v[28:31], v[60:63]
    ds_read_b64_tr_b16 v[116:117], v127 offset:24576
    v_mfma_f32_16x16x32_bf16 v[64:67], v[40:43], v[32:35], v[64:67]
    ds_read_b64_tr_b16 v[118:119], v127 offset:24832
    v_mfma_f32_16x16x32_bf16 v[68:71], v[40:43], v[36:39], v[68:71]
    v_mov_b32 v7, 0
    buffer_load_dword v6, v7, s[44:47], 0 offen sc1
    s_lshr_b32 s68, s2, 3
    s_lshl_b32 s68, s68, 2
    s_add_u32 s68, s68, s3
    v_lshlrev_b32 v219, 7, v1
    s_mul_i32 s86, s68, 3200
    s_mov_b64 exec, 0x1ffffff
    buffer_load_dword v234, v219, s[16:19], s86 offen
    s_mov_b64 exec, -1
    v_lshrrev_b32 v219, 2, v1
    v_mul_u32_u24 v219, 3584, v219
    v_and_b32 v220, 3, v1
    v_lshl_add_u32 v219, v220, 7, v219
    s_mul_i32 s68, s68, 57344
    s_and_b32 s69, s2, 7
    s_mul_i32 s86, s69, 3
    s_add_u32 s86, s86, 4
    s_lshl_b32 s87, s69, 2
    s_min_u32 s86, s86, s87
    s_lshl_b32 s86, s86, 7
    s_add_u32 s86, s86, s68
    s_cmp_lt_u32 s69, 4
    s_cselect_b32 exec_lo, -1, 0x77777777
    s_cselect_b32 exec_hi, -1, 0x77777777
    s_lshr_b32 s68, s2, 3
    s_sub_u32 s68, s68, s69
    s_and_b32 s68, s68, 7
    s_cmp_lt_u32 s68, 4
    s_cselect_b64 exec, exec, 0
    buffer_load_dword v235, v219, s[20:23], s86 offen
    s_mov_b64 exec, -1
    s_waitcnt lgkmcnt(8)
    v_mfma_f32_16x16x32_bf16 v[136:139], v[88:91], v[16:19], v[136:139]
    ds_read_b128 v[28:31], v129 offset:0
    v_mfma_f32_16x16x32_bf16 v[160:163], v[88:91], v[20:23], v[160:163]
    ds_read_b128 v[32:35], v129 offset:2048
    v_mfma_f32_16x16x32_bf16 v[140:143], v[92:95], v[16:19], v[140:143]
    ds_read_b128 v[36:39], v131 offset:0
    v_mfma_f32_16x16x32_bf16 v[164:167], v[92:95], v[20:23], v[164:167]
    ds_read_b64_tr_b16 v[88:89], v124 offset:30720
    v_mfma_f32_16x16x32_bf16 v[144:147], v[96:99], v[16:19], v[144:147]
    ds_read_b64_tr_b16 v[90:91], v124 offset:30976
    v_mfma_f32_16x16x32_bf16 v[168:171], v[96:99], v[20:23], v[168:171]
    ds_read_b64_tr_b16 v[92:93], v125 offset:30720
    v_mfma_f32_16x16x32_bf16 v[148:151], v[100:103], v[16:19], v[148:151]
    ds_read_b64_tr_b16 v[94:95], v125 offset:30976
    v_mfma_f32_16x16x32_bf16 v[172:175], v[100:103], v[20:23], v[172:175]
    ds_read_b64_tr_b16 v[96:97], v124 offset:32768
    s_waitcnt lgkmcnt(8)
    v_mfma_f32_16x16x32_bf16 v[152:155], v[16:19], v[104:107], v[152:155]
    ds_read_b64_tr_b16 v[98:99], v124 offset:33024
    v_mfma_f32_16x16x32_bf16 v[176:179], v[20:23], v[104:107], v[176:179]
    ds_read_b64_tr_b16 v[100:101], v125 offset:32768
    v_mfma_f32_16x16x32_bf16 v[156:159], v[16:19], v[108:111], v[156:159]
    ds_read_b64_tr_b16 v[102:103], v125 offset:33024
    v_mfma_f32_16x16x32_bf16 v[180:183], v[20:23], v[108:111], v[180:183]
    ds_read_b64_tr_b16 v[104:105], v124 offset:34816
    v_mfma_f32_16x16x32_bf16 v[184:187], v[112:115], v[24:27], v[184:187]
    ds_read_b64_tr_b16 v[106:107], v124 offset:35072
    v_mfma_f32_16x16x32_bf16 v[188:191], v[116:119], v[24:27], v[188:191]
    ds_read_b64_tr_b16 v[108:109], v125 offset:34816
    v_mfma_f32_16x16x32_bf16 v[48:51], v[16:19], v[16:19], v[48:51]
    ds_read_b64_tr_b16 v[110:111], v125 offset:35072
    v_mfma_f32_16x16x32_bf16 v[52:55], v[20:23], v[20:23], v[52:55]
    ds_read_b64_tr_b16 v[112:113], v126 offset:30720
    v_mfma_f32_16x16x32_bf16 v[56:59], v[24:27], v[24:27], v[56:59]
    ds_read_b64_tr_b16 v[114:115], v126 offset:30976
    v_mfma_f32_16x16x32_bf16 v[60:63], v[40:43], v[16:19], v[60:63]
    ds_read_b64_tr_b16 v[116:117], v127 offset:30720
    v_mfma_f32_16x16x32_bf16 v[64:67], v[40:43], v[20:23], v[64:67]
    ds_read_b64_tr_b16 v[118:119], v127 offset:30976
    v_mfma_f32_16x16x32_bf16 v[68:71], v[40:43], v[24:27], v[68:71]
    s_waitcnt lgkmcnt(9)
    v_mfma_f32_16x16x32_bf16 v[48:51], v[28:31], v[28:31], v[48:51]
    v_mfma_f32_16x16x32_bf16 v[52:55], v[32:35], v[32:35], v[52:55]
    v_mfma_f32_16x16x32_bf16 v[56:59], v[36:39], v[36:39], v[56:59]
    v_mfma_f32_16x16x32_bf16 v[60:63], v[40:43], v[28:31], v[60:63]
    v_mfma_f32_16x16x32_bf16 v[64:67], v[40:43], v[32:35], v[64:67]
    v_mfma_f32_16x16x32_bf16 v[68:71], v[40:43], v[36:39], v[68:71]
    s_waitcnt lgkmcnt(2)
    v_mfma_f32_16x16x32_bf16 v[184:187], v[112:115], v[36:39], v[184:187]
    s_waitcnt lgkmcnt(0)
    v_mfma_f32_16x16x32_bf16 v[188:191], v[116:119], v[36:39], v[188:191]
    v_mfma_f32_16x16x32_bf16 v[144:147], v[96:99], v[28:31], v[144:147]
    v_cndmask_b32 v48, v48, v49, s[88:89]
    v_cndmask_b32 v52, v52, v53, s[88:89]
    v_cndmask_b32 v56, v56, v57, s[88:89]
    v_mfma_f32_16x16x32_bf16 v[168:171], v[96:99], v[32:35], v[168:171]
    v_cndmask_b32 v48, v48, v50, s[90:91]
    v_cndmask_b32 v52, v52, v54, s[90:91]
    v_cndmask_b32 v56, v56, v58, s[90:91]
    v_mfma_f32_16x16x32_bf16 v[148:151], v[100:103], v[28:31], v[148:151]
    v_cndmask_b32 v48, v48, v51, s[92:93]
    v_cndmask_b32 v52, v52, v55, s[92:93]
    v_cndmask_b32 v56, v56, v59, s[92:93]
    v_mfma_f32_16x16x32_bf16 v[172:175], v[100:103], v[32:35], v[172:175]
    v_mul_f32 v133, 0x3b124925, v60
    v_mul_f32 v135, 0x3b124925, v64
    v_mul_f32 v85, 0x3b124925, v68
    v_mfma_f32_16x16x32_bf16 v[152:155], v[28:31], v[104:107], v[152:155]
    v_mul_f32 v132, v133, v133
    v_mul_f32 v134, v135, v135
    v_mul_f32_e64 v84, v85, v85
    v_mfma_f32_16x16x32_bf16 v[176:179], v[32:35], v[104:107], v[176:179]
    v_mul_f32 v48, 0x3b124925, v48
    v_mul_f32 v52, 0x3b124925, v52
    v_mul_f32 v56, 0x3b124925, v56
    v_mfma_f32_16x16x32_bf16 v[156:159], v[28:31], v[108:111], v[156:159]
    s_mov_b32 exec_lo, 0x00010001
    s_mov_b32 exec_hi, 0x00010001
    ds_write_b128 v73, v[184:187] offset:128
    ds_write_b128 v74, v[188:191] offset:0
    s_mov_b64 exec, -1
    v_sub_f32 v132, v48, v132
    v_sub_f32_e64 v134, v52, v134
    v_mfma_f32_16x16x32_bf16 v[180:183], v[32:35], v[108:111], v[180:183]
    v_sub_f32 v84, v56, v84
    v_max_f32 v132, 0, v132
    v_max_f32_e64 v134, 0, v134
    v_mfma_f32_16x16x32_bf16 v[136:139], v[88:91], v[28:31], v[136:139]
    v_max_f32_e64 v84, 0, v84
    v_add_f32 v132, 0x3727c5ac, v132
    v_add_f32 v134, 0x3727c5ac, v134
    v_mfma_f32_16x16x32_bf16 v[160:163], v[88:91], v[32:35], v[160:163]
    v_add_f32 v84, 0x3727c5ac, v84
    v_rsq_f32 v132, v132
    v_rsq_f32 v134, v134
    v_mfma_f32_16x16x32_bf16 v[140:143], v[92:95], v[28:31], v[140:143]
    v_rsq_f32_e64 v84, v84
    s_mov_b32 exec_lo, 0x00f0000f
    s_mov_b32 exec_hi, 0xf0000f00
    ds_write2_b32 v75, v132, v133 offset0:128 offset1:144
    ds_write2_b32 v75, v134, v135 offset0:160 offset1:176
    ds_write2_b32 v75, v84, v85 offset0:192 offset1:208
    s_mov_b64 exec, -1
    v_mov_b32_dpp v224, v184 row_newbcast:0 row_mask:0xf bank_mask:0xf
    v_mfma_f32_16x16x32_bf16 v[164:167], v[92:95], v[32:35], v[164:167]
    v_mov_b32_dpp v225, v185 row_newbcast:0 row_mask:0xf bank_mask:0xf
    v_mov_b32_dpp v226, v186 row_newbcast:0 row_mask:0xf bank_mask:0xf
    v_mov_b32_dpp v227, v187 row_newbcast:0 row_mask:0xf bank_mask:0xf
    v_fma_f32 v224, -v224, v85, v184
    v_fma_f32 v225, -v225, v85, v185
    v_fma_f32 v226, -v226, v85, v186
    v_fma_f32 v227, -v227, v85, v187
    s_cmp_eq_u32 s49, 15
    s_cselect_b32 s88, 0xffff0000, -1
    s_mov_b32 s89, -1
    s_mov_b32 s90, -1
    s_cselect_b32 s91, -1, 0xffff
    s_waitcnt lgkmcnt(0)
    s_barrier
    ds_read_b32 v134, v75 offset:640
    ds_read_b32 v84, v75 offset:768
    ds_read_b32 v132, v75 offset:512
    ds_read_b128 v[56:59], v72 offset:128
    ds_read_b128 v[60:63], v72 offset:192
    ds_read_b32 v64, v77 offset:256
    ds_read_b32 v65, v77 offset:320
    ds_read_b128 v[44:47], v76 offset:704
    ds_read_b128 v[40:43], v76 offset:640
    ds_read_b128 v[36:39], v76 offset:576
    ds_read_b128 v[32:35], v76 offset:512
    ds_read_b128 v[48:51], v72 offset:0
    ds_read_b128 v[52:55], v72 offset:64
    s_waitcnt lgkmcnt(9)
    v_pk_fma_f32 v[168:169], v[56:57], v[134:135], v[168:169] op_sel:[0,1,0] op_sel_hi:[1,1,1] neg_lo:[0,1,0] neg_hi:[0,1,0]
    v_pk_fma_f32 v[170:171], v[58:59], v[134:135], v[170:171] op_sel:[0,1,0] op_sel_hi:[1,1,1] neg_lo:[0,1,0] neg_hi:[0,1,0]
    v_pk_mul_f32 v[168:169], v[168:169], v[134:135] op_sel:[0,0] op_sel_hi:[1,0]
    v_pk_mul_f32 v[170:171], v[170:171], v[134:135] op_sel:[0,0] op_sel_hi:[1,0]
    v_cvt_pk_bf16_f32 v104, v168, v169
    v_cvt_pk_bf16_f32 v105, v170, v171
    s_waitcnt lgkmcnt(8)
    v_pk_fma_f32 v[172:173], v[60:61], v[134:135], v[172:173] op_sel:[0,1,0] op_sel_hi:[1,1,1] neg_lo:[0,1,0] neg_hi:[0,1,0]
    v_pk_fma_f32 v[174:175], v[62:63], v[134:135], v[174:175] op_sel:[0,1,0] op_sel_hi:[1,1,1] neg_lo:[0,1,0] neg_hi:[0,1,0]
    v_pk_mul_f32 v[172:173], v[172:173], v[134:135] op_sel:[0,0] op_sel_hi:[1,0]
    v_pk_mul_f32 v[174:175], v[174:175], v[134:135] op_sel:[0,0] op_sel_hi:[1,0]
    v_cvt_pk_bf16_f32 v106, v172, v173
    v_cvt_pk_bf16_f32 v107, v174, v175
    ds_write_b128 v78, v[104:107] offset:4096
    v_pk_mul_f32 v[224:225], v[224:225], v[84:85] op_sel_hi:[1,0]
    v_pk_mul_f32 v[226:227], v[226:227], v[84:85] op_sel_hi:[1,0]
    v_cvt_pk_bf16_f32 v224, v224, v225
    v_cvt_pk_bf16_f32 v226, v226, v227
    ds_write_b16 v80, v224 offset:2048
    ds_write_b16_d16_hi v81, v224 offset:2048
    ds_write_b16 v82, v226 offset:2048
    ds_write_b16_d16_hi v83, v226 offset:2048
    s_waitcnt lgkmcnt(10)
    v_pk_fma_f32 v[176:177], v[44:45], v[64:65], v[176:177] op_sel:[0,0,0] op_sel_hi:[1,0,1] neg_lo:[0,1,0] neg_hi:[0,1,0]
    v_pk_fma_f32 v[178:179], v[46:47], v[64:65], v[178:179] op_sel:[0,0,0] op_sel_hi:[1,0,1] neg_lo:[0,1,0] neg_hi:[0,1,0]
    s_waitcnt lgkmcnt(9)
    v_pk_mul_f32 v[176:177], v[176:177], v[40:41]
    v_pk_mul_f32 v[178:179], v[178:179], v[42:43]
    v_cvt_pk_bf16_f32 v112, v176, v177
    v_cvt_pk_bf16_f32 v113, v178, v179
    v_pk_fma_f32 v[180:181], v[44:45], v[64:65], v[180:181] op_sel:[0,1,0] op_sel_hi:[1,1,1] neg_lo:[0,1,0] neg_hi:[0,1,0]
    v_pk_fma_f32 v[182:183], v[46:47], v[64:65], v[182:183] op_sel:[0,1,0] op_sel_hi:[1,1,1] neg_lo:[0,1,0] neg_hi:[0,1,0]
    v_pk_mul_f32 v[180:181], v[180:181], v[40:41]
    v_pk_mul_f32 v[182:183], v[182:183], v[42:43]
    v_cvt_pk_bf16_f32 v118, v180, v181
    v_cvt_pk_bf16_f32 v119, v182, v183
    ds_write_b64 v78, v[112:113] offset:5120
    ds_write_b64 v78, v[118:119] offset:5128
    v_mul_f32 v68, 0x3e8b97f6, v132
    v_mul_f32 v70, 0x3e8b97f6, v134
    v_cndmask_b32 v69, 0, v68, s[90:91]
    v_cndmask_b32 v68, 0, v68, s[88:89]
    v_cndmask_b32 v71, 0, v70, s[90:91]
    v_cndmask_b32 v70, 0, v70, s[88:89]
    v_pk_fma_f32 v[144:145], v[56:57], v[132:133], v[144:145] op_sel:[0,1,0] op_sel_hi:[1,1,1] neg_lo:[0,1,0] neg_hi:[0,1,0]
    v_pk_fma_f32 v[146:147], v[58:59], v[132:133], v[146:147] op_sel:[0,1,0] op_sel_hi:[1,1,1] neg_lo:[0,1,0] neg_hi:[0,1,0]
    v_pk_mul_f32 v[144:145], v[144:145], v[132:133] op_sel:[0,0] op_sel_hi:[1,0]
    v_pk_mul_f32 v[146:147], v[146:147], v[132:133] op_sel:[0,0] op_sel_hi:[1,0]
    v_cvt_pk_bf16_f32 v100, v144, v145
    v_cvt_pk_bf16_f32 v101, v146, v147
    v_pk_fma_f32 v[148:149], v[60:61], v[132:133], v[148:149] op_sel:[0,1,0] op_sel_hi:[1,1,1] neg_lo:[0,1,0] neg_hi:[0,1,0]
    v_pk_fma_f32 v[150:151], v[62:63], v[132:133], v[150:151] op_sel:[0,1,0] op_sel_hi:[1,1,1] neg_lo:[0,1,0] neg_hi:[0,1,0]
    v_pk_mul_f32 v[148:149], v[148:149], v[132:133] op_sel:[0,0] op_sel_hi:[1,0]
    v_pk_mul_f32 v[150:151], v[150:151], v[132:133] op_sel:[0,0] op_sel_hi:[1,0]
    v_cvt_pk_bf16_f32 v102, v148, v149
    v_cvt_pk_bf16_f32 v103, v150, v151
    s_waitcnt lgkmcnt(0)
    s_barrier
    ds_read_b128 v[96:99], v78 offset:2048
    ds_read_b64 v[108:109], v78 offset:3072
    ds_read_b64 v[114:115], v78 offset:3080
    v_pk_fma_f32 v[160:161], v[48:49], v[134:135], v[160:161] op_sel:[0,1,0] op_sel_hi:[1,1,1] neg_lo:[0,1,0] neg_hi:[0,1,0]
    v_pk_fma_f32 v[162:163], v[50:51], v[134:135], v[162:163] op_sel:[0,1,0] op_sel_hi:[1,1,1] neg_lo:[0,1,0] neg_hi:[0,1,0]
    v_pk_mul_f32 v[160:161], v[160:161], v[70:71] op_sel:[0,0] op_sel_hi:[1,0]
    v_pk_mul_f32 v[162:163], v[162:163], v[70:71] op_sel:[0,0] op_sel_hi:[1,0]
    v_cvt_pk_bf16_f32 v92, v160, v161
    v_cvt_pk_bf16_f32 v93, v162, v163
    v_pk_fma_f32 v[164:165], v[52:53], v[134:135], v[164:165] op_sel:[0,1,0] op_sel_hi:[1,1,1] neg_lo:[0,1,0] neg_hi:[0,1,0]
    v_pk_fma_f32 v[166:167], v[54:55], v[134:135], v[166:167] op_sel:[0,1,0] op_sel_hi:[1,1,1] neg_lo:[0,1,0] neg_hi:[0,1,0]
    v_pk_mul_f32 v[164:165], v[164:165], v[70:71] op_sel:[0,1] op_sel_hi:[1,1]
    v_pk_mul_f32 v[166:167], v[166:167], v[70:71] op_sel:[0,1] op_sel_hi:[1,1]
    v_cvt_pk_bf16_f32 v94, v164, v165
    v_cvt_pk_bf16_f32 v95, v166, v167
    s_nop 1
    v_mfma_f32_16x16x32_bf16 v[24:27], v[100:103], v[92:95], v[240:243]
    v_mfma_f32_16x16x32_bf16 v[28:31], v[104:107], v[92:95], v[244:247]
    v_pk_fma_f32 v[136:137], v[48:49], v[132:133], v[136:137] op_sel:[0,1,0] op_sel_hi:[1,1,1] neg_lo:[0,1,0] neg_hi:[0,1,0]
    v_pk_fma_f32 v[138:139], v[50:51], v[132:133], v[138:139] op_sel:[0,1,0] op_sel_hi:[1,1,1] neg_lo:[0,1,0] neg_hi:[0,1,0]
    v_pk_mul_f32 v[136:137], v[136:137], v[68:69] op_sel:[0,0] op_sel_hi:[1,0]
    v_pk_mul_f32 v[138:139], v[138:139], v[68:69] op_sel:[0,0] op_sel_hi:[1,0]
    v_cvt_pk_bf16_f32 v88, v136, v137
    v_cvt_pk_bf16_f32 v89, v138, v139
    v_pk_fma_f32 v[140:141], v[52:53], v[132:133], v[140:141] op_sel:[0,1,0] op_sel_hi:[1,1,1] neg_lo:[0,1,0] neg_hi:[0,1,0]
    v_pk_fma_f32 v[142:143], v[54:55], v[132:133], v[142:143] op_sel:[0,1,0] op_sel_hi:[1,1,1] neg_lo:[0,1,0] neg_hi:[0,1,0]
    v_pk_mul_f32 v[140:141], v[140:141], v[68:69] op_sel:[0,1] op_sel_hi:[1,1]
    v_pk_mul_f32 v[142:143], v[142:143], v[68:69] op_sel:[0,1] op_sel_hi:[1,1]
    v_cvt_pk_bf16_f32 v90, v140, v141
    v_cvt_pk_bf16_f32 v91, v142, v143
    s_waitcnt lgkmcnt(2)
    s_nop 0
    v_mfma_f32_16x16x32_bf16 v[16:19], v[96:99], v[88:91], v[248:251]
    v_mfma_f32_16x16x32_bf16 v[20:23], v[100:103], v[88:91], v[244:247]
    v_pk_fma_f32 v[152:153], v[36:37], v[64:65], v[152:153] op_sel:[0,0,0] op_sel_hi:[1,0,1] neg_lo:[0,1,0] neg_hi:[0,1,0]
    v_pk_fma_f32 v[154:155], v[38:39], v[64:65], v[154:155] op_sel:[0,0,0] op_sel_hi:[1,0,1] neg_lo:[0,1,0] neg_hi:[0,1,0]
    v_pk_mul_f32 v[152:153], v[152:153], v[32:33]
    v_pk_mul_f32 v[154:155], v[154:155], v[34:35]
    v_cvt_pk_bf16_f32 v110, v152, v153
    v_cvt_pk_bf16_f32 v111, v154, v155
    v_pk_fma_f32 v[156:157], v[36:37], v[64:65], v[156:157] op_sel:[0,1,0] op_sel_hi:[1,1,1] neg_lo:[0,1,0] neg_hi:[0,1,0]
    v_pk_fma_f32 v[158:159], v[38:39], v[64:65], v[158:159] op_sel:[0,1,0] op_sel_hi:[1,1,1] neg_lo:[0,1,0] neg_hi:[0,1,0]
    v_pk_mul_f32 v[156:157], v[156:157], v[32:33]
    v_pk_mul_f32 v[158:159], v[158:159], v[34:35]
    v_cvt_pk_bf16_f32 v116, v156, v157
    v_cvt_pk_bf16_f32 v117, v158, v159
    v_max3_f32 v137, v24, v25, v26
    v_max3_f32 v139, v27, v28, v29
    v_max3_f32 v137, v137, v30, v31
    v_max_f32 v137, v137, v139
    v_max3_f32 v136, v16, v17, v18
    v_max3_f32 v138, v19, v20, v21
    v_max3_f32 v136, v136, v22, v23
    v_max_f32 v136, v136, v138
    v_mov_b32 v138, v136
    v_mov_b32 v139, v137
    s_nop 0
    v_permlane32_swap_b32 v136, v138
    v_permlane32_swap_b32 v137, v139
    v_max_f32 v136, v136, v138
    v_max_f32 v137, v137, v139
    v_mov_b32 v138, v136
    v_mov_b32 v139, v137
    s_nop 0
    v_permlane16_swap_b32 v136, v138
    v_permlane16_swap_b32 v137, v139
    v_max_f32 v136, v136, v138
    v_max_f32_e64 v137, v137, v139
    v_pk_add_f32 v[24:25], v[24:25], v[136:137] op_sel:[0,1] op_sel_hi:[1,1] neg_lo:[0,1] neg_hi:[0,1]
    v_pk_add_f32 v[26:27], v[26:27], v[136:137] op_sel:[0,1] op_sel_hi:[1,1] neg_lo:[0,1] neg_hi:[0,1]
    v_pk_add_f32 v[28:29], v[28:29], v[136:137] op_sel:[0,1] op_sel_hi:[1,1] neg_lo:[0,1] neg_hi:[0,1]
    v_pk_add_f32 v[30:31], v[30:31], v[136:137] op_sel:[0,1] op_sel_hi:[1,1] neg_lo:[0,1] neg_hi:[0,1]
    v_exp_f32 v24, v24
    v_exp_f32 v25, v25
    v_exp_f32 v26, v26
    v_exp_f32 v27, v27
    v_exp_f32 v28, v28
    v_exp_f32 v29, v29
    v_exp_f32_e64 v30, v30
    v_exp_f32 v31, v31
    v_cvt_pk_bf16_f32 v148, v24, v25
    v_cvt_pk_bf16_f32 v149, v26, v27
    v_cvt_pk_bf16_f32 v150, v28, v29
    v_cvt_pk_bf16_f32 v151, v30, v31
    s_nop 1
    v_mfma_f32_16x16x32_bf16 v[160:163], v[110:113], v[148:151], 0
    v_mfma_f32_16x16x32_bf16 v[164:167], v[116:119], v[148:151], 0
    v_pk_add_f32 v[16:17], v[16:17], v[136:137] op_sel:[0,0] op_sel_hi:[1,0] neg_lo:[0,1] neg_hi:[0,1]
    v_pk_add_f32 v[18:19], v[18:19], v[136:137] op_sel:[0,0] op_sel_hi:[1,0] neg_lo:[0,1] neg_hi:[0,1]
    v_pk_add_f32 v[20:21], v[20:21], v[136:137] op_sel:[0,0] op_sel_hi:[1,0] neg_lo:[0,1] neg_hi:[0,1]
    v_pk_add_f32 v[22:23], v[22:23], v[136:137] op_sel:[0,0] op_sel_hi:[1,0] neg_lo:[0,1] neg_hi:[0,1]
    v_exp_f32 v16, v16
    v_exp_f32 v17, v17
    v_exp_f32 v18, v18
    v_exp_f32 v19, v19
    v_exp_f32 v20, v20
    v_exp_f32 v21, v21
    v_exp_f32_e64 v22, v22
    v_exp_f32 v23, v23
    v_cvt_pk_bf16_f32 v144, v16, v17
    v_cvt_pk_bf16_f32 v145, v18, v19
    v_cvt_pk_bf16_f32 v146, v20, v21
    v_cvt_pk_bf16_f32 v147, v22, v23
    s_waitcnt lgkmcnt(1)
    s_nop 0
    v_mfma_f32_16x16x32_bf16 v[152:155], v[108:111], v[144:147], 0
    s_waitcnt lgkmcnt(0)
    v_mfma_f32_16x16x32_bf16 v[156:159], v[114:117], v[144:147], 0
    v_pk_add_f32 v[16:17], v[16:17], v[18:19]
    v_pk_add_f32 v[20:21], v[20:21], v[22:23]
    v_pk_add_f32 v[24:25], v[24:25], v[26:27]
    v_pk_add_f32 v[28:29], v[28:29], v[30:31]
    v_pk_add_f32 v[16:17], v[16:17], v[20:21]
    v_pk_add_f32 v[24:25], v[24:25], v[28:29]
    v_add_f32 v140, v16, v17
    v_add_f32 v142, v24, v25
    v_mov_b32 v138, v140
    v_mov_b32 v139, v142
    s_nop 0
    v_permlane32_swap_b32 v140, v138
    v_permlane32_swap_b32 v142, v139
    v_add_f32 v140, v140, v138
    v_add_f32 v142, v142, v139
    v_mov_b32 v138, v140
    v_mov_b32 v139, v142
    s_nop 0
    v_permlane16_swap_b32 v140, v138
    v_permlane16_swap_b32 v142, v139
    v_add_f32 v140, v140, v138
    v_add_f32 v142, v142, v139
    v_rcp_f32 v140, v140
    v_rcp_f32 v142, v142
    v_cndmask_b32 v141, 0, v140, s[90:91]
    v_cndmask_b32 v140, 0, v140, s[88:89]
    v_cndmask_b32 v143, 0, v142, s[90:91]
    v_cndmask_b32 v142, 0, v142, s[88:89]
    v_pk_mul_f32 v[152:153], v[152:153], v[140:141] op_sel_hi:[1,0]
    v_pk_mul_f32 v[154:155], v[154:155], v[140:141] op_sel_hi:[1,0]
    v_pk_mul_f32 v[156:157], v[156:157], v[140:141] op_sel:[0,1] op_sel_hi:[1,1]
    v_pk_mul_f32 v[158:159], v[158:159], v[140:141] op_sel:[0,1] op_sel_hi:[1,1]
    v_cvt_pk_bf16_f32 v144, v152, v153
    v_cvt_pk_bf16_f32 v145, v154, v155
    v_cvt_pk_bf16_f32 v146, v156, v157
    v_cvt_pk_bf16_f32 v147, v158, v159
    buffer_store_dwordx4 v[144:147], v4, s[40:43], s62 offen sc1
    v_pk_mul_f32 v[160:161], v[160:161], v[142:143] op_sel_hi:[1,0]
    v_pk_mul_f32 v[162:163], v[162:163], v[142:143] op_sel_hi:[1,0]
    v_pk_mul_f32 v[164:165], v[164:165], v[142:143] op_sel:[0,1] op_sel_hi:[1,1]
    v_pk_mul_f32 v[166:167], v[166:167], v[142:143] op_sel:[0,1] op_sel_hi:[1,1]
    v_cvt_pk_bf16_f32 v148, v160, v161
    v_cvt_pk_bf16_f32 v149, v162, v163
    v_cvt_pk_bf16_f32 v150, v164, v165
    v_cvt_pk_bf16_f32 v151, v166, v167
    buffer_store_dwordx4 v[148:151], v4, s[40:43], s63 offen sc1
    s_add_u32 m0, s59, 0
    s_mov_b32 s73, 0
    buffer_load_dwordx4 v208, s[16:19], s73 offen lds
    s_add_u32 m0, s59, 1024
    s_mov_b32 s73, 7168
    buffer_load_dwordx4 v208, s[16:19], s73 offen lds
    s_add_u32 m0, s59, 2048
    s_mov_b32 s73, 14336
    buffer_load_dwordx4 v208, s[16:19], s73 offen lds
    s_add_u32 m0, s59, 3072
    s_mov_b32 s73, 21504
    buffer_load_dwordx4 v208, s[16:19], s73 offen lds
    s_add_u32 m0, s59, 4096
    s_mov_b32 s73, 28672
    buffer_load_dwordx4 v208, s[16:19], s73 offen lds
    s_add_u32 m0, s59, 5120
    s_mov_b32 s73, 35840
    buffer_load_dwordx4 v208, s[16:19], s73 offen lds
    s_add_u32 m0, s59, 6144
    s_mov_b32 s73, 43008
    buffer_load_dwordx4 v208, s[16:19], s73 offen lds
    s_add_u32 m0, s59, 7168
    s_mov_b32 s73, 50176
    buffer_load_dwordx4 v208, s[16:19], s73 offen lds
    s_add_u32 m0, s59, 8192
    s_mov_b32 s73, 57344
    buffer_load_dwordx4 v208, s[16:19], s73 offen lds
    s_add_u32 m0, s59, 9216
    s_mov_b32 s73, 64512
    buffer_load_dwordx4 v208, s[16:19], s73 offen lds
    s_add_u32 m0, s59, 10240
    s_mov_b32 s73, 71680
    buffer_load_dwordx4 v208, s[16:19], s73 offen lds
    s_add_u32 m0, s59, 11264
    s_mov_b32 s73, 78848
    buffer_load_dwordx4 v208, s[16:19], s73 offen lds
    s_add_u32 m0, s59, 12288
    s_mov_b32 s73, 86016
    buffer_load_dwordx4 v208, s[16:19], s73 offen lds
    s_add_u32 m0, s59, 13312
    s_mov_b32 s73, 93184
    buffer_load_dwordx4 v208, s[16:19], s73 offen lds
    s_waitcnt vmcnt(18)
    v_readfirstlane_b32 s4, v6
    s_nop 1
    s_cmp_lg_u32 s4, 0
    s_cbranch_scc1 Lepd_P_2
    s_nop 0
Lepg_P_1:
    s_sub_u32 s6, s6, 1
    s_cbranch_scc1 L_end_P
    buffer_load_dword v6, v7, s[44:47], 0 offen sc1
    s_waitcnt vmcnt(0)
    v_readfirstlane_b32 s4, v6
    s_nop 1
    s_cmp_eq_u32 s4, 0
    s_cbranch_scc1 Lepg_P_1
Lepd_P_2:
    s_waitcnt vmcnt(14)
    v_mov_b32 v8, s4
    s_mov_b64 exec, 1
    buffer_store_dword v8, v9, s[40:43], s80 offen sc1
    s_mov_b64 exec, -1
    s_and_b32 s68, s2, 7
    s_cmp_ge_u32 s68, 7
    s_cselect_b32 s48, 7, 0
    s_sub_u32 s68, s68, s48
    s_lshl_b32 s48, s68, 12
    s_add_u32 s68, s68, 1
    s_cmp_ge_u32 s68, 7
    s_cselect_b32 s49, 7, 0
    s_sub_u32 s68, s68, s49
    s_lshl_b32 s49, s68, 12
    s_add_u32 s68, s68, 1
    s_cmp_ge_u32 s68, 7
    s_cselect_b32 s50, 7, 0
    s_sub_u32 s68, s68, s50
    s_lshl_b32 s50, s68, 12
    s_add_u32 s68, s68, 1
    s_cmp_ge_u32 s68, 7
    s_cselect_b32 s51, 7, 0
    s_sub_u32 s68, s68, s51
    s_lshl_b32 s51, s68, 12
    s_add_u32 s68, s68, 1
    s_cmp_ge_u32 s68, 7
    s_cselect_b32 s52, 7, 0
    s_sub_u32 s68, s68, s52
    s_lshl_b32 s52, s68, 12
    s_add_u32 s68, s68, 1
    s_cmp_ge_u32 s68, 7
    s_cselect_b32 s53, 7, 0
    s_sub_u32 s68, s68, s53
    s_lshl_b32 s53, s68, 12
    s_add_u32 s68, s68, 1
    s_cmp_ge_u32 s68, 7
    s_cselect_b32 s54, 7, 0
    s_sub_u32 s68, s68, s54
    s_lshl_b32 s54, s68, 12
    s_cmp_lt_u32 s67, 99
    s_cbranch_scc1 Lnotag_P_3
    s_lshr_b32 s68, s2, 3
    s_sub_u32 s68, s68, 28
    s_mul_i32 s68, s68, 1835008
    s_mul_i32 s69, s3, 57344
    s_add_u32 s68, s68, s69
    s_and_b32 s69, s2, 7
    s_mul_i32 s86, s69, 3
    s_add_u32 s86, s86, 4
    s_lshl_b32 s87, s69, 2
    s_min_u32 s86, s86, s87
    s_lshl_b32 s86, s86, 7
    s_add_u32 s68, s68, s86
    v_lshrrev_b32 v16, 2, v1
    v_mul_u32_u24 v16, 3584, v16
    v_and_b32_e64 v17, 3, v1
    v_lshl_add_u32 v16, v17, 7, v16
    s_mul_i32 s86, s98, 56
    s_add_u32 s86, s86, s68
    buffer_load_dword v30, v16, s[20:23], s86 offen
    s_mul_i32 s86, s99, 56
    s_add_u32 s86, s86, s68
    buffer_load_dword v31, v16, s[20:23], s86 offen
    s_mul_i32 s86, s100, 56
    s_add_u32 s86, s86, s68
    buffer_load_dword v32, v16, s[20:23], s86 offen
    s_mul_i32 s86, s101, 56
    s_add_u32 s86, s86, s68
    buffer_load_dword v33, v16, s[20:23], s86 offen
    s_lshr_b32 s68, s2, 3
    s_sub_u32 s68, s68, 28
    s_mul_i32 s68, s68, 28
    s_add_u32 s68, s68, s3
    s_lshl_b32 s68, s68, 16
    s_and_b32 s69, s2, 7
    s_lshl_b32 s69, s69, 9
    s_add_u32 s68, s68, s69
    v_lshrrev_b32 v16, 2, v1
    v_lshlrev_b32 v16, 12, v16
    v_and_b32_e64 v17, 3, v1
    v_lshl_add_u32 v16, v17, 7, v16
    s_lshl_b32 s86, s48, 6
    s_add_u32 s86, s86, s68
    buffer_load_dword v18, v16, s[24:27], s86 offen
    s_waitcnt vmcnt(1)
    s_lshl_b32 s86, s49, 6
    s_add_u32 s86, s86, s68
    buffer_load_dword v19, v16, s[24:27], s86 offen
    s_waitcnt vmcnt(1)
    s_lshl_b32 s86, s50, 6
    s_add_u32 s86, s86, s68
    buffer_load_dword v20, v16, s[24:27], s86 offen
    s_waitcnt vmcnt(1)
    s_lshl_b32 s86, s51, 6
    s_add_u32 s86, s86, s68
    buffer_load_dword v21, v16, s[24:27], s86 offen
    s_waitcnt vmcnt(1)
    s_lshl_b32 s86, s52, 6
    s_add_u32 s86, s86, s68
    buffer_load_dword v22, v16, s[24:27], s86 offen
    s_waitcnt vmcnt(1)
    s_lshl_b32 s86, s53, 6
    s_add_u32 s86, s86, s68
    buffer_load_dword v23, v16, s[24:27], s86 offen
    s_waitcnt vmcnt(1)
    s_lshl_b32 s86, s54, 6
    s_add_u32 s86, s86, s68
    buffer_load_dword v24, v16, s[24:27], s86 offen
    s_waitcnt vmcnt(1)
    s_waitcnt vmcnt(0)
    s_branch L_end_P
Lnotag_P_3:
    v_lshrrev_b32 v221, 5, v1
    v_mul_u32_u24 v221, 3584, v221
    v_and_b32 v222, 31, v1
    v_lshl_add_u32 v221, v222, 1, v221
    s_lshl_b32 s58, s67, 1
    s_lshr_b32 s60, s3, 1
    s_add_u32 s58, s58, s60
    s_mul_i32 s58, s58, 28672
    s_lshl_b32 s60, s66, 7
    s_add_u32 s58, s58, s60
    s_and_b32 s60, s3, 1
    s_lshl_b32 s60, s60, 6
    s_add_u32 s58, s58, s60
    buffer_load_ushort v192, v221, s[8:11], s58 offen offset:0
    buffer_load_ushort v193, v221, s[8:11], s58 offen offset:896
    buffer_load_ushort v194, v221, s[8:11], s58 offen offset:1792
    buffer_load_ushort v195, v221, s[8:11], s58 offen offset:2688
    s_add_u32 s58, s58, 7168
    buffer_load_ushort v196, v221, s[8:11], s58 offen offset:0
    buffer_load_ushort v197, v221, s[8:11], s58 offen offset:896
    buffer_load_ushort v198, v221, s[8:11], s58 offen offset:1792
    buffer_load_ushort v199, v221, s[8:11], s58 offen offset:2688
    s_add_u32 s58, s58, 7168
    buffer_load_ushort v200, v221, s[8:11], s58 offen offset:0
    buffer_load_ushort v201, v221, s[8:11], s58 offen offset:896
    buffer_load_ushort v202, v221, s[8:11], s58 offen offset:1792
    buffer_load_ushort v203, v221, s[8:11], s58 offen offset:2688
    s_add_u32 s58, s58, 7168
    buffer_load_ushort v204, v221, s[8:11], s58 offen offset:0
    buffer_load_ushort v205, v221, s[8:11], s58 offen offset:896
    buffer_load_ushort v206, v221, s[8:11], s58 offen offset:1792
    buffer_load_ushort v207, v221, s[8:11], s58 offen offset:2688
    s_add_u32 m0, s70, 16384
    s_mul_i32 s73, s94, 56
    s_add_u32 s73, s73, 0
    buffer_load_dwordx4 v213, s[20:23], s73 offen lds
    s_add_u32 m0, s70, 17408
    s_mul_i32 s73, s94, 56
    s_add_u32 s73, s73, 28672
    buffer_load_dwordx4 v213, s[20:23], s73 offen lds
    s_add_u32 m0, s70, 18432
    s_mul_i32 s73, s94, 56
    s_add_u32 s73, s73, 57344
    buffer_load_dwordx4 v213, s[20:23], s73 offen lds
    s_add_u32 m0, s70, 19456
    s_mul_i32 s73, s94, 56
    s_add_u32 s73, s73, 86016
    buffer_load_dwordx4 v213, s[20:23], s73 offen lds
    s_add_u32 m0, s70, 20480
    s_mul_i32 s73, s94, 56
    s_add_u32 s73, s73, 114688
    buffer_load_dwordx4 v213, s[20:23], s73 offen lds
    s_add_u32 m0, s70, 21504
    s_mul_i32 s73, s94, 56
    s_add_u32 s73, s73, 143360
    buffer_load_dwordx4 v213, s[20:23], s73 offen lds
    s_add_u32 m0, s70, 22528
    s_mul_i32 s73, s94, 56
    s_add_u32 s73, s73, 172032
    buffer_load_dwordx4 v213, s[20:23], s73 offen lds
    s_add_u32 m0, s70, 23552
    s_mul_i32 s73, s94, 56
    s_add_u32 s73, s73, 200704
    buffer_load_dwordx4 v213, s[20:23], s73 offen lds
    s_waitcnt vmcnt(25)
    s_barrier
    ds_read_b64_tr_b16 a[0:1], v209 offset:0
    ds_read_b64_tr_b16 a[2:3], v209 offset:2048
    s_add_u32 m0, s70, 24576
    s_mul_i32 s73, s95, 56
    s_add_u32 s73, s73, 0
    buffer_load_dwordx4 v213, s[20:23], s73 offen lds
    ds_read_b64_tr_b16 a[4:5], v209 offset:1024
    ds_read_b64_tr_b16 a[6:7], v209 offset:3072
    s_add_u32 m0, s70, 25600
    s_mul_i32 s73, s95, 56
    s_add_u32 s73, s73, 28672
    buffer_load_dwordx4 v213, s[20:23], s73 offen lds
    ds_read_b64_tr_b16 a[8:9], v209 offset:3584
    ds_read_b64_tr_b16 a[10:11], v209 offset:5632
    ds_read_b64_tr_b16 a[12:13], v209 offset:4608
    ds_read_b64_tr_b16 a[14:15], v209 offset:6656
    s_add_u32 m0, s70, 26624
    s_mul_i32 s73, s95, 56
    s_add_u32 s73, s73, 57344
    buffer_load_dwordx4 v213, s[20:23], s73 offen lds
    ds_read_b64_tr_b16 a[16:17], v209 offset:7168
    ds_read_b64_tr_b16 a[18:19], v209 offset:9216
    s_add_u32 m0, s70, 27648
    s_mul_i32 s73, s95, 56
    s_add_u32 s73, s73, 86016
    buffer_load_dwordx4 v213, s[20:23], s73 offen lds
    ds_read_b64_tr_b16 a[20:21], v209 offset:8192
    ds_read_b64_tr_b16 a[22:23], v209 offset:10240
    ds_read_b64_tr_b16 a[24:25], v209 offset:10752
    ds_read_b64_tr_b16 a[26:27], v209 offset:12800
    s_add_u32 m0, s70, 28672
    s_mul_i32 s73, s95, 56
    s_add_u32 s73, s73, 114688
    buffer_load_dwordx4 v213, s[20:23], s73 offen lds
    ds_read_b64_tr_b16 a[28:29], v209 offset:11776
    ds_read_b64_tr_b16 a[30:31], v210 offset:13824
    s_add_u32 m0, s70, 29696
    s_mul_i32 s73, s95, 56
    s_add_u32 s73, s73, 143360
    buffer_load_dwordx4 v213, s[20:23], s73 offen lds
    ds_read_b64_tr_b16 a[32:33], v209 offset:36864
    ds_read_b64_tr_b16 a[34:35], v209 offset:38912
    ds_read_b64_tr_b16 a[36:37], v209 offset:37888
    ds_read_b64_tr_b16 a[38:39], v209 offset:39936
    s_add_u32 m0, s70, 30720
    s_mul_i32 s73, s95, 56
    s_add_u32 s73, s73, 172032
    buffer_load_dwordx4 v213, s[20:23], s73 offen lds
    ds_read_b64_tr_b16 a[40:41], v209 offset:40448
    ds_read_b64_tr_b16 a[42:43], v209 offset:42496
    s_add_u32 m0, s70, 31744
    s_mul_i32 s73, s95, 56
    s_add_u32 s73, s73, 200704
    buffer_load_dwordx4 v213, s[20:23], s73 offen lds
    ds_read_b64_tr_b16 a[44:45], v209 offset:41472
    ds_read_b64_tr_b16 a[46:47], v209 offset:43520
    ds_read_b64_tr_b16 a[48:49], v209 offset:44032
    ds_read_b64_tr_b16 a[50:51], v209 offset:46080
    s_add_u32 m0, s70, 32768
    s_mul_i32 s73, s96, 56
    s_add_u32 s73, s73, 0
    buffer_load_dwordx4 v213, s[20:23], s73 offen lds
    ds_read_b64_tr_b16 a[52:53], v209 offset:45056
    ds_read_b64_tr_b16 a[54:55], v209 offset:47104
    s_add_u32 m0, s70, 33792
    s_mul_i32 s73, s96, 56
    s_add_u32 s73, s73, 28672
    buffer_load_dwordx4 v213, s[20:23], s73 offen lds
    ds_read_b64_tr_b16 a[56:57], v209 offset:47616
    ds_read_b64_tr_b16 a[58:59], v209 offset:49664
    ds_read_b64_tr_b16 a[60:61], v209 offset:48640
    ds_read_b64_tr_b16 a[62:63], v210 offset:50688
    s_add_u32 m0, s70, 34816
    s_mul_i32 s73, s96, 56
    s_add_u32 s73, s73, 57344
    buffer_load_dwordx4 v213, s[20:23], s73 offen lds
    v_add_u32 v209, 73728, v209
    v_add_u32 v210, 73728, v210
    ds_read_b64_tr_b16 a[64:65], v209 offset:0
    ds_read_b64_tr_b16 a[66:67], v209 offset:2048
    s_add_u32 m0, s70, 35840
    s_mul_i32 s73, s96, 56
    s_add_u32 s73, s73, 86016
    buffer_load_dwordx4 v213, s[20:23], s73 offen lds
    ds_read_b64_tr_b16 a[68:69], v209 offset:1024
    ds_read_b64_tr_b16 a[70:71], v209 offset:3072
    ds_read_b64_tr_b16 a[72:73], v209 offset:3584
    ds_read_b64_tr_b16 a[74:75], v209 offset:5632
    ds_read_b64_tr_b16 a[76:77], v209 offset:4608
    ds_read_b64_tr_b16 a[78:79], v209 offset:6656
    ds_read_b64_tr_b16 a[80:81], v209 offset:7168
    ds_read_b64_tr_b16 a[82:83], v209 offset:9216
    ds_read_b64_tr_b16 a[84:85], v209 offset:8192
    ds_read_b64_tr_b16 a[86:87], v209 offset:10240
    ds_read_b64_tr_b16 a[88:89], v209 offset:10752
    ds_read_b64_tr_b16 a[90:91], v209 offset:12800
    ds_read_b64_tr_b16 a[92:93], v209 offset:11776
    ds_read_b64_tr_b16 a[94:95], v210 offset:13824
    ds_read_b64_tr_b16 a[96:97], v209 offset:36864
    ds_read_b64_tr_b16 a[98:99], v209 offset:38912
    ds_read_b64_tr_b16 a[100:101], v209 offset:37888
    ds_read_b64_tr_b16 a[102:103], v209 offset:39936
    ds_read_b64_tr_b16 a[104:105], v209 offset:40448
    ds_read_b64_tr_b16 a[106:107], v209 offset:42496
    ds_read_b64_tr_b16 a[108:109], v209 offset:41472
    ds_read_b64_tr_b16 a[110:111], v209 offset:43520
    ds_read_b64_tr_b16 a[112:113], v209 offset:44032
    ds_read_b64_tr_b16 a[114:115], v209 offset:46080
    ds_read_b64_tr_b16 a[116:117], v209 offset:45056
    ds_read_b64_tr_b16 a[118:119], v209 offset:47104
    ds_read_b64_tr_b16 a[120:121], v209 offset:47104
    ds_read_b64_tr_b16 a[122:123], v209 offset:49152
    ds_read_b64_tr_b16 a[124:125], v209 offset:48128
    ds_read_b64_tr_b16 a[126:127], v209 offset:50176
    s_waitcnt lgkmcnt(0)
    s_barrier
    buffer_load_dword v249, v10, s[40:43], s83 offen sc1
    s_sleep 3
    buffer_load_dword v250, v10, s[40:43], s83 offen sc1
    s_sleep 3
    s_nop 0
Lpoll_P_4:
    s_sub_u32 s6, s6, 1
    s_cbranch_scc1 L_end_P
    buffer_load_dword v251, v10, s[40:43], s83 offen sc1
    s_waitcnt vmcnt(2)
    v_cmp_ne_u32_e64 vcc, s4, v249
    s_nop 1
    s_cbranch_vccz Lpd_P_5
    buffer_load_dword v249, v10, s[40:43], s83 offen sc1
    s_waitcnt vmcnt(2)
    v_cmp_ne_u32 vcc, s4, v250
    s_nop 1
    s_cbranch_vccz Lpd_P_5
    buffer_load_dword v250, v10, s[40:43], s83 offen sc1
    s_waitcnt vmcnt(2)
    v_cmp_ne_u32 vcc, s4, v251
    s_nop 1
    s_cbranch_vccnz Lpoll_P_4
    s_nop 1
Lpd_P_5:
    s_lshl_b32 s58, s67, 16
    s_lshl_b32 s60, s3, 14
    s_add_u32 s58, s58, s60
    s_add_u32 m0, s70, 0
    s_nop 0
    buffer_load_dwordx4 v4, s[40:43], s58 offen offset:0 sc1 lds
    buffer_load_dwordx4 v4, s[40:43], s58 offen offset:1024 sc1 lds
    buffer_load_dwordx4 v4, s[40:43], s58 offen offset:2048 sc1 lds
    buffer_load_dwordx4 v4, s[40:43], s58 offen offset:3072 sc1 lds
    s_add_u32 m0, s70, 4096
    s_add_u32 s58, s58, 4096
    buffer_load_dwordx4 v4, s[40:43], s58 offen offset:0 sc1 lds
    buffer_load_dwordx4 v4, s[40:43], s58 offen offset:1024 sc1 lds
    buffer_load_dwordx4 v4, s[40:43], s58 offen offset:2048 sc1 lds
    buffer_load_dwordx4 v4, s[40:43], s58 offen offset:3072 sc1 lds
    s_add_u32 m0, s70, 8192
    s_add_u32 s58, s58, 4096
    buffer_load_dwordx4 v4, s[40:43], s58 offen offset:0 sc1 lds
    buffer_load_dwordx4 v4, s[40:43], s58 offen offset:1024 sc1 lds
    buffer_load_dwordx4 v4, s[40:43], s58 offen offset:2048 sc1 lds
    buffer_load_dwordx4 v4, s[40:43], s58 offen offset:3072 sc1 lds
    s_add_u32 m0, s70, 12288
    s_add_u32 s58, s58, 4096
    buffer_load_dwordx4 v4, s[40:43], s58 offen offset:0 sc1 lds
    buffer_load_dwordx4 v4, s[40:43], s58 offen offset:1024 sc1 lds
    buffer_load_dwordx4 v4, s[40:43], s58 offen offset:2048 sc1 lds
    buffer_load_dwordx4 v4, s[40:43], s58 offen offset:3072 sc1 lds
    v_and_b32_e64 v64, 1, v3
    v_mul_u32_u24 v64, 36864, v64
    v_lshl_add_u32 v64, v2, 4, v64
    v_lshrrev_b32 v65, 5, v1
    v_lshl_add_u32 v64, v65, 8, v64
    s_lshr_b32 s60, s3, 1
    s_mul_i32 s60, s60, 73728
    s_add_u32 s60, s60, 12288
    v_add_u32_e64 v64, s60, v64
    ds_read_b64_tr_b16 a[128:129], v215 offset:16384
    ds_read_b64_tr_b16 a[130:131], v215 offset:17408
    ds_read_b64_tr_b16 a[132:133], v216 offset:16384
    ds_read_b64_tr_b16 a[134:135], v216 offset:17408
    ds_read_b64_tr_b16 a[136:137], v215 offset:18432
    ds_read_b64_tr_b16 a[138:139], v215 offset:19456
    ds_read_b64_tr_b16 a[140:141], v216 offset:18432
    ds_read_b64_tr_b16 a[142:143], v216 offset:19456
    ds_read_b64_tr_b16 a[144:145], v215 offset:20480
    ds_read_b64_tr_b16 a[146:147], v215 offset:21504
    ds_read_b64_tr_b16 a[148:149], v216 offset:20480
    ds_read_b64_tr_b16 a[150:151], v216 offset:21504
    ds_read_b64_tr_b16 a[152:153], v215 offset:22528
    ds_read_b64_tr_b16 a[154:155], v215 offset:23552
    ds_read_b64_tr_b16 a[156:157], v216 offset:22528
    ds_read_b64_tr_b16 a[158:159], v216 offset:23552
    ds_read_b64_tr_b16 a[160:161], v215 offset:24576
    ds_read_b64_tr_b16 a[162:163], v215 offset:25600
    ds_read_b64_tr_b16 a[164:165], v216 offset:24576
    ds_read_b64_tr_b16 a[166:167], v216 offset:25600
    ds_read_b64_tr_b16 a[168:169], v215 offset:26624
    ds_read_b64_tr_b16 a[170:171], v215 offset:27648
    ds_read_b64_tr_b16 a[172:173], v216 offset:26624
    ds_read_b64_tr_b16 a[174:175], v216 offset:27648
    ds_read_b64_tr_b16 a[176:177], v215 offset:28672
    ds_read_b64_tr_b16 a[178:179], v215 offset:29696
    ds_read_b64_tr_b16 a[180:181], v216 offset:28672
    ds_read_b64_tr_b16 a[182:183], v216 offset:29696
    ds_read_b64_tr_b16 a[184:185], v215 offset:30720
    ds_read_b64_tr_b16 a[186:187], v215 offset:31744
    ds_read_b64_tr_b16 a[188:189], v216 offset:30720
    ds_read_b64_tr_b16 a[190:191], v216 offset:31744
    ds_read_b64_tr_b16 a[192:193], v215 offset:32768
    ds_read_b64_tr_b16 a[194:195], v215 offset:33792
    ds_read_b64_tr_b16 a[196:197], v216 offset:32768
    ds_read_b64_tr_b16 a[198:199], v216 offset:33792
    ds_read_b64_tr_b16 a[200:201], v215 offset:34816
    ds_read_b64_tr_b16 a[202:203], v215 offset:35840
    ds_read_b64_tr_b16 a[204:205], v216 offset:34816
    ds_read_b64_tr_b16 a[206:207], v216 offset:35840
    v_lshlrev_b32 v192, 16, v192
    v_lshlrev_b32 v193, 16, v193
    v_lshlrev_b32 v194, 16, v194
    v_lshlrev_b32 v195, 16, v195
    v_lshlrev_b32 v196, 16, v196
    v_lshlrev_b32 v197, 16, v197
    v_lshlrev_b32 v198, 16, v198
    v_lshlrev_b32 v199, 16, v199
    v_lshlrev_b32 v200, 16, v200
    v_lshlrev_b32 v201, 16, v201
    v_lshlrev_b32 v202, 16, v202
    v_lshlrev_b32 v203, 16, v203
    v_lshlrev_b32 v204, 16, v204
    v_lshlrev_b32 v205, 16, v205
    v_lshlrev_b32_e64 v206, 16, v206
    v_lshlrev_b32 v207, 16, v207
    s_waitcnt vmcnt(8)
    s_barrier
    ds_read_b128 v[32:35], v64 offset:0
    ds_read_b128 v[36:39], v64 offset:512
    ds_read_b128 v[40:43], v64 offset:1024
    ds_read_b128 v[44:47], v64 offset:1536
    ds_read_b128 v[48:51], v64 offset:2048
    ds_read_b128 v[52:55], v64 offset:2560
    s_waitcnt lgkmcnt(5)
    v_mfma_f32_32x32x16_bf16 v[192:207], v[32:35], a[0:3], v[192:207]
    ds_read_b128 v[56:59], v64 offset:3072
    s_add_u32 m0, s70, 16384
    s_mul_i32 s73, s96, 56
    s_add_u32 s73, s73, 114688
    buffer_load_dwordx4 v213, s[20:23], s73 offen lds
    s_waitcnt lgkmcnt(5)
    v_mfma_f32_32x32x16_bf16 v[192:207], v[36:39], a[4:7], v[192:207]
    ds_read_b128 v[60:63], v64 offset:3584
    s_waitcnt lgkmcnt(5)
    v_mfma_f32_32x32x16_bf16 v[192:207], v[40:43], a[8:11], v[192:207]
    ds_read_b128 v[32:35], v64 offset:4096
    s_waitcnt lgkmcnt(5)
    v_mfma_f32_32x32x16_bf16 v[192:207], v[44:47], a[12:15], v[192:207]
    ds_read_b128 v[36:39], v64 offset:4608
    s_add_u32 m0, s70, 17408
    s_mul_i32 s73, s96, 56
    s_add_u32 s73, s73, 143360
    buffer_load_dwordx4 v213, s[20:23], s73 offen lds
    s_waitcnt lgkmcnt(5)
    v_mfma_f32_32x32x16_bf16 v[192:207], v[48:51], a[16:19], v[192:207]
    ds_read_b128 v[40:43], v64 offset:5120
    s_waitcnt lgkmcnt(5)
    v_mfma_f32_32x32x16_bf16 v[192:207], v[52:55], a[20:23], v[192:207]
    ds_read_b128 v[44:47], v64 offset:5632
    s_waitcnt lgkmcnt(5)
    v_mfma_f32_32x32x16_bf16 v[192:207], v[56:59], a[24:27], v[192:207]
    ds_read_b128 v[48:51], v64 offset:6144
    s_add_u32 m0, s70, 18432
    s_mul_i32 s73, s96, 56
    s_add_u32 s73, s73, 172032
    buffer_load_dwordx4 v213, s[20:23], s73 offen lds
    s_waitcnt lgkmcnt(5)
    v_mfma_f32_32x32x16_bf16 v[192:207], v[60:63], a[28:31], v[192:207]
    ds_read_b128 v[52:55], v64 offset:6656
    s_waitcnt lgkmcnt(5)
    v_mfma_f32_32x32x16_bf16 v[192:207], v[32:35], a[32:35], v[192:207]
    ds_read_b128 v[56:59], v64 offset:7168
    s_waitcnt lgkmcnt(5)
    v_mfma_f32_32x32x16_bf16 v[192:207], v[36:39], a[36:39], v[192:207]
    ds_read_b128 v[60:63], v64 offset:7680
    s_add_u32 m0, s70, 19456
    s_mul_i32 s73, s96, 56
    s_add_u32 s73, s73, 200704
    buffer_load_dwordx4 v213, s[20:23], s73 offen lds
    s_waitcnt lgkmcnt(5)
    v_mfma_f32_32x32x16_bf16 v[192:207], v[40:43], a[40:43], v[192:207]
    s_waitcnt lgkmcnt(4)
    v_mfma_f32_32x32x16_bf16 v[192:207], v[44:47], a[44:47], v[192:207]
    s_waitcnt vmcnt(4)
    s_barrier
    ds_read_b128 v[32:35], v64 offset:8192
    ds_read_b128 v[36:39], v64 offset:8704
    s_waitcnt lgkmcnt(5)
    v_mfma_f32_32x32x16_bf16 v[192:207], v[48:51], a[48:51], v[192:207]
    ds_read_b128 v[40:43], v64 offset:9216
    s_add_u32 m0, s70, 20480
    s_mul_i32 s73, s97, 56
    s_add_u32 s73, s73, 0
    buffer_load_dwordx4 v213, s[20:23], s73 offen lds
    s_waitcnt lgkmcnt(5)
    v_mfma_f32_32x32x16_bf16 v[192:207], v[52:55], a[52:55], v[192:207]
    ds_read_b128 v[44:47], v64 offset:9728
    s_waitcnt lgkmcnt(5)
    v_mfma_f32_32x32x16_bf16 v[192:207], v[56:59], a[56:59], v[192:207]
    ds_read_b128 v[48:51], v64 offset:10240
    s_waitcnt lgkmcnt(5)
    v_mfma_f32_32x32x16_bf16 v[192:207], v[60:63], a[60:63], v[192:207]
    ds_read_b128 v[52:55], v64 offset:10752
    s_add_u32 m0, s70, 21504
    s_mul_i32 s73, s97, 56
    s_add_u32 s73, s73, 28672
    buffer_load_dwordx4 v213, s[20:23], s73 offen lds
    s_waitcnt lgkmcnt(5)
    v_mfma_f32_32x32x16_bf16 v[192:207], v[32:35], a[64:67], v[192:207]
    ds_read_b128 v[56:59], v64 offset:11264
    s_waitcnt lgkmcnt(5)
    v_mfma_f32_32x32x16_bf16 v[192:207], v[36:39], a[68:71], v[192:207]
    ds_read_b128 v[60:63], v64 offset:11776
    s_waitcnt lgkmcnt(5)
    v_mfma_f32_32x32x16_bf16 v[192:207], v[40:43], a[72:75], v[192:207]
    ds_read_b128 v[32:35], v64 offset:12288
    s_add_u32 m0, s70, 22528
    s_mul_i32 s73, s97, 56
    s_add_u32 s73, s73, 57344
    buffer_load_dwordx4 v213, s[20:23], s73 offen lds
    s_waitcnt lgkmcnt(5)
    v_mfma_f32_32x32x16_bf16 v[192:207], v[44:47], a[76:79], v[192:207]
    ds_read_b128 v[36:39], v64 offset:12800
    s_waitcnt lgkmcnt(5)
    v_mfma_f32_32x32x16_bf16 v[192:207], v[48:51], a[80:83], v[192:207]
    ds_read_b128 v[40:43], v64 offset:13312
    s_waitcnt lgkmcnt(5)
    v_mfma_f32_32x32x16_bf16 v[192:207], v[52:55], a[84:87], v[192:207]
    ds_read_b128 v[44:47], v64 offset:13824
    s_add_u32 m0, s70, 23552
    s_mul_i32 s73, s97, 56
    s_add_u32 s73, s73, 86016
    buffer_load_dwordx4 v213, s[20:23], s73 offen lds
    s_waitcnt lgkmcnt(5)
    v_mfma_f32_32x32x16_bf16 v[192:207], v[56:59], a[88:91], v[192:207]
    ds_read_b128 v[48:51], v64 offset:14336
    s_waitcnt lgkmcnt(5)
    v_mfma_f32_32x32x16_bf16 v[192:207], v[60:63], a[92:95], v[192:207]
    ds_read_b128 v[52:55], v64 offset:14848
    s_waitcnt lgkmcnt(5)
    v_mfma_f32_32x32x16_bf16 v[192:207], v[32:35], a[96:99], v[192:207]
    ds_read_b128 v[56:59], v64 offset:15360
    s_add_u32 m0, s70, 24576
    s_mul_i32 s73, s97, 56
    s_add_u32 s73, s73, 114688
    buffer_load_dwordx4 v213, s[20:23], s73 offen lds
    s_waitcnt lgkmcnt(5)
    v_mfma_f32_32x32x16_bf16 v[192:207], v[36:39], a[100:103], v[192:207]
    ds_read_b128 v[60:63], v64 offset:15872
    s_waitcnt lgkmcnt(5)
    v_mfma_f32_32x32x16_bf16 v[192:207], v[40:43], a[104:107], v[192:207]
    s_waitcnt lgkmcnt(4)
    v_mfma_f32_32x32x16_bf16 v[192:207], v[44:47], a[108:111], v[192:207]
    s_add_u32 m0, s70, 25600
    s_mul_i32 s73, s97, 56
    s_add_u32 s73, s73, 143360
    buffer_load_dwordx4 v213, s[20:23], s73 offen lds
    s_waitcnt lgkmcnt(3)
    v_mfma_f32_32x32x16_bf16 v[192:207], v[48:51], a[112:115], v[192:207]
    s_waitcnt lgkmcnt(2)
    v_mfma_f32_32x32x16_bf16 v[192:207], v[52:55], a[116:119], v[192:207]
    s_waitcnt lgkmcnt(1)
    v_mfma_f32_32x32x16_bf16 v[192:207], v[56:59], a[120:123], v[192:207]
    s_add_u32 m0, s70, 26624
    s_mul_i32 s73, s97, 56
    s_add_u32 s73, s73, 172032
    buffer_load_dwordx4 v213, s[20:23], s73 offen lds
    s_waitcnt lgkmcnt(0)
    v_mfma_f32_32x32x16_bf16 v[192:207], v[60:63], a[124:127], v[192:207]
    s_nop 11
    v_pk_mul_f32 v[68:69], v[192:193], v[192:193]
    v_pk_mul_f32 v[70:71], v[194:195], v[194:195]
    v_pk_mul_f32 v[72:73], v[196:197], v[196:197]
    v_pk_mul_f32 v[74:75], v[198:199], v[198:199]
    v_pk_mul_f32 v[76:77], v[200:201], v[200:201]
    v_pk_mul_f32 v[78:79], v[202:203], v[202:203]
    v_pk_mul_f32 v[80:81], v[204:205], v[204:205]
    v_pk_mul_f32 v[82:83], v[206:207], v[206:207]
    s_add_u32 m0, s70, 27648
    s_mul_i32 s73, s97, 56
    s_add_u32 s73, s73, 200704
    buffer_load_dwordx4 v213, s[20:23], s73 offen lds
    v_add_f32_dpp v84, v192, v192 row_mirror row_mask:0xf bank_mask:0x3
    v_add_f32_dpp v85, v193, v193 row_mirror row_mask:0xf bank_mask:0x3
    v_add_f32_dpp v86, v196, v196 row_mirror row_mask:0xf bank_mask:0x3
    v_add_f32_dpp v87, v197, v197 row_mirror row_mask:0xf bank_mask:0x3
    v_add_f32_dpp v88, v200, v200 row_mirror row_mask:0xf bank_mask:0x3
    v_add_f32_dpp v89, v201, v201 row_mirror row_mask:0xf bank_mask:0x3
    v_add_f32_dpp v90, v204, v204 row_mirror row_mask:0xf bank_mask:0x3
    v_add_f32_dpp v91, v205, v205 row_mirror row_mask:0xf bank_mask:0x3
    s_add_u32 m0, s70, 28672
    s_mul_i32 s73, s98, 56
    s_add_u32 s73, s73, 0
    buffer_load_dwordx4 v213, s[20:23], s73 offen lds
    v_add_f32_dpp v92, v68, v68 row_mirror row_mask:0xf bank_mask:0x3
    v_add_f32_dpp v93, v69, v69 row_mirror row_mask:0xf bank_mask:0x3
    v_add_f32_dpp v94, v72, v72 row_mirror row_mask:0xf bank_mask:0x3
    v_add_f32_dpp v95, v73, v73 row_mirror row_mask:0xf bank_mask:0x3
    v_add_f32_dpp v96, v76, v76 row_mirror row_mask:0xf bank_mask:0x3
    v_add_f32_dpp v97, v77, v77 row_mirror row_mask:0xf bank_mask:0x3
    v_add_f32_dpp v98, v80, v80 row_mirror row_mask:0xf bank_mask:0x3
    v_add_f32_dpp v99, v81, v81 row_mirror row_mask:0xf bank_mask:0x3
    s_add_u32 m0, s70, 29696
    s_mul_i32 s73, s98, 56
    s_add_u32 s73, s73, 28672
    buffer_load_dwordx4 v213, s[20:23], s73 offen lds
    v_add_f32_dpp v84, v194, v194 row_mirror row_mask:0xf bank_mask:0xc
    v_add_f32_dpp v85, v195, v195 row_mirror row_mask:0xf bank_mask:0xc
    v_add_f32_dpp v86, v198, v198 row_mirror row_mask:0xf bank_mask:0xc
    v_add_f32_dpp v87, v199, v199 row_mirror row_mask:0xf bank_mask:0xc
    v_add_f32_dpp v88, v202, v202 row_mirror row_mask:0xf bank_mask:0xc
    v_add_f32_dpp v89, v203, v203 row_mirror row_mask:0xf bank_mask:0xc
    v_add_f32_dpp v90, v206, v206 row_mirror row_mask:0xf bank_mask:0xc
    v_add_f32_dpp v91, v207, v207 row_mirror row_mask:0xf bank_mask:0xc
    s_add_u32 m0, s70, 30720
    s_mul_i32 s73, s98, 56
    s_add_u32 s73, s73, 57344
    buffer_load_dwordx4 v213, s[20:23], s73 offen lds
    v_add_f32_dpp v92, v70, v70 row_mirror row_mask:0xf bank_mask:0xc
    v_add_f32_dpp v93, v71, v71 row_mirror row_mask:0xf bank_mask:0xc
    v_add_f32_dpp v94, v74, v74 row_mirror row_mask:0xf bank_mask:0xc
    v_add_f32_dpp v95, v75, v75 row_mirror row_mask:0xf bank_mask:0xc
    v_add_f32_dpp v96, v78, v78 row_mirror row_mask:0xf bank_mask:0xc
    v_add_f32_dpp v97, v79, v79 row_mirror row_mask:0xf bank_mask:0xc
    v_add_f32_dpp v98, v82, v82 row_mirror row_mask:0xf bank_mask:0xc
    v_add_f32_dpp v99, v83, v83 row_mirror row_mask:0xf bank_mask:0xc
    s_add_u32 m0, s70, 31744
    s_mul_i32 s73, s98, 56
    s_add_u32 s73, s73, 86016
    buffer_load_dwordx4 v213, s[20:23], s73 offen lds
    v_add_f32_dpp v84, v84, v84 row_half_mirror row_mask:0xf bank_mask:0x5
    v_add_f32_dpp v86, v86, v86 row_half_mirror row_mask:0xf bank_mask:0x5
    v_add_f32_dpp v88, v88, v88 row_half_mirror row_mask:0xf bank_mask:0x5
    v_add_f32_dpp v90, v90, v90 row_half_mirror row_mask:0xf bank_mask:0x5
    v_add_f32_dpp v92, v92, v92 row_half_mirror row_mask:0xf bank_mask:0x5
    v_add_f32_dpp v94, v94, v94 row_half_mirror row_mask:0xf bank_mask:0x5
    v_add_f32_dpp v96, v96, v96 row_half_mirror row_mask:0xf bank_mask:0x5
    v_add_f32_dpp v98, v98, v98 row_half_mirror row_mask:0xf bank_mask:0x5
    v_add_f32_dpp v84, v85, v85 row_half_mirror row_mask:0xf bank_mask:0xa
    v_add_f32_dpp v86, v87, v87 row_half_mirror row_mask:0xf bank_mask:0xa
    v_add_f32_dpp v88, v89, v89 row_half_mirror row_mask:0xf bank_mask:0xa
    v_add_f32_dpp v90, v91, v91 row_half_mirror row_mask:0xf bank_mask:0xa
    v_add_f32_dpp v92, v93, v93 row_half_mirror row_mask:0xf bank_mask:0xa
    v_add_f32_dpp v94, v95, v95 row_half_mirror row_mask:0xf bank_mask:0xa
    v_add_f32_dpp v96, v97, v97 row_half_mirror row_mask:0xf bank_mask:0xa
    v_add_f32_dpp v98, v99, v99 row_half_mirror row_mask:0xf bank_mask:0xa
    v_add_f32_dpp v85, v84, v84 quad_perm:[1,0,3,2] row_mask:0xf bank_mask:0xf
    v_add_f32_dpp v87, v86, v86 quad_perm:[1,0,3,2] row_mask:0xf bank_mask:0xf
    v_add_f32_dpp v89, v88, v88 quad_perm:[1,0,3,2] row_mask:0xf bank_mask:0xf
    v_add_f32_dpp v91, v90, v90 quad_perm:[1,0,3,2] row_mask:0xf bank_mask:0xf
    v_add_f32_dpp v93, v92, v92 quad_perm:[1,0,3,2] row_mask:0xf bank_mask:0xf
    v_add_f32_dpp v95, v94, v94 quad_perm:[1,0,3,2] row_mask:0xf bank_mask:0xf
    v_add_f32_dpp v97, v96, v96 quad_perm:[1,0,3,2] row_mask:0xf bank_mask:0xf
    v_add_f32_dpp v99, v98, v98 quad_perm:[1,0,3,2] row_mask:0xf bank_mask:0xf
    v_add_f32_dpp v68, v85, v85 quad_perm:[2,3,0,1] row_mask:0xf bank_mask:0xf
    v_add_f32_dpp v69, v87, v87 quad_perm:[2,3,0,1] row_mask:0xf bank_mask:0xf
    v_add_f32_dpp v70, v89, v89 quad_perm:[2,3,0,1] row_mask:0xf bank_mask:0xf
    v_add_f32_dpp v71, v91, v91 quad_perm:[2,3,0,1] row_mask:0xf bank_mask:0xf
    v_add_f32_dpp v72, v93, v93 quad_perm:[2,3,0,1] row_mask:0xf bank_mask:0xf
    v_add_f32_dpp v73, v95, v95 quad_perm:[2,3,0,1] row_mask:0xf bank_mask:0xf
    v_add_f32_dpp v74, v97, v97 quad_perm:[2,3,0,1] row_mask:0xf bank_mask:0xf
    v_add_f32_dpp v75, v99, v99 quad_perm:[2,3,0,1] row_mask:0xf bank_mask:0xf
    v_permlane16_swap_b32 v68, v69
    v_permlane16_swap_b32 v70, v71
    v_permlane16_swap_b32 v72, v73
    v_permlane16_swap_b32 v74, v75
    v_add_f32 v84, v68, v69
    v_add_f32 v85, v72, v73
    v_add_f32 v86, v70, v71
    v_add_f32 v87, v74, v75
    v_and_b32 v65, 1, v3
    v_lshlrev_b32 v65, 6, v65
    v_lshrrev_b32_e64 v66, 5, v1
    v_lshl_add_u32 v65, v66, 5, v65
    v_bfe_u32 v67, v1, 2, 2
    v_lshl_add_u32 v65, v67, 3, v65
    s_lshl_b32 s58, s3, 8
    v_add_u32 v65, s58, v65
    ds_write_b64 v65, v[84:85] offset:0
    ds_write_b64 v65, v[86:87] offset:128
    v_and_b32 v67, 31, v1
    v_lshlrev_b32 v65, 9, v66
    v_lshl_add_u32 v65, v67, 4, v65
    v_lshlrev_b32_e64 v66, 8, v66
    v_lshl_add_u32 v66, v67, 3, v66
    s_and_b32 s58, s58, 512
    v_add_u32_e64 v66, s58, v66
    s_lshl_b32 s58, s67, 1
    s_lshr_b32 s60, s3, 1
    s_add_u32 s58, s58, s60
    s_lshl_b32 s58, s58, 12
    s_add_u32 s58, s58, 0x548000
    s_lshl_b32 s60, s66, 9
    s_add_u32 s60, s60, s58
    s_waitcnt lgkmcnt(0)
    s_barrier
    ds_read_b64 v[84:85], v66 offset:0
    v_mov_b32 v89, s4
    v_mov_b32 v91, s4
    s_waitcnt lgkmcnt(0)
    v_mov_b32 v88, v84
    v_mov_b32 v90, v85
    s_nop 0
    v_permlane32_swap_b32 v88, v84
    v_permlane32_swap_b32 v90, v85
    v_add_f32 v88, v88, v84
    v_add_f32 v90, v90, v85
    s_bitcmp0_b32 s3, 0
    s_cselect_b32 exec_lo, -1, 0
    s_mov_b32 exec_hi, 0
    buffer_store_dwordx4 v[88:91], v65, s[40:43], s60 offen sc1
    s_mov_b64 exec, -1
    v_cvt_pk_bf16_f32 v240, v192, v193
    v_cvt_pk_bf16_f32 v241, v194, v195
    v_cvt_pk_bf16_f32 v242, v196, v197
    v_cvt_pk_bf16_f32 v243, v198, v199
    v_cvt_pk_bf16_f32 v244, v200, v201
    v_cvt_pk_bf16_f32 v245, v202, v203
    v_cvt_pk_bf16_f32 v246, v204, v205
    v_cvt_pk_bf16_f32 v247, v206, v207
    s_lshl_b32 s61, s66, 1
    s_and_b32 s60, s3, 1
    s_add_u32 s61, s61, s60
    s_lshl_b32 s61, s61, 7
    s_lshl_b32 s60, s67, 2
    s_add_u32 s61, s61, s60
    s_and_b32 s60, s3, 2
    s_add_u32 s61, s61, s60
    s_lshl_b32 s61, s61, 10
    s_add_u32 s61, s61, 0x200000
    v_lshlrev_b32_e64 v66, 4, v67
    v_cmp_gt_u32 s[86:87], 32, v1
    s_add_u32 m0, s70, 0
    s_mul_i32 s73, s98, 56
    s_add_u32 s73, s73, 114688
    buffer_load_dwordx4 v213, s[20:23], s73 offen lds
    s_add_u32 m0, s70, 1024
    s_mul_i32 s73, s98, 56
    s_add_u32 s73, s73, 143360
    buffer_load_dwordx4 v213, s[20:23], s73 offen lds
    s_add_u32 m0, s70, 2048
    s_mul_i32 s73, s98, 56
    s_add_u32 s73, s73, 172032
    buffer_load_dwordx4 v213, s[20:23], s73 offen lds
    s_add_u32 m0, s70, 3072
    s_mul_i32 s73, s98, 56
    s_add_u32 s73, s73, 200704
    buffer_load_dwordx4 v213, s[20:23], s73 offen lds
    s_add_u32 m0, s70, 4096
    s_mul_i32 s73, s99, 56
    s_add_u32 s73, s73, 0
    buffer_load_dwordx4 v213, s[20:23], s73 offen lds
    s_add_u32 m0, s70, 5120
    s_mul_i32 s73, s99, 56
    s_add_u32 s73, s73, 28672
    buffer_load_dwordx4 v213, s[20:23], s73 offen lds
    s_add_u32 m0, s70, 6144
    s_mul_i32 s73, s99, 56
    s_add_u32 s73, s73, 57344
    buffer_load_dwordx4 v213, s[20:23], s73 offen lds
    s_add_u32 m0, s70, 7168
    s_mul_i32 s73, s99, 56
    s_add_u32 s73, s73, 86016
    buffer_load_dwordx4 v213, s[20:23], s73 offen lds
    s_add_u32 m0, s70, 8192
    s_mul_i32 s73, s99, 56
    s_add_u32 s73, s73, 114688
    buffer_load_dwordx4 v213, s[20:23], s73 offen lds
    s_add_u32 m0, s70, 9216
    s_mul_i32 s73, s99, 56
    s_add_u32 s73, s73, 143360
    buffer_load_dwordx4 v213, s[20:23], s73 offen lds
    s_add_u32 m0, s70, 10240
    s_mul_i32 s73, s99, 56
    s_add_u32 s73, s73, 172032
    buffer_load_dwordx4 v213, s[20:23], s73 offen lds
    s_add_u32 m0, s70, 11264
    s_mul_i32 s73, s99, 56
    s_add_u32 s73, s73, 200704
    buffer_load_dwordx4 v213, s[20:23], s73 offen lds
    s_add_u32 m0, s70, 12288
    s_mul_i32 s73, s100, 56
    s_add_u32 s73, s73, 0
    buffer_load_dwordx4 v213, s[20:23], s73 offen lds
    s_add_u32 m0, s70, 13312
    s_mul_i32 s73, s100, 56
    s_add_u32 s73, s73, 28672
    buffer_load_dwordx4 v213, s[20:23], s73 offen lds
    s_add_u32 m0, s70, 14336
    s_mul_i32 s73, s100, 56
    s_add_u32 s73, s73, 57344
    buffer_load_dwordx4 v213, s[20:23], s73 offen lds
    s_add_u32 m0, s70, 15360
    s_mul_i32 s73, s100, 56
    s_add_u32 s73, s73, 86016
    buffer_load_dwordx4 v213, s[20:23], s73 offen lds
    buffer_load_dwordx4 v[96:99], v65, s[40:43], s58 offen offset:0 sc1
    buffer_load_dwordx4 v[100:103], v65, s[40:43], s58 offen offset:1024 sc1
    buffer_load_dwordx4 v[104:107], v65, s[40:43], s58 offen offset:2048 sc1
    buffer_load_dwordx4 v[108:111], v66, s[40:43], s58 offen offset:3072 sc1
    s_sleep 5
    s_nop 0
Lst_P_6:
    s_sub_u32 s6, s6, 1
    s_cbranch_scc1 L_end_P
    buffer_load_dwordx4 v[112:115], v65, s[40:43], s58 offen offset:0 sc1
    buffer_load_dwordx4 v[116:119], v65, s[40:43], s58 offen offset:1024 sc1
    buffer_load_dwordx4 v[120:123], v65, s[40:43], s58 offen offset:2048 sc1
    buffer_load_dwordx4 v[124:127], v66, s[40:43], s58 offen offset:3072 sc1
    s_waitcnt vmcnt(4)
    v_xor_b32 v97, s4, v97
    v_xor_b32 v99, s4, v99
    v_xor_b32 v101, s4, v101
    v_xor_b32 v103, s4, v103
    v_xor_b32 v105, s4, v105
    v_xor_b32 v107, s4, v107
    v_xor_b32 v109, s4, v109
    v_xor_b32_e64 v111, s4, v111
    v_cndmask_b32 v108, 0, v108, s[86:87]
    v_cndmask_b32 v110, 0, v110, s[86:87]
    v_or3_b32 v97, v97, v99, v101
    v_or3_b32 v103, v103, v105, v107
    v_or3_b32 v97, v97, v109, v111
    v_or_b32 v97, v97, v103
    v_cmp_ne_u32 vcc, 0, v97
    v_add_f32 v128, v96, v100
    v_add_f32 v129, v104, v108
    v_add_f32_e64 v130, v98, v102
    v_add_f32 v131, v106, v110
    s_cbranch_vccz Lstd_P_7
    buffer_load_dwordx4 v[96:99], v65, s[40:43], s58 offen offset:0 sc1
    buffer_load_dwordx4 v[100:103], v65, s[40:43], s58 offen offset:1024 sc1
    buffer_load_dwordx4 v[104:107], v65, s[40:43], s58 offen offset:2048 sc1
    buffer_load_dwordx4 v[108:111], v66, s[40:43], s58 offen offset:3072 sc1
    s_waitcnt vmcnt(4)
    v_xor_b32 v113, s4, v113
    v_xor_b32 v115, s4, v115
    v_xor_b32 v117, s4, v117
    v_xor_b32 v119, s4, v119
    v_xor_b32 v121, s4, v121
    v_xor_b32 v123, s4, v123
    v_xor_b32 v125, s4, v125
    v_xor_b32_e64 v127, s4, v127
    v_cndmask_b32 v124, 0, v124, s[86:87]
    v_cndmask_b32 v126, 0, v126, s[86:87]
    v_or3_b32 v113, v113, v115, v117
    v_or3_b32 v119, v119, v121, v123
    v_or3_b32 v113, v113, v125, v127
    v_or_b32 v113, v113, v119
    v_cmp_ne_u32 vcc, 0, v113
    v_add_f32 v128, v112, v116
    v_add_f32 v129, v120, v124
    v_add_f32 v130, v114, v118
    v_add_f32 v131, v122, v126
    s_cbranch_vccnz Lst_P_6
    s_nop 3
Lstd_P_7:
    v_add_f32 v128, v128, v129
    v_add_f32 v130, v130, v131
    v_mov_b32 v136, v128
    v_mov_b32 v138, v130
    s_nop 0
    v_permlane32_swap_b32 v128, v136
    v_permlane32_swap_b32 v130, v138
    v_add_f32 v128, v128, v136
    v_add_f32_e64 v130, v130, v138
    v_mul_f32 v133, 0x3b124925, v128
    v_mul_f32 v130, 0x3b124925, v130
    v_fma_f32 v130, -v133, v133, v130
    v_max_f32_e64 v130, 0, v130
    v_add_f32 v135, 0x3727c5ac, v130
    v_rsq_f32 v135, v135
    s_nop 0
    v_mul_f32_e64 v130, v130, v135
    v_fmaak_f32 v130, v130, v135, 0x3727c5ac
    v_rsq_f32 v130, v130
    s_nop 0
    v_mul_f32 v135, v135, v130
    s_lshl_b32 s60, s3, 8
    v_lshl_add_u32 v66, v67, 2, s60
    ds_write_b32 v66, v133 offset:1024
    ds_write_b32 v66, v135 offset:1152
    v_lshrrev_b32 v66, 5, v1
    v_lshl_add_u32 v66, v66, 4, s60
    s_waitcnt lgkmcnt(0)
    ds_read_b128 v[140:143], v66 offset:1024
    ds_read_b128 v[156:159], v66 offset:1152
    ds_read_b128 v[144:147], v66 offset:1056
    ds_read_b128 v[160:163], v66 offset:1184
    ds_read_b128 v[148:151], v66 offset:1088
    ds_read_b128 v[164:167], v66 offset:1216
    ds_read_b128 v[152:155], v66 offset:1120
    ds_read_b128 v[168:171], v66 offset:1248
    s_waitcnt lgkmcnt(7)
    v_pk_add_f32 v[192:193], v[192:193], v[140:141] neg_lo:[0,1] neg_hi:[0,1]
    v_pk_add_f32 v[194:195], v[194:195], v[142:143] neg_lo:[0,1] neg_hi:[0,1]
    s_waitcnt lgkmcnt(5)
    v_pk_add_f32 v[196:197], v[196:197], v[144:145] neg_lo:[0,1] neg_hi:[0,1]
    v_pk_add_f32 v[198:199], v[198:199], v[146:147] neg_lo:[0,1] neg_hi:[0,1]
    v_pk_mul_f32 v[192:193], v[192:193], v[156:157]
    v_pk_mul_f32 v[194:195], v[194:195], v[158:159]
    s_waitcnt lgkmcnt(4)
    v_pk_mul_f32 v[196:197], v[196:197], v[160:161]
    v_pk_mul_f32 v[198:199], v[198:199], v[162:163]
    v_cvt_pk_bf16_f32 v84, v192, v193
    v_cvt_pk_bf16_f32 v85, v194, v195
    v_cvt_pk_bf16_f32 v86, v196, v197
    v_cvt_pk_bf16_f32 v87, v198, v199
    buffer_store_dwordx4 v[84:87], v4, s[40:43], s61 offen offset:0 sc1
    s_waitcnt lgkmcnt(3)
    v_pk_add_f32 v[200:201], v[200:201], v[148:149] neg_lo:[0,1] neg_hi:[0,1]
    v_pk_add_f32 v[202:203], v[202:203], v[150:151] neg_lo:[0,1] neg_hi:[0,1]
    s_waitcnt lgkmcnt(1)
    v_pk_add_f32 v[204:205], v[204:205], v[152:153] neg_lo:[0,1] neg_hi:[0,1]
    v_pk_add_f32 v[206:207], v[206:207], v[154:155] neg_lo:[0,1] neg_hi:[0,1]
    v_pk_mul_f32 v[200:201], v[200:201], v[164:165]
    v_pk_mul_f32 v[202:203], v[202:203], v[166:167]
    s_waitcnt lgkmcnt(0)
    v_pk_mul_f32 v[204:205], v[204:205], v[168:169]
    v_pk_mul_f32 v[206:207], v[206:207], v[170:171]
    v_cvt_pk_bf16_f32 v88, v200, v201
    v_cvt_pk_bf16_f32 v89, v202, v203
    v_cvt_pk_bf16_f32 v90, v204, v205
    v_cvt_pk_bf16_f32 v91, v206, v207
    buffer_store_dwordx4 v[88:91], v4, s[40:43], s61 offen offset:1024 sc1
    ds_read_b64_tr_b16 a[208:209], v215 offset:16384
    ds_read_b64_tr_b16 a[210:211], v215 offset:17408
    ds_read_b64_tr_b16 a[212:213], v216 offset:16384
    ds_read_b64_tr_b16 a[214:215], v216 offset:17408
    ds_read_b64_tr_b16 a[216:217], v215 offset:18432
    ds_read_b64_tr_b16 a[218:219], v215 offset:19456
    ds_read_b64_tr_b16 a[220:221], v216 offset:18432
    ds_read_b64_tr_b16 a[222:223], v216 offset:19456
    ds_read_b64_tr_b16 a[224:225], v215 offset:20480
    ds_read_b64_tr_b16 a[226:227], v215 offset:21504
    ds_read_b64_tr_b16 a[228:229], v216 offset:20480
    ds_read_b64_tr_b16 a[230:231], v216 offset:21504
    ds_read_b64_tr_b16 a[232:233], v215 offset:22528
    ds_read_b64_tr_b16 a[234:235], v215 offset:23552
    ds_read_b64_tr_b16 a[236:237], v216 offset:22528
    ds_read_b64_tr_b16 a[238:239], v216 offset:23552
    ds_read_b64_tr_b16 a[240:241], v215 offset:24576
    ds_read_b64_tr_b16 a[242:243], v215 offset:25600
    ds_read_b64_tr_b16 a[244:245], v216 offset:24576
    ds_read_b64_tr_b16 a[246:247], v216 offset:25600
    ds_read_b64_tr_b16 a[248:249], v215 offset:26624
    ds_read_b64_tr_b16 a[250:251], v215 offset:27648
    ds_read_b64_tr_b16 a[252:253], v216 offset:26624
    ds_read_b64_tr_b16 a[254:255], v216 offset:27648
    ds_read_b64_tr_b16 a[0:1], v215 offset:28672
    ds_read_b64_tr_b16 a[2:3], v215 offset:29696
    ds_read_b64_tr_b16 a[4:5], v216 offset:28672
    ds_read_b64_tr_b16 a[6:7], v216 offset:29696
    ds_read_b64_tr_b16 a[8:9], v215 offset:30720
    ds_read_b64_tr_b16 a[10:11], v215 offset:31744
    ds_read_b64_tr_b16 a[12:13], v216 offset:30720
    ds_read_b64_tr_b16 a[14:15], v216 offset:31744
    ds_read_b64_tr_b16 a[16:17], v215 offset:0
    ds_read_b64_tr_b16 a[18:19], v215 offset:1024
    ds_read_b64_tr_b16 a[20:21], v216 offset:0
    ds_read_b64_tr_b16 a[22:23], v216 offset:1024
    ds_read_b64_tr_b16 a[24:25], v215 offset:2048
    ds_read_b64_tr_b16 a[26:27], v215 offset:3072
    ds_read_b64_tr_b16 a[28:29], v216 offset:2048
    ds_read_b64_tr_b16 a[30:31], v216 offset:3072
    ds_read_b64_tr_b16 a[32:33], v215 offset:4096
    ds_read_b64_tr_b16 a[34:35], v215 offset:5120
    ds_read_b64_tr_b16 a[36:37], v216 offset:4096
    ds_read_b64_tr_b16 a[38:39], v216 offset:5120
    ds_read_b64_tr_b16 a[40:41], v215 offset:6144
    ds_read_b64_tr_b16 a[42:43], v215 offset:7168
    ds_read_b64_tr_b16 a[44:45], v216 offset:6144
    ds_read_b64_tr_b16 a[46:47], v216 offset:7168
    ds_read_b64_tr_b16 a[48:49], v215 offset:8192
    ds_read_b64_tr_b16 a[50:51], v215 offset:9216
    ds_read_b64_tr_b16 a[52:53], v216 offset:8192
    ds_read_b64_tr_b16 a[54:55], v216 offset:9216
    ds_read_b64_tr_b16 a[56:57], v215 offset:10240
    ds_read_b64_tr_b16 a[58:59], v215 offset:11264
    ds_read_b64_tr_b16 a[60:61], v216 offset:10240
    ds_read_b64_tr_b16 a[62:63], v216 offset:11264
    ds_read_b64_tr_b16 a[64:65], v215 offset:12288
    ds_read_b64_tr_b16 a[66:67], v215 offset:13312
    ds_read_b64_tr_b16 a[68:69], v216 offset:12288
    ds_read_b64_tr_b16 a[70:71], v216 offset:13312
    ds_read_b64_tr_b16 a[72:73], v215 offset:14336
    ds_read_b64_tr_b16 a[74:75], v215 offset:15360
    ds_read_b64_tr_b16 a[76:77], v216 offset:14336
    ds_read_b64_tr_b16 a[78:79], v216 offset:15360
    s_waitcnt vmcnt(0)
    v_mov_b32 v8, s4
    s_mov_b64 exec, 1
    buffer_store_dword v8, v9, s[40:43], s81 offen sc1
    s_mov_b64 exec, -1
    s_waitcnt lgkmcnt(4)
    s_add_u32 m0, s70, 12288
    s_mul_i32 s73, s100, 56
    s_add_u32 s73, s73, 114688
    buffer_load_dwordx4 v213, s[20:23], s73 offen lds
    s_add_u32 m0, s70, 13312
    s_mul_i32 s73, s100, 56
    s_add_u32 s73, s73, 143360
    buffer_load_dwordx4 v213, s[20:23], s73 offen lds
    s_waitcnt lgkmcnt(0)
    s_add_u32 m0, s70, 14336
    s_mul_i32 s73, s100, 56
    s_add_u32 s73, s73, 172032
    buffer_load_dwordx4 v213, s[20:23], s73 offen lds
    s_add_u32 m0, s70, 15360
    s_mul_i32 s73, s100, 56
    s_add_u32 s73, s73, 200704
    buffer_load_dwordx4 v213, s[20:23], s73 offen lds
    s_add_u32 m0, s70, 16384
    s_mul_i32 s73, s101, 56
    s_add_u32 s73, s73, 0
    buffer_load_dwordx4 v213, s[20:23], s73 offen lds
    s_add_u32 m0, s70, 17408
    s_mul_i32 s73, s101, 56
    s_add_u32 s73, s73, 28672
    buffer_load_dwordx4 v213, s[20:23], s73 offen lds
    s_add_u32 m0, s70, 18432
    s_mul_i32 s73, s101, 56
    s_add_u32 s73, s73, 57344
    buffer_load_dwordx4 v213, s[20:23], s73 offen lds
    s_add_u32 m0, s70, 19456
    s_mul_i32 s73, s101, 56
    s_add_u32 s73, s73, 86016
    buffer_load_dwordx4 v213, s[20:23], s73 offen lds
    s_add_u32 m0, s70, 20480
    s_mul_i32 s73, s101, 56
    s_add_u32 s73, s73, 114688
    buffer_load_dwordx4 v213, s[20:23], s73 offen lds
    s_add_u32 m0, s70, 21504
    s_mul_i32 s73, s101, 56
    s_add_u32 s73, s73, 143360
    buffer_load_dwordx4 v213, s[20:23], s73 offen lds
    s_add_u32 m0, s70, 22528
    s_mul_i32 s73, s101, 56
    s_add_u32 s73, s73, 172032
    buffer_load_dwordx4 v213, s[20:23], s73 offen lds
    s_add_u32 m0, s70, 23552
    s_mul_i32 s73, s101, 56
    s_add_u32 s73, s73, 200704
    buffer_load_dwordx4 v213, s[20:23], s73 offen lds
    s_add_u32 m0, s70, 24576
    s_mul_i32 s73, s48, 64
    s_add_u32 s73, s73, 0
    buffer_load_dwordx4 v214, s[24:27], s73 offen lds
    s_add_u32 m0, s70, 25600
    s_mul_i32 s73, s48, 64
    s_add_u32 s73, s73, 32768
    buffer_load_dwordx4 v214, s[24:27], s73 offen lds
    s_add_u32 m0, s70, 26624
    s_mul_i32 s73, s48, 64
    s_add_u32 s73, s73, 65536
    buffer_load_dwordx4 v214, s[24:27], s73 offen lds
    s_add_u32 m0, s70, 27648
    s_mul_i32 s73, s48, 64
    s_add_u32 s73, s73, 98304
    buffer_load_dwordx4 v214, s[24:27], s73 offen lds
    s_add_u32 m0, s70, 28672
    s_mul_i32 s73, s48, 64
    s_add_u32 s73, s73, 131072
    buffer_load_dwordx4 v214, s[24:27], s73 offen lds
    s_add_u32 m0, s70, 29696
    s_mul_i32 s73, s48, 64
    s_add_u32 s73, s73, 163840
    buffer_load_dwordx4 v214, s[24:27], s73 offen lds
    s_add_u32 m0, s70, 30720
    s_mul_i32 s73, s48, 64
    s_add_u32 s73, s73, 196608
    buffer_load_dwordx4 v214, s[24:27], s73 offen lds
    s_add_u32 m0, s70, 31744
    s_mul_i32 s73, s48, 64
    s_add_u32 s73, s73, 229376
    buffer_load_dwordx4 v214, s[24:27], s73 offen lds
    s_add_u32 m0, s70, 32768
    s_mul_i32 s73, s49, 64
    s_add_u32 s73, s73, 0
    buffer_load_dwordx4 v214, s[24:27], s73 offen lds
    s_add_u32 m0, s70, 33792
    s_mul_i32 s73, s49, 64
    s_add_u32 s73, s73, 32768
    buffer_load_dwordx4 v214, s[24:27], s73 offen lds
    s_add_u32 m0, s70, 34816
    s_mul_i32 s73, s49, 64
    s_add_u32 s73, s73, 65536
    buffer_load_dwordx4 v214, s[24:27], s73 offen lds
    s_add_u32 m0, s70, 35840
    s_mul_i32 s73, s49, 64
    s_add_u32 s73, s73, 98304
    buffer_load_dwordx4 v214, s[24:27], s73 offen lds
    s_lshl_b32 s71, s64, 18
    s_lshl_b32 s86, s3, 15
    s_add_u32 s71, s71, s86
    s_add_u32 s71, s71, 0x200000
    s_add_u32 s72, s71, 0x20000
    s_mul_i32 s58, s66, 229376
    s_add_u32 s58, s58, 0x3c0000
    s_lshl_b32 s86, s65, 2
    s_add_u32 s86, s86, s3
    s_lshl_b32 s86, s86, 10
    s_add_u32 s57, s58, s86
    s_mul_i32 s86, s3, 28672
    s_add_u32 s58, s58, s86
    s_add_u32 s59, s58, 114688
    v_lshrrev_b32 v208, 5, v1
    v_lshlrev_b32 v208, 3, v208
    s_lshl_b32 s86, s65, 7
    s_lshl_b32 s87, s3, 5
    s_add_u32 s86, s86, s87
    buffer_load_dwordx2 v[220:221], v208, s[28:31], s86 offen offset:0
    buffer_load_dwordx2 v[222:223], v208, s[28:31], s86 offen offset:16
    s_lshl_b32 s86, s67, 7
    s_lshr_b32 s87, s3, 1
    s_lshl_b32 s87, s87, 6
    s_add_u32 s86, s86, s87
    buffer_load_dwordx2 v[224:225], v208, s[32:35], s86 offen offset:0
    buffer_load_dwordx2 v[226:227], v208, s[32:35], s86 offen offset:16
    buffer_load_dwordx2 v[228:229], v208, s[32:35], s86 offen offset:32
    buffer_load_dwordx2 v[230:231], v208, s[32:35], s86 offen offset:48
    v_add_u32 v232, s70, v4
    s_xor_b32 s86, s3, 1
    s_mul_i32 s86, s86, 36864
    s_add_u32 s86, s86, 12288
    v_add_u32 v233, s86, v4
    s_xor_b32 s86, s3, 2
    s_mul_i32 s86, s86, 36864
    s_add_u32 s86, s86, 14336
    v_add_u32 v234, s86, v4
    s_xor_b32 s86, s3, 3
    s_mul_i32 s86, s86, 36864
    s_add_u32 s86, s86, 16384
    v_add_u32 v235, s86, v4
    v_lshrrev_b32 v208, 5, v1
    v_lshlrev_b32 v208, 9, v208
    v_and_b32 v209, 31, v1
    v_lshl_add_u32 v208, v209, 2, v208
    s_lshr_b32 s86, s3, 1
    s_lshl_b32 s86, s86, 12
    v_add_u32_e64 v208, s86, v208
    v_xor_b32 v209, 0x1000, v208
    v_add_u32_e64 v236, s70, v208
    v_add_u32 v237, s70, v209
    s_lshl_b32 s86, s3, 11
    s_add_u32 s86, s86, 12288
    v_add_u32_e64 v238, s86, v4
    v_add_u32 v239, 73728, v238
    v_lshrrev_b32_e64 v208, 3, v1
    v_mul_u32_u24 v212, 896, v208
    v_and_b32_e64 v208, 7, v1
    v_lshl_add_u32 v212, v208, 3, v212
    s_lshl_b32 s68, s67, 2
    s_add_u32 s68, s68, s3
    s_mul_i32 s68, s68, 14336
    s_lshl_b32 s86, s66, 7
    s_add_u32 s68, s68, s86
    s_add_u32 s69, s68, 7168
    s_mov_b32 s88, 0xc0135761
    s_mov_b32 s89, 0xc0135761
    s_mov_b32 s90, 0xbdd2d3e8
    s_mov_b32 s91, 0xffff0000
    buffer_load_dword v249, v11, s[40:43], s84 offen sc1
    s_sleep 3
    buffer_load_dword v250, v11, s[40:43], s84 offen sc1
    s_sleep 3
    s_nop 0
Lpoll_P_8:
    s_sub_u32 s6, s6, 1
    s_cbranch_scc1 L_end_P
    buffer_load_dword v251, v11, s[40:43], s84 offen sc1
    s_waitcnt vmcnt(2)
    v_cmp_ne_u32_e64 vcc, s4, v249
    s_nop 1
    s_cbranch_vccz Lpd_P_9
    buffer_load_dword v249, v11, s[40:43], s84 offen sc1
    s_waitcnt vmcnt(2)
    v_cmp_ne_u32 vcc, s4, v250
    s_nop 1
    s_cbranch_vccz Lpd_P_9
    buffer_load_dword v250, v11, s[40:43], s84 offen sc1
    s_waitcnt vmcnt(2)
    v_cmp_ne_u32 vcc, s4, v251
    s_nop 1
    s_cbranch_vccnz Lpoll_P_8
    s_nop 1
Lpd_P_9:
    s_add_u32 s56, s71, s94
    buffer_load_dwordx4 v[80:83], v5, s[40:43], s56 offen offset:0 sc1
    buffer_load_dwordx4 v[84:87], v5, s[40:43], s56 offen offset:1024 sc1
    buffer_load_dwordx4 v[88:91], v5, s[40:43], s56 offen offset:2048 sc1
    buffer_load_dwordx4 v[92:95], v5, s[40:43], s56 offen offset:3072 sc1
    s_add_u32 s56, s71, s95
    buffer_load_dwordx4 v[96:99], v5, s[40:43], s56 offen offset:0 sc1
    buffer_load_dwordx4 v[100:103], v5, s[40:43], s56 offen offset:1024 sc1
    buffer_load_dwordx4 v[104:107], v5, s[40:43], s56 offen offset:2048 sc1
    buffer_load_dwordx4 v[108:111], v5, s[40:43], s56 offen offset:3072 sc1
    v_lshlrev_b32 v16, 16, v220
    v_and_b32 v17, s91, v220
    v_lshlrev_b32 v18, 16, v221
    v_and_b32 v19, s91, v221
    v_lshlrev_b32 v20, 16, v222
    v_and_b32 v21, s91, v222
    v_lshlrev_b32 v22, 16, v223
    v_and_b32_e64 v23, s91, v223
    v_mov_b64 v[24:25], 0
    v_mov_b64 v[26:27], 0
    v_mov_b64 v[28:29], 0
    v_mov_b64 v[30:31], 0
    ds_read_b64_tr_b16 a[80:81], v215 offset:12288
    ds_read_b64_tr_b16 a[82:83], v215 offset:13312
    ds_read_b64_tr_b16 a[84:85], v216 offset:12288
    ds_read_b64_tr_b16 a[86:87], v216 offset:13312
    ds_read_b64_tr_b16 a[88:89], v215 offset:14336
    ds_read_b64_tr_b16 a[90:91], v215 offset:15360
    ds_read_b64_tr_b16 a[92:93], v216 offset:14336
    ds_read_b64_tr_b16 a[94:95], v216 offset:15360
    ds_read_b64_tr_b16 a[96:97], v215 offset:16384
    ds_read_b64_tr_b16 a[98:99], v215 offset:17408
    ds_read_b64_tr_b16 a[100:101], v216 offset:16384
    ds_read_b64_tr_b16 a[102:103], v216 offset:17408
    ds_read_b64_tr_b16 a[104:105], v215 offset:18432
    ds_read_b64_tr_b16 a[106:107], v215 offset:19456
    ds_read_b64_tr_b16 a[108:109], v216 offset:18432
    ds_read_b64_tr_b16 a[110:111], v216 offset:19456
    ds_read_b64_tr_b16 a[112:113], v215 offset:20480
    ds_read_b64_tr_b16 a[114:115], v215 offset:21504
    ds_read_b64_tr_b16 a[116:117], v216 offset:20480
    ds_read_b64_tr_b16 a[118:119], v216 offset:21504
    ds_read_b64_tr_b16 a[120:121], v215 offset:22528
    ds_read_b64_tr_b16 a[122:123], v215 offset:23552
    ds_read_b64_tr_b16 a[124:125], v216 offset:22528
    ds_read_b64_tr_b16 a[126:127], v216 offset:23552
    v_mov_b32 v9, v5
    s_add_u32 s56, s71, s96
    buffer_load_dwordx4 v[112:115], v5, s[40:43], s56 offen offset:0 sc1
    buffer_load_dwordx4 v[116:119], v5, s[40:43], s56 offen offset:1024 sc1
    s_waitcnt vmcnt(9)
    v_mfma_f32_32x32x16_bf16 v[16:31], a[128:131], v[80:83], v[16:31]
    v_mfma_f32_32x32x16_bf16 v[32:47], a[132:135], v[80:83], 0
    buffer_load_dwordx4 v[120:123], v5, s[40:43], s56 offen offset:2048 sc1
    s_waitcnt vmcnt(9)
    v_mfma_f32_32x32x16_bf16 v[16:31], a[136:139], v[84:87], v[16:31]
    v_mfma_f32_32x32x16_bf16 v[32:47], a[140:143], v[84:87], v[32:47]
    buffer_load_dwordx4 v[124:127], v5, s[40:43], s56 offen offset:3072 sc1
    s_waitcnt vmcnt(9)
    v_mfma_f32_32x32x16_bf16 v[16:31], a[144:147], v[88:91], v[16:31]
    v_mfma_f32_32x32x16_bf16 v[32:47], a[148:151], v[88:91], v[32:47]
    s_add_u32 s56, s71, s97
    buffer_load_dwordx4 v[128:131], v5, s[40:43], s56 offen offset:0 sc1
    s_waitcnt vmcnt(9)
    v_mfma_f32_32x32x16_bf16 v[16:31], a[152:155], v[92:95], v[16:31]
    v_mfma_f32_32x32x16_bf16 v[32:47], a[156:159], v[92:95], v[32:47]
    buffer_load_dwordx4 v[132:135], v5, s[40:43], s56 offen offset:1024 sc1
    s_waitcnt vmcnt(9)
    v_mfma_f32_32x32x16_bf16 v[16:31], a[160:163], v[96:99], v[16:31]
    v_mfma_f32_32x32x16_bf16 v[32:47], a[164:167], v[96:99], v[32:47]
    buffer_load_dwordx4 v[136:139], v5, s[40:43], s56 offen offset:2048 sc1
    s_waitcnt vmcnt(9)
    v_mfma_f32_32x32x16_bf16 v[16:31], a[168:171], v[100:103], v[16:31]
    v_mfma_f32_32x32x16_bf16 v[32:47], a[172:175], v[100:103], v[32:47]
    buffer_load_dwordx4 v[140:143], v5, s[40:43], s56 offen offset:3072 sc1
    s_waitcnt vmcnt(9)
    v_mfma_f32_32x32x16_bf16 v[16:31], a[176:179], v[104:107], v[16:31]
    v_mfma_f32_32x32x16_bf16 v[32:47], a[180:183], v[104:107], v[32:47]
    s_add_u32 s56, s71, s98
    buffer_load_dwordx4 v[144:147], v5, s[40:43], s56 offen offset:0 sc1
    s_waitcnt vmcnt(9)
    v_mfma_f32_32x32x16_bf16 v[16:31], a[184:187], v[108:111], v[16:31]
    v_mfma_f32_32x32x16_bf16 v[32:47], a[188:191], v[108:111], v[32:47]
    buffer_load_dwordx4 v[148:151], v5, s[40:43], s56 offen offset:1024 sc1
    s_waitcnt vmcnt(9)
    v_mfma_f32_32x32x16_bf16 v[16:31], a[192:195], v[112:115], v[16:31]
    v_mfma_f32_32x32x16_bf16 v[32:47], a[196:199], v[112:115], v[32:47]
    buffer_load_dwordx4 v[152:155], v5, s[40:43], s56 offen offset:2048 sc1
    s_waitcnt vmcnt(9)
    v_mfma_f32_32x32x16_bf16 v[16:31], a[200:203], v[116:119], v[16:31]
    v_mfma_f32_32x32x16_bf16 v[32:47], a[204:207], v[116:119], v[32:47]
    buffer_load_dwordx4 v[156:159], v5, s[40:43], s56 offen offset:3072 sc1
    s_waitcnt vmcnt(9)
    v_mfma_f32_32x32x16_bf16 v[16:31], a[208:211], v[120:123], v[16:31]
    v_mfma_f32_32x32x16_bf16 v[32:47], a[212:215], v[120:123], v[32:47]
    s_waitcnt lgkmcnt(15)
    s_add_u32 m0, s70, 12288
    s_mul_i32 s73, s49, 64
    s_add_u32 s73, s73, 131072
    buffer_load_dwordx4 v214, s[24:27], s73 offen lds
    s_add_u32 m0, s70, 13312
    s_mul_i32 s73, s49, 64
    s_add_u32 s73, s73, 163840
    buffer_load_dwordx4 v214, s[24:27], s73 offen lds
    s_add_u32 s56, s71, s99
    buffer_load_dwordx4 v[160:163], v5, s[40:43], s56 offen offset:0 sc1
    s_waitcnt vmcnt(11)
    v_mfma_f32_32x32x16_bf16 v[16:31], a[216:219], v[124:127], v[16:31]
    v_mfma_f32_32x32x16_bf16 v[32:47], a[220:223], v[124:127], v[32:47]
    s_add_u32 m0, s70, 14336
    s_mul_i32 s73, s49, 64
    s_add_u32 s73, s73, 196608
    buffer_load_dwordx4 v214, s[24:27], s73 offen lds
    s_add_u32 m0, s70, 15360
    s_mul_i32 s73, s49, 64
    s_add_u32 s73, s73, 229376
    buffer_load_dwordx4 v214, s[24:27], s73 offen lds
    buffer_load_dwordx4 v[164:167], v5, s[40:43], s56 offen offset:1024 sc1
    s_waitcnt vmcnt(13)
    v_mfma_f32_32x32x16_bf16 v[16:31], a[224:227], v[128:131], v[16:31]
    v_mfma_f32_32x32x16_bf16 v[32:47], a[228:231], v[128:131], v[32:47]
    s_waitcnt lgkmcnt(12)
    s_add_u32 m0, s70, 16384
    s_mul_i32 s73, s50, 64
    s_add_u32 s73, s73, 0
    buffer_load_dwordx4 v214, s[24:27], s73 offen lds
    s_add_u32 m0, s70, 17408
    s_mul_i32 s73, s50, 64
    s_add_u32 s73, s73, 32768
    buffer_load_dwordx4 v214, s[24:27], s73 offen lds
    buffer_load_dwordx4 v[168:171], v5, s[40:43], s56 offen offset:2048 sc1
    s_waitcnt vmcnt(15)
    v_mfma_f32_32x32x16_bf16 v[16:31], a[232:235], v[132:135], v[16:31]
    v_mfma_f32_32x32x16_bf16 v[32:47], a[236:239], v[132:135], v[32:47]
    s_waitcnt lgkmcnt(8)
    s_add_u32 m0, s70, 18432
    s_mul_i32 s73, s50, 64
    s_add_u32 s73, s73, 65536
    buffer_load_dwordx4 v214, s[24:27], s73 offen lds
    s_add_u32 m0, s70, 19456
    s_mul_i32 s73, s50, 64
    s_add_u32 s73, s73, 98304
    buffer_load_dwordx4 v214, s[24:27], s73 offen lds
    buffer_load_dwordx4 v[172:175], v5, s[40:43], s56 offen offset:3072 sc1
    s_waitcnt vmcnt(17)
    v_mfma_f32_32x32x16_bf16 v[16:31], a[240:243], v[136:139], v[16:31]
    v_mfma_f32_32x32x16_bf16 v[32:47], a[244:247], v[136:139], v[32:47]
    s_waitcnt lgkmcnt(4)
    s_add_u32 m0, s70, 20480
    s_mul_i32 s73, s50, 64
    s_add_u32 s73, s73, 131072
    buffer_load_dwordx4 v214, s[24:27], s73 offen lds
    s_add_u32 m0, s70, 21504
    s_mul_i32 s73, s50, 64
    s_add_u32 s73, s73, 163840
    buffer_load_dwordx4 v214, s[24:27], s73 offen lds
    s_add_u32 s56, s71, s100
    buffer_load_dwordx4 v[176:179], v5, s[40:43], s56 offen offset:0 sc1
    s_waitcnt vmcnt(19)
    v_mfma_f32_32x32x16_bf16 v[16:31], a[248:251], v[140:143], v[16:31]
    v_mfma_f32_32x32x16_bf16 v[32:47], a[252:255], v[140:143], v[32:47]
    s_waitcnt lgkmcnt(0)
    s_add_u32 m0, s70, 22528
    s_mul_i32 s73, s50, 64
    s_add_u32 s73, s73, 196608
    buffer_load_dwordx4 v214, s[24:27], s73 offen lds
    s_add_u32 m0, s70, 23552
    s_mul_i32 s73, s50, 64
    s_add_u32 s73, s73, 229376
    buffer_load_dwordx4 v214, s[24:27], s73 offen lds
    buffer_load_dwordx4 v[180:183], v5, s[40:43], s56 offen offset:1024 sc1
    s_waitcnt vmcnt(21)
    v_mfma_f32_32x32x16_bf16 v[16:31], a[0:3], v[144:147], v[16:31]
    v_mfma_f32_32x32x16_bf16 v[32:47], a[4:7], v[144:147], v[32:47]
    s_barrier
    buffer_load_dwordx4 v[184:187], v5, s[40:43], s56 offen offset:2048 sc1
    s_waitcnt vmcnt(21)
    v_mfma_f32_32x32x16_bf16 v[16:31], a[8:11], v[148:151], v[16:31]
    v_mfma_f32_32x32x16_bf16 v[32:47], a[12:15], v[148:151], v[32:47]
    buffer_load_dwordx4 v[188:191], v5, s[40:43], s56 offen offset:3072 sc1
    s_waitcnt vmcnt(21)
    v_mfma_f32_32x32x16_bf16 v[16:31], a[16:19], v[152:155], v[16:31]
    v_mfma_f32_32x32x16_bf16 v[32:47], a[20:23], v[152:155], v[32:47]
    s_add_u32 s56, s71, s101
    buffer_load_dwordx4 v[192:195], v5, s[40:43], s56 offen offset:0 sc1
    s_waitcnt vmcnt(21)
    v_mfma_f32_32x32x16_bf16 v[16:31], a[24:27], v[156:159], v[16:31]
    v_mfma_f32_32x32x16_bf16 v[32:47], a[28:31], v[156:159], v[32:47]
    buffer_load_dwordx4 v[196:199], v5, s[40:43], s56 offen offset:1024 sc1
    s_waitcnt vmcnt(19)
    v_mfma_f32_32x32x16_bf16 v[16:31], a[32:35], v[160:163], v[16:31]
    v_mfma_f32_32x32x16_bf16 v[32:47], a[36:39], v[160:163], v[32:47]
    v_lshlrev_b32 v48, 16, v220
    v_and_b32 v49, s91, v220
    v_lshlrev_b32 v50, 16, v221
    v_and_b32 v51, s91, v221
    buffer_load_dwordx4 v[200:203], v5, s[40:43], s56 offen offset:2048 sc1
    s_waitcnt vmcnt(17)
    v_mfma_f32_32x32x16_bf16 v[16:31], a[40:43], v[164:167], v[16:31]
    v_mfma_f32_32x32x16_bf16 v[32:47], a[44:47], v[164:167], v[32:47]
    v_lshlrev_b32 v52, 16, v222
    v_and_b32 v53, s91, v222
    v_lshlrev_b32_e64 v54, 16, v223
    v_and_b32 v55, s91, v223
    buffer_load_dwordx4 v[204:207], v5, s[40:43], s56 offen offset:3072 sc1
    s_waitcnt vmcnt(15)
    v_mfma_f32_32x32x16_bf16 v[16:31], a[48:51], v[168:171], v[16:31]
    v_mfma_f32_32x32x16_bf16 v[32:47], a[52:55], v[168:171], v[32:47]
    v_mov_b64 v[56:57], 0
    v_mov_b64 v[58:59], 0
    v_mov_b64 v[60:61], 0
    v_mov_b64 v[62:63], 0
    s_add_u32 s56, s72, s94
    buffer_load_dwordx4 v[80:83], v5, s[40:43], s56 offen offset:0 sc1
    s_waitcnt vmcnt(13)
    v_mfma_f32_32x32x16_bf16 v[16:31], a[56:59], v[172:175], v[16:31]
    v_mfma_f32_32x32x16_bf16 v[32:47], a[60:63], v[172:175], v[32:47]
    buffer_load_dwordx4 v[84:87], v5, s[40:43], s56 offen offset:1024 sc1
    s_waitcnt vmcnt(11)
    v_mfma_f32_32x32x16_bf16 v[16:31], a[64:67], v[176:179], v[16:31]
    v_mfma_f32_32x32x16_bf16 v[32:47], a[68:71], v[176:179], v[32:47]
    buffer_load_dwordx4 v[88:91], v5, s[40:43], s56 offen offset:2048 sc1
    s_waitcnt vmcnt(9)
    v_mfma_f32_32x32x16_bf16 v[16:31], a[72:75], v[180:183], v[16:31]
    v_mfma_f32_32x32x16_bf16 v[32:47], a[76:79], v[180:183], v[32:47]
    buffer_load_dwordx4 v[92:95], v5, s[40:43], s56 offen offset:3072 sc1
    s_waitcnt vmcnt(9)
    v_mfma_f32_32x32x16_bf16 v[16:31], a[80:83], v[184:187], v[16:31]
    v_mfma_f32_32x32x16_bf16 v[32:47], a[84:87], v[184:187], v[32:47]
    s_add_u32 s56, s72, s95
    buffer_load_dwordx4 v[96:99], v5, s[40:43], s56 offen offset:0 sc1
    s_waitcnt vmcnt(9)
    v_mfma_f32_32x32x16_bf16 v[16:31], a[88:91], v[188:191], v[16:31]
    v_mfma_f32_32x32x16_bf16 v[32:47], a[92:95], v[188:191], v[32:47]
    buffer_load_dwordx4 v[100:103], v5, s[40:43], s56 offen offset:1024 sc1
    s_waitcnt vmcnt(9)
    v_mfma_f32_32x32x16_bf16 v[16:31], a[96:99], v[192:195], v[16:31]
    v_mfma_f32_32x32x16_bf16 v[32:47], a[100:103], v[192:195], v[32:47]
    buffer_load_dwordx4 v[104:107], v5, s[40:43], s56 offen offset:2048 sc1
    s_waitcnt vmcnt(9)
    v_mfma_f32_32x32x16_bf16 v[16:31], a[104:107], v[196:199], v[16:31]
    v_mfma_f32_32x32x16_bf16 v[32:47], a[108:111], v[196:199], v[32:47]
    buffer_load_dwordx4 v[108:111], v5, s[40:43], s56 offen offset:3072 sc1
    s_waitcnt vmcnt(9)
    v_mfma_f32_32x32x16_bf16 v[16:31], a[112:115], v[200:203], v[16:31]
    v_mfma_f32_32x32x16_bf16 v[32:47], a[116:119], v[200:203], v[32:47]
    s_add_u32 s56, s72, s96
    buffer_load_dwordx4 v[112:115], v5, s[40:43], s56 offen offset:0 sc1
    s_waitcnt vmcnt(9)
    v_mfma_f32_32x32x16_bf16 v[16:31], a[120:123], v[204:207], v[16:31]
    v_mfma_f32_32x32x16_bf16 v[32:47], a[124:127], v[204:207], v[32:47]
    buffer_load_dwordx4 v[116:119], v5, s[40:43], s56 offen offset:1024 sc1
    s_waitcnt vmcnt(9)
    v_mfma_f32_32x32x16_bf16 v[48:63], a[128:131], v[80:83], v[48:63]
    v_mfma_f32_32x32x16_bf16 v[64:79], a[132:135], v[80:83], 0
    s_nop 7
    ds_write_b128 v235, v[40:43] offset:0
    ds_write_b128 v235, v[44:47] offset:1024
    ds_write_b128 v234, v[32:35] offset:0
    buffer_load_dwordx4 v[120:123], v5, s[40:43], s56 offen offset:2048 sc1
    s_waitcnt vmcnt(9)
    v_mfma_f32_32x32x16_bf16 v[48:63], a[136:139], v[84:87], v[48:63]
    v_mfma_f32_32x32x16_bf16 v[64:79], a[140:143], v[84:87], v[64:79]
    ds_write_b128 v234, v[36:39] offset:1024
    ds_write_b128 v233, v[24:27] offset:0
    ds_write_b128 v233, v[28:31] offset:1024
    buffer_load_dwordx4 v[124:127], v5, s[40:43], s56 offen offset:3072 sc1
    s_waitcnt vmcnt(9)
    v_mfma_f32_32x32x16_bf16 v[48:63], a[144:147], v[88:91], v[48:63]
    v_mfma_f32_32x32x16_bf16 v[64:79], a[148:151], v[88:91], v[64:79]
    s_waitcnt lgkmcnt(0)
    s_barrier
    ds_read_b128 v[24:27], v232 offset:0
    ds_read_b128 v[32:35], v232 offset:2048
    ds_read_b128 v[40:43], v232 offset:4096
    ds_read_b128 v[28:31], v232 offset:1024
    ds_read_b128 v[36:39], v232 offset:3072
    ds_read_b128 v[44:47], v232 offset:5120
    s_add_u32 s56, s72, s97
    buffer_load_dwordx4 v[128:131], v5, s[40:43], s56 offen offset:0 sc1
    s_waitcnt vmcnt(9)
    v_mfma_f32_32x32x16_bf16 v[48:63], a[152:155], v[92:95], v[48:63]
    v_mfma_f32_32x32x16_bf16 v[64:79], a[156:159], v[92:95], v[64:79]
    buffer_load_dwordx4 v[132:135], v5, s[40:43], s56 offen offset:1024 sc1
    s_waitcnt vmcnt(9)
    v_mfma_f32_32x32x16_bf16 v[48:63], a[160:163], v[96:99], v[48:63]
    v_mfma_f32_32x32x16_bf16 v[64:79], a[164:167], v[96:99], v[64:79]
    v_mov_b32 v211, s88
    s_waitcnt lgkmcnt(4)
    v_add_f32 v24, v24, v32
    s_waitcnt lgkmcnt(3)
    v_add_f32 v16, v16, v40
    v_add_f32 v25, v25, v33
    v_add_f32 v17, v17, v41
    v_add_f32 v26, v26, v34
    v_add_f32 v18, v18, v42
    v_add_f32 v27, v27, v35
    v_add_f32 v19, v19, v43
    s_waitcnt lgkmcnt(1)
    v_add_f32 v28, v28, v36
    s_waitcnt lgkmcnt(0)
    v_add_f32 v20, v20, v44
    v_add_f32 v29, v29, v37
    v_add_f32 v21, v21, v45
    v_add_f32 v30, v30, v38
    v_add_f32 v22, v22, v46
    v_add_f32 v31, v31, v39
    buffer_load_dwordx4 v[136:139], v5, s[40:43], s56 offen offset:2048 sc1
    s_waitcnt vmcnt(9)
    v_mfma_f32_32x32x16_bf16 v[48:63], a[168:171], v[100:103], v[48:63]
    v_mfma_f32_32x32x16_bf16 v[64:79], a[172:175], v[100:103], v[64:79]
    v_add_f32 v23, v23, v47
    v_add_f32 v16, v16, v24
    v_add_f32 v17, v17, v25
    v_add_f32 v18, v18, v26
    v_add_f32 v19, v19, v27
    v_add_f32 v20, v20, v28
    v_add_f32 v21, v21, v29
    v_add_f32 v22, v22, v30
    v_add_f32 v23, v23, v31
    v_mul_f32 v24, v16, v16
    v_mul_f32 v25, v17, v17
    v_mul_f32 v26, v18, v18
    v_mul_f32 v27, v19, v19
    v_mul_f32 v28, v20, v20
    v_mul_f32_e64 v29, v21, v21
    v_mul_f32 v30, v22, v22
    buffer_load_dwordx4 v[140:143], v5, s[40:43], s56 offen offset:3072 sc1
    s_waitcnt vmcnt(9)
    v_mfma_f32_32x32x16_bf16 v[48:63], a[176:179], v[104:107], v[48:63]
    v_mfma_f32_32x32x16_bf16 v[64:79], a[180:183], v[104:107], v[64:79]
    v_mul_f32_e64 v31, v23, v23
    v_fma_f32 v24, v24, s90, v211
    v_fma_f32 v25, v25, s90, v211
    v_fma_f32 v26, v26, s90, v211
    v_fma_f32 v27, v27, s90, v211
    v_fma_f32 v28, v28, s90, v211
    v_fma_f32 v29, v29, s90, v211
    v_fma_f32 v30, v30, s90, v211
    v_fma_f32 v31, v31, s90, v211
    v_mul_f32 v24, v24, v16
    v_mul_f32 v25, v25, v17
    v_mul_f32 v26, v26, v18
    v_mul_f32 v27, v27, v19
    v_mul_f32 v28, v28, v20
    v_mul_f32 v29, v29, v21
    v_mul_f32_e64 v30, v30, v22
    s_add_u32 s56, s72, s98
    buffer_load_dwordx4 v[144:147], v5, s[40:43], s56 offen offset:0 sc1
    s_waitcnt vmcnt(9)
    v_mfma_f32_32x32x16_bf16 v[48:63], a[184:187], v[108:111], v[48:63]
    v_mfma_f32_32x32x16_bf16 v[64:79], a[188:191], v[108:111], v[64:79]
    v_mul_f32 v31, v31, v23
    v_exp_f32 v24, v24
    v_exp_f32 v25, v25
    v_exp_f32 v26, v26
    v_exp_f32 v27, v27
    v_exp_f32 v28, v28
    v_exp_f32 v29, v29
    v_exp_f32 v30, v30
    v_exp_f32 v31, v31
    v_add_f32 v24, 1.0, v24
    v_add_f32 v25, 1.0, v25
    v_add_f32 v26, 1.0, v26
    v_add_f32 v27, 1.0, v27
    v_add_f32 v28, 1.0, v28
    v_add_f32 v29, 1.0, v29
    v_add_f32 v30, 1.0, v30
    ds_read_b64_tr_b16 a[128:129], v217 offset:24576
    ds_read_b64_tr_b16 a[130:131], v217 offset:25600
    ds_read_b64_tr_b16 a[132:133], v218 offset:24576
    ds_read_b64_tr_b16 a[134:135], v218 offset:25600
    ds_read_b64_tr_b16 a[136:137], v217 offset:26624
    ds_read_b64_tr_b16 a[138:139], v217 offset:27648
    ds_read_b64_tr_b16 a[140:141], v218 offset:26624
    ds_read_b64_tr_b16 a[142:143], v218 offset:27648
    buffer_load_dwordx4 v[148:151], v5, s[40:43], s56 offen offset:1024 sc1
    s_waitcnt vmcnt(9)
    v_mfma_f32_32x32x16_bf16 v[48:63], a[192:195], v[112:115], v[48:63]
    v_mfma_f32_32x32x16_bf16 v[64:79], a[196:199], v[112:115], v[64:79]
    v_add_f32 v31, 1.0, v31
    v_rcp_f32 v24, v24
    v_rcp_f32 v25, v25
    v_rcp_f32 v26, v26
    v_rcp_f32 v27, v27
    v_rcp_f32 v28, v28
    v_rcp_f32 v29, v29
    v_rcp_f32 v30, v30
    v_rcp_f32 v31, v31
    v_mul_f32 v24, v24, v16
    v_mul_f32 v25, v25, v17
    v_mul_f32 v26, v26, v18
    v_mul_f32 v27, v27, v19
    v_mul_f32 v28, v28, v20
    v_mul_f32 v29, v29, v21
    v_mul_f32_e64 v30, v30, v22
    ds_read_b64_tr_b16 a[144:145], v217 offset:28672
    ds_read_b64_tr_b16 a[146:147], v217 offset:29696
    ds_read_b64_tr_b16 a[148:149], v218 offset:28672
    ds_read_b64_tr_b16 a[150:151], v218 offset:29696
    ds_read_b64_tr_b16 a[152:153], v217 offset:30720
    ds_read_b64_tr_b16 a[154:155], v217 offset:31744
    ds_read_b64_tr_b16 a[156:157], v218 offset:30720
    ds_read_b64_tr_b16 a[158:159], v218 offset:31744
    buffer_load_dwordx4 v[152:155], v5, s[40:43], s56 offen offset:2048 sc1
    s_waitcnt vmcnt(9)
    v_mfma_f32_32x32x16_bf16 v[48:63], a[200:203], v[116:119], v[48:63]
    v_mfma_f32_32x32x16_bf16 v[64:79], a[204:207], v[116:119], v[64:79]
    v_mul_f32 v31, v31, v23
    v_cvt_pk_bf16_f32 v32, v24, v25
    v_cvt_pk_bf16_f32 v33, v26, v27
    v_cvt_pk_bf16_f32 v34, v28, v29
    v_cvt_pk_bf16_f32 v35, v30, v31
    buffer_store_dwordx4 v[32:35], v5, s[40:43], s57 offen sc1
    ds_read_b64_tr_b16 a[160:161], v217 offset:32768
    ds_read_b64_tr_b16 a[162:163], v217 offset:33792
    ds_read_b64_tr_b16 a[164:165], v218 offset:32768
    ds_read_b64_tr_b16 a[166:167], v218 offset:33792
    ds_read_b64_tr_b16 a[168:169], v217 offset:34816
    ds_read_b64_tr_b16 a[170:171], v217 offset:35840
    ds_read_b64_tr_b16 a[172:173], v218 offset:34816
    ds_read_b64_tr_b16 a[174:175], v218 offset:35840
    buffer_load_dwordx4 v[156:159], v5, s[40:43], s56 offen offset:3072 sc1
    s_waitcnt vmcnt(10)
    v_mfma_f32_32x32x16_bf16 v[48:63], a[208:211], v[120:123], v[48:63]
    v_mfma_f32_32x32x16_bf16 v[64:79], a[212:215], v[120:123], v[64:79]
    ds_read_b64_tr_b16 a[176:177], v217 offset:12288
    ds_read_b64_tr_b16 a[178:179], v217 offset:13312
    ds_read_b64_tr_b16 a[180:181], v218 offset:12288
    ds_read_b64_tr_b16 a[182:183], v218 offset:13312
    ds_read_b64_tr_b16 a[184:185], v217 offset:14336
    ds_read_b64_tr_b16 a[186:187], v217 offset:15360
    ds_read_b64_tr_b16 a[188:189], v218 offset:14336
    ds_read_b64_tr_b16 a[190:191], v218 offset:15360
    s_and_b32 s60, s3, 1
    s_cmp_eq_u32 s60, 0
    s_cselect_b32 s60, 1.0, 0
    v_lshlrev_b32 v16, 16, v224
    v_and_b32 v17, s91, v224
    v_lshlrev_b32 v208, 16, v240
    v_and_b32 v209, s91, v240
    v_add_f32_e64 v16, v16, v208
    s_add_u32 s56, s72, s99
    buffer_load_dwordx4 v[160:163], v5, s[40:43], s56 offen offset:0 sc1
    s_waitcnt vmcnt(10)
    v_mfma_f32_32x32x16_bf16 v[48:63], a[216:219], v[124:127], v[48:63]
    v_mfma_f32_32x32x16_bf16 v[64:79], a[220:223], v[124:127], v[64:79]
    ds_read_b64_tr_b16 a[192:193], v217 offset:16384
    ds_read_b64_tr_b16 a[194:195], v217 offset:17408
    ds_read_b64_tr_b16 a[196:197], v218 offset:16384
    ds_read_b64_tr_b16 a[198:199], v218 offset:17408
    ds_read_b64_tr_b16 a[200:201], v217 offset:18432
    ds_read_b64_tr_b16 a[202:203], v217 offset:19456
    ds_read_b64_tr_b16 a[204:205], v218 offset:18432
    ds_read_b64_tr_b16 a[206:207], v218 offset:19456
    v_add_f32 v17, v17, v209
    v_mul_f32 v16, s60, v16
    v_mul_f32 v17, s60, v17
    v_lshlrev_b32 v18, 16, v225
    v_and_b32_e64 v19, s91, v225
    v_lshlrev_b32 v210, 16, v241
    buffer_load_dwordx4 v[164:167], v5, s[40:43], s56 offen offset:1024 sc1
    s_waitcnt vmcnt(10)
    v_mfma_f32_32x32x16_bf16 v[48:63], a[224:227], v[128:131], v[48:63]
    v_mfma_f32_32x32x16_bf16 v[64:79], a[228:231], v[128:131], v[64:79]
    ds_read_b64_tr_b16 a[208:209], v217 offset:20480
    ds_read_b64_tr_b16 a[210:211], v217 offset:21504
    ds_read_b64_tr_b16 a[212:213], v218 offset:20480
    ds_read_b64_tr_b16 a[214:215], v218 offset:21504
    ds_read_b64_tr_b16 a[216:217], v217 offset:22528
    ds_read_b64_tr_b16 a[218:219], v217 offset:23552
    ds_read_b64_tr_b16 a[220:221], v218 offset:22528
    ds_read_b64_tr_b16 a[222:223], v218 offset:23552
    s_waitcnt lgkmcnt(15)
    s_add_u32 m0, s70, 24576
    s_mul_i32 s73, s51, 64
    s_add_u32 s73, s73, 0
    buffer_load_dwordx4 v214, s[24:27], s73 offen lds
    s_add_u32 m0, s70, 25600
    s_mul_i32 s73, s51, 64
    s_add_u32 s73, s73, 32768
    buffer_load_dwordx4 v214, s[24:27], s73 offen lds
    v_and_b32 v211, s91, v241
    v_add_f32 v18, v18, v210
    v_add_f32 v19, v19, v211
    v_mul_f32 v18, s60, v18
    v_mul_f32 v19, s60, v19
    v_lshlrev_b32 v20, 16, v226
    buffer_load_dwordx4 v[168:171], v5, s[40:43], s56 offen offset:2048 sc1
    s_waitcnt vmcnt(12)
    v_mfma_f32_32x32x16_bf16 v[48:63], a[232:235], v[132:135], v[48:63]
    v_mfma_f32_32x32x16_bf16 v[64:79], a[236:239], v[132:135], v[64:79]
    s_waitcnt vmcnt(6)
    v_mov_b32 v8, s4
    s_mov_b64 exec, 1
    buffer_store_dword v8, v9, s[40:43], s82 offen sc1
    s_mov_b64 exec, -1
    s_add_u32 m0, s70, 26624
    s_mul_i32 s73, s51, 64
    s_add_u32 s73, s73, 65536
    buffer_load_dwordx4 v214, s[24:27], s73 offen lds
    s_add_u32 m0, s70, 27648
    s_mul_i32 s73, s51, 64
    s_add_u32 s73, s73, 98304
    buffer_load_dwordx4 v214, s[24:27], s73 offen lds
    v_and_b32 v21, s91, v226
    v_lshlrev_b32 v208, 16, v242
    v_and_b32 v209, s91, v242
    v_add_f32 v20, v20, v208
    v_add_f32 v21, v21, v209
    v_mul_f32_e64 v20, s60, v20
    buffer_load_dwordx4 v[172:175], v5, s[40:43], s56 offen offset:3072 sc1
    v_mfma_f32_32x32x16_bf16 v[48:63], a[240:243], v[136:139], v[48:63]
    v_mfma_f32_32x32x16_bf16 v[64:79], a[244:247], v[136:139], v[64:79]
    s_add_u32 m0, s70, 28672
    s_mul_i32 s73, s51, 64
    s_add_u32 s73, s73, 131072
    buffer_load_dwordx4 v214, s[24:27], s73 offen lds
    s_add_u32 m0, s70, 29696
    s_mul_i32 s73, s51, 64
    s_add_u32 s73, s73, 163840
    buffer_load_dwordx4 v214, s[24:27], s73 offen lds
    v_mul_f32 v21, s60, v21
    v_lshlrev_b32 v22, 16, v227
    v_and_b32 v23, s91, v227
    v_lshlrev_b32 v210, 16, v243
    v_and_b32_e64 v211, s91, v243
    v_add_f32 v22, v22, v210
    s_add_u32 s56, s72, s100
    buffer_load_dwordx4 v[176:179], v5, s[40:43], s56 offen offset:0 sc1
    v_mfma_f32_32x32x16_bf16 v[48:63], a[248:251], v[140:143], v[48:63]
    v_mfma_f32_32x32x16_bf16 v[64:79], a[252:255], v[140:143], v[64:79]
    s_add_u32 m0, s70, 30720
    s_mul_i32 s73, s51, 64
    s_add_u32 s73, s73, 196608
    buffer_load_dwordx4 v214, s[24:27], s73 offen lds
    s_add_u32 m0, s70, 31744
    s_mul_i32 s73, s51, 64
    s_add_u32 s73, s73, 229376
    buffer_load_dwordx4 v214, s[24:27], s73 offen lds
    v_add_f32 v23, v23, v211
    v_mul_f32 v22, s60, v22
    v_mul_f32 v23, s60, v23
    v_lshlrev_b32 v24, 16, v228
    v_and_b32 v25, s91, v228
    v_lshlrev_b32 v208, 16, v244
    buffer_load_dwordx4 v[180:183], v5, s[40:43], s56 offen offset:1024 sc1
    v_mfma_f32_32x32x16_bf16 v[48:63], a[0:3], v[144:147], v[48:63]
    v_mfma_f32_32x32x16_bf16 v[64:79], a[4:7], v[144:147], v[64:79]
    s_add_u32 m0, s70, 32768
    s_mul_i32 s73, s52, 64
    s_add_u32 s73, s73, 0
    buffer_load_dwordx4 v214, s[24:27], s73 offen lds
    s_add_u32 m0, s70, 33792
    s_mul_i32 s73, s52, 64
    s_add_u32 s73, s73, 32768
    buffer_load_dwordx4 v214, s[24:27], s73 offen lds
    v_and_b32 v209, s91, v244
    v_add_f32 v24, v24, v208
    v_add_f32 v25, v25, v209
    v_mul_f32 v24, s60, v24
    v_mul_f32 v25, s60, v25
    v_lshlrev_b32_e64 v26, 16, v229
    buffer_load_dwordx4 v[184:187], v5, s[40:43], s56 offen offset:2048 sc1
    v_mfma_f32_32x32x16_bf16 v[48:63], a[8:11], v[148:151], v[48:63]
    v_mfma_f32_32x32x16_bf16 v[64:79], a[12:15], v[148:151], v[64:79]
    s_add_u32 m0, s70, 34816
    s_mul_i32 s73, s52, 64
    s_add_u32 s73, s73, 65536
    buffer_load_dwordx4 v214, s[24:27], s73 offen lds
    s_add_u32 m0, s70, 35840
    s_mul_i32 s73, s52, 64
    s_add_u32 s73, s73, 98304
    buffer_load_dwordx4 v214, s[24:27], s73 offen lds
    v_and_b32 v27, s91, v229
    v_lshlrev_b32 v210, 16, v245
    v_and_b32 v211, s91, v245
    v_add_f32 v26, v26, v210
    v_add_f32 v27, v27, v211
    v_mul_f32 v26, s60, v26
    buffer_load_dwordx4 v[188:191], v5, s[40:43], s56 offen offset:3072 sc1
    v_mfma_f32_32x32x16_bf16 v[48:63], a[16:19], v[152:155], v[48:63]
    v_mfma_f32_32x32x16_bf16 v[64:79], a[20:23], v[152:155], v[64:79]
    s_add_u32 m0, s70, 12288
    s_mul_i32 s73, s52, 64
    s_add_u32 s73, s73, 131072
    buffer_load_dwordx4 v214, s[24:27], s73 offen lds
    s_add_u32 m0, s70, 13312
    s_mul_i32 s73, s52, 64
    s_add_u32 s73, s73, 163840
    buffer_load_dwordx4 v214, s[24:27], s73 offen lds
    v_mul_f32 v27, s60, v27
    v_lshlrev_b32 v28, 16, v230
    v_and_b32 v29, s91, v230
    v_lshlrev_b32 v208, 16, v246
    v_and_b32 v209, s91, v246
    v_add_f32 v28, v28, v208
    buffer_load_dword v248, v12, s[40:43], s85 offen offset:0 sc1
    s_add_u32 s56, s72, s101
    buffer_load_dwordx4 v[192:195], v5, s[40:43], s56 offen offset:0 sc1
    s_waitcnt vmcnt(25)
    v_mfma_f32_32x32x16_bf16 v[48:63], a[24:27], v[156:159], v[48:63]
    v_mfma_f32_32x32x16_bf16 v[64:79], a[28:31], v[156:159], v[64:79]
    s_add_u32 m0, s70, 14336
    s_mul_i32 s73, s52, 64
    s_add_u32 s73, s73, 196608
    buffer_load_dwordx4 v214, s[24:27], s73 offen lds
    s_add_u32 m0, s70, 15360
    s_mul_i32 s73, s52, 64
    s_add_u32 s73, s73, 229376
    buffer_load_dwordx4 v214, s[24:27], s73 offen lds
    v_add_f32 v29, v29, v209
    v_mul_f32 v28, s60, v28
    v_mul_f32 v29, s60, v29
    v_lshlrev_b32 v30, 16, v231
    v_and_b32 v31, s91, v231
    v_lshlrev_b32 v210, 16, v247
    buffer_load_dwordx4 v[196:199], v5, s[40:43], s56 offen offset:1024 sc1
    s_waitcnt vmcnt(27)
    v_mfma_f32_32x32x16_bf16 v[48:63], a[32:35], v[160:163], v[48:63]
    v_mfma_f32_32x32x16_bf16 v[64:79], a[36:39], v[160:163], v[64:79]
    s_waitcnt vmcnt(24)
    ds_read_b64_tr_b16 a[224:225], v217 offset:24576
    ds_read_b64_tr_b16 a[226:227], v217 offset:25600
    ds_read_b64_tr_b16 a[228:229], v218 offset:24576
    ds_read_b64_tr_b16 a[230:231], v218 offset:25600
    v_and_b32 v211, s91, v247
    v_add_f32 v30, v30, v210
    v_add_f32 v31, v31, v211
    v_mul_f32 v30, s60, v30
    v_mul_f32 v31, s60, v31
    buffer_load_dwordx4 v[200:203], v5, s[40:43], s56 offen offset:2048 sc1
    v_mfma_f32_32x32x16_bf16 v[48:63], a[40:43], v[164:167], v[48:63]
    v_mfma_f32_32x32x16_bf16 v[64:79], a[44:47], v[164:167], v[64:79]
    s_waitcnt vmcnt(21)
    ds_read_b64_tr_b16 a[232:233], v217 offset:26624
    ds_read_b64_tr_b16 a[234:235], v217 offset:27648
    ds_read_b64_tr_b16 a[236:237], v218 offset:26624
    ds_read_b64_tr_b16 a[238:239], v218 offset:27648
    buffer_load_dwordx4 v[204:207], v5, s[40:43], s56 offen offset:3072 sc1
    v_mfma_f32_32x32x16_bf16 v[48:63], a[48:51], v[168:171], v[48:63]
    v_mfma_f32_32x32x16_bf16 v[64:79], a[52:55], v[168:171], v[64:79]
    s_waitcnt vmcnt(19)
    ds_read_b64_tr_b16 a[240:241], v217 offset:28672
    ds_read_b64_tr_b16 a[242:243], v217 offset:29696
    ds_read_b64_tr_b16 a[244:245], v218 offset:28672
    ds_read_b64_tr_b16 a[246:247], v218 offset:29696
    s_waitcnt vmcnt(6)
    v_cmp_ne_u32_e64 vcc, s4, v248
    s_nop 1
    s_cbranch_vccz Lpcd_P_11
    s_nop 1
Lpc_P_10:
    s_sub_u32 s6, s6, 1
    s_cbranch_scc1 L_end_P
    buffer_load_dword v248, v12, s[40:43], s85 offen offset:0 sc1
    s_waitcnt vmcnt(0)
    v_cmp_ne_u32 vcc, s4, v248
    s_nop 1
    s_cbranch_vccnz Lpc_P_10
Lpcd_P_11:
    s_add_u32 s56, s58, s48
    buffer_load_dwordx4 v[80:83], v4, s[40:43], s56 offen offset:0 sc1
    v_mfma_f32_32x32x16_bf16 v[48:63], a[56:59], v[172:175], v[48:63]
    v_mfma_f32_32x32x16_bf16 v[64:79], a[60:63], v[172:175], v[64:79]
    ds_read_b64_tr_b16 a[248:249], v217 offset:30720
    ds_read_b64_tr_b16 a[250:251], v217 offset:31744
    ds_read_b64_tr_b16 a[252:253], v218 offset:30720
    ds_read_b64_tr_b16 a[254:255], v218 offset:31744
    buffer_load_dwordx4 v[84:87], v4, s[40:43], s56 offen offset:1024 sc1
    v_mfma_f32_32x32x16_bf16 v[48:63], a[64:67], v[176:179], v[48:63]
    v_mfma_f32_32x32x16_bf16 v[64:79], a[68:71], v[176:179], v[64:79]
    ds_read_b64_tr_b16 a[0:1], v217 offset:32768
    ds_read_b64_tr_b16 a[2:3], v217 offset:33792
    ds_read_b64_tr_b16 a[4:5], v218 offset:32768
    ds_read_b64_tr_b16 a[6:7], v218 offset:33792
    buffer_load_dwordx4 v[88:91], v4, s[40:43], s56 offen offset:2048 sc1
    v_mfma_f32_32x32x16_bf16 v[48:63], a[72:75], v[180:183], v[48:63]
    v_mfma_f32_32x32x16_bf16 v[64:79], a[76:79], v[180:183], v[64:79]
    ds_read_b64_tr_b16 a[8:9], v217 offset:34816
    ds_read_b64_tr_b16 a[10:11], v217 offset:35840
    ds_read_b64_tr_b16 a[12:13], v218 offset:34816
    ds_read_b64_tr_b16 a[14:15], v218 offset:35840
    buffer_load_dwordx4 v[92:95], v4, s[40:43], s56 offen offset:3072 sc1
    v_mfma_f32_32x32x16_bf16 v[48:63], a[80:83], v[184:187], v[48:63]
    v_mfma_f32_32x32x16_bf16 v[64:79], a[84:87], v[184:187], v[64:79]
    ds_read_b64_tr_b16 a[16:17], v217 offset:12288
    ds_read_b64_tr_b16 a[18:19], v217 offset:13312
    ds_read_b64_tr_b16 a[20:21], v218 offset:12288
    ds_read_b64_tr_b16 a[22:23], v218 offset:13312
    s_add_u32 s56, s58, s49
    buffer_load_dwordx4 v[96:99], v4, s[40:43], s56 offen offset:0 sc1
    v_mfma_f32_32x32x16_bf16 v[48:63], a[88:91], v[188:191], v[48:63]
    v_mfma_f32_32x32x16_bf16 v[64:79], a[92:95], v[188:191], v[64:79]
    s_waitcnt vmcnt(8)
    ds_read_b64_tr_b16 a[24:25], v217 offset:14336
    ds_read_b64_tr_b16 a[26:27], v217 offset:15360
    ds_read_b64_tr_b16 a[28:29], v218 offset:14336
    ds_read_b64_tr_b16 a[30:31], v218 offset:15360
    buffer_load_dwordx4 v[100:103], v4, s[40:43], s56 offen offset:1024 sc1
    buffer_load_dwordx4 v[104:107], v4, s[40:43], s56 offen offset:2048 sc1
    buffer_load_dwordx4 v[108:111], v4, s[40:43], s56 offen offset:3072 sc1
    s_add_u32 s56, s58, s50
    buffer_load_dwordx4 v[112:115], v4, s[40:43], s56 offen offset:0 sc1
    v_mfma_f32_32x32x16_bf16 v[64:79], a[100:103], v[192:195], v[64:79]
    s_waitcnt vmcnt(11)
    v_mfma_f32_32x32x16_bf16 v[64:79], a[108:111], v[196:199], v[64:79]
    s_waitcnt vmcnt(10)
    v_mfma_f32_32x32x16_bf16 v[64:79], a[116:119], v[200:203], v[64:79]
    s_waitcnt vmcnt(9)
    v_mfma_f32_32x32x16_bf16 v[64:79], a[124:127], v[204:207], v[64:79]
    v_mfma_f32_32x32x16_bf16 v[48:63], a[96:99], v[192:195], v[48:63]
    v_mfma_f32_32x32x16_bf16 v[48:63], a[104:107], v[196:199], v[48:63]
    s_nop 9
    ds_write_b128 v235, v[72:75] offset:6144
    ds_write_b128 v235, v[76:79] offset:7168
    v_mfma_f32_32x32x16_bf16 v[48:63], a[112:115], v[200:203], v[48:63]
    ds_write_b128 v234, v[64:67] offset:6144
    ds_write_b128 v234, v[68:71] offset:7168
    v_mfma_f32_32x32x16_bf16 v[48:63], a[120:123], v[204:207], v[48:63]
    s_nop 11
    ds_write_b128 v233, v[56:59] offset:6144
    ds_write_b128 v233, v[60:63] offset:7168
    s_waitcnt lgkmcnt(0)
    s_barrier
    ds_read_b128 v[56:59], v232 offset:6144
    ds_read_b128 v[64:67], v232 offset:8192
    ds_read_b128 v[72:75], v232 offset:10240
    ds_read_b128 v[60:63], v232 offset:7168
    ds_read_b128 v[68:71], v232 offset:9216
    ds_read_b128 v[76:79], v232 offset:11264
    v_mov_b32_e64 v211, s88
    s_waitcnt lgkmcnt(4)
    v_pk_add_f32 v[56:57], v[56:57], v[64:65]
    s_waitcnt lgkmcnt(3)
    v_pk_add_f32 v[48:49], v[48:49], v[72:73]
    v_pk_add_f32 v[58:59], v[58:59], v[66:67]
    v_pk_add_f32 v[50:51], v[50:51], v[74:75]
    s_waitcnt lgkmcnt(1)
    v_pk_add_f32 v[60:61], v[60:61], v[68:69]
    s_waitcnt lgkmcnt(0)
    v_pk_add_f32 v[52:53], v[52:53], v[76:77]
    v_pk_add_f32 v[62:63], v[62:63], v[70:71]
    v_pk_add_f32 v[54:55], v[54:55], v[78:79]
    v_pk_add_f32 v[48:49], v[48:49], v[56:57]
    v_pk_add_f32 v[50:51], v[50:51], v[58:59]
    v_pk_add_f32 v[52:53], v[52:53], v[60:61]
    v_pk_add_f32 v[54:55], v[54:55], v[62:63]
    v_pk_mul_f32 v[56:57], v[48:49], v[48:49]
    v_pk_mul_f32 v[58:59], v[50:51], v[50:51]
    v_pk_mul_f32 v[60:61], v[52:53], v[52:53]
    v_pk_mul_f32 v[62:63], v[54:55], v[54:55]
    v_fma_f32 v56, v56, s90, v211
    v_fma_f32 v57, v57, s90, v211
    v_fma_f32 v58, v58, s90, v211
    v_fma_f32 v59, v59, s90, v211
    v_fma_f32 v60, v60, s90, v211
    v_fma_f32 v61, v61, s90, v211
    v_fma_f32 v62, v62, s90, v211
    v_fma_f32 v63, v63, s90, v211
    v_pk_mul_f32 v[56:57], v[56:57], v[48:49]
    v_pk_mul_f32 v[58:59], v[58:59], v[50:51]
    v_pk_mul_f32 v[60:61], v[60:61], v[52:53]
    v_pk_mul_f32 v[62:63], v[62:63], v[54:55]
    v_exp_f32 v56, v56
    v_exp_f32 v57, v57
    v_exp_f32 v58, v58
    v_exp_f32 v59, v59
    v_exp_f32 v60, v60
    v_exp_f32 v61, v61
    v_exp_f32 v62, v62
    v_exp_f32 v63, v63
    v_add_f32 v56, 1.0, v56
    v_add_f32 v57, 1.0, v57
    v_add_f32 v58, 1.0, v58
    v_add_f32 v59, 1.0, v59
    v_add_f32 v60, 1.0, v60
    v_add_f32 v61, 1.0, v61
    v_add_f32 v62, 1.0, v62
    v_add_f32 v63, 1.0, v63
    v_rcp_f32 v56, v56
    v_rcp_f32 v57, v57
    v_rcp_f32 v58, v58
    v_rcp_f32 v59, v59
    v_rcp_f32 v60, v60
    v_rcp_f32 v61, v61
    v_rcp_f32 v62, v62
    v_rcp_f32 v63, v63
    v_mul_f32 v56, v56, v48
    v_mul_f32 v57, v57, v49
    v_mul_f32 v58, v58, v50
    v_mul_f32 v59, v59, v51
    v_mul_f32 v60, v60, v52
    v_mul_f32 v61, v61, v53
    v_mul_f32 v62, v62, v54
    v_mul_f32 v63, v63, v55
    v_cvt_pk_bf16_f32 v64, v56, v57
    v_cvt_pk_bf16_f32 v65, v58, v59
    v_cvt_pk_bf16_f32 v66, v60, v61
    v_cvt_pk_bf16_f32 v67, v62, v63
    s_add_u32 s57, s57, 114688
    buffer_store_dwordx4 v[64:67], v5, s[40:43], s57 offen sc1
    s_add_u32 s82, s82, 4096
    s_add_u32 s85, s85, 4096
    buffer_load_dwordx4 v[116:119], v4, s[40:43], s56 offen offset:1024 sc1
    s_waitcnt vmcnt(10)
    v_mfma_f32_32x32x16_bf16 v[16:31], a[128:131], v[80:83], v[16:31]
    v_mfma_f32_32x32x16_bf16 v[32:47], a[132:135], v[80:83], 0
    s_add_u32 m0, s70, 16384
    s_mul_i32 s73, s53, 64
    s_add_u32 s73, s73, 0
    buffer_load_dwordx4 v214, s[24:27], s73 offen lds
    s_add_u32 m0, s70, 17408
    s_mul_i32 s73, s53, 64
    s_add_u32 s73, s73, 32768
    buffer_load_dwordx4 v214, s[24:27], s73 offen lds
    buffer_load_dwordx4 v[120:123], v4, s[40:43], s56 offen offset:2048 sc1
    s_waitcnt vmcnt(12)
    v_mfma_f32_32x32x16_bf16 v[16:31], a[136:139], v[84:87], v[16:31]
    v_mfma_f32_32x32x16_bf16 v[32:47], a[140:143], v[84:87], v[32:47]
    s_add_u32 m0, s70, 18432
    s_mul_i32 s73, s53, 64
    s_add_u32 s73, s73, 65536
    buffer_load_dwordx4 v214, s[24:27], s73 offen lds
    s_add_u32 m0, s70, 19456
    s_mul_i32 s73, s53, 64
    s_add_u32 s73, s73, 98304
    buffer_load_dwordx4 v214, s[24:27], s73 offen lds
    buffer_load_dwordx4 v[124:127], v4, s[40:43], s56 offen offset:3072 sc1
    s_waitcnt vmcnt(14)
    v_mfma_f32_32x32x16_bf16 v[16:31], a[144:147], v[88:91], v[16:31]
    v_mfma_f32_32x32x16_bf16 v[32:47], a[148:151], v[88:91], v[32:47]
    s_add_u32 m0, s70, 20480
    s_mul_i32 s73, s53, 64
    s_add_u32 s73, s73, 131072
    buffer_load_dwordx4 v214, s[24:27], s73 offen lds
    s_add_u32 m0, s70, 21504
    s_mul_i32 s73, s53, 64
    s_add_u32 s73, s73, 163840
    buffer_load_dwordx4 v214, s[24:27], s73 offen lds
    s_add_u32 s56, s58, s51
    buffer_load_dwordx4 v[128:131], v4, s[40:43], s56 offen offset:0 sc1
    s_waitcnt vmcnt(16)
    v_mfma_f32_32x32x16_bf16 v[16:31], a[152:155], v[92:95], v[16:31]
    v_mfma_f32_32x32x16_bf16 v[32:47], a[156:159], v[92:95], v[32:47]
    s_add_u32 m0, s70, 22528
    s_mul_i32 s73, s53, 64
    s_add_u32 s73, s73, 196608
    buffer_load_dwordx4 v214, s[24:27], s73 offen lds
    s_add_u32 m0, s70, 23552
    s_mul_i32 s73, s53, 64
    s_add_u32 s73, s73, 229376
    buffer_load_dwordx4 v214, s[24:27], s73 offen lds
    buffer_load_dwordx4 v[132:135], v4, s[40:43], s56 offen offset:1024 sc1
    s_waitcnt vmcnt(18)
    v_mfma_f32_32x32x16_bf16 v[16:31], a[160:163], v[96:99], v[16:31]
    v_mfma_f32_32x32x16_bf16 v[32:47], a[164:167], v[96:99], v[32:47]
    s_add_u32 m0, s70, 24576
    s_mul_i32 s73, s54, 64
    s_add_u32 s73, s73, 0
    buffer_load_dwordx4 v214, s[24:27], s73 offen lds
    s_add_u32 m0, s70, 25600
    s_mul_i32 s73, s54, 64
    s_add_u32 s73, s73, 32768
    buffer_load_dwordx4 v214, s[24:27], s73 offen lds
    s_waitcnt vmcnt(15)
    v_mov_b32 v8, s4
    s_mov_b64 exec, 1
    buffer_store_dword v8, v9, s[40:43], s82 offen sc1
    s_mov_b64 exec, -1
    buffer_load_dwordx4 v[136:139], v4, s[40:43], s56 offen offset:2048 sc1
    v_mfma_f32_32x32x16_bf16 v[16:31], a[168:171], v[100:103], v[16:31]
    v_mfma_f32_32x32x16_bf16 v[32:47], a[172:175], v[100:103], v[32:47]
    s_add_u32 m0, s70, 26624
    s_mul_i32 s73, s54, 64
    s_add_u32 s73, s73, 65536
    buffer_load_dwordx4 v214, s[24:27], s73 offen lds
    s_add_u32 m0, s70, 27648
    s_mul_i32 s73, s54, 64
    s_add_u32 s73, s73, 98304
    buffer_load_dwordx4 v214, s[24:27], s73 offen lds
    buffer_load_dwordx4 v[140:143], v4, s[40:43], s56 offen offset:3072 sc1
    v_mfma_f32_32x32x16_bf16 v[16:31], a[176:179], v[104:107], v[16:31]
    v_mfma_f32_32x32x16_bf16 v[32:47], a[180:183], v[104:107], v[32:47]
    s_add_u32 m0, s70, 28672
    s_mul_i32 s73, s54, 64
    s_add_u32 s73, s73, 131072
    buffer_load_dwordx4 v214, s[24:27], s73 offen lds
    s_add_u32 m0, s70, 29696
    s_mul_i32 s73, s54, 64
    s_add_u32 s73, s73, 163840
    buffer_load_dwordx4 v214, s[24:27], s73 offen lds
    s_and_b32 s60, s3, 1
    s_cmp_eq_u32 s60, 1
    s_cselect_b32 s60, 1.0, 0
    v_lshlrev_b32 v48, 16, v224
    v_and_b32 v49, s91, v224
    v_lshlrev_b32 v208, 16, v240
    v_and_b32_e64 v209, s91, v240
    v_add_f32 v48, v48, v208
    s_add_u32 s56, s58, s52
    buffer_load_dwordx4 v[144:147], v4, s[40:43], s56 offen offset:0 sc1
    v_mfma_f32_32x32x16_bf16 v[16:31], a[184:187], v[108:111], v[16:31]
    v_mfma_f32_32x32x16_bf16 v[32:47], a[188:191], v[108:111], v[32:47]
    s_add_u32 m0, s70, 30720
    s_mul_i32 s73, s54, 64
    s_add_u32 s73, s73, 196608
    buffer_load_dwordx4 v214, s[24:27], s73 offen lds
    s_add_u32 m0, s70, 31744
    s_mul_i32 s73, s54, 64
    s_add_u32 s73, s73, 229376
    buffer_load_dwordx4 v214, s[24:27], s73 offen lds
    v_add_f32 v49, v49, v209
    v_mul_f32 v48, s60, v48
    v_mul_f32 v49, s60, v49
    v_lshlrev_b32 v50, 16, v225
    v_and_b32_e64 v51, s91, v225
    v_lshlrev_b32 v210, 16, v241
    buffer_load_dwordx4 v[148:151], v4, s[40:43], s56 offen offset:1024 sc1
    v_mfma_f32_32x32x16_bf16 v[16:31], a[192:195], v[112:115], v[16:31]
    v_mfma_f32_32x32x16_bf16 v[32:47], a[196:199], v[112:115], v[32:47]
    s_waitcnt vmcnt(23)
    ds_read_b64_tr_b16 a[32:33], v217 offset:16384
    ds_read_b64_tr_b16 a[34:35], v217 offset:17408
    ds_read_b64_tr_b16 a[36:37], v218 offset:16384
    ds_read_b64_tr_b16 a[38:39], v218 offset:17408
    v_and_b32 v211, s91, v241
    v_add_f32 v50, v50, v210
    v_add_f32 v51, v51, v211
    v_mul_f32 v50, s60, v50
    v_mul_f32_e64 v51, s60, v51
    v_lshlrev_b32 v52, 16, v226
    buffer_load_dwordx4 v[152:155], v4, s[40:43], s56 offen offset:2048 sc1
    v_mfma_f32_32x32x16_bf16 v[16:31], a[200:203], v[116:119], v[16:31]
    v_mfma_f32_32x32x16_bf16 v[32:47], a[204:207], v[116:119], v[32:47]
    s_waitcnt vmcnt(21)
    ds_read_b64_tr_b16 a[40:41], v217 offset:18432
    ds_read_b64_tr_b16 a[42:43], v217 offset:19456
    ds_read_b64_tr_b16 a[44:45], v218 offset:18432
    ds_read_b64_tr_b16 a[46:47], v218 offset:19456
    v_and_b32 v53, s91, v226
    v_lshlrev_b32 v208, 16, v242
    v_and_b32 v209, s91, v242
    v_add_f32 v52, v52, v208
    v_add_f32_e64 v53, v53, v209
    v_mul_f32 v52, s60, v52
    buffer_load_dwordx4 v[156:159], v4, s[40:43], s56 offen offset:3072 sc1
    v_mfma_f32_32x32x16_bf16 v[16:31], a[208:211], v[120:123], v[16:31]
    v_mfma_f32_32x32x16_bf16 v[32:47], a[212:215], v[120:123], v[32:47]
    s_waitcnt vmcnt(19)
    ds_read_b64_tr_b16 a[48:49], v217 offset:20480
    ds_read_b64_tr_b16 a[50:51], v217 offset:21504
    ds_read_b64_tr_b16 a[52:53], v218 offset:20480
    ds_read_b64_tr_b16 a[54:55], v218 offset:21504
    v_mul_f32 v53, s60, v53
    v_lshlrev_b32 v54, 16, v227
    v_and_b32 v55, s91, v227
    v_lshlrev_b32 v210, 16, v243
    v_and_b32 v211, s91, v243
    v_add_f32 v54, v54, v210
    s_add_u32 s56, s58, s53
    buffer_load_dwordx4 v[160:163], v4, s[40:43], s56 offen offset:0 sc1
    v_mfma_f32_32x32x16_bf16 v[16:31], a[216:219], v[124:127], v[16:31]
    v_mfma_f32_32x32x16_bf16 v[32:47], a[220:223], v[124:127], v[32:47]
    s_waitcnt vmcnt(17)
    ds_read_b64_tr_b16 a[56:57], v217 offset:22528
    ds_read_b64_tr_b16 a[58:59], v217 offset:23552
    ds_read_b64_tr_b16 a[60:61], v218 offset:22528
    ds_read_b64_tr_b16 a[62:63], v218 offset:23552
    v_add_f32 v55, v55, v211
    v_mul_f32 v54, s60, v54
    v_mul_f32 v55, s60, v55
    v_lshlrev_b32 v56, 16, v228
    v_and_b32_e64 v57, s91, v228
    v_lshlrev_b32 v208, 16, v244
    buffer_load_dwordx4 v[164:167], v4, s[40:43], s56 offen offset:1024 sc1
    v_mfma_f32_32x32x16_bf16 v[16:31], a[224:227], v[128:131], v[16:31]
    v_mfma_f32_32x32x16_bf16 v[32:47], a[228:231], v[128:131], v[32:47]
    s_waitcnt vmcnt(15)
    ds_read_b64_tr_b16 a[64:65], v217 offset:24576
    ds_read_b64_tr_b16 a[66:67], v217 offset:25600
    ds_read_b64_tr_b16 a[68:69], v218 offset:24576
    ds_read_b64_tr_b16 a[70:71], v218 offset:25600
    v_and_b32 v209, s91, v244
    v_add_f32 v56, v56, v208
    v_add_f32 v57, v57, v209
    v_mul_f32 v56, s60, v56
    v_mul_f32 v57, s60, v57
    v_lshlrev_b32 v58, 16, v229
    buffer_load_dword v248, v12, s[40:43], s85 offen offset:0 sc1
    buffer_load_dwordx4 v[168:171], v4, s[40:43], s56 offen offset:2048 sc1
    v_mfma_f32_32x32x16_bf16 v[16:31], a[232:235], v[132:135], v[16:31]
    v_mfma_f32_32x32x16_bf16 v[32:47], a[236:239], v[132:135], v[32:47]
    s_waitcnt vmcnt(13)
    ds_read_b64_tr_b16 a[72:73], v217 offset:26624
    ds_read_b64_tr_b16 a[74:75], v217 offset:27648
    ds_read_b64_tr_b16 a[76:77], v218 offset:26624
    ds_read_b64_tr_b16 a[78:79], v218 offset:27648
    v_and_b32 v59, s91, v229
    v_lshlrev_b32 v210, 16, v245
    v_and_b32 v211, s91, v245
    v_add_f32 v58, v58, v210
    v_add_f32 v59, v59, v211
    v_mul_f32 v58, s60, v58
    buffer_load_dwordx4 v[172:175], v4, s[40:43], s56 offen offset:3072 sc1
    v_mfma_f32_32x32x16_bf16 v[16:31], a[240:243], v[136:139], v[16:31]
    v_mfma_f32_32x32x16_bf16 v[32:47], a[244:247], v[136:139], v[32:47]
    s_waitcnt vmcnt(11)
    ds_read_b64_tr_b16 a[80:81], v217 offset:28672
    ds_read_b64_tr_b16 a[82:83], v217 offset:29696
    ds_read_b64_tr_b16 a[84:85], v218 offset:28672
    ds_read_b64_tr_b16 a[86:87], v218 offset:29696
    v_mul_f32 v59, s60, v59
    v_lshlrev_b32 v60, 16, v230
    v_and_b32 v61, s91, v230
    v_lshlrev_b32 v208, 16, v246
    v_and_b32 v209, s91, v246
    v_add_f32 v60, v60, v208
    s_add_u32 s56, s58, s54
    buffer_load_dwordx4 v[176:179], v4, s[40:43], s56 offen offset:0 sc1
    v_mfma_f32_32x32x16_bf16 v[16:31], a[248:251], v[140:143], v[16:31]
    v_mfma_f32_32x32x16_bf16 v[32:47], a[252:255], v[140:143], v[32:47]
    s_waitcnt vmcnt(9)
    ds_read_b64_tr_b16 a[88:89], v217 offset:30720
    ds_read_b64_tr_b16 a[90:91], v217 offset:31744
    ds_read_b64_tr_b16 a[92:93], v218 offset:30720
    ds_read_b64_tr_b16 a[94:95], v218 offset:31744
    v_add_f32 v61, v61, v209
    v_mul_f32 v60, s60, v60
    v_mul_f32 v61, s60, v61
    v_lshlrev_b32 v62, 16, v231
    v_and_b32 v63, s91, v231
    v_lshlrev_b32 v210, 16, v247
    buffer_load_dwordx4 v[180:183], v4, s[40:43], s56 offen offset:1024 sc1
    v_mfma_f32_32x32x16_bf16 v[16:31], a[0:3], v[144:147], v[16:31]
    v_mfma_f32_32x32x16_bf16 v[32:47], a[4:7], v[144:147], v[32:47]
    v_and_b32 v211, s91, v247
    v_add_f32 v62, v62, v210
    v_add_f32 v63, v63, v211
    v_mul_f32 v62, s60, v62
    v_mul_f32 v63, s60, v63
    s_waitcnt vmcnt(4)
    v_cmp_ne_u32 vcc, s4, v248
    s_nop 1
    s_cbranch_vccz Lpcd_P_13
    s_nop 1
Lpc_P_12:
    s_sub_u32 s6, s6, 1
    s_cbranch_scc1 L_end_P
    buffer_load_dword v248, v12, s[40:43], s85 offen offset:0 sc1
    s_waitcnt vmcnt(0)
    v_cmp_ne_u32 vcc, s4, v248
    s_nop 1
    s_cbranch_vccnz Lpc_P_12
Lpcd_P_13:
    buffer_load_dwordx4 v[184:187], v4, s[40:43], s56 offen offset:2048 sc1
    v_mfma_f32_32x32x16_bf16 v[16:31], a[8:11], v[148:151], v[16:31]
    v_mfma_f32_32x32x16_bf16 v[32:47], a[12:15], v[148:151], v[32:47]
    buffer_load_dwordx4 v[188:191], v4, s[40:43], s56 offen offset:3072 sc1
    v_mfma_f32_32x32x16_bf16 v[16:31], a[16:19], v[152:155], v[16:31]
    v_mfma_f32_32x32x16_bf16 v[32:47], a[20:23], v[152:155], v[32:47]
    s_add_u32 s56, s59, s48
    buffer_load_dwordx4 v[192:195], v4, s[40:43], s56 offen offset:0 sc1
    v_mfma_f32_32x32x16_bf16 v[16:31], a[24:27], v[156:159], v[16:31]
    v_mfma_f32_32x32x16_bf16 v[32:47], a[28:31], v[156:159], v[32:47]
    buffer_load_dwordx4 v[196:199], v4, s[40:43], s56 offen offset:1024 sc1
    s_waitcnt lgkmcnt(15)
    v_mfma_f32_32x32x16_bf16 v[16:31], a[32:35], v[160:163], v[16:31]
    v_mfma_f32_32x32x16_bf16 v[32:47], a[36:39], v[160:163], v[32:47]
    buffer_load_dwordx4 v[200:203], v4, s[40:43], s56 offen offset:2048 sc1
    v_mfma_f32_32x32x16_bf16 v[16:31], a[40:43], v[164:167], v[16:31]
    v_mfma_f32_32x32x16_bf16 v[32:47], a[44:47], v[164:167], v[32:47]
    buffer_load_dwordx4 v[204:207], v4, s[40:43], s56 offen offset:3072 sc1
    s_waitcnt vmcnt(9)
    v_mfma_f32_32x32x16_bf16 v[16:31], a[48:51], v[168:171], v[16:31]
    v_mfma_f32_32x32x16_bf16 v[32:47], a[52:55], v[168:171], v[32:47]
    s_add_u32 s56, s59, s49
    buffer_load_dwordx4 v[80:83], v4, s[40:43], s56 offen offset:0 sc1
    s_waitcnt vmcnt(9)
    v_mfma_f32_32x32x16_bf16 v[16:31], a[56:59], v[172:175], v[16:31]
    v_mfma_f32_32x32x16_bf16 v[32:47], a[60:63], v[172:175], v[32:47]
    buffer_load_dwordx4 v[84:87], v4, s[40:43], s56 offen offset:1024 sc1
    s_waitcnt vmcnt(9) lgkmcnt(14)
    v_mfma_f32_32x32x16_bf16 v[16:31], a[64:67], v[176:179], v[16:31]
    s_waitcnt lgkmcnt(12)
    v_mfma_f32_32x32x16_bf16 v[32:47], a[68:71], v[176:179], v[32:47]
    buffer_load_dwordx4 v[88:91], v4, s[40:43], s56 offen offset:2048 sc1
    s_waitcnt vmcnt(9) lgkmcnt(10)
    v_mfma_f32_32x32x16_bf16 v[16:31], a[72:75], v[180:183], v[16:31]
    s_waitcnt lgkmcnt(8)
    v_mfma_f32_32x32x16_bf16 v[32:47], a[76:79], v[180:183], v[32:47]
    buffer_load_dwordx4 v[92:95], v4, s[40:43], s56 offen offset:3072 sc1
    s_waitcnt vmcnt(9) lgkmcnt(6)
    v_mfma_f32_32x32x16_bf16 v[16:31], a[80:83], v[184:187], v[16:31]
    s_waitcnt lgkmcnt(4)
    v_mfma_f32_32x32x16_bf16 v[32:47], a[84:87], v[184:187], v[32:47]
    s_add_u32 s56, s59, s50
    buffer_load_dwordx4 v[96:99], v4, s[40:43], s56 offen offset:0 sc1
    s_waitcnt vmcnt(9) lgkmcnt(2)
    v_mfma_f32_32x32x16_bf16 v[16:31], a[88:91], v[188:191], v[16:31]
    s_waitcnt lgkmcnt(0)
    v_mfma_f32_32x32x16_bf16 v[32:47], a[92:95], v[188:191], v[32:47]
    buffer_load_dwordx4 v[100:103], v4, s[40:43], s56 offen offset:1024 sc1
    s_waitcnt vmcnt(9)
    v_mfma_f32_32x32x16_bf16 v[48:63], a[128:131], v[192:195], v[48:63]
    v_mfma_f32_32x32x16_bf16 v[64:79], a[132:135], v[192:195], 0
    s_nop 7
    ds_write_b32 v237, v32 offset:0
    ds_write_b32 v237, v34 offset:256
    ds_write_b32 v237, v33 offset:128
    ds_write_b32 v237, v35 offset:384
    ds_write_b32 v237, v36 offset:1024
    ds_write_b32 v237, v38 offset:1280
    buffer_load_dwordx4 v[104:107], v4, s[40:43], s56 offen offset:2048 sc1
    s_waitcnt vmcnt(9)
    v_mfma_f32_32x32x16_bf16 v[48:63], a[136:139], v[196:199], v[48:63]
    v_mfma_f32_32x32x16_bf16 v[64:79], a[140:143], v[196:199], v[64:79]
    ds_write_b32 v237, v37 offset:1152
    ds_write_b32 v237, v39 offset:1408
    ds_write_b32 v237, v40 offset:2048
    ds_write_b32 v237, v42 offset:2304
    ds_write_b32 v237, v41 offset:2176
    ds_write_b32 v237, v43 offset:2432
    buffer_load_dwordx4 v[108:111], v4, s[40:43], s56 offen offset:3072 sc1
    s_waitcnt vmcnt(9)
    v_mfma_f32_32x32x16_bf16 v[48:63], a[144:147], v[200:203], v[48:63]
    v_mfma_f32_32x32x16_bf16 v[64:79], a[148:151], v[200:203], v[64:79]
    ds_write_b32 v237, v44 offset:3072
    ds_write_b32 v237, v46 offset:3328
    ds_write_b32 v237, v45 offset:3200
    ds_write_b32 v237, v47 offset:3456
    ds_write_b32 v236, v16 offset:0
    ds_write_b32 v236, v18 offset:256
    s_add_u32 s56, s59, s51
    buffer_load_dwordx4 v[112:115], v4, s[40:43], s56 offen offset:0 sc1
    s_waitcnt vmcnt(9)
    v_mfma_f32_32x32x16_bf16 v[48:63], a[152:155], v[204:207], v[48:63]
    v_mfma_f32_32x32x16_bf16 v[64:79], a[156:159], v[204:207], v[64:79]
    ds_write_b32 v236, v17 offset:128
    ds_write_b32 v236, v19 offset:384
    ds_write_b32 v236, v20 offset:1024
    ds_write_b32 v236, v22 offset:1280
    ds_write_b32 v236, v21 offset:1152
    ds_write_b32 v236, v23 offset:1408
    buffer_load_dwordx4 v[116:119], v4, s[40:43], s56 offen offset:1024 sc1
    s_waitcnt vmcnt(9)
    v_mfma_f32_32x32x16_bf16 v[48:63], a[160:163], v[80:83], v[48:63]
    v_mfma_f32_32x32x16_bf16 v[64:79], a[164:167], v[80:83], v[64:79]
    ds_write_b32 v236, v24 offset:2048
    ds_write_b32 v236, v26 offset:2304
    ds_write_b32 v236, v25 offset:2176
    ds_write_b32 v236, v27 offset:2432
    ds_write_b32 v236, v28 offset:3072
    ds_write_b32 v236, v30 offset:3328
    buffer_load_dwordx4 v[120:123], v4, s[40:43], s56 offen offset:2048 sc1
    s_waitcnt vmcnt(9)
    v_mfma_f32_32x32x16_bf16 v[48:63], a[168:171], v[84:87], v[48:63]
    v_mfma_f32_32x32x16_bf16 v[64:79], a[172:175], v[84:87], v[64:79]
    ds_write_b32 v236, v29 offset:3200
    ds_write_b32 v236, v31 offset:3456
    buffer_load_dwordx4 v[124:127], v4, s[40:43], s56 offen offset:3072 sc1
    s_waitcnt vmcnt(9)
    v_mfma_f32_32x32x16_bf16 v[48:63], a[176:179], v[88:91], v[48:63]
    v_mfma_f32_32x32x16_bf16 v[64:79], a[180:183], v[88:91], v[64:79]
    s_add_u32 s56, s59, s52
    buffer_load_dwordx4 v[128:131], v4, s[40:43], s56 offen offset:0 sc1
    s_waitcnt vmcnt(9)
    v_mfma_f32_32x32x16_bf16 v[48:63], a[184:187], v[92:95], v[48:63]
    v_mfma_f32_32x32x16_bf16 v[64:79], a[188:191], v[92:95], v[64:79]
    s_waitcnt lgkmcnt(0)
    s_barrier
    ds_read_b128 v[16:19], v238 offset:0
    ds_read_b128 v[20:23], v238 offset:36864
    ds_read_b128 v[24:27], v239 offset:0
    ds_read_b128 v[28:31], v239 offset:36864
    ds_read_b128 v[32:35], v238 offset:1024
    ds_read_b128 v[36:39], v238 offset:37888
    ds_read_b128 v[40:43], v239 offset:1024
    ds_read_b128 v[44:47], v239 offset:37888
    buffer_load_dwordx4 v[132:135], v4, s[40:43], s56 offen offset:1024 sc1
    s_waitcnt vmcnt(9)
    v_mfma_f32_32x32x16_bf16 v[48:63], a[192:195], v[96:99], v[48:63]
    v_mfma_f32_32x32x16_bf16 v[64:79], a[196:199], v[96:99], v[64:79]
    buffer_load_dwordx4 v[136:139], v4, s[40:43], s56 offen offset:2048 sc1
    s_waitcnt vmcnt(9)
    v_mfma_f32_32x32x16_bf16 v[48:63], a[200:203], v[100:103], v[48:63]
    v_mfma_f32_32x32x16_bf16 v[64:79], a[204:207], v[100:103], v[64:79]
    s_waitcnt lgkmcnt(6)
    v_add_f32 v16, v16, v20
    s_waitcnt lgkmcnt(4)
    v_add_f32 v24, v24, v28
    v_add_f32 v17, v17, v21
    v_add_f32 v25, v25, v29
    v_add_f32 v18, v18, v22
    v_add_f32 v26, v26, v30
    buffer_load_dwordx4 v[140:143], v4, s[40:43], s56 offen offset:3072 sc1
    s_waitcnt vmcnt(9)
    v_mfma_f32_32x32x16_bf16 v[48:63], a[208:211], v[104:107], v[48:63]
    v_mfma_f32_32x32x16_bf16 v[64:79], a[212:215], v[104:107], v[64:79]
    v_add_f32 v19, v19, v23
    v_add_f32 v27, v27, v31
    v_add_f32 v16, v16, v24
    v_add_f32 v17, v17, v25
    v_add_f32 v18, v18, v26
    v_add_f32 v19, v19, v27
    s_add_u32 s56, s59, s53
    buffer_load_dwordx4 v[144:147], v4, s[40:43], s56 offen offset:0 sc1
    s_waitcnt vmcnt(9)
    v_mfma_f32_32x32x16_bf16 v[48:63], a[216:219], v[108:111], v[48:63]
    v_mfma_f32_32x32x16_bf16 v[64:79], a[220:223], v[108:111], v[64:79]
    v_cvt_pk_bf16_f32 v20, v16, v17
    v_cvt_pk_bf16_f32 v21, v18, v19
    buffer_store_dwordx2 v[20:21], v212, s[36:39], s68 offen offset:0
    s_waitcnt lgkmcnt(2)
    v_add_f32 v32, v32, v36
    s_waitcnt lgkmcnt(0)
    v_add_f32 v40, v40, v44
    v_add_f32 v33, v33, v37
    buffer_load_dwordx4 v[148:151], v4, s[40:43], s56 offen offset:1024 sc1
    s_waitcnt vmcnt(10)
    v_mfma_f32_32x32x16_bf16 v[48:63], a[224:227], v[112:115], v[48:63]
    v_mfma_f32_32x32x16_bf16 v[64:79], a[228:231], v[112:115], v[64:79]
    v_add_f32 v41, v41, v45
    v_add_f32 v34, v34, v38
    v_add_f32 v42, v42, v46
    v_add_f32 v35, v35, v39
    v_add_f32_e64 v43, v43, v47
    v_add_f32 v32, v32, v40
    buffer_load_dwordx4 v[152:155], v4, s[40:43], s56 offen offset:2048 sc1
    s_waitcnt vmcnt(10)
    v_mfma_f32_32x32x16_bf16 v[48:63], a[232:235], v[116:119], v[48:63]
    v_mfma_f32_32x32x16_bf16 v[64:79], a[236:239], v[116:119], v[64:79]
    v_add_f32 v33, v33, v41
    v_add_f32 v34, v34, v42
    v_add_f32 v35, v35, v43
    v_cvt_pk_bf16_f32 v36, v32, v33
    v_cvt_pk_bf16_f32 v37, v34, v35
    buffer_store_dwordx2 v[36:37], v212, s[36:39], s69 offen offset:0
    buffer_load_dwordx4 v[156:159], v4, s[40:43], s56 offen offset:3072 sc1
    s_waitcnt vmcnt(11)
    v_mfma_f32_32x32x16_bf16 v[48:63], a[240:243], v[120:123], v[48:63]
    v_mfma_f32_32x32x16_bf16 v[64:79], a[244:247], v[120:123], v[64:79]
    s_add_u32 s56, s59, s54
    buffer_load_dwordx4 v[160:163], v4, s[40:43], s56 offen offset:0 sc1
    s_waitcnt vmcnt(11)
    v_mfma_f32_32x32x16_bf16 v[48:63], a[248:251], v[124:127], v[48:63]
    v_mfma_f32_32x32x16_bf16 v[64:79], a[252:255], v[124:127], v[64:79]
    buffer_load_dwordx4 v[164:167], v4, s[40:43], s56 offen offset:1024 sc1
    s_waitcnt vmcnt(11)
    v_mfma_f32_32x32x16_bf16 v[48:63], a[0:3], v[128:131], v[48:63]
    v_mfma_f32_32x32x16_bf16 v[64:79], a[4:7], v[128:131], v[64:79]
    buffer_load_dwordx4 v[168:171], v4, s[40:43], s56 offen offset:2048 sc1
    s_waitcnt vmcnt(11)
    v_mfma_f32_32x32x16_bf16 v[48:63], a[8:11], v[132:135], v[48:63]
    v_mfma_f32_32x32x16_bf16 v[64:79], a[12:15], v[132:135], v[64:79]
    buffer_load_dwordx4 v[172:175], v4, s[40:43], s56 offen offset:3072 sc1
    s_waitcnt vmcnt(11)
    v_mfma_f32_32x32x16_bf16 v[48:63], a[16:19], v[136:139], v[48:63]
    v_mfma_f32_32x32x16_bf16 v[64:79], a[20:23], v[136:139], v[64:79]
    s_waitcnt vmcnt(10)
    v_mfma_f32_32x32x16_bf16 v[48:63], a[24:27], v[140:143], v[48:63]
    v_mfma_f32_32x32x16_bf16 v[64:79], a[28:31], v[140:143], v[64:79]
    s_waitcnt vmcnt(9)
    v_mfma_f32_32x32x16_bf16 v[48:63], a[32:35], v[144:147], v[48:63]
    v_mfma_f32_32x32x16_bf16 v[64:79], a[36:39], v[144:147], v[64:79]
    s_waitcnt vmcnt(7)
    v_mfma_f32_32x32x16_bf16 v[48:63], a[40:43], v[148:151], v[48:63]
    v_mfma_f32_32x32x16_bf16 v[64:79], a[44:47], v[148:151], v[64:79]
    s_waitcnt vmcnt(6)
    v_mfma_f32_32x32x16_bf16 v[48:63], a[48:51], v[152:155], v[48:63]
    v_mfma_f32_32x32x16_bf16 v[64:79], a[52:55], v[152:155], v[64:79]
    s_waitcnt vmcnt(4)
    v_mfma_f32_32x32x16_bf16 v[48:63], a[56:59], v[156:159], v[48:63]
    v_mfma_f32_32x32x16_bf16 v[64:79], a[60:63], v[156:159], v[64:79]
    s_waitcnt vmcnt(3)
    v_mfma_f32_32x32x16_bf16 v[64:79], a[68:71], v[160:163], v[64:79]
    s_waitcnt vmcnt(2)
    v_mfma_f32_32x32x16_bf16 v[64:79], a[76:79], v[164:167], v[64:79]
    s_waitcnt vmcnt(1)
    v_mfma_f32_32x32x16_bf16 v[64:79], a[84:87], v[168:171], v[64:79]
    s_waitcnt vmcnt(0)
    v_mfma_f32_32x32x16_bf16 v[64:79], a[92:95], v[172:175], v[64:79]
    v_mfma_f32_32x32x16_bf16 v[48:63], a[64:67], v[160:163], v[48:63]
    v_mfma_f32_32x32x16_bf16 v[48:63], a[72:75], v[164:167], v[48:63]
    s_nop 9
    ds_write_b32 v237, v64 offset:8192
    ds_write_b32 v237, v66 offset:8448
    ds_write_b32 v237, v65 offset:8320
    ds_write_b32 v237, v67 offset:8576
    ds_write_b32 v237, v68 offset:9216
    ds_write_b32 v237, v70 offset:9472
    v_mfma_f32_32x32x16_bf16 v[48:63], a[80:83], v[168:171], v[48:63]
    ds_write_b32 v237, v69 offset:9344
    ds_write_b32 v237, v71 offset:9600
    ds_write_b32 v237, v72 offset:10240
    ds_write_b32 v237, v74 offset:10496
    ds_write_b32 v237, v73 offset:10368
    ds_write_b32 v237, v75 offset:10624
    v_mfma_f32_32x32x16_bf16 v[48:63], a[88:91], v[172:175], v[48:63]
    ds_write_b32 v237, v76 offset:11264
    ds_write_b32 v237, v78 offset:11520
    ds_write_b32 v237, v77 offset:11392
    ds_write_b32 v237, v79 offset:11648
    s_nop 7
    ds_write_b32 v236, v48 offset:8192
    ds_write_b32 v236, v50 offset:8448
    ds_write_b32 v236, v49 offset:8320
    ds_write_b32 v236, v51 offset:8576
    ds_write_b32 v236, v52 offset:9216
    ds_write_b32 v236, v54 offset:9472
    ds_write_b32 v236, v53 offset:9344
    ds_write_b32 v236, v55 offset:9600
    ds_write_b32 v236, v56 offset:10240
    ds_write_b32 v236, v58 offset:10496
    ds_write_b32 v236, v57 offset:10368
    ds_write_b32 v236, v59 offset:10624
    ds_write_b32 v236, v60 offset:11264
    ds_write_b32 v236, v62 offset:11520
    ds_write_b32 v236, v61 offset:11392
    ds_write_b32 v236, v63 offset:11648
    s_waitcnt lgkmcnt(0)
    s_barrier
    ds_read_b128 v[48:51], v238 offset:8192
    ds_read_b128 v[52:55], v238 offset:45056
    ds_read_b128 v[56:59], v239 offset:8192
    ds_read_b128 v[60:63], v239 offset:45056
    ds_read_b128 v[64:67], v238 offset:9216
    ds_read_b128 v[68:71], v238 offset:46080
    ds_read_b128 v[72:75], v239 offset:9216
    ds_read_b128 v[76:79], v239 offset:46080
    s_waitcnt lgkmcnt(6)
    v_pk_add_f32 v[48:49], v[48:49], v[52:53]
    s_waitcnt lgkmcnt(4)
    v_pk_add_f32 v[56:57], v[56:57], v[60:61]
    v_pk_add_f32 v[50:51], v[50:51], v[54:55]
    v_pk_add_f32 v[58:59], v[58:59], v[62:63]
    v_pk_add_f32 v[48:49], v[48:49], v[56:57]
    v_pk_add_f32 v[50:51], v[50:51], v[58:59]
    v_cvt_pk_bf16_f32 v52, v48, v49
    v_cvt_pk_bf16_f32 v53, v50, v51
    buffer_store_dwordx2 v[52:53], v212, s[36:39], s68 offen offset:64
    s_waitcnt lgkmcnt(2)
    v_pk_add_f32 v[64:65], v[64:65], v[68:69]
    s_waitcnt lgkmcnt(0)
    v_pk_add_f32 v[72:73], v[72:73], v[76:77]
    v_pk_add_f32 v[66:67], v[66:67], v[70:71]
    v_pk_add_f32 v[74:75], v[74:75], v[78:79]
    v_pk_add_f32 v[64:65], v[64:65], v[72:73]
    v_pk_add_f32 v[66:67], v[66:67], v[74:75]
    v_cvt_pk_bf16_f32 v68, v64, v65
    v_cvt_pk_bf16_f32 v69, v66, v67
    buffer_store_dwordx2 v[68:69], v212, s[36:39], s69 offen offset:64
L_end_P:
    s_endpgm

.section .rodata,"a"
.p2align 6
.amdhsa_kernel sequential_preLN__sliding_local_dilated__mixer_token_mlp__prompt_kernel
  .amdhsa_next_free_vgpr 508
  .amdhsa_next_free_sgpr 102
  .amdhsa_accum_offset 252
  .amdhsa_group_segment_fixed_size 0
  .amdhsa_kernarg_size 88
  .amdhsa_user_sgpr_count 2
  .amdhsa_user_sgpr_kernarg_segment_ptr 1
  .amdhsa_system_sgpr_workgroup_id_x 1
.end_amdhsa_kernel
```

```asm
; @launch grid=(256,1,1) block=(256,1,1) lds=163840
.amdgcn_target "amdgcn-amd-amdhsa--gfx950"
.text
.globl sequential_preLN__sliding_local_dilated__mixer_token_mlp__prompt_kernel
.p2align 8
.type sequential_preLN__sliding_local_dilated__mixer_token_mlp__prompt_kernel,@function
sequential_preLN__sliding_local_dilated__mixer_token_mlp__prompt_kernel:
    s_cmp_ge_u32 s2, 256
    s_cbranch_scc1 L_end_P
    s_load_dwordx2 s[8:9], s[0:1], 0
    s_load_dwordx2 s[12:13], s[0:1], 8
    s_load_dwordx2 s[44:45], s[0:1], 72
    s_load_dwordx2 s[40:41], s[0:1], 80
    s_load_dwordx2 s[16:17], s[0:1], 16
    s_load_dwordx2 s[20:21], s[0:1], 32
    s_load_dwordx2 s[24:25], s[0:1], 48
    s_load_dwordx2 s[28:29], s[0:1], 40
    s_load_dwordx2 s[32:33], s[0:1], 56
    s_load_dwordx2 s[36:37], s[0:1], 64
    v_lshrrev_b32 v1, 6, v0
    s_nop 0
    v_readfirstlane_b32 s3, v1
    v_and_b32 v1, 63, v0
    v_and_b32 v2, 15, v0
    v_lshrrev_b32 v3, 4, v1
    v_lshlrev_b32 v4, 4, v1
    s_mov_b32 s10, 0x1c0000
    s_mov_b32 s11, 0x00020000
    s_mov_b32 s14, 0x126000
    s_mov_b32 s15, 0x00020000
    s_mov_b32 s46, 0x100
    s_mov_b32 s47, 0x00020000
    s_mov_b32 s42, 0x610000
    s_mov_b32 s43, 0x00020000
    s_mov_b32 s18, 0x62000
    s_mov_b32 s19, 0x00020000
    s_mov_b32 s22, 0x700000
    s_mov_b32 s23, 0x00020000
    s_mov_b32 s26, 0x700000
    s_mov_b32 s27, 0x00020000
    s_mov_b32 s30, 0xe00
    s_mov_b32 s31, 0x00020000
    s_mov_b32 s34, 0x1000
    s_mov_b32 s35, 0x00020000
    s_mov_b32 s38, 0x1c0000
    s_mov_b32 s39, 0x00020000
    s_mov_b32 s5, 0x3f803f80
    s_mov_b32 s6, 0x200000
    s_bfe_u32 s48, s2, 0x20001
    s_lshl_b32 s48, s48, 2
    s_lshr_b32 s53, s2, 6
    s_add_u32 s48, s48, s53
    s_bfe_u32 s49, s2, 0x30003
    s_and_b32 s53, s2, 1
    s_lshl_b32 s53, s53, 3
    s_add_u32 s49, s49, s53
    v_lshrrev_b32_e64 v237, 2, v1
    v_mul_u32_u24 v123, 2688, v237
    v_lshrrev_b32 v237, 5, v1
    v_lshlrev_b32 v237, 1, v237
    v_and_b32 v238, 3, v1
    v_xor_b32 v237, v237, v238
    v_lshl_add_u32 v123, v237, 4, v123
    s_mul_i32 s53, s49, 56
    s_min_u32 s53, s53, 832
    s_mul_i32 s51, s3, 43008
    s_add_u32 s53, s53, s51
    v_add_u32 v123, s53, v123
    s_lshr_b32 s53, s3, 1
    s_mul_i32 s51, s53, 6144
    s_and_b32 s53, s3, 1
    s_lshl_b32 s53, s53, 10
    s_add_u32 s51, s51, s53
    v_lshrrev_b32 v237, 3, v1
    v_mul_u32_u24 v122, 896, v237
    v_and_b32 v237, 7, v1
    v_xor_b32 v237, v237, v3
    v_lshl_add_u32 v120, v237, 4, v122
    s_lshl_b32 s50, s48, 7
    s_lshl_b32 s53, s3, 5
    s_add_u32 s53, s53, s50
    s_mul_i32 s53, s53, 896
    v_xor_b32 v121, 64, v120
    v_add_u32_e64 v120, s53, v120
    s_add_u32 s53, s53, 7168
    v_add_u32 v121, s53, v121
    s_lshl_b32 s53, s3, 1
    v_xor_b32 v237, s53, v237
    v_lshl_add_u32 v122, v237, 4, v122
    s_lshl_b32 s53, s3, 2
    s_add_u32 s53, s53, s50
    s_sub_u32 s53, s53, 16
    s_mul_i32 s53, s53, 896
    s_cmp_eq_u32 s48, 0
    s_cselect_b32 s53, 0x40000000, s53
    v_add_u32 v122, s53, v122
    s_lshl_b32 s52, s3, 12
    s_add_u32 s52, s52, 63488
    s_lshl_b32 s7, s3, 9
    s_cmp_eq_u32 s3, 0
    s_cselect_b32 s54, 0xffffff00, -1
    s_mov_b32 s55, 0
    s_memrealtime s[86:87]
    v_mov_b32 v7, 0
    s_waitcnt lgkmcnt(0)
    s_or_b32 s86, s86, 1
    v_mov_b32 v6, s86
    s_or_b32 s86, s2, s3
    s_cmp_eq_u32 s86, 0
    s_cselect_b64 exec, 1, 0
    buffer_store_dword v6, v7, s[44:47], 0 offen sc1
    s_mov_b64 exec, -1
    s_add_u32 m0, s51, 12288
    s_mov_b32 s73, 0
    buffer_load_dwordx4 v123, s[12:15], s73 offen lds
    s_add_u32 m0, s51, 14336
    s_mov_b32 s73, 896
    buffer_load_dwordx4 v123, s[12:15], s73 offen lds
    s_add_u32 m0, s51, 16384
    s_mov_b32 s73, 1792
    buffer_load_dwordx4 v123, s[12:15], s73 offen lds
    s_add_u32 m0, s52, 36864
    s_mov_b32 s73, 0
    buffer_load_dwordx4 v120, s[8:11], s73 offen lds
    s_add_u32 m0, s52, 37888
    s_mov_b32 s73, 0
    buffer_load_dwordx4 v121, s[8:11], s73 offen lds
    s_add_u32 m0, s52, 38912
    s_mov_b32 s73, 14336
    buffer_load_dwordx4 v120, s[8:11], s73 offen lds
    s_add_u32 m0, s52, 39936
    s_mov_b32 s73, 14336
    buffer_load_dwordx4 v121, s[8:11], s73 offen lds
    s_add_u32 m0, s7, 98304
    s_mov_b32 s73, 0
    s_mov_b64 exec, s[54:55]
    buffer_load_dwordx4 v122, s[8:11], s73 offen lds
    s_mov_b64 exec, -1
    s_bfe_u32 s53, s2, 0x30003
    s_add_u32 s86, s53, 1
    s_lshr_b32 s86, s86, 1
    s_lshr_b32 s87, s2, 6
    s_mul_i32 s87, s87, 5
    s_add_u32 s86, s86, s87
    s_lshl_b32 s86, s86, 2
    s_add_u32 s53, s86, s3
    s_mov_b32 s56, s53
    s_mov_b32 s86, 0x2a54
    s_bitcmp1_b32 s86, s49
    s_cselect_b32 s57, 0x40000000, 0
    s_mul_i32 s86, s53, 58
    v_add_u32_e64 v237, s86, v1
    v_mul_u32_u24 v238, 43691, v237
    v_lshrrev_b32 v238, 19, v238
    v_mul_u32_u24 v239, 12, v238
    v_sub_u32 v239, v237, v239
    v_lshrrev_b32 v239, 2, v239
    v_mul_u32_u24 v239, 896, v239
    v_mul_u32_u24 v238, 2688, v238
    v_and_b32 v237, 3, v237
    v_lshlrev_b32 v237, 7, v237
    v_add3_u32 v237, v237, v238, v239
    v_add_u32 v237, s57, v237
    s_and_b32 s87, s2, 1
    s_mul_i32 s87, s87, 384
    s_add_u32 s87, s87, 172032
    s_mov_b32 exec_lo, 0xffffffff
    s_mov_b32 exec_hi, 0x3ffffff
    buffer_load_dword v232, v237, s[12:15], s87 offen
    s_mov_b64 exec, -1
    v_lshlrev_b32 v237, 7, v1
    v_add_u32 v238, s57, v237
    s_mul_i32 s86, s53, 6016
    s_bfe_u32 s87, s2, 0x20001
    s_mul_i32 s87, s87, 458752
    s_add_u32 s86, s86, s87
    s_max_u32 s86, s86, 14336
    s_sub_u32 s86, s86, 14336
    s_mov_b32 exec_hi, 0x7fff
    buffer_load_dword v233, v238, s[8:11], s86 offen
    s_getpc_b64 s[86:87]
Lpc_P:
    s_mul_i32 s53, s53, 384
    v_add_u32_e64 v237, s53, v237
    v_min_u32 v237, L_end_P-Lpc_P, v237
    s_mov_b64 exec, 7
    global_load_dword v236, v237, s[86:87]
    s_mov_b64 exec, -1
    v_mul_u32_u24 v237, 18432, v3
    v_lshl_add_u32 v237, v2, 3, v237
    v_mov_b32_e64 v238, s5
    v_add_u32 v237, 61440, v237
    ds_write2_b32 v237, v238, v238 offset0:0 offset1:1
    s_lshr_b32 s68, s2, 3
    s_mul_i32 s69, s68, 37
    s_lshr_b32 s69, s69, 8
    s_mul_i32 s64, s69, 7
    s_sub_u32 s64, s68, s64
    s_mov_b32 s66, s64
    s_and_b32 s68, s2, 7
    s_lshl_b32 s67, s68, 2
    s_add_u32 s67, s67, s69
    s_cmp_ge_u32 s69, 4
    s_cselect_b32 s67, 99, s67
    s_mul_i32 s71, s68, 3
    s_add_u32 s71, s71, 4
    s_lshl_b32 s72, s68, 2
    s_cmp_lt_u32 s68, 4
    s_cselect_b32 s65, s72, s71
    s_cselect_b32 s71, 4, 3
    s_add_u32 s65, s65, s69
    s_cmp_ge_u32 s69, s71
    s_cselect_b32 s65, 99, s65
    v_lshrrev_b32_e64 v219, 3, v1
    v_mul_u32_u24 v208, 896, v219
    v_and_b32 v219, 1, v3
    v_lshlrev_b32 v219, 2, v219
    v_and_b32 v220, 7, v1
    v_xor_b32 v219, v219, v220
    v_lshl_add_u32 v208, v219, 4, v208
    s_lshl_b32 s58, s66, 7
    s_mul_i32 s60, s3, 100352
    s_add_u32 s58, s58, s60
    v_add_u32_e64 v208, s58, v208
    s_mul_i32 s59, s3, 36864
    s_add_u32 s59, s59, 12288
    v_lshrrev_b32 v219, 5, v1
    v_lshlrev_b32 v209, 9, v219
    v_bfe_u32 v219, v1, 2, 2
    v_lshl_add_u32 v209, v219, 7, v209
    v_lshrrev_b32 v219, 1, v219
    s_and_b32 s58, s3, 1
    v_xor_b32_e64 v219, s58, v219
    v_lshl_add_u32 v209, v219, 6, v209
    v_and_b32_e64 v219, 1, v3
    v_lshl_add_u32 v209, v219, 5, v209
    v_and_b32_e64 v219, 3, v1
    v_lshl_add_u32 v209, v219, 3, v209
    v_add_u32 v209, 12288, v209
    v_lshrrev_b32 v219, 5, v1
    v_lshlrev_b32 v219, 10, v219
    v_sub_u32_e64 v210, v209, v219
    s_mul_i32 s70, s3, 36864
    s_add_u32 s70, s70, 12288
    v_lshrrev_b32_e64 v219, 3, v1
    v_mul_u32_u24 v213, 3584, v219
    v_and_b32 v219, 1, v3
    v_lshlrev_b32 v219, 2, v219
    v_and_b32 v220, 7, v1
    v_xor_b32 v219, v219, v220
    v_lshl_add_u32 v213, v219, 4, v213
    s_mul_i32 s68, s3, 1835008
    s_lshl_b32 s69, s65, 7
    s_add_u32 s68, s68, s69
    s_cmp_ge_u32 s65, 99
    s_cselect_b32 s68, 0x40000000, s68
    v_add_u32 v213, s68, v213
    s_cselect_b32 s68, 0x40000000, 0
    v_add_u32 v5, s68, v4
    v_lshrrev_b32 v219, 5, v1
    v_lshlrev_b32 v215, 9, v219
    v_bfe_u32 v219, v1, 2, 2
    v_lshl_add_u32 v215, v219, 7, v215
    v_lshrrev_b32 v219, 1, v219
    s_lshr_b32 s68, s3, 1
    v_xor_b32_e64 v219, s68, v219
    v_lshl_add_u32 v215, v219, 6, v215
    v_and_b32_e64 v219, 1, v3
    v_lshl_add_u32 v215, v219, 5, v215
    v_and_b32_e64 v219, 3, v1
    v_lshl_add_u32 v215, v219, 3, v215
    s_and_b32 s68, s3, 1
    s_lshl_b32 s68, s68, 5
    v_xor_b32 v215, s68, v215
    v_add_u32 v215, s70, v215
    v_xor_b32_e64 v216, 64, v215
    s_mul_i32 s70, s3, 36864
    s_add_u32 s70, s70, 12288
    v_lshrrev_b32_e64 v219, 3, v1
    v_mul_u32_u24 v214, 4096, v219
    v_and_b32 v219, 1, v3
    v_lshlrev_b32 v219, 2, v219
    v_and_b32 v220, 7, v1
    v_xor_b32 v219, v219, v220
    v_lshl_add_u32 v214, v219, 4, v214
    s_mul_i32 s68, s3, 1835008
    s_lshl_b32 s69, s67, 7
    s_add_u32 s68, s68, s69
    s_cmp_ge_u32 s67, 99
    s_cselect_b32 s68, 0x40000000, s68
    v_add_u32 v214, s68, v214
    v_lshrrev_b32 v219, 5, v1
    v_lshlrev_b32 v217, 9, v219
    v_bfe_u32 v219, v1, 2, 2
    v_lshl_add_u32 v217, v219, 7, v217
    v_lshrrev_b32 v219, 1, v219
    s_lshr_b32 s68, s3, 1
    v_xor_b32_e64 v219, s68, v219
    v_lshl_add_u32 v217, v219, 6, v217
    v_and_b32_e64 v219, 1, v3
    v_lshl_add_u32 v217, v219, 5, v217
    v_and_b32_e64 v219, 3, v1
    v_lshl_add_u32 v217, v219, 3, v217
    v_add_u32_e64 v217, s70, v217
    v_xor_b32 v218, 64, v217
    s_and_b32 s68, s2, 7
    s_cmp_ge_u32 s68, 8
    s_cselect_b32 s94, 8, 0
    s_sub_u32 s68, s68, s94
    s_lshl_b32 s94, s68, 12
    s_add_u32 s68, s68, 1
    s_cmp_ge_u32 s68, 8
    s_cselect_b32 s95, 8, 0
    s_sub_u32 s68, s68, s95
    s_lshl_b32 s95, s68, 12
    s_add_u32 s68, s68, 1
    s_cmp_ge_u32 s68, 8
    s_cselect_b32 s96, 8, 0
    s_sub_u32 s68, s68, s96
    s_lshl_b32 s96, s68, 12
    s_add_u32 s68, s68, 1
    s_cmp_ge_u32 s68, 8
    s_cselect_b32 s97, 8, 0
    s_sub_u32 s68, s68, s97
    s_lshl_b32 s97, s68, 12
    s_add_u32 s68, s68, 1
    s_cmp_ge_u32 s68, 8
    s_cselect_b32 s98, 8, 0
    s_sub_u32 s68, s68, s98
    s_lshl_b32 s98, s68, 12
    s_add_u32 s68, s68, 1
    s_cmp_ge_u32 s68, 8
    s_cselect_b32 s99, 8, 0
    s_sub_u32 s68, s68, s99
    s_lshl_b32 s99, s68, 12
    s_add_u32 s68, s68, 1
    s_cmp_ge_u32 s68, 8
    s_cselect_b32 s100, 8, 0
    s_sub_u32 s68, s68, s100
    s_lshl_b32 s100, s68, 12
    s_add_u32 s68, s68, 1
    s_cmp_ge_u32 s68, 8
    s_cselect_b32 s101, 8, 0
    s_sub_u32 s68, s68, s101
    s_lshl_b32 s101, s68, 12
    s_lshl_b32 s80, s48, 2
    s_add_u32 s80, s80, s3
    s_lshl_b32 s80, s80, 11
    s_lshr_b32 s93, s49, 2
    s_lshl_b32 s93, s93, 7
    s_add_u32 s80, s80, s93
    s_and_b32 s93, s49, 3
    s_lshl_b32 s93, s93, 2
    s_add_u32 s80, s80, s93
    s_add_u32 s80, s80, 0x5c8000
    s_lshl_b32 s83, s67, 1
    s_lshr_b32 s93, s3, 1
    s_add_u32 s83, s83, s93
    s_lshl_b32 s83, s83, 11
    s_add_u32 s83, s83, 0x5c8000
    v_lshrrev_b32 v10, 2, v2
    v_lshlrev_b32 v10, 7, v10
    v_and_b32_e64 v219, 3, v2
    v_lshl_add_u32 v10, v219, 2, v10
    s_lshl_b32 s84, s64, 12
    s_lshl_b32 s85, s84, 1
    s_add_u32 s85, s85, 0x5f0000
    s_add_u32 s84, s84, 0x5e8000
    s_lshl_b32 s81, s67, 5
    s_add_u32 s81, s81, s3
    s_lshl_b32 s81, s81, 2
    s_add_u32 s81, s81, s84
    s_lshl_b32 s93, s3, 10
    s_add_u32 s84, s84, s93
    v_bfe_u32 v11, v1, 2, 3
    v_min_u32 v12, 6, v11
    v_and_b32 v219, 3, v1
    v_lshlrev_b32_e64 v219, 2, v219
    v_lshl_add_u32 v11, v11, 7, v219
    v_lshl_add_u32 v12, v12, 7, v219
    s_lshl_b32 s82, s65, 5
    s_add_u32 s82, s82, s3
    s_lshl_b32 s82, s82, 2
    s_add_u32 s82, s82, s85
    s_mul_i32 s93, s3, 896
    s_add_u32 s85, s85, s93
    v_mov_b32 v9, 0
    v_lshlrev_b32_e64 v124, 9, v3
    v_bfe_u32 v237, v1, 2, 2
    v_lshl_add_u32 v124, v237, 6, v124
    v_and_b32_e64 v237, 3, v1
    v_lshl_add_u32 v124, v237, 3, v124
    v_and_b32 v237, 1, v3
    v_lshlrev_b32 v237, 5, v237
    v_add_u32_e64 v124, v124, v237
    v_add_u32 v124, 12288, v124
    v_xor_b32 v125, 32, v124
    s_and_b32 s53, s3, 1
    s_lshl_b32 s53, s53, 5
    v_xor_b32 v127, s53, v124
    s_lshr_b32 s53, s3, 1
    s_lshl_b32 s53, s53, 11
    s_add_u32 s53, s53, 2048
    v_add_u32 v126, s53, v127
    v_lshrrev_b32 v237, 1, v2
    v_xor_b32 v237, v237, v3
    v_lshlrev_b32 v237, 4, v237
    v_lshl_add_u32 v237, v2, 7, v237
    v_add_u32 v130, 61440, v237
    v_xor_b32 v131, 64, v130
    v_add_u32 v128, s52, v237
    v_xor_b32 v129, 64, v128
    v_lshlrev_b32 v237, 2, v3
    v_sub_u32_e64 v237, v2, v237
    v_mov_b32 v239, 0xf149f2ca
    v_add_u32 v238, 16, v237
    v_and_b32 v238, 0xfffffff1, v238
    v_cmp_eq_u32 vcc, 0, v238
    s_nop 1
    v_cndmask_b32 v240, v239, 0, vcc
    v_add_u32 v238, 15, v237
    v_and_b32 v238, 0xfffffff1, v238
    v_cmp_eq_u32 vcc, 0, v238
    s_nop 1
    v_cndmask_b32 v241, v239, 0, vcc
    v_add_u32 v238, 14, v237
    v_and_b32 v238, 0xfffffff1, v238
    v_cmp_eq_u32 vcc, 0, v238
    s_nop 1
    v_cndmask_b32 v242, v239, 0, vcc
    v_add_u32 v238, 13, v237
    v_and_b32 v238, 0xfffffff1, v238
    v_cmp_eq_u32 vcc, 0, v238
    s_nop 1
    v_cndmask_b32 v243, v239, 0, vcc
    v_add_u32 v238, 0, v237
    v_and_b32 v238, 0xfffffff1, v238
    v_cmp_eq_u32 vcc, 0, v238
    s_nop 1
    v_cndmask_b32 v244, v239, 0, vcc
    v_add_u32 v238, -1, v237
    v_and_b32 v238, 0xfffffff1, v238
    v_cmp_eq_u32 vcc, 0, v238
    s_nop 1
    v_cndmask_b32 v245, v239, 0, vcc
    v_add_u32 v238, -2, v237
    v_and_b32 v238, 0xfffffff1, v238
    v_cmp_eq_u32 vcc, 0, v238
    s_nop 1
    v_cndmask_b32 v246, v239, 0, vcc
    v_add_u32 v238, -3, v237
    v_and_b32 v238, 0xfffffff1, v238
    v_cmp_eq_u32 vcc, 0, v238
    s_nop 1
    v_cndmask_b32 v247, v239, 0, vcc
    s_or_b32 s53, s48, s3
    s_cmp_eq_u32 s53, 0
    s_cselect_b64 vcc, -1, 0
    v_cndmask_b32 v248, v240, v239, vcc
    v_cndmask_b32 v249, v241, v239, vcc
    v_cndmask_b32 v250, v242, v239, vcc
    v_cndmask_b32 v251, v243, v239, vcc
    v_mov_b32 v40, s5
    v_mov_b32 v41, s5
    v_mov_b32 v42, s5
    v_mov_b32_e64 v43, s5
    s_mov_b32 s88, 0x22222222
    s_mov_b32 s89, 0x22222222
    s_mov_b32 s90, 0x44444444
    s_mov_b32 s91, 0x44444444
    s_mov_b32 s92, 0x88888888
    s_mov_b32 s93, 0x88888888
    v_lshlrev_b32 v72, 4, v3
    s_lshl_b32 s53, s3, 6
    v_add_u32 v73, s53, v72
    s_and_b32 s53, s53, 64
    v_add_u32_e64 v74, s53, v72
    s_mul_i32 s53, s3, 384
    v_lshl_add_u32 v75, v2, 2, s53
    v_add_u32 v76, s53, v72
    s_and_b32 s53, s3, 1
    s_lshl_b32 s53, s53, 3
    v_add_u32 v80, s53, v4
    v_lshrrev_b32 v81, 2, v2
    v_lshlrev_b32 v81, 8, v81
    v_lshl_add_u32 v81, v3, 6, v81
    v_and_b32_e64 v82, 3, v2
    v_lshl_add_u32 v81, v82, 1, v81
    v_add_u32_e64 v81, s53, v81
    v_add_u32 v81, 1024, v81
    s_cmp_lt_u32 s3, 2
    s_cselect_b64 vcc, -1, 0
    s_cselect_b32 s53, 2, 16
    v_cndmask_b32 v80, v81, v80, vcc
    v_add_u32 v81, s53, v80
    v_add_u32 v82, s53, v81
    v_add_u32 v83, s53, v82
    v_lshlrev_b32 v77, 2, v2
    s_lshl_b32 s53, s3, 11
    v_add_u32 v78, s53, v4
    s_lshl_b32 s62, s48, 3
    s_lshl_b32 s63, s3, 1
    s_add_u32 s62, s62, s63
    s_lshl_b32 s62, s62, 4
    s_add_u32 s62, s62, s49
    s_lshl_b32 s62, s62, 10
    s_add_u32 s63, s62, 16384
    s_add_u32 m0, s51, 24576
    s_mov_b32 s73, 172032
    buffer_load_dwordx4 v123, s[12:15], s73 offen lds
    s_add_u32 m0, s51, 26624
    s_mov_b32 s73, 172928
    buffer_load_dwordx4 v123, s[12:15], s73 offen lds
    s_add_u32 m0, s51, 28672
    s_mov_b32 s73, 173824
    buffer_load_dwordx4 v123, s[12:15], s73 offen lds
    s_add_u32 m0, s52, 18432
    s_mov_b32 s73, 128
    buffer_load_dwordx4 v120, s[8:11], s73 offen lds
    s_add_u32 m0, s52, 19456
    s_mov_b32 s73, 128
    buffer_load_dwordx4 v121, s[8:11], s73 offen lds
    s_add_u32 m0, s52, 20480
    s_mov_b32 s73, 14464
    buffer_load_dwordx4 v120, s[8:11], s73 offen lds
    s_add_u32 m0, s52, 21504
    s_mov_b32 s73, 14464
    buffer_load_dwordx4 v121, s[8:11], s73 offen lds
    s_add_u32 m0, s7, 79872
    s_mov_b32 s73, 128
    s_mov_b64 exec, s[54:55]
    buffer_load_dwordx4 v122, s[8:11], s73 offen lds
    s_mov_b64 exec, -1
    s_waitcnt vmcnt(11)
    s_waitcnt lgkmcnt(0)
    s_barrier
    ds_read_b128 v[16:19], v128 offset:36864
    ds_read_b128 v[20:23], v128 offset:38912
    ds_read_b128 v[24:27], v130 offset:36864
    ds_read_b64_tr_b16 v[88:89], v124 offset:0
    ds_read_b64_tr_b16 v[90:91], v124 offset:256
    ds_read_b64_tr_b16 v[92:93], v125 offset:0
    ds_read_b64_tr_b16 v[94:95], v125 offset:256
    ds_read_b64_tr_b16 v[96:97], v124 offset:2048
    ds_read_b64_tr_b16 v[98:99], v124 offset:2304
    ds_read_b64_tr_b16 v[100:101], v125 offset:2048
    ds_read_b64_tr_b16 v[102:103], v125 offset:2304
    ds_read_b64_tr_b16 v[104:105], v124 offset:4096
    ds_read_b64_tr_b16 v[106:107], v124 offset:4352
    ds_read_b64_tr_b16 v[108:109], v125 offset:4096
    ds_read_b64_tr_b16 v[110:111], v125 offset:4352
    ds_read_b64_tr_b16 v[112:113], v126 offset:0
    ds_read_b64_tr_b16 v[114:115], v126 offset:256
    ds_read_b64_tr_b16 v[116:117], v127 offset:0
    ds_read_b64_tr_b16 v[118:119], v127 offset:256
    s_waitcnt lgkmcnt(8)
    v_mfma_f32_16x16x32_bf16 v[136:139], v[88:91], v[16:19], 0
    ds_read_b128 v[28:31], v129 offset:36864
    v_mfma_f32_16x16x32_bf16 v[160:163], v[88:91], v[20:23], 0
    ds_read_b128 v[32:35], v129 offset:38912
    v_mfma_f32_16x16x32_bf16 v[140:143], v[92:95], v[16:19], 0
    ds_read_b128 v[36:39], v131 offset:36864
    v_mfma_f32_16x16x32_bf16 v[164:167], v[92:95], v[20:23], 0
    ds_read_b64_tr_b16 v[88:89], v124 offset:6144
    v_mfma_f32_16x16x32_bf16 v[144:147], v[96:99], v[16:19], 0
    ds_read_b64_tr_b16 v[90:91], v124 offset:6400
    s_add_u32 m0, s51, 36864
    s_mov_b32 s73, 344064
    buffer_load_dwordx4 v123, s[12:15], s73 offen lds
    v_mfma_f32_16x16x32_bf16 v[168:171], v[96:99], v[20:23], 0
    ds_read_b64_tr_b16 v[92:93], v125 offset:6144
    v_mfma_f32_16x16x32_bf16 v[148:151], v[100:103], v[16:19], 0
    ds_read_b64_tr_b16 v[94:95], v125 offset:6400
    v_mfma_f32_16x16x32_bf16 v[172:175], v[100:103], v[20:23], 0
    ds_read_b64_tr_b16 v[96:97], v124 offset:8192
    s_waitcnt lgkmcnt(8)
    v_mfma_f32_16x16x32_bf16 v[152:155], v[16:19], v[104:107], 0
    ds_read_b64_tr_b16 v[98:99], v124 offset:8448
    v_mfma_f32_16x16x32_bf16 v[176:179], v[20:23], v[104:107], 0
    ds_read_b64_tr_b16 v[100:101], v125 offset:8192
    s_add_u32 m0, s51, 38912
    s_mov_b32 s73, 344960
    buffer_load_dwordx4 v123, s[12:15], s73 offen lds
    v_mfma_f32_16x16x32_bf16 v[156:159], v[16:19], v[108:111], 0
    ds_read_b64_tr_b16 v[102:103], v125 offset:8448
    v_mfma_f32_16x16x32_bf16 v[180:183], v[20:23], v[108:111], 0
    ds_read_b64_tr_b16 v[104:105], v124 offset:10240
    v_mfma_f32_16x16x32_bf16 v[184:187], v[112:115], v[24:27], 0
    ds_read_b64_tr_b16 v[106:107], v124 offset:10496
    v_mfma_f32_16x16x32_bf16 v[188:191], v[116:119], v[24:27], 0
    ds_read_b64_tr_b16 v[108:109], v125 offset:10240
    v_mfma_f32_16x16x32_bf16 v[48:51], v[16:19], v[16:19], 0
    ds_read_b64_tr_b16 v[110:111], v125 offset:10496
    s_add_u32 m0, s51, 40960
    s_mov_b32 s73, 345856
    buffer_load_dwordx4 v123, s[12:15], s73 offen lds
    v_mfma_f32_16x16x32_bf16 v[52:55], v[20:23], v[20:23], 0
    ds_read_b64_tr_b16 v[112:113], v126 offset:6144
    v_mfma_f32_16x16x32_bf16 v[56:59], v[24:27], v[24:27], 0
    ds_read_b64_tr_b16 v[114:115], v126 offset:6400
    v_mfma_f32_16x16x32_bf16 v[60:63], v[40:43], v[16:19], 0
    ds_read_b64_tr_b16 v[116:117], v127 offset:6144
    v_mfma_f32_16x16x32_bf16 v[64:67], v[40:43], v[20:23], 0
    ds_read_b64_tr_b16 v[118:119], v127 offset:6400
    v_mfma_f32_16x16x32_bf16 v[68:71], v[40:43], v[24:27], 0
    s_add_u32 m0, s52, 0
    s_mov_b32 s73, 256
    buffer_load_dwordx4 v120, s[8:11], s73 offen lds
    s_add_u32 m0, s52, 1024
    s_mov_b32 s73, 256
    buffer_load_dwordx4 v121, s[8:11], s73 offen lds
    s_add_u32 m0, s52, 2048
    s_mov_b32 s73, 14592
    buffer_load_dwordx4 v120, s[8:11], s73 offen lds
    s_add_u32 m0, s52, 3072
    s_mov_b32 s73, 14592
    buffer_load_dwordx4 v121, s[8:11], s73 offen lds
    s_add_u32 m0, s7, 61440
    s_mov_b32 s73, 256
    s_mov_b64 exec, s[54:55]
    buffer_load_dwordx4 v122, s[8:11], s73 offen lds
    s_mov_b64 exec, -1
    s_waitcnt vmcnt(8)
    s_barrier
    s_waitcnt lgkmcnt(8)
    v_mfma_f32_16x16x32_bf16 v[136:139], v[88:91], v[28:31], v[136:139]
    ds_read_b128 v[16:19], v128 offset:18432
    v_mfma_f32_16x16x32_bf16 v[160:163], v[88:91], v[32:35], v[160:163]
    ds_read_b128 v[20:23], v128 offset:20480
    v_mfma_f32_16x16x32_bf16 v[140:143], v[92:95], v[28:31], v[140:143]
    ds_read_b128 v[24:27], v130 offset:18432
    v_mfma_f32_16x16x32_bf16 v[164:167], v[92:95], v[32:35], v[164:167]
    ds_read_b64_tr_b16 v[88:89], v124 offset:12288
    v_mfma_f32_16x16x32_bf16 v[144:147], v[96:99], v[28:31], v[144:147]
    ds_read_b64_tr_b16 v[90:91], v124 offset:12544
    s_add_u32 m0, s51, 49152
    s_mov_b32 s73, 516096
    buffer_load_dwordx4 v123, s[12:15], s73 offen lds
    v_mfma_f32_16x16x32_bf16 v[168:171], v[96:99], v[32:35], v[168:171]
    ds_read_b64_tr_b16 v[92:93], v125 offset:12288
    v_mfma_f32_16x16x32_bf16 v[148:151], v[100:103], v[28:31], v[148:151]
    ds_read_b64_tr_b16 v[94:95], v125 offset:12544
    v_mfma_f32_16x16x32_bf16 v[172:175], v[100:103], v[32:35], v[172:175]
    ds_read_b64_tr_b16 v[96:97], v124 offset:14336
    s_waitcnt lgkmcnt(8)
    v_mfma_f32_16x16x32_bf16 v[152:155], v[28:31], v[104:107], v[152:155]
    ds_read_b64_tr_b16 v[98:99], v124 offset:14592
    v_mfma_f32_16x16x32_bf16 v[176:179], v[32:35], v[104:107], v[176:179]
    ds_read_b64_tr_b16 v[100:101], v125 offset:14336
    s_add_u32 m0, s51, 51200
    s_mov_b32 s73, 516992
    buffer_load_dwordx4 v123, s[12:15], s73 offen lds
    v_mfma_f32_16x16x32_bf16 v[156:159], v[28:31], v[108:111], v[156:159]
    ds_read_b64_tr_b16 v[102:103], v125 offset:14592
    v_mfma_f32_16x16x32_bf16 v[180:183], v[32:35], v[108:111], v[180:183]
    ds_read_b64_tr_b16 v[104:105], v124 offset:16384
    v_mfma_f32_16x16x32_bf16 v[184:187], v[112:115], v[36:39], v[184:187]
    ds_read_b64_tr_b16 v[106:107], v124 offset:16640
    v_mfma_f32_16x16x32_bf16 v[188:191], v[116:119], v[36:39], v[188:191]
    ds_read_b64_tr_b16 v[108:109], v125 offset:16384
    v_mfma_f32_16x16x32_bf16 v[48:51], v[28:31], v[28:31], v[48:51]
    ds_read_b64_tr_b16 v[110:111], v125 offset:16640
    s_add_u32 m0, s51, 53248
    s_mov_b32 s73, 517888
    buffer_load_dwordx4 v123, s[12:15], s73 offen lds
    v_mfma_f32_16x16x32_bf16 v[52:55], v[32:35], v[32:35], v[52:55]
    ds_read_b64_tr_b16 v[112:113], v126 offset:12288
    v_mfma_f32_16x16x32_bf16 v[56:59], v[36:39], v[36:39], v[56:59]
    ds_read_b64_tr_b16 v[114:115], v126 offset:12544
    v_mfma_f32_16x16x32_bf16 v[60:63], v[40:43], v[28:31], v[60:63]
    ds_read_b64_tr_b16 v[116:117], v127 offset:12288
    v_mfma_f32_16x16x32_bf16 v[64:67], v[40:43], v[32:35], v[64:67]
    ds_read_b64_tr_b16 v[118:119], v127 offset:12544
    v_mfma_f32_16x16x32_bf16 v[68:71], v[40:43], v[36:39], v[68:71]
    s_add_u32 m0, s52, 55296
    s_mov_b32 s73, 384
    buffer_load_dwordx4 v120, s[8:11], s73 offen lds
    s_waitcnt lgkmcnt(8)
    v_mfma_f32_16x16x32_bf16 v[136:139], v[88:91], v[16:19], v[136:139]
    ds_read_b128 v[28:31], v129 offset:18432
    v_mfma_f32_16x16x32_bf16 v[160:163], v[88:91], v[20:23], v[160:163]
    ds_read_b128 v[32:35], v129 offset:20480
    v_mfma_f32_16x16x32_bf16 v[140:143], v[92:95], v[16:19], v[140:143]
    ds_read_b128 v[36:39], v131 offset:18432
    v_mfma_f32_16x16x32_bf16 v[164:167], v[92:95], v[20:23], v[164:167]
    ds_read_b64_tr_b16 v[88:89], v124 offset:18432
    v_mfma_f32_16x16x32_bf16 v[144:147], v[96:99], v[16:19], v[144:147]
    ds_read_b64_tr_b16 v[90:91], v124 offset:18688
    s_add_u32 m0, s52, 56320
    s_mov_b32 s73, 384
    buffer_load_dwordx4 v121, s[8:11], s73 offen lds
    v_mfma_f32_16x16x32_bf16 v[168:171], v[96:99], v[20:23], v[168:171]
    ds_read_b64_tr_b16 v[92:93], v125 offset:18432
    v_mfma_f32_16x16x32_bf16 v[148:151], v[100:103], v[16:19], v[148:151]
    ds_read_b64_tr_b16 v[94:95], v125 offset:18688
    v_mfma_f32_16x16x32_bf16 v[172:175], v[100:103], v[20:23], v[172:175]
    ds_read_b64_tr_b16 v[96:97], v124 offset:20480
    s_waitcnt lgkmcnt(8)
    v_mfma_f32_16x16x32_bf16 v[152:155], v[16:19], v[104:107], v[152:155]
    ds_read_b64_tr_b16 v[98:99], v124 offset:20736
    v_mfma_f32_16x16x32_bf16 v[176:179], v[20:23], v[104:107], v[176:179]
    ds_read_b64_tr_b16 v[100:101], v125 offset:20480
    s_add_u32 m0, s52, 57344
    s_mov_b32 s73, 14720
    buffer_load_dwordx4 v120, s[8:11], s73 offen lds
    v_mfma_f32_16x16x32_bf16 v[156:159], v[16:19], v[108:111], v[156:159]
    ds_read_b64_tr_b16 v[102:103], v125 offset:20736
    v_mfma_f32_16x16x32_bf16 v[180:183], v[20:23], v[108:111], v[180:183]
    ds_read_b64_tr_b16 v[104:105], v124 offset:22528
    v_mfma_f32_16x16x32_bf16 v[184:187], v[112:115], v[24:27], v[184:187]
    ds_read_b64_tr_b16 v[106:107], v124 offset:22784
    v_mfma_f32_16x16x32_bf16 v[188:191], v[116:119], v[24:27], v[188:191]
    ds_read_b64_tr_b16 v[108:109], v125 offset:22528
    v_mfma_f32_16x16x32_bf16 v[48:51], v[16:19], v[16:19], v[48:51]
    ds_read_b64_tr_b16 v[110:111], v125 offset:22784
    s_add_u32 m0, s52, 58368
    s_mov_b32 s73, 14720
    buffer_load_dwordx4 v121, s[8:11], s73 offen lds
    v_mfma_f32_16x16x32_bf16 v[52:55], v[20:23], v[20:23], v[52:55]
    ds_read_b64_tr_b16 v[112:113], v126 offset:18432
    v_mfma_f32_16x16x32_bf16 v[56:59], v[24:27], v[24:27], v[56:59]
    ds_read_b64_tr_b16 v[114:115], v126 offset:18688
    v_mfma_f32_16x16x32_bf16 v[60:63], v[40:43], v[16:19], v[60:63]
    ds_read_b64_tr_b16 v[116:117], v127 offset:18432
    v_mfma_f32_16x16x32_bf16 v[64:67], v[40:43], v[20:23], v[64:67]
    ds_read_b64_tr_b16 v[118:119], v127 offset:18688
    v_mfma_f32_16x16x32_bf16 v[68:71], v[40:43], v[24:27], v[68:71]
    s_add_u32 m0, s7, 116736
    s_mov_b32 s73, 384
    s_mov_b64 exec, s[54:55]
    buffer_load_dwordx4 v122, s[8:11], s73 offen lds
    s_mov_b64 exec, -1
    s_waitcnt vmcnt(8)
    s_barrier
    s_waitcnt lgkmcnt(8)
    v_mfma_f32_16x16x32_bf16 v[136:139], v[88:91], v[28:31], v[136:139]
    ds_read_b128 v[16:19], v128 offset:0
    v_mfma_f32_16x16x32_bf16 v[160:163], v[88:91], v[32:35], v[160:163]
    ds_read_b128 v[20:23], v128 offset:2048
    v_mfma_f32_16x16x32_bf16 v[140:143], v[92:95], v[28:31], v[140:143]
    ds_read_b128 v[24:27], v130 offset:0
    v_mfma_f32_16x16x32_bf16 v[164:167], v[92:95], v[32:35], v[164:167]
    ds_read_b64_tr_b16 v[88:89], v124 offset:24576
    v_mfma_f32_16x16x32_bf16 v[144:147], v[96:99], v[28:31], v[144:147]
    ds_read_b64_tr_b16 v[90:91], v124 offset:24832
    s_add_u32 m0, s51, 12288
    s_mov_b32 s73, 688128
    buffer_load_dwordx4 v123, s[12:15], s73 offen lds
    v_mfma_f32_16x16x32_bf16 v[168:171], v[96:99], v[32:35], v[168:171]
    ds_read_b64_tr_b16 v[92:93], v125 offset:24576
    v_mfma_f32_16x16x32_bf16 v[148:151], v[100:103], v[28:31], v[148:151]
    ds_read_b64_tr_b16 v[94:95], v125 offset:24832
    v_mfma_f32_16x16x32_bf16 v[172:175], v[100:103], v[32:35], v[172:175]
    ds_read_b64_tr_b16 v[96:97], v124 offset:26624
    s_waitcnt lgkmcnt(8)
    v_mfma_f32_16x16x32_bf16 v[152:155], v[28:31], v[104:107], v[152:155]
    ds_read_b64_tr_b16 v[98:99], v124 offset:26880
    v_mfma_f32_16x16x32_bf16 v[176:179], v[32:35], v[104:107], v[176:179]
    ds_read_b64_tr_b16 v[100:101], v125 offset:26624
    s_add_u32 m0, s51, 14336
    s_mov_b32 s73, 689024
    buffer_load_dwordx4 v123, s[12:15], s73 offen lds
    v_mfma_f32_16x16x32_bf16 v[156:159], v[28:31], v[108:111], v[156:159]
    ds_read_b64_tr_b16 v[102:103], v125 offset:26880
    v_mfma_f32_16x16x32_bf16 v[180:183], v[32:35], v[108:111], v[180:183]
    ds_read_b64_tr_b16 v[104:105], v124 offset:28672
    v_mfma_f32_16x16x32_bf16 v[184:187], v[112:115], v[36:39], v[184:187]
    ds_read_b64_tr_b16 v[106:107], v124 offset:28928
    v_mfma_f32_16x16x32_bf16 v[188:191], v[116:119], v[36:39], v[188:191]
    ds_read_b64_tr_b16 v[108:109], v125 offset:28672
    v_mfma_f32_16x16x32_bf16 v[48:51], v[28:31], v[28:31], v[48:51]
    ds_read_b64_tr_b16 v[110:111], v125 offset:28928
    s_add_u32 m0, s51, 16384
    s_mov_b32 s73, 689920
    buffer_load_dwordx4 v123, s[12:15], s73 offen lds
    v_mfma_f32_16x16x32_bf16 v[52:55], v[32:35], v[32:35], v[52:55]
    ds_read_b64_tr_b16 v[112:113], v126 offset:24576
    v_mfma_f32_16x16x32_bf16 v[56:59], v[36:39], v[36:39], v[56:59]
    ds_read_b64_tr_b16 v[114:115], v126 offset:24832
    v_mfma_f32_16x16x32_bf16 v[60:63], v[40:43], v[28:31], v[60:63]
    ds_read_b64_tr_b16 v[116:117], v127 offset:24576
    v_mfma_f32_16x16x32_bf16 v[64:67], v[40:43], v[32:35], v[64:67]
    ds_read_b64_tr_b16 v[118:119], v127 offset:24832
    v_mfma_f32_16x16x32_bf16 v[68:71], v[40:43], v[36:39], v[68:71]
    s_add_u32 m0, s52, 36864
    s_mov_b32 s73, 512
    buffer_load_dwordx4 v120, s[8:11], s73 offen lds
    s_waitcnt lgkmcnt(8)
    v_mfma_f32_16x16x32_bf16 v[136:139], v[88:91], v[16:19], v[136:139]
    ds_read_b128 v[28:31], v129 offset:0
    v_mfma_f32_16x16x32_bf16 v[160:163], v[88:91], v[20:23], v[160:163]
    ds_read_b128 v[32:35], v129 offset:2048
    v_mfma_f32_16x16x32_bf16 v[140:143], v[92:95], v[16:19], v[140:143]
    ds_read_b128 v[36:39], v131 offset:0
    v_mfma_f32_16x16x32_bf16 v[164:167], v[92:95], v[20:23], v[164:167]
    ds_read_b64_tr_b16 v[88:89], v124 offset:30720
    v_mfma_f32_16x16x32_bf16 v[144:147], v[96:99], v[16:19], v[144:147]
    ds_read_b64_tr_b16 v[90:91], v124 offset:30976
    s_add_u32 m0, s52, 37888
    s_mov_b32 s73, 512
    buffer_load_dwordx4 v121, s[8:11], s73 offen lds
    v_mfma_f32_16x16x32_bf16 v[168:171], v[96:99], v[20:23], v[168:171]
    ds_read_b64_tr_b16 v[92:93], v125 offset:30720
    v_mfma_f32_16x16x32_bf16 v[148:151], v[100:103], v[16:19], v[148:151]
    ds_read_b64_tr_b16 v[94:95], v125 offset:30976
    v_mfma_f32_16x16x32_bf16 v[172:175], v[100:103], v[20:23], v[172:175]
    ds_read_b64_tr_b16 v[96:97], v124 offset:32768
    s_waitcnt lgkmcnt(8)
    v_mfma_f32_16x16x32_bf16 v[152:155], v[16:19], v[104:107], v[152:155]
    ds_read_b64_tr_b16 v[98:99], v124 offset:33024
    v_mfma_f32_16x16x32_bf16 v[176:179], v[20:23], v[104:107], v[176:179]
    ds_read_b64_tr_b16 v[100:101], v125 offset:32768
    s_add_u32 m0, s52, 38912
    s_mov_b32 s73, 14848
    buffer_load_dwordx4 v120, s[8:11], s73 offen lds
    v_mfma_f32_16x16x32_bf16 v[156:159], v[16:19], v[108:111], v[156:159]
    ds_read_b64_tr_b16 v[102:103], v125 offset:33024
    v_mfma_f32_16x16x32_bf16 v[180:183], v[20:23], v[108:111], v[180:183]
    ds_read_b64_tr_b16 v[104:105], v124 offset:34816
    v_mfma_f32_16x16x32_bf16 v[184:187], v[112:115], v[24:27], v[184:187]
    ds_read_b64_tr_b16 v[106:107], v124 offset:35072
    v_mfma_f32_16x16x32_bf16 v[188:191], v[116:119], v[24:27], v[188:191]
    ds_read_b64_tr_b16 v[108:109], v125 offset:34816
    v_mfma_f32_16x16x32_bf16 v[48:51], v[16:19], v[16:19], v[48:51]
    ds_read_b64_tr_b16 v[110:111], v125 offset:35072
    s_add_u32 m0, s52, 39936
    s_mov_b32 s73, 14848
    buffer_load_dwordx4 v121, s[8:11], s73 offen lds
    v_mfma_f32_16x16x32_bf16 v[52:55], v[20:23], v[20:23], v[52:55]
    ds_read_b64_tr_b16 v[112:113], v126 offset:30720
    v_mfma_f32_16x16x32_bf16 v[56:59], v[24:27], v[24:27], v[56:59]
    ds_read_b64_tr_b16 v[114:115], v126 offset:30976
    v_mfma_f32_16x16x32_bf16 v[60:63], v[40:43], v[16:19], v[60:63]
    ds_read_b64_tr_b16 v[116:117], v127 offset:30720
    v_mfma_f32_16x16x32_bf16 v[64:67], v[40:43], v[20:23], v[64:67]
    ds_read_b64_tr_b16 v[118:119], v127 offset:30976
    v_mfma_f32_16x16x32_bf16 v[68:71], v[40:43], v[24:27], v[68:71]
    s_add_u32 m0, s7, 98304
    s_mov_b32 s73, 512
    s_mov_b64 exec, s[54:55]
    buffer_load_dwordx4 v122, s[8:11], s73 offen lds
    s_mov_b64 exec, -1
    s_waitcnt vmcnt(8)
    s_barrier
    s_waitcnt lgkmcnt(8)
    v_mfma_f32_16x16x32_bf16 v[136:139], v[88:91], v[28:31], v[136:139]
    ds_read_b128 v[16:19], v128 offset:55296
    v_mfma_f32_16x16x32_bf16 v[160:163], v[88:91], v[32:35], v[160:163]
    ds_read_b128 v[20:23], v128 offset:57344
    v_mfma_f32_16x16x32_bf16 v[140:143], v[92:95], v[28:31], v[140:143]
    ds_read_b128 v[24:27], v130 offset:55296
    v_mfma_f32_16x16x32_bf16 v[164:167], v[92:95], v[32:35], v[164:167]
    ds_read_b64_tr_b16 v[88:89], v124 offset:36864
    v_mfma_f32_16x16x32_bf16 v[144:147], v[96:99], v[28:31], v[144:147]
    ds_read_b64_tr_b16 v[90:91], v124 offset:37120
    s_add_u32 m0, s51, 24576
    s_mov_b32 s73, 860160
    buffer_load_dwordx4 v123, s[12:15], s73 offen lds
    v_mfma_f32_16x16x32_bf16 v[168:171], v[96:99], v[32:35], v[168:171]
    ds_read_b64_tr_b16 v[92:93], v125 offset:36864
    v_mfma_f32_16x16x32_bf16 v[148:151], v[100:103], v[28:31], v[148:151]
    ds_read_b64_tr_b16 v[94:95], v125 offset:37120
    v_mfma_f32_16x16x32_bf16 v[172:175], v[100:103], v[32:35], v[172:175]
    ds_read_b64_tr_b16 v[96:97], v124 offset:38912
    s_waitcnt lgkmcnt(8)
    v_mfma_f32_16x16x32_bf16 v[152:155], v[28:31], v[104:107], v[152:155]
    ds_read_b64_tr_b16 v[98:99], v124 offset:39168
    v_mfma_f32_16x16x32_bf16 v[176:179], v[32:35], v[104:107], v[176:179]
    ds_read_b64_tr_b16 v[100:101], v125 offset:38912
    s_add_u32 m0, s51, 26624
    s_mov_b32 s73, 861056
    buffer_load_dwordx4 v123, s[12:15], s73 offen lds
    v_mfma_f32_16x16x32_bf16 v[156:159], v[28:31], v[108:111], v[156:159]
    ds_read_b64_tr_b16 v[102:103], v125 offset:39168
    v_mfma_f32_16x16x32_bf16 v[180:183], v[32:35], v[108:111], v[180:183]
    ds_read_b64_tr_b16 v[104:105], v124 offset:40960
    v_mfma_f32_16x16x32_bf16 v[184:187], v[112:115], v[36:39], v[184:187]
    ds_read_b64_tr_b16 v[106:107], v124 offset:41216
    v_mfma_f32_16x16x32_bf16 v[188:191], v[116:119], v[36:39], v[188:191]
    ds_read_b64_tr_b16 v[108:109], v125 offset:40960
    v_mfma_f32_16x16x32_bf16 v[48:51], v[28:31], v[28:31], v[48:51]
    ds_read_b64_tr_b16 v[110:111], v125 offset:41216
    s_add_u32 m0, s51, 28672
    s_mov_b32 s73, 861952
    buffer_load_dwordx4 v123, s[12:15], s73 offen lds
    v_mfma_f32_16x16x32_bf16 v[52:55], v[32:35], v[32:35], v[52:55]
    ds_read_b64_tr_b16 v[112:113], v126 offset:36864
    v_mfma_f32_16x16x32_bf16 v[56:59], v[36:39], v[36:39], v[56:59]
    ds_read_b64_tr_b16 v[114:115], v126 offset:37120
    v_mfma_f32_16x16x32_bf16 v[60:63], v[40:43], v[28:31], v[60:63]
    ds_read_b64_tr_b16 v[116:117], v127 offset:36864
    v_mfma_f32_16x16x32_bf16 v[64:67], v[40:43], v[32:35], v[64:67]
    ds_read_b64_tr_b16 v[118:119], v127 offset:37120
    v_mfma_f32_16x16x32_bf16 v[68:71], v[40:43], v[36:39], v[68:71]
    s_add_u32 m0, s52, 18432
    s_mov_b32 s73, 640
    buffer_load_dwordx4 v120, s[8:11], s73 offen lds
    s_waitcnt lgkmcnt(8)
    v_mfma_f32_16x16x32_bf16 v[136:139], v[88:91], v[16:19], v[136:139]
    ds_read_b128 v[28:31], v129 offset:55296
    v_mfma_f32_16x16x32_bf16 v[160:163], v[88:91], v[20:23], v[160:163]
    ds_read_b128 v[32:35], v129 offset:57344
    v_mfma_f32_16x16x32_bf16 v[140:143], v[92:95], v[16:19], v[140:143]
    ds_read_b128 v[36:39], v131 offset:55296
    v_mfma_f32_16x16x32_bf16 v[164:167], v[92:95], v[20:23], v[164:167]
    ds_read_b64_tr_b16 v[88:89], v124 offset:43008
    v_mfma_f32_16x16x32_bf16 v[144:147], v[96:99], v[16:19], v[144:147]
    ds_read_b64_tr_b16 v[90:91], v124 offset:43264
    s_add_u32 m0, s52, 19456
    s_mov_b32 s73, 640
    buffer_load_dwordx4 v121, s[8:11], s73 offen lds
    v_mfma_f32_16x16x32_bf16 v[168:171], v[96:99], v[20:23], v[168:171]
    ds_read_b64_tr_b16 v[92:93], v125 offset:43008
    v_mfma_f32_16x16x32_bf16 v[148:151], v[100:103], v[16:19], v[148:151]
    ds_read_b64_tr_b16 v[94:95], v125 offset:43264
    v_mfma_f32_16x16x32_bf16 v[172:175], v[100:103], v[20:23], v[172:175]
    ds_read_b64_tr_b16 v[96:97], v124 offset:45056
    s_waitcnt lgkmcnt(8)
    v_mfma_f32_16x16x32_bf16 v[152:155], v[16:19], v[104:107], v[152:155]
    ds_read_b64_tr_b16 v[98:99], v124 offset:45312
    v_mfma_f32_16x16x32_bf16 v[176:179], v[20:23], v[104:107], v[176:179]
    ds_read_b64_tr_b16 v[100:101], v125 offset:45056
    s_add_u32 m0, s52, 20480
    s_mov_b32 s73, 14976
    buffer_load_dwordx4 v120, s[8:11], s73 offen lds
    v_mfma_f32_16x16x32_bf16 v[156:159], v[16:19], v[108:111], v[156:159]
    ds_read_b64_tr_b16 v[102:103], v125 offset:45312
    v_mfma_f32_16x16x32_bf16 v[180:183], v[20:23], v[108:111], v[180:183]
    ds_read_b64_tr_b16 v[104:105], v124 offset:47104
    v_mfma_f32_16x16x32_bf16 v[184:187], v[112:115], v[24:27], v[184:187]
    ds_read_b64_tr_b16 v[106:107], v124 offset:47360
    v_mfma_f32_16x16x32_bf16 v[188:191], v[116:119], v[24:27], v[188:191]
    ds_read_b64_tr_b16 v[108:109], v125 offset:47104
    v_mfma_f32_16x16x32_bf16 v[48:51], v[16:19], v[16:19], v[48:51]
    ds_read_b64_tr_b16 v[110:111], v125 offset:47360
    s_add_u32 m0, s52, 21504
    s_mov_b32 s73, 14976
    buffer_load_dwordx4 v121, s[8:11], s73 offen lds
    v_mfma_f32_16x16x32_bf16 v[52:55], v[20:23], v[20:23], v[52:55]
    ds_read_b64_tr_b16 v[112:113], v126 offset:43008
    v_mfma_f32_16x16x32_bf16 v[56:59], v[24:27], v[24:27], v[56:59]
    ds_read_b64_tr_b16 v[114:115], v126 offset:43264
    v_mfma_f32_16x16x32_bf16 v[60:63], v[40:43], v[16:19], v[60:63]
    ds_read_b64_tr_b16 v[116:117], v127 offset:43008
    v_mfma_f32_16x16x32_bf16 v[64:67], v[40:43], v[20:23], v[64:67]
    ds_read_b64_tr_b16 v[118:119], v127 offset:43264
    v_mfma_f32_16x16x32_bf16 v[68:71], v[40:43], v[24:27], v[68:71]
    s_add_u32 m0, s7, 79872
    s_mov_b32 s73, 640
    s_mov_b64 exec, s[54:55]
    buffer_load_dwordx4 v122, s[8:11], s73 offen lds
    s_mov_b64 exec, -1
    s_waitcnt vmcnt(8)
    s_barrier
    s_waitcnt lgkmcnt(8)
    v_mfma_f32_16x16x32_bf16 v[136:139], v[88:91], v[28:31], v[136:139]
    ds_read_b128 v[16:19], v128 offset:36864
    v_mfma_f32_16x16x32_bf16 v[160:163], v[88:91], v[32:35], v[160:163]
    ds_read_b128 v[20:23], v128 offset:38912
    v_mfma_f32_16x16x32_bf16 v[140:143], v[92:95], v[28:31], v[140:143]
    ds_read_b128 v[24:27], v130 offset:36864
    v_mfma_f32_16x16x32_bf16 v[164:167], v[92:95], v[32:35], v[164:167]
    ds_read_b64_tr_b16 v[88:89], v124 offset:0
    v_mfma_f32_16x16x32_bf16 v[144:147], v[96:99], v[28:31], v[144:147]
    ds_read_b64_tr_b16 v[90:91], v124 offset:256
    s_add_u32 m0, s51, 36864
    s_mov_b32 s73, 1032192
    buffer_load_dwordx4 v123, s[12:15], s73 offen lds
    v_mfma_f32_16x16x32_bf16 v[168:171], v[96:99], v[32:35], v[168:171]
    ds_read_b64_tr_b16 v[92:93], v125 offset:0
    v_mfma_f32_16x16x32_bf16 v[148:151], v[100:103], v[28:31], v[148:151]
    ds_read_b64_tr_b16 v[94:95], v125 offset:256
    v_mfma_f32_16x16x32_bf16 v[172:175], v[100:103], v[32:35], v[172:175]
    ds_read_b64_tr_b16 v[96:97], v124 offset:2048
    s_waitcnt lgkmcnt(8)
    v_mfma_f32_16x16x32_bf16 v[152:155], v[28:31], v[104:107], v[152:155]
    ds_read_b64_tr_b16 v[98:99], v124 offset:2304
    v_mfma_f32_16x16x32_bf16 v[176:179], v[32:35], v[104:107], v[176:179]
    ds_read_b64_tr_b16 v[100:101], v125 offset:2048
    s_add_u32 m0, s51, 38912
    s_mov_b32 s73, 1033088
    buffer_load_dwordx4 v123, s[12:15], s73 offen lds
    v_mfma_f32_16x16x32_bf16 v[156:159], v[28:31], v[108:111], v[156:159]
    ds_read_b64_tr_b16 v[102:103], v125 offset:2304
    v_mfma_f32_16x16x32_bf16 v[180:183], v[32:35], v[108:111], v[180:183]
    ds_read_b64_tr_b16 v[104:105], v124 offset:4096
    v_mfma_f32_16x16x32_bf16 v[184:187], v[112:115], v[36:39], v[184:187]
    ds_read_b64_tr_b16 v[106:107], v124 offset:4352
    v_mfma_f32_16x16x32_bf16 v[188:191], v[116:119], v[36:39], v[188:191]
    ds_read_b64_tr_b16 v[108:109], v125 offset:4096
    v_mfma_f32_16x16x32_bf16 v[48:51], v[28:31], v[28:31], v[48:51]
    ds_read_b64_tr_b16 v[110:111], v125 offset:4352
    s_add_u32 m0, s51, 40960
    s_mov_b32 s73, 1033984
    buffer_load_dwordx4 v123, s[12:15], s73 offen lds
    v_mfma_f32_16x16x32_bf16 v[52:55], v[32:35], v[32:35], v[52:55]
    ds_read_b64_tr_b16 v[112:113], v126 offset:0
    v_mfma_f32_16x16x32_bf16 v[56:59], v[36:39], v[36:39], v[56:59]
    ds_read_b64_tr_b16 v[114:115], v126 offset:256
    v_mfma_f32_16x16x32_bf16 v[60:63], v[40:43], v[28:31], v[60:63]
    ds_read_b64_tr_b16 v[116:117], v127 offset:0
    v_mfma_f32_16x16x32_bf16 v[64:67], v[40:43], v[32:35], v[64:67]
    ds_read_b64_tr_b16 v[118:119], v127 offset:256
    v_mfma_f32_16x16x32_bf16 v[68:71], v[40:43], v[36:39], v[68:71]
    s_add_u32 m0, s52, 0
    s_mov_b32 s73, 768
    buffer_load_dwordx4 v120, s[8:11], s73 offen lds
    s_waitcnt lgkmcnt(8)
    v_mfma_f32_16x16x32_bf16 v[136:139], v[88:91], v[16:19], v[136:139]
    ds_read_b128 v[28:31], v129 offset:36864
    v_mfma_f32_16x16x32_bf16 v[160:163], v[88:91], v[20:23], v[160:163]
    ds_read_b128 v[32:35], v129 offset:38912
    v_mfma_f32_16x16x32_bf16 v[140:143], v[92:95], v[16:19], v[140:143]
    ds_read_b128 v[36:39], v131 offset:36864
    v_mfma_f32_16x16x32_bf16 v[164:167], v[92:95], v[20:23], v[164:167]
    ds_read_b64_tr_b16 v[88:89], v124 offset:6144
    v_mfma_f32_16x16x32_bf16 v[144:147], v[96:99], v[16:19], v[144:147]
    ds_read_b64_tr_b16 v[90:91], v124 offset:6400
    s_add_u32 m0, s52, 1024
    s_mov_b32 s73, 768
    buffer_load_dwordx4 v121, s[8:11], s73 offen lds
    v_mfma_f32_16x16x32_bf16 v[168:171], v[96:99], v[20:23], v[168:171]
    ds_read_b64_tr_b16 v[92:93], v125 offset:6144
    v_mfma_f32_16x16x32_bf16 v[148:151], v[100:103], v[16:19], v[148:151]
    ds_read_b64_tr_b16 v[94:95], v125 offset:6400
    v_mfma_f32_16x16x32_bf16 v[172:175], v[100:103], v[20:23], v[172:175]
    ds_read_b64_tr_b16 v[96:97], v124 offset:8192
    s_waitcnt lgkmcnt(8)
    v_mfma_f32_16x16x32_bf16 v[152:155], v[16:19], v[104:107], v[152:155]
    ds_read_b64_tr_b16 v[98:99], v124 offset:8448
    v_mfma_f32_16x16x32_bf16 v[176:179], v[20:23], v[104:107], v[176:179]
    ds_read_b64_tr_b16 v[100:101], v125 offset:8192
    s_add_u32 m0, s52, 2048
    s_mov_b32 s73, 15104
    buffer_load_dwordx4 v120, s[8:11], s73 offen lds
    v_mfma_f32_16x16x32_bf16 v[156:159], v[16:19], v[108:111], v[156:159]
    ds_read_b64_tr_b16 v[102:103], v125 offset:8448
    v_mfma_f32_16x16x32_bf16 v[180:183], v[20:23], v[108:111], v[180:183]
    ds_read_b64_tr_b16 v[104:105], v124 offset:10240
    v_mfma_f32_16x16x32_bf16 v[184:187], v[112:115], v[24:27], v[184:187]
    ds_read_b64_tr_b16 v[106:107], v124 offset:10496
    v_mfma_f32_16x16x32_bf16 v[188:191], v[116:119], v[24:27], v[188:191]
    ds_read_b64_tr_b16 v[108:109], v125 offset:10240
    v_mfma_f32_16x16x32_bf16 v[48:51], v[16:19], v[16:19], v[48:51]
    ds_read_b64_tr_b16 v[110:111], v125 offset:10496
    s_add_u32 m0, s52, 3072
    s_mov_b32 s73, 15104
    buffer_load_dwordx4 v121, s[8:11], s73 offen lds
    v_mfma_f32_16x16x32_bf16 v[52:55], v[20:23], v[20:23], v[52:55]
    ds_read_b64_tr_b16 v[112:113], v126 offset:6144
    v_mfma_f32_16x16x32_bf16 v[56:59], v[24:27], v[24:27], v[56:59]
    ds_read_b64_tr_b16 v[114:115], v126 offset:6400
    v_mfma_f32_16x16x32_bf16 v[60:63], v[40:43], v[16:19], v[60:63]
    ds_read_b64_tr_b16 v[116:117], v127 offset:6144
    v_mfma_f32_16x16x32_bf16 v[64:67], v[40:43], v[20:23], v[64:67]
    ds_read_b64_tr_b16 v[118:119], v127 offset:6400
    v_mfma_f32_16x16x32_bf16 v[68:71], v[40:43], v[24:27], v[68:71]
    s_add_u32 m0, s7, 61440
    s_mov_b32 s73, 768
    s_mov_b64 exec, s[54:55]
    buffer_load_dwordx4 v122, s[8:11], s73 offen lds
    s_mov_b64 exec, -1
    s_waitcnt vmcnt(8)
    s_barrier
    s_waitcnt lgkmcnt(8)
    v_mfma_f32_16x16x32_bf16 v[136:139], v[88:91], v[28:31], v[136:139]
    ds_read_b128 v[16:19], v128 offset:18432
    v_mfma_f32_16x16x32_bf16 v[160:163], v[88:91], v[32:35], v[160:163]
    ds_read_b128 v[20:23], v128 offset:20480
    v_mfma_f32_16x16x32_bf16 v[140:143], v[92:95], v[28:31], v[140:143]
    ds_read_b128 v[24:27], v130 offset:18432
    v_mfma_f32_16x16x32_bf16 v[164:167], v[92:95], v[32:35], v[164:167]
    ds_read_b64_tr_b16 v[88:89], v124 offset:12288
    v_mfma_f32_16x16x32_bf16 v[144:147], v[96:99], v[28:31], v[144:147]
    ds_read_b64_tr_b16 v[90:91], v124 offset:12544
    v_mfma_f32_16x16x32_bf16 v[168:171], v[96:99], v[32:35], v[168:171]
    ds_read_b64_tr_b16 v[92:93], v125 offset:12288
    v_mfma_f32_16x16x32_bf16 v[148:151], v[100:103], v[28:31], v[148:151]
    ds_read_b64_tr_b16 v[94:95], v125 offset:12544
    v_mfma_f32_16x16x32_bf16 v[172:175], v[100:103], v[32:35], v[172:175]
    ds_read_b64_tr_b16 v[96:97], v124 offset:14336
    s_waitcnt lgkmcnt(8)
    v_mfma_f32_16x16x32_bf16 v[152:155], v[28:31], v[104:107], v[152:155]
    ds_read_b64_tr_b16 v[98:99], v124 offset:14592
    v_mfma_f32_16x16x32_bf16 v[176:179], v[32:35], v[104:107], v[176:179]
    ds_read_b64_tr_b16 v[100:101], v125 offset:14336
    v_mfma_f32_16x16x32_bf16 v[156:159], v[28:31], v[108:111], v[156:159]
    ds_read_b64_tr_b16 v[102:103], v125 offset:14592
    v_mfma_f32_16x16x32_bf16 v[180:183], v[32:35], v[108:111], v[180:183]
    ds_read_b64_tr_b16 v[104:105], v124 offset:16384
    v_mfma_f32_16x16x32_bf16 v[184:187], v[112:115], v[36:39], v[184:187]
    ds_read_b64_tr_b16 v[106:107], v124 offset:16640
    v_mfma_f32_16x16x32_bf16 v[188:191], v[116:119], v[36:39], v[188:191]
    ds_read_b64_tr_b16 v[108:109], v125 offset:16384
    v_mfma_f32_16x16x32_bf16 v[48:51], v[28:31], v[28:31], v[48:51]
    ds_read_b64_tr_b16 v[110:111], v125 offset:16640
    v_mfma_f32_16x16x32_bf16 v[52:55], v[32:35], v[32:35], v[52:55]
    ds_read_b64_tr_b16 v[112:113], v126 offset:12288
    v_mfma_f32_16x16x32_bf16 v[56:59], v[36:39], v[36:39], v[56:59]
    ds_read_b64_tr_b16 v[114:115], v126 offset:12544
    v_mfma_f32_16x16x32_bf16 v[60:63], v[40:43], v[28:31], v[60:63]
    ds_read_b64_tr_b16 v[116:117], v127 offset:12288
    v_mfma_f32_16x16x32_bf16 v[64:67], v[40:43], v[32:35], v[64:67]
    ds_read_b64_tr_b16 v[118:119], v127 offset:12544
    v_mfma_f32_16x16x32_bf16 v[68:71], v[40:43], v[36:39], v[68:71]
    s_waitcnt lgkmcnt(8)
    v_mfma_f32_16x16x32_bf16 v[136:139], v[88:91], v[16:19], v[136:139]
    ds_read_b128 v[28:31], v129 offset:18432
    v_mfma_f32_16x16x32_bf16 v[160:163], v[88:91], v[20:23], v[160:163]
    ds_read_b128 v[32:35], v129 offset:20480
    v_mfma_f32_16x16x32_bf16 v[140:143], v[92:95], v[16:19], v[140:143]
    ds_read_b128 v[36:39], v131 offset:18432
    v_mfma_f32_16x16x32_bf16 v[164:167], v[92:95], v[20:23], v[164:167]
    ds_read_b64_tr_b16 v[88:89], v124 offset:18432
    v_mfma_f32_16x16x32_bf16 v[144:147], v[96:99], v[16:19], v[144:147]
    ds_read_b64_tr_b16 v[90:91], v124 offset:18688
    v_mfma_f32_16x16x32_bf16 v[168:171], v[96:99], v[20:23], v[168:171]
    ds_read_b64_tr_b16 v[92:93], v125 offset:18432
    v_mfma_f32_16x16x32_bf16 v[148:151], v[100:103], v[16:19], v[148:151]
    ds_read_b64_tr_b16 v[94:95], v125 offset:18688
    v_mfma_f32_16x16x32_bf16 v[172:175], v[100:103], v[20:23], v[172:175]
    ds_read_b64_tr_b16 v[96:97], v124 offset:20480
    s_waitcnt lgkmcnt(8)
    v_mfma_f32_16x16x32_bf16 v[152:155], v[16:19], v[104:107], v[152:155]
    ds_read_b64_tr_b16 v[98:99], v124 offset:20736
    v_mfma_f32_16x16x32_bf16 v[176:179], v[20:23], v[104:107], v[176:179]
    ds_read_b64_tr_b16 v[100:101], v125 offset:20480
    v_mfma_f32_16x16x32_bf16 v[156:159], v[16:19], v[108:111], v[156:159]
    ds_read_b64_tr_b16 v[102:103], v125 offset:20736
    v_mfma_f32_16x16x32_bf16 v[180:183], v[20:23], v[108:111], v[180:183]
    ds_read_b64_tr_b16 v[104:105], v124 offset:22528
    v_mfma_f32_16x16x32_bf16 v[184:187], v[112:115], v[24:27], v[184:187]
    ds_read_b64_tr_b16 v[106:107], v124 offset:22784
    v_mfma_f32_16x16x32_bf16 v[188:191], v[116:119], v[24:27], v[188:191]
    ds_read_b64_tr_b16 v[108:109], v125 offset:22528
    v_mfma_f32_16x16x32_bf16 v[48:51], v[16:19], v[16:19], v[48:51]
    ds_read_b64_tr_b16 v[110:111], v125 offset:22784
    v_mfma_f32_16x16x32_bf16 v[52:55], v[20:23], v[20:23], v[52:55]
    ds_read_b64_tr_b16 v[112:113], v126 offset:18432
    v_mfma_f32_16x16x32_bf16 v[56:59], v[24:27], v[24:27], v[56:59]
    ds_read_b64_tr_b16 v[114:115], v126 offset:18688
    v_mfma_f32_16x16x32_bf16 v[60:63], v[40:43], v[16:19], v[60:63]
    ds_read_b64_tr_b16 v[116:117], v127 offset:18432
    v_mfma_f32_16x16x32_bf16 v[64:67], v[40:43], v[20:23], v[64:67]
    ds_read_b64_tr_b16 v[118:119], v127 offset:18688
    v_mfma_f32_16x16x32_bf16 v[68:71], v[40:43], v[24:27], v[68:71]
    v_mov_b32 v7, 0
    buffer_load_dword v6, v7, s[44:47], 0 offen sc1
    s_lshr_b32 s68, s2, 3
    s_lshl_b32 s68, s68, 2
    s_add_u32 s68, s68, s3
    v_lshlrev_b32 v219, 7, v1
    s_mul_i32 s86, s68, 3200
    s_mov_b64 exec, 0x1ffffff
    buffer_load_dword v234, v219, s[16:19], s86 offen
    s_mov_b64 exec, -1
    v_lshrrev_b32 v219, 2, v1
    v_mul_u32_u24 v219, 3584, v219
    v_and_b32 v220, 3, v1
    v_lshl_add_u32 v219, v220, 7, v219
    s_mul_i32 s68, s68, 57344
    s_and_b32 s69, s2, 7
    s_mul_i32 s86, s69, 3
    s_add_u32 s86, s86, 4
    s_lshl_b32 s87, s69, 2
    s_min_u32 s86, s86, s87
    s_lshl_b32 s86, s86, 7
    s_add_u32 s86, s86, s68
    s_cmp_lt_u32 s69, 4
    s_cselect_b32 exec_lo, -1, 0x77777777
    s_cselect_b32 exec_hi, -1, 0x77777777
    s_lshr_b32 s68, s2, 3
    s_sub_u32 s68, s68, s69
    s_and_b32 s68, s68, 7
    s_cmp_lt_u32 s68, 4
    s_cselect_b64 exec, exec, 0
    buffer_load_dword v235, v219, s[20:23], s86 offen
    s_mov_b64 exec, -1
    s_waitcnt vmcnt(3)
    s_barrier
    s_waitcnt lgkmcnt(8)
    v_mfma_f32_16x16x32_bf16 v[136:139], v[88:91], v[28:31], v[136:139]
    ds_read_b128 v[16:19], v128 offset:0
    v_mfma_f32_16x16x32_bf16 v[160:163], v[88:91], v[32:35], v[160:163]
    ds_read_b128 v[20:23], v128 offset:2048
    v_mfma_f32_16x16x32_bf16 v[140:143], v[92:95], v[28:31], v[140:143]
    ds_read_b128 v[24:27], v130 offset:0
    v_mfma_f32_16x16x32_bf16 v[164:167], v[92:95], v[32:35], v[164:167]
    ds_read_b64_tr_b16 v[88:89], v124 offset:24576
    v_mfma_f32_16x16x32_bf16 v[144:147], v[96:99], v[28:31], v[144:147]
    ds_read_b64_tr_b16 v[90:91], v124 offset:24832
    v_mfma_f32_16x16x32_bf16 v[168:171], v[96:99], v[32:35], v[168:171]
    ds_read_b64_tr_b16 v[92:93], v125 offset:24576
    v_mfma_f32_16x16x32_bf16 v[148:151], v[100:103], v[28:31], v[148:151]
    ds_read_b64_tr_b16 v[94:95], v125 offset:24832
    v_mfma_f32_16x16x32_bf16 v[172:175], v[100:103], v[32:35], v[172:175]
    ds_read_b64_tr_b16 v[96:97], v124 offset:26624
    s_waitcnt lgkmcnt(8)
    v_mfma_f32_16x16x32_bf16 v[152:155], v[28:31], v[104:107], v[152:155]
    ds_read_b64_tr_b16 v[98:99], v124 offset:26880
    v_mfma_f32_16x16x32_bf16 v[176:179], v[32:35], v[104:107], v[176:179]
    ds_read_b64_tr_b16 v[100:101], v125 offset:26624
    v_mfma_f32_16x16x32_bf16 v[156:159], v[28:31], v[108:111], v[156:159]
    ds_read_b64_tr_b16 v[102:103], v125 offset:26880
    v_mfma_f32_16x16x32_bf16 v[180:183], v[32:35], v[108:111], v[180:183]
    ds_read_b64_tr_b16 v[104:105], v124 offset:28672
    v_mfma_f32_16x16x32_bf16 v[184:187], v[112:115], v[36:39], v[184:187]
    ds_read_b64_tr_b16 v[106:107], v124 offset:28928
    v_mfma_f32_16x16x32_bf16 v[188:191], v[116:119], v[36:39], v[188:191]
    ds_read_b64_tr_b16 v[108:109], v125 offset:28672
    v_mfma_f32_16x16x32_bf16 v[48:51], v[28:31], v[28:31], v[48:51]
    ds_read_b64_tr_b16 v[110:111], v125 offset:28928
    v_mfma_f32_16x16x32_bf16 v[52:55], v[32:35], v[32:35], v[52:55]
    ds_read_b64_tr_b16 v[112:113], v126 offset:24576
    v_mfma_f32_16x16x32_bf16 v[56:59], v[36:39], v[36:39], v[56:59]
    ds_read_b64_tr_b16 v[114:115], v126 offset:24832
    v_mfma_f32_16x16x32_bf16 v[60:63], v[40:43], v[28:31], v[60:63]
    ds_read_b64_tr_b16 v[116:117], v127 offset:24576
    v_mfma_f32_16x16x32_bf16 v[64:67], v[40:43], v[32:35], v[64:67]
    ds_read_b64_tr_b16 v[118:119], v127 offset:24832
    v_mfma_f32_16x16x32_bf16 v[68:71], v[40:43], v[36:39], v[68:71]
    s_waitcnt lgkmcnt(8)
    v_mfma_f32_16x16x32_bf16 v[136:139], v[88:91], v[16:19], v[136:139]
    ds_read_b128 v[28:31], v129 offset:0
    v_mfma_f32_16x16x32_bf16 v[160:163], v[88:91], v[20:23], v[160:163]
    ds_read_b128 v[32:35], v129 offset:2048
    v_mfma_f32_16x16x32_bf16 v[140:143], v[92:95], v[16:19], v[140:143]
    ds_read_b128 v[36:39], v131 offset:0
    v_mfma_f32_16x16x32_bf16 v[164:167], v[92:95], v[20:23], v[164:167]
    ds_read_b64_tr_b16 v[88:89], v124 offset:30720
    v_mfma_f32_16x16x32_bf16 v[144:147], v[96:99], v[16:19], v[144:147]
    ds_read_b64_tr_b16 v[90:91], v124 offset:30976
    v_mfma_f32_16x16x32_bf16 v[168:171], v[96:99], v[20:23], v[168:171]
    ds_read_b64_tr_b16 v[92:93], v125 offset:30720
    v_mfma_f32_16x16x32_bf16 v[148:151], v[100:103], v[16:19], v[148:151]
    ds_read_b64_tr_b16 v[94:95], v125 offset:30976
    v_mfma_f32_16x16x32_bf16 v[172:175], v[100:103], v[20:23], v[172:175]
    ds_read_b64_tr_b16 v[96:97], v124 offset:32768
    s_waitcnt lgkmcnt(8)
    v_mfma_f32_16x16x32_bf16 v[152:155], v[16:19], v[104:107], v[152:155]
    ds_read_b64_tr_b16 v[98:99], v124 offset:33024
    v_mfma_f32_16x16x32_bf16 v[176:179], v[20:23], v[104:107], v[176:179]
    ds_read_b64_tr_b16 v[100:101], v125 offset:32768
    v_mfma_f32_16x16x32_bf16 v[156:159], v[16:19], v[108:111], v[156:159]
    ds_read_b64_tr_b16 v[102:103], v125 offset:33024
    v_mfma_f32_16x16x32_bf16 v[180:183], v[20:23], v[108:111], v[180:183]
    ds_read_b64_tr_b16 v[104:105], v124 offset:34816
    v_mfma_f32_16x16x32_bf16 v[184:187], v[112:115], v[24:27], v[184:187]
    ds_read_b64_tr_b16 v[106:107], v124 offset:35072
    v_mfma_f32_16x16x32_bf16 v[188:191], v[116:119], v[24:27], v[188:191]
    ds_read_b64_tr_b16 v[108:109], v125 offset:34816
    v_mfma_f32_16x16x32_bf16 v[48:51], v[16:19], v[16:19], v[48:51]
    ds_read_b64_tr_b16 v[110:111], v125 offset:35072
    v_mfma_f32_16x16x32_bf16 v[52:55], v[20:23], v[20:23], v[52:55]
    ds_read_b64_tr_b16 v[112:113], v126 offset:30720
    v_mfma_f32_16x16x32_bf16 v[56:59], v[24:27], v[24:27], v[56:59]
    ds_read_b64_tr_b16 v[114:115], v126 offset:30976
    v_mfma_f32_16x16x32_bf16 v[60:63], v[40:43], v[16:19], v[60:63]
    ds_read_b64_tr_b16 v[116:117], v127 offset:30720
    v_mfma_f32_16x16x32_bf16 v[64:67], v[40:43], v[20:23], v[64:67]
    ds_read_b64_tr_b16 v[118:119], v127 offset:30976
    v_mfma_f32_16x16x32_bf16 v[68:71], v[40:43], v[24:27], v[68:71]
    s_waitcnt lgkmcnt(9)
    v_mfma_f32_16x16x32_bf16 v[48:51], v[28:31], v[28:31], v[48:51]
    v_mfma_f32_16x16x32_bf16 v[52:55], v[32:35], v[32:35], v[52:55]
    v_mfma_f32_16x16x32_bf16 v[56:59], v[36:39], v[36:39], v[56:59]
    v_mfma_f32_16x16x32_bf16 v[60:63], v[40:43], v[28:31], v[60:63]
    v_mfma_f32_16x16x32_bf16 v[64:67], v[40:43], v[32:35], v[64:67]
    v_mfma_f32_16x16x32_bf16 v[68:71], v[40:43], v[36:39], v[68:71]
    s_waitcnt lgkmcnt(2)
    v_mfma_f32_16x16x32_bf16 v[184:187], v[112:115], v[36:39], v[184:187]
    s_waitcnt lgkmcnt(0)
    v_mfma_f32_16x16x32_bf16 v[188:191], v[116:119], v[36:39], v[188:191]
    v_mfma_f32_16x16x32_bf16 v[144:147], v[96:99], v[28:31], v[144:147]
    v_cndmask_b32 v48, v48, v49, s[88:89]
    v_cndmask_b32 v52, v52, v53, s[88:89]
    v_cndmask_b32 v56, v56, v57, s[88:89]
    v_mfma_f32_16x16x32_bf16 v[168:171], v[96:99], v[32:35], v[168:171]
    v_cndmask_b32 v48, v48, v50, s[90:91]
    v_cndmask_b32 v52, v52, v54, s[90:91]
    v_cndmask_b32 v56, v56, v58, s[90:91]
    v_mfma_f32_16x16x32_bf16 v[148:151], v[100:103], v[28:31], v[148:151]
    v_cndmask_b32 v48, v48, v51, s[92:93]
    v_cndmask_b32 v52, v52, v55, s[92:93]
    v_cndmask_b32 v56, v56, v59, s[92:93]
    v_mfma_f32_16x16x32_bf16 v[172:175], v[100:103], v[32:35], v[172:175]
    v_mul_f32 v133, 0x3b124925, v60
    v_mul_f32 v135, 0x3b124925, v64
    v_mul_f32 v85, 0x3b124925, v68
    v_mfma_f32_16x16x32_bf16 v[152:155], v[28:31], v[104:107], v[152:155]
    v_mul_f32 v132, v133, v133
    v_mul_f32 v134, v135, v135
    v_mul_f32_e64 v84, v85, v85
    v_mfma_f32_16x16x32_bf16 v[176:179], v[32:35], v[104:107], v[176:179]
    v_mul_f32 v48, 0x3b124925, v48
    v_mul_f32 v52, 0x3b124925, v52
    v_mul_f32 v56, 0x3b124925, v56
    v_mfma_f32_16x16x32_bf16 v[156:159], v[28:31], v[108:111], v[156:159]
    s_mov_b32 exec_lo, 0x00010001
    s_mov_b32 exec_hi, 0x00010001
    ds_write_b128 v73, v[184:187] offset:128
    ds_write_b128 v74, v[188:191] offset:0
    s_mov_b64 exec, -1
    v_sub_f32 v132, v48, v132
    v_sub_f32_e64 v134, v52, v134
    v_mfma_f32_16x16x32_bf16 v[180:183], v[32:35], v[108:111], v[180:183]
    v_sub_f32 v84, v56, v84
    v_max_f32 v132, 0, v132
    v_max_f32_e64 v134, 0, v134
    v_mfma_f32_16x16x32_bf16 v[136:139], v[88:91], v[28:31], v[136:139]
    v_max_f32_e64 v84, 0, v84
    v_add_f32 v132, 0x3727c5ac, v132
    v_add_f32 v134, 0x3727c5ac, v134
    v_mfma_f32_16x16x32_bf16 v[160:163], v[88:91], v[32:35], v[160:163]
    v_add_f32 v84, 0x3727c5ac, v84
    v_rsq_f32 v132, v132
    v_rsq_f32 v134, v134
    v_mfma_f32_16x16x32_bf16 v[140:143], v[92:95], v[28:31], v[140:143]
    v_rsq_f32_e64 v84, v84
    s_mov_b32 exec_lo, 0x00f0000f
    s_mov_b32 exec_hi, 0xf0000f00
    ds_write2_b32 v75, v132, v133 offset0:128 offset1:144
    ds_write2_b32 v75, v134, v135 offset0:160 offset1:176
    ds_write2_b32 v75, v84, v85 offset0:192 offset1:208
    s_mov_b64 exec, -1
    v_mov_b32_dpp v224, v184 row_newbcast:0 row_mask:0xf bank_mask:0xf
    v_mfma_f32_16x16x32_bf16 v[164:167], v[92:95], v[32:35], v[164:167]
    v_mov_b32_dpp v225, v185 row_newbcast:0 row_mask:0xf bank_mask:0xf
    v_mov_b32_dpp v226, v186 row_newbcast:0 row_mask:0xf bank_mask:0xf
    v_mov_b32_dpp v227, v187 row_newbcast:0 row_mask:0xf bank_mask:0xf
    v_fma_f32 v224, -v224, v85, v184
    v_fma_f32 v225, -v225, v85, v185
    v_fma_f32 v226, -v226, v85, v186
    v_fma_f32 v227, -v227, v85, v187
    s_cmp_eq_u32 s49, 15
    s_cselect_b32 s88, 0xffff0000, -1
    s_mov_b32 s89, -1
    s_mov_b32 s90, -1
    s_cselect_b32 s91, -1, 0xffff
    s_waitcnt lgkmcnt(0)
    s_barrier
    ds_read_b32 v134, v75 offset:640
    ds_read_b32 v84, v75 offset:768
    ds_read_b32 v132, v75 offset:512
    ds_read_b128 v[56:59], v72 offset:128
    ds_read_b128 v[60:63], v72 offset:192
    ds_read_b32 v64, v77 offset:256
    ds_read_b32 v65, v77 offset:320
    ds_read_b128 v[44:47], v76 offset:704
    ds_read_b128 v[40:43], v76 offset:640
    ds_read_b128 v[36:39], v76 offset:576
    ds_read_b128 v[32:35], v76 offset:512
    ds_read_b128 v[48:51], v72 offset:0
    ds_read_b128 v[52:55], v72 offset:64
    s_waitcnt lgkmcnt(9)
    v_pk_fma_f32 v[168:169], v[56:57], v[134:135], v[168:169] op_sel:[0,1,0] op_sel_hi:[1,1,1] neg_lo:[0,1,0] neg_hi:[0,1,0]
    v_pk_fma_f32 v[170:171], v[58:59], v[134:135], v[170:171] op_sel:[0,1,0] op_sel_hi:[1,1,1] neg_lo:[0,1,0] neg_hi:[0,1,0]
    v_pk_mul_f32 v[168:169], v[168:169], v[134:135] op_sel:[0,0] op_sel_hi:[1,0]
    v_pk_mul_f32 v[170:171], v[170:171], v[134:135] op_sel:[0,0] op_sel_hi:[1,0]
    v_cvt_pk_bf16_f32 v104, v168, v169
    v_cvt_pk_bf16_f32 v105, v170, v171
    s_waitcnt lgkmcnt(8)
    v_pk_fma_f32 v[172:173], v[60:61], v[134:135], v[172:173] op_sel:[0,1,0] op_sel_hi:[1,1,1] neg_lo:[0,1,0] neg_hi:[0,1,0]
    v_pk_fma_f32 v[174:175], v[62:63], v[134:135], v[174:175] op_sel:[0,1,0] op_sel_hi:[1,1,1] neg_lo:[0,1,0] neg_hi:[0,1,0]
    v_pk_mul_f32 v[172:173], v[172:173], v[134:135] op_sel:[0,0] op_sel_hi:[1,0]
    v_pk_mul_f32 v[174:175], v[174:175], v[134:135] op_sel:[0,0] op_sel_hi:[1,0]
    v_cvt_pk_bf16_f32 v106, v172, v173
    v_cvt_pk_bf16_f32 v107, v174, v175
    ds_write_b128 v78, v[104:107] offset:4096
    v_pk_mul_f32 v[224:225], v[224:225], v[84:85] op_sel_hi:[1,0]
    v_pk_mul_f32 v[226:227], v[226:227], v[84:85] op_sel_hi:[1,0]
    v_cvt_pk_bf16_f32 v224, v224, v225
    v_cvt_pk_bf16_f32 v226, v226, v227
    ds_write_b16 v80, v224 offset:2048
    ds_write_b16_d16_hi v81, v224 offset:2048
    ds_write_b16 v82, v226 offset:2048
    ds_write_b16_d16_hi v83, v226 offset:2048
    s_waitcnt lgkmcnt(10)
    v_pk_fma_f32 v[176:177], v[44:45], v[64:65], v[176:177] op_sel:[0,0,0] op_sel_hi:[1,0,1] neg_lo:[0,1,0] neg_hi:[0,1,0]
    v_pk_fma_f32 v[178:179], v[46:47], v[64:65], v[178:179] op_sel:[0,0,0] op_sel_hi:[1,0,1] neg_lo:[0,1,0] neg_hi:[0,1,0]
    s_waitcnt lgkmcnt(9)
    v_pk_mul_f32 v[176:177], v[176:177], v[40:41]
    v_pk_mul_f32 v[178:179], v[178:179], v[42:43]
    v_cvt_pk_bf16_f32 v112, v176, v177
    v_cvt_pk_bf16_f32 v113, v178, v179
    v_pk_fma_f32 v[180:181], v[44:45], v[64:65], v[180:181] op_sel:[0,1,0] op_sel_hi:[1,1,1] neg_lo:[0,1,0] neg_hi:[0,1,0]
    v_pk_fma_f32 v[182:183], v[46:47], v[64:65], v[182:183] op_sel:[0,1,0] op_sel_hi:[1,1,1] neg_lo:[0,1,0] neg_hi:[0,1,0]
    v_pk_mul_f32 v[180:181], v[180:181], v[40:41]
    v_pk_mul_f32 v[182:183], v[182:183], v[42:43]
    v_cvt_pk_bf16_f32 v118, v180, v181
    v_cvt_pk_bf16_f32 v119, v182, v183
    ds_write_b64 v78, v[112:113] offset:5120
    ds_write_b64 v78, v[118:119] offset:5128
    v_mul_f32 v68, 0x3e8b97f6, v132
    v_mul_f32 v70, 0x3e8b97f6, v134
    v_cndmask_b32 v69, 0, v68, s[90:91]
    v_cndmask_b32 v68, 0, v68, s[88:89]
    v_cndmask_b32 v71, 0, v70, s[90:91]
    v_cndmask_b32 v70, 0, v70, s[88:89]
    v_pk_fma_f32 v[144:145], v[56:57], v[132:133], v[144:145] op_sel:[0,1,0] op_sel_hi:[1,1,1] neg_lo:[0,1,0] neg_hi:[0,1,0]
    v_pk_fma_f32 v[146:147], v[58:59], v[132:133], v[146:147] op_sel:[0,1,0] op_sel_hi:[1,1,1] neg_lo:[0,1,0] neg_hi:[0,1,0]
    v_pk_mul_f32 v[144:145], v[144:145], v[132:133] op_sel:[0,0] op_sel_hi:[1,0]
    v_pk_mul_f32 v[146:147], v[146:147], v[132:133] op_sel:[0,0] op_sel_hi:[1,0]
    v_cvt_pk_bf16_f32 v100, v144, v145
    v_cvt_pk_bf16_f32 v101, v146, v147
    v_pk_fma_f32 v[148:149], v[60:61], v[132:133], v[148:149] op_sel:[0,1,0] op_sel_hi:[1,1,1] neg_lo:[0,1,0] neg_hi:[0,1,0]
    v_pk_fma_f32 v[150:151], v[62:63], v[132:133], v[150:151] op_sel:[0,1,0] op_sel_hi:[1,1,1] neg_lo:[0,1,0] neg_hi:[0,1,0]
    v_pk_mul_f32 v[148:149], v[148:149], v[132:133] op_sel:[0,0] op_sel_hi:[1,0]
    v_pk_mul_f32 v[150:151], v[150:151], v[132:133] op_sel:[0,0] op_sel_hi:[1,0]
    v_cvt_pk_bf16_f32 v102, v148, v149
    v_cvt_pk_bf16_f32 v103, v150, v151
    s_waitcnt lgkmcnt(0)
    s_barrier
    ds_read_b128 v[96:99], v78 offset:2048
    ds_read_b64 v[108:109], v78 offset:3072
    ds_read_b64 v[114:115], v78 offset:3080
    v_pk_fma_f32 v[160:161], v[48:49], v[134:135], v[160:161] op_sel:[0,1,0] op_sel_hi:[1,1,1] neg_lo:[0,1,0] neg_hi:[0,1,0]
    v_pk_fma_f32 v[162:163], v[50:51], v[134:135], v[162:163] op_sel:[0,1,0] op_sel_hi:[1,1,1] neg_lo:[0,1,0] neg_hi:[0,1,0]
    v_pk_mul_f32 v[160:161], v[160:161], v[70:71] op_sel:[0,0] op_sel_hi:[1,0]
    v_pk_mul_f32 v[162:163], v[162:163], v[70:71] op_sel:[0,0] op_sel_hi:[1,0]
    v_cvt_pk_bf16_f32 v92, v160, v161
    v_cvt_pk_bf16_f32 v93, v162, v163
    v_pk_fma_f32 v[164:165], v[52:53], v[134:135], v[164:165] op_sel:[0,1,0] op_sel_hi:[1,1,1] neg_lo:[0,1,0] neg_hi:[0,1,0]
    v_pk_fma_f32 v[166:167], v[54:55], v[134:135], v[166:167] op_sel:[0,1,0] op_sel_hi:[1,1,1] neg_lo:[0,1,0] neg_hi:[0,1,0]
    v_pk_mul_f32 v[164:165], v[164:165], v[70:71] op_sel:[0,1] op_sel_hi:[1,1]
    v_pk_mul_f32 v[166:167], v[166:167], v[70:71] op_sel:[0,1] op_sel_hi:[1,1]
    v_cvt_pk_bf16_f32 v94, v164, v165
    v_cvt_pk_bf16_f32 v95, v166, v167
    s_nop 1
    v_mfma_f32_16x16x32_bf16 v[24:27], v[100:103], v[92:95], v[240:243]
    v_mfma_f32_16x16x32_bf16 v[28:31], v[104:107], v[92:95], v[244:247]
    v_pk_fma_f32 v[136:137], v[48:49], v[132:133], v[136:137] op_sel:[0,1,0] op_sel_hi:[1,1,1] neg_lo:[0,1,0] neg_hi:[0,1,0]
    v_pk_fma_f32 v[138:139], v[50:51], v[132:133], v[138:139] op_sel:[0,1,0] op_sel_hi:[1,1,1] neg_lo:[0,1,0] neg_hi:[0,1,0]
    v_pk_mul_f32 v[136:137], v[136:137], v[68:69] op_sel:[0,0] op_sel_hi:[1,0]
    v_pk_mul_f32 v[138:139], v[138:139], v[68:69] op_sel:[0,0] op_sel_hi:[1,0]
    v_cvt_pk_bf16_f32 v88, v136, v137
    v_cvt_pk_bf16_f32 v89, v138, v139
    v_pk_fma_f32 v[140:141], v[52:53], v[132:133], v[140:141] op_sel:[0,1,0] op_sel_hi:[1,1,1] neg_lo:[0,1,0] neg_hi:[0,1,0]
    v_pk_fma_f32 v[142:143], v[54:55], v[132:133], v[142:143] op_sel:[0,1,0] op_sel_hi:[1,1,1] neg_lo:[0,1,0] neg_hi:[0,1,0]
    v_pk_mul_f32 v[140:141], v[140:141], v[68:69] op_sel:[0,1] op_sel_hi:[1,1]
    v_pk_mul_f32 v[142:143], v[142:143], v[68:69] op_sel:[0,1] op_sel_hi:[1,1]
    v_cvt_pk_bf16_f32 v90, v140, v141
    v_cvt_pk_bf16_f32 v91, v142, v143
    s_waitcnt lgkmcnt(2)
    s_nop 0
    v_mfma_f32_16x16x32_bf16 v[16:19], v[96:99], v[88:91], v[248:251]
    v_mfma_f32_16x16x32_bf16 v[20:23], v[100:103], v[88:91], v[244:247]
    v_pk_fma_f32 v[152:153], v[36:37], v[64:65], v[152:153] op_sel:[0,0,0] op_sel_hi:[1,0,1] neg_lo:[0,1,0] neg_hi:[0,1,0]
    v_pk_fma_f32 v[154:155], v[38:39], v[64:65], v[154:155] op_sel:[0,0,0] op_sel_hi:[1,0,1] neg_lo:[0,1,0] neg_hi:[0,1,0]
    v_pk_mul_f32 v[152:153], v[152:153], v[32:33]
    v_pk_mul_f32 v[154:155], v[154:155], v[34:35]
    v_cvt_pk_bf16_f32 v110, v152, v153
    v_cvt_pk_bf16_f32 v111, v154, v155
    v_pk_fma_f32 v[156:157], v[36:37], v[64:65], v[156:157] op_sel:[0,1,0] op_sel_hi:[1,1,1] neg_lo:[0,1,0] neg_hi:[0,1,0]
    v_pk_fma_f32 v[158:159], v[38:39], v[64:65], v[158:159] op_sel:[0,1,0] op_sel_hi:[1,1,1] neg_lo:[0,1,0] neg_hi:[0,1,0]
    v_pk_mul_f32 v[156:157], v[156:157], v[32:33]
    v_pk_mul_f32 v[158:159], v[158:159], v[34:35]
    v_cvt_pk_bf16_f32 v116, v156, v157
    v_cvt_pk_bf16_f32 v117, v158, v159
    v_max3_f32 v137, v24, v25, v26
    v_max3_f32 v139, v27, v28, v29
    v_max3_f32 v137, v137, v30, v31
    v_max_f32 v137, v137, v139
    v_max3_f32 v136, v16, v17, v18
    v_max3_f32 v138, v19, v20, v21
    v_max3_f32 v136, v136, v22, v23
    v_max_f32 v136, v136, v138
    v_mov_b32 v138, v136
    v_mov_b32 v139, v137
    s_nop 0
    v_permlane32_swap_b32 v136, v138
    v_permlane32_swap_b32 v137, v139
    v_max_f32 v136, v136, v138
    v_max_f32 v137, v137, v139
    v_mov_b32 v138, v136
    v_mov_b32 v139, v137
    s_nop 0
    v_permlane16_swap_b32 v136, v138
    v_permlane16_swap_b32 v137, v139
    v_max_f32 v136, v136, v138
    v_max_f32_e64 v137, v137, v139
    v_pk_add_f32 v[24:25], v[24:25], v[136:137] op_sel:[0,1] op_sel_hi:[1,1] neg_lo:[0,1] neg_hi:[0,1]
    v_pk_add_f32 v[26:27], v[26:27], v[136:137] op_sel:[0,1] op_sel_hi:[1,1] neg_lo:[0,1] neg_hi:[0,1]
    v_pk_add_f32 v[28:29], v[28:29], v[136:137] op_sel:[0,1] op_sel_hi:[1,1] neg_lo:[0,1] neg_hi:[0,1]
    v_pk_add_f32 v[30:31], v[30:31], v[136:137] op_sel:[0,1] op_sel_hi:[1,1] neg_lo:[0,1] neg_hi:[0,1]
    v_exp_f32 v24, v24
    v_exp_f32 v25, v25
    v_exp_f32 v26, v26
    v_exp_f32 v27, v27
    v_exp_f32 v28, v28
    v_exp_f32 v29, v29
    v_exp_f32_e64 v30, v30
    v_exp_f32 v31, v31
    v_cvt_pk_bf16_f32 v148, v24, v25
    v_cvt_pk_bf16_f32 v149, v26, v27
    v_cvt_pk_bf16_f32 v150, v28, v29
    v_cvt_pk_bf16_f32 v151, v30, v31
    s_nop 1
    v_mfma_f32_16x16x32_bf16 v[160:163], v[110:113], v[148:151], 0
    v_mfma_f32_16x16x32_bf16 v[164:167], v[116:119], v[148:151], 0
    v_pk_add_f32 v[16:17], v[16:17], v[136:137] op_sel:[0,0] op_sel_hi:[1,0] neg_lo:[0,1] neg_hi:[0,1]
    v_pk_add_f32 v[18:19], v[18:19], v[136:137] op_sel:[0,0] op_sel_hi:[1,0] neg_lo:[0,1] neg_hi:[0,1]
    v_pk_add_f32 v[20:21], v[20:21], v[136:137] op_sel:[0,0] op_sel_hi:[1,0] neg_lo:[0,1] neg_hi:[0,1]
    v_pk_add_f32 v[22:23], v[22:23], v[136:137] op_sel:[0,0] op_sel_hi:[1,0] neg_lo:[0,1] neg_hi:[0,1]
    v_exp_f32 v16, v16
    v_exp_f32 v17, v17
    v_exp_f32 v18, v18
    v_exp_f32 v19, v19
    v_exp_f32 v20, v20
    v_exp_f32 v21, v21
    v_exp_f32_e64 v22, v22
    v_exp_f32 v23, v23
    v_cvt_pk_bf16_f32 v144, v16, v17
    v_cvt_pk_bf16_f32 v145, v18, v19
    v_cvt_pk_bf16_f32 v146, v20, v21
    v_cvt_pk_bf16_f32 v147, v22, v23
    s_waitcnt lgkmcnt(1)
    s_nop 0
    v_mfma_f32_16x16x32_bf16 v[152:155], v[108:111], v[144:147], 0
    s_waitcnt lgkmcnt(0)
    v_mfma_f32_16x16x32_bf16 v[156:159], v[114:117], v[144:147], 0
    v_pk_add_f32 v[16:17], v[16:17], v[18:19]
    v_pk_add_f32 v[20:21], v[20:21], v[22:23]
    v_pk_add_f32 v[24:25], v[24:25], v[26:27]
    v_pk_add_f32 v[28:29], v[28:29], v[30:31]
    v_pk_add_f32 v[16:17], v[16:17], v[20:21]
    v_pk_add_f32 v[24:25], v[24:25], v[28:29]
    v_add_f32 v140, v16, v17
    v_add_f32 v142, v24, v25
    v_mov_b32 v138, v140
    v_mov_b32 v139, v142
    s_nop 0
    v_permlane32_swap_b32 v140, v138
    v_permlane32_swap_b32 v142, v139
    v_add_f32 v140, v140, v138
    v_add_f32 v142, v142, v139
    v_mov_b32 v138, v140
    v_mov_b32 v139, v142
    s_nop 0
    v_permlane16_swap_b32 v140, v138
    v_permlane16_swap_b32 v142, v139
    v_add_f32 v140, v140, v138
    v_add_f32 v142, v142, v139
    v_rcp_f32 v140, v140
    v_rcp_f32 v142, v142
    v_cndmask_b32 v141, 0, v140, s[90:91]
    v_cndmask_b32 v140, 0, v140, s[88:89]
    v_cndmask_b32 v143, 0, v142, s[90:91]
    v_cndmask_b32 v142, 0, v142, s[88:89]
    v_pk_mul_f32 v[152:153], v[152:153], v[140:141] op_sel_hi:[1,0]
    v_pk_mul_f32 v[154:155], v[154:155], v[140:141] op_sel_hi:[1,0]
    v_pk_mul_f32 v[156:157], v[156:157], v[140:141] op_sel:[0,1] op_sel_hi:[1,1]
    v_pk_mul_f32 v[158:159], v[158:159], v[140:141] op_sel:[0,1] op_sel_hi:[1,1]
    v_cvt_pk_bf16_f32 v144, v152, v153
    v_cvt_pk_bf16_f32 v145, v154, v155
    v_cvt_pk_bf16_f32 v146, v156, v157
    v_cvt_pk_bf16_f32 v147, v158, v159
    buffer_store_dwordx4 v[144:147], v4, s[40:43], s62 offen sc1
    v_pk_mul_f32 v[160:161], v[160:161], v[142:143] op_sel_hi:[1,0]
    v_pk_mul_f32 v[162:163], v[162:163], v[142:143] op_sel_hi:[1,0]
    v_pk_mul_f32 v[164:165], v[164:165], v[142:143] op_sel:[0,1] op_sel_hi:[1,1]
    v_pk_mul_f32 v[166:167], v[166:167], v[142:143] op_sel:[0,1] op_sel_hi:[1,1]
    v_cvt_pk_bf16_f32 v148, v160, v161
    v_cvt_pk_bf16_f32 v149, v162, v163
    v_cvt_pk_bf16_f32 v150, v164, v165
    v_cvt_pk_bf16_f32 v151, v166, v167
    buffer_store_dwordx4 v[148:151], v4, s[40:43], s63 offen sc1
    s_add_u32 m0, s59, 0
    s_mov_b32 s73, 0
    buffer_load_dwordx4 v208, s[16:19], s73 offen lds
    s_add_u32 m0, s59, 1024
    s_mov_b32 s73, 7168
    buffer_load_dwordx4 v208, s[16:19], s73 offen lds
    s_add_u32 m0, s59, 2048
    s_mov_b32 s73, 14336
    buffer_load_dwordx4 v208, s[16:19], s73 offen lds
    s_add_u32 m0, s59, 3072
    s_mov_b32 s73, 21504
    buffer_load_dwordx4 v208, s[16:19], s73 offen lds
    s_add_u32 m0, s59, 4096
    s_mov_b32 s73, 28672
    buffer_load_dwordx4 v208, s[16:19], s73 offen lds
    s_add_u32 m0, s59, 5120
    s_mov_b32 s73, 35840
    buffer_load_dwordx4 v208, s[16:19], s73 offen lds
    s_add_u32 m0, s59, 6144
    s_mov_b32 s73, 43008
    buffer_load_dwordx4 v208, s[16:19], s73 offen lds
    s_add_u32 m0, s59, 7168
    s_mov_b32 s73, 50176
    buffer_load_dwordx4 v208, s[16:19], s73 offen lds
    s_add_u32 m0, s59, 8192
    s_mov_b32 s73, 57344
    buffer_load_dwordx4 v208, s[16:19], s73 offen lds
    s_add_u32 m0, s59, 9216
    s_mov_b32 s73, 64512
    buffer_load_dwordx4 v208, s[16:19], s73 offen lds
    s_add_u32 m0, s59, 10240
    s_mov_b32 s73, 71680
    buffer_load_dwordx4 v208, s[16:19], s73 offen lds
    s_add_u32 m0, s59, 11264
    s_mov_b32 s73, 78848
    buffer_load_dwordx4 v208, s[16:19], s73 offen lds
    s_add_u32 m0, s59, 12288
    s_mov_b32 s73, 86016
    buffer_load_dwordx4 v208, s[16:19], s73 offen lds
    s_add_u32 m0, s59, 13312
    s_mov_b32 s73, 93184
    buffer_load_dwordx4 v208, s[16:19], s73 offen lds
    s_waitcnt vmcnt(18)
    v_readfirstlane_b32 s4, v6
    s_nop 1
    s_cmp_lg_u32 s4, 0
    s_cbranch_scc1 Lepd_P_2
    s_nop 0
Lepg_P_1:
    s_sub_u32 s6, s6, 1
    s_cbranch_scc1 L_end_P
    buffer_load_dword v6, v7, s[44:47], 0 offen sc1
    s_waitcnt vmcnt(0)
    v_readfirstlane_b32 s4, v6
    s_nop 1
    s_cmp_eq_u32 s4, 0
    s_cbranch_scc1 Lepg_P_1
Lepd_P_2:
    s_waitcnt vmcnt(14)
    v_mov_b32 v8, s4
    s_mov_b64 exec, 1
    buffer_store_dword v8, v9, s[40:43], s80 offen sc1
    s_mov_b64 exec, -1
    s_and_b32 s68, s2, 7
    s_cmp_ge_u32 s68, 7
    s_cselect_b32 s48, 7, 0
    s_sub_u32 s68, s68, s48
    s_lshl_b32 s48, s68, 12
    s_add_u32 s68, s68, 1
    s_cmp_ge_u32 s68, 7
    s_cselect_b32 s49, 7, 0
    s_sub_u32 s68, s68, s49
    s_lshl_b32 s49, s68, 12
    s_add_u32 s68, s68, 1
    s_cmp_ge_u32 s68, 7
    s_cselect_b32 s50, 7, 0
    s_sub_u32 s68, s68, s50
    s_lshl_b32 s50, s68, 12
    s_add_u32 s68, s68, 1
    s_cmp_ge_u32 s68, 7
    s_cselect_b32 s51, 7, 0
    s_sub_u32 s68, s68, s51
    s_lshl_b32 s51, s68, 12
    s_add_u32 s68, s68, 1
    s_cmp_ge_u32 s68, 7
    s_cselect_b32 s52, 7, 0
    s_sub_u32 s68, s68, s52
    s_lshl_b32 s52, s68, 12
    s_add_u32 s68, s68, 1
    s_cmp_ge_u32 s68, 7
    s_cselect_b32 s53, 7, 0
    s_sub_u32 s68, s68, s53
    s_lshl_b32 s53, s68, 12
    s_add_u32 s68, s68, 1
    s_cmp_ge_u32 s68, 7
    s_cselect_b32 s54, 7, 0
    s_sub_u32 s68, s68, s54
    s_lshl_b32 s54, s68, 12
    s_cmp_lt_u32 s67, 99
    s_cbranch_scc1 Lnotag_P_3
    s_lshr_b32 s68, s2, 3
    s_sub_u32 s68, s68, 28
    s_mul_i32 s68, s68, 1835008
    s_mul_i32 s69, s3, 57344
    s_add_u32 s68, s68, s69
    s_and_b32 s69, s2, 7
    s_mul_i32 s86, s69, 3
    s_add_u32 s86, s86, 4
    s_lshl_b32 s87, s69, 2
    s_min_u32 s86, s86, s87
    s_lshl_b32 s86, s86, 7
    s_add_u32 s68, s68, s86
    v_lshrrev_b32 v16, 2, v1
    v_mul_u32_u24 v16, 3584, v16
    v_and_b32_e64 v17, 3, v1
    v_lshl_add_u32 v16, v17, 7, v16
    s_mul_i32 s86, s98, 56
    s_add_u32 s86, s86, s68
    buffer_load_dword v30, v16, s[20:23], s86 offen
    s_mul_i32 s86, s99, 56
    s_add_u32 s86, s86, s68
    buffer_load_dword v31, v16, s[20:23], s86 offen
    s_mul_i32 s86, s100, 56
    s_add_u32 s86, s86, s68
    buffer_load_dword v32, v16, s[20:23], s86 offen
    s_mul_i32 s86, s101, 56
    s_add_u32 s86, s86, s68
    buffer_load_dword v33, v16, s[20:23], s86 offen
    s_lshr_b32 s68, s2, 3
    s_sub_u32 s68, s68, 28
    s_mul_i32 s68, s68, 28
    s_add_u32 s68, s68, s3
    s_lshl_b32 s68, s68, 16
    s_and_b32 s69, s2, 7
    s_lshl_b32 s69, s69, 9
    s_add_u32 s68, s68, s69
    v_lshrrev_b32 v16, 2, v1
    v_lshlrev_b32 v16, 12, v16
    v_and_b32_e64 v17, 3, v1
    v_lshl_add_u32 v16, v17, 7, v16
    s_lshl_b32 s86, s48, 6
    s_add_u32 s86, s86, s68
    buffer_load_dword v18, v16, s[24:27], s86 offen
    s_waitcnt vmcnt(1)
    s_lshl_b32 s86, s49, 6
    s_add_u32 s86, s86, s68
    buffer_load_dword v19, v16, s[24:27], s86 offen
    s_waitcnt vmcnt(1)
    s_lshl_b32 s86, s50, 6
    s_add_u32 s86, s86, s68
    buffer_load_dword v20, v16, s[24:27], s86 offen
    s_waitcnt vmcnt(1)
    s_lshl_b32 s86, s51, 6
    s_add_u32 s86, s86, s68
    buffer_load_dword v21, v16, s[24:27], s86 offen
    s_waitcnt vmcnt(1)
    s_lshl_b32 s86, s52, 6
    s_add_u32 s86, s86, s68
    buffer_load_dword v22, v16, s[24:27], s86 offen
    s_waitcnt vmcnt(1)
    s_lshl_b32 s86, s53, 6
    s_add_u32 s86, s86, s68
    buffer_load_dword v23, v16, s[24:27], s86 offen
    s_waitcnt vmcnt(1)
    s_lshl_b32 s86, s54, 6
    s_add_u32 s86, s86, s68
    buffer_load_dword v24, v16, s[24:27], s86 offen
    s_waitcnt vmcnt(1)
    s_waitcnt vmcnt(0)
    s_branch L_end_P
Lnotag_P_3:
    v_lshrrev_b32 v221, 5, v1
    v_mul_u32_u24 v221, 3584, v221
    v_and_b32 v222, 31, v1
    v_lshl_add_u32 v221, v222, 1, v221
    s_lshl_b32 s58, s67, 1
    s_lshr_b32 s60, s3, 1
    s_add_u32 s58, s58, s60
    s_mul_i32 s58, s58, 28672
    s_lshl_b32 s60, s66, 7
    s_add_u32 s58, s58, s60
    s_and_b32 s60, s3, 1
    s_lshl_b32 s60, s60, 6
    s_add_u32 s58, s58, s60
    buffer_load_ushort v192, v221, s[8:11], s58 offen offset:0
    buffer_load_ushort v193, v221, s[8:11], s58 offen offset:896
    buffer_load_ushort v194, v221, s[8:11], s58 offen offset:1792
    buffer_load_ushort v195, v221, s[8:11], s58 offen offset:2688
    s_add_u32 s58, s58, 7168
    buffer_load_ushort v196, v221, s[8:11], s58 offen offset:0
    buffer_load_ushort v197, v221, s[8:11], s58 offen offset:896
    buffer_load_ushort v198, v221, s[8:11], s58 offen offset:1792
    buffer_load_ushort v199, v221, s[8:11], s58 offen offset:2688
    s_add_u32 s58, s58, 7168
    buffer_load_ushort v200, v221, s[8:11], s58 offen offset:0
    buffer_load_ushort v201, v221, s[8:11], s58 offen offset:896
    buffer_load_ushort v202, v221, s[8:11], s58 offen offset:1792
    buffer_load_ushort v203, v221, s[8:11], s58 offen offset:2688
    s_add_u32 s58, s58, 7168
    buffer_load_ushort v204, v221, s[8:11], s58 offen offset:0
    buffer_load_ushort v205, v221, s[8:11], s58 offen offset:896
    buffer_load_ushort v206, v221, s[8:11], s58 offen offset:1792
    buffer_load_ushort v207, v221, s[8:11], s58 offen offset:2688
    s_add_u32 m0, s70, 16384
    s_mul_i32 s73, s94, 56
    s_add_u32 s73, s73, 0
    buffer_load_dwordx4 v213, s[20:23], s73 offen lds
    s_add_u32 m0, s70, 17408
    s_mul_i32 s73, s94, 56
    s_add_u32 s73, s73, 28672
    buffer_load_dwordx4 v213, s[20:23], s73 offen lds
    s_add_u32 m0, s70, 18432
    s_mul_i32 s73, s94, 56
    s_add_u32 s73, s73, 57344
    buffer_load_dwordx4 v213, s[20:23], s73 offen lds
    s_add_u32 m0, s70, 19456
    s_mul_i32 s73, s94, 56
    s_add_u32 s73, s73, 86016
    buffer_load_dwordx4 v213, s[20:23], s73 offen lds
    s_add_u32 m0, s70, 20480
    s_mul_i32 s73, s94, 56
    s_add_u32 s73, s73, 114688
    buffer_load_dwordx4 v213, s[20:23], s73 offen lds
    s_add_u32 m0, s70, 21504
    s_mul_i32 s73, s94, 56
    s_add_u32 s73, s73, 143360
    buffer_load_dwordx4 v213, s[20:23], s73 offen lds
    s_add_u32 m0, s70, 22528
    s_mul_i32 s73, s94, 56
    s_add_u32 s73, s73, 172032
    buffer_load_dwordx4 v213, s[20:23], s73 offen lds
    s_add_u32 m0, s70, 23552
    s_mul_i32 s73, s94, 56
    s_add_u32 s73, s73, 200704
    buffer_load_dwordx4 v213, s[20:23], s73 offen lds
    s_waitcnt vmcnt(25)
    s_barrier
    ds_read_b64_tr_b16 a[0:1], v209 offset:0
    ds_read_b64_tr_b16 a[2:3], v209 offset:2048
    s_add_u32 m0, s70, 24576
    s_mul_i32 s73, s95, 56
    s_add_u32 s73, s73, 0
    buffer_load_dwordx4 v213, s[20:23], s73 offen lds
    ds_read_b64_tr_b16 a[4:5], v209 offset:1024
    ds_read_b64_tr_b16 a[6:7], v209 offset:3072
    s_add_u32 m0, s70, 25600
    s_mul_i32 s73, s95, 56
    s_add_u32 s73, s73, 28672
    buffer_load_dwordx4 v213, s[20:23], s73 offen lds
    ds_read_b64_tr_b16 a[8:9], v209 offset:3584
    ds_read_b64_tr_b16 a[10:11], v209 offset:5632
    ds_read_b64_tr_b16 a[12:13], v209 offset:4608
    ds_read_b64_tr_b16 a[14:15], v209 offset:6656
    s_add_u32 m0, s70, 26624
    s_mul_i32 s73, s95, 56
    s_add_u32 s73, s73, 57344
    buffer_load_dwordx4 v213, s[20:23], s73 offen lds
    ds_read_b64_tr_b16 a[16:17], v209 offset:7168
    ds_read_b64_tr_b16 a[18:19], v209 offset:9216
    s_add_u32 m0, s70, 27648
    s_mul_i32 s73, s95, 56
    s_add_u32 s73, s73, 86016
    buffer_load_dwordx4 v213, s[20:23], s73 offen lds
    ds_read_b64_tr_b16 a[20:21], v209 offset:8192
    ds_read_b64_tr_b16 a[22:23], v209 offset:10240
    ds_read_b64_tr_b16 a[24:25], v209 offset:10752
    ds_read_b64_tr_b16 a[26:27], v209 offset:12800
    s_add_u32 m0, s70, 28672
    s_mul_i32 s73, s95, 56
    s_add_u32 s73, s73, 114688
    buffer_load_dwordx4 v213, s[20:23], s73 offen lds
    ds_read_b64_tr_b16 a[28:29], v209 offset:11776
    ds_read_b64_tr_b16 a[30:31], v210 offset:13824
    s_add_u32 m0, s70, 29696
    s_mul_i32 s73, s95, 56
    s_add_u32 s73, s73, 143360
    buffer_load_dwordx4 v213, s[20:23], s73 offen lds
    ds_read_b64_tr_b16 a[32:33], v209 offset:36864
    ds_read_b64_tr_b16 a[34:35], v209 offset:38912
    ds_read_b64_tr_b16 a[36:37], v209 offset:37888
    ds_read_b64_tr_b16 a[38:39], v209 offset:39936
    s_add_u32 m0, s70, 30720
    s_mul_i32 s73, s95, 56
    s_add_u32 s73, s73, 172032
    buffer_load_dwordx4 v213, s[20:23], s73 offen lds
    ds_read_b64_tr_b16 a[40:41], v209 offset:40448
    ds_read_b64_tr_b16 a[42:43], v209 offset:42496
    s_add_u32 m0, s70, 31744
    s_mul_i32 s73, s95, 56
    s_add_u32 s73, s73, 200704
    buffer_load_dwordx4 v213, s[20:23], s73 offen lds
    ds_read_b64_tr_b16 a[44:45], v209 offset:41472
    ds_read_b64_tr_b16 a[46:47], v209 offset:43520
    ds_read_b64_tr_b16 a[48:49], v209 offset:44032
    ds_read_b64_tr_b16 a[50:51], v209 offset:46080
    s_add_u32 m0, s70, 32768
    s_mul_i32 s73, s96, 56
    s_add_u32 s73, s73, 0
    buffer_load_dwordx4 v213, s[20:23], s73 offen lds
    ds_read_b64_tr_b16 a[52:53], v209 offset:45056
    ds_read_b64_tr_b16 a[54:55], v209 offset:47104
    s_add_u32 m0, s70, 33792
    s_mul_i32 s73, s96, 56
    s_add_u32 s73, s73, 28672
    buffer_load_dwordx4 v213, s[20:23], s73 offen lds
    ds_read_b64_tr_b16 a[56:57], v209 offset:47616
    ds_read_b64_tr_b16 a[58:59], v209 offset:49664
    ds_read_b64_tr_b16 a[60:61], v209 offset:48640
    ds_read_b64_tr_b16 a[62:63], v210 offset:50688
    s_add_u32 m0, s70, 34816
    s_mul_i32 s73, s96, 56
    s_add_u32 s73, s73, 57344
    buffer_load_dwordx4 v213, s[20:23], s73 offen lds
    v_add_u32 v209, 73728, v209
    v_add_u32 v210, 73728, v210
    ds_read_b64_tr_b16 a[64:65], v209 offset:0
    ds_read_b64_tr_b16 a[66:67], v209 offset:2048
    s_add_u32 m0, s70, 35840
    s_mul_i32 s73, s96, 56
    s_add_u32 s73, s73, 86016
    buffer_load_dwordx4 v213, s[20:23], s73 offen lds
    ds_read_b64_tr_b16 a[68:69], v209 offset:1024
    ds_read_b64_tr_b16 a[70:71], v209 offset:3072
    ds_read_b64_tr_b16 a[72:73], v209 offset:3584
    ds_read_b64_tr_b16 a[74:75], v209 offset:5632
    ds_read_b64_tr_b16 a[76:77], v209 offset:4608
    ds_read_b64_tr_b16 a[78:79], v209 offset:6656
    ds_read_b64_tr_b16 a[80:81], v209 offset:7168
    ds_read_b64_tr_b16 a[82:83], v209 offset:9216
    ds_read_b64_tr_b16 a[84:85], v209 offset:8192
    ds_read_b64_tr_b16 a[86:87], v209 offset:10240
    ds_read_b64_tr_b16 a[88:89], v209 offset:10752
    ds_read_b64_tr_b16 a[90:91], v209 offset:12800
    ds_read_b64_tr_b16 a[92:93], v209 offset:11776
    ds_read_b64_tr_b16 a[94:95], v210 offset:13824
    ds_read_b64_tr_b16 a[96:97], v209 offset:36864
    ds_read_b64_tr_b16 a[98:99], v209 offset:38912
    ds_read_b64_tr_b16 a[100:101], v209 offset:37888
    ds_read_b64_tr_b16 a[102:103], v209 offset:39936
    ds_read_b64_tr_b16 a[104:105], v209 offset:40448
    ds_read_b64_tr_b16 a[106:107], v209 offset:42496
    ds_read_b64_tr_b16 a[108:109], v209 offset:41472
    ds_read_b64_tr_b16 a[110:111], v209 offset:43520
    ds_read_b64_tr_b16 a[112:113], v209 offset:44032
    ds_read_b64_tr_b16 a[114:115], v209 offset:46080
    ds_read_b64_tr_b16 a[116:117], v209 offset:45056
    ds_read_b64_tr_b16 a[118:119], v209 offset:47104
    ds_read_b64_tr_b16 a[120:121], v209 offset:47104
    ds_read_b64_tr_b16 a[122:123], v209 offset:49152
    ds_read_b64_tr_b16 a[124:125], v209 offset:48128
    ds_read_b64_tr_b16 a[126:127], v209 offset:50176
    s_waitcnt lgkmcnt(0)
    s_barrier
    buffer_load_dword v249, v10, s[40:43], s83 offen sc1
    s_sleep 3
    buffer_load_dword v250, v10, s[40:43], s83 offen sc1
    s_sleep 3
    s_nop 0
Lpoll_P_4:
    s_sub_u32 s6, s6, 1
    s_cbranch_scc1 L_end_P
    buffer_load_dword v251, v10, s[40:43], s83 offen sc1
    s_waitcnt vmcnt(2)
    v_cmp_ne_u32_e64 vcc, s4, v249
    s_nop 1
    s_cbranch_vccz Lpd_P_5
    buffer_load_dword v249, v10, s[40:43], s83 offen sc1
    s_waitcnt vmcnt(2)
    v_cmp_ne_u32 vcc, s4, v250
    s_nop 1
    s_cbranch_vccz Lpd_P_5
    buffer_load_dword v250, v10, s[40:43], s83 offen sc1
    s_waitcnt vmcnt(2)
    v_cmp_ne_u32 vcc, s4, v251
    s_nop 1
    s_cbranch_vccnz Lpoll_P_4
    s_nop 1
Lpd_P_5:
    s_lshl_b32 s58, s67, 16
    s_lshl_b32 s60, s3, 14
    s_add_u32 s58, s58, s60
    s_add_u32 m0, s70, 0
    s_nop 0
    buffer_load_dwordx4 v4, s[40:43], s58 offen offset:0 sc1 lds
    buffer_load_dwordx4 v4, s[40:43], s58 offen offset:1024 sc1 lds
    buffer_load_dwordx4 v4, s[40:43], s58 offen offset:2048 sc1 lds
    buffer_load_dwordx4 v4, s[40:43], s58 offen offset:3072 sc1 lds
    s_add_u32 m0, s70, 4096
    s_add_u32 s58, s58, 4096
    buffer_load_dwordx4 v4, s[40:43], s58 offen offset:0 sc1 lds
    buffer_load_dwordx4 v4, s[40:43], s58 offen offset:1024 sc1 lds
    buffer_load_dwordx4 v4, s[40:43], s58 offen offset:2048 sc1 lds
    buffer_load_dwordx4 v4, s[40:43], s58 offen offset:3072 sc1 lds
    s_add_u32 m0, s70, 8192
    s_add_u32 s58, s58, 4096
    buffer_load_dwordx4 v4, s[40:43], s58 offen offset:0 sc1 lds
    buffer_load_dwordx4 v4, s[40:43], s58 offen offset:1024 sc1 lds
    buffer_load_dwordx4 v4, s[40:43], s58 offen offset:2048 sc1 lds
    buffer_load_dwordx4 v4, s[40:43], s58 offen offset:3072 sc1 lds
    s_add_u32 m0, s70, 12288
    s_add_u32 s58, s58, 4096
    buffer_load_dwordx4 v4, s[40:43], s58 offen offset:0 sc1 lds
    buffer_load_dwordx4 v4, s[40:43], s58 offen offset:1024 sc1 lds
    buffer_load_dwordx4 v4, s[40:43], s58 offen offset:2048 sc1 lds
    buffer_load_dwordx4 v4, s[40:43], s58 offen offset:3072 sc1 lds
    v_and_b32_e64 v64, 1, v3
    v_mul_u32_u24 v64, 36864, v64
    v_lshl_add_u32 v64, v2, 4, v64
    v_lshrrev_b32 v65, 5, v1
    v_lshl_add_u32 v64, v65, 8, v64
    s_lshr_b32 s60, s3, 1
    s_mul_i32 s60, s60, 73728
    s_add_u32 s60, s60, 12288
    v_add_u32_e64 v64, s60, v64
    ds_read_b64_tr_b16 a[128:129], v215 offset:16384
    ds_read_b64_tr_b16 a[130:131], v215 offset:17408
    ds_read_b64_tr_b16 a[132:133], v216 offset:16384
    ds_read_b64_tr_b16 a[134:135], v216 offset:17408
    ds_read_b64_tr_b16 a[136:137], v215 offset:18432
    ds_read_b64_tr_b16 a[138:139], v215 offset:19456
    ds_read_b64_tr_b16 a[140:141], v216 offset:18432
    ds_read_b64_tr_b16 a[142:143], v216 offset:19456
    ds_read_b64_tr_b16 a[144:145], v215 offset:20480
    ds_read_b64_tr_b16 a[146:147], v215 offset:21504
    ds_read_b64_tr_b16 a[148:149], v216 offset:20480
    ds_read_b64_tr_b16 a[150:151], v216 offset:21504
    ds_read_b64_tr_b16 a[152:153], v215 offset:22528
    ds_read_b64_tr_b16 a[154:155], v215 offset:23552
    ds_read_b64_tr_b16 a[156:157], v216 offset:22528
    ds_read_b64_tr_b16 a[158:159], v216 offset:23552
    ds_read_b64_tr_b16 a[160:161], v215 offset:24576
    ds_read_b64_tr_b16 a[162:163], v215 offset:25600
    ds_read_b64_tr_b16 a[164:165], v216 offset:24576
    ds_read_b64_tr_b16 a[166:167], v216 offset:25600
    ds_read_b64_tr_b16 a[168:169], v215 offset:26624
    ds_read_b64_tr_b16 a[170:171], v215 offset:27648
    ds_read_b64_tr_b16 a[172:173], v216 offset:26624
    ds_read_b64_tr_b16 a[174:175], v216 offset:27648
    ds_read_b64_tr_b16 a[176:177], v215 offset:28672
    ds_read_b64_tr_b16 a[178:179], v215 offset:29696
    ds_read_b64_tr_b16 a[180:181], v216 offset:28672
    ds_read_b64_tr_b16 a[182:183], v216 offset:29696
    ds_read_b64_tr_b16 a[184:185], v215 offset:30720
    ds_read_b64_tr_b16 a[186:187], v215 offset:31744
    ds_read_b64_tr_b16 a[188:189], v216 offset:30720
    ds_read_b64_tr_b16 a[190:191], v216 offset:31744
    ds_read_b64_tr_b16 a[192:193], v215 offset:32768
    ds_read_b64_tr_b16 a[194:195], v215 offset:33792
    ds_read_b64_tr_b16 a[196:197], v216 offset:32768
    ds_read_b64_tr_b16 a[198:199], v216 offset:33792
    ds_read_b64_tr_b16 a[200:201], v215 offset:34816
    ds_read_b64_tr_b16 a[202:203], v215 offset:35840
    ds_read_b64_tr_b16 a[204:205], v216 offset:34816
    ds_read_b64_tr_b16 a[206:207], v216 offset:35840
    v_lshlrev_b32 v192, 16, v192
    v_lshlrev_b32 v193, 16, v193
    v_lshlrev_b32 v194, 16, v194
    v_lshlrev_b32 v195, 16, v195
    v_lshlrev_b32 v196, 16, v196
    v_lshlrev_b32 v197, 16, v197
    v_lshlrev_b32 v198, 16, v198
    v_lshlrev_b32 v199, 16, v199
    v_lshlrev_b32 v200, 16, v200
    v_lshlrev_b32 v201, 16, v201
    v_lshlrev_b32 v202, 16, v202
    v_lshlrev_b32 v203, 16, v203
    v_lshlrev_b32 v204, 16, v204
    v_lshlrev_b32 v205, 16, v205
    v_lshlrev_b32_e64 v206, 16, v206
    v_lshlrev_b32 v207, 16, v207
    s_waitcnt vmcnt(8)
    s_barrier
    ds_read_b128 v[32:35], v64 offset:0
    ds_read_b128 v[36:39], v64 offset:512
    ds_read_b128 v[40:43], v64 offset:1024
    ds_read_b128 v[44:47], v64 offset:1536
    ds_read_b128 v[48:51], v64 offset:2048
    ds_read_b128 v[52:55], v64 offset:2560
    s_waitcnt lgkmcnt(5)
    v_mfma_f32_32x32x16_bf16 v[192:207], v[32:35], a[0:3], v[192:207]
    ds_read_b128 v[56:59], v64 offset:3072
    s_add_u32 m0, s70, 16384
    s_mul_i32 s73, s96, 56
    s_add_u32 s73, s73, 114688
    buffer_load_dwordx4 v213, s[20:23], s73 offen lds
    s_waitcnt lgkmcnt(5)
    v_mfma_f32_32x32x16_bf16 v[192:207], v[36:39], a[4:7], v[192:207]
    ds_read_b128 v[60:63], v64 offset:3584
    s_waitcnt lgkmcnt(5)
    v_mfma_f32_32x32x16_bf16 v[192:207], v[40:43], a[8:11], v[192:207]
    ds_read_b128 v[32:35], v64 offset:4096
    s_waitcnt lgkmcnt(5)
    v_mfma_f32_32x32x16_bf16 v[192:207], v[44:47], a[12:15], v[192:207]
    ds_read_b128 v[36:39], v64 offset:4608
    s_add_u32 m0, s70, 17408
    s_mul_i32 s73, s96, 56
    s_add_u32 s73, s73, 143360
    buffer_load_dwordx4 v213, s[20:23], s73 offen lds
    s_waitcnt lgkmcnt(5)
    v_mfma_f32_32x32x16_bf16 v[192:207], v[48:51], a[16:19], v[192:207]
    ds_read_b128 v[40:43], v64 offset:5120
    s_waitcnt lgkmcnt(5)
    v_mfma_f32_32x32x16_bf16 v[192:207], v[52:55], a[20:23], v[192:207]
    ds_read_b128 v[44:47], v64 offset:5632
    s_waitcnt lgkmcnt(5)
    v_mfma_f32_32x32x16_bf16 v[192:207], v[56:59], a[24:27], v[192:207]
    ds_read_b128 v[48:51], v64 offset:6144
    s_add_u32 m0, s70, 18432
    s_mul_i32 s73, s96, 56
    s_add_u32 s73, s73, 172032
    buffer_load_dwordx4 v213, s[20:23], s73 offen lds
    s_waitcnt lgkmcnt(5)
    v_mfma_f32_32x32x16_bf16 v[192:207], v[60:63], a[28:31], v[192:207]
    ds_read_b128 v[52:55], v64 offset:6656
    s_waitcnt lgkmcnt(5)
    v_mfma_f32_32x32x16_bf16 v[192:207], v[32:35], a[32:35], v[192:207]
    ds_read_b128 v[56:59], v64 offset:7168
    s_waitcnt lgkmcnt(5)
    v_mfma_f32_32x32x16_bf16 v[192:207], v[36:39], a[36:39], v[192:207]
    ds_read_b128 v[60:63], v64 offset:7680
    s_add_u32 m0, s70, 19456
    s_mul_i32 s73, s96, 56
    s_add_u32 s73, s73, 200704
    buffer_load_dwordx4 v213, s[20:23], s73 offen lds
    s_waitcnt lgkmcnt(5)
    v_mfma_f32_32x32x16_bf16 v[192:207], v[40:43], a[40:43], v[192:207]
    s_waitcnt lgkmcnt(4)
    v_mfma_f32_32x32x16_bf16 v[192:207], v[44:47], a[44:47], v[192:207]
    s_waitcnt vmcnt(4)
    s_barrier
    ds_read_b128 v[32:35], v64 offset:8192
    ds_read_b128 v[36:39], v64 offset:8704
    s_waitcnt lgkmcnt(5)
    v_mfma_f32_32x32x16_bf16 v[192:207], v[48:51], a[48:51], v[192:207]
    ds_read_b128 v[40:43], v64 offset:9216
    s_add_u32 m0, s70, 20480
    s_mul_i32 s73, s97, 56
    s_add_u32 s73, s73, 0
    buffer_load_dwordx4 v213, s[20:23], s73 offen lds
    s_waitcnt lgkmcnt(5)
    v_mfma_f32_32x32x16_bf16 v[192:207], v[52:55], a[52:55], v[192:207]
    ds_read_b128 v[44:47], v64 offset:9728
    s_waitcnt lgkmcnt(5)
    v_mfma_f32_32x32x16_bf16 v[192:207], v[56:59], a[56:59], v[192:207]
    ds_read_b128 v[48:51], v64 offset:10240
    s_waitcnt lgkmcnt(5)
    v_mfma_f32_32x32x16_bf16 v[192:207], v[60:63], a[60:63], v[192:207]
    ds_read_b128 v[52:55], v64 offset:10752
    s_add_u32 m0, s70, 21504
    s_mul_i32 s73, s97, 56
    s_add_u32 s73, s73, 28672
    buffer_load_dwordx4 v213, s[20:23], s73 offen lds
    s_waitcnt lgkmcnt(5)
    v_mfma_f32_32x32x16_bf16 v[192:207], v[32:35], a[64:67], v[192:207]
    ds_read_b128 v[56:59], v64 offset:11264
    s_waitcnt lgkmcnt(5)
    v_mfma_f32_32x32x16_bf16 v[192:207], v[36:39], a[68:71], v[192:207]
    ds_read_b128 v[60:63], v64 offset:11776
    s_waitcnt lgkmcnt(5)
    v_mfma_f32_32x32x16_bf16 v[192:207], v[40:43], a[72:75], v[192:207]
    ds_read_b128 v[32:35], v64 offset:12288
    s_add_u32 m0, s70, 22528
    s_mul_i32 s73, s97, 56
    s_add_u32 s73, s73, 57344
    buffer_load_dwordx4 v213, s[20:23], s73 offen lds
    s_waitcnt lgkmcnt(5)
    v_mfma_f32_32x32x16_bf16 v[192:207], v[44:47], a[76:79], v[192:207]
    ds_read_b128 v[36:39], v64 offset:12800
    s_waitcnt lgkmcnt(5)
    v_mfma_f32_32x32x16_bf16 v[192:207], v[48:51], a[80:83], v[192:207]
    ds_read_b128 v[40:43], v64 offset:13312
    s_waitcnt lgkmcnt(5)
    v_mfma_f32_32x32x16_bf16 v[192:207], v[52:55], a[84:87], v[192:207]
    ds_read_b128 v[44:47], v64 offset:13824
    s_add_u32 m0, s70, 23552
    s_mul_i32 s73, s97, 56
    s_add_u32 s73, s73, 86016
    buffer_load_dwordx4 v213, s[20:23], s73 offen lds
    s_waitcnt lgkmcnt(5)
    v_mfma_f32_32x32x16_bf16 v[192:207], v[56:59], a[88:91], v[192:207]
    ds_read_b128 v[48:51], v64 offset:14336
    s_waitcnt lgkmcnt(5)
    v_mfma_f32_32x32x16_bf16 v[192:207], v[60:63], a[92:95], v[192:207]
    ds_read_b128 v[52:55], v64 offset:14848
    s_waitcnt lgkmcnt(5)
    v_mfma_f32_32x32x16_bf16 v[192:207], v[32:35], a[96:99], v[192:207]
    ds_read_b128 v[56:59], v64 offset:15360
    s_add_u32 m0, s70, 24576
    s_mul_i32 s73, s97, 56
    s_add_u32 s73, s73, 114688
    buffer_load_dwordx4 v213, s[20:23], s73 offen lds
    s_waitcnt lgkmcnt(5)
    v_mfma_f32_32x32x16_bf16 v[192:207], v[36:39], a[100:103], v[192:207]
    ds_read_b128 v[60:63], v64 offset:15872
    s_waitcnt lgkmcnt(5)
    v_mfma_f32_32x32x16_bf16 v[192:207], v[40:43], a[104:107], v[192:207]
    s_waitcnt lgkmcnt(4)
    v_mfma_f32_32x32x16_bf16 v[192:207], v[44:47], a[108:111], v[192:207]
    s_add_u32 m0, s70, 25600
    s_mul_i32 s73, s97, 56
    s_add_u32 s73, s73, 143360
    buffer_load_dwordx4 v213, s[20:23], s73 offen lds
    s_waitcnt lgkmcnt(3)
    v_mfma_f32_32x32x16_bf16 v[192:207], v[48:51], a[112:115], v[192:207]
    s_waitcnt lgkmcnt(2)
    v_mfma_f32_32x32x16_bf16 v[192:207], v[52:55], a[116:119], v[192:207]
    s_waitcnt lgkmcnt(1)
    v_mfma_f32_32x32x16_bf16 v[192:207], v[56:59], a[120:123], v[192:207]
    s_add_u32 m0, s70, 26624
    s_mul_i32 s73, s97, 56
    s_add_u32 s73, s73, 172032
    buffer_load_dwordx4 v213, s[20:23], s73 offen lds
    s_waitcnt lgkmcnt(0)
    v_mfma_f32_32x32x16_bf16 v[192:207], v[60:63], a[124:127], v[192:207]
    s_nop 11
    v_pk_mul_f32 v[68:69], v[192:193], v[192:193]
    v_pk_mul_f32 v[70:71], v[194:195], v[194:195]
    v_pk_mul_f32 v[72:73], v[196:197], v[196:197]
    v_pk_mul_f32 v[74:75], v[198:199], v[198:199]
    v_pk_mul_f32 v[76:77], v[200:201], v[200:201]
    v_pk_mul_f32 v[78:79], v[202:203], v[202:203]
    v_pk_mul_f32 v[80:81], v[204:205], v[204:205]
    v_pk_mul_f32 v[82:83], v[206:207], v[206:207]
    s_add_u32 m0, s70, 27648
    s_mul_i32 s73, s97, 56
    s_add_u32 s73, s73, 200704
    buffer_load_dwordx4 v213, s[20:23], s73 offen lds
    v_add_f32_dpp v84, v192, v192 row_mirror row_mask:0xf bank_mask:0x3
    v_add_f32_dpp v85, v193, v193 row_mirror row_mask:0xf bank_mask:0x3
    v_add_f32_dpp v86, v196, v196 row_mirror row_mask:0xf bank_mask:0x3
    v_add_f32_dpp v87, v197, v197 row_mirror row_mask:0xf bank_mask:0x3
    v_add_f32_dpp v88, v200, v200 row_mirror row_mask:0xf bank_mask:0x3
    v_add_f32_dpp v89, v201, v201 row_mirror row_mask:0xf bank_mask:0x3
    v_add_f32_dpp v90, v204, v204 row_mirror row_mask:0xf bank_mask:0x3
    v_add_f32_dpp v91, v205, v205 row_mirror row_mask:0xf bank_mask:0x3
    s_add_u32 m0, s70, 28672
    s_mul_i32 s73, s98, 56
    s_add_u32 s73, s73, 0
    buffer_load_dwordx4 v213, s[20:23], s73 offen lds
    v_add_f32_dpp v92, v68, v68 row_mirror row_mask:0xf bank_mask:0x3
    v_add_f32_dpp v93, v69, v69 row_mirror row_mask:0xf bank_mask:0x3
    v_add_f32_dpp v94, v72, v72 row_mirror row_mask:0xf bank_mask:0x3
    v_add_f32_dpp v95, v73, v73 row_mirror row_mask:0xf bank_mask:0x3
    v_add_f32_dpp v96, v76, v76 row_mirror row_mask:0xf bank_mask:0x3
    v_add_f32_dpp v97, v77, v77 row_mirror row_mask:0xf bank_mask:0x3
    v_add_f32_dpp v98, v80, v80 row_mirror row_mask:0xf bank_mask:0x3
    v_add_f32_dpp v99, v81, v81 row_mirror row_mask:0xf bank_mask:0x3
    s_add_u32 m0, s70, 29696
    s_mul_i32 s73, s98, 56
    s_add_u32 s73, s73, 28672
    buffer_load_dwordx4 v213, s[20:23], s73 offen lds
    v_add_f32_dpp v84, v194, v194 row_mirror row_mask:0xf bank_mask:0xc
    v_add_f32_dpp v85, v195, v195 row_mirror row_mask:0xf bank_mask:0xc
    v_add_f32_dpp v86, v198, v198 row_mirror row_mask:0xf bank_mask:0xc
    v_add_f32_dpp v87, v199, v199 row_mirror row_mask:0xf bank_mask:0xc
    v_add_f32_dpp v88, v202, v202 row_mirror row_mask:0xf bank_mask:0xc
    v_add_f32_dpp v89, v203, v203 row_mirror row_mask:0xf bank_mask:0xc
    v_add_f32_dpp v90, v206, v206 row_mirror row_mask:0xf bank_mask:0xc
    v_add_f32_dpp v91, v207, v207 row_mirror row_mask:0xf bank_mask:0xc
    s_add_u32 m0, s70, 30720
    s_mul_i32 s73, s98, 56
    s_add_u32 s73, s73, 57344
    buffer_load_dwordx4 v213, s[20:23], s73 offen lds
    v_add_f32_dpp v92, v70, v70 row_mirror row_mask:0xf bank_mask:0xc
    v_add_f32_dpp v93, v71, v71 row_mirror row_mask:0xf bank_mask:0xc
    v_add_f32_dpp v94, v74, v74 row_mirror row_mask:0xf bank_mask:0xc
    v_add_f32_dpp v95, v75, v75 row_mirror row_mask:0xf bank_mask:0xc
    v_add_f32_dpp v96, v78, v78 row_mirror row_mask:0xf bank_mask:0xc
    v_add_f32_dpp v97, v79, v79 row_mirror row_mask:0xf bank_mask:0xc
    v_add_f32_dpp v98, v82, v82 row_mirror row_mask:0xf bank_mask:0xc
    v_add_f32_dpp v99, v83, v83 row_mirror row_mask:0xf bank_mask:0xc
    s_add_u32 m0, s70, 31744
    s_mul_i32 s73, s98, 56
    s_add_u32 s73, s73, 86016
    buffer_load_dwordx4 v213, s[20:23], s73 offen lds
    v_add_f32_dpp v84, v84, v84 row_half_mirror row_mask:0xf bank_mask:0x5
    v_add_f32_dpp v86, v86, v86 row_half_mirror row_mask:0xf bank_mask:0x5
    v_add_f32_dpp v88, v88, v88 row_half_mirror row_mask:0xf bank_mask:0x5
    v_add_f32_dpp v90, v90, v90 row_half_mirror row_mask:0xf bank_mask:0x5
    v_add_f32_dpp v92, v92, v92 row_half_mirror row_mask:0xf bank_mask:0x5
    v_add_f32_dpp v94, v94, v94 row_half_mirror row_mask:0xf bank_mask:0x5
    v_add_f32_dpp v96, v96, v96 row_half_mirror row_mask:0xf bank_mask:0x5
    v_add_f32_dpp v98, v98, v98 row_half_mirror row_mask:0xf bank_mask:0x5
    v_add_f32_dpp v84, v85, v85 row_half_mirror row_mask:0xf bank_mask:0xa
    v_add_f32_dpp v86, v87, v87 row_half_mirror row_mask:0xf bank_mask:0xa
    v_add_f32_dpp v88, v89, v89 row_half_mirror row_mask:0xf bank_mask:0xa
    v_add_f32_dpp v90, v91, v91 row_half_mirror row_mask:0xf bank_mask:0xa
    v_add_f32_dpp v92, v93, v93 row_half_mirror row_mask:0xf bank_mask:0xa
    v_add_f32_dpp v94, v95, v95 row_half_mirror row_mask:0xf bank_mask:0xa
    v_add_f32_dpp v96, v97, v97 row_half_mirror row_mask:0xf bank_mask:0xa
    v_add_f32_dpp v98, v99, v99 row_half_mirror row_mask:0xf bank_mask:0xa
    v_add_f32_dpp v85, v84, v84 quad_perm:[1,0,3,2] row_mask:0xf bank_mask:0xf
    v_add_f32_dpp v87, v86, v86 quad_perm:[1,0,3,2] row_mask:0xf bank_mask:0xf
    v_add_f32_dpp v89, v88, v88 quad_perm:[1,0,3,2] row_mask:0xf bank_mask:0xf
    v_add_f32_dpp v91, v90, v90 quad_perm:[1,0,3,2] row_mask:0xf bank_mask:0xf
    v_add_f32_dpp v93, v92, v92 quad_perm:[1,0,3,2] row_mask:0xf bank_mask:0xf
    v_add_f32_dpp v95, v94, v94 quad_perm:[1,0,3,2] row_mask:0xf bank_mask:0xf
    v_add_f32_dpp v97, v96, v96 quad_perm:[1,0,3,2] row_mask:0xf bank_mask:0xf
    v_add_f32_dpp v99, v98, v98 quad_perm:[1,0,3,2] row_mask:0xf bank_mask:0xf
    v_add_f32_dpp v68, v85, v85 quad_perm:[2,3,0,1] row_mask:0xf bank_mask:0xf
    v_add_f32_dpp v69, v87, v87 quad_perm:[2,3,0,1] row_mask:0xf bank_mask:0xf
    v_add_f32_dpp v70, v89, v89 quad_perm:[2,3,0,1] row_mask:0xf bank_mask:0xf
    v_add_f32_dpp v71, v91, v91 quad_perm:[2,3,0,1] row_mask:0xf bank_mask:0xf
    v_add_f32_dpp v72, v93, v93 quad_perm:[2,3,0,1] row_mask:0xf bank_mask:0xf
    v_add_f32_dpp v73, v95, v95 quad_perm:[2,3,0,1] row_mask:0xf bank_mask:0xf
    v_add_f32_dpp v74, v97, v97 quad_perm:[2,3,0,1] row_mask:0xf bank_mask:0xf
    v_add_f32_dpp v75, v99, v99 quad_perm:[2,3,0,1] row_mask:0xf bank_mask:0xf
    v_permlane16_swap_b32 v68, v69
    v_permlane16_swap_b32 v70, v71
    v_permlane16_swap_b32 v72, v73
    v_permlane16_swap_b32 v74, v75
    v_add_f32 v84, v68, v69
    v_add_f32 v85, v72, v73
    v_add_f32 v86, v70, v71
    v_add_f32 v87, v74, v75
    v_and_b32 v65, 1, v3
    v_lshlrev_b32 v65, 6, v65
    v_lshrrev_b32_e64 v66, 5, v1
    v_lshl_add_u32 v65, v66, 5, v65
    v_bfe_u32 v67, v1, 2, 2
    v_lshl_add_u32 v65, v67, 3, v65
    s_lshl_b32 s58, s3, 8
    v_add_u32 v65, s58, v65
    ds_write_b64 v65, v[84:85] offset:0
    ds_write_b64 v65, v[86:87] offset:128
    v_and_b32 v67, 31, v1
    v_lshlrev_b32 v65, 9, v66
    v_lshl_add_u32 v65, v67, 4, v65
    v_lshlrev_b32_e64 v66, 8, v66
    v_lshl_add_u32 v66, v67, 3, v66
    s_and_b32 s58, s58, 512
    v_add_u32_e64 v66, s58, v66
    s_lshl_b32 s58, s67, 1
    s_lshr_b32 s60, s3, 1
    s_add_u32 s58, s58, s60
    s_lshl_b32 s58, s58, 12
    s_add_u32 s58, s58, 0x548000
    s_lshl_b32 s60, s66, 9
    s_add_u32 s60, s60, s58
    s_waitcnt lgkmcnt(0)
    s_barrier
    ds_read_b64 v[84:85], v66 offset:0
    v_mov_b32 v89, s4
    v_mov_b32 v91, s4
    s_waitcnt lgkmcnt(0)
    v_mov_b32 v88, v84
    v_mov_b32 v90, v85
    s_nop 0
    v_permlane32_swap_b32 v88, v84
    v_permlane32_swap_b32 v90, v85
    v_add_f32 v88, v88, v84
    v_add_f32 v90, v90, v85
    s_bitcmp0_b32 s3, 0
    s_cselect_b32 exec_lo, -1, 0
    s_mov_b32 exec_hi, 0
    buffer_store_dwordx4 v[88:91], v65, s[40:43], s60 offen sc1
    s_mov_b64 exec, -1
    v_cvt_pk_bf16_f32 v240, v192, v193
    v_cvt_pk_bf16_f32 v241, v194, v195
    v_cvt_pk_bf16_f32 v242, v196, v197
    v_cvt_pk_bf16_f32 v243, v198, v199
    v_cvt_pk_bf16_f32 v244, v200, v201
    v_cvt_pk_bf16_f32 v245, v202, v203
    v_cvt_pk_bf16_f32 v246, v204, v205
    v_cvt_pk_bf16_f32 v247, v206, v207
    s_lshl_b32 s61, s66, 1
    s_and_b32 s60, s3, 1
    s_add_u32 s61, s61, s60
    s_lshl_b32 s61, s61, 7
    s_lshl_b32 s60, s67, 2
    s_add_u32 s61, s61, s60
    s_and_b32 s60, s3, 2
    s_add_u32 s61, s61, s60
    s_lshl_b32 s61, s61, 10
    s_add_u32 s61, s61, 0x200000
    v_lshlrev_b32_e64 v66, 4, v67
    v_cmp_gt_u32 s[86:87], 32, v1
    s_add_u32 m0, s70, 0
    s_mul_i32 s73, s98, 56
    s_add_u32 s73, s73, 114688
    buffer_load_dwordx4 v213, s[20:23], s73 offen lds
    s_add_u32 m0, s70, 1024
    s_mul_i32 s73, s98, 56
    s_add_u32 s73, s73, 143360
    buffer_load_dwordx4 v213, s[20:23], s73 offen lds
    s_add_u32 m0, s70, 2048
    s_mul_i32 s73, s98, 56
    s_add_u32 s73, s73, 172032
    buffer_load_dwordx4 v213, s[20:23], s73 offen lds
    s_add_u32 m0, s70, 3072
    s_mul_i32 s73, s98, 56
    s_add_u32 s73, s73, 200704
    buffer_load_dwordx4 v213, s[20:23], s73 offen lds
    s_add_u32 m0, s70, 4096
    s_mul_i32 s73, s99, 56
    s_add_u32 s73, s73, 0
    buffer_load_dwordx4 v213, s[20:23], s73 offen lds
    s_add_u32 m0, s70, 5120
    s_mul_i32 s73, s99, 56
    s_add_u32 s73, s73, 28672
    buffer_load_dwordx4 v213, s[20:23], s73 offen lds
    s_add_u32 m0, s70, 6144
    s_mul_i32 s73, s99, 56
    s_add_u32 s73, s73, 57344
    buffer_load_dwordx4 v213, s[20:23], s73 offen lds
    s_add_u32 m0, s70, 7168
    s_mul_i32 s73, s99, 56
    s_add_u32 s73, s73, 86016
    buffer_load_dwordx4 v213, s[20:23], s73 offen lds
    s_add_u32 m0, s70, 8192
    s_mul_i32 s73, s99, 56
    s_add_u32 s73, s73, 114688
    buffer_load_dwordx4 v213, s[20:23], s73 offen lds
    s_add_u32 m0, s70, 9216
    s_mul_i32 s73, s99, 56
    s_add_u32 s73, s73, 143360
    buffer_load_dwordx4 v213, s[20:23], s73 offen lds
    s_add_u32 m0, s70, 10240
    s_mul_i32 s73, s99, 56
    s_add_u32 s73, s73, 172032
    buffer_load_dwordx4 v213, s[20:23], s73 offen lds
    s_add_u32 m0, s70, 11264
    s_mul_i32 s73, s99, 56
    s_add_u32 s73, s73, 200704
    buffer_load_dwordx4 v213, s[20:23], s73 offen lds
    s_add_u32 m0, s70, 12288
    s_mul_i32 s73, s100, 56
    s_add_u32 s73, s73, 0
    buffer_load_dwordx4 v213, s[20:23], s73 offen lds
    s_add_u32 m0, s70, 13312
    s_mul_i32 s73, s100, 56
    s_add_u32 s73, s73, 28672
    buffer_load_dwordx4 v213, s[20:23], s73 offen lds
    s_add_u32 m0, s70, 14336
    s_mul_i32 s73, s100, 56
    s_add_u32 s73, s73, 57344
    buffer_load_dwordx4 v213, s[20:23], s73 offen lds
    s_add_u32 m0, s70, 15360
    s_mul_i32 s73, s100, 56
    s_add_u32 s73, s73, 86016
    buffer_load_dwordx4 v213, s[20:23], s73 offen lds
    buffer_load_dwordx4 v[96:99], v65, s[40:43], s58 offen offset:0 sc1
    buffer_load_dwordx4 v[100:103], v65, s[40:43], s58 offen offset:1024 sc1
    buffer_load_dwordx4 v[104:107], v65, s[40:43], s58 offen offset:2048 sc1
    buffer_load_dwordx4 v[108:111], v66, s[40:43], s58 offen offset:3072 sc1
    s_sleep 5
    s_nop 0
Lst_P_6:
    s_sub_u32 s6, s6, 1
    s_cbranch_scc1 L_end_P
    buffer_load_dwordx4 v[112:115], v65, s[40:43], s58 offen offset:0 sc1
    buffer_load_dwordx4 v[116:119], v65, s[40:43], s58 offen offset:1024 sc1
    buffer_load_dwordx4 v[120:123], v65, s[40:43], s58 offen offset:2048 sc1
    buffer_load_dwordx4 v[124:127], v66, s[40:43], s58 offen offset:3072 sc1
    s_waitcnt vmcnt(4)
    v_xor_b32 v97, s4, v97
    v_xor_b32 v99, s4, v99
    v_xor_b32 v101, s4, v101
    v_xor_b32 v103, s4, v103
    v_xor_b32 v105, s4, v105
    v_xor_b32 v107, s4, v107
    v_xor_b32 v109, s4, v109
    v_xor_b32_e64 v111, s4, v111
    v_cndmask_b32 v108, 0, v108, s[86:87]
    v_cndmask_b32 v110, 0, v110, s[86:87]
    v_or3_b32 v97, v97, v99, v101
    v_or3_b32 v103, v103, v105, v107
    v_or3_b32 v97, v97, v109, v111
    v_or_b32 v97, v97, v103
    v_cmp_ne_u32 vcc, 0, v97
    v_add_f32 v128, v96, v100
    v_add_f32 v129, v104, v108
    v_add_f32_e64 v130, v98, v102
    v_add_f32 v131, v106, v110
    s_cbranch_vccz Lstd_P_7
    buffer_load_dwordx4 v[96:99], v65, s[40:43], s58 offen offset:0 sc1
    buffer_load_dwordx4 v[100:103], v65, s[40:43], s58 offen offset:1024 sc1
    buffer_load_dwordx4 v[104:107], v65, s[40:43], s58 offen offset:2048 sc1
    buffer_load_dwordx4 v[108:111], v66, s[40:43], s58 offen offset:3072 sc1
    s_waitcnt vmcnt(4)
    v_xor_b32 v113, s4, v113
    v_xor_b32 v115, s4, v115
    v_xor_b32 v117, s4, v117
    v_xor_b32 v119, s4, v119
    v_xor_b32 v121, s4, v121
    v_xor_b32 v123, s4, v123
    v_xor_b32 v125, s4, v125
    v_xor_b32_e64 v127, s4, v127
    v_cndmask_b32 v124, 0, v124, s[86:87]
    v_cndmask_b32 v126, 0, v126, s[86:87]
    v_or3_b32 v113, v113, v115, v117
    v_or3_b32 v119, v119, v121, v123
    v_or3_b32 v113, v113, v125, v127
    v_or_b32 v113, v113, v119
    v_cmp_ne_u32 vcc, 0, v113
    v_add_f32 v128, v112, v116
    v_add_f32 v129, v120, v124
    v_add_f32 v130, v114, v118
    v_add_f32 v131, v122, v126
    s_cbranch_vccnz Lst_P_6
    s_nop 3
Lstd_P_7:
    v_add_f32 v128, v128, v129
    v_add_f32 v130, v130, v131
    v_mov_b32 v136, v128
    v_mov_b32 v138, v130
    s_nop 0
    v_permlane32_swap_b32 v128, v136
    v_permlane32_swap_b32 v130, v138
    v_add_f32 v128, v128, v136
    v_add_f32_e64 v130, v130, v138
    v_mul_f32 v133, 0x3b124925, v128
    v_mul_f32 v130, 0x3b124925, v130
    v_fma_f32 v130, -v133, v133, v130
    v_max_f32_e64 v130, 0, v130
    v_add_f32 v135, 0x3727c5ac, v130
    v_rsq_f32 v135, v135
    s_nop 0
    v_mul_f32_e64 v130, v130, v135
    v_fmaak_f32 v130, v130, v135, 0x3727c5ac
    v_rsq_f32 v130, v130
    s_nop 0
    v_mul_f32 v135, v135, v130
    s_lshl_b32 s60, s3, 8
    v_lshl_add_u32 v66, v67, 2, s60
    ds_write_b32 v66, v133 offset:1024
    ds_write_b32 v66, v135 offset:1152
    v_lshrrev_b32 v66, 5, v1
    v_lshl_add_u32 v66, v66, 4, s60
    s_waitcnt lgkmcnt(0)
    ds_read_b128 v[140:143], v66 offset:1024
    ds_read_b128 v[156:159], v66 offset:1152
    ds_read_b128 v[144:147], v66 offset:1056
    ds_read_b128 v[160:163], v66 offset:1184
    ds_read_b128 v[148:151], v66 offset:1088
    ds_read_b128 v[164:167], v66 offset:1216
    ds_read_b128 v[152:155], v66 offset:1120
    ds_read_b128 v[168:171], v66 offset:1248
    s_waitcnt lgkmcnt(7)
    v_pk_add_f32 v[192:193], v[192:193], v[140:141] neg_lo:[0,1] neg_hi:[0,1]
    v_pk_add_f32 v[194:195], v[194:195], v[142:143] neg_lo:[0,1] neg_hi:[0,1]
    s_waitcnt lgkmcnt(5)
    v_pk_add_f32 v[196:197], v[196:197], v[144:145] neg_lo:[0,1] neg_hi:[0,1]
    v_pk_add_f32 v[198:199], v[198:199], v[146:147] neg_lo:[0,1] neg_hi:[0,1]
    v_pk_mul_f32 v[192:193], v[192:193], v[156:157]
    v_pk_mul_f32 v[194:195], v[194:195], v[158:159]
    s_waitcnt lgkmcnt(4)
    v_pk_mul_f32 v[196:197], v[196:197], v[160:161]
    v_pk_mul_f32 v[198:199], v[198:199], v[162:163]
    v_cvt_pk_bf16_f32 v84, v192, v193
    v_cvt_pk_bf16_f32 v85, v194, v195
    v_cvt_pk_bf16_f32 v86, v196, v197
    v_cvt_pk_bf16_f32 v87, v198, v199
    buffer_store_dwordx4 v[84:87], v4, s[40:43], s61 offen offset:0 sc1
    s_waitcnt lgkmcnt(3)
    v_pk_add_f32 v[200:201], v[200:201], v[148:149] neg_lo:[0,1] neg_hi:[0,1]
    v_pk_add_f32 v[202:203], v[202:203], v[150:151] neg_lo:[0,1] neg_hi:[0,1]
    s_waitcnt lgkmcnt(1)
    v_pk_add_f32 v[204:205], v[204:205], v[152:153] neg_lo:[0,1] neg_hi:[0,1]
    v_pk_add_f32 v[206:207], v[206:207], v[154:155] neg_lo:[0,1] neg_hi:[0,1]
    v_pk_mul_f32 v[200:201], v[200:201], v[164:165]
    v_pk_mul_f32 v[202:203], v[202:203], v[166:167]
    s_waitcnt lgkmcnt(0)
    v_pk_mul_f32 v[204:205], v[204:205], v[168:169]
    v_pk_mul_f32 v[206:207], v[206:207], v[170:171]
    v_cvt_pk_bf16_f32 v88, v200, v201
    v_cvt_pk_bf16_f32 v89, v202, v203
    v_cvt_pk_bf16_f32 v90, v204, v205
    v_cvt_pk_bf16_f32 v91, v206, v207
    buffer_store_dwordx4 v[88:91], v4, s[40:43], s61 offen offset:1024 sc1
    ds_read_b64_tr_b16 a[208:209], v215 offset:16384
    ds_read_b64_tr_b16 a[210:211], v215 offset:17408
    ds_read_b64_tr_b16 a[212:213], v216 offset:16384
    ds_read_b64_tr_b16 a[214:215], v216 offset:17408
    ds_read_b64_tr_b16 a[216:217], v215 offset:18432
    ds_read_b64_tr_b16 a[218:219], v215 offset:19456
    ds_read_b64_tr_b16 a[220:221], v216 offset:18432
    ds_read_b64_tr_b16 a[222:223], v216 offset:19456
    ds_read_b64_tr_b16 a[224:225], v215 offset:20480
    ds_read_b64_tr_b16 a[226:227], v215 offset:21504
    ds_read_b64_tr_b16 a[228:229], v216 offset:20480
    ds_read_b64_tr_b16 a[230:231], v216 offset:21504
    ds_read_b64_tr_b16 a[232:233], v215 offset:22528
    ds_read_b64_tr_b16 a[234:235], v215 offset:23552
    ds_read_b64_tr_b16 a[236:237], v216 offset:22528
    ds_read_b64_tr_b16 a[238:239], v216 offset:23552
    ds_read_b64_tr_b16 a[240:241], v215 offset:24576
    ds_read_b64_tr_b16 a[242:243], v215 offset:25600
    ds_read_b64_tr_b16 a[244:245], v216 offset:24576
    ds_read_b64_tr_b16 a[246:247], v216 offset:25600
    ds_read_b64_tr_b16 a[248:249], v215 offset:26624
    ds_read_b64_tr_b16 a[250:251], v215 offset:27648
    ds_read_b64_tr_b16 a[252:253], v216 offset:26624
    ds_read_b64_tr_b16 a[254:255], v216 offset:27648
    ds_read_b64_tr_b16 a[0:1], v215 offset:28672
    ds_read_b64_tr_b16 a[2:3], v215 offset:29696
    ds_read_b64_tr_b16 a[4:5], v216 offset:28672
    ds_read_b64_tr_b16 a[6:7], v216 offset:29696
    ds_read_b64_tr_b16 a[8:9], v215 offset:30720
    ds_read_b64_tr_b16 a[10:11], v215 offset:31744
    ds_read_b64_tr_b16 a[12:13], v216 offset:30720
    ds_read_b64_tr_b16 a[14:15], v216 offset:31744
    ds_read_b64_tr_b16 a[16:17], v215 offset:0
    ds_read_b64_tr_b16 a[18:19], v215 offset:1024
    ds_read_b64_tr_b16 a[20:21], v216 offset:0
    ds_read_b64_tr_b16 a[22:23], v216 offset:1024
    ds_read_b64_tr_b16 a[24:25], v215 offset:2048
    ds_read_b64_tr_b16 a[26:27], v215 offset:3072
    ds_read_b64_tr_b16 a[28:29], v216 offset:2048
    ds_read_b64_tr_b16 a[30:31], v216 offset:3072
    ds_read_b64_tr_b16 a[32:33], v215 offset:4096
    ds_read_b64_tr_b16 a[34:35], v215 offset:5120
    ds_read_b64_tr_b16 a[36:37], v216 offset:4096
    ds_read_b64_tr_b16 a[38:39], v216 offset:5120
    ds_read_b64_tr_b16 a[40:41], v215 offset:6144
    ds_read_b64_tr_b16 a[42:43], v215 offset:7168
    ds_read_b64_tr_b16 a[44:45], v216 offset:6144
    ds_read_b64_tr_b16 a[46:47], v216 offset:7168
    ds_read_b64_tr_b16 a[48:49], v215 offset:8192
    ds_read_b64_tr_b16 a[50:51], v215 offset:9216
    ds_read_b64_tr_b16 a[52:53], v216 offset:8192
    ds_read_b64_tr_b16 a[54:55], v216 offset:9216
    ds_read_b64_tr_b16 a[56:57], v215 offset:10240
    ds_read_b64_tr_b16 a[58:59], v215 offset:11264
    ds_read_b64_tr_b16 a[60:61], v216 offset:10240
    ds_read_b64_tr_b16 a[62:63], v216 offset:11264
    ds_read_b64_tr_b16 a[64:65], v215 offset:12288
    ds_read_b64_tr_b16 a[66:67], v215 offset:13312
    ds_read_b64_tr_b16 a[68:69], v216 offset:12288
    ds_read_b64_tr_b16 a[70:71], v216 offset:13312
    ds_read_b64_tr_b16 a[72:73], v215 offset:14336
    ds_read_b64_tr_b16 a[74:75], v215 offset:15360
    ds_read_b64_tr_b16 a[76:77], v216 offset:14336
    ds_read_b64_tr_b16 a[78:79], v216 offset:15360
    s_waitcnt vmcnt(0)
    v_mov_b32 v8, s4
    s_mov_b64 exec, 1
    buffer_store_dword v8, v9, s[40:43], s81 offen sc1
    s_mov_b64 exec, -1
    s_waitcnt lgkmcnt(4)
    s_add_u32 m0, s70, 12288
    s_mul_i32 s73, s100, 56
    s_add_u32 s73, s73, 114688
    buffer_load_dwordx4 v213, s[20:23], s73 offen lds
    s_add_u32 m0, s70, 13312
    s_mul_i32 s73, s100, 56
    s_add_u32 s73, s73, 143360
    buffer_load_dwordx4 v213, s[20:23], s73 offen lds
    s_waitcnt lgkmcnt(0)
    s_add_u32 m0, s70, 14336
    s_mul_i32 s73, s100, 56
    s_add_u32 s73, s73, 172032
    buffer_load_dwordx4 v213, s[20:23], s73 offen lds
    s_add_u32 m0, s70, 15360
    s_mul_i32 s73, s100, 56
    s_add_u32 s73, s73, 200704
    buffer_load_dwordx4 v213, s[20:23], s73 offen lds
    s_add_u32 m0, s70, 16384
    s_mul_i32 s73, s101, 56
    s_add_u32 s73, s73, 0
    buffer_load_dwordx4 v213, s[20:23], s73 offen lds
    s_add_u32 m0, s70, 17408
    s_mul_i32 s73, s101, 56
    s_add_u32 s73, s73, 28672
    buffer_load_dwordx4 v213, s[20:23], s73 offen lds
    s_add_u32 m0, s70, 18432
    s_mul_i32 s73, s101, 56
    s_add_u32 s73, s73, 57344
    buffer_load_dwordx4 v213, s[20:23], s73 offen lds
    s_add_u32 m0, s70, 19456
    s_mul_i32 s73, s101, 56
    s_add_u32 s73, s73, 86016
    buffer_load_dwordx4 v213, s[20:23], s73 offen lds
    s_add_u32 m0, s70, 20480
    s_mul_i32 s73, s101, 56
    s_add_u32 s73, s73, 114688
    buffer_load_dwordx4 v213, s[20:23], s73 offen lds
    s_add_u32 m0, s70, 21504
    s_mul_i32 s73, s101, 56
    s_add_u32 s73, s73, 143360
    buffer_load_dwordx4 v213, s[20:23], s73 offen lds
    s_add_u32 m0, s70, 22528
    s_mul_i32 s73, s101, 56
    s_add_u32 s73, s73, 172032
    buffer_load_dwordx4 v213, s[20:23], s73 offen lds
    s_add_u32 m0, s70, 23552
    s_mul_i32 s73, s101, 56
    s_add_u32 s73, s73, 200704
    buffer_load_dwordx4 v213, s[20:23], s73 offen lds
    s_add_u32 m0, s70, 24576
    s_mul_i32 s73, s48, 64
    s_add_u32 s73, s73, 0
    buffer_load_dwordx4 v214, s[24:27], s73 offen lds
    s_add_u32 m0, s70, 25600
    s_mul_i32 s73, s48, 64
    s_add_u32 s73, s73, 32768
    buffer_load_dwordx4 v214, s[24:27], s73 offen lds
    s_add_u32 m0, s70, 26624
    s_mul_i32 s73, s48, 64
    s_add_u32 s73, s73, 65536
    buffer_load_dwordx4 v214, s[24:27], s73 offen lds
    s_add_u32 m0, s70, 27648
    s_mul_i32 s73, s48, 64
    s_add_u32 s73, s73, 98304
    buffer_load_dwordx4 v214, s[24:27], s73 offen lds
    s_add_u32 m0, s70, 28672
    s_mul_i32 s73, s48, 64
    s_add_u32 s73, s73, 131072
    buffer_load_dwordx4 v214, s[24:27], s73 offen lds
    s_add_u32 m0, s70, 29696
    s_mul_i32 s73, s48, 64
    s_add_u32 s73, s73, 163840
    buffer_load_dwordx4 v214, s[24:27], s73 offen lds
    s_add_u32 m0, s70, 30720
    s_mul_i32 s73, s48, 64
    s_add_u32 s73, s73, 196608
    buffer_load_dwordx4 v214, s[24:27], s73 offen lds
    s_add_u32 m0, s70, 31744
    s_mul_i32 s73, s48, 64
    s_add_u32 s73, s73, 229376
    buffer_load_dwordx4 v214, s[24:27], s73 offen lds
    s_add_u32 m0, s70, 32768
    s_mul_i32 s73, s49, 64
    s_add_u32 s73, s73, 0
    buffer_load_dwordx4 v214, s[24:27], s73 offen lds
    s_add_u32 m0, s70, 33792
    s_mul_i32 s73, s49, 64
    s_add_u32 s73, s73, 32768
    buffer_load_dwordx4 v214, s[24:27], s73 offen lds
    s_add_u32 m0, s70, 34816
    s_mul_i32 s73, s49, 64
    s_add_u32 s73, s73, 65536
    buffer_load_dwordx4 v214, s[24:27], s73 offen lds
    s_add_u32 m0, s70, 35840
    s_mul_i32 s73, s49, 64
    s_add_u32 s73, s73, 98304
    buffer_load_dwordx4 v214, s[24:27], s73 offen lds
    s_lshl_b32 s71, s64, 18
    s_lshl_b32 s86, s3, 15
    s_add_u32 s71, s71, s86
    s_add_u32 s71, s71, 0x200000
    s_add_u32 s72, s71, 0x20000
    s_mul_i32 s58, s66, 229376
    s_add_u32 s58, s58, 0x3c0000
    s_lshl_b32 s86, s65, 2
    s_add_u32 s86, s86, s3
    s_lshl_b32 s86, s86, 10
    s_add_u32 s57, s58, s86
    s_mul_i32 s86, s3, 28672
    s_add_u32 s58, s58, s86
    s_add_u32 s59, s58, 114688
    v_lshrrev_b32 v208, 5, v1
    v_lshlrev_b32 v208, 3, v208
    s_lshl_b32 s86, s65, 7
    s_lshl_b32 s87, s3, 5
    s_add_u32 s86, s86, s87
    buffer_load_dwordx2 v[220:221], v208, s[28:31], s86 offen offset:0
    buffer_load_dwordx2 v[222:223], v208, s[28:31], s86 offen offset:16
    s_lshl_b32 s86, s67, 7
    s_lshr_b32 s87, s3, 1
    s_lshl_b32 s87, s87, 6
    s_add_u32 s86, s86, s87
    buffer_load_dwordx2 v[224:225], v208, s[32:35], s86 offen offset:0
    buffer_load_dwordx2 v[226:227], v208, s[32:35], s86 offen offset:16
    buffer_load_dwordx2 v[228:229], v208, s[32:35], s86 offen offset:32
    buffer_load_dwordx2 v[230:231], v208, s[32:35], s86 offen offset:48
    v_add_u32 v232, s70, v4
    s_xor_b32 s86, s3, 1
    s_mul_i32 s86, s86, 36864
    s_add_u32 s86, s86, 12288
    v_add_u32 v233, s86, v4
    s_xor_b32 s86, s3, 2
    s_mul_i32 s86, s86, 36864
    s_add_u32 s86, s86, 14336
    v_add_u32 v234, s86, v4
    s_xor_b32 s86, s3, 3
    s_mul_i32 s86, s86, 36864
    s_add_u32 s86, s86, 16384
    v_add_u32 v235, s86, v4
    v_lshrrev_b32 v208, 5, v1
    v_lshlrev_b32 v208, 9, v208
    v_and_b32 v209, 31, v1
    v_lshl_add_u32 v208, v209, 2, v208
    s_lshr_b32 s86, s3, 1
    s_lshl_b32 s86, s86, 12
    v_add_u32_e64 v208, s86, v208
    v_xor_b32 v209, 0x1000, v208
    v_add_u32_e64 v236, s70, v208
    v_add_u32 v237, s70, v209
    s_lshl_b32 s86, s3, 11
    s_add_u32 s86, s86, 12288
    v_add_u32_e64 v238, s86, v4
    v_add_u32 v239, 73728, v238
    v_lshrrev_b32_e64 v208, 3, v1
    v_mul_u32_u24 v212, 896, v208
    v_and_b32_e64 v208, 7, v1
    v_lshl_add_u32 v212, v208, 3, v212
    s_lshl_b32 s68, s67, 2
    s_add_u32 s68, s68, s3
    s_mul_i32 s68, s68, 14336
    s_lshl_b32 s86, s66, 7
    s_add_u32 s68, s68, s86
    s_add_u32 s69, s68, 7168
    s_mov_b32 s88, 0xc0135761
    s_mov_b32 s89, 0xc0135761
    s_mov_b32 s90, 0xbdd2d3e8
    s_mov_b32 s91, 0xffff0000
    buffer_load_dword v249, v11, s[40:43], s84 offen sc1
    s_sleep 3
    buffer_load_dword v250, v11, s[40:43], s84 offen sc1
    s_sleep 3
    s_nop 0
Lpoll_P_8:
    s_sub_u32 s6, s6, 1
    s_cbranch_scc1 L_end_P
    buffer_load_dword v251, v11, s[40:43], s84 offen sc1
    s_waitcnt vmcnt(2)
    v_cmp_ne_u32_e64 vcc, s4, v249
    s_nop 1
    s_cbranch_vccz Lpd_P_9
    buffer_load_dword v249, v11, s[40:43], s84 offen sc1
    s_waitcnt vmcnt(2)
    v_cmp_ne_u32 vcc, s4, v250
    s_nop 1
    s_cbranch_vccz Lpd_P_9
    buffer_load_dword v250, v11, s[40:43], s84 offen sc1
    s_waitcnt vmcnt(2)
    v_cmp_ne_u32 vcc, s4, v251
    s_nop 1
    s_cbranch_vccnz Lpoll_P_8
    s_nop 1
Lpd_P_9:
    s_add_u32 s56, s71, s94
    buffer_load_dwordx4 v[80:83], v5, s[40:43], s56 offen offset:0 sc1
    buffer_load_dwordx4 v[84:87], v5, s[40:43], s56 offen offset:1024 sc1
    buffer_load_dwordx4 v[88:91], v5, s[40:43], s56 offen offset:2048 sc1
    buffer_load_dwordx4 v[92:95], v5, s[40:43], s56 offen offset:3072 sc1
    s_add_u32 s56, s71, s95
    buffer_load_dwordx4 v[96:99], v5, s[40:43], s56 offen offset:0 sc1
    buffer_load_dwordx4 v[100:103], v5, s[40:43], s56 offen offset:1024 sc1
    buffer_load_dwordx4 v[104:107], v5, s[40:43], s56 offen offset:2048 sc1
    buffer_load_dwordx4 v[108:111], v5, s[40:43], s56 offen offset:3072 sc1
    v_lshlrev_b32 v16, 16, v220
    v_and_b32 v17, s91, v220
    v_lshlrev_b32 v18, 16, v221
    v_and_b32 v19, s91, v221
    v_lshlrev_b32 v20, 16, v222
    v_and_b32 v21, s91, v222
    v_lshlrev_b32 v22, 16, v223
    v_and_b32_e64 v23, s91, v223
    v_mov_b64 v[24:25], 0
    v_mov_b64 v[26:27], 0
    v_mov_b64 v[28:29], 0
    v_mov_b64 v[30:31], 0
    ds_read_b64_tr_b16 a[80:81], v215 offset:12288
    ds_read_b64_tr_b16 a[82:83], v215 offset:13312
    ds_read_b64_tr_b16 a[84:85], v216 offset:12288
    ds_read_b64_tr_b16 a[86:87], v216 offset:13312
    ds_read_b64_tr_b16 a[88:89], v215 offset:14336
    ds_read_b64_tr_b16 a[90:91], v215 offset:15360
    ds_read_b64_tr_b16 a[92:93], v216 offset:14336
    ds_read_b64_tr_b16 a[94:95], v216 offset:15360
    ds_read_b64_tr_b16 a[96:97], v215 offset:16384
    ds_read_b64_tr_b16 a[98:99], v215 offset:17408
    ds_read_b64_tr_b16 a[100:101], v216 offset:16384
    ds_read_b64_tr_b16 a[102:103], v216 offset:17408
    ds_read_b64_tr_b16 a[104:105], v215 offset:18432
    ds_read_b64_tr_b16 a[106:107], v215 offset:19456
    ds_read_b64_tr_b16 a[108:109], v216 offset:18432
    ds_read_b64_tr_b16 a[110:111], v216 offset:19456
    ds_read_b64_tr_b16 a[112:113], v215 offset:20480
    ds_read_b64_tr_b16 a[114:115], v215 offset:21504
    ds_read_b64_tr_b16 a[116:117], v216 offset:20480
    ds_read_b64_tr_b16 a[118:119], v216 offset:21504
    ds_read_b64_tr_b16 a[120:121], v215 offset:22528
    ds_read_b64_tr_b16 a[122:123], v215 offset:23552
    ds_read_b64_tr_b16 a[124:125], v216 offset:22528
    ds_read_b64_tr_b16 a[126:127], v216 offset:23552
    v_mov_b32 v9, v5
    s_add_u32 s56, s71, s96
    buffer_load_dwordx4 v[112:115], v5, s[40:43], s56 offen offset:0 sc1
    buffer_load_dwordx4 v[116:119], v5, s[40:43], s56 offen offset:1024 sc1
    s_waitcnt vmcnt(9)
    v_mfma_f32_32x32x16_bf16 v[16:31], a[128:131], v[80:83], v[16:31]
    v_mfma_f32_32x32x16_bf16 v[32:47], a[132:135], v[80:83], 0
    buffer_load_dwordx4 v[120:123], v5, s[40:43], s56 offen offset:2048 sc1
    s_waitcnt vmcnt(9)
    v_mfma_f32_32x32x16_bf16 v[16:31], a[136:139], v[84:87], v[16:31]
    v_mfma_f32_32x32x16_bf16 v[32:47], a[140:143], v[84:87], v[32:47]
    buffer_load_dwordx4 v[124:127], v5, s[40:43], s56 offen offset:3072 sc1
    s_waitcnt vmcnt(9)
    v_mfma_f32_32x32x16_bf16 v[16:31], a[144:147], v[88:91], v[16:31]
    v_mfma_f32_32x32x16_bf16 v[32:47], a[148:151], v[88:91], v[32:47]
    s_add_u32 s56, s71, s97
    buffer_load_dwordx4 v[128:131], v5, s[40:43], s56 offen offset:0 sc1
    s_waitcnt vmcnt(9)
    v_mfma_f32_32x32x16_bf16 v[16:31], a[152:155], v[92:95], v[16:31]
    v_mfma_f32_32x32x16_bf16 v[32:47], a[156:159], v[92:95], v[32:47]
    buffer_load_dwordx4 v[132:135], v5, s[40:43], s56 offen offset:1024 sc1
    s_waitcnt vmcnt(9)
    v_mfma_f32_32x32x16_bf16 v[16:31], a[160:163], v[96:99], v[16:31]
    v_mfma_f32_32x32x16_bf16 v[32:47], a[164:167], v[96:99], v[32:47]
    buffer_load_dwordx4 v[136:139], v5, s[40:43], s56 offen offset:2048 sc1
    s_waitcnt vmcnt(9)
    v_mfma_f32_32x32x16_bf16 v[16:31], a[168:171], v[100:103], v[16:31]
    v_mfma_f32_32x32x16_bf16 v[32:47], a[172:175], v[100:103], v[32:47]
    buffer_load_dwordx4 v[140:143], v5, s[40:43], s56 offen offset:3072 sc1
    s_waitcnt vmcnt(9)
    v_mfma_f32_32x32x16_bf16 v[16:31], a[176:179], v[104:107], v[16:31]
    v_mfma_f32_32x32x16_bf16 v[32:47], a[180:183], v[104:107], v[32:47]
    s_add_u32 s56, s71, s98
    buffer_load_dwordx4 v[144:147], v5, s[40:43], s56 offen offset:0 sc1
    s_waitcnt vmcnt(9)
    v_mfma_f32_32x32x16_bf16 v[16:31], a[184:187], v[108:111], v[16:31]
    v_mfma_f32_32x32x16_bf16 v[32:47], a[188:191], v[108:111], v[32:47]
    buffer_load_dwordx4 v[148:151], v5, s[40:43], s56 offen offset:1024 sc1
    s_waitcnt vmcnt(9)
    v_mfma_f32_32x32x16_bf16 v[16:31], a[192:195], v[112:115], v[16:31]
    v_mfma_f32_32x32x16_bf16 v[32:47], a[196:199], v[112:115], v[32:47]
    buffer_load_dwordx4 v[152:155], v5, s[40:43], s56 offen offset:2048 sc1
    s_waitcnt vmcnt(9)
    v_mfma_f32_32x32x16_bf16 v[16:31], a[200:203], v[116:119], v[16:31]
    v_mfma_f32_32x32x16_bf16 v[32:47], a[204:207], v[116:119], v[32:47]
    buffer_load_dwordx4 v[156:159], v5, s[40:43], s56 offen offset:3072 sc1
    s_waitcnt vmcnt(9)
    v_mfma_f32_32x32x16_bf16 v[16:31], a[208:211], v[120:123], v[16:31]
    v_mfma_f32_32x32x16_bf16 v[32:47], a[212:215], v[120:123], v[32:47]
    s_waitcnt lgkmcnt(15)
    s_add_u32 m0, s70, 12288
    s_mul_i32 s73, s49, 64
    s_add_u32 s73, s73, 131072
    buffer_load_dwordx4 v214, s[24:27], s73 offen lds
    s_add_u32 m0, s70, 13312
    s_mul_i32 s73, s49, 64
    s_add_u32 s73, s73, 163840
    buffer_load_dwordx4 v214, s[24:27], s73 offen lds
    s_add_u32 s56, s71, s99
    buffer_load_dwordx4 v[160:163], v5, s[40:43], s56 offen offset:0 sc1
    s_waitcnt vmcnt(11)
    v_mfma_f32_32x32x16_bf16 v[16:31], a[216:219], v[124:127], v[16:31]
    v_mfma_f32_32x32x16_bf16 v[32:47], a[220:223], v[124:127], v[32:47]
    s_add_u32 m0, s70, 14336
    s_mul_i32 s73, s49, 64
    s_add_u32 s73, s73, 196608
    buffer_load_dwordx4 v214, s[24:27], s73 offen lds
    s_add_u32 m0, s70, 15360
    s_mul_i32 s73, s49, 64
    s_add_u32 s73, s73, 229376
    buffer_load_dwordx4 v214, s[24:27], s73 offen lds
    buffer_load_dwordx4 v[164:167], v5, s[40:43], s56 offen offset:1024 sc1
    s_waitcnt vmcnt(13)
    v_mfma_f32_32x32x16_bf16 v[16:31], a[224:227], v[128:131], v[16:31]
    v_mfma_f32_32x32x16_bf16 v[32:47], a[228:231], v[128:131], v[32:47]
    s_waitcnt lgkmcnt(12)
    s_add_u32 m0, s70, 16384
    s_mul_i32 s73, s50, 64
    s_add_u32 s73, s73, 0
    buffer_load_dwordx4 v214, s[24:27], s73 offen lds
    s_add_u32 m0, s70, 17408
    s_mul_i32 s73, s50, 64
    s_add_u32 s73, s73, 32768
    buffer_load_dwordx4 v214, s[24:27], s73 offen lds
    buffer_load_dwordx4 v[168:171], v5, s[40:43], s56 offen offset:2048 sc1
    s_waitcnt vmcnt(15)
    v_mfma_f32_32x32x16_bf16 v[16:31], a[232:235], v[132:135], v[16:31]
    v_mfma_f32_32x32x16_bf16 v[32:47], a[236:239], v[132:135], v[32:47]
    s_waitcnt lgkmcnt(8)
    s_add_u32 m0, s70, 18432
    s_mul_i32 s73, s50, 64
    s_add_u32 s73, s73, 65536
    buffer_load_dwordx4 v214, s[24:27], s73 offen lds
    s_add_u32 m0, s70, 19456
    s_mul_i32 s73, s50, 64
    s_add_u32 s73, s73, 98304
    buffer_load_dwordx4 v214, s[24:27], s73 offen lds
    buffer_load_dwordx4 v[172:175], v5, s[40:43], s56 offen offset:3072 sc1
    s_waitcnt vmcnt(17)
    v_mfma_f32_32x32x16_bf16 v[16:31], a[240:243], v[136:139], v[16:31]
    v_mfma_f32_32x32x16_bf16 v[32:47], a[244:247], v[136:139], v[32:47]
    s_waitcnt lgkmcnt(4)
    s_add_u32 m0, s70, 20480
    s_mul_i32 s73, s50, 64
    s_add_u32 s73, s73, 131072
    buffer_load_dwordx4 v214, s[24:27], s73 offen lds
    s_add_u32 m0, s70, 21504
    s_mul_i32 s73, s50, 64
    s_add_u32 s73, s73, 163840
    buffer_load_dwordx4 v214, s[24:27], s73 offen lds
    s_add_u32 s56, s71, s100
    buffer_load_dwordx4 v[176:179], v5, s[40:43], s56 offen offset:0 sc1
    s_waitcnt vmcnt(19)
    v_mfma_f32_32x32x16_bf16 v[16:31], a[248:251], v[140:143], v[16:31]
    v_mfma_f32_32x32x16_bf16 v[32:47], a[252:255], v[140:143], v[32:47]
    s_waitcnt lgkmcnt(0)
    s_add_u32 m0, s70, 22528
    s_mul_i32 s73, s50, 64
    s_add_u32 s73, s73, 196608
    buffer_load_dwordx4 v214, s[24:27], s73 offen lds
    s_add_u32 m0, s70, 23552
    s_mul_i32 s73, s50, 64
    s_add_u32 s73, s73, 229376
    buffer_load_dwordx4 v214, s[24:27], s73 offen lds
    buffer_load_dwordx4 v[180:183], v5, s[40:43], s56 offen offset:1024 sc1
    s_waitcnt vmcnt(21)
    v_mfma_f32_32x32x16_bf16 v[16:31], a[0:3], v[144:147], v[16:31]
    v_mfma_f32_32x32x16_bf16 v[32:47], a[4:7], v[144:147], v[32:47]
    s_barrier
    buffer_load_dwordx4 v[184:187], v5, s[40:43], s56 offen offset:2048 sc1
    s_waitcnt vmcnt(21)
    v_mfma_f32_32x32x16_bf16 v[16:31], a[8:11], v[148:151], v[16:31]
    v_mfma_f32_32x32x16_bf16 v[32:47], a[12:15], v[148:151], v[32:47]
    buffer_load_dwordx4 v[188:191], v5, s[40:43], s56 offen offset:3072 sc1
    s_waitcnt vmcnt(21)
    v_mfma_f32_32x32x16_bf16 v[16:31], a[16:19], v[152:155], v[16:31]
    v_mfma_f32_32x32x16_bf16 v[32:47], a[20:23], v[152:155], v[32:47]
    s_add_u32 s56, s71, s101
    buffer_load_dwordx4 v[192:195], v5, s[40:43], s56 offen offset:0 sc1
    s_waitcnt vmcnt(21)
    v_mfma_f32_32x32x16_bf16 v[16:31], a[24:27], v[156:159], v[16:31]
    v_mfma_f32_32x32x16_bf16 v[32:47], a[28:31], v[156:159], v[32:47]
    buffer_load_dwordx4 v[196:199], v5, s[40:43], s56 offen offset:1024 sc1
    s_waitcnt vmcnt(19)
    v_mfma_f32_32x32x16_bf16 v[16:31], a[32:35], v[160:163], v[16:31]
    v_mfma_f32_32x32x16_bf16 v[32:47], a[36:39], v[160:163], v[32:47]
    v_lshlrev_b32 v48, 16, v220
    v_and_b32 v49, s91, v220
    v_lshlrev_b32 v50, 16, v221
    v_and_b32 v51, s91, v221
    buffer_load_dwordx4 v[200:203], v5, s[40:43], s56 offen offset:2048 sc1
    s_waitcnt vmcnt(17)
    v_mfma_f32_32x32x16_bf16 v[16:31], a[40:43], v[164:167], v[16:31]
    v_mfma_f32_32x32x16_bf16 v[32:47], a[44:47], v[164:167], v[32:47]
    v_lshlrev_b32 v52, 16, v222
    v_and_b32 v53, s91, v222
    v_lshlrev_b32_e64 v54, 16, v223
    v_and_b32 v55, s91, v223
    buffer_load_dwordx4 v[204:207], v5, s[40:43], s56 offen offset:3072 sc1
    s_waitcnt vmcnt(15)
    v_mfma_f32_32x32x16_bf16 v[16:31], a[48:51], v[168:171], v[16:31]
    v_mfma_f32_32x32x16_bf16 v[32:47], a[52:55], v[168:171], v[32:47]
    v_mov_b64 v[56:57], 0
    v_mov_b64 v[58:59], 0
    v_mov_b64 v[60:61], 0
    v_mov_b64 v[62:63], 0
    s_add_u32 s56, s72, s94
    buffer_load_dwordx4 v[80:83], v5, s[40:43], s56 offen offset:0 sc1
    s_waitcnt vmcnt(13)
    v_mfma_f32_32x32x16_bf16 v[16:31], a[56:59], v[172:175], v[16:31]
    v_mfma_f32_32x32x16_bf16 v[32:47], a[60:63], v[172:175], v[32:47]
    buffer_load_dwordx4 v[84:87], v5, s[40:43], s56 offen offset:1024 sc1
    s_waitcnt vmcnt(11)
    v_mfma_f32_32x32x16_bf16 v[16:31], a[64:67], v[176:179], v[16:31]
    v_mfma_f32_32x32x16_bf16 v[32:47], a[68:71], v[176:179], v[32:47]
    buffer_load_dwordx4 v[88:91], v5, s[40:43], s56 offen offset:2048 sc1
    s_waitcnt vmcnt(9)
    v_mfma_f32_32x32x16_bf16 v[16:31], a[72:75], v[180:183], v[16:31]
    v_mfma_f32_32x32x16_bf16 v[32:47], a[76:79], v[180:183], v[32:47]
    buffer_load_dwordx4 v[92:95], v5, s[40:43], s56 offen offset:3072 sc1
    s_waitcnt vmcnt(9)
    v_mfma_f32_32x32x16_bf16 v[16:31], a[80:83], v[184:187], v[16:31]
    v_mfma_f32_32x32x16_bf16 v[32:47], a[84:87], v[184:187], v[32:47]
    s_add_u32 s56, s72, s95
    buffer_load_dwordx4 v[96:99], v5, s[40:43], s56 offen offset:0 sc1
    s_waitcnt vmcnt(9)
    v_mfma_f32_32x32x16_bf16 v[16:31], a[88:91], v[188:191], v[16:31]
    v_mfma_f32_32x32x16_bf16 v[32:47], a[92:95], v[188:191], v[32:47]
    buffer_load_dwordx4 v[100:103], v5, s[40:43], s56 offen offset:1024 sc1
    s_waitcnt vmcnt(9)
    v_mfma_f32_32x32x16_bf16 v[16:31], a[96:99], v[192:195], v[16:31]
    v_mfma_f32_32x32x16_bf16 v[32:47], a[100:103], v[192:195], v[32:47]
    buffer_load_dwordx4 v[104:107], v5, s[40:43], s56 offen offset:2048 sc1
    s_waitcnt vmcnt(9)
    v_mfma_f32_32x32x16_bf16 v[16:31], a[104:107], v[196:199], v[16:31]
    v_mfma_f32_32x32x16_bf16 v[32:47], a[108:111], v[196:199], v[32:47]
    buffer_load_dwordx4 v[108:111], v5, s[40:43], s56 offen offset:3072 sc1
    s_waitcnt vmcnt(9)
    v_mfma_f32_32x32x16_bf16 v[16:31], a[112:115], v[200:203], v[16:31]
    v_mfma_f32_32x32x16_bf16 v[32:47], a[116:119], v[200:203], v[32:47]
    s_add_u32 s56, s72, s96
    buffer_load_dwordx4 v[112:115], v5, s[40:43], s56 offen offset:0 sc1
    s_waitcnt vmcnt(9)
    v_mfma_f32_32x32x16_bf16 v[16:31], a[120:123], v[204:207], v[16:31]
    v_mfma_f32_32x32x16_bf16 v[32:47], a[124:127], v[204:207], v[32:47]
    buffer_load_dwordx4 v[116:119], v5, s[40:43], s56 offen offset:1024 sc1
    s_waitcnt vmcnt(9)
    v_mfma_f32_32x32x16_bf16 v[48:63], a[128:131], v[80:83], v[48:63]
    v_mfma_f32_32x32x16_bf16 v[64:79], a[132:135], v[80:83], 0
    s_nop 7
    ds_write_b128 v235, v[40:43] offset:0
    ds_write_b128 v235, v[44:47] offset:1024
    ds_write_b128 v234, v[32:35] offset:0
    buffer_load_dwordx4 v[120:123], v5, s[40:43], s56 offen offset:2048 sc1
    s_waitcnt vmcnt(9)
    v_mfma_f32_32x32x16_bf16 v[48:63], a[136:139], v[84:87], v[48:63]
    v_mfma_f32_32x32x16_bf16 v[64:79], a[140:143], v[84:87], v[64:79]
    ds_write_b128 v234, v[36:39] offset:1024
    ds_write_b128 v233, v[24:27] offset:0
    ds_write_b128 v233, v[28:31] offset:1024
    buffer_load_dwordx4 v[124:127], v5, s[40:43], s56 offen offset:3072 sc1
    s_waitcnt vmcnt(9)
    v_mfma_f32_32x32x16_bf16 v[48:63], a[144:147], v[88:91], v[48:63]
    v_mfma_f32_32x32x16_bf16 v[64:79], a[148:151], v[88:91], v[64:79]
    s_waitcnt lgkmcnt(0)
    s_barrier
    ds_read_b128 v[24:27], v232 offset:0
    ds_read_b128 v[32:35], v232 offset:2048
    ds_read_b128 v[40:43], v232 offset:4096
    ds_read_b128 v[28:31], v232 offset:1024
    ds_read_b128 v[36:39], v232 offset:3072
    ds_read_b128 v[44:47], v232 offset:5120
    s_add_u32 s56, s72, s97
    buffer_load_dwordx4 v[128:131], v5, s[40:43], s56 offen offset:0 sc1
    s_waitcnt vmcnt(9)
    v_mfma_f32_32x32x16_bf16 v[48:63], a[152:155], v[92:95], v[48:63]
    v_mfma_f32_32x32x16_bf16 v[64:79], a[156:159], v[92:95], v[64:79]
    buffer_load_dwordx4 v[132:135], v5, s[40:43], s56 offen offset:1024 sc1
    s_waitcnt vmcnt(9)
    v_mfma_f32_32x32x16_bf16 v[48:63], a[160:163], v[96:99], v[48:63]
    v_mfma_f32_32x32x16_bf16 v[64:79], a[164:167], v[96:99], v[64:79]
    v_mov_b32 v211, s88
    s_waitcnt lgkmcnt(4)
    v_add_f32 v24, v24, v32
    s_waitcnt lgkmcnt(3)
    v_add_f32 v16, v16, v40
    v_add_f32 v25, v25, v33
    v_add_f32 v17, v17, v41
    v_add_f32 v26, v26, v34
    v_add_f32 v18, v18, v42
    v_add_f32 v27, v27, v35
    v_add_f32 v19, v19, v43
    s_waitcnt lgkmcnt(1)
    v_add_f32 v28, v28, v36
    s_waitcnt lgkmcnt(0)
    v_add_f32 v20, v20, v44
    v_add_f32 v29, v29, v37
    v_add_f32 v21, v21, v45
    v_add_f32 v30, v30, v38
    v_add_f32 v22, v22, v46
    v_add_f32 v31, v31, v39
    buffer_load_dwordx4 v[136:139], v5, s[40:43], s56 offen offset:2048 sc1
    s_waitcnt vmcnt(9)
    v_mfma_f32_32x32x16_bf16 v[48:63], a[168:171], v[100:103], v[48:63]
    v_mfma_f32_32x32x16_bf16 v[64:79], a[172:175], v[100:103], v[64:79]
    v_add_f32 v23, v23, v47
    v_add_f32 v16, v16, v24
    v_add_f32 v17, v17, v25
    v_add_f32 v18, v18, v26
    v_add_f32 v19, v19, v27
    v_add_f32 v20, v20, v28
    v_add_f32 v21, v21, v29
    v_add_f32 v22, v22, v30
    v_add_f32 v23, v23, v31
    v_mul_f32 v24, v16, v16
    v_mul_f32 v25, v17, v17
    v_mul_f32 v26, v18, v18
    v_mul_f32 v27, v19, v19
    v_mul_f32 v28, v20, v20
    v_mul_f32_e64 v29, v21, v21
    v_mul_f32 v30, v22, v22
    buffer_load_dwordx4 v[140:143], v5, s[40:43], s56 offen offset:3072 sc1
    s_waitcnt vmcnt(9)
    v_mfma_f32_32x32x16_bf16 v[48:63], a[176:179], v[104:107], v[48:63]
    v_mfma_f32_32x32x16_bf16 v[64:79], a[180:183], v[104:107], v[64:79]
    v_mul_f32_e64 v31, v23, v23
    v_fma_f32 v24, v24, s90, v211
    v_fma_f32 v25, v25, s90, v211
    v_fma_f32 v26, v26, s90, v211
    v_fma_f32 v27, v27, s90, v211
    v_fma_f32 v28, v28, s90, v211
    v_fma_f32 v29, v29, s90, v211
    v_fma_f32 v30, v30, s90, v211
    v_fma_f32 v31, v31, s90, v211
    v_mul_f32 v24, v24, v16
    v_mul_f32 v25, v25, v17
    v_mul_f32 v26, v26, v18
    v_mul_f32 v27, v27, v19
    v_mul_f32 v28, v28, v20
    v_mul_f32 v29, v29, v21
    v_mul_f32_e64 v30, v30, v22
    s_add_u32 s56, s72, s98
    buffer_load_dwordx4 v[144:147], v5, s[40:43], s56 offen offset:0 sc1
    s_waitcnt vmcnt(9)
    v_mfma_f32_32x32x16_bf16 v[48:63], a[184:187], v[108:111], v[48:63]
    v_mfma_f32_32x32x16_bf16 v[64:79], a[188:191], v[108:111], v[64:79]
    v_mul_f32 v31, v31, v23
    v_exp_f32 v24, v24
    v_exp_f32 v25, v25
    v_exp_f32 v26, v26
    v_exp_f32 v27, v27
    v_exp_f32 v28, v28
    v_exp_f32 v29, v29
    v_exp_f32 v30, v30
    v_exp_f32 v31, v31
    v_add_f32 v24, 1.0, v24
    v_add_f32 v25, 1.0, v25
    v_add_f32 v26, 1.0, v26
    v_add_f32 v27, 1.0, v27
    v_add_f32 v28, 1.0, v28
    v_add_f32 v29, 1.0, v29
    v_add_f32 v30, 1.0, v30
    ds_read_b64_tr_b16 a[128:129], v217 offset:24576
    ds_read_b64_tr_b16 a[130:131], v217 offset:25600
    ds_read_b64_tr_b16 a[132:133], v218 offset:24576
    ds_read_b64_tr_b16 a[134:135], v218 offset:25600
    ds_read_b64_tr_b16 a[136:137], v217 offset:26624
    ds_read_b64_tr_b16 a[138:139], v217 offset:27648
    ds_read_b64_tr_b16 a[140:141], v218 offset:26624
    ds_read_b64_tr_b16 a[142:143], v218 offset:27648
    buffer_load_dwordx4 v[148:151], v5, s[40:43], s56 offen offset:1024 sc1
    s_waitcnt vmcnt(9)
    v_mfma_f32_32x32x16_bf16 v[48:63], a[192:195], v[112:115], v[48:63]
    v_mfma_f32_32x32x16_bf16 v[64:79], a[196:199], v[112:115], v[64:79]
    v_add_f32 v31, 1.0, v31
    v_rcp_f32 v24, v24
    v_rcp_f32 v25, v25
    v_rcp_f32 v26, v26
    v_rcp_f32 v27, v27
    v_rcp_f32 v28, v28
    v_rcp_f32 v29, v29
    v_rcp_f32 v30, v30
    v_rcp_f32 v31, v31
    v_mul_f32 v24, v24, v16
    v_mul_f32 v25, v25, v17
    v_mul_f32 v26, v26, v18
    v_mul_f32 v27, v27, v19
    v_mul_f32 v28, v28, v20
    v_mul_f32 v29, v29, v21
    v_mul_f32_e64 v30, v30, v22
    ds_read_b64_tr_b16 a[144:145], v217 offset:28672
    ds_read_b64_tr_b16 a[146:147], v217 offset:29696
    ds_read_b64_tr_b16 a[148:149], v218 offset:28672
    ds_read_b64_tr_b16 a[150:151], v218 offset:29696
    ds_read_b64_tr_b16 a[152:153], v217 offset:30720
    ds_read_b64_tr_b16 a[154:155], v217 offset:31744
    ds_read_b64_tr_b16 a[156:157], v218 offset:30720
    ds_read_b64_tr_b16 a[158:159], v218 offset:31744
    buffer_load_dwordx4 v[152:155], v5, s[40:43], s56 offen offset:2048 sc1
    s_waitcnt vmcnt(9)
    v_mfma_f32_32x32x16_bf16 v[48:63], a[200:203], v[116:119], v[48:63]
    v_mfma_f32_32x32x16_bf16 v[64:79], a[204:207], v[116:119], v[64:79]
    v_mul_f32 v31, v31, v23
    v_cvt_pk_bf16_f32 v32, v24, v25
    v_cvt_pk_bf16_f32 v33, v26, v27
    v_cvt_pk_bf16_f32 v34, v28, v29
    v_cvt_pk_bf16_f32 v35, v30, v31
    buffer_store_dwordx4 v[32:35], v5, s[40:43], s57 offen sc1
    ds_read_b64_tr_b16 a[160:161], v217 offset:32768
    ds_read_b64_tr_b16 a[162:163], v217 offset:33792
    ds_read_b64_tr_b16 a[164:165], v218 offset:32768
    ds_read_b64_tr_b16 a[166:167], v218 offset:33792
    ds_read_b64_tr_b16 a[168:169], v217 offset:34816
    ds_read_b64_tr_b16 a[170:171], v217 offset:35840
    ds_read_b64_tr_b16 a[172:173], v218 offset:34816
    ds_read_b64_tr_b16 a[174:175], v218 offset:35840
    buffer_load_dwordx4 v[156:159], v5, s[40:43], s56 offen offset:3072 sc1
    s_waitcnt vmcnt(10)
    v_mfma_f32_32x32x16_bf16 v[48:63], a[208:211], v[120:123], v[48:63]
    v_mfma_f32_32x32x16_bf16 v[64:79], a[212:215], v[120:123], v[64:79]
    ds_read_b64_tr_b16 a[176:177], v217 offset:12288
    ds_read_b64_tr_b16 a[178:179], v217 offset:13312
    ds_read_b64_tr_b16 a[180:181], v218 offset:12288
    ds_read_b64_tr_b16 a[182:183], v218 offset:13312
    ds_read_b64_tr_b16 a[184:185], v217 offset:14336
    ds_read_b64_tr_b16 a[186:187], v217 offset:15360
    ds_read_b64_tr_b16 a[188:189], v218 offset:14336
    ds_read_b64_tr_b16 a[190:191], v218 offset:15360
    s_and_b32 s60, s3, 1
    s_cmp_eq_u32 s60, 0
    s_cselect_b32 s60, 1.0, 0
    v_lshlrev_b32 v16, 16, v224
    v_and_b32 v17, s91, v224
    v_lshlrev_b32 v208, 16, v240
    v_and_b32 v209, s91, v240
    v_add_f32_e64 v16, v16, v208
    s_add_u32 s56, s72, s99
    buffer_load_dwordx4 v[160:163], v5, s[40:43], s56 offen offset:0 sc1
    s_waitcnt vmcnt(10)
    v_mfma_f32_32x32x16_bf16 v[48:63], a[216:219], v[124:127], v[48:63]
    v_mfma_f32_32x32x16_bf16 v[64:79], a[220:223], v[124:127], v[64:79]
    ds_read_b64_tr_b16 a[192:193], v217 offset:16384
    ds_read_b64_tr_b16 a[194:195], v217 offset:17408
    ds_read_b64_tr_b16 a[196:197], v218 offset:16384
    ds_read_b64_tr_b16 a[198:199], v218 offset:17408
    ds_read_b64_tr_b16 a[200:201], v217 offset:18432
    ds_read_b64_tr_b16 a[202:203], v217 offset:19456
    ds_read_b64_tr_b16 a[204:205], v218 offset:18432
    ds_read_b64_tr_b16 a[206:207], v218 offset:19456
    v_add_f32 v17, v17, v209
    v_mul_f32 v16, s60, v16
    v_mul_f32 v17, s60, v17
    v_lshlrev_b32 v18, 16, v225
    v_and_b32_e64 v19, s91, v225
    v_lshlrev_b32 v210, 16, v241
    buffer_load_dwordx4 v[164:167], v5, s[40:43], s56 offen offset:1024 sc1
    s_waitcnt vmcnt(10)
    v_mfma_f32_32x32x16_bf16 v[48:63], a[224:227], v[128:131], v[48:63]
    v_mfma_f32_32x32x16_bf16 v[64:79], a[228:231], v[128:131], v[64:79]
    ds_read_b64_tr_b16 a[208:209], v217 offset:20480
    ds_read_b64_tr_b16 a[210:211], v217 offset:21504
    ds_read_b64_tr_b16 a[212:213], v218 offset:20480
    ds_read_b64_tr_b16 a[214:215], v218 offset:21504
    ds_read_b64_tr_b16 a[216:217], v217 offset:22528
    ds_read_b64_tr_b16 a[218:219], v217 offset:23552
    ds_read_b64_tr_b16 a[220:221], v218 offset:22528
    ds_read_b64_tr_b16 a[222:223], v218 offset:23552
    s_waitcnt lgkmcnt(15)
    s_add_u32 m0, s70, 24576
    s_mul_i32 s73, s51, 64
    s_add_u32 s73, s73, 0
    buffer_load_dwordx4 v214, s[24:27], s73 offen lds
    s_add_u32 m0, s70, 25600
    s_mul_i32 s73, s51, 64
    s_add_u32 s73, s73, 32768
    buffer_load_dwordx4 v214, s[24:27], s73 offen lds
    v_and_b32 v211, s91, v241
    v_add_f32 v18, v18, v210
    v_add_f32 v19, v19, v211
    v_mul_f32 v18, s60, v18
    v_mul_f32 v19, s60, v19
    v_lshlrev_b32 v20, 16, v226
    buffer_load_dwordx4 v[168:171], v5, s[40:43], s56 offen offset:2048 sc1
    s_waitcnt vmcnt(12)
    v_mfma_f32_32x32x16_bf16 v[48:63], a[232:235], v[132:135], v[48:63]
    v_mfma_f32_32x32x16_bf16 v[64:79], a[236:239], v[132:135], v[64:79]
    s_waitcnt vmcnt(6)
    v_mov_b32 v8, s4
    s_mov_b64 exec, 1
    buffer_store_dword v8, v9, s[40:43], s82 offen sc1
    s_mov_b64 exec, -1
    s_add_u32 m0, s70, 26624
    s_mul_i32 s73, s51, 64
    s_add_u32 s73, s73, 65536
    buffer_load_dwordx4 v214, s[24:27], s73 offen lds
    s_add_u32 m0, s70, 27648
    s_mul_i32 s73, s51, 64
    s_add_u32 s73, s73, 98304
    buffer_load_dwordx4 v214, s[24:27], s73 offen lds
    v_and_b32 v21, s91, v226
    v_lshlrev_b32 v208, 16, v242
    v_and_b32 v209, s91, v242
    v_add_f32 v20, v20, v208
    v_add_f32 v21, v21, v209
    v_mul_f32_e64 v20, s60, v20
    buffer_load_dwordx4 v[172:175], v5, s[40:43], s56 offen offset:3072 sc1
    v_mfma_f32_32x32x16_bf16 v[48:63], a[240:243], v[136:139], v[48:63]
    v_mfma_f32_32x32x16_bf16 v[64:79], a[244:247], v[136:139], v[64:79]
    s_add_u32 m0, s70, 28672
    s_mul_i32 s73, s51, 64
    s_add_u32 s73, s73, 131072
    buffer_load_dwordx4 v214, s[24:27], s73 offen lds
    s_add_u32 m0, s70, 29696
    s_mul_i32 s73, s51, 64
    s_add_u32 s73, s73, 163840
    buffer_load_dwordx4 v214, s[24:27], s73 offen lds
    v_mul_f32 v21, s60, v21
    v_lshlrev_b32 v22, 16, v227
    v_and_b32 v23, s91, v227
    v_lshlrev_b32 v210, 16, v243
    v_and_b32_e64 v211, s91, v243
    v_add_f32 v22, v22, v210
    s_add_u32 s56, s72, s100
    buffer_load_dwordx4 v[176:179], v5, s[40:43], s56 offen offset:0 sc1
    v_mfma_f32_32x32x16_bf16 v[48:63], a[248:251], v[140:143], v[48:63]
    v_mfma_f32_32x32x16_bf16 v[64:79], a[252:255], v[140:143], v[64:79]
    s_add_u32 m0, s70, 30720
    s_mul_i32 s73, s51, 64
    s_add_u32 s73, s73, 196608
    buffer_load_dwordx4 v214, s[24:27], s73 offen lds
    s_add_u32 m0, s70, 31744
    s_mul_i32 s73, s51, 64
    s_add_u32 s73, s73, 229376
    buffer_load_dwordx4 v214, s[24:27], s73 offen lds
    v_add_f32 v23, v23, v211
    v_mul_f32 v22, s60, v22
    v_mul_f32 v23, s60, v23
    v_lshlrev_b32 v24, 16, v228
    v_and_b32 v25, s91, v228
    v_lshlrev_b32 v208, 16, v244
    buffer_load_dwordx4 v[180:183], v5, s[40:43], s56 offen offset:1024 sc1
    v_mfma_f32_32x32x16_bf16 v[48:63], a[0:3], v[144:147], v[48:63]
    v_mfma_f32_32x32x16_bf16 v[64:79], a[4:7], v[144:147], v[64:79]
    s_add_u32 m0, s70, 32768
    s_mul_i32 s73, s52, 64
    s_add_u32 s73, s73, 0
    buffer_load_dwordx4 v214, s[24:27], s73 offen lds
    s_add_u32 m0, s70, 33792
    s_mul_i32 s73, s52, 64
    s_add_u32 s73, s73, 32768
    buffer_load_dwordx4 v214, s[24:27], s73 offen lds
    v_and_b32 v209, s91, v244
    v_add_f32 v24, v24, v208
    v_add_f32 v25, v25, v209
    v_mul_f32 v24, s60, v24
    v_mul_f32 v25, s60, v25
    v_lshlrev_b32_e64 v26, 16, v229
    buffer_load_dwordx4 v[184:187], v5, s[40:43], s56 offen offset:2048 sc1
    v_mfma_f32_32x32x16_bf16 v[48:63], a[8:11], v[148:151], v[48:63]
    v_mfma_f32_32x32x16_bf16 v[64:79], a[12:15], v[148:151], v[64:79]
    s_add_u32 m0, s70, 34816
    s_mul_i32 s73, s52, 64
    s_add_u32 s73, s73, 65536
    buffer_load_dwordx4 v214, s[24:27], s73 offen lds
    s_add_u32 m0, s70, 35840
    s_mul_i32 s73, s52, 64
    s_add_u32 s73, s73, 98304
    buffer_load_dwordx4 v214, s[24:27], s73 offen lds
    v_and_b32 v27, s91, v229
    v_lshlrev_b32 v210, 16, v245
    v_and_b32 v211, s91, v245
    v_add_f32 v26, v26, v210
    v_add_f32 v27, v27, v211
    v_mul_f32 v26, s60, v26
    buffer_load_dwordx4 v[188:191], v5, s[40:43], s56 offen offset:3072 sc1
    v_mfma_f32_32x32x16_bf16 v[48:63], a[16:19], v[152:155], v[48:63]
    v_mfma_f32_32x32x16_bf16 v[64:79], a[20:23], v[152:155], v[64:79]
    s_add_u32 m0, s70, 12288
    s_mul_i32 s73, s52, 64
    s_add_u32 s73, s73, 131072
    buffer_load_dwordx4 v214, s[24:27], s73 offen lds
    s_add_u32 m0, s70, 13312
    s_mul_i32 s73, s52, 64
    s_add_u32 s73, s73, 163840
    buffer_load_dwordx4 v214, s[24:27], s73 offen lds
    v_mul_f32 v27, s60, v27
    v_lshlrev_b32 v28, 16, v230
    v_and_b32 v29, s91, v230
    v_lshlrev_b32 v208, 16, v246
    v_and_b32 v209, s91, v246
    v_add_f32 v28, v28, v208
    buffer_load_dword v248, v12, s[40:43], s85 offen offset:0 sc1
    s_add_u32 s56, s72, s101
    buffer_load_dwordx4 v[192:195], v5, s[40:43], s56 offen offset:0 sc1
    s_waitcnt vmcnt(25)
    v_mfma_f32_32x32x16_bf16 v[48:63], a[24:27], v[156:159], v[48:63]
    v_mfma_f32_32x32x16_bf16 v[64:79], a[28:31], v[156:159], v[64:79]
    s_add_u32 m0, s70, 14336
    s_mul_i32 s73, s52, 64
    s_add_u32 s73, s73, 196608
    buffer_load_dwordx4 v214, s[24:27], s73 offen lds
    s_add_u32 m0, s70, 15360
    s_mul_i32 s73, s52, 64
    s_add_u32 s73, s73, 229376
    buffer_load_dwordx4 v214, s[24:27], s73 offen lds
    v_add_f32 v29, v29, v209
    v_mul_f32 v28, s60, v28
    v_mul_f32 v29, s60, v29
    v_lshlrev_b32 v30, 16, v231
    v_and_b32 v31, s91, v231
    v_lshlrev_b32 v210, 16, v247
    buffer_load_dwordx4 v[196:199], v5, s[40:43], s56 offen offset:1024 sc1
    s_waitcnt vmcnt(27)
    v_mfma_f32_32x32x16_bf16 v[48:63], a[32:35], v[160:163], v[48:63]
    v_mfma_f32_32x32x16_bf16 v[64:79], a[36:39], v[160:163], v[64:79]
    s_waitcnt vmcnt(24)
    ds_read_b64_tr_b16 a[224:225], v217 offset:24576
    ds_read_b64_tr_b16 a[226:227], v217 offset:25600
    ds_read_b64_tr_b16 a[228:229], v218 offset:24576
    ds_read_b64_tr_b16 a[230:231], v218 offset:25600
    v_and_b32 v211, s91, v247
    v_add_f32 v30, v30, v210
    v_add_f32 v31, v31, v211
    v_mul_f32 v30, s60, v30
    v_mul_f32 v31, s60, v31
    buffer_load_dwordx4 v[200:203], v5, s[40:43], s56 offen offset:2048 sc1
    v_mfma_f32_32x32x16_bf16 v[48:63], a[40:43], v[164:167], v[48:63]
    v_mfma_f32_32x32x16_bf16 v[64:79], a[44:47], v[164:167], v[64:79]
    s_waitcnt vmcnt(21)
    ds_read_b64_tr_b16 a[232:233], v217 offset:26624
    ds_read_b64_tr_b16 a[234:235], v217 offset:27648
    ds_read_b64_tr_b16 a[236:237], v218 offset:26624
    ds_read_b64_tr_b16 a[238:239], v218 offset:27648
    buffer_load_dwordx4 v[204:207], v5, s[40:43], s56 offen offset:3072 sc1
    v_mfma_f32_32x32x16_bf16 v[48:63], a[48:51], v[168:171], v[48:63]
    v_mfma_f32_32x32x16_bf16 v[64:79], a[52:55], v[168:171], v[64:79]
    s_waitcnt vmcnt(19)
    ds_read_b64_tr_b16 a[240:241], v217 offset:28672
    ds_read_b64_tr_b16 a[242:243], v217 offset:29696
    ds_read_b64_tr_b16 a[244:245], v218 offset:28672
    ds_read_b64_tr_b16 a[246:247], v218 offset:29696
    s_waitcnt vmcnt(6)
    v_cmp_ne_u32_e64 vcc, s4, v248
    s_nop 1
    s_cbranch_vccz Lpcd_P_11
    s_nop 1
Lpc_P_10:
    s_sub_u32 s6, s6, 1
    s_cbranch_scc1 L_end_P
    buffer_load_dword v248, v12, s[40:43], s85 offen offset:0 sc1
    s_waitcnt vmcnt(0)
    v_cmp_ne_u32 vcc, s4, v248
    s_nop 1
    s_cbranch_vccnz Lpc_P_10
Lpcd_P_11:
    s_add_u32 s56, s58, s48
    buffer_load_dwordx4 v[80:83], v4, s[40:43], s56 offen offset:0 sc1
    v_mfma_f32_32x32x16_bf16 v[48:63], a[56:59], v[172:175], v[48:63]
    v_mfma_f32_32x32x16_bf16 v[64:79], a[60:63], v[172:175], v[64:79]
    ds_read_b64_tr_b16 a[248:249], v217 offset:30720
    ds_read_b64_tr_b16 a[250:251], v217 offset:31744
    ds_read_b64_tr_b16 a[252:253], v218 offset:30720
    ds_read_b64_tr_b16 a[254:255], v218 offset:31744
    buffer_load_dwordx4 v[84:87], v4, s[40:43], s56 offen offset:1024 sc1
    v_mfma_f32_32x32x16_bf16 v[48:63], a[64:67], v[176:179], v[48:63]
    v_mfma_f32_32x32x16_bf16 v[64:79], a[68:71], v[176:179], v[64:79]
    ds_read_b64_tr_b16 a[0:1], v217 offset:32768
    ds_read_b64_tr_b16 a[2:3], v217 offset:33792
    ds_read_b64_tr_b16 a[4:5], v218 offset:32768
    ds_read_b64_tr_b16 a[6:7], v218 offset:33792
    buffer_load_dwordx4 v[88:91], v4, s[40:43], s56 offen offset:2048 sc1
    v_mfma_f32_32x32x16_bf16 v[48:63], a[72:75], v[180:183], v[48:63]
    v_mfma_f32_32x32x16_bf16 v[64:79], a[76:79], v[180:183], v[64:79]
    ds_read_b64_tr_b16 a[8:9], v217 offset:34816
    ds_read_b64_tr_b16 a[10:11], v217 offset:35840
    ds_read_b64_tr_b16 a[12:13], v218 offset:34816
    ds_read_b64_tr_b16 a[14:15], v218 offset:35840
    buffer_load_dwordx4 v[92:95], v4, s[40:43], s56 offen offset:3072 sc1
    v_mfma_f32_32x32x16_bf16 v[48:63], a[80:83], v[184:187], v[48:63]
    v_mfma_f32_32x32x16_bf16 v[64:79], a[84:87], v[184:187], v[64:79]
    ds_read_b64_tr_b16 a[16:17], v217 offset:12288
    ds_read_b64_tr_b16 a[18:19], v217 offset:13312
    ds_read_b64_tr_b16 a[20:21], v218 offset:12288
    ds_read_b64_tr_b16 a[22:23], v218 offset:13312
    s_add_u32 s56, s58, s49
    buffer_load_dwordx4 v[96:99], v4, s[40:43], s56 offen offset:0 sc1
    v_mfma_f32_32x32x16_bf16 v[48:63], a[88:91], v[188:191], v[48:63]
    v_mfma_f32_32x32x16_bf16 v[64:79], a[92:95], v[188:191], v[64:79]
    s_waitcnt vmcnt(8)
    ds_read_b64_tr_b16 a[24:25], v217 offset:14336
    ds_read_b64_tr_b16 a[26:27], v217 offset:15360
    ds_read_b64_tr_b16 a[28:29], v218 offset:14336
    ds_read_b64_tr_b16 a[30:31], v218 offset:15360
    buffer_load_dwordx4 v[100:103], v4, s[40:43], s56 offen offset:1024 sc1
    buffer_load_dwordx4 v[104:107], v4, s[40:43], s56 offen offset:2048 sc1
    buffer_load_dwordx4 v[108:111], v4, s[40:43], s56 offen offset:3072 sc1
    s_add_u32 s56, s58, s50
    buffer_load_dwordx4 v[112:115], v4, s[40:43], s56 offen offset:0 sc1
    v_mfma_f32_32x32x16_bf16 v[64:79], a[100:103], v[192:195], v[64:79]
    s_waitcnt vmcnt(11)
    v_mfma_f32_32x32x16_bf16 v[64:79], a[108:111], v[196:199], v[64:79]
    s_waitcnt vmcnt(10)
    v_mfma_f32_32x32x16_bf16 v[64:79], a[116:119], v[200:203], v[64:79]
    s_waitcnt vmcnt(9)
    v_mfma_f32_32x32x16_bf16 v[64:79], a[124:127], v[204:207], v[64:79]
    v_mfma_f32_32x32x16_bf16 v[48:63], a[96:99], v[192:195], v[48:63]
    v_mfma_f32_32x32x16_bf16 v[48:63], a[104:107], v[196:199], v[48:63]
    s_nop 9
    ds_write_b128 v235, v[72:75] offset:6144
    ds_write_b128 v235, v[76:79] offset:7168
    v_mfma_f32_32x32x16_bf16 v[48:63], a[112:115], v[200:203], v[48:63]
    ds_write_b128 v234, v[64:67] offset:6144
    ds_write_b128 v234, v[68:71] offset:7168
    v_mfma_f32_32x32x16_bf16 v[48:63], a[120:123], v[204:207], v[48:63]
    s_nop 11
    ds_write_b128 v233, v[56:59] offset:6144
    ds_write_b128 v233, v[60:63] offset:7168
    s_waitcnt lgkmcnt(0)
    s_barrier
    ds_read_b128 v[56:59], v232 offset:6144
    ds_read_b128 v[64:67], v232 offset:8192
    ds_read_b128 v[72:75], v232 offset:10240
    ds_read_b128 v[60:63], v232 offset:7168
    ds_read_b128 v[68:71], v232 offset:9216
    ds_read_b128 v[76:79], v232 offset:11264
    v_mov_b32_e64 v211, s88
    s_waitcnt lgkmcnt(4)
    v_pk_add_f32 v[56:57], v[56:57], v[64:65]
    s_waitcnt lgkmcnt(3)
    v_pk_add_f32 v[48:49], v[48:49], v[72:73]
    v_pk_add_f32 v[58:59], v[58:59], v[66:67]
    v_pk_add_f32 v[50:51], v[50:51], v[74:75]
    s_waitcnt lgkmcnt(1)
    v_pk_add_f32 v[60:61], v[60:61], v[68:69]
    s_waitcnt lgkmcnt(0)
    v_pk_add_f32 v[52:53], v[52:53], v[76:77]
    v_pk_add_f32 v[62:63], v[62:63], v[70:71]
    v_pk_add_f32 v[54:55], v[54:55], v[78:79]
    v_pk_add_f32 v[48:49], v[48:49], v[56:57]
    v_pk_add_f32 v[50:51], v[50:51], v[58:59]
    v_pk_add_f32 v[52:53], v[52:53], v[60:61]
    v_pk_add_f32 v[54:55], v[54:55], v[62:63]
    v_pk_mul_f32 v[56:57], v[48:49], v[48:49]
    v_pk_mul_f32 v[58:59], v[50:51], v[50:51]
    v_pk_mul_f32 v[60:61], v[52:53], v[52:53]
    v_pk_mul_f32 v[62:63], v[54:55], v[54:55]
    v_fma_f32 v56, v56, s90, v211
    v_fma_f32 v57, v57, s90, v211
    v_fma_f32 v58, v58, s90, v211
    v_fma_f32 v59, v59, s90, v211
    v_fma_f32 v60, v60, s90, v211
    v_fma_f32 v61, v61, s90, v211
    v_fma_f32 v62, v62, s90, v211
    v_fma_f32 v63, v63, s90, v211
    v_pk_mul_f32 v[56:57], v[56:57], v[48:49]
    v_pk_mul_f32 v[58:59], v[58:59], v[50:51]
    v_pk_mul_f32 v[60:61], v[60:61], v[52:53]
    v_pk_mul_f32 v[62:63], v[62:63], v[54:55]
    v_exp_f32 v56, v56
    v_exp_f32 v57, v57
    v_exp_f32 v58, v58
    v_exp_f32 v59, v59
    v_exp_f32 v60, v60
    v_exp_f32 v61, v61
    v_exp_f32 v62, v62
    v_exp_f32 v63, v63
    v_add_f32 v56, 1.0, v56
    v_add_f32 v57, 1.0, v57
    v_add_f32 v58, 1.0, v58
    v_add_f32 v59, 1.0, v59
    v_add_f32 v60, 1.0, v60
    v_add_f32 v61, 1.0, v61
    v_add_f32 v62, 1.0, v62
    v_add_f32 v63, 1.0, v63
    v_rcp_f32 v56, v56
    v_rcp_f32 v57, v57
    v_rcp_f32 v58, v58
    v_rcp_f32 v59, v59
    v_rcp_f32 v60, v60
    v_rcp_f32 v61, v61
    v_rcp_f32 v62, v62
    v_rcp_f32 v63, v63
    v_mul_f32 v56, v56, v48
    v_mul_f32 v57, v57, v49
    v_mul_f32 v58, v58, v50
    v_mul_f32 v59, v59, v51
    v_mul_f32 v60, v60, v52
    v_mul_f32 v61, v61, v53
    v_mul_f32 v62, v62, v54
    v_mul_f32 v63, v63, v55
    v_cvt_pk_bf16_f32 v64, v56, v57
    v_cvt_pk_bf16_f32 v65, v58, v59
    v_cvt_pk_bf16_f32 v66, v60, v61
    v_cvt_pk_bf16_f32 v67, v62, v63
    s_add_u32 s57, s57, 114688
    buffer_store_dwordx4 v[64:67], v5, s[40:43], s57 offen sc1
    s_add_u32 s82, s82, 4096
    s_add_u32 s85, s85, 4096
    buffer_load_dwordx4 v[116:119], v4, s[40:43], s56 offen offset:1024 sc1
    s_waitcnt vmcnt(10)
    v_mfma_f32_32x32x16_bf16 v[16:31], a[128:131], v[80:83], v[16:31]
    v_mfma_f32_32x32x16_bf16 v[32:47], a[132:135], v[80:83], 0
    s_add_u32 m0, s70, 16384
    s_mul_i32 s73, s53, 64
    s_add_u32 s73, s73, 0
    buffer_load_dwordx4 v214, s[24:27], s73 offen lds
    s_add_u32 m0, s70, 17408
    s_mul_i32 s73, s53, 64
    s_add_u32 s73, s73, 32768
    buffer_load_dwordx4 v214, s[24:27], s73 offen lds
    buffer_load_dwordx4 v[120:123], v4, s[40:43], s56 offen offset:2048 sc1
    s_waitcnt vmcnt(12)
    v_mfma_f32_32x32x16_bf16 v[16:31], a[136:139], v[84:87], v[16:31]
    v_mfma_f32_32x32x16_bf16 v[32:47], a[140:143], v[84:87], v[32:47]
    s_add_u32 m0, s70, 18432
    s_mul_i32 s73, s53, 64
    s_add_u32 s73, s73, 65536
    buffer_load_dwordx4 v214, s[24:27], s73 offen lds
    s_add_u32 m0, s70, 19456
    s_mul_i32 s73, s53, 64
    s_add_u32 s73, s73, 98304
    buffer_load_dwordx4 v214, s[24:27], s73 offen lds
    buffer_load_dwordx4 v[124:127], v4, s[40:43], s56 offen offset:3072 sc1
    s_waitcnt vmcnt(14)
    v_mfma_f32_32x32x16_bf16 v[16:31], a[144:147], v[88:91], v[16:31]
    v_mfma_f32_32x32x16_bf16 v[32:47], a[148:151], v[88:91], v[32:47]
    s_add_u32 m0, s70, 20480
    s_mul_i32 s73, s53, 64
    s_add_u32 s73, s73, 131072
    buffer_load_dwordx4 v214, s[24:27], s73 offen lds
    s_add_u32 m0, s70, 21504
    s_mul_i32 s73, s53, 64
    s_add_u32 s73, s73, 163840
    buffer_load_dwordx4 v214, s[24:27], s73 offen lds
    s_add_u32 s56, s58, s51
    buffer_load_dwordx4 v[128:131], v4, s[40:43], s56 offen offset:0 sc1
    s_waitcnt vmcnt(16)
    v_mfma_f32_32x32x16_bf16 v[16:31], a[152:155], v[92:95], v[16:31]
    v_mfma_f32_32x32x16_bf16 v[32:47], a[156:159], v[92:95], v[32:47]
    s_add_u32 m0, s70, 22528
    s_mul_i32 s73, s53, 64
    s_add_u32 s73, s73, 196608
    buffer_load_dwordx4 v214, s[24:27], s73 offen lds
    s_add_u32 m0, s70, 23552
    s_mul_i32 s73, s53, 64
    s_add_u32 s73, s73, 229376
    buffer_load_dwordx4 v214, s[24:27], s73 offen lds
    buffer_load_dwordx4 v[132:135], v4, s[40:43], s56 offen offset:1024 sc1
    s_waitcnt vmcnt(18)
    v_mfma_f32_32x32x16_bf16 v[16:31], a[160:163], v[96:99], v[16:31]
    v_mfma_f32_32x32x16_bf16 v[32:47], a[164:167], v[96:99], v[32:47]
    s_add_u32 m0, s70, 24576
    s_mul_i32 s73, s54, 64
    s_add_u32 s73, s73, 0
    buffer_load_dwordx4 v214, s[24:27], s73 offen lds
    s_add_u32 m0, s70, 25600
    s_mul_i32 s73, s54, 64
    s_add_u32 s73, s73, 32768
    buffer_load_dwordx4 v214, s[24:27], s73 offen lds
    s_waitcnt vmcnt(15)
    v_mov_b32 v8, s4
    s_mov_b64 exec, 1
    buffer_store_dword v8, v9, s[40:43], s82 offen sc1
    s_mov_b64 exec, -1
    buffer_load_dwordx4 v[136:139], v4, s[40:43], s56 offen offset:2048 sc1
    v_mfma_f32_32x32x16_bf16 v[16:31], a[168:171], v[100:103], v[16:31]
    v_mfma_f32_32x32x16_bf16 v[32:47], a[172:175], v[100:103], v[32:47]
    s_add_u32 m0, s70, 26624
    s_mul_i32 s73, s54, 64
    s_add_u32 s73, s73, 65536
    buffer_load_dwordx4 v214, s[24:27], s73 offen lds
    s_add_u32 m0, s70, 27648
    s_mul_i32 s73, s54, 64
    s_add_u32 s73, s73, 98304
    buffer_load_dwordx4 v214, s[24:27], s73 offen lds
    buffer_load_dwordx4 v[140:143], v4, s[40:43], s56 offen offset:3072 sc1
    v_mfma_f32_32x32x16_bf16 v[16:31], a[176:179], v[104:107], v[16:31]
    v_mfma_f32_32x32x16_bf16 v[32:47], a[180:183], v[104:107], v[32:47]
    s_add_u32 m0, s70, 28672
    s_mul_i32 s73, s54, 64
    s_add_u32 s73, s73, 131072
    buffer_load_dwordx4 v214, s[24:27], s73 offen lds
    s_add_u32 m0, s70, 29696
    s_mul_i32 s73, s54, 64
    s_add_u32 s73, s73, 163840
    buffer_load_dwordx4 v214, s[24:27], s73 offen lds
    s_and_b32 s60, s3, 1
    s_cmp_eq_u32 s60, 1
    s_cselect_b32 s60, 1.0, 0
    v_lshlrev_b32 v48, 16, v224
    v_and_b32 v49, s91, v224
    v_lshlrev_b32 v208, 16, v240
    v_and_b32_e64 v209, s91, v240
    v_add_f32 v48, v48, v208
    s_add_u32 s56, s58, s52
    buffer_load_dwordx4 v[144:147], v4, s[40:43], s56 offen offset:0 sc1
    v_mfma_f32_32x32x16_bf16 v[16:31], a[184:187], v[108:111], v[16:31]
    v_mfma_f32_32x32x16_bf16 v[32:47], a[188:191], v[108:111], v[32:47]
    s_add_u32 m0, s70, 30720
    s_mul_i32 s73, s54, 64
    s_add_u32 s73, s73, 196608
    buffer_load_dwordx4 v214, s[24:27], s73 offen lds
    s_add_u32 m0, s70, 31744
    s_mul_i32 s73, s54, 64
    s_add_u32 s73, s73, 229376
    buffer_load_dwordx4 v214, s[24:27], s73 offen lds
    v_add_f32 v49, v49, v209
    v_mul_f32 v48, s60, v48
    v_mul_f32 v49, s60, v49
    v_lshlrev_b32 v50, 16, v225
    v_and_b32_e64 v51, s91, v225
    v_lshlrev_b32 v210, 16, v241
    buffer_load_dwordx4 v[148:151], v4, s[40:43], s56 offen offset:1024 sc1
    v_mfma_f32_32x32x16_bf16 v[16:31], a[192:195], v[112:115], v[16:31]
    v_mfma_f32_32x32x16_bf16 v[32:47], a[196:199], v[112:115], v[32:47]
    s_waitcnt vmcnt(23)
    ds_read_b64_tr_b16 a[32:33], v217 offset:16384
    ds_read_b64_tr_b16 a[34:35], v217 offset:17408
    ds_read_b64_tr_b16 a[36:37], v218 offset:16384
    ds_read_b64_tr_b16 a[38:39], v218 offset:17408
    v_and_b32 v211, s91, v241
    v_add_f32 v50, v50, v210
    v_add_f32 v51, v51, v211
    v_mul_f32 v50, s60, v50
    v_mul_f32_e64 v51, s60, v51
    v_lshlrev_b32 v52, 16, v226
    buffer_load_dwordx4 v[152:155], v4, s[40:43], s56 offen offset:2048 sc1
    v_mfma_f32_32x32x16_bf16 v[16:31], a[200:203], v[116:119], v[16:31]
    v_mfma_f32_32x32x16_bf16 v[32:47], a[204:207], v[116:119], v[32:47]
    s_waitcnt vmcnt(21)
    ds_read_b64_tr_b16 a[40:41], v217 offset:18432
    ds_read_b64_tr_b16 a[42:43], v217 offset:19456
    ds_read_b64_tr_b16 a[44:45], v218 offset:18432
    ds_read_b64_tr_b16 a[46:47], v218 offset:19456
    v_and_b32 v53, s91, v226
    v_lshlrev_b32 v208, 16, v242
    v_and_b32 v209, s91, v242
    v_add_f32 v52, v52, v208
    v_add_f32_e64 v53, v53, v209
    v_mul_f32 v52, s60, v52
    buffer_load_dwordx4 v[156:159], v4, s[40:43], s56 offen offset:3072 sc1
    v_mfma_f32_32x32x16_bf16 v[16:31], a[208:211], v[120:123], v[16:31]
    v_mfma_f32_32x32x16_bf16 v[32:47], a[212:215], v[120:123], v[32:47]
    s_waitcnt vmcnt(19)
    ds_read_b64_tr_b16 a[48:49], v217 offset:20480
    ds_read_b64_tr_b16 a[50:51], v217 offset:21504
    ds_read_b64_tr_b16 a[52:53], v218 offset:20480
    ds_read_b64_tr_b16 a[54:55], v218 offset:21504
    v_mul_f32 v53, s60, v53
    v_lshlrev_b32 v54, 16, v227
    v_and_b32 v55, s91, v227
    v_lshlrev_b32 v210, 16, v243
    v_and_b32 v211, s91, v243
    v_add_f32 v54, v54, v210
    s_add_u32 s56, s58, s53
    buffer_load_dwordx4 v[160:163], v4, s[40:43], s56 offen offset:0 sc1
    v_mfma_f32_32x32x16_bf16 v[16:31], a[216:219], v[124:127], v[16:31]
    v_mfma_f32_32x32x16_bf16 v[32:47], a[220:223], v[124:127], v[32:47]
    s_waitcnt vmcnt(17)
    ds_read_b64_tr_b16 a[56:57], v217 offset:22528
    ds_read_b64_tr_b16 a[58:59], v217 offset:23552
    ds_read_b64_tr_b16 a[60:61], v218 offset:22528
    ds_read_b64_tr_b16 a[62:63], v218 offset:23552
    v_add_f32 v55, v55, v211
    v_mul_f32 v54, s60, v54
    v_mul_f32 v55, s60, v55
    v_lshlrev_b32 v56, 16, v228
    v_and_b32_e64 v57, s91, v228
    v_lshlrev_b32 v208, 16, v244
    buffer_load_dwordx4 v[164:167], v4, s[40:43], s56 offen offset:1024 sc1
    v_mfma_f32_32x32x16_bf16 v[16:31], a[224:227], v[128:131], v[16:31]
    v_mfma_f32_32x32x16_bf16 v[32:47], a[228:231], v[128:131], v[32:47]
    s_waitcnt vmcnt(15)
    ds_read_b64_tr_b16 a[64:65], v217 offset:24576
    ds_read_b64_tr_b16 a[66:67], v217 offset:25600
    ds_read_b64_tr_b16 a[68:69], v218 offset:24576
    ds_read_b64_tr_b16 a[70:71], v218 offset:25600
    v_and_b32 v209, s91, v244
    v_add_f32 v56, v56, v208
    v_add_f32 v57, v57, v209
    v_mul_f32 v56, s60, v56
    v_mul_f32 v57, s60, v57
    v_lshlrev_b32 v58, 16, v229
    buffer_load_dword v248, v12, s[40:43], s85 offen offset:0 sc1
    buffer_load_dwordx4 v[168:171], v4, s[40:43], s56 offen offset:2048 sc1
    v_mfma_f32_32x32x16_bf16 v[16:31], a[232:235], v[132:135], v[16:31]
    v_mfma_f32_32x32x16_bf16 v[32:47], a[236:239], v[132:135], v[32:47]
    s_waitcnt vmcnt(13)
    ds_read_b64_tr_b16 a[72:73], v217 offset:26624
    ds_read_b64_tr_b16 a[74:75], v217 offset:27648
    ds_read_b64_tr_b16 a[76:77], v218 offset:26624
    ds_read_b64_tr_b16 a[78:79], v218 offset:27648
    v_and_b32 v59, s91, v229
    v_lshlrev_b32 v210, 16, v245
    v_and_b32 v211, s91, v245
    v_add_f32 v58, v58, v210
    v_add_f32 v59, v59, v211
    v_mul_f32 v58, s60, v58
    buffer_load_dwordx4 v[172:175], v4, s[40:43], s56 offen offset:3072 sc1
    v_mfma_f32_32x32x16_bf16 v[16:31], a[240:243], v[136:139], v[16:31]
    v_mfma_f32_32x32x16_bf16 v[32:47], a[244:247], v[136:139], v[32:47]
    s_waitcnt vmcnt(11)
    ds_read_b64_tr_b16 a[80:81], v217 offset:28672
    ds_read_b64_tr_b16 a[82:83], v217 offset:29696
    ds_read_b64_tr_b16 a[84:85], v218 offset:28672
    ds_read_b64_tr_b16 a[86:87], v218 offset:29696
    v_mul_f32 v59, s60, v59
    v_lshlrev_b32 v60, 16, v230
    v_and_b32 v61, s91, v230
    v_lshlrev_b32 v208, 16, v246
    v_and_b32 v209, s91, v246
    v_add_f32 v60, v60, v208
    s_add_u32 s56, s58, s54
    buffer_load_dwordx4 v[176:179], v4, s[40:43], s56 offen offset:0 sc1
    v_mfma_f32_32x32x16_bf16 v[16:31], a[248:251], v[140:143], v[16:31]
    v_mfma_f32_32x32x16_bf16 v[32:47], a[252:255], v[140:143], v[32:47]
    s_waitcnt vmcnt(9)
    ds_read_b64_tr_b16 a[88:89], v217 offset:30720
    ds_read_b64_tr_b16 a[90:91], v217 offset:31744
    ds_read_b64_tr_b16 a[92:93], v218 offset:30720
    ds_read_b64_tr_b16 a[94:95], v218 offset:31744
    v_add_f32 v61, v61, v209
    v_mul_f32 v60, s60, v60
    v_mul_f32 v61, s60, v61
    v_lshlrev_b32 v62, 16, v231
    v_and_b32 v63, s91, v231
    v_lshlrev_b32 v210, 16, v247
    buffer_load_dwordx4 v[180:183], v4, s[40:43], s56 offen offset:1024 sc1
    v_mfma_f32_32x32x16_bf16 v[16:31], a[0:3], v[144:147], v[16:31]
    v_mfma_f32_32x32x16_bf16 v[32:47], a[4:7], v[144:147], v[32:47]
    v_and_b32 v211, s91, v247
    v_add_f32 v62, v62, v210
    v_add_f32 v63, v63, v211
    v_mul_f32 v62, s60, v62
    v_mul_f32 v63, s60, v63
    s_waitcnt vmcnt(4)
    v_cmp_ne_u32 vcc, s4, v248
    s_nop 1
    s_cbranch_vccz Lpcd_P_13
    s_nop 1
Lpc_P_12:
    s_sub_u32 s6, s6, 1
    s_cbranch_scc1 L_end_P
    buffer_load_dword v248, v12, s[40:43], s85 offen offset:0 sc1
    s_waitcnt vmcnt(0)
    v_cmp_ne_u32 vcc, s4, v248
    s_nop 1
    s_cbranch_vccnz Lpc_P_12
Lpcd_P_13:
    buffer_load_dwordx4 v[184:187], v4, s[40:43], s56 offen offset:2048 sc1
    v_mfma_f32_32x32x16_bf16 v[16:31], a[8:11], v[148:151], v[16:31]
    v_mfma_f32_32x32x16_bf16 v[32:47], a[12:15], v[148:151], v[32:47]
    buffer_load_dwordx4 v[188:191], v4, s[40:43], s56 offen offset:3072 sc1
    v_mfma_f32_32x32x16_bf16 v[16:31], a[16:19], v[152:155], v[16:31]
    v_mfma_f32_32x32x16_bf16 v[32:47], a[20:23], v[152:155], v[32:47]
    s_add_u32 s56, s59, s48
    buffer_load_dwordx4 v[192:195], v4, s[40:43], s56 offen offset:0 sc1
    v_mfma_f32_32x32x16_bf16 v[16:31], a[24:27], v[156:159], v[16:31]
    v_mfma_f32_32x32x16_bf16 v[32:47], a[28:31], v[156:159], v[32:47]
    buffer_load_dwordx4 v[196:199], v4, s[40:43], s56 offen offset:1024 sc1
    s_waitcnt lgkmcnt(15)
    v_mfma_f32_32x32x16_bf16 v[16:31], a[32:35], v[160:163], v[16:31]
    v_mfma_f32_32x32x16_bf16 v[32:47], a[36:39], v[160:163], v[32:47]
    buffer_load_dwordx4 v[200:203], v4, s[40:43], s56 offen offset:2048 sc1
    v_mfma_f32_32x32x16_bf16 v[16:31], a[40:43], v[164:167], v[16:31]
    v_mfma_f32_32x32x16_bf16 v[32:47], a[44:47], v[164:167], v[32:47]
    buffer_load_dwordx4 v[204:207], v4, s[40:43], s56 offen offset:3072 sc1
    s_waitcnt vmcnt(9)
    v_mfma_f32_32x32x16_bf16 v[16:31], a[48:51], v[168:171], v[16:31]
    v_mfma_f32_32x32x16_bf16 v[32:47], a[52:55], v[168:171], v[32:47]
    s_add_u32 s56, s59, s49
    buffer_load_dwordx4 v[80:83], v4, s[40:43], s56 offen offset:0 sc1
    s_waitcnt vmcnt(9)
    v_mfma_f32_32x32x16_bf16 v[16:31], a[56:59], v[172:175], v[16:31]
    v_mfma_f32_32x32x16_bf16 v[32:47], a[60:63], v[172:175], v[32:47]
    buffer_load_dwordx4 v[84:87], v4, s[40:43], s56 offen offset:1024 sc1
    s_waitcnt vmcnt(9) lgkmcnt(14)
    v_mfma_f32_32x32x16_bf16 v[16:31], a[64:67], v[176:179], v[16:31]
    s_waitcnt lgkmcnt(12)
    v_mfma_f32_32x32x16_bf16 v[32:47], a[68:71], v[176:179], v[32:47]
    buffer_load_dwordx4 v[88:91], v4, s[40:43], s56 offen offset:2048 sc1
    s_waitcnt vmcnt(9) lgkmcnt(10)
    v_mfma_f32_32x32x16_bf16 v[16:31], a[72:75], v[180:183], v[16:31]
    s_waitcnt lgkmcnt(8)
    v_mfma_f32_32x32x16_bf16 v[32:47], a[76:79], v[180:183], v[32:47]
    buffer_load_dwordx4 v[92:95], v4, s[40:43], s56 offen offset:3072 sc1
    s_waitcnt vmcnt(9) lgkmcnt(6)
    v_mfma_f32_32x32x16_bf16 v[16:31], a[80:83], v[184:187], v[16:31]
    s_waitcnt lgkmcnt(4)
    v_mfma_f32_32x32x16_bf16 v[32:47], a[84:87], v[184:187], v[32:47]
    s_add_u32 s56, s59, s50
    buffer_load_dwordx4 v[96:99], v4, s[40:43], s56 offen offset:0 sc1
    s_waitcnt vmcnt(9) lgkmcnt(2)
    v_mfma_f32_32x32x16_bf16 v[16:31], a[88:91], v[188:191], v[16:31]
    s_waitcnt lgkmcnt(0)
    v_mfma_f32_32x32x16_bf16 v[32:47], a[92:95], v[188:191], v[32:47]
    buffer_load_dwordx4 v[100:103], v4, s[40:43], s56 offen offset:1024 sc1
    s_waitcnt vmcnt(9)
    v_mfma_f32_32x32x16_bf16 v[48:63], a[128:131], v[192:195], v[48:63]
    v_mfma_f32_32x32x16_bf16 v[64:79], a[132:135], v[192:195], 0
    s_nop 7
    ds_write_b32 v237, v32 offset:0
    ds_write_b32 v237, v34 offset:256
    ds_write_b32 v237, v33 offset:128
    ds_write_b32 v237, v35 offset:384
    ds_write_b32 v237, v36 offset:1024
    ds_write_b32 v237, v38 offset:1280
    buffer_load_dwordx4 v[104:107], v4, s[40:43], s56 offen offset:2048 sc1
    s_waitcnt vmcnt(9)
    v_mfma_f32_32x32x16_bf16 v[48:63], a[136:139], v[196:199], v[48:63]
    v_mfma_f32_32x32x16_bf16 v[64:79], a[140:143], v[196:199], v[64:79]
    ds_write_b32 v237, v37 offset:1152
    ds_write_b32 v237, v39 offset:1408
    ds_write_b32 v237, v40 offset:2048
    ds_write_b32 v237, v42 offset:2304
    ds_write_b32 v237, v41 offset:2176
    ds_write_b32 v237, v43 offset:2432
    buffer_load_dwordx4 v[108:111], v4, s[40:43], s56 offen offset:3072 sc1
    s_waitcnt vmcnt(9)
    v_mfma_f32_32x32x16_bf16 v[48:63], a[144:147], v[200:203], v[48:63]
    v_mfma_f32_32x32x16_bf16 v[64:79], a[148:151], v[200:203], v[64:79]
    ds_write_b32 v237, v44 offset:3072
    ds_write_b32 v237, v46 offset:3328
    ds_write_b32 v237, v45 offset:3200
    ds_write_b32 v237, v47 offset:3456
    ds_write_b32 v236, v16 offset:0
    ds_write_b32 v236, v18 offset:256
    s_add_u32 s56, s59, s51
    buffer_load_dwordx4 v[112:115], v4, s[40:43], s56 offen offset:0 sc1
    s_waitcnt vmcnt(9)
    v_mfma_f32_32x32x16_bf16 v[48:63], a[152:155], v[204:207], v[48:63]
    v_mfma_f32_32x32x16_bf16 v[64:79], a[156:159], v[204:207], v[64:79]
    ds_write_b32 v236, v17 offset:128
    ds_write_b32 v236, v19 offset:384
    ds_write_b32 v236, v20 offset:1024
    ds_write_b32 v236, v22 offset:1280
    ds_write_b32 v236, v21 offset:1152
    ds_write_b32 v236, v23 offset:1408
    buffer_load_dwordx4 v[116:119], v4, s[40:43], s56 offen offset:1024 sc1
    s_waitcnt vmcnt(9)
    v_mfma_f32_32x32x16_bf16 v[48:63], a[160:163], v[80:83], v[48:63]
    v_mfma_f32_32x32x16_bf16 v[64:79], a[164:167], v[80:83], v[64:79]
    ds_write_b32 v236, v24 offset:2048
    ds_write_b32 v236, v26 offset:2304
    ds_write_b32 v236, v25 offset:2176
    ds_write_b32 v236, v27 offset:2432
    ds_write_b32 v236, v28 offset:3072
    ds_write_b32 v236, v30 offset:3328
    buffer_load_dwordx4 v[120:123], v4, s[40:43], s56 offen offset:2048 sc1
    s_waitcnt vmcnt(9)
    v_mfma_f32_32x32x16_bf16 v[48:63], a[168:171], v[84:87], v[48:63]
    v_mfma_f32_32x32x16_bf16 v[64:79], a[172:175], v[84:87], v[64:79]
    ds_write_b32 v236, v29 offset:3200
    ds_write_b32 v236, v31 offset:3456
    buffer_load_dwordx4 v[124:127], v4, s[40:43], s56 offen offset:3072 sc1
    s_waitcnt vmcnt(9)
    v_mfma_f32_32x32x16_bf16 v[48:63], a[176:179], v[88:91], v[48:63]
    v_mfma_f32_32x32x16_bf16 v[64:79], a[180:183], v[88:91], v[64:79]
    s_add_u32 s56, s59, s52
    buffer_load_dwordx4 v[128:131], v4, s[40:43], s56 offen offset:0 sc1
    s_waitcnt vmcnt(9)
    v_mfma_f32_32x32x16_bf16 v[48:63], a[184:187], v[92:95], v[48:63]
    v_mfma_f32_32x32x16_bf16 v[64:79], a[188:191], v[92:95], v[64:79]
    s_waitcnt lgkmcnt(0)
    s_barrier
    ds_read_b128 v[16:19], v238 offset:0
    ds_read_b128 v[20:23], v238 offset:36864
    ds_read_b128 v[24:27], v239 offset:0
    ds_read_b128 v[28:31], v239 offset:36864
    ds_read_b128 v[32:35], v238 offset:1024
    ds_read_b128 v[36:39], v238 offset:37888
    ds_read_b128 v[40:43], v239 offset:1024
    ds_read_b128 v[44:47], v239 offset:37888
    buffer_load_dwordx4 v[132:135], v4, s[40:43], s56 offen offset:1024 sc1
    s_waitcnt vmcnt(9)
    v_mfma_f32_32x32x16_bf16 v[48:63], a[192:195], v[96:99], v[48:63]
    v_mfma_f32_32x32x16_bf16 v[64:79], a[196:199], v[96:99], v[64:79]
    buffer_load_dwordx4 v[136:139], v4, s[40:43], s56 offen offset:2048 sc1
    s_waitcnt vmcnt(9)
    v_mfma_f32_32x32x16_bf16 v[48:63], a[200:203], v[100:103], v[48:63]
    v_mfma_f32_32x32x16_bf16 v[64:79], a[204:207], v[100:103], v[64:79]
    s_waitcnt lgkmcnt(6)
    v_add_f32 v16, v16, v20
    s_waitcnt lgkmcnt(4)
    v_add_f32 v24, v24, v28
    v_add_f32 v17, v17, v21
    v_add_f32 v25, v25, v29
    v_add_f32 v18, v18, v22
    v_add_f32 v26, v26, v30
    buffer_load_dwordx4 v[140:143], v4, s[40:43], s56 offen offset:3072 sc1
    s_waitcnt vmcnt(9)
    v_mfma_f32_32x32x16_bf16 v[48:63], a[208:211], v[104:107], v[48:63]
    v_mfma_f32_32x32x16_bf16 v[64:79], a[212:215], v[104:107], v[64:79]
    v_add_f32 v19, v19, v23
    v_add_f32 v27, v27, v31
    v_add_f32 v16, v16, v24
    v_add_f32 v17, v17, v25
    v_add_f32 v18, v18, v26
    v_add_f32 v19, v19, v27
    s_add_u32 s56, s59, s53
    buffer_load_dwordx4 v[144:147], v4, s[40:43], s56 offen offset:0 sc1
    s_waitcnt vmcnt(9)
    v_mfma_f32_32x32x16_bf16 v[48:63], a[216:219], v[108:111], v[48:63]
    v_mfma_f32_32x32x16_bf16 v[64:79], a[220:223], v[108:111], v[64:79]
    v_cvt_pk_bf16_f32 v20, v16, v17
    v_cvt_pk_bf16_f32 v21, v18, v19
    buffer_store_dwordx2 v[20:21], v212, s[36:39], s68 offen offset:0
    s_waitcnt lgkmcnt(2)
    v_add_f32 v32, v32, v36
    s_waitcnt lgkmcnt(0)
    v_add_f32 v40, v40, v44
    v_add_f32 v33, v33, v37
    buffer_load_dwordx4 v[148:151], v4, s[40:43], s56 offen offset:1024 sc1
    s_waitcnt vmcnt(10)
    v_mfma_f32_32x32x16_bf16 v[48:63], a[224:227], v[112:115], v[48:63]
    v_mfma_f32_32x32x16_bf16 v[64:79], a[228:231], v[112:115], v[64:79]
    v_add_f32 v41, v41, v45
    v_add_f32 v34, v34, v38
    v_add_f32 v42, v42, v46
    v_add_f32 v35, v35, v39
    v_add_f32_e64 v43, v43, v47
    v_add_f32 v32, v32, v40
    buffer_load_dwordx4 v[152:155], v4, s[40:43], s56 offen offset:2048 sc1
    s_waitcnt vmcnt(10)
    v_mfma_f32_32x32x16_bf16 v[48:63], a[232:235], v[116:119], v[48:63]
    v_mfma_f32_32x32x16_bf16 v[64:79], a[236:239], v[116:119], v[64:79]
    v_add_f32 v33, v33, v41
    v_add_f32 v34, v34, v42
    v_add_f32 v35, v35, v43
    v_cvt_pk_bf16_f32 v36, v32, v33
    v_cvt_pk_bf16_f32 v37, v34, v35
    buffer_store_dwordx2 v[36:37], v212, s[36:39], s69 offen offset:0
    buffer_load_dwordx4 v[156:159], v4, s[40:43], s56 offen offset:3072 sc1
    s_waitcnt vmcnt(11)
    v_mfma_f32_32x32x16_bf16 v[48:63], a[240:243], v[120:123], v[48:63]
    v_mfma_f32_32x32x16_bf16 v[64:79], a[244:247], v[120:123], v[64:79]
    s_add_u32 s56, s59, s54
    buffer_load_dwordx4 v[160:163], v4, s[40:43], s56 offen offset:0 sc1
    s_waitcnt vmcnt(11)
    v_mfma_f32_32x32x16_bf16 v[48:63], a[248:251], v[124:127], v[48:63]
    v_mfma_f32_32x32x16_bf16 v[64:79], a[252:255], v[124:127], v[64:79]
    buffer_load_dwordx4 v[164:167], v4, s[40:43], s56 offen offset:1024 sc1
    s_waitcnt vmcnt(11)
    v_mfma_f32_32x32x16_bf16 v[48:63], a[0:3], v[128:131], v[48:63]
    v_mfma_f32_32x32x16_bf16 v[64:79], a[4:7], v[128:131], v[64:79]
    buffer_load_dwordx4 v[168:171], v4, s[40:43], s56 offen offset:2048 sc1
    s_waitcnt vmcnt(11)
    v_mfma_f32_32x32x16_bf16 v[48:63], a[8:11], v[132:135], v[48:63]
    v_mfma_f32_32x32x16_bf16 v[64:79], a[12:15], v[132:135], v[64:79]
    buffer_load_dwordx4 v[172:175], v4, s[40:43], s56 offen offset:3072 sc1
    s_waitcnt vmcnt(11)
    v_mfma_f32_32x32x16_bf16 v[48:63], a[16:19], v[136:139], v[48:63]
    v_mfma_f32_32x32x16_bf16 v[64:79], a[20:23], v[136:139], v[64:79]
    s_waitcnt vmcnt(10)
    v_mfma_f32_32x32x16_bf16 v[48:63], a[24:27], v[140:143], v[48:63]
    v_mfma_f32_32x32x16_bf16 v[64:79], a[28:31], v[140:143], v[64:79]
    s_waitcnt vmcnt(9)
    v_mfma_f32_32x32x16_bf16 v[48:63], a[32:35], v[144:147], v[48:63]
    v_mfma_f32_32x32x16_bf16 v[64:79], a[36:39], v[144:147], v[64:79]
    s_waitcnt vmcnt(7)
    v_mfma_f32_32x32x16_bf16 v[48:63], a[40:43], v[148:151], v[48:63]
    v_mfma_f32_32x32x16_bf16 v[64:79], a[44:47], v[148:151], v[64:79]
    s_waitcnt vmcnt(6)
    v_mfma_f32_32x32x16_bf16 v[48:63], a[48:51], v[152:155], v[48:63]
    v_mfma_f32_32x32x16_bf16 v[64:79], a[52:55], v[152:155], v[64:79]
    s_waitcnt vmcnt(4)
    v_mfma_f32_32x32x16_bf16 v[48:63], a[56:59], v[156:159], v[48:63]
    v_mfma_f32_32x32x16_bf16 v[64:79], a[60:63], v[156:159], v[64:79]
    s_waitcnt vmcnt(3)
    v_mfma_f32_32x32x16_bf16 v[64:79], a[68:71], v[160:163], v[64:79]
    s_waitcnt vmcnt(2)
    v_mfma_f32_32x32x16_bf16 v[64:79], a[76:79], v[164:167], v[64:79]
    s_waitcnt vmcnt(1)
    v_mfma_f32_32x32x16_bf16 v[64:79], a[84:87], v[168:171], v[64:79]
    s_waitcnt vmcnt(0)
    v_mfma_f32_32x32x16_bf16 v[64:79], a[92:95], v[172:175], v[64:79]
    v_mfma_f32_32x32x16_bf16 v[48:63], a[64:67], v[160:163], v[48:63]
    v_mfma_f32_32x32x16_bf16 v[48:63], a[72:75], v[164:167], v[48:63]
    s_nop 9
    ds_write_b32 v237, v64 offset:8192
    ds_write_b32 v237, v66 offset:8448
    ds_write_b32 v237, v65 offset:8320
    ds_write_b32 v237, v67 offset:8576
    ds_write_b32 v237, v68 offset:9216
    ds_write_b32 v237, v70 offset:9472
    v_mfma_f32_32x32x16_bf16 v[48:63], a[80:83], v[168:171], v[48:63]
    ds_write_b32 v237, v69 offset:9344
    ds_write_b32 v237, v71 offset:9600
    ds_write_b32 v237, v72 offset:10240
    ds_write_b32 v237, v74 offset:10496
    ds_write_b32 v237, v73 offset:10368
    ds_write_b32 v237, v75 offset:10624
    v_mfma_f32_32x32x16_bf16 v[48:63], a[88:91], v[172:175], v[48:63]
    ds_write_b32 v237, v76 offset:11264
    ds_write_b32 v237, v78 offset:11520
    ds_write_b32 v237, v77 offset:11392
    ds_write_b32 v237, v79 offset:11648
    s_nop 7
    ds_write_b32 v236, v48 offset:8192
    ds_write_b32 v236, v50 offset:8448
    ds_write_b32 v236, v49 offset:8320
    ds_write_b32 v236, v51 offset:8576
    ds_write_b32 v236, v52 offset:9216
    ds_write_b32 v236, v54 offset:9472
    ds_write_b32 v236, v53 offset:9344
    ds_write_b32 v236, v55 offset:9600
    ds_write_b32 v236, v56 offset:10240
    ds_write_b32 v236, v58 offset:10496
    ds_write_b32 v236, v57 offset:10368
    ds_write_b32 v236, v59 offset:10624
    ds_write_b32 v236, v60 offset:11264
    ds_write_b32 v236, v62 offset:11520
    ds_write_b32 v236, v61 offset:11392
    ds_write_b32 v236, v63 offset:11648
    s_waitcnt lgkmcnt(0)
    s_barrier
    ds_read_b128 v[48:51], v238 offset:8192
    ds_read_b128 v[52:55], v238 offset:45056
    ds_read_b128 v[56:59], v239 offset:8192
    ds_read_b128 v[60:63], v239 offset:45056
    ds_read_b128 v[64:67], v238 offset:9216
    ds_read_b128 v[68:71], v238 offset:46080
    ds_read_b128 v[72:75], v239 offset:9216
    ds_read_b128 v[76:79], v239 offset:46080
    s_waitcnt lgkmcnt(6)
    v_pk_add_f32 v[48:49], v[48:49], v[52:53]
    s_waitcnt lgkmcnt(4)
    v_pk_add_f32 v[56:57], v[56:57], v[60:61]
    v_pk_add_f32 v[50:51], v[50:51], v[54:55]
    v_pk_add_f32 v[58:59], v[58:59], v[62:63]
    v_pk_add_f32 v[48:49], v[48:49], v[56:57]
    v_pk_add_f32 v[50:51], v[50:51], v[58:59]
    v_cvt_pk_bf16_f32 v52, v48, v49
    v_cvt_pk_bf16_f32 v53, v50, v51
    buffer_store_dwordx2 v[52:53], v212, s[36:39], s68 offen offset:64
    s_waitcnt lgkmcnt(2)
    v_pk_add_f32 v[64:65], v[64:65], v[68:69]
    s_waitcnt lgkmcnt(0)
    v_pk_add_f32 v[72:73], v[72:73], v[76:77]
    v_pk_add_f32 v[66:67], v[66:67], v[70:71]
    v_pk_add_f32 v[74:75], v[74:75], v[78:79]
    v_pk_add_f32 v[64:65], v[64:65], v[72:73]
    v_pk_add_f32 v[66:67], v[66:67], v[74:75]
    v_cvt_pk_bf16_f32 v68, v64, v65
    v_cvt_pk_bf16_f32 v69, v66, v67
    buffer_store_dwordx2 v[68:69], v212, s[36:39], s69 offen offset:64
L_end_P:
    s_endpgm

.section .rodata,"a"
.p2align 6
.amdhsa_kernel sequential_preLN__sliding_local_dilated__mixer_token_mlp__prompt_kernel
  .amdhsa_next_free_vgpr 508
  .amdhsa_next_free_sgpr 102
  .amdhsa_accum_offset 252
  .amdhsa_group_segment_fixed_size 0
  .amdhsa_kernarg_size 88
  .amdhsa_user_sgpr_count 2
  .amdhsa_user_sgpr_kernarg_segment_ptr 1
  .amdhsa_system_sgpr_workgroup_id_x 1
.end_amdhsa_kernel
```
